```python
import torch

def _softmax(x, axis=-1):
    return torch.softmax(x, dim=axis)
def _gelu(x):
    return torch.nn.functional.gelu(x, approximate="tanh")
def _silu(x):
    return torch.nn.functional.silu(x)
def _sigmoid(x):
    return torch.sigmoid(x)
def _layernorm(x, axis=-1, eps=1e-5):
    m = x.mean(dim=axis, keepdim=True)
    v = x.var(dim=axis, keepdim=True, unbiased=False)
    return (x - m) / torch.sqrt(v + eps)
def _scatter_add(tgt, idx, src, axis=0):
    return tgt.clone().index_add_(axis, idx, src)
def _segment_sum(src, seg, n):
    out = torch.zeros((n,) + src.shape[1:], dtype=src.dtype)
    return out.index_add_(0, seg, src)
def _pad(x, pw):
    flat = tuple(v for pair in reversed(pw) for v in pair)
    return torch.nn.functional.pad(x, flat)

kernel_name = 'concat_heads__mha_block_cached__gqa_block_cached__near_ridge'

def setup_inputs():

    _w = (lambda a: (lambda t: t.to(torch.bfloat16) if t.is_floating_point() else t)(torch.as_tensor(a)))
    def _A_setup():
        B, Sq, D = 16, 160, 640
        H, Sk, Dh = 32, 512, 192
        return {
            "x": _w((lambda *s: torch.randn(*s, dtype=torch.bfloat16) * 0.8)(B, Sq, D)),
            "k_cache": _w((lambda *s: torch.randn(*s, dtype=torch.bfloat16) * 0.8)(B, H, Sk, Dh)),
            "v_cache": _w((lambda *s: torch.randn(*s, dtype=torch.bfloat16) * 0.05)(B, H, Sk, Dh)),
            "wq": _w((lambda *s: torch.randn(*s, dtype=torch.bfloat16) * 0.8)(D, H * Dh) * (D ** -0.5)),
            "wo": _w((lambda *s: torch.randn(*s, dtype=torch.bfloat16) * 0.05)(H * Dh, D) * ((H * Dh) ** -0.5)),
        }
    _A_in = _A_setup()

    def _B_setup():
        B, Sq, D = 16, 160, 640
        Hq, Hkv, Sk, Dh = 32, 32, 512, 192
        assert Hq % Hkv == 0, (Hq, Hkv)
        return {
            "x": _w((lambda *s: torch.randn(*s, dtype=torch.bfloat16) * 0.8)(B, Sq, D)),
            "k_cache": _w((lambda *s: torch.randn(*s, dtype=torch.bfloat16) * 0.8)(B, Hkv, Sk, Dh)),
            "v_cache": _w((lambda *s: torch.randn(*s, dtype=torch.bfloat16) * 0.05)(B, Hkv, Sk, Dh)),
            "wq": _w((lambda *s: torch.randn(*s, dtype=torch.bfloat16) * 0.8)(D, Hq * Dh) * (D ** -0.5)),
            "wo": _w((lambda *s: torch.randn(*s, dtype=torch.bfloat16) * 0.05)(Hq * Dh, D) * ((Hq * Dh) ** -0.5)),
        }
    _B_in = _B_setup()

    return {
        "A_x": _A_in["x"],
        "A_k_cache": _A_in["k_cache"],
        "A_v_cache": _A_in["v_cache"],
        "A_wq": _A_in["wq"],
        "A_wo": _A_in["wo"],
        "B_x": _B_in["x"],
        "B_k_cache": _B_in["k_cache"],
        "B_v_cache": _B_in["v_cache"],
        "B_wq": _B_in["wq"],
        "B_wo": _B_in["wo"],
    }

def reference(A_x, A_k_cache, A_v_cache, A_wq, A_wo, B_x, B_k_cache, B_v_cache, B_wq, B_wo):
    def _A_ref(x, k_cache, v_cache, wq, wo):
        B, Sq, D = x.shape
        H, Dh = 32, 192
        q = (lambda x, *d: x.permute(*d))((x @ wq).reshape(B, Sq, H, Dh), 0, 2, 1, 3)
        scores = torch.einsum("bhqd,bhkd->bhqk", q, k_cache) * (Dh ** -0.5)
        p = _softmax(scores, axis=-1)
        o = torch.einsum("bhqk,bhkd->bhqd", p, v_cache)
        return (lambda x, *d: x.permute(*d))(o, 0, 2, 1, 3).reshape(B, Sq, H * Dh) @ wo

    def _B_ref(x, k_cache, v_cache, wq, wo):
        B, Sq, D = x.shape
        Hq, Dh = 32, 192
        Hkv = k_cache.shape[1]
        rep = Hq // Hkv
        q = (lambda x, *d: x.permute(*d))((x @ wq).reshape(B, Sq, Hq, Dh), 0, 2, 1, 3)
        k = (lambda x, n, axis: torch.repeat_interleave(x, n, dim=axis))(k_cache, rep, axis=1)
        v = (lambda x, n, axis: torch.repeat_interleave(x, n, dim=axis))(v_cache, rep, axis=1)
        scores = torch.einsum("bhqd,bhkd->bhqk", q, k) * (Dh ** -0.5)
        p = _softmax(scores, axis=-1)
        o = torch.einsum("bhqk,bhkd->bhqd", p, v)
        return (lambda x, *d: x.permute(*d))(o, 0, 2, 1, 3).reshape(B, Sq, Hq * Dh) @ wo

    a = _A_ref(A_x, A_k_cache, A_v_cache, A_wq, A_wo)
    b = _B_ref(B_x, B_k_cache, B_v_cache, B_wq, B_wo)
    return torch.concatenate([a, b], axis=-1)
```

```asm
; @launch grid=(256,1,1) block=(256,1,1) lds=163840
.amdgcn_target "amdgcn-amd-amdhsa--gfx950"
.text
.globl concat_heads__mha_block_cached__gqa_block_cached__near_ridge_kernel
.p2align 8
.type concat_heads__mha_block_cached__gqa_block_cached__near_ridge_kernel,@function
concat_heads__mha_block_cached__gqa_block_cached__near_ridge_kernel:
s_cmp_ge_u32 s2, 256
s_cbranch_scc1 L_concat_heads__mha_block_cached__gqa_block_cached__near_ridge_kernel_done
s_getpc_b64 s[4:5]
L_concat_heads__mha_block_cached__gqa_block_cached__near_ridge_kernel_pc:
s_lshr_b32 s88, s2, 3
s_lshl_b32 s88, s88, 12
v_lshlrev_b32 v4, 4, v0
v_add_u32 v4, s88, v4
v_min_u32 v4, L_concat_heads__mha_block_cached__gqa_block_cached__near_ridge_kernel_end-L_concat_heads__mha_block_cached__gqa_block_cached__near_ridge_kernel_pc-16, v4
global_load_dwordx4 a[236:239], v4, s[4:5]
s_and_b32 s88, s2, 7
s_lshr_b32 s89, s2, 3
s_lshr_b32 s90, s88, 2
s_and_b32 s91, s88, 3
s_lshl_b32 s91, s91, 2
s_lshr_b32 s92, s89, 3
s_add_u32 s91, s91, s92
s_and_b32 s92, s89, 7
s_mul_i32 s4, s90, 40
s_add_u32 s4, s0, s4
s_addc_u32 s5, s1, 0
s_load_dwordx2 s[8:9], s[4:5], 0
s_load_dwordx2 s[12:13], s[4:5], 8
s_load_dwordx2 s[16:17], s[4:5], 16
s_load_dwordx2 s[20:21], s[4:5], 24
s_load_dwordx2 s[60:61], s[4:5], 32
s_load_dwordx2 s[68:69], s[0:1], 80
s_load_dwordx2 s[72:73], s[0:1], 88
s_load_dwordx2 s[6:7], s[0:1], 96
v_lshrrev_b32 v1, 6, v0
v_and_b32 v0, 63, v0
v_readfirstlane_b32 s28, v1
s_nop 3
s_lshr_b32 s29, s28, 1
s_and_b32 s30, s28, 1
v_add_u32 v3, 0, v0
v_mul_u32_u24 v1, 171, v3
v_lshrrev_b32 v1, 12, v1
v_mul_u32_u24 v2, 24, v1
v_sub_u32 v2, v3, v2
v_bfe_u32 v4, v1, 1, 1
v_mul_u32_u24 v5, 3, v4
v_and_b32 v6, 4, v1
v_or_b32 v5, v5, v6
v_xor_b32 v5, v5, v2
v_lshlrev_b32 v5, 4, v5
v_mul_u32_u24 v6, 384, v1
v_add_u32 v5, v5, v6
v_subrev_u32 v245, 0, v5
v_and_b32 v5, 2, v1
s_lshl_b32 s93, s30, 2
v_or_b32 v5, s93, v5
v_xor_b32 v5, v5, v2
v_lshlrev_b32 v5, 4, v5
v_mul_u32_u24 v6, 12288, v1
v_add_u32 v5, v5, v6
v_subrev_u32 v248, 0, v5
v_add_u32 v3, 64, v0
v_mul_u32_u24 v1, 171, v3
v_lshrrev_b32 v1, 12, v1
v_mul_u32_u24 v2, 24, v1
v_sub_u32 v2, v3, v2
v_bfe_u32 v4, v1, 1, 1
v_mul_u32_u24 v5, 3, v4
v_and_b32 v6, 4, v1
v_or_b32 v5, v5, v6
v_xor_b32 v5, v5, v2
v_lshlrev_b32 v5, 4, v5
v_mul_u32_u24 v6, 384, v1
v_add_u32 v5, v5, v6
v_subrev_u32 v246, 1024, v5
v_and_b32 v5, 2, v1
s_lshl_b32 s93, s30, 2
v_or_b32 v5, s93, v5
v_xor_b32 v5, v5, v2
v_lshlrev_b32 v5, 4, v5
v_mul_u32_u24 v6, 12288, v1
v_add_u32 v5, v5, v6
v_subrev_u32 v249, 1024, v5
v_add_u32 v3, 128, v0
v_mul_u32_u24 v1, 171, v3
v_lshrrev_b32 v1, 12, v1
v_mul_u32_u24 v2, 24, v1
v_sub_u32 v2, v3, v2
v_bfe_u32 v4, v1, 1, 1
v_mul_u32_u24 v5, 3, v4
v_and_b32 v6, 4, v1
v_or_b32 v5, v5, v6
v_xor_b32 v5, v5, v2
v_lshlrev_b32 v5, 4, v5
v_mul_u32_u24 v6, 384, v1
v_add_u32 v5, v5, v6
v_subrev_u32 v247, 2048, v5
v_and_b32 v5, 2, v1
s_lshl_b32 s93, s30, 2
v_or_b32 v5, s93, v5
v_xor_b32 v5, v5, v2
v_lshlrev_b32 v5, 4, v5
v_mul_u32_u24 v6, 12288, v1
v_add_u32 v5, v5, v6
v_subrev_u32 v250, 2048, v5
v_lshrrev_b32 v1, 3, v0
v_and_b32 v2, 7, v0
v_and_b32 v4, 6, v1
v_xor_b32 v2, v2, v4
v_lshlrev_b32 v2, 4, v2
v_mul_u32_u24 v1, 1280, v1
v_add_u32 v251, v1, v2
s_mul_i32 s93, s29, 12288
s_mul_i32 s94, s30, 6144
s_add_u32 s37, s93, s94
s_mul_i32 s94, s30, 3072
s_add_u32 s38, s93, s94
s_mul_i32 s85, s28, 5120
s_lshl_b32 s95, s92, 2
s_add_u32 s95, s95, s29
s_mul_i32 s48, s95, 384
s_mul_i32 s94, s30, 98304
s_add_u32 s48, s48, s94
s_sub_u32 s48, s48, 768
s_mul_i32 s49, s91, 204800
s_mul_i32 s94, s28, 51200
s_add_u32 s49, s49, s94
s_mul_i32 s55, s28, 5120
s_and_b32 s93, s88, 3
s_mul_i32 s93, s93, 5
s_add_u32 s93, s93, 1
s_lshr_b32 s93, s93, 1
s_mul_i32 s87, s93, 786432
s_lshl_b32 s3, s93, 7
s_mov_b32 s31, 0
s_mov_b32 s32, 0
s_lshl_b32 s76, s28, 12
s_add_u32 s76, s76, 147456
s_waitcnt lgkmcnt(0)
s_and_b32 s9, s9, 0xffff
s_mov_b32 s10, 3276800
s_mov_b32 s11, 0x20000
s_and_b32 s13, s13, 0xffff
s_mov_b32 s14, 100663296
s_mov_b32 s15, 0x20000
s_and_b32 s17, s17, 0xffff
s_mov_b32 s18, 100663296
s_mov_b32 s19, 0x20000
s_and_b32 s21, s21, 0xffff
s_mov_b32 s22, 7864320
s_mov_b32 s23, 0x20000
s_and_b32 s61, s61, 0xffff
s_mov_b32 s62, 7864320
s_mov_b32 s63, 0x20000
s_and_b32 s69, s69, 0xffff
s_mov_b32 s70, 6553600
s_mov_b32 s71, 0x20000
s_and_b32 s73, s73, 0xffff
s_mov_b32 s74, 256
s_mov_b32 s75, 0x20000
s_add_u32 s48, s48, 768
s_mov_b32 s35, s87
s_mov_b32 s54, s3
s_add_u32 m0, s31, s38
s_add_u32 s40, s35, s48
buffer_load_dwordx4 v248, s[20:23], s40 offen offset:0 lds
buffer_load_dwordx4 v249, s[20:23], s40 offen offset:1024 lds
buffer_load_dwordx4 v250, s[20:23], s40 offen offset:2048 lds
s_add_u32 m0, m0, 6144
s_add_u32 s40, s40, 196608
buffer_load_dwordx4 v248, s[20:23], s40 offen offset:0 lds
buffer_load_dwordx4 v249, s[20:23], s40 offen offset:1024 lds
buffer_load_dwordx4 v250, s[20:23], s40 offen offset:2048 lds
s_add_u32 s35, s35, 393216
s_sub_u32 s40, s35, 7864320
s_min_u32 s35, s35, s40
s_add_u32 s31, s31, 24576
s_sub_u32 s41, s31, 147456
s_min_u32 s31, s31, s41
s_add_u32 m0, s31, s55
s_add_u32 s40, s54, s49
buffer_load_dwordx4 v251, s[8:11], s40 offen offset:0 lds
s_add_u32 s40, s40, 9216
buffer_load_dwordx4 v251, s[8:11], s40 offen offset:1024 lds
s_add_u32 s40, s40, 9216
buffer_load_dwordx4 v251, s[8:11], s40 offen offset:2048 lds
s_add_u32 s40, s40, 9216
buffer_load_dwordx4 v251, s[8:11], s40 offen offset:3072 lds
s_add_u32 m0, m0, 4096
s_add_u32 s40, s40, 13312
buffer_load_dwordx4 v251, s[8:11], s40 offen lds
s_add_u32 s54, s54, 128
s_sub_u32 s40, s54, 1280
s_min_u32 s54, s54, s40
s_add_u32 s31, s31, 24576
s_sub_u32 s41, s31, 147456
s_min_u32 s31, s31, s41
s_and_b32 s93, s88, 3
s_lshl_b32 s93, s93, 5
s_add_u32 s93, s93, s89
s_lshl_b32 s93, s93, 2
s_add_u32 s93, s93, s28
s_mul_i32 s59, s93, 15360
s_lshl_b32 s94, s92, 2
s_add_u32 s94, s94, s28
s_mul_i32 s94, s94, 6400
s_mul_i32 s93, s91, 204800
s_add_u32 s93, s93, s94
s_mov_b32 m0, s76
v_lshlrev_b32 v4, 7, v0
buffer_load_dword v4, s[8:11], s93 offen lds
v_and_b32 v1, 15, v0
v_lshrrev_b32 v2, 4, v0
s_mul_i32 s93, s29, 12288
v_and_b32 v3, 1, v2
v_lshlrev_b32 v3, 1, v3
v_lshrrev_b32 v4, 1, v2
v_or_b32 v3, v3, v4
v_bfe_u32 v4, v1, 1, 1
v_mul_u32_u24 v4, 3, v4
v_and_b32 v5, 4, v1
v_or_b32 v4, v4, v5
v_xor_b32 v3, v3, v4
v_lshlrev_b32 v3, 4, v3
v_mul_u32_u24 v4, 384, v1
v_add3_u32 v252, v3, v4, s93
v_lshrrev_b32 v3, 2, v1
v_and_b32 v4, 3, v0
v_lshl_add_u32 v5, v2, 2, v3
v_bfe_u32 v6, v5, 1, 1
v_mul_u32_u24 v6, 3, v6
v_and_b32 v7, 4, v5
v_or_b32 v6, v6, v7
v_lshrrev_b32 v7, 1, v4
v_xor_b32 v6, v6, v7
v_lshlrev_b32 v6, 4, v6
v_and_b32 v8, 1, v4
v_lshl_add_u32 v6, v8, 3, v6
v_mul_u32_u24 v5, 384, v5
v_add3_u32 v253, v5, v6, s93
v_lshl_add_u32 v5, v2, 3, v3
v_and_b32 v6, 2, v3
v_and_b32 v9, 1, v2
v_lshl_or_b32 v6, v9, 2, v6
v_xor_b32 v6, v6, v7
v_lshlrev_b32 v6, 4, v6
v_lshl_add_u32 v6, v8, 3, v6
v_mul_u32_u24 v5, 384, v5
v_add3_u32 v254, v5, v6, s93
s_mul_i32 s93, s30, 10240
v_lshrrev_b32 v3, 3, v1
v_lshlrev_b32 v3, 10, v3
v_and_b32 v4, 7, v1
v_lshl_add_u32 v3, v4, 7, v3
v_and_b32 v4, 6, v1
v_xor_b32 v4, v4, v2
v_lshlrev_b32 v4, 4, v4
v_add3_u32 v255, v3, v4, s93
s_lshl_b32 s96, s91, 5
s_add_u32 s96, s96, s95
s_mul_i32 s33, s96, 196608
s_mul_i32 s94, s30, 6144
s_add_u32 s33, s33, s94
s_mov_b32 s34, s33
s_lshl_b32 s97, s90, 4
s_add_u32 s97, s97, s91
s_mul_i32 s93, s97, 1966080
s_add_u32 s93, s93, 0
s_add_u32 s24, s6, s93
s_addc_u32 s25, s7, 0
s_and_b32 s25, s25, 0xffff
s_mov_b32 s26, 0
s_mov_b32 s36, 0
s_mov_b32 s27, 0x20000
s_mul_i32 s93, s92, 24
s_mul_i32 s94, s29, 6
s_add_u32 s93, s93, s94
s_mul_i32 s47, s93, 10240
s_mul_i32 s94, s30, 5120
s_add_u32 s47, s47, s94
s_lshr_b32 s93, s92, 2
s_and_b32 s94, s92, 3
s_mul_i32 s83, s29, 30720
s_add_u32 s83, s83, 10240
s_mul_i32 s82, s93, 96
s_mul_i32 s82, s82, s83
s_mul_i32 s95, s94, 320
s_mul_i32 s95, s95, s29
s_add_u32 s82, s82, s95
s_lshr_b32 s95, s83, 1
s_mul_i32 s95, s95, s30
s_add_u32 s82, s82, s95
s_mul_i32 s100, s93, 96
s_mul_i32 s100, s100, s83
s_mul_i32 s95, s94, 3
s_and_b32 s96, s91, 3
s_add_u32 s95, s95, s96
s_mul_i32 s95, s95, s29
s_add_u32 s95, s95, s94
s_mul_i32 s95, s95, 5120
s_add_u32 s100, s100, s95
s_mul_i32 s95, s30, 2560
s_add_u32 s100, s100, s95
s_mov_b32 s67, s82
s_and_b32 s66, s88, 3
s_mul_i32 s95, s66, 24
s_mul_i32 s95, s95, s83
s_add_u32 s82, s82, s95
s_mul_i32 s84, s91, 409600
s_mul_i32 s95, s30, 204800
s_add_u32 s84, s84, s95
s_mul_i32 s95, s90, 1280
s_add_u32 s84, s84, s95
s_mul_i32 s95, s94, 320
s_add_u32 s84, s84, s95
s_mul_i32 s95, s29, 160
s_add_u32 s84, s84, s95
s_mov_b32 s56, s92
s_lshl_b32 s95, s97, 3
s_add_u32 s93, s95, s92
s_lshl_b32 s93, s93, 2
s_add_u32 s93, s93, s28
s_mul_i32 s57, s93, 13312
s_lshl_b32 s64, s93, 7
s_add_u32 s64, s64, 13631488
s_xor_b32 s93, s93, 16
s_mul_i32 s58, s93, 13312
s_lshl_b32 s65, s93, 7
s_add_u32 s65, s65, 13631488
s_lshl_b32 s77, s97, 3
s_mov_b32 s46, 0x3dd53b95
s_mov_b32 s45, 0
s_mov_b32 s52, 0
s_mov_b32 s53, 0
s_add_u32 m0, s31, s38
s_add_u32 s40, s35, s48
buffer_load_dwordx4 v248, s[20:23], s40 offen offset:0 lds
buffer_load_dwordx4 v249, s[20:23], s40 offen offset:1024 lds
buffer_load_dwordx4 v250, s[20:23], s40 offen offset:2048 lds
s_add_u32 m0, m0, 6144
s_add_u32 s40, s40, 196608
buffer_load_dwordx4 v248, s[20:23], s40 offen offset:0 lds
buffer_load_dwordx4 v249, s[20:23], s40 offen offset:1024 lds
buffer_load_dwordx4 v250, s[20:23], s40 offen offset:2048 lds
s_add_u32 s35, s35, 393216
s_sub_u32 s40, s35, 7864320
s_min_u32 s35, s35, s40
s_add_u32 s31, s31, 24576
s_sub_u32 s41, s31, 147456
s_min_u32 s31, s31, s41
s_add_u32 m0, s31, s38
s_add_u32 s40, s35, s48
buffer_load_dwordx4 v248, s[20:23], s40 offen offset:0 lds
buffer_load_dwordx4 v249, s[20:23], s40 offen offset:1024 lds
buffer_load_dwordx4 v250, s[20:23], s40 offen offset:2048 lds
s_add_u32 m0, m0, 6144
s_add_u32 s40, s40, 196608
buffer_load_dwordx4 v248, s[20:23], s40 offen offset:0 lds
buffer_load_dwordx4 v249, s[20:23], s40 offen offset:1024 lds
buffer_load_dwordx4 v250, s[20:23], s40 offen offset:2048 lds
s_add_u32 s35, s35, 393216
s_sub_u32 s40, s35, 7864320
s_min_u32 s35, s35, s40
s_add_u32 s31, s31, 24576
s_sub_u32 s41, s31, 147456
s_min_u32 s31, s31, s41
L_concat_heads__mha_block_cached__gqa_block_cached__near_ridge_kernel_unit:
v_mbcnt_lo_u32_b32 v0, -1, 0
v_mbcnt_hi_u32_b32 v0, -1, v0
v_lshlrev_b32 v1, 7, v0
v_cmp_gt_u32 vcc, 24, v0
v_mov_b32 v2, 0x7ffffff0
s_nop 0
v_cndmask_b32 v238, v2, v1, vcc
v_lshlrev_b32 v239, 4, v0
v_add_u32 v225, 4096, v239
s_cmp_eq_u32 s45, 0
s_cbranch_scc1 L_concat_heads__mha_block_cached__gqa_block_cached__near_ridge_kernel_nodrain
v_accvgpr_read_b32 v8, a0
v_accvgpr_read_b32 v9, a1
v_accvgpr_read_b32 v10, a2
v_accvgpr_read_b32 v11, a3
v_pk_mul_f32 v[8:9], v[8:9], v[220:221] op_sel_hi:[1,0]
v_pk_mul_f32 v[10:11], v[10:11], v[220:221] op_sel_hi:[1,0]
v_cvt_pk_bf16_f32 v48, v8, v9
v_cvt_pk_bf16_f32 v49, v10, v11
v_accvgpr_read_b32 v12, a20
v_accvgpr_read_b32 v13, a21
v_accvgpr_read_b32 v14, a22
v_accvgpr_read_b32 v15, a23
v_pk_mul_f32 v[12:13], v[12:13], v[220:221] op_sel_hi:[1,0]
v_pk_mul_f32 v[14:15], v[14:15], v[220:221] op_sel_hi:[1,0]
v_cvt_pk_bf16_f32 v50, v12, v13
v_cvt_pk_bf16_f32 v51, v14, v15
s_add_u32 s39, s47, 0
buffer_store_dwordx4 v[48:51], v239, s[24:27], s39 offen offset:0 sc1
v_accvgpr_read_b32 v16, a4
v_accvgpr_read_b32 v17, a5
v_accvgpr_read_b32 v18, a6
v_accvgpr_read_b32 v19, a7
v_pk_mul_f32 v[16:17], v[16:17], v[220:221] op_sel:[0,1] op_sel_hi:[1,1]
v_pk_mul_f32 v[18:19], v[18:19], v[220:221] op_sel:[0,1] op_sel_hi:[1,1]
v_cvt_pk_bf16_f32 v52, v16, v17
v_cvt_pk_bf16_f32 v53, v18, v19
v_accvgpr_read_b32 v20, a24
v_accvgpr_read_b32 v21, a25
v_accvgpr_read_b32 v22, a26
v_accvgpr_read_b32 v23, a27
v_pk_mul_f32 v[20:21], v[20:21], v[220:221] op_sel:[0,1] op_sel_hi:[1,1]
v_pk_mul_f32 v[22:23], v[22:23], v[220:221] op_sel:[0,1] op_sel_hi:[1,1]
v_cvt_pk_bf16_f32 v54, v20, v21
v_cvt_pk_bf16_f32 v55, v22, v23
buffer_store_dwordx4 v[52:55], v239, s[24:27], s39 offen offset:1024 sc1
v_accvgpr_read_b32 v24, a8
v_accvgpr_read_b32 v25, a9
v_accvgpr_read_b32 v26, a10
v_accvgpr_read_b32 v27, a11
v_pk_mul_f32 v[24:25], v[24:25], v[222:223] op_sel_hi:[1,0]
v_pk_mul_f32 v[26:27], v[26:27], v[222:223] op_sel_hi:[1,0]
v_cvt_pk_bf16_f32 v56, v24, v25
v_cvt_pk_bf16_f32 v57, v26, v27
v_accvgpr_read_b32 v28, a28
v_accvgpr_read_b32 v29, a29
v_accvgpr_read_b32 v30, a30
v_accvgpr_read_b32 v31, a31
v_pk_mul_f32 v[28:29], v[28:29], v[222:223] op_sel_hi:[1,0]
v_pk_mul_f32 v[30:31], v[30:31], v[222:223] op_sel_hi:[1,0]
v_cvt_pk_bf16_f32 v58, v28, v29
v_cvt_pk_bf16_f32 v59, v30, v31
buffer_store_dwordx4 v[56:59], v239, s[24:27], s39 offen offset:2048 sc1
v_accvgpr_read_b32 v32, a12
v_accvgpr_read_b32 v33, a13
v_accvgpr_read_b32 v34, a14
v_accvgpr_read_b32 v35, a15
v_pk_mul_f32 v[32:33], v[32:33], v[222:223] op_sel:[0,1] op_sel_hi:[1,1]
v_pk_mul_f32 v[34:35], v[34:35], v[222:223] op_sel:[0,1] op_sel_hi:[1,1]
v_cvt_pk_bf16_f32 v60, v32, v33
v_cvt_pk_bf16_f32 v61, v34, v35
v_accvgpr_read_b32 v36, a32
v_accvgpr_read_b32 v37, a33
v_accvgpr_read_b32 v38, a34
v_accvgpr_read_b32 v39, a35
v_pk_mul_f32 v[36:37], v[36:37], v[222:223] op_sel:[0,1] op_sel_hi:[1,1]
v_pk_mul_f32 v[38:39], v[38:39], v[222:223] op_sel:[0,1] op_sel_hi:[1,1]
v_cvt_pk_bf16_f32 v62, v36, v37
v_cvt_pk_bf16_f32 v63, v38, v39
buffer_store_dwordx4 v[60:63], v239, s[24:27], s39 offen offset:3072 sc1
v_accvgpr_read_b32 v8, a16
v_accvgpr_read_b32 v9, a17
v_accvgpr_read_b32 v10, a18
v_accvgpr_read_b32 v11, a19
v_pk_mul_f32 v[8:9], v[8:9], v[224:225] op_sel_hi:[1,0]
v_pk_mul_f32 v[10:11], v[10:11], v[224:225] op_sel_hi:[1,0]
v_cvt_pk_bf16_f32 v48, v8, v9
v_cvt_pk_bf16_f32 v49, v10, v11
v_accvgpr_read_b32 v12, a36
v_accvgpr_read_b32 v13, a37
v_accvgpr_read_b32 v14, a38
v_accvgpr_read_b32 v15, a39
v_pk_mul_f32 v[12:13], v[12:13], v[224:225] op_sel_hi:[1,0]
v_pk_mul_f32 v[14:15], v[14:15], v[224:225] op_sel_hi:[1,0]
v_cvt_pk_bf16_f32 v50, v12, v13
v_cvt_pk_bf16_f32 v51, v14, v15
buffer_store_dwordx4 v[48:51], v225, s[24:27], s39 offen sc1
v_accvgpr_read_b32 v16, a40
v_accvgpr_read_b32 v17, a41
v_accvgpr_read_b32 v18, a42
v_accvgpr_read_b32 v19, a43
v_pk_mul_f32 v[16:17], v[16:17], v[220:221] op_sel_hi:[1,0]
v_pk_mul_f32 v[18:19], v[18:19], v[220:221] op_sel_hi:[1,0]
v_cvt_pk_bf16_f32 v52, v16, v17
v_cvt_pk_bf16_f32 v53, v18, v19
v_accvgpr_read_b32 v20, a60
v_accvgpr_read_b32 v21, a61
v_accvgpr_read_b32 v22, a62
v_accvgpr_read_b32 v23, a63
v_pk_mul_f32 v[20:21], v[20:21], v[220:221] op_sel_hi:[1,0]
v_pk_mul_f32 v[22:23], v[22:23], v[220:221] op_sel_hi:[1,0]
v_cvt_pk_bf16_f32 v54, v20, v21
v_cvt_pk_bf16_f32 v55, v22, v23
s_add_u32 s39, s47, 10240
buffer_store_dwordx4 v[52:55], v239, s[24:27], s39 offen offset:0 sc1
v_accvgpr_read_b32 v24, a44
v_accvgpr_read_b32 v25, a45
v_accvgpr_read_b32 v26, a46
v_accvgpr_read_b32 v27, a47
v_pk_mul_f32 v[24:25], v[24:25], v[220:221] op_sel:[0,1] op_sel_hi:[1,1]
v_pk_mul_f32 v[26:27], v[26:27], v[220:221] op_sel:[0,1] op_sel_hi:[1,1]
v_cvt_pk_bf16_f32 v56, v24, v25
v_cvt_pk_bf16_f32 v57, v26, v27
v_accvgpr_read_b32 v28, a64
v_accvgpr_read_b32 v29, a65
v_accvgpr_read_b32 v30, a66
v_accvgpr_read_b32 v31, a67
v_pk_mul_f32 v[28:29], v[28:29], v[220:221] op_sel:[0,1] op_sel_hi:[1,1]
v_pk_mul_f32 v[30:31], v[30:31], v[220:221] op_sel:[0,1] op_sel_hi:[1,1]
v_cvt_pk_bf16_f32 v58, v28, v29
v_cvt_pk_bf16_f32 v59, v30, v31
buffer_store_dwordx4 v[56:59], v239, s[24:27], s39 offen offset:1024 sc1
v_accvgpr_read_b32 v32, a48
v_accvgpr_read_b32 v33, a49
v_accvgpr_read_b32 v34, a50
v_accvgpr_read_b32 v35, a51
v_pk_mul_f32 v[32:33], v[32:33], v[222:223] op_sel_hi:[1,0]
v_pk_mul_f32 v[34:35], v[34:35], v[222:223] op_sel_hi:[1,0]
v_cvt_pk_bf16_f32 v60, v32, v33
v_cvt_pk_bf16_f32 v61, v34, v35
v_accvgpr_read_b32 v36, a68
v_accvgpr_read_b32 v37, a69
v_accvgpr_read_b32 v38, a70
v_accvgpr_read_b32 v39, a71
v_pk_mul_f32 v[36:37], v[36:37], v[222:223] op_sel_hi:[1,0]
v_pk_mul_f32 v[38:39], v[38:39], v[222:223] op_sel_hi:[1,0]
v_cvt_pk_bf16_f32 v62, v36, v37
v_cvt_pk_bf16_f32 v63, v38, v39
buffer_store_dwordx4 v[60:63], v239, s[24:27], s39 offen offset:2048 sc1
v_accvgpr_read_b32 v8, a52
v_accvgpr_read_b32 v9, a53
v_accvgpr_read_b32 v10, a54
v_accvgpr_read_b32 v11, a55
v_pk_mul_f32 v[8:9], v[8:9], v[222:223] op_sel:[0,1] op_sel_hi:[1,1]
v_pk_mul_f32 v[10:11], v[10:11], v[222:223] op_sel:[0,1] op_sel_hi:[1,1]
v_cvt_pk_bf16_f32 v48, v8, v9
v_cvt_pk_bf16_f32 v49, v10, v11
v_accvgpr_read_b32 v12, a72
v_accvgpr_read_b32 v13, a73
v_accvgpr_read_b32 v14, a74
v_accvgpr_read_b32 v15, a75
v_pk_mul_f32 v[12:13], v[12:13], v[222:223] op_sel:[0,1] op_sel_hi:[1,1]
v_pk_mul_f32 v[14:15], v[14:15], v[222:223] op_sel:[0,1] op_sel_hi:[1,1]
v_cvt_pk_bf16_f32 v50, v12, v13
v_cvt_pk_bf16_f32 v51, v14, v15
buffer_store_dwordx4 v[48:51], v239, s[24:27], s39 offen offset:3072 sc1
v_accvgpr_read_b32 v16, a56
v_accvgpr_read_b32 v17, a57
v_accvgpr_read_b32 v18, a58
v_accvgpr_read_b32 v19, a59
v_pk_mul_f32 v[16:17], v[16:17], v[224:225] op_sel_hi:[1,0]
v_pk_mul_f32 v[18:19], v[18:19], v[224:225] op_sel_hi:[1,0]
v_cvt_pk_bf16_f32 v52, v16, v17
v_cvt_pk_bf16_f32 v53, v18, v19
v_accvgpr_read_b32 v20, a76
v_accvgpr_read_b32 v21, a77
v_accvgpr_read_b32 v22, a78
v_accvgpr_read_b32 v23, a79
v_pk_mul_f32 v[20:21], v[20:21], v[224:225] op_sel_hi:[1,0]
v_pk_mul_f32 v[22:23], v[22:23], v[224:225] op_sel_hi:[1,0]
v_cvt_pk_bf16_f32 v54, v20, v21
v_cvt_pk_bf16_f32 v55, v22, v23
buffer_store_dwordx4 v[52:55], v225, s[24:27], s39 offen sc1
s_waitcnt vmcnt(27) lgkmcnt(0)
s_barrier
v_add_u32 v240, s32, v254
v_xor_b32 v241, 32, v240
v_xor_b32 v242, 64, v240
v_xor_b32 v243, 64, v241
s_add_u32 s32, s32, 24576
s_sub_u32 s42, s32, 147456
s_min_u32 s32, s32, s42
v_add_u32 v244, s32, v255
s_add_u32 s32, s32, 24576
s_sub_u32 s42, s32, 147456
s_min_u32 s32, s32, s42
ds_read_b64_tr_b16 a[240:241], v240 offset:0
ds_read_b64_tr_b16 a[242:243], v240 offset:1536
ds_read_b128 a[0:3], v244 offset:0
ds_read_b128 a[4:7], v244 offset:2048
ds_read_b128 a[8:11], v244 offset:4096
ds_read_b128 a[12:15], v244 offset:6144
ds_read_b128 a[16:19], v244 offset:8192
ds_read_b64_tr_b16 a[244:245], v241 offset:0
ds_read_b64_tr_b16 a[246:247], v241 offset:1536
ds_read_b64_tr_b16 a[248:249], v242 offset:0
ds_read_b64_tr_b16 a[250:251], v242 offset:1536
s_add_u32 m0, s31, s38
s_add_u32 s40, s35, s48
buffer_load_dwordx4 v248, s[20:23], s40 offen offset:0 lds
buffer_load_dwordx4 v249, s[20:23], s40 offen offset:1024 lds
buffer_load_dwordx4 v250, s[20:23], s40 offen offset:2048 lds
s_add_u32 m0, m0, 6144
s_add_u32 s40, s40, 196608
buffer_load_dwordx4 v248, s[20:23], s40 offen offset:0 lds
buffer_load_dwordx4 v249, s[20:23], s40 offen offset:1024 lds
buffer_load_dwordx4 v250, s[20:23], s40 offen offset:2048 lds
s_add_u32 s35, s35, 393216
s_sub_u32 s40, s35, 7864320
s_min_u32 s35, s35, s40
s_add_u32 s31, s31, 24576
s_sub_u32 s41, s31, 147456
s_min_u32 s31, s31, s41
s_waitcnt lgkmcnt(4)
v_mfma_f32_16x16x32_bf16 v[0:3], a[240:243], a[0:3], 0
ds_read_b64_tr_b16 a[252:253], v243 offset:0
ds_read_b64_tr_b16 a[254:255], v243 offset:1536
v_mfma_f32_16x16x32_bf16 v[4:7], a[240:243], a[4:7], 0
v_accvgpr_read_b32 v226, a80
v_accvgpr_read_b32 v227, a81
v_mfma_f32_16x16x32_bf16 v[8:11], a[240:243], a[8:11], 0
v_accvgpr_read_b32 v228, a82
v_accvgpr_read_b32 v229, a83
v_mfma_f32_16x16x32_bf16 v[12:15], a[240:243], a[12:15], 0
v_mul_f32 v226, v220, v226
v_mul_f32 v227, v220, v227
v_mfma_f32_16x16x32_bf16 v[16:19], a[240:243], a[16:19], 0
s_waitcnt lgkmcnt(4)
ds_read_b64_tr_b16 a[240:241], v240 offset:128
ds_read_b64_tr_b16 a[242:243], v240 offset:1664
v_mfma_f32_16x16x32_bf16 v[20:23], a[244:247], a[0:3], 0
v_mul_f32 v228, v220, v228
v_mul_f32 v229, v220, v229
v_mfma_f32_16x16x32_bf16 v[24:27], a[244:247], a[4:7], 0
v_cvt_pk_bf16_f32 v234, v226, v227
v_cvt_pk_bf16_f32 v235, v228, v229
v_mfma_f32_16x16x32_bf16 v[28:31], a[244:247], a[8:11], 0
v_accvgpr_read_b32 v230, a100
v_accvgpr_read_b32 v231, a101
v_mfma_f32_16x16x32_bf16 v[32:35], a[244:247], a[12:15], 0
v_accvgpr_read_b32 v232, a102
v_accvgpr_read_b32 v233, a103
v_mfma_f32_16x16x32_bf16 v[36:39], a[244:247], a[16:19], 0
s_waitcnt lgkmcnt(4)
ds_read_b64_tr_b16 a[244:245], v241 offset:128
ds_read_b64_tr_b16 a[246:247], v241 offset:1664
v_mfma_f32_16x16x32_bf16 v[40:43], a[248:251], a[0:3], 0
v_mul_f32 v230, v220, v230
v_mul_f32 v231, v220, v231
v_mfma_f32_16x16x32_bf16 v[44:47], a[248:251], a[4:7], 0
v_mul_f32 v232, v220, v232
v_mul_f32 v233, v220, v233
v_mfma_f32_16x16x32_bf16 v[48:51], a[248:251], a[8:11], 0
v_cvt_pk_bf16_f32 v236, v230, v231
v_cvt_pk_bf16_f32 v237, v232, v233
v_mfma_f32_16x16x32_bf16 v[52:55], a[248:251], a[12:15], 0
s_add_u32 s39, s47, 20480
v_mfma_f32_16x16x32_bf16 v[56:59], a[248:251], a[16:19], 0
s_waitcnt lgkmcnt(4)
ds_read_b64_tr_b16 a[248:249], v242 offset:128
ds_read_b64_tr_b16 a[250:251], v242 offset:1664
v_mfma_f32_16x16x32_bf16 v[60:63], a[252:255], a[0:3], 0
v_xor_b32 v244, 64, v244
v_mfma_f32_16x16x32_bf16 v[64:67], a[252:255], a[4:7], 0
ds_read_b128 a[20:23], v244 offset:0
ds_read_b128 a[24:27], v244 offset:2048
v_mfma_f32_16x16x32_bf16 v[68:71], a[252:255], a[8:11], 0
ds_read_b128 a[28:31], v244 offset:4096
ds_read_b128 a[32:35], v244 offset:6144
v_mfma_f32_16x16x32_bf16 v[72:75], a[252:255], a[12:15], 0
ds_read_b128 a[36:39], v244 offset:8192
v_mfma_f32_16x16x32_bf16 v[76:79], a[252:255], a[16:19], 0
s_waitcnt lgkmcnt(9)
ds_read_b64_tr_b16 a[252:253], v243 offset:128
ds_read_b64_tr_b16 a[254:255], v243 offset:1664
v_mfma_f32_16x16x32_bf16 v[80:83], a[240:243], a[0:3], 0
buffer_store_dwordx4 v[234:237], v239, s[24:27], s39 offen offset:0 sc1
v_mfma_f32_16x16x32_bf16 v[84:87], a[240:243], a[4:7], 0
v_accvgpr_read_b32 v226, a84
v_accvgpr_read_b32 v227, a85
v_mfma_f32_16x16x32_bf16 v[88:91], a[240:243], a[8:11], 0
v_accvgpr_read_b32 v228, a86
v_accvgpr_read_b32 v229, a87
v_mfma_f32_16x16x32_bf16 v[92:95], a[240:243], a[12:15], 0
v_mul_f32 v226, v221, v226
v_mul_f32 v227, v221, v227
v_mfma_f32_16x16x32_bf16 v[96:99], a[240:243], a[16:19], 0
s_waitcnt lgkmcnt(9)
ds_read_b64_tr_b16 a[240:241], v240 offset:256
ds_read_b64_tr_b16 a[242:243], v240 offset:1792
v_mfma_f32_16x16x32_bf16 v[100:103], a[244:247], a[0:3], 0
v_mul_f32 v228, v221, v228
v_mul_f32 v229, v221, v229
v_mfma_f32_16x16x32_bf16 v[104:107], a[244:247], a[4:7], 0
v_cvt_pk_bf16_f32 v234, v226, v227
v_cvt_pk_bf16_f32 v235, v228, v229
v_mfma_f32_16x16x32_bf16 v[108:111], a[244:247], a[8:11], 0
v_accvgpr_read_b32 v230, a104
v_accvgpr_read_b32 v231, a105
v_mfma_f32_16x16x32_bf16 v[112:115], a[244:247], a[12:15], 0
v_accvgpr_read_b32 v232, a106
v_accvgpr_read_b32 v233, a107
v_mfma_f32_16x16x32_bf16 v[116:119], a[244:247], a[16:19], 0
s_waitcnt lgkmcnt(9)
ds_read_b64_tr_b16 a[244:245], v241 offset:256
ds_read_b64_tr_b16 a[246:247], v241 offset:1792
v_mfma_f32_16x16x32_bf16 v[120:123], a[248:251], a[0:3], 0
v_mul_f32 v230, v221, v230
v_mul_f32 v231, v221, v231
v_mfma_f32_16x16x32_bf16 v[124:127], a[248:251], a[4:7], 0
v_mul_f32 v232, v221, v232
v_mul_f32 v233, v221, v233
v_mfma_f32_16x16x32_bf16 v[128:131], a[248:251], a[8:11], 0
v_cvt_pk_bf16_f32 v236, v230, v231
v_cvt_pk_bf16_f32 v237, v232, v233
v_mfma_f32_16x16x32_bf16 v[132:135], a[248:251], a[12:15], 0
buffer_store_dwordx4 v[234:237], v239, s[24:27], s39 offen offset:1024 sc1
v_mfma_f32_16x16x32_bf16 v[136:139], a[248:251], a[16:19], 0
s_waitcnt lgkmcnt(4)
ds_read_b64_tr_b16 a[248:249], v242 offset:256
ds_read_b64_tr_b16 a[250:251], v242 offset:1792
v_mfma_f32_16x16x32_bf16 v[140:143], a[252:255], a[0:3], 0
v_accvgpr_read_b32 v226, a88
v_accvgpr_read_b32 v227, a89
v_mfma_f32_16x16x32_bf16 v[144:147], a[252:255], a[4:7], 0
v_accvgpr_read_b32 v228, a90
v_accvgpr_read_b32 v229, a91
v_mfma_f32_16x16x32_bf16 v[148:151], a[252:255], a[8:11], 0
v_mul_f32 v226, v222, v226
v_mul_f32 v227, v222, v227
v_mfma_f32_16x16x32_bf16 v[152:155], a[252:255], a[12:15], 0
v_mul_f32 v228, v222, v228
v_mul_f32 v229, v222, v229
v_mfma_f32_16x16x32_bf16 v[156:159], a[252:255], a[16:19], 0
s_waitcnt lgkmcnt(4)
ds_read_b64_tr_b16 a[252:253], v243 offset:256
ds_read_b64_tr_b16 a[254:255], v243 offset:1792
v_mfma_f32_16x16x32_bf16 v[160:163], a[240:243], a[0:3], 0
v_add_u32 v240, s32, v254
v_xor_b32 v241, 32, v240
v_mfma_f32_16x16x32_bf16 v[164:167], a[240:243], a[4:7], 0
v_xor_b32 v242, 64, v240
v_xor_b32 v243, 64, v241
v_mfma_f32_16x16x32_bf16 v[168:171], a[240:243], a[8:11], 0
s_add_u32 s32, s32, 24576
s_sub_u32 s42, s32, 147456
s_min_u32 s32, s32, s42
v_mfma_f32_16x16x32_bf16 v[172:175], a[240:243], a[12:15], 0
v_cvt_pk_bf16_f32 v234, v226, v227
v_cvt_pk_bf16_f32 v235, v228, v229
v_mfma_f32_16x16x32_bf16 v[176:179], a[240:243], a[16:19], 0
s_waitcnt lgkmcnt(4)
v_accvgpr_read_b32 v230, a108
v_accvgpr_read_b32 v231, a109
v_mfma_f32_16x16x32_bf16 v[180:183], a[244:247], a[0:3], 0
v_accvgpr_read_b32 v232, a110
v_accvgpr_read_b32 v233, a111
v_mfma_f32_16x16x32_bf16 v[184:187], a[244:247], a[4:7], 0
v_mul_f32 v230, v222, v230
v_mul_f32 v231, v222, v231
v_mfma_f32_16x16x32_bf16 v[188:191], a[244:247], a[8:11], 0
s_waitcnt vmcnt(29) lgkmcnt(0)
s_barrier
ds_read_b64_tr_b16 a[240:241], v240 offset:0
v_mfma_f32_16x16x32_bf16 v[192:195], a[244:247], a[12:15], 0
s_add_u32 m0, s31, s38
s_add_u32 s40, s35, s48
ds_read_b64_tr_b16 a[242:243], v240 offset:1536
v_mfma_f32_16x16x32_bf16 v[196:199], a[244:247], a[16:19], 0
s_waitcnt lgkmcnt(15)
ds_read_b64_tr_b16 a[244:245], v241 offset:0
ds_read_b64_tr_b16 a[246:247], v241 offset:1536
v_mfma_f32_16x16x32_bf16 v[200:203], a[248:251], a[0:3], 0
buffer_load_dwordx4 v248, s[20:23], s40 offen offset:0 lds
v_mfma_f32_16x16x32_bf16 v[204:207], a[248:251], a[4:7], 0
v_mul_f32 v232, v222, v232
v_mul_f32 v233, v222, v233
v_mfma_f32_16x16x32_bf16 v[208:211], a[248:251], a[8:11], 0
v_cvt_pk_bf16_f32 v236, v230, v231
v_cvt_pk_bf16_f32 v237, v232, v233
v_mfma_f32_16x16x32_bf16 v[212:215], a[248:251], a[12:15], 0
buffer_load_dwordx4 v249, s[20:23], s40 offen offset:1024 lds
v_mfma_f32_16x16x32_bf16 v[216:219], a[248:251], a[16:19], 0
s_waitcnt lgkmcnt(15)
ds_read_b64_tr_b16 a[248:249], v242 offset:0
ds_read_b64_tr_b16 a[250:251], v242 offset:1536
v_mfma_f32_16x16x32_bf16 a[60:63], a[252:255], a[0:3], 0
v_mfma_f32_16x16x32_bf16 a[64:67], a[252:255], a[4:7], 0
buffer_load_dwordx4 v250, s[20:23], s40 offen offset:2048 lds
v_mfma_f32_16x16x32_bf16 a[68:71], a[252:255], a[8:11], 0
s_add_u32 m0, m0, 6144
s_add_u32 s40, s40, 196608
v_mfma_f32_16x16x32_bf16 a[72:75], a[252:255], a[12:15], 0
v_mfma_f32_16x16x32_bf16 a[76:79], a[252:255], a[16:19], 0
s_waitcnt lgkmcnt(4)
ds_read_b64_tr_b16 a[252:253], v243 offset:0
ds_read_b64_tr_b16 a[254:255], v243 offset:1536
v_mfma_f32_16x16x32_bf16 v[0:3], a[240:243], a[20:23], v[0:3]
buffer_load_dwordx4 v248, s[20:23], s40 offen offset:0 lds
v_mfma_f32_16x16x32_bf16 v[4:7], a[240:243], a[24:27], v[4:7]
v_mfma_f32_16x16x32_bf16 v[8:11], a[240:243], a[28:31], v[8:11]
v_mfma_f32_16x16x32_bf16 v[12:15], a[240:243], a[32:35], v[12:15]
buffer_load_dwordx4 v249, s[20:23], s40 offen offset:1024 lds
v_mfma_f32_16x16x32_bf16 v[16:19], a[240:243], a[36:39], v[16:19]
s_waitcnt lgkmcnt(4)
ds_read_b64_tr_b16 a[240:241], v240 offset:128
ds_read_b64_tr_b16 a[242:243], v240 offset:1664
v_mfma_f32_16x16x32_bf16 v[20:23], a[244:247], a[20:23], v[20:23]
v_mfma_f32_16x16x32_bf16 v[24:27], a[244:247], a[24:27], v[24:27]
buffer_load_dwordx4 v250, s[20:23], s40 offen offset:2048 lds
v_mfma_f32_16x16x32_bf16 v[28:31], a[244:247], a[28:31], v[28:31]
s_add_u32 s35, s35, 393216
s_sub_u32 s40, s35, 7864320
s_min_u32 s35, s35, s40
v_mfma_f32_16x16x32_bf16 v[32:35], a[244:247], a[32:35], v[32:35]
s_add_u32 s31, s31, 24576
s_sub_u32 s41, s31, 147456
s_min_u32 s31, s31, s41
v_mfma_f32_16x16x32_bf16 v[36:39], a[244:247], a[36:39], v[36:39]
s_waitcnt lgkmcnt(4)
ds_read_b64_tr_b16 a[244:245], v241 offset:128
ds_read_b64_tr_b16 a[246:247], v241 offset:1664
v_mfma_f32_16x16x32_bf16 v[40:43], a[248:251], a[20:23], v[40:43]
s_add_u32 m0, s31, s55
s_add_u32 s40, s54, s49
v_mfma_f32_16x16x32_bf16 v[44:47], a[248:251], a[24:27], v[44:47]
buffer_load_dwordx4 v251, s[8:11], s40 offen offset:0 lds
v_mfma_f32_16x16x32_bf16 v[48:51], a[248:251], a[28:31], v[48:51]
s_add_u32 s40, s40, 9216
v_mfma_f32_16x16x32_bf16 v[52:55], a[248:251], a[32:35], v[52:55]
v_mfma_f32_16x16x32_bf16 v[56:59], a[248:251], a[36:39], v[56:59]
s_waitcnt lgkmcnt(4)
ds_read_b64_tr_b16 a[248:249], v242 offset:128
ds_read_b64_tr_b16 a[250:251], v242 offset:1664
v_mfma_f32_16x16x32_bf16 v[60:63], a[252:255], a[20:23], v[60:63]
buffer_load_dwordx4 v251, s[8:11], s40 offen offset:1024 lds
v_mfma_f32_16x16x32_bf16 v[64:67], a[252:255], a[24:27], v[64:67]
s_add_u32 s40, s40, 9216
v_mfma_f32_16x16x32_bf16 v[68:71], a[252:255], a[28:31], v[68:71]
v_mfma_f32_16x16x32_bf16 v[72:75], a[252:255], a[32:35], v[72:75]
buffer_load_dwordx4 v251, s[8:11], s40 offen offset:2048 lds
v_mfma_f32_16x16x32_bf16 v[76:79], a[252:255], a[36:39], v[76:79]
s_waitcnt lgkmcnt(4)
ds_read_b64_tr_b16 a[252:253], v243 offset:128
ds_read_b64_tr_b16 a[254:255], v243 offset:1664
v_mfma_f32_16x16x32_bf16 v[80:83], a[240:243], a[20:23], v[80:83]
s_add_u32 s40, s40, 9216
v_mfma_f32_16x16x32_bf16 v[84:87], a[240:243], a[24:27], v[84:87]
buffer_load_dwordx4 v251, s[8:11], s40 offen offset:3072 lds
v_mfma_f32_16x16x32_bf16 v[88:91], a[240:243], a[28:31], v[88:91]
s_add_u32 m0, m0, 4096
s_add_u32 s40, s40, 13312
v_mfma_f32_16x16x32_bf16 v[92:95], a[240:243], a[32:35], v[92:95]
v_mfma_f32_16x16x32_bf16 v[96:99], a[240:243], a[36:39], v[96:99]
s_waitcnt lgkmcnt(4)
ds_read_b64_tr_b16 a[240:241], v240 offset:256
ds_read_b64_tr_b16 a[242:243], v240 offset:1792
v_mfma_f32_16x16x32_bf16 v[100:103], a[244:247], a[20:23], v[100:103]
buffer_load_dwordx4 v251, s[8:11], s40 offen lds
v_mfma_f32_16x16x32_bf16 v[104:107], a[244:247], a[24:27], v[104:107]
s_add_u32 s54, s54, 128
s_sub_u32 s40, s54, 1280
s_min_u32 s54, s54, s40
v_mfma_f32_16x16x32_bf16 v[108:111], a[244:247], a[28:31], v[108:111]
s_add_u32 s31, s31, 24576
s_sub_u32 s41, s31, 147456
s_min_u32 s31, s31, s41
v_mfma_f32_16x16x32_bf16 v[112:115], a[244:247], a[32:35], v[112:115]
buffer_store_dwordx4 v[234:237], v239, s[24:27], s39 offen offset:2048 sc1
v_mfma_f32_16x16x32_bf16 v[116:119], a[244:247], a[36:39], v[116:119]
s_waitcnt lgkmcnt(4)
ds_read_b64_tr_b16 a[244:245], v241 offset:256
ds_read_b64_tr_b16 a[246:247], v241 offset:1792
v_mfma_f32_16x16x32_bf16 v[120:123], a[248:251], a[20:23], v[120:123]
v_accvgpr_read_b32 v226, a92
v_accvgpr_read_b32 v227, a93
v_mfma_f32_16x16x32_bf16 v[124:127], a[248:251], a[24:27], v[124:127]
v_accvgpr_read_b32 v228, a94
v_accvgpr_read_b32 v229, a95
v_mfma_f32_16x16x32_bf16 v[128:131], a[248:251], a[28:31], v[128:131]
v_mul_f32 v226, v223, v226
v_mul_f32 v227, v223, v227
v_mfma_f32_16x16x32_bf16 v[132:135], a[248:251], a[32:35], v[132:135]
v_mul_f32 v228, v223, v228
v_mul_f32 v229, v223, v229
v_mfma_f32_16x16x32_bf16 v[136:139], a[248:251], a[36:39], v[136:139]
s_waitcnt lgkmcnt(4)
ds_read_b64_tr_b16 a[248:249], v242 offset:256
ds_read_b64_tr_b16 a[250:251], v242 offset:1792
v_mfma_f32_16x16x32_bf16 v[140:143], a[252:255], a[20:23], v[140:143]
v_cvt_pk_bf16_f32 v234, v226, v227
v_cvt_pk_bf16_f32 v235, v228, v229
v_mfma_f32_16x16x32_bf16 v[144:147], a[252:255], a[24:27], v[144:147]
v_accvgpr_read_b32 v230, a112
v_accvgpr_read_b32 v231, a113
v_mfma_f32_16x16x32_bf16 v[148:151], a[252:255], a[28:31], v[148:151]
v_accvgpr_read_b32 v232, a114
v_accvgpr_read_b32 v233, a115
v_mfma_f32_16x16x32_bf16 v[152:155], a[252:255], a[32:35], v[152:155]
v_mul_f32 v230, v223, v230
v_mul_f32 v231, v223, v231
v_mfma_f32_16x16x32_bf16 v[156:159], a[252:255], a[36:39], v[156:159]
s_waitcnt lgkmcnt(4)
ds_read_b64_tr_b16 a[252:253], v243 offset:256
ds_read_b64_tr_b16 a[254:255], v243 offset:1792
v_mfma_f32_16x16x32_bf16 v[160:163], a[240:243], a[20:23], v[160:163]
v_add_u32 v240, s32, v254
v_xor_b32 v241, 32, v240
v_mfma_f32_16x16x32_bf16 v[164:167], a[240:243], a[24:27], v[164:167]
v_xor_b32 v242, 64, v240
v_xor_b32 v243, 64, v241
v_mfma_f32_16x16x32_bf16 v[168:171], a[240:243], a[28:31], v[168:171]
s_add_u32 s32, s32, 24576
s_sub_u32 s42, s32, 147456
s_min_u32 s32, s32, s42
v_mfma_f32_16x16x32_bf16 v[172:175], a[240:243], a[32:35], v[172:175]
v_add_u32 v244, s32, v255
v_mul_f32 v232, v223, v232
v_mfma_f32_16x16x32_bf16 v[176:179], a[240:243], a[36:39], v[176:179]
s_waitcnt lgkmcnt(4)
s_add_u32 s32, s32, 24576
s_sub_u32 s42, s32, 147456
v_mfma_f32_16x16x32_bf16 v[180:183], a[244:247], a[20:23], v[180:183]
s_min_u32 s32, s32, s42
v_mul_f32 v233, v223, v233
v_cvt_pk_bf16_f32 v236, v230, v231
v_mfma_f32_16x16x32_bf16 v[184:187], a[244:247], a[24:27], v[184:187]
v_cvt_pk_bf16_f32 v237, v232, v233
v_mfma_f32_16x16x32_bf16 v[188:191], a[244:247], a[28:31], v[188:191]
s_waitcnt vmcnt(30) lgkmcnt(0)
s_barrier
ds_read_b64_tr_b16 a[240:241], v240 offset:0
v_mfma_f32_16x16x32_bf16 v[192:195], a[244:247], a[32:35], v[192:195]
s_add_u32 m0, s31, s38
ds_read_b64_tr_b16 a[242:243], v240 offset:1536
ds_read_b128 a[0:3], v244 offset:0
v_mfma_f32_16x16x32_bf16 v[196:199], a[244:247], a[36:39], v[196:199]
s_waitcnt lgkmcnt(15)
ds_read_b128 a[4:7], v244 offset:2048
ds_read_b128 a[8:11], v244 offset:4096
v_mfma_f32_16x16x32_bf16 v[200:203], a[248:251], a[20:23], v[200:203]
s_add_u32 s40, s35, s48
ds_read_b128 a[12:15], v244 offset:6144
ds_read_b128 a[16:19], v244 offset:8192
v_mfma_f32_16x16x32_bf16 v[204:207], a[248:251], a[24:27], v[204:207]
ds_read_b64_tr_b16 a[244:245], v241 offset:0
ds_read_b64_tr_b16 a[246:247], v241 offset:1536
v_mfma_f32_16x16x32_bf16 v[208:211], a[248:251], a[28:31], v[208:211]
buffer_load_dwordx4 v248, s[20:23], s40 offen offset:0 lds
v_mfma_f32_16x16x32_bf16 v[212:215], a[248:251], a[32:35], v[212:215]
v_mfma_f32_16x16x32_bf16 v[216:219], a[248:251], a[36:39], v[216:219]
s_waitcnt lgkmcnt(15)
ds_read_b64_tr_b16 a[248:249], v242 offset:0
ds_read_b64_tr_b16 a[250:251], v242 offset:1536
v_mfma_f32_16x16x32_bf16 a[60:63], a[252:255], a[20:23], a[60:63]
buffer_load_dwordx4 v249, s[20:23], s40 offen offset:1024 lds
v_mfma_f32_16x16x32_bf16 a[64:67], a[252:255], a[24:27], a[64:67]
v_mfma_f32_16x16x32_bf16 a[68:71], a[252:255], a[28:31], a[68:71]
v_mfma_f32_16x16x32_bf16 a[72:75], a[252:255], a[32:35], a[72:75]
buffer_load_dwordx4 v250, s[20:23], s40 offen offset:2048 lds
v_mfma_f32_16x16x32_bf16 a[76:79], a[252:255], a[36:39], a[76:79]
s_waitcnt lgkmcnt(4)
ds_read_b64_tr_b16 a[252:253], v243 offset:0
ds_read_b64_tr_b16 a[254:255], v243 offset:1536
s_branch L_concat_heads__mha_block_cached__gqa_block_cached__near_ridge_kernel_q1
L_concat_heads__mha_block_cached__gqa_block_cached__near_ridge_kernel_nodrain:
s_waitcnt vmcnt(13) lgkmcnt(0)
s_barrier
v_add_u32 v240, s32, v254
v_xor_b32 v241, 32, v240
v_xor_b32 v242, 64, v240
v_xor_b32 v243, 64, v241
s_add_u32 s32, s32, 24576
s_sub_u32 s42, s32, 147456
s_min_u32 s32, s32, s42
v_add_u32 v244, s32, v255
s_add_u32 s32, s32, 24576
s_sub_u32 s42, s32, 147456
s_min_u32 s32, s32, s42
ds_read_b64_tr_b16 a[240:241], v240 offset:0
ds_read_b64_tr_b16 a[242:243], v240 offset:1536
ds_read_b128 a[0:3], v244 offset:0
ds_read_b128 a[4:7], v244 offset:2048
ds_read_b128 a[8:11], v244 offset:4096
ds_read_b128 a[12:15], v244 offset:6144
ds_read_b128 a[16:19], v244 offset:8192
ds_read_b64_tr_b16 a[244:245], v241 offset:0
ds_read_b64_tr_b16 a[246:247], v241 offset:1536
ds_read_b64_tr_b16 a[248:249], v242 offset:0
ds_read_b64_tr_b16 a[250:251], v242 offset:1536
s_waitcnt lgkmcnt(4)
v_mfma_f32_16x16x32_bf16 v[0:3], a[240:243], a[0:3], 0
s_add_u32 m0, s31, s55
ds_read_b64_tr_b16 a[252:253], v243 offset:0
ds_read_b64_tr_b16 a[254:255], v243 offset:1536
v_mfma_f32_16x16x32_bf16 v[4:7], a[240:243], a[4:7], 0
s_add_u32 s40, s54, s49
v_mfma_f32_16x16x32_bf16 v[8:11], a[240:243], a[8:11], 0
buffer_load_dwordx4 v251, s[8:11], s40 offen offset:0 lds
v_mfma_f32_16x16x32_bf16 v[12:15], a[240:243], a[12:15], 0
s_add_u32 s40, s40, 9216
v_mfma_f32_16x16x32_bf16 v[16:19], a[240:243], a[16:19], 0
s_waitcnt lgkmcnt(4)
ds_read_b64_tr_b16 a[240:241], v240 offset:128
ds_read_b64_tr_b16 a[242:243], v240 offset:1664
v_mfma_f32_16x16x32_bf16 v[20:23], a[244:247], a[0:3], 0
buffer_load_dwordx4 v251, s[8:11], s40 offen offset:1024 lds
v_mfma_f32_16x16x32_bf16 v[24:27], a[244:247], a[4:7], 0
s_add_u32 s40, s40, 9216
v_mfma_f32_16x16x32_bf16 v[28:31], a[244:247], a[8:11], 0
buffer_load_dwordx4 v251, s[8:11], s40 offen offset:2048 lds
v_mfma_f32_16x16x32_bf16 v[32:35], a[244:247], a[12:15], 0
s_add_u32 s40, s40, 9216
v_mfma_f32_16x16x32_bf16 v[36:39], a[244:247], a[16:19], 0
s_waitcnt lgkmcnt(4)
ds_read_b64_tr_b16 a[244:245], v241 offset:128
ds_read_b64_tr_b16 a[246:247], v241 offset:1664
v_mfma_f32_16x16x32_bf16 v[40:43], a[248:251], a[0:3], 0
buffer_load_dwordx4 v251, s[8:11], s40 offen offset:3072 lds
v_mfma_f32_16x16x32_bf16 v[44:47], a[248:251], a[4:7], 0
s_add_u32 m0, m0, 4096
s_add_u32 s40, s40, 13312
v_mfma_f32_16x16x32_bf16 v[48:51], a[248:251], a[8:11], 0
buffer_load_dwordx4 v251, s[8:11], s40 offen lds
v_mfma_f32_16x16x32_bf16 v[52:55], a[248:251], a[12:15], 0
s_add_u32 s54, s54, 128
s_sub_u32 s40, s54, 1280
s_min_u32 s54, s54, s40
v_mfma_f32_16x16x32_bf16 v[56:59], a[248:251], a[16:19], 0
s_waitcnt lgkmcnt(4)
ds_read_b64_tr_b16 a[248:249], v242 offset:128
ds_read_b64_tr_b16 a[250:251], v242 offset:1664
v_mfma_f32_16x16x32_bf16 v[60:63], a[252:255], a[0:3], 0
s_add_u32 s31, s31, 24576
s_sub_u32 s41, s31, 147456
v_xor_b32 v244, 64, v244
v_mfma_f32_16x16x32_bf16 v[64:67], a[252:255], a[4:7], 0
s_min_u32 s31, s31, s41
ds_read_b128 a[20:23], v244 offset:0
ds_read_b128 a[24:27], v244 offset:2048
v_mfma_f32_16x16x32_bf16 v[68:71], a[252:255], a[8:11], 0
s_add_u32 m0, s31, s38
ds_read_b128 a[28:31], v244 offset:4096
ds_read_b128 a[32:35], v244 offset:6144
v_mfma_f32_16x16x32_bf16 v[72:75], a[252:255], a[12:15], 0
s_add_u32 s40, s35, s48
ds_read_b128 a[36:39], v244 offset:8192
v_mfma_f32_16x16x32_bf16 v[76:79], a[252:255], a[16:19], 0
s_waitcnt lgkmcnt(9)
ds_read_b64_tr_b16 a[252:253], v243 offset:128
ds_read_b64_tr_b16 a[254:255], v243 offset:1664
v_mfma_f32_16x16x32_bf16 v[80:83], a[240:243], a[0:3], 0
buffer_load_dwordx4 v248, s[20:23], s40 offen offset:0 lds
v_mfma_f32_16x16x32_bf16 v[84:87], a[240:243], a[4:7], 0
v_mfma_f32_16x16x32_bf16 v[88:91], a[240:243], a[8:11], 0
buffer_load_dwordx4 v249, s[20:23], s40 offen offset:1024 lds
v_mfma_f32_16x16x32_bf16 v[92:95], a[240:243], a[12:15], 0
v_mfma_f32_16x16x32_bf16 v[96:99], a[240:243], a[16:19], 0
s_waitcnt lgkmcnt(9)
ds_read_b64_tr_b16 a[240:241], v240 offset:256
ds_read_b64_tr_b16 a[242:243], v240 offset:1792
v_mfma_f32_16x16x32_bf16 v[100:103], a[244:247], a[0:3], 0
buffer_load_dwordx4 v250, s[20:23], s40 offen offset:2048 lds
v_mfma_f32_16x16x32_bf16 v[104:107], a[244:247], a[4:7], 0
s_add_u32 m0, m0, 6144
s_add_u32 s40, s40, 196608
v_mfma_f32_16x16x32_bf16 v[108:111], a[244:247], a[8:11], 0
buffer_load_dwordx4 v248, s[20:23], s40 offen offset:0 lds
v_mfma_f32_16x16x32_bf16 v[112:115], a[244:247], a[12:15], 0
v_mfma_f32_16x16x32_bf16 v[116:119], a[244:247], a[16:19], 0
s_waitcnt lgkmcnt(9)
ds_read_b64_tr_b16 a[244:245], v241 offset:256
ds_read_b64_tr_b16 a[246:247], v241 offset:1792
v_mfma_f32_16x16x32_bf16 v[120:123], a[248:251], a[0:3], 0
buffer_load_dwordx4 v249, s[20:23], s40 offen offset:1024 lds
v_mfma_f32_16x16x32_bf16 v[124:127], a[248:251], a[4:7], 0
v_mfma_f32_16x16x32_bf16 v[128:131], a[248:251], a[8:11], 0
buffer_load_dwordx4 v250, s[20:23], s40 offen offset:2048 lds
v_mfma_f32_16x16x32_bf16 v[132:135], a[248:251], a[12:15], 0
s_add_u32 s35, s35, 393216
s_sub_u32 s40, s35, 7864320
s_min_u32 s35, s35, s40
v_mfma_f32_16x16x32_bf16 v[136:139], a[248:251], a[16:19], 0
s_waitcnt lgkmcnt(4)
ds_read_b64_tr_b16 a[248:249], v242 offset:256
ds_read_b64_tr_b16 a[250:251], v242 offset:1792
v_mfma_f32_16x16x32_bf16 v[140:143], a[252:255], a[0:3], 0
s_add_u32 s31, s31, 24576
s_sub_u32 s41, s31, 147456
s_min_u32 s31, s31, s41
v_mfma_f32_16x16x32_bf16 v[144:147], a[252:255], a[4:7], 0
v_mfma_f32_16x16x32_bf16 v[148:151], a[252:255], a[8:11], 0
v_mfma_f32_16x16x32_bf16 v[152:155], a[252:255], a[12:15], 0
v_mfma_f32_16x16x32_bf16 v[156:159], a[252:255], a[16:19], 0
s_waitcnt lgkmcnt(4)
ds_read_b64_tr_b16 a[252:253], v243 offset:256
ds_read_b64_tr_b16 a[254:255], v243 offset:1792
v_mfma_f32_16x16x32_bf16 v[160:163], a[240:243], a[0:3], 0
v_add_u32 v240, s32, v254
v_xor_b32 v241, 32, v240
v_mfma_f32_16x16x32_bf16 v[164:167], a[240:243], a[4:7], 0
v_xor_b32 v242, 64, v240
v_xor_b32 v243, 64, v241
v_mfma_f32_16x16x32_bf16 v[168:171], a[240:243], a[8:11], 0
s_add_u32 s32, s32, 24576
s_sub_u32 s42, s32, 147456
s_min_u32 s32, s32, s42
v_mfma_f32_16x16x32_bf16 v[172:175], a[240:243], a[12:15], 0
v_mfma_f32_16x16x32_bf16 v[176:179], a[240:243], a[16:19], 0
s_waitcnt lgkmcnt(4)
v_mfma_f32_16x16x32_bf16 v[180:183], a[244:247], a[0:3], 0
v_mfma_f32_16x16x32_bf16 v[184:187], a[244:247], a[4:7], 0
v_mfma_f32_16x16x32_bf16 v[188:191], a[244:247], a[8:11], 0
s_waitcnt vmcnt(17) lgkmcnt(0)
s_barrier
ds_read_b64_tr_b16 a[240:241], v240 offset:0
v_mfma_f32_16x16x32_bf16 v[192:195], a[244:247], a[12:15], 0
s_add_u32 m0, s31, s38
s_add_u32 s40, s35, s48
ds_read_b64_tr_b16 a[242:243], v240 offset:1536
v_mfma_f32_16x16x32_bf16 v[196:199], a[244:247], a[16:19], 0
s_waitcnt lgkmcnt(15)
ds_read_b64_tr_b16 a[244:245], v241 offset:0
ds_read_b64_tr_b16 a[246:247], v241 offset:1536
v_mfma_f32_16x16x32_bf16 v[200:203], a[248:251], a[0:3], 0
buffer_load_dwordx4 v248, s[20:23], s40 offen offset:0 lds
v_mfma_f32_16x16x32_bf16 v[204:207], a[248:251], a[4:7], 0
v_mul_f32 v232, v222, v232
v_mul_f32 v233, v222, v233
v_mfma_f32_16x16x32_bf16 v[208:211], a[248:251], a[8:11], 0
v_cvt_pk_bf16_f32 v236, v230, v231
v_cvt_pk_bf16_f32 v237, v232, v233
v_mfma_f32_16x16x32_bf16 v[212:215], a[248:251], a[12:15], 0
buffer_load_dwordx4 v249, s[20:23], s40 offen offset:1024 lds
v_mfma_f32_16x16x32_bf16 v[216:219], a[248:251], a[16:19], 0
s_waitcnt lgkmcnt(15)
ds_read_b64_tr_b16 a[248:249], v242 offset:0
ds_read_b64_tr_b16 a[250:251], v242 offset:1536
v_mfma_f32_16x16x32_bf16 a[60:63], a[252:255], a[0:3], 0
v_mfma_f32_16x16x32_bf16 a[64:67], a[252:255], a[4:7], 0
buffer_load_dwordx4 v250, s[20:23], s40 offen offset:2048 lds
v_mfma_f32_16x16x32_bf16 a[68:71], a[252:255], a[8:11], 0
s_add_u32 m0, m0, 6144
s_add_u32 s40, s40, 196608
v_mfma_f32_16x16x32_bf16 a[72:75], a[252:255], a[12:15], 0
v_mfma_f32_16x16x32_bf16 a[76:79], a[252:255], a[16:19], 0
s_waitcnt lgkmcnt(4)
ds_read_b64_tr_b16 a[252:253], v243 offset:0
ds_read_b64_tr_b16 a[254:255], v243 offset:1536
v_mfma_f32_16x16x32_bf16 v[0:3], a[240:243], a[20:23], v[0:3]
buffer_load_dwordx4 v248, s[20:23], s40 offen offset:0 lds
v_mfma_f32_16x16x32_bf16 v[4:7], a[240:243], a[24:27], v[4:7]
v_mfma_f32_16x16x32_bf16 v[8:11], a[240:243], a[28:31], v[8:11]
v_mfma_f32_16x16x32_bf16 v[12:15], a[240:243], a[32:35], v[12:15]
buffer_load_dwordx4 v249, s[20:23], s40 offen offset:1024 lds
v_mfma_f32_16x16x32_bf16 v[16:19], a[240:243], a[36:39], v[16:19]
s_waitcnt lgkmcnt(4)
ds_read_b64_tr_b16 a[240:241], v240 offset:128
ds_read_b64_tr_b16 a[242:243], v240 offset:1664
v_mfma_f32_16x16x32_bf16 v[20:23], a[244:247], a[20:23], v[20:23]
v_mfma_f32_16x16x32_bf16 v[24:27], a[244:247], a[24:27], v[24:27]
buffer_load_dwordx4 v250, s[20:23], s40 offen offset:2048 lds
v_mfma_f32_16x16x32_bf16 v[28:31], a[244:247], a[28:31], v[28:31]
s_add_u32 s35, s35, 393216
s_sub_u32 s40, s35, 7864320
s_min_u32 s35, s35, s40
v_mfma_f32_16x16x32_bf16 v[32:35], a[244:247], a[32:35], v[32:35]
s_add_u32 s31, s31, 24576
s_sub_u32 s41, s31, 147456
s_min_u32 s31, s31, s41
v_mfma_f32_16x16x32_bf16 v[36:39], a[244:247], a[36:39], v[36:39]
s_waitcnt lgkmcnt(4)
ds_read_b64_tr_b16 a[244:245], v241 offset:128
ds_read_b64_tr_b16 a[246:247], v241 offset:1664
v_mfma_f32_16x16x32_bf16 v[40:43], a[248:251], a[20:23], v[40:43]
s_add_u32 m0, s31, s55
s_add_u32 s40, s54, s49
v_mfma_f32_16x16x32_bf16 v[44:47], a[248:251], a[24:27], v[44:47]
buffer_load_dwordx4 v251, s[8:11], s40 offen offset:0 lds
v_mfma_f32_16x16x32_bf16 v[48:51], a[248:251], a[28:31], v[48:51]
s_add_u32 s40, s40, 9216
v_mfma_f32_16x16x32_bf16 v[52:55], a[248:251], a[32:35], v[52:55]
v_mfma_f32_16x16x32_bf16 v[56:59], a[248:251], a[36:39], v[56:59]
s_waitcnt lgkmcnt(4)
ds_read_b64_tr_b16 a[248:249], v242 offset:128
ds_read_b64_tr_b16 a[250:251], v242 offset:1664
v_mfma_f32_16x16x32_bf16 v[60:63], a[252:255], a[20:23], v[60:63]
buffer_load_dwordx4 v251, s[8:11], s40 offen offset:1024 lds
v_mfma_f32_16x16x32_bf16 v[64:67], a[252:255], a[24:27], v[64:67]
s_add_u32 s40, s40, 9216
v_mfma_f32_16x16x32_bf16 v[68:71], a[252:255], a[28:31], v[68:71]
v_mfma_f32_16x16x32_bf16 v[72:75], a[252:255], a[32:35], v[72:75]
buffer_load_dwordx4 v251, s[8:11], s40 offen offset:2048 lds
v_mfma_f32_16x16x32_bf16 v[76:79], a[252:255], a[36:39], v[76:79]
s_waitcnt lgkmcnt(4)
ds_read_b64_tr_b16 a[252:253], v243 offset:128
ds_read_b64_tr_b16 a[254:255], v243 offset:1664
v_mfma_f32_16x16x32_bf16 v[80:83], a[240:243], a[20:23], v[80:83]
s_add_u32 s40, s40, 9216
v_mfma_f32_16x16x32_bf16 v[84:87], a[240:243], a[24:27], v[84:87]
buffer_load_dwordx4 v251, s[8:11], s40 offen offset:3072 lds
v_mfma_f32_16x16x32_bf16 v[88:91], a[240:243], a[28:31], v[88:91]
s_add_u32 m0, m0, 4096
s_add_u32 s40, s40, 13312
v_mfma_f32_16x16x32_bf16 v[92:95], a[240:243], a[32:35], v[92:95]
v_mfma_f32_16x16x32_bf16 v[96:99], a[240:243], a[36:39], v[96:99]
s_waitcnt lgkmcnt(4)
ds_read_b64_tr_b16 a[240:241], v240 offset:256
ds_read_b64_tr_b16 a[242:243], v240 offset:1792
v_mfma_f32_16x16x32_bf16 v[100:103], a[244:247], a[20:23], v[100:103]
buffer_load_dwordx4 v251, s[8:11], s40 offen lds
v_mfma_f32_16x16x32_bf16 v[104:107], a[244:247], a[24:27], v[104:107]
s_add_u32 s54, s54, 128
s_sub_u32 s40, s54, 1280
s_min_u32 s54, s54, s40
v_mfma_f32_16x16x32_bf16 v[108:111], a[244:247], a[28:31], v[108:111]
s_add_u32 s31, s31, 24576
s_sub_u32 s41, s31, 147456
s_min_u32 s31, s31, s41
v_mfma_f32_16x16x32_bf16 v[112:115], a[244:247], a[32:35], v[112:115]
buffer_store_dwordx4 v[234:237], v239, s[24:27], s39 offen offset:2048 sc1
v_mfma_f32_16x16x32_bf16 v[116:119], a[244:247], a[36:39], v[116:119]
s_waitcnt lgkmcnt(4)
ds_read_b64_tr_b16 a[244:245], v241 offset:256
ds_read_b64_tr_b16 a[246:247], v241 offset:1792
v_mfma_f32_16x16x32_bf16 v[120:123], a[248:251], a[20:23], v[120:123]
v_accvgpr_read_b32 v226, a92
v_accvgpr_read_b32 v227, a93
v_mfma_f32_16x16x32_bf16 v[124:127], a[248:251], a[24:27], v[124:127]
v_accvgpr_read_b32 v228, a94
v_accvgpr_read_b32 v229, a95
v_mfma_f32_16x16x32_bf16 v[128:131], a[248:251], a[28:31], v[128:131]
v_mul_f32 v226, v223, v226
v_mul_f32 v227, v223, v227
v_mfma_f32_16x16x32_bf16 v[132:135], a[248:251], a[32:35], v[132:135]
v_mul_f32 v228, v223, v228
v_mul_f32 v229, v223, v229
v_mfma_f32_16x16x32_bf16 v[136:139], a[248:251], a[36:39], v[136:139]
s_waitcnt lgkmcnt(4)
ds_read_b64_tr_b16 a[248:249], v242 offset:256
ds_read_b64_tr_b16 a[250:251], v242 offset:1792
v_mfma_f32_16x16x32_bf16 v[140:143], a[252:255], a[20:23], v[140:143]
v_cvt_pk_bf16_f32 v234, v226, v227
v_cvt_pk_bf16_f32 v235, v228, v229
v_mfma_f32_16x16x32_bf16 v[144:147], a[252:255], a[24:27], v[144:147]
v_accvgpr_read_b32 v230, a112
v_accvgpr_read_b32 v231, a113
v_mfma_f32_16x16x32_bf16 v[148:151], a[252:255], a[28:31], v[148:151]
v_accvgpr_read_b32 v232, a114
v_accvgpr_read_b32 v233, a115
v_mfma_f32_16x16x32_bf16 v[152:155], a[252:255], a[32:35], v[152:155]
v_mul_f32 v230, v223, v230
v_mul_f32 v231, v223, v231
v_mfma_f32_16x16x32_bf16 v[156:159], a[252:255], a[36:39], v[156:159]
s_waitcnt lgkmcnt(4)
ds_read_b64_tr_b16 a[252:253], v243 offset:256
ds_read_b64_tr_b16 a[254:255], v243 offset:1792
v_mfma_f32_16x16x32_bf16 v[160:163], a[240:243], a[20:23], v[160:163]
v_add_u32 v240, s32, v254
v_xor_b32 v241, 32, v240
v_mfma_f32_16x16x32_bf16 v[164:167], a[240:243], a[24:27], v[164:167]
v_xor_b32 v242, 64, v240
v_xor_b32 v243, 64, v241
v_mfma_f32_16x16x32_bf16 v[168:171], a[240:243], a[28:31], v[168:171]
s_add_u32 s32, s32, 24576
s_sub_u32 s42, s32, 147456
s_min_u32 s32, s32, s42
v_mfma_f32_16x16x32_bf16 v[172:175], a[240:243], a[32:35], v[172:175]
v_add_u32 v244, s32, v255
v_mul_f32 v232, v223, v232
v_mfma_f32_16x16x32_bf16 v[176:179], a[240:243], a[36:39], v[176:179]
s_waitcnt lgkmcnt(4)
s_add_u32 s32, s32, 24576
s_sub_u32 s42, s32, 147456
v_mfma_f32_16x16x32_bf16 v[180:183], a[244:247], a[20:23], v[180:183]
s_min_u32 s32, s32, s42
v_mul_f32 v233, v223, v233
v_cvt_pk_bf16_f32 v236, v230, v231
v_mfma_f32_16x16x32_bf16 v[184:187], a[244:247], a[24:27], v[184:187]
v_cvt_pk_bf16_f32 v237, v232, v233
v_mfma_f32_16x16x32_bf16 v[188:191], a[244:247], a[28:31], v[188:191]
s_waitcnt vmcnt(18) lgkmcnt(0)
s_barrier
ds_read_b64_tr_b16 a[240:241], v240 offset:0
v_mfma_f32_16x16x32_bf16 v[192:195], a[244:247], a[32:35], v[192:195]
s_add_u32 m0, s31, s38
ds_read_b64_tr_b16 a[242:243], v240 offset:1536
ds_read_b128 a[0:3], v244 offset:0
v_mfma_f32_16x16x32_bf16 v[196:199], a[244:247], a[36:39], v[196:199]
s_waitcnt lgkmcnt(15)
ds_read_b128 a[4:7], v244 offset:2048
ds_read_b128 a[8:11], v244 offset:4096
v_mfma_f32_16x16x32_bf16 v[200:203], a[248:251], a[20:23], v[200:203]
s_add_u32 s40, s35, s48
ds_read_b128 a[12:15], v244 offset:6144
ds_read_b128 a[16:19], v244 offset:8192
v_mfma_f32_16x16x32_bf16 v[204:207], a[248:251], a[24:27], v[204:207]
ds_read_b64_tr_b16 a[244:245], v241 offset:0
ds_read_b64_tr_b16 a[246:247], v241 offset:1536
v_mfma_f32_16x16x32_bf16 v[208:211], a[248:251], a[28:31], v[208:211]
buffer_load_dwordx4 v248, s[20:23], s40 offen offset:0 lds
v_mfma_f32_16x16x32_bf16 v[212:215], a[248:251], a[32:35], v[212:215]
v_mfma_f32_16x16x32_bf16 v[216:219], a[248:251], a[36:39], v[216:219]
s_waitcnt lgkmcnt(15)
ds_read_b64_tr_b16 a[248:249], v242 offset:0
ds_read_b64_tr_b16 a[250:251], v242 offset:1536
v_mfma_f32_16x16x32_bf16 a[60:63], a[252:255], a[20:23], a[60:63]
buffer_load_dwordx4 v249, s[20:23], s40 offen offset:1024 lds
v_mfma_f32_16x16x32_bf16 a[64:67], a[252:255], a[24:27], a[64:67]
v_mfma_f32_16x16x32_bf16 a[68:71], a[252:255], a[28:31], a[68:71]
v_mfma_f32_16x16x32_bf16 a[72:75], a[252:255], a[32:35], a[72:75]
buffer_load_dwordx4 v250, s[20:23], s40 offen offset:2048 lds
v_mfma_f32_16x16x32_bf16 a[76:79], a[252:255], a[36:39], a[76:79]
s_waitcnt lgkmcnt(4)
ds_read_b64_tr_b16 a[252:253], v243 offset:0
ds_read_b64_tr_b16 a[254:255], v243 offset:1536
L_concat_heads__mha_block_cached__gqa_block_cached__near_ridge_kernel_q1:
v_mfma_f32_16x16x32_bf16 v[0:3], a[240:243], a[0:3], v[0:3]
s_add_u32 m0, m0, 6144
s_add_u32 s40, s40, 196608
v_mfma_f32_16x16x32_bf16 v[4:7], a[240:243], a[4:7], v[4:7]
buffer_load_dwordx4 v248, s[20:23], s40 offen offset:0 lds
v_mfma_f32_16x16x32_bf16 v[8:11], a[240:243], a[8:11], v[8:11]
v_mfma_f32_16x16x32_bf16 v[12:15], a[240:243], a[12:15], v[12:15]
v_mfma_f32_16x16x32_bf16 v[16:19], a[240:243], a[16:19], v[16:19]
s_waitcnt lgkmcnt(4)
ds_read_b64_tr_b16 a[240:241], v240 offset:128
ds_read_b64_tr_b16 a[242:243], v240 offset:1664
v_mfma_f32_16x16x32_bf16 v[20:23], a[244:247], a[0:3], v[20:23]
buffer_load_dwordx4 v249, s[20:23], s40 offen offset:1024 lds
v_mfma_f32_16x16x32_bf16 v[24:27], a[244:247], a[4:7], v[24:27]
v_mfma_f32_16x16x32_bf16 v[28:31], a[244:247], a[8:11], v[28:31]
v_mfma_f32_16x16x32_bf16 v[32:35], a[244:247], a[12:15], v[32:35]
buffer_load_dwordx4 v250, s[20:23], s40 offen offset:2048 lds
v_mfma_f32_16x16x32_bf16 v[36:39], a[244:247], a[16:19], v[36:39]
s_waitcnt lgkmcnt(4)
ds_read_b64_tr_b16 a[244:245], v241 offset:128
ds_read_b64_tr_b16 a[246:247], v241 offset:1664
v_mfma_f32_16x16x32_bf16 v[40:43], a[248:251], a[0:3], v[40:43]
s_add_u32 s35, s35, 393216
s_sub_u32 s40, s35, 7864320
s_min_u32 s35, s35, s40
v_mfma_f32_16x16x32_bf16 v[44:47], a[248:251], a[4:7], v[44:47]
s_add_u32 s31, s31, 24576
s_sub_u32 s41, s31, 147456
s_min_u32 s31, s31, s41
v_mfma_f32_16x16x32_bf16 v[48:51], a[248:251], a[8:11], v[48:51]
buffer_store_dwordx4 v[234:237], v239, s[24:27], s39 offen offset:3072 sc1
v_mfma_f32_16x16x32_bf16 v[52:55], a[248:251], a[12:15], v[52:55]
v_accvgpr_read_b32 v226, a96
v_accvgpr_read_b32 v227, a97
v_mfma_f32_16x16x32_bf16 v[56:59], a[248:251], a[16:19], v[56:59]
s_waitcnt lgkmcnt(4)
ds_read_b64_tr_b16 a[248:249], v242 offset:128
ds_read_b64_tr_b16 a[250:251], v242 offset:1664
v_mfma_f32_16x16x32_bf16 v[60:63], a[252:255], a[0:3], v[60:63]
v_xor_b32 v244, 64, v244
v_accvgpr_read_b32 v228, a98
v_mfma_f32_16x16x32_bf16 v[64:67], a[252:255], a[4:7], v[64:67]
ds_read_b128 a[20:23], v244 offset:0
ds_read_b128 a[24:27], v244 offset:2048
v_mfma_f32_16x16x32_bf16 v[68:71], a[252:255], a[8:11], v[68:71]
ds_read_b128 a[28:31], v244 offset:4096
ds_read_b128 a[32:35], v244 offset:6144
v_mfma_f32_16x16x32_bf16 v[72:75], a[252:255], a[12:15], v[72:75]
ds_read_b128 a[36:39], v244 offset:8192
v_accvgpr_read_b32 v229, a99
v_mfma_f32_16x16x32_bf16 v[76:79], a[252:255], a[16:19], v[76:79]
s_waitcnt lgkmcnt(9)
ds_read_b64_tr_b16 a[252:253], v243 offset:128
ds_read_b64_tr_b16 a[254:255], v243 offset:1664
v_mfma_f32_16x16x32_bf16 v[80:83], a[240:243], a[0:3], v[80:83]
v_mul_f32 v226, v224, v226
v_mul_f32 v227, v224, v227
v_mfma_f32_16x16x32_bf16 v[84:87], a[240:243], a[4:7], v[84:87]
v_mul_f32 v228, v224, v228
v_mul_f32 v229, v224, v229
v_mfma_f32_16x16x32_bf16 v[88:91], a[240:243], a[8:11], v[88:91]
v_cvt_pk_bf16_f32 v234, v226, v227
v_cvt_pk_bf16_f32 v235, v228, v229
v_mfma_f32_16x16x32_bf16 v[92:95], a[240:243], a[12:15], v[92:95]
v_accvgpr_read_b32 v230, a116
v_accvgpr_read_b32 v231, a117
v_mfma_f32_16x16x32_bf16 v[96:99], a[240:243], a[16:19], v[96:99]
s_waitcnt lgkmcnt(9)
ds_read_b64_tr_b16 a[240:241], v240 offset:256
ds_read_b64_tr_b16 a[242:243], v240 offset:1792
v_mfma_f32_16x16x32_bf16 v[100:103], a[244:247], a[0:3], v[100:103]
v_accvgpr_read_b32 v232, a118
v_accvgpr_read_b32 v233, a119
v_mfma_f32_16x16x32_bf16 v[104:107], a[244:247], a[4:7], v[104:107]
v_mul_f32 v230, v224, v230
v_mul_f32 v231, v224, v231
v_mfma_f32_16x16x32_bf16 v[108:111], a[244:247], a[8:11], v[108:111]
v_mul_f32 v232, v224, v232
v_mul_f32 v233, v224, v233
v_mfma_f32_16x16x32_bf16 v[112:115], a[244:247], a[12:15], v[112:115]
v_cvt_pk_bf16_f32 v236, v230, v231
v_cvt_pk_bf16_f32 v237, v232, v233
v_mfma_f32_16x16x32_bf16 v[116:119], a[244:247], a[16:19], v[116:119]
s_waitcnt lgkmcnt(9)
ds_read_b64_tr_b16 a[244:245], v241 offset:256
ds_read_b64_tr_b16 a[246:247], v241 offset:1792
v_mfma_f32_16x16x32_bf16 v[120:123], a[248:251], a[0:3], v[120:123]
buffer_store_dwordx4 v[234:237], v225, s[24:27], s39 offen sc1
v_mfma_f32_16x16x32_bf16 v[124:127], a[248:251], a[4:7], v[124:127]
v_accvgpr_read_b32 v226, a120
v_accvgpr_read_b32 v227, a121
v_mfma_f32_16x16x32_bf16 v[128:131], a[248:251], a[8:11], v[128:131]
v_accvgpr_read_b32 v228, a122
v_accvgpr_read_b32 v229, a123
v_mfma_f32_16x16x32_bf16 v[132:135], a[248:251], a[12:15], v[132:135]
v_mul_f32 v226, v220, v226
v_mul_f32 v227, v220, v227
v_mfma_f32_16x16x32_bf16 v[136:139], a[248:251], a[16:19], v[136:139]
s_waitcnt lgkmcnt(4)
ds_read_b64_tr_b16 a[248:249], v242 offset:256
ds_read_b64_tr_b16 a[250:251], v242 offset:1792
v_mfma_f32_16x16x32_bf16 v[140:143], a[252:255], a[0:3], v[140:143]
v_mul_f32 v228, v220, v228
v_mul_f32 v229, v220, v229
v_mfma_f32_16x16x32_bf16 v[144:147], a[252:255], a[4:7], v[144:147]
v_cvt_pk_bf16_f32 v234, v226, v227
v_cvt_pk_bf16_f32 v235, v228, v229
v_mfma_f32_16x16x32_bf16 v[148:151], a[252:255], a[8:11], v[148:151]
v_accvgpr_read_b32 v230, a140
v_accvgpr_read_b32 v231, a141
v_mfma_f32_16x16x32_bf16 v[152:155], a[252:255], a[12:15], v[152:155]
v_accvgpr_read_b32 v232, a142
v_accvgpr_read_b32 v233, a143
v_mfma_f32_16x16x32_bf16 v[156:159], a[252:255], a[16:19], v[156:159]
s_waitcnt lgkmcnt(4)
ds_read_b64_tr_b16 a[252:253], v243 offset:256
ds_read_b64_tr_b16 a[254:255], v243 offset:1792
v_mfma_f32_16x16x32_bf16 v[160:163], a[240:243], a[0:3], v[160:163]
v_add_u32 v240, s32, v254
v_xor_b32 v241, 32, v240
v_mfma_f32_16x16x32_bf16 v[164:167], a[240:243], a[4:7], v[164:167]
v_xor_b32 v242, 64, v240
v_xor_b32 v243, 64, v241
v_mfma_f32_16x16x32_bf16 v[168:171], a[240:243], a[8:11], v[168:171]
s_add_u32 s32, s32, 24576
s_sub_u32 s42, s32, 147456
s_min_u32 s32, s32, s42
v_mfma_f32_16x16x32_bf16 v[172:175], a[240:243], a[12:15], v[172:175]
v_mul_f32 v230, v220, v230
v_mul_f32 v231, v220, v231
v_mfma_f32_16x16x32_bf16 v[176:179], a[240:243], a[16:19], v[176:179]
s_waitcnt lgkmcnt(4)
v_mul_f32 v232, v220, v232
v_mul_f32 v233, v220, v233
v_mfma_f32_16x16x32_bf16 v[180:183], a[244:247], a[0:3], v[180:183]
v_cvt_pk_bf16_f32 v236, v230, v231
v_cvt_pk_bf16_f32 v237, v232, v233
v_mfma_f32_16x16x32_bf16 v[184:187], a[244:247], a[4:7], v[184:187]
s_add_u32 s39, s47, 30720
v_mfma_f32_16x16x32_bf16 v[188:191], a[244:247], a[8:11], v[188:191]
s_waitcnt vmcnt(20) lgkmcnt(0)
s_barrier
ds_read_b64_tr_b16 a[240:241], v240 offset:0
v_mfma_f32_16x16x32_bf16 v[192:195], a[244:247], a[12:15], v[192:195]
s_add_u32 m0, s31, s38
s_add_u32 s40, s35, s48
ds_read_b64_tr_b16 a[242:243], v240 offset:1536
v_mfma_f32_16x16x32_bf16 v[196:199], a[244:247], a[16:19], v[196:199]
s_waitcnt lgkmcnt(15)
ds_read_b64_tr_b16 a[244:245], v241 offset:0
ds_read_b64_tr_b16 a[246:247], v241 offset:1536
v_mfma_f32_16x16x32_bf16 v[200:203], a[248:251], a[0:3], v[200:203]
buffer_load_dwordx4 v248, s[20:23], s40 offen offset:0 lds
v_mfma_f32_16x16x32_bf16 v[204:207], a[248:251], a[4:7], v[204:207]
v_mfma_f32_16x16x32_bf16 v[208:211], a[248:251], a[8:11], v[208:211]
v_mfma_f32_16x16x32_bf16 v[212:215], a[248:251], a[12:15], v[212:215]
buffer_load_dwordx4 v249, s[20:23], s40 offen offset:1024 lds
v_mfma_f32_16x16x32_bf16 v[216:219], a[248:251], a[16:19], v[216:219]
s_waitcnt lgkmcnt(15)
ds_read_b64_tr_b16 a[248:249], v242 offset:0
ds_read_b64_tr_b16 a[250:251], v242 offset:1536
v_mfma_f32_16x16x32_bf16 a[60:63], a[252:255], a[0:3], a[60:63]
v_mfma_f32_16x16x32_bf16 a[64:67], a[252:255], a[4:7], a[64:67]
buffer_load_dwordx4 v250, s[20:23], s40 offen offset:2048 lds
v_mfma_f32_16x16x32_bf16 a[68:71], a[252:255], a[8:11], a[68:71]
s_add_u32 m0, m0, 6144
s_add_u32 s40, s40, 196608
v_mfma_f32_16x16x32_bf16 a[72:75], a[252:255], a[12:15], a[72:75]
v_mfma_f32_16x16x32_bf16 a[76:79], a[252:255], a[16:19], a[76:79]
s_waitcnt lgkmcnt(4)
ds_read_b64_tr_b16 a[252:253], v243 offset:0
ds_read_b64_tr_b16 a[254:255], v243 offset:1536
v_mfma_f32_16x16x32_bf16 v[0:3], a[240:243], a[20:23], v[0:3]
buffer_load_dwordx4 v248, s[20:23], s40 offen offset:0 lds
v_mfma_f32_16x16x32_bf16 v[4:7], a[240:243], a[24:27], v[4:7]
v_mfma_f32_16x16x32_bf16 v[8:11], a[240:243], a[28:31], v[8:11]
v_mfma_f32_16x16x32_bf16 v[12:15], a[240:243], a[32:35], v[12:15]
buffer_load_dwordx4 v249, s[20:23], s40 offen offset:1024 lds
v_mfma_f32_16x16x32_bf16 v[16:19], a[240:243], a[36:39], v[16:19]
s_waitcnt lgkmcnt(4)
ds_read_b64_tr_b16 a[240:241], v240 offset:128
ds_read_b64_tr_b16 a[242:243], v240 offset:1664
v_mfma_f32_16x16x32_bf16 v[20:23], a[244:247], a[20:23], v[20:23]
v_mfma_f32_16x16x32_bf16 v[24:27], a[244:247], a[24:27], v[24:27]
buffer_load_dwordx4 v250, s[20:23], s40 offen offset:2048 lds
v_mfma_f32_16x16x32_bf16 v[28:31], a[244:247], a[28:31], v[28:31]
s_add_u32 s35, s35, 393216
s_sub_u32 s40, s35, 7864320
s_min_u32 s35, s35, s40
v_mfma_f32_16x16x32_bf16 v[32:35], a[244:247], a[32:35], v[32:35]
s_add_u32 s31, s31, 24576
s_sub_u32 s41, s31, 147456
s_min_u32 s31, s31, s41
v_mfma_f32_16x16x32_bf16 v[36:39], a[244:247], a[36:39], v[36:39]
s_waitcnt lgkmcnt(4)
ds_read_b64_tr_b16 a[244:245], v241 offset:128
ds_read_b64_tr_b16 a[246:247], v241 offset:1664
v_mfma_f32_16x16x32_bf16 v[40:43], a[248:251], a[20:23], v[40:43]
s_add_u32 m0, s31, s55
s_add_u32 s40, s54, s49
v_mfma_f32_16x16x32_bf16 v[44:47], a[248:251], a[24:27], v[44:47]
buffer_load_dwordx4 v251, s[8:11], s40 offen offset:0 lds
v_mfma_f32_16x16x32_bf16 v[48:51], a[248:251], a[28:31], v[48:51]
s_add_u32 s40, s40, 9216
v_mfma_f32_16x16x32_bf16 v[52:55], a[248:251], a[32:35], v[52:55]
v_mfma_f32_16x16x32_bf16 v[56:59], a[248:251], a[36:39], v[56:59]
s_waitcnt lgkmcnt(4)
ds_read_b64_tr_b16 a[248:249], v242 offset:128
ds_read_b64_tr_b16 a[250:251], v242 offset:1664
v_mfma_f32_16x16x32_bf16 v[60:63], a[252:255], a[20:23], v[60:63]
buffer_load_dwordx4 v251, s[8:11], s40 offen offset:1024 lds
v_mfma_f32_16x16x32_bf16 v[64:67], a[252:255], a[24:27], v[64:67]
s_add_u32 s40, s40, 9216
v_mfma_f32_16x16x32_bf16 v[68:71], a[252:255], a[28:31], v[68:71]
v_mfma_f32_16x16x32_bf16 v[72:75], a[252:255], a[32:35], v[72:75]
buffer_load_dwordx4 v251, s[8:11], s40 offen offset:2048 lds
v_mfma_f32_16x16x32_bf16 v[76:79], a[252:255], a[36:39], v[76:79]
s_waitcnt lgkmcnt(4)
ds_read_b64_tr_b16 a[252:253], v243 offset:128
ds_read_b64_tr_b16 a[254:255], v243 offset:1664
v_mfma_f32_16x16x32_bf16 v[80:83], a[240:243], a[20:23], v[80:83]
s_add_u32 s40, s40, 9216
v_mfma_f32_16x16x32_bf16 v[84:87], a[240:243], a[24:27], v[84:87]
buffer_load_dwordx4 v251, s[8:11], s40 offen offset:3072 lds
v_mfma_f32_16x16x32_bf16 v[88:91], a[240:243], a[28:31], v[88:91]
s_add_u32 m0, m0, 4096
s_add_u32 s40, s40, 13312
v_mfma_f32_16x16x32_bf16 v[92:95], a[240:243], a[32:35], v[92:95]
v_mfma_f32_16x16x32_bf16 v[96:99], a[240:243], a[36:39], v[96:99]
s_waitcnt lgkmcnt(4)
ds_read_b64_tr_b16 a[240:241], v240 offset:256
ds_read_b64_tr_b16 a[242:243], v240 offset:1792
v_mfma_f32_16x16x32_bf16 v[100:103], a[244:247], a[20:23], v[100:103]
buffer_load_dwordx4 v251, s[8:11], s40 offen lds
v_mfma_f32_16x16x32_bf16 v[104:107], a[244:247], a[24:27], v[104:107]
s_add_u32 s54, s54, 128
s_sub_u32 s40, s54, 1280
s_min_u32 s54, s54, s40
v_mfma_f32_16x16x32_bf16 v[108:111], a[244:247], a[28:31], v[108:111]
s_add_u32 s31, s31, 24576
s_sub_u32 s41, s31, 147456
s_min_u32 s31, s31, s41
v_mfma_f32_16x16x32_bf16 v[112:115], a[244:247], a[32:35], v[112:115]
buffer_store_dwordx4 v[234:237], v239, s[24:27], s39 offen offset:0 sc1
v_mfma_f32_16x16x32_bf16 v[116:119], a[244:247], a[36:39], v[116:119]
s_waitcnt lgkmcnt(4)
ds_read_b64_tr_b16 a[244:245], v241 offset:256
ds_read_b64_tr_b16 a[246:247], v241 offset:1792
v_mfma_f32_16x16x32_bf16 v[120:123], a[248:251], a[20:23], v[120:123]
v_accvgpr_read_b32 v226, a124
v_accvgpr_read_b32 v227, a125
v_mfma_f32_16x16x32_bf16 v[124:127], a[248:251], a[24:27], v[124:127]
v_accvgpr_read_b32 v228, a126
v_accvgpr_read_b32 v229, a127
v_mfma_f32_16x16x32_bf16 v[128:131], a[248:251], a[28:31], v[128:131]
v_mul_f32 v226, v221, v226
v_mul_f32 v227, v221, v227
v_mfma_f32_16x16x32_bf16 v[132:135], a[248:251], a[32:35], v[132:135]
v_mul_f32 v228, v221, v228
v_mul_f32 v229, v221, v229
v_mfma_f32_16x16x32_bf16 v[136:139], a[248:251], a[36:39], v[136:139]
s_waitcnt lgkmcnt(4)
ds_read_b64_tr_b16 a[248:249], v242 offset:256
ds_read_b64_tr_b16 a[250:251], v242 offset:1792
v_mfma_f32_16x16x32_bf16 v[140:143], a[252:255], a[20:23], v[140:143]
v_cvt_pk_bf16_f32 v234, v226, v227
v_cvt_pk_bf16_f32 v235, v228, v229
v_mfma_f32_16x16x32_bf16 v[144:147], a[252:255], a[24:27], v[144:147]
v_accvgpr_read_b32 v230, a144
v_accvgpr_read_b32 v231, a145
v_mfma_f32_16x16x32_bf16 v[148:151], a[252:255], a[28:31], v[148:151]
v_accvgpr_read_b32 v232, a146
v_accvgpr_read_b32 v233, a147
v_mfma_f32_16x16x32_bf16 v[152:155], a[252:255], a[32:35], v[152:155]
v_mul_f32 v230, v221, v230
v_mul_f32 v231, v221, v231
v_mfma_f32_16x16x32_bf16 v[156:159], a[252:255], a[36:39], v[156:159]
s_waitcnt lgkmcnt(4)
ds_read_b64_tr_b16 a[252:253], v243 offset:256
ds_read_b64_tr_b16 a[254:255], v243 offset:1792
v_mfma_f32_16x16x32_bf16 v[160:163], a[240:243], a[20:23], v[160:163]
v_add_u32 v240, s32, v254
v_xor_b32 v241, 32, v240
v_mfma_f32_16x16x32_bf16 v[164:167], a[240:243], a[24:27], v[164:167]
v_xor_b32 v242, 64, v240
v_xor_b32 v243, 64, v241
v_mfma_f32_16x16x32_bf16 v[168:171], a[240:243], a[28:31], v[168:171]
s_add_u32 s32, s32, 24576
s_sub_u32 s42, s32, 147456
s_min_u32 s32, s32, s42
v_mfma_f32_16x16x32_bf16 v[172:175], a[240:243], a[32:35], v[172:175]
v_add_u32 v244, s32, v255
v_mul_f32 v232, v221, v232
v_mfma_f32_16x16x32_bf16 v[176:179], a[240:243], a[36:39], v[176:179]
s_waitcnt lgkmcnt(4)
s_add_u32 s32, s32, 24576
s_sub_u32 s42, s32, 147456
v_mfma_f32_16x16x32_bf16 v[180:183], a[244:247], a[20:23], v[180:183]
s_min_u32 s32, s32, s42
v_mul_f32 v233, v221, v233
v_cvt_pk_bf16_f32 v236, v230, v231
v_mfma_f32_16x16x32_bf16 v[184:187], a[244:247], a[24:27], v[184:187]
v_cvt_pk_bf16_f32 v237, v232, v233
v_mfma_f32_16x16x32_bf16 v[188:191], a[244:247], a[28:31], v[188:191]
s_waitcnt vmcnt(21) lgkmcnt(0)
s_barrier
ds_read_b64_tr_b16 a[240:241], v240 offset:0
v_mfma_f32_16x16x32_bf16 v[192:195], a[244:247], a[32:35], v[192:195]
s_add_u32 m0, s31, s38
ds_read_b64_tr_b16 a[242:243], v240 offset:1536
ds_read_b128 a[0:3], v244 offset:0
v_mfma_f32_16x16x32_bf16 v[196:199], a[244:247], a[36:39], v[196:199]
s_waitcnt lgkmcnt(15)
ds_read_b128 a[4:7], v244 offset:2048
ds_read_b128 a[8:11], v244 offset:4096
v_mfma_f32_16x16x32_bf16 v[200:203], a[248:251], a[20:23], v[200:203]
s_add_u32 s40, s35, s48
ds_read_b128 a[12:15], v244 offset:6144
ds_read_b128 a[16:19], v244 offset:8192
v_mfma_f32_16x16x32_bf16 v[204:207], a[248:251], a[24:27], v[204:207]
ds_read_b64_tr_b16 a[244:245], v241 offset:0
ds_read_b64_tr_b16 a[246:247], v241 offset:1536
v_mfma_f32_16x16x32_bf16 v[208:211], a[248:251], a[28:31], v[208:211]
buffer_load_dwordx4 v248, s[20:23], s40 offen offset:0 lds
v_mfma_f32_16x16x32_bf16 v[212:215], a[248:251], a[32:35], v[212:215]
v_mfma_f32_16x16x32_bf16 v[216:219], a[248:251], a[36:39], v[216:219]
s_waitcnt lgkmcnt(15)
ds_read_b64_tr_b16 a[248:249], v242 offset:0
ds_read_b64_tr_b16 a[250:251], v242 offset:1536
v_mfma_f32_16x16x32_bf16 a[60:63], a[252:255], a[20:23], a[60:63]
buffer_load_dwordx4 v249, s[20:23], s40 offen offset:1024 lds
v_mfma_f32_16x16x32_bf16 a[64:67], a[252:255], a[24:27], a[64:67]
v_mfma_f32_16x16x32_bf16 a[68:71], a[252:255], a[28:31], a[68:71]
v_mfma_f32_16x16x32_bf16 a[72:75], a[252:255], a[32:35], a[72:75]
buffer_load_dwordx4 v250, s[20:23], s40 offen offset:2048 lds
v_mfma_f32_16x16x32_bf16 a[76:79], a[252:255], a[36:39], a[76:79]
s_waitcnt lgkmcnt(4)
ds_read_b64_tr_b16 a[252:253], v243 offset:0
ds_read_b64_tr_b16 a[254:255], v243 offset:1536
v_mfma_f32_16x16x32_bf16 v[0:3], a[240:243], a[0:3], v[0:3]
s_add_u32 m0, m0, 6144
s_add_u32 s40, s40, 196608
v_mfma_f32_16x16x32_bf16 v[4:7], a[240:243], a[4:7], v[4:7]
buffer_load_dwordx4 v248, s[20:23], s40 offen offset:0 lds
v_mfma_f32_16x16x32_bf16 v[8:11], a[240:243], a[8:11], v[8:11]
v_mfma_f32_16x16x32_bf16 v[12:15], a[240:243], a[12:15], v[12:15]
v_mfma_f32_16x16x32_bf16 v[16:19], a[240:243], a[16:19], v[16:19]
s_waitcnt lgkmcnt(4)
ds_read_b64_tr_b16 a[240:241], v240 offset:128
ds_read_b64_tr_b16 a[242:243], v240 offset:1664
v_mfma_f32_16x16x32_bf16 v[20:23], a[244:247], a[0:3], v[20:23]
buffer_load_dwordx4 v249, s[20:23], s40 offen offset:1024 lds
v_mfma_f32_16x16x32_bf16 v[24:27], a[244:247], a[4:7], v[24:27]
v_mfma_f32_16x16x32_bf16 v[28:31], a[244:247], a[8:11], v[28:31]
v_mfma_f32_16x16x32_bf16 v[32:35], a[244:247], a[12:15], v[32:35]
buffer_load_dwordx4 v250, s[20:23], s40 offen offset:2048 lds
v_mfma_f32_16x16x32_bf16 v[36:39], a[244:247], a[16:19], v[36:39]
s_waitcnt lgkmcnt(4)
ds_read_b64_tr_b16 a[244:245], v241 offset:128
ds_read_b64_tr_b16 a[246:247], v241 offset:1664
v_mfma_f32_16x16x32_bf16 v[40:43], a[248:251], a[0:3], v[40:43]
s_add_u32 s35, s35, 393216
s_sub_u32 s40, s35, 7864320
s_min_u32 s35, s35, s40
v_mfma_f32_16x16x32_bf16 v[44:47], a[248:251], a[4:7], v[44:47]
s_add_u32 s31, s31, 24576
s_sub_u32 s41, s31, 147456
s_min_u32 s31, s31, s41
v_mfma_f32_16x16x32_bf16 v[48:51], a[248:251], a[8:11], v[48:51]
s_mov_b32 m0, s76
v_mfma_f32_16x16x32_bf16 v[52:55], a[248:251], a[12:15], v[52:55]
buffer_load_dword v238, s[60:63], s59 offen lds
v_mfma_f32_16x16x32_bf16 v[56:59], a[248:251], a[16:19], v[56:59]
s_waitcnt lgkmcnt(4)
ds_read_b64_tr_b16 a[248:249], v242 offset:128
ds_read_b64_tr_b16 a[250:251], v242 offset:1664
v_mfma_f32_16x16x32_bf16 v[60:63], a[252:255], a[0:3], v[60:63]
s_add_u32 s59, s59, 3072
v_xor_b32 v244, 64, v244
v_mfma_f32_16x16x32_bf16 v[64:67], a[252:255], a[4:7], v[64:67]
ds_read_b128 a[20:23], v244 offset:0
ds_read_b128 a[24:27], v244 offset:2048
v_mfma_f32_16x16x32_bf16 v[68:71], a[252:255], a[8:11], v[68:71]
ds_read_b128 a[28:31], v244 offset:4096
ds_read_b128 a[32:35], v244 offset:6144
v_mfma_f32_16x16x32_bf16 v[72:75], a[252:255], a[12:15], v[72:75]
ds_read_b128 a[36:39], v244 offset:8192
v_mfma_f32_16x16x32_bf16 v[76:79], a[252:255], a[16:19], v[76:79]
s_waitcnt lgkmcnt(9)
ds_read_b64_tr_b16 a[252:253], v243 offset:128
ds_read_b64_tr_b16 a[254:255], v243 offset:1664
v_mfma_f32_16x16x32_bf16 v[80:83], a[240:243], a[0:3], v[80:83]
buffer_store_dwordx4 v[234:237], v239, s[24:27], s39 offen offset:1024 sc1
v_mfma_f32_16x16x32_bf16 v[84:87], a[240:243], a[4:7], v[84:87]
v_accvgpr_read_b32 v226, a128
v_accvgpr_read_b32 v227, a129
v_mfma_f32_16x16x32_bf16 v[88:91], a[240:243], a[8:11], v[88:91]
v_accvgpr_read_b32 v228, a130
v_accvgpr_read_b32 v229, a131
v_mfma_f32_16x16x32_bf16 v[92:95], a[240:243], a[12:15], v[92:95]
v_mul_f32 v226, v222, v226
v_mul_f32 v227, v222, v227
v_mfma_f32_16x16x32_bf16 v[96:99], a[240:243], a[16:19], v[96:99]
s_waitcnt lgkmcnt(9)
ds_read_b64_tr_b16 a[240:241], v240 offset:256
ds_read_b64_tr_b16 a[242:243], v240 offset:1792
v_mfma_f32_16x16x32_bf16 v[100:103], a[244:247], a[0:3], v[100:103]
v_mul_f32 v228, v222, v228
v_mul_f32 v229, v222, v229
v_mfma_f32_16x16x32_bf16 v[104:107], a[244:247], a[4:7], v[104:107]
v_cvt_pk_bf16_f32 v234, v226, v227
v_cvt_pk_bf16_f32 v235, v228, v229
v_mfma_f32_16x16x32_bf16 v[108:111], a[244:247], a[8:11], v[108:111]
v_accvgpr_read_b32 v230, a148
v_accvgpr_read_b32 v231, a149
v_mfma_f32_16x16x32_bf16 v[112:115], a[244:247], a[12:15], v[112:115]
v_accvgpr_read_b32 v232, a150
v_accvgpr_read_b32 v233, a151
v_mfma_f32_16x16x32_bf16 v[116:119], a[244:247], a[16:19], v[116:119]
s_waitcnt lgkmcnt(9)
ds_read_b64_tr_b16 a[244:245], v241 offset:256
ds_read_b64_tr_b16 a[246:247], v241 offset:1792
v_mfma_f32_16x16x32_bf16 v[120:123], a[248:251], a[0:3], v[120:123]
v_mul_f32 v230, v222, v230
v_mul_f32 v231, v222, v231
v_mfma_f32_16x16x32_bf16 v[124:127], a[248:251], a[4:7], v[124:127]
v_mul_f32 v232, v222, v232
v_mul_f32 v233, v222, v233
v_mfma_f32_16x16x32_bf16 v[128:131], a[248:251], a[8:11], v[128:131]
v_cvt_pk_bf16_f32 v236, v230, v231
v_cvt_pk_bf16_f32 v237, v232, v233
v_mfma_f32_16x16x32_bf16 v[132:135], a[248:251], a[12:15], v[132:135]
buffer_store_dwordx4 v[234:237], v239, s[24:27], s39 offen offset:2048 sc1
v_mfma_f32_16x16x32_bf16 v[136:139], a[248:251], a[16:19], v[136:139]
s_waitcnt lgkmcnt(4)
ds_read_b64_tr_b16 a[248:249], v242 offset:256
ds_read_b64_tr_b16 a[250:251], v242 offset:1792
v_mfma_f32_16x16x32_bf16 v[140:143], a[252:255], a[0:3], v[140:143]
v_accvgpr_read_b32 v226, a132
v_accvgpr_read_b32 v227, a133
v_mfma_f32_16x16x32_bf16 v[144:147], a[252:255], a[4:7], v[144:147]
v_accvgpr_read_b32 v228, a134
v_accvgpr_read_b32 v229, a135
v_mfma_f32_16x16x32_bf16 v[148:151], a[252:255], a[8:11], v[148:151]
v_mul_f32 v226, v223, v226
v_mul_f32 v227, v223, v227
v_mfma_f32_16x16x32_bf16 v[152:155], a[252:255], a[12:15], v[152:155]
v_mul_f32 v228, v223, v228
v_mul_f32 v229, v223, v229
v_mfma_f32_16x16x32_bf16 v[156:159], a[252:255], a[16:19], v[156:159]
s_waitcnt lgkmcnt(4)
ds_read_b64_tr_b16 a[252:253], v243 offset:256
ds_read_b64_tr_b16 a[254:255], v243 offset:1792
v_mfma_f32_16x16x32_bf16 v[160:163], a[240:243], a[0:3], v[160:163]
v_add_u32 v240, s32, v254
v_xor_b32 v241, 32, v240
v_mfma_f32_16x16x32_bf16 v[164:167], a[240:243], a[4:7], v[164:167]
v_xor_b32 v242, 64, v240
v_xor_b32 v243, 64, v241
v_mfma_f32_16x16x32_bf16 v[168:171], a[240:243], a[8:11], v[168:171]
s_add_u32 s32, s32, 24576
s_sub_u32 s42, s32, 147456
s_min_u32 s32, s32, s42
v_mfma_f32_16x16x32_bf16 v[172:175], a[240:243], a[12:15], v[172:175]
v_cvt_pk_bf16_f32 v234, v226, v227
v_cvt_pk_bf16_f32 v235, v228, v229
v_mfma_f32_16x16x32_bf16 v[176:179], a[240:243], a[16:19], v[176:179]
s_waitcnt lgkmcnt(4)
v_accvgpr_read_b32 v230, a152
v_accvgpr_read_b32 v231, a153
v_mfma_f32_16x16x32_bf16 v[180:183], a[244:247], a[0:3], v[180:183]
v_accvgpr_read_b32 v232, a154
v_accvgpr_read_b32 v233, a155
v_mfma_f32_16x16x32_bf16 v[184:187], a[244:247], a[4:7], v[184:187]
v_mul_f32 v230, v223, v230
v_mul_f32 v231, v223, v231
v_mfma_f32_16x16x32_bf16 v[188:191], a[244:247], a[8:11], v[188:191]
s_waitcnt vmcnt(23) lgkmcnt(0)
s_barrier
ds_read_b64_tr_b16 a[240:241], v240 offset:0
v_mfma_f32_16x16x32_bf16 v[192:195], a[244:247], a[12:15], v[192:195]
s_add_u32 m0, s31, s38
s_add_u32 s40, s35, s48
ds_read_b64_tr_b16 a[242:243], v240 offset:1536
v_mfma_f32_16x16x32_bf16 v[196:199], a[244:247], a[16:19], v[196:199]
s_waitcnt lgkmcnt(15)
ds_read_b64_tr_b16 a[244:245], v241 offset:0
ds_read_b64_tr_b16 a[246:247], v241 offset:1536
v_mfma_f32_16x16x32_bf16 v[200:203], a[248:251], a[0:3], v[200:203]
buffer_load_dwordx4 v248, s[20:23], s40 offen offset:0 lds
v_mfma_f32_16x16x32_bf16 v[204:207], a[248:251], a[4:7], v[204:207]
v_mul_f32 v232, v223, v232
v_mul_f32 v233, v223, v233
v_mfma_f32_16x16x32_bf16 v[208:211], a[248:251], a[8:11], v[208:211]
v_cvt_pk_bf16_f32 v236, v230, v231
v_cvt_pk_bf16_f32 v237, v232, v233
v_mfma_f32_16x16x32_bf16 v[212:215], a[248:251], a[12:15], v[212:215]
buffer_load_dwordx4 v249, s[20:23], s40 offen offset:1024 lds
v_mfma_f32_16x16x32_bf16 v[216:219], a[248:251], a[16:19], v[216:219]
s_waitcnt lgkmcnt(15)
ds_read_b64_tr_b16 a[248:249], v242 offset:0
ds_read_b64_tr_b16 a[250:251], v242 offset:1536
v_mfma_f32_16x16x32_bf16 a[60:63], a[252:255], a[0:3], a[60:63]
v_mfma_f32_16x16x32_bf16 a[64:67], a[252:255], a[4:7], a[64:67]
buffer_load_dwordx4 v250, s[20:23], s40 offen offset:2048 lds
v_mfma_f32_16x16x32_bf16 a[68:71], a[252:255], a[8:11], a[68:71]
s_add_u32 m0, m0, 6144
s_add_u32 s40, s40, 196608
v_mfma_f32_16x16x32_bf16 a[72:75], a[252:255], a[12:15], a[72:75]
v_mfma_f32_16x16x32_bf16 a[76:79], a[252:255], a[16:19], a[76:79]
s_waitcnt lgkmcnt(4)
ds_read_b64_tr_b16 a[252:253], v243 offset:0
ds_read_b64_tr_b16 a[254:255], v243 offset:1536
v_mfma_f32_16x16x32_bf16 v[0:3], a[240:243], a[20:23], v[0:3]
buffer_load_dwordx4 v248, s[20:23], s40 offen offset:0 lds
v_mfma_f32_16x16x32_bf16 v[4:7], a[240:243], a[24:27], v[4:7]
v_mfma_f32_16x16x32_bf16 v[8:11], a[240:243], a[28:31], v[8:11]
v_mfma_f32_16x16x32_bf16 v[12:15], a[240:243], a[32:35], v[12:15]
buffer_load_dwordx4 v249, s[20:23], s40 offen offset:1024 lds
v_mfma_f32_16x16x32_bf16 v[16:19], a[240:243], a[36:39], v[16:19]
s_waitcnt lgkmcnt(4)
ds_read_b64_tr_b16 a[240:241], v240 offset:128
ds_read_b64_tr_b16 a[242:243], v240 offset:1664
v_mfma_f32_16x16x32_bf16 v[20:23], a[244:247], a[20:23], v[20:23]
v_mfma_f32_16x16x32_bf16 v[24:27], a[244:247], a[24:27], v[24:27]
buffer_load_dwordx4 v250, s[20:23], s40 offen offset:2048 lds
v_mfma_f32_16x16x32_bf16 v[28:31], a[244:247], a[28:31], v[28:31]
s_add_u32 s35, s35, 393216
s_sub_u32 s40, s35, 7864320
s_min_u32 s35, s35, s40
v_mfma_f32_16x16x32_bf16 v[32:35], a[244:247], a[32:35], v[32:35]
s_add_u32 s31, s31, 24576
s_sub_u32 s41, s31, 147456
s_min_u32 s31, s31, s41
v_mfma_f32_16x16x32_bf16 v[36:39], a[244:247], a[36:39], v[36:39]
s_waitcnt lgkmcnt(4)
ds_read_b64_tr_b16 a[244:245], v241 offset:128
ds_read_b64_tr_b16 a[246:247], v241 offset:1664
v_mfma_f32_16x16x32_bf16 v[40:43], a[248:251], a[20:23], v[40:43]
s_add_u32 m0, s31, s55
s_add_u32 s40, s54, s49
v_mfma_f32_16x16x32_bf16 v[44:47], a[248:251], a[24:27], v[44:47]
buffer_load_dwordx4 v251, s[8:11], s40 offen offset:0 lds
v_mfma_f32_16x16x32_bf16 v[48:51], a[248:251], a[28:31], v[48:51]
s_add_u32 s40, s40, 9216
v_mfma_f32_16x16x32_bf16 v[52:55], a[248:251], a[32:35], v[52:55]
v_mfma_f32_16x16x32_bf16 v[56:59], a[248:251], a[36:39], v[56:59]
s_waitcnt lgkmcnt(4)
ds_read_b64_tr_b16 a[248:249], v242 offset:128
ds_read_b64_tr_b16 a[250:251], v242 offset:1664
v_mfma_f32_16x16x32_bf16 v[60:63], a[252:255], a[20:23], v[60:63]
buffer_load_dwordx4 v251, s[8:11], s40 offen offset:1024 lds
v_mfma_f32_16x16x32_bf16 v[64:67], a[252:255], a[24:27], v[64:67]
s_add_u32 s40, s40, 9216
v_mfma_f32_16x16x32_bf16 v[68:71], a[252:255], a[28:31], v[68:71]
v_mfma_f32_16x16x32_bf16 v[72:75], a[252:255], a[32:35], v[72:75]
buffer_load_dwordx4 v251, s[8:11], s40 offen offset:2048 lds
v_mfma_f32_16x16x32_bf16 v[76:79], a[252:255], a[36:39], v[76:79]
s_waitcnt lgkmcnt(4)
ds_read_b64_tr_b16 a[252:253], v243 offset:128
ds_read_b64_tr_b16 a[254:255], v243 offset:1664
v_mfma_f32_16x16x32_bf16 v[80:83], a[240:243], a[20:23], v[80:83]
s_add_u32 s40, s40, 9216
v_mfma_f32_16x16x32_bf16 v[84:87], a[240:243], a[24:27], v[84:87]
buffer_load_dwordx4 v251, s[8:11], s40 offen offset:3072 lds
v_mfma_f32_16x16x32_bf16 v[88:91], a[240:243], a[28:31], v[88:91]
s_add_u32 m0, m0, 4096
s_add_u32 s40, s40, 13312
v_mfma_f32_16x16x32_bf16 v[92:95], a[240:243], a[32:35], v[92:95]
v_mfma_f32_16x16x32_bf16 v[96:99], a[240:243], a[36:39], v[96:99]
s_waitcnt lgkmcnt(4)
ds_read_b64_tr_b16 a[240:241], v240 offset:256
ds_read_b64_tr_b16 a[242:243], v240 offset:1792
v_mfma_f32_16x16x32_bf16 v[100:103], a[244:247], a[20:23], v[100:103]
buffer_load_dwordx4 v251, s[8:11], s40 offen lds
v_mfma_f32_16x16x32_bf16 v[104:107], a[244:247], a[24:27], v[104:107]
s_add_u32 s54, s54, 128
s_sub_u32 s40, s54, 1280
s_min_u32 s54, s54, s40
v_mfma_f32_16x16x32_bf16 v[108:111], a[244:247], a[28:31], v[108:111]
s_add_u32 s31, s31, 24576
s_sub_u32 s41, s31, 147456
s_min_u32 s31, s31, s41
v_mfma_f32_16x16x32_bf16 v[112:115], a[244:247], a[32:35], v[112:115]
buffer_store_dwordx4 v[234:237], v239, s[24:27], s39 offen offset:3072 sc1
v_mfma_f32_16x16x32_bf16 v[116:119], a[244:247], a[36:39], v[116:119]
s_waitcnt lgkmcnt(4)
ds_read_b64_tr_b16 a[244:245], v241 offset:256
ds_read_b64_tr_b16 a[246:247], v241 offset:1792
v_mfma_f32_16x16x32_bf16 v[120:123], a[248:251], a[20:23], v[120:123]
v_accvgpr_read_b32 v226, a136
v_accvgpr_read_b32 v227, a137
v_mfma_f32_16x16x32_bf16 v[124:127], a[248:251], a[24:27], v[124:127]
v_accvgpr_read_b32 v228, a138
v_accvgpr_read_b32 v229, a139
v_mfma_f32_16x16x32_bf16 v[128:131], a[248:251], a[28:31], v[128:131]
v_mul_f32 v226, v224, v226
v_mul_f32 v227, v224, v227
v_mfma_f32_16x16x32_bf16 v[132:135], a[248:251], a[32:35], v[132:135]
v_mul_f32 v228, v224, v228
v_mul_f32 v229, v224, v229
v_mfma_f32_16x16x32_bf16 v[136:139], a[248:251], a[36:39], v[136:139]
s_waitcnt lgkmcnt(4)
ds_read_b64_tr_b16 a[248:249], v242 offset:256
ds_read_b64_tr_b16 a[250:251], v242 offset:1792
v_mfma_f32_16x16x32_bf16 v[140:143], a[252:255], a[20:23], v[140:143]
v_cvt_pk_bf16_f32 v234, v226, v227
v_cvt_pk_bf16_f32 v235, v228, v229
v_mfma_f32_16x16x32_bf16 v[144:147], a[252:255], a[24:27], v[144:147]
v_accvgpr_read_b32 v230, a156
v_accvgpr_read_b32 v231, a157
v_mfma_f32_16x16x32_bf16 v[148:151], a[252:255], a[28:31], v[148:151]
v_accvgpr_read_b32 v232, a158
v_accvgpr_read_b32 v233, a159
v_mfma_f32_16x16x32_bf16 v[152:155], a[252:255], a[32:35], v[152:155]
v_mul_f32 v230, v224, v230
v_mul_f32 v231, v224, v231
v_mfma_f32_16x16x32_bf16 v[156:159], a[252:255], a[36:39], v[156:159]
s_waitcnt lgkmcnt(4)
ds_read_b64_tr_b16 a[252:253], v243 offset:256
ds_read_b64_tr_b16 a[254:255], v243 offset:1792
v_mfma_f32_16x16x32_bf16 v[160:163], a[240:243], a[20:23], v[160:163]
v_add_u32 v240, s32, v254
v_xor_b32 v241, 32, v240
v_mfma_f32_16x16x32_bf16 v[164:167], a[240:243], a[24:27], v[164:167]
v_xor_b32 v242, 64, v240
v_xor_b32 v243, 64, v241
v_mfma_f32_16x16x32_bf16 v[168:171], a[240:243], a[28:31], v[168:171]
s_add_u32 s32, s32, 24576
s_sub_u32 s42, s32, 147456
s_min_u32 s32, s32, s42
v_mfma_f32_16x16x32_bf16 v[172:175], a[240:243], a[32:35], v[172:175]
v_add_u32 v244, s32, v255
v_mul_f32 v232, v224, v232
v_mfma_f32_16x16x32_bf16 v[176:179], a[240:243], a[36:39], v[176:179]
s_waitcnt lgkmcnt(4)
s_add_u32 s32, s32, 24576
s_sub_u32 s42, s32, 147456
v_mfma_f32_16x16x32_bf16 v[180:183], a[244:247], a[20:23], v[180:183]
s_min_u32 s32, s32, s42
v_mul_f32 v233, v224, v233
v_cvt_pk_bf16_f32 v236, v230, v231
v_mfma_f32_16x16x32_bf16 v[184:187], a[244:247], a[24:27], v[184:187]
v_cvt_pk_bf16_f32 v237, v232, v233
v_mfma_f32_16x16x32_bf16 v[188:191], a[244:247], a[28:31], v[188:191]
s_waitcnt vmcnt(22) lgkmcnt(0)
s_barrier
ds_read_b64_tr_b16 a[240:241], v240 offset:0
v_mfma_f32_16x16x32_bf16 v[192:195], a[244:247], a[32:35], v[192:195]
s_add_u32 m0, s31, s38
ds_read_b64_tr_b16 a[242:243], v240 offset:1536
ds_read_b128 a[0:3], v244 offset:0
v_mfma_f32_16x16x32_bf16 v[196:199], a[244:247], a[36:39], v[196:199]
s_waitcnt lgkmcnt(15)
ds_read_b128 a[4:7], v244 offset:2048
ds_read_b128 a[8:11], v244 offset:4096
v_mfma_f32_16x16x32_bf16 v[200:203], a[248:251], a[20:23], v[200:203]
s_add_u32 s40, s35, s48
ds_read_b128 a[12:15], v244 offset:6144
ds_read_b128 a[16:19], v244 offset:8192
v_mfma_f32_16x16x32_bf16 v[204:207], a[248:251], a[24:27], v[204:207]
ds_read_b64_tr_b16 a[244:245], v241 offset:0
ds_read_b64_tr_b16 a[246:247], v241 offset:1536
v_mfma_f32_16x16x32_bf16 v[208:211], a[248:251], a[28:31], v[208:211]
buffer_load_dwordx4 v248, s[20:23], s40 offen offset:0 lds
v_mfma_f32_16x16x32_bf16 v[212:215], a[248:251], a[32:35], v[212:215]
v_mfma_f32_16x16x32_bf16 v[216:219], a[248:251], a[36:39], v[216:219]
s_waitcnt lgkmcnt(15)
ds_read_b64_tr_b16 a[248:249], v242 offset:0
ds_read_b64_tr_b16 a[250:251], v242 offset:1536
v_mfma_f32_16x16x32_bf16 a[60:63], a[252:255], a[20:23], a[60:63]
buffer_load_dwordx4 v249, s[20:23], s40 offen offset:1024 lds
v_mfma_f32_16x16x32_bf16 a[64:67], a[252:255], a[24:27], a[64:67]
v_mfma_f32_16x16x32_bf16 a[68:71], a[252:255], a[28:31], a[68:71]
v_mfma_f32_16x16x32_bf16 a[72:75], a[252:255], a[32:35], a[72:75]
buffer_load_dwordx4 v250, s[20:23], s40 offen offset:2048 lds
v_mfma_f32_16x16x32_bf16 a[76:79], a[252:255], a[36:39], a[76:79]
s_waitcnt lgkmcnt(4)
ds_read_b64_tr_b16 a[252:253], v243 offset:0
ds_read_b64_tr_b16 a[254:255], v243 offset:1536
v_mfma_f32_16x16x32_bf16 v[0:3], a[240:243], a[0:3], v[0:3]
s_add_u32 m0, m0, 6144
s_add_u32 s40, s40, 196608
v_mfma_f32_16x16x32_bf16 v[4:7], a[240:243], a[4:7], v[4:7]
buffer_load_dwordx4 v248, s[20:23], s40 offen offset:0 lds
v_mfma_f32_16x16x32_bf16 v[8:11], a[240:243], a[8:11], v[8:11]
v_mfma_f32_16x16x32_bf16 v[12:15], a[240:243], a[12:15], v[12:15]
v_mfma_f32_16x16x32_bf16 v[16:19], a[240:243], a[16:19], v[16:19]
s_waitcnt lgkmcnt(4)
ds_read_b64_tr_b16 a[240:241], v240 offset:128
ds_read_b64_tr_b16 a[242:243], v240 offset:1664
v_mfma_f32_16x16x32_bf16 v[20:23], a[244:247], a[0:3], v[20:23]
buffer_load_dwordx4 v249, s[20:23], s40 offen offset:1024 lds
v_mfma_f32_16x16x32_bf16 v[24:27], a[244:247], a[4:7], v[24:27]
v_mfma_f32_16x16x32_bf16 v[28:31], a[244:247], a[8:11], v[28:31]
v_mfma_f32_16x16x32_bf16 v[32:35], a[244:247], a[12:15], v[32:35]
buffer_load_dwordx4 v250, s[20:23], s40 offen offset:2048 lds
v_mfma_f32_16x16x32_bf16 v[36:39], a[244:247], a[16:19], v[36:39]
s_waitcnt lgkmcnt(4)
ds_read_b64_tr_b16 a[244:245], v241 offset:128
ds_read_b64_tr_b16 a[246:247], v241 offset:1664
v_mfma_f32_16x16x32_bf16 v[40:43], a[248:251], a[0:3], v[40:43]
s_add_u32 s35, s35, 393216
s_sub_u32 s40, s35, 7864320
s_min_u32 s35, s35, s40
v_mfma_f32_16x16x32_bf16 v[44:47], a[248:251], a[4:7], v[44:47]
s_add_u32 s31, s31, 24576
s_sub_u32 s41, s31, 147456
s_min_u32 s31, s31, s41
v_mfma_f32_16x16x32_bf16 v[48:51], a[248:251], a[8:11], v[48:51]
s_mov_b32 m0, s76
v_mfma_f32_16x16x32_bf16 v[52:55], a[248:251], a[12:15], v[52:55]
buffer_load_dword v238, s[60:63], s59 offen lds
v_mfma_f32_16x16x32_bf16 v[56:59], a[248:251], a[16:19], v[56:59]
s_waitcnt lgkmcnt(4)
ds_read_b64_tr_b16 a[248:249], v242 offset:128
ds_read_b64_tr_b16 a[250:251], v242 offset:1664
v_mfma_f32_16x16x32_bf16 v[60:63], a[252:255], a[0:3], v[60:63]
s_add_u32 s59, s59, 3072
v_xor_b32 v244, 64, v244
v_mfma_f32_16x16x32_bf16 v[64:67], a[252:255], a[4:7], v[64:67]
ds_read_b128 a[20:23], v244 offset:0
ds_read_b128 a[24:27], v244 offset:2048
v_mfma_f32_16x16x32_bf16 v[68:71], a[252:255], a[8:11], v[68:71]
ds_read_b128 a[28:31], v244 offset:4096
ds_read_b128 a[32:35], v244 offset:6144
v_mfma_f32_16x16x32_bf16 v[72:75], a[252:255], a[12:15], v[72:75]
ds_read_b128 a[36:39], v244 offset:8192
v_mfma_f32_16x16x32_bf16 v[76:79], a[252:255], a[16:19], v[76:79]
s_waitcnt lgkmcnt(9)
ds_read_b64_tr_b16 a[252:253], v243 offset:128
ds_read_b64_tr_b16 a[254:255], v243 offset:1664
v_mfma_f32_16x16x32_bf16 v[80:83], a[240:243], a[0:3], v[80:83]
buffer_store_dwordx4 v[234:237], v225, s[24:27], s39 offen sc1
v_mfma_f32_16x16x32_bf16 v[84:87], a[240:243], a[4:7], v[84:87]
v_accvgpr_read_b32 v226, a160
v_accvgpr_read_b32 v227, a161
v_mfma_f32_16x16x32_bf16 v[88:91], a[240:243], a[8:11], v[88:91]
v_accvgpr_read_b32 v228, a162
v_accvgpr_read_b32 v229, a163
v_mfma_f32_16x16x32_bf16 v[92:95], a[240:243], a[12:15], v[92:95]
v_mul_f32 v226, v220, v226
v_mul_f32 v227, v220, v227
v_mfma_f32_16x16x32_bf16 v[96:99], a[240:243], a[16:19], v[96:99]
s_waitcnt lgkmcnt(9)
ds_read_b64_tr_b16 a[240:241], v240 offset:256
ds_read_b64_tr_b16 a[242:243], v240 offset:1792
v_mfma_f32_16x16x32_bf16 v[100:103], a[244:247], a[0:3], v[100:103]
v_mul_f32 v228, v220, v228
v_mul_f32 v229, v220, v229
v_mfma_f32_16x16x32_bf16 v[104:107], a[244:247], a[4:7], v[104:107]
v_cvt_pk_bf16_f32 v234, v226, v227
v_cvt_pk_bf16_f32 v235, v228, v229
v_mfma_f32_16x16x32_bf16 v[108:111], a[244:247], a[8:11], v[108:111]
v_accvgpr_read_b32 v230, a180
v_accvgpr_read_b32 v231, a181
v_mfma_f32_16x16x32_bf16 v[112:115], a[244:247], a[12:15], v[112:115]
v_accvgpr_read_b32 v232, a182
v_accvgpr_read_b32 v233, a183
v_mfma_f32_16x16x32_bf16 v[116:119], a[244:247], a[16:19], v[116:119]
s_waitcnt lgkmcnt(9)
ds_read_b64_tr_b16 a[244:245], v241 offset:256
ds_read_b64_tr_b16 a[246:247], v241 offset:1792
v_mfma_f32_16x16x32_bf16 v[120:123], a[248:251], a[0:3], v[120:123]
v_mul_f32 v230, v220, v230
v_mul_f32 v231, v220, v231
v_mfma_f32_16x16x32_bf16 v[124:127], a[248:251], a[4:7], v[124:127]
v_mul_f32 v232, v220, v232
v_mul_f32 v233, v220, v233
v_mfma_f32_16x16x32_bf16 v[128:131], a[248:251], a[8:11], v[128:131]
v_cvt_pk_bf16_f32 v236, v230, v231
v_cvt_pk_bf16_f32 v237, v232, v233
v_mfma_f32_16x16x32_bf16 v[132:135], a[248:251], a[12:15], v[132:135]
s_add_u32 s39, s47, 40960
v_mfma_f32_16x16x32_bf16 v[136:139], a[248:251], a[16:19], v[136:139]
s_waitcnt lgkmcnt(4)
ds_read_b64_tr_b16 a[248:249], v242 offset:256
ds_read_b64_tr_b16 a[250:251], v242 offset:1792
v_mfma_f32_16x16x32_bf16 v[140:143], a[252:255], a[0:3], v[140:143]
buffer_store_dwordx4 v[234:237], v239, s[24:27], s39 offen offset:0 sc1
v_mfma_f32_16x16x32_bf16 v[144:147], a[252:255], a[4:7], v[144:147]
v_accvgpr_read_b32 v226, a164
v_accvgpr_read_b32 v227, a165
v_mfma_f32_16x16x32_bf16 v[148:151], a[252:255], a[8:11], v[148:151]
v_accvgpr_read_b32 v228, a166
v_accvgpr_read_b32 v229, a167
v_mfma_f32_16x16x32_bf16 v[152:155], a[252:255], a[12:15], v[152:155]
v_mul_f32 v226, v221, v226
v_mul_f32 v227, v221, v227
v_mfma_f32_16x16x32_bf16 v[156:159], a[252:255], a[16:19], v[156:159]
s_waitcnt lgkmcnt(4)
ds_read_b64_tr_b16 a[252:253], v243 offset:256
ds_read_b64_tr_b16 a[254:255], v243 offset:1792
v_mfma_f32_16x16x32_bf16 v[160:163], a[240:243], a[0:3], v[160:163]
v_add_u32 v240, s32, v254
v_xor_b32 v241, 32, v240
v_mfma_f32_16x16x32_bf16 v[164:167], a[240:243], a[4:7], v[164:167]
v_xor_b32 v242, 64, v240
v_xor_b32 v243, 64, v241
v_mfma_f32_16x16x32_bf16 v[168:171], a[240:243], a[8:11], v[168:171]
s_add_u32 s32, s32, 24576
s_sub_u32 s42, s32, 147456
s_min_u32 s32, s32, s42
v_mfma_f32_16x16x32_bf16 v[172:175], a[240:243], a[12:15], v[172:175]
v_mul_f32 v228, v221, v228
v_mul_f32 v229, v221, v229
v_mfma_f32_16x16x32_bf16 v[176:179], a[240:243], a[16:19], v[176:179]
s_waitcnt lgkmcnt(4)
v_cvt_pk_bf16_f32 v234, v226, v227
v_cvt_pk_bf16_f32 v235, v228, v229
v_mfma_f32_16x16x32_bf16 v[180:183], a[244:247], a[0:3], v[180:183]
v_accvgpr_read_b32 v230, a184
v_accvgpr_read_b32 v231, a185
v_mfma_f32_16x16x32_bf16 v[184:187], a[244:247], a[4:7], v[184:187]
v_accvgpr_read_b32 v232, a186
v_accvgpr_read_b32 v233, a187
v_mfma_f32_16x16x32_bf16 v[188:191], a[244:247], a[8:11], v[188:191]
s_waitcnt vmcnt(24) lgkmcnt(0)
s_barrier
ds_read_b64_tr_b16 a[240:241], v240 offset:0
v_mfma_f32_16x16x32_bf16 v[192:195], a[244:247], a[12:15], v[192:195]
s_add_u32 m0, s31, s38
s_add_u32 s40, s35, s48
ds_read_b64_tr_b16 a[242:243], v240 offset:1536
v_mfma_f32_16x16x32_bf16 v[196:199], a[244:247], a[16:19], v[196:199]
s_waitcnt lgkmcnt(15)
ds_read_b64_tr_b16 a[244:245], v241 offset:0
ds_read_b64_tr_b16 a[246:247], v241 offset:1536
v_mfma_f32_16x16x32_bf16 v[200:203], a[248:251], a[0:3], v[200:203]
buffer_load_dwordx4 v248, s[20:23], s40 offen offset:0 lds
v_mfma_f32_16x16x32_bf16 v[204:207], a[248:251], a[4:7], v[204:207]
v_mul_f32 v230, v221, v230
v_mul_f32 v231, v221, v231
v_mfma_f32_16x16x32_bf16 v[208:211], a[248:251], a[8:11], v[208:211]
v_mul_f32 v232, v221, v232
v_mul_f32 v233, v221, v233
v_mfma_f32_16x16x32_bf16 v[212:215], a[248:251], a[12:15], v[212:215]
buffer_load_dwordx4 v249, s[20:23], s40 offen offset:1024 lds
v_mfma_f32_16x16x32_bf16 v[216:219], a[248:251], a[16:19], v[216:219]
s_waitcnt lgkmcnt(15)
ds_read_b64_tr_b16 a[248:249], v242 offset:0
ds_read_b64_tr_b16 a[250:251], v242 offset:1536
v_mfma_f32_16x16x32_bf16 a[60:63], a[252:255], a[0:3], a[60:63]
v_cvt_pk_bf16_f32 v236, v230, v231
v_cvt_pk_bf16_f32 v237, v232, v233
v_mfma_f32_16x16x32_bf16 a[64:67], a[252:255], a[4:7], a[64:67]
buffer_load_dwordx4 v250, s[20:23], s40 offen offset:2048 lds
v_mfma_f32_16x16x32_bf16 a[68:71], a[252:255], a[8:11], a[68:71]
s_add_u32 m0, m0, 6144
s_add_u32 s40, s40, 196608
v_mfma_f32_16x16x32_bf16 a[72:75], a[252:255], a[12:15], a[72:75]
v_mfma_f32_16x16x32_bf16 a[76:79], a[252:255], a[16:19], a[76:79]
s_waitcnt lgkmcnt(4)
ds_read_b64_tr_b16 a[252:253], v243 offset:0
ds_read_b64_tr_b16 a[254:255], v243 offset:1536
v_mfma_f32_16x16x32_bf16 v[0:3], a[240:243], a[20:23], v[0:3]
buffer_load_dwordx4 v248, s[20:23], s40 offen offset:0 lds
v_mfma_f32_16x16x32_bf16 v[4:7], a[240:243], a[24:27], v[4:7]
v_mfma_f32_16x16x32_bf16 v[8:11], a[240:243], a[28:31], v[8:11]
v_mfma_f32_16x16x32_bf16 v[12:15], a[240:243], a[32:35], v[12:15]
buffer_load_dwordx4 v249, s[20:23], s40 offen offset:1024 lds
v_mfma_f32_16x16x32_bf16 v[16:19], a[240:243], a[36:39], v[16:19]
s_waitcnt lgkmcnt(4)
ds_read_b64_tr_b16 a[240:241], v240 offset:128
ds_read_b64_tr_b16 a[242:243], v240 offset:1664
v_mfma_f32_16x16x32_bf16 v[20:23], a[244:247], a[20:23], v[20:23]
v_mfma_f32_16x16x32_bf16 v[24:27], a[244:247], a[24:27], v[24:27]
buffer_load_dwordx4 v250, s[20:23], s40 offen offset:2048 lds
v_mfma_f32_16x16x32_bf16 v[28:31], a[244:247], a[28:31], v[28:31]
s_add_u32 s35, s35, 393216
s_sub_u32 s40, s35, 7864320
s_min_u32 s35, s35, s40
v_mfma_f32_16x16x32_bf16 v[32:35], a[244:247], a[32:35], v[32:35]
s_add_u32 s31, s31, 24576
s_sub_u32 s41, s31, 147456
s_min_u32 s31, s31, s41
v_mfma_f32_16x16x32_bf16 v[36:39], a[244:247], a[36:39], v[36:39]
s_waitcnt lgkmcnt(4)
ds_read_b64_tr_b16 a[244:245], v241 offset:128
ds_read_b64_tr_b16 a[246:247], v241 offset:1664
v_mfma_f32_16x16x32_bf16 v[40:43], a[248:251], a[20:23], v[40:43]
s_add_u32 m0, s31, s55
s_add_u32 s40, s54, s49
v_mfma_f32_16x16x32_bf16 v[44:47], a[248:251], a[24:27], v[44:47]
buffer_load_dwordx4 v251, s[8:11], s40 offen offset:0 lds
v_mfma_f32_16x16x32_bf16 v[48:51], a[248:251], a[28:31], v[48:51]
s_add_u32 s40, s40, 9216
v_mfma_f32_16x16x32_bf16 v[52:55], a[248:251], a[32:35], v[52:55]
v_mfma_f32_16x16x32_bf16 v[56:59], a[248:251], a[36:39], v[56:59]
s_waitcnt lgkmcnt(4)
ds_read_b64_tr_b16 a[248:249], v242 offset:128
ds_read_b64_tr_b16 a[250:251], v242 offset:1664
v_mfma_f32_16x16x32_bf16 v[60:63], a[252:255], a[20:23], v[60:63]
buffer_load_dwordx4 v251, s[8:11], s40 offen offset:1024 lds
v_mfma_f32_16x16x32_bf16 v[64:67], a[252:255], a[24:27], v[64:67]
s_add_u32 s40, s40, 9216
v_mfma_f32_16x16x32_bf16 v[68:71], a[252:255], a[28:31], v[68:71]
v_mfma_f32_16x16x32_bf16 v[72:75], a[252:255], a[32:35], v[72:75]
buffer_load_dwordx4 v251, s[8:11], s40 offen offset:2048 lds
v_mfma_f32_16x16x32_bf16 v[76:79], a[252:255], a[36:39], v[76:79]
s_waitcnt lgkmcnt(4)
ds_read_b64_tr_b16 a[252:253], v243 offset:128
ds_read_b64_tr_b16 a[254:255], v243 offset:1664
v_mfma_f32_16x16x32_bf16 v[80:83], a[240:243], a[20:23], v[80:83]
s_add_u32 s40, s40, 9216
v_mfma_f32_16x16x32_bf16 v[84:87], a[240:243], a[24:27], v[84:87]
buffer_load_dwordx4 v251, s[8:11], s40 offen offset:3072 lds
v_mfma_f32_16x16x32_bf16 v[88:91], a[240:243], a[28:31], v[88:91]
s_add_u32 m0, m0, 4096
s_add_u32 s40, s40, 13312
v_mfma_f32_16x16x32_bf16 v[92:95], a[240:243], a[32:35], v[92:95]
v_mfma_f32_16x16x32_bf16 v[96:99], a[240:243], a[36:39], v[96:99]
s_waitcnt lgkmcnt(4)
ds_read_b64_tr_b16 a[240:241], v240 offset:256
ds_read_b64_tr_b16 a[242:243], v240 offset:1792
v_mfma_f32_16x16x32_bf16 v[100:103], a[244:247], a[20:23], v[100:103]
buffer_load_dwordx4 v251, s[8:11], s40 offen lds
v_mfma_f32_16x16x32_bf16 v[104:107], a[244:247], a[24:27], v[104:107]
s_add_u32 s54, s54, 128
s_sub_u32 s40, s54, 1280
s_min_u32 s54, s54, s40
v_mfma_f32_16x16x32_bf16 v[108:111], a[244:247], a[28:31], v[108:111]
s_add_u32 s31, s31, 24576
s_sub_u32 s41, s31, 147456
s_min_u32 s31, s31, s41
v_mfma_f32_16x16x32_bf16 v[112:115], a[244:247], a[32:35], v[112:115]
buffer_store_dwordx4 v[234:237], v239, s[24:27], s39 offen offset:1024 sc1
v_mfma_f32_16x16x32_bf16 v[116:119], a[244:247], a[36:39], v[116:119]
s_waitcnt lgkmcnt(4)
ds_read_b64_tr_b16 a[244:245], v241 offset:256
ds_read_b64_tr_b16 a[246:247], v241 offset:1792
v_mfma_f32_16x16x32_bf16 v[120:123], a[248:251], a[20:23], v[120:123]
v_accvgpr_read_b32 v226, a168
v_accvgpr_read_b32 v227, a169
v_mfma_f32_16x16x32_bf16 v[124:127], a[248:251], a[24:27], v[124:127]
v_accvgpr_read_b32 v228, a170
v_accvgpr_read_b32 v229, a171
v_mfma_f32_16x16x32_bf16 v[128:131], a[248:251], a[28:31], v[128:131]
v_mul_f32 v226, v222, v226
v_mul_f32 v227, v222, v227
v_mfma_f32_16x16x32_bf16 v[132:135], a[248:251], a[32:35], v[132:135]
v_mul_f32 v228, v222, v228
v_mul_f32 v229, v222, v229
v_mfma_f32_16x16x32_bf16 v[136:139], a[248:251], a[36:39], v[136:139]
s_waitcnt lgkmcnt(4)
ds_read_b64_tr_b16 a[248:249], v242 offset:256
ds_read_b64_tr_b16 a[250:251], v242 offset:1792
v_mfma_f32_16x16x32_bf16 v[140:143], a[252:255], a[20:23], v[140:143]
v_cvt_pk_bf16_f32 v234, v226, v227
v_cvt_pk_bf16_f32 v235, v228, v229
v_mfma_f32_16x16x32_bf16 v[144:147], a[252:255], a[24:27], v[144:147]
v_accvgpr_read_b32 v230, a188
v_accvgpr_read_b32 v231, a189
v_mfma_f32_16x16x32_bf16 v[148:151], a[252:255], a[28:31], v[148:151]
v_accvgpr_read_b32 v232, a190
v_accvgpr_read_b32 v233, a191
v_mfma_f32_16x16x32_bf16 v[152:155], a[252:255], a[32:35], v[152:155]
v_mul_f32 v230, v222, v230
v_mul_f32 v231, v222, v231
v_mfma_f32_16x16x32_bf16 v[156:159], a[252:255], a[36:39], v[156:159]
s_waitcnt lgkmcnt(4)
ds_read_b64_tr_b16 a[252:253], v243 offset:256
ds_read_b64_tr_b16 a[254:255], v243 offset:1792
v_mfma_f32_16x16x32_bf16 v[160:163], a[240:243], a[20:23], v[160:163]
v_add_u32 v240, s32, v254
v_xor_b32 v241, 32, v240
v_mfma_f32_16x16x32_bf16 v[164:167], a[240:243], a[24:27], v[164:167]
v_xor_b32 v242, 64, v240
v_xor_b32 v243, 64, v241
v_mfma_f32_16x16x32_bf16 v[168:171], a[240:243], a[28:31], v[168:171]
s_add_u32 s32, s32, 24576
s_sub_u32 s42, s32, 147456
s_min_u32 s32, s32, s42
v_mfma_f32_16x16x32_bf16 v[172:175], a[240:243], a[32:35], v[172:175]
v_add_u32 v244, s32, v255
v_mul_f32 v232, v222, v232
v_mfma_f32_16x16x32_bf16 v[176:179], a[240:243], a[36:39], v[176:179]
s_waitcnt lgkmcnt(4)
s_add_u32 s32, s32, 24576
s_sub_u32 s42, s32, 147456
v_mfma_f32_16x16x32_bf16 v[180:183], a[244:247], a[20:23], v[180:183]
s_min_u32 s32, s32, s42
v_mul_f32 v233, v222, v233
v_cvt_pk_bf16_f32 v236, v230, v231
v_mfma_f32_16x16x32_bf16 v[184:187], a[244:247], a[24:27], v[184:187]
v_cvt_pk_bf16_f32 v237, v232, v233
v_mfma_f32_16x16x32_bf16 v[188:191], a[244:247], a[28:31], v[188:191]
s_waitcnt vmcnt(22) lgkmcnt(0)
s_barrier
ds_read_b64_tr_b16 a[240:241], v240 offset:0
v_mfma_f32_16x16x32_bf16 v[192:195], a[244:247], a[32:35], v[192:195]
s_add_u32 m0, s31, s38
ds_read_b64_tr_b16 a[242:243], v240 offset:1536
ds_read_b128 a[0:3], v244 offset:0
v_mfma_f32_16x16x32_bf16 v[196:199], a[244:247], a[36:39], v[196:199]
s_waitcnt lgkmcnt(15)
ds_read_b128 a[4:7], v244 offset:2048
ds_read_b128 a[8:11], v244 offset:4096
v_mfma_f32_16x16x32_bf16 v[200:203], a[248:251], a[20:23], v[200:203]
s_add_u32 s40, s35, s48
ds_read_b128 a[12:15], v244 offset:6144
ds_read_b128 a[16:19], v244 offset:8192
v_mfma_f32_16x16x32_bf16 v[204:207], a[248:251], a[24:27], v[204:207]
ds_read_b64_tr_b16 a[244:245], v241 offset:0
ds_read_b64_tr_b16 a[246:247], v241 offset:1536
v_mfma_f32_16x16x32_bf16 v[208:211], a[248:251], a[28:31], v[208:211]
buffer_load_dwordx4 v248, s[20:23], s40 offen offset:0 lds
v_mfma_f32_16x16x32_bf16 v[212:215], a[248:251], a[32:35], v[212:215]
v_mfma_f32_16x16x32_bf16 v[216:219], a[248:251], a[36:39], v[216:219]
s_waitcnt lgkmcnt(15)
ds_read_b64_tr_b16 a[248:249], v242 offset:0
ds_read_b64_tr_b16 a[250:251], v242 offset:1536
v_mfma_f32_16x16x32_bf16 a[60:63], a[252:255], a[20:23], a[60:63]
buffer_load_dwordx4 v249, s[20:23], s40 offen offset:1024 lds
v_mfma_f32_16x16x32_bf16 a[64:67], a[252:255], a[24:27], a[64:67]
v_mfma_f32_16x16x32_bf16 a[68:71], a[252:255], a[28:31], a[68:71]
v_mfma_f32_16x16x32_bf16 a[72:75], a[252:255], a[32:35], a[72:75]
buffer_load_dwordx4 v250, s[20:23], s40 offen offset:2048 lds
v_mfma_f32_16x16x32_bf16 a[76:79], a[252:255], a[36:39], a[76:79]
s_waitcnt lgkmcnt(4)
ds_read_b64_tr_b16 a[252:253], v243 offset:0
ds_read_b64_tr_b16 a[254:255], v243 offset:1536
v_mfma_f32_16x16x32_bf16 v[0:3], a[240:243], a[0:3], v[0:3]
s_add_u32 m0, m0, 6144
s_add_u32 s40, s40, 196608
v_mfma_f32_16x16x32_bf16 v[4:7], a[240:243], a[4:7], v[4:7]
buffer_load_dwordx4 v248, s[20:23], s40 offen offset:0 lds
v_mfma_f32_16x16x32_bf16 v[8:11], a[240:243], a[8:11], v[8:11]
v_mfma_f32_16x16x32_bf16 v[12:15], a[240:243], a[12:15], v[12:15]
v_mfma_f32_16x16x32_bf16 v[16:19], a[240:243], a[16:19], v[16:19]
s_waitcnt lgkmcnt(4)
ds_read_b64_tr_b16 a[240:241], v240 offset:128
ds_read_b64_tr_b16 a[242:243], v240 offset:1664
v_mfma_f32_16x16x32_bf16 v[20:23], a[244:247], a[0:3], v[20:23]
buffer_load_dwordx4 v249, s[20:23], s40 offen offset:1024 lds
v_mfma_f32_16x16x32_bf16 v[24:27], a[244:247], a[4:7], v[24:27]
v_mfma_f32_16x16x32_bf16 v[28:31], a[244:247], a[8:11], v[28:31]
v_mfma_f32_16x16x32_bf16 v[32:35], a[244:247], a[12:15], v[32:35]
buffer_load_dwordx4 v250, s[20:23], s40 offen offset:2048 lds
v_mfma_f32_16x16x32_bf16 v[36:39], a[244:247], a[16:19], v[36:39]
s_waitcnt lgkmcnt(4)
ds_read_b64_tr_b16 a[244:245], v241 offset:128
ds_read_b64_tr_b16 a[246:247], v241 offset:1664
v_mfma_f32_16x16x32_bf16 v[40:43], a[248:251], a[0:3], v[40:43]
s_add_u32 s35, s35, 393216
s_sub_u32 s40, s35, 7864320
s_min_u32 s35, s35, s40
v_mfma_f32_16x16x32_bf16 v[44:47], a[248:251], a[4:7], v[44:47]
s_add_u32 s31, s31, 24576
s_sub_u32 s41, s31, 147456
s_min_u32 s31, s31, s41
v_mfma_f32_16x16x32_bf16 v[48:51], a[248:251], a[8:11], v[48:51]
s_mov_b32 m0, s76
v_mfma_f32_16x16x32_bf16 v[52:55], a[248:251], a[12:15], v[52:55]
buffer_load_dword v238, s[60:63], s59 offen lds
v_mfma_f32_16x16x32_bf16 v[56:59], a[248:251], a[16:19], v[56:59]
s_waitcnt lgkmcnt(4)
ds_read_b64_tr_b16 a[248:249], v242 offset:128
ds_read_b64_tr_b16 a[250:251], v242 offset:1664
v_mfma_f32_16x16x32_bf16 v[60:63], a[252:255], a[0:3], v[60:63]
s_add_u32 s59, s59, 3072
v_xor_b32 v244, 64, v244
v_mfma_f32_16x16x32_bf16 v[64:67], a[252:255], a[4:7], v[64:67]
ds_read_b128 a[20:23], v244 offset:0
ds_read_b128 a[24:27], v244 offset:2048
v_mfma_f32_16x16x32_bf16 v[68:71], a[252:255], a[8:11], v[68:71]
ds_read_b128 a[28:31], v244 offset:4096
ds_read_b128 a[32:35], v244 offset:6144
v_mfma_f32_16x16x32_bf16 v[72:75], a[252:255], a[12:15], v[72:75]
ds_read_b128 a[36:39], v244 offset:8192
v_mfma_f32_16x16x32_bf16 v[76:79], a[252:255], a[16:19], v[76:79]
s_waitcnt lgkmcnt(9)
ds_read_b64_tr_b16 a[252:253], v243 offset:128
ds_read_b64_tr_b16 a[254:255], v243 offset:1664
v_mfma_f32_16x16x32_bf16 v[80:83], a[240:243], a[0:3], v[80:83]
buffer_store_dwordx4 v[234:237], v239, s[24:27], s39 offen offset:2048 sc1
v_mfma_f32_16x16x32_bf16 v[84:87], a[240:243], a[4:7], v[84:87]
v_accvgpr_read_b32 v226, a172
v_accvgpr_read_b32 v227, a173
v_mfma_f32_16x16x32_bf16 v[88:91], a[240:243], a[8:11], v[88:91]
v_accvgpr_read_b32 v228, a174
v_accvgpr_read_b32 v229, a175
v_mfma_f32_16x16x32_bf16 v[92:95], a[240:243], a[12:15], v[92:95]
v_mul_f32 v226, v223, v226
v_mul_f32 v227, v223, v227
v_mfma_f32_16x16x32_bf16 v[96:99], a[240:243], a[16:19], v[96:99]
s_waitcnt lgkmcnt(9)
ds_read_b64_tr_b16 a[240:241], v240 offset:256
ds_read_b64_tr_b16 a[242:243], v240 offset:1792
v_mfma_f32_16x16x32_bf16 v[100:103], a[244:247], a[0:3], v[100:103]
v_mul_f32 v228, v223, v228
v_mul_f32 v229, v223, v229
v_mfma_f32_16x16x32_bf16 v[104:107], a[244:247], a[4:7], v[104:107]
v_cvt_pk_bf16_f32 v234, v226, v227
v_cvt_pk_bf16_f32 v235, v228, v229
v_mfma_f32_16x16x32_bf16 v[108:111], a[244:247], a[8:11], v[108:111]
v_accvgpr_read_b32 v230, a192
v_accvgpr_read_b32 v231, a193
v_mfma_f32_16x16x32_bf16 v[112:115], a[244:247], a[12:15], v[112:115]
v_accvgpr_read_b32 v232, a194
v_accvgpr_read_b32 v233, a195
v_mfma_f32_16x16x32_bf16 v[116:119], a[244:247], a[16:19], v[116:119]
s_waitcnt lgkmcnt(9)
ds_read_b64_tr_b16 a[244:245], v241 offset:256
ds_read_b64_tr_b16 a[246:247], v241 offset:1792
v_mfma_f32_16x16x32_bf16 v[120:123], a[248:251], a[0:3], v[120:123]
v_mul_f32 v230, v223, v230
v_mul_f32 v231, v223, v231
v_mfma_f32_16x16x32_bf16 v[124:127], a[248:251], a[4:7], v[124:127]
v_mul_f32 v232, v223, v232
v_mul_f32 v233, v223, v233
v_mfma_f32_16x16x32_bf16 v[128:131], a[248:251], a[8:11], v[128:131]
v_cvt_pk_bf16_f32 v236, v230, v231
v_cvt_pk_bf16_f32 v237, v232, v233
v_mfma_f32_16x16x32_bf16 v[132:135], a[248:251], a[12:15], v[132:135]
buffer_store_dwordx4 v[234:237], v239, s[24:27], s39 offen offset:3072 sc1
v_mfma_f32_16x16x32_bf16 v[136:139], a[248:251], a[16:19], v[136:139]
s_waitcnt lgkmcnt(4)
ds_read_b64_tr_b16 a[248:249], v242 offset:256
ds_read_b64_tr_b16 a[250:251], v242 offset:1792
v_mfma_f32_16x16x32_bf16 v[140:143], a[252:255], a[0:3], v[140:143]
v_accvgpr_read_b32 v226, a176
v_accvgpr_read_b32 v227, a177
v_mfma_f32_16x16x32_bf16 v[144:147], a[252:255], a[4:7], v[144:147]
v_accvgpr_read_b32 v228, a178
v_accvgpr_read_b32 v229, a179
v_mfma_f32_16x16x32_bf16 v[148:151], a[252:255], a[8:11], v[148:151]
v_mul_f32 v226, v224, v226
v_mul_f32 v227, v224, v227
v_mfma_f32_16x16x32_bf16 v[152:155], a[252:255], a[12:15], v[152:155]
v_mul_f32 v228, v224, v228
v_mul_f32 v229, v224, v229
v_mfma_f32_16x16x32_bf16 v[156:159], a[252:255], a[16:19], v[156:159]
s_waitcnt lgkmcnt(4)
ds_read_b64_tr_b16 a[252:253], v243 offset:256
ds_read_b64_tr_b16 a[254:255], v243 offset:1792
v_mfma_f32_16x16x32_bf16 v[160:163], a[240:243], a[0:3], v[160:163]
v_add_u32 v240, s32, v254
v_xor_b32 v241, 32, v240
v_mfma_f32_16x16x32_bf16 v[164:167], a[240:243], a[4:7], v[164:167]
v_xor_b32 v242, 64, v240
v_xor_b32 v243, 64, v241
v_mfma_f32_16x16x32_bf16 v[168:171], a[240:243], a[8:11], v[168:171]
s_add_u32 s32, s32, 24576
s_sub_u32 s42, s32, 147456
s_min_u32 s32, s32, s42
v_mfma_f32_16x16x32_bf16 v[172:175], a[240:243], a[12:15], v[172:175]
v_cvt_pk_bf16_f32 v234, v226, v227
v_cvt_pk_bf16_f32 v235, v228, v229
v_mfma_f32_16x16x32_bf16 v[176:179], a[240:243], a[16:19], v[176:179]
s_waitcnt lgkmcnt(4)
v_accvgpr_read_b32 v230, a196
v_accvgpr_read_b32 v231, a197
v_mfma_f32_16x16x32_bf16 v[180:183], a[244:247], a[0:3], v[180:183]
v_accvgpr_read_b32 v232, a198
v_accvgpr_read_b32 v233, a199
v_mfma_f32_16x16x32_bf16 v[184:187], a[244:247], a[4:7], v[184:187]
v_mul_f32 v230, v224, v230
v_mul_f32 v231, v224, v231
v_mfma_f32_16x16x32_bf16 v[188:191], a[244:247], a[8:11], v[188:191]
s_waitcnt vmcnt(24) lgkmcnt(0)
s_barrier
ds_read_b64_tr_b16 a[240:241], v240 offset:0
v_mfma_f32_16x16x32_bf16 v[192:195], a[244:247], a[12:15], v[192:195]
s_add_u32 m0, s31, s38
s_add_u32 s40, s35, s48
ds_read_b64_tr_b16 a[242:243], v240 offset:1536
v_mfma_f32_16x16x32_bf16 v[196:199], a[244:247], a[16:19], v[196:199]
s_waitcnt lgkmcnt(15)
ds_read_b64_tr_b16 a[244:245], v241 offset:0
ds_read_b64_tr_b16 a[246:247], v241 offset:1536
v_mfma_f32_16x16x32_bf16 v[200:203], a[248:251], a[0:3], v[200:203]
buffer_load_dwordx4 v248, s[20:23], s40 offen offset:0 lds
v_mfma_f32_16x16x32_bf16 v[204:207], a[248:251], a[4:7], v[204:207]
v_mul_f32 v232, v224, v232
v_mul_f32 v233, v224, v233
v_mfma_f32_16x16x32_bf16 v[208:211], a[248:251], a[8:11], v[208:211]
v_cvt_pk_bf16_f32 v236, v230, v231
v_cvt_pk_bf16_f32 v237, v232, v233
v_mfma_f32_16x16x32_bf16 v[212:215], a[248:251], a[12:15], v[212:215]
buffer_load_dwordx4 v249, s[20:23], s40 offen offset:1024 lds
v_mfma_f32_16x16x32_bf16 v[216:219], a[248:251], a[16:19], v[216:219]
s_waitcnt lgkmcnt(15)
ds_read_b64_tr_b16 a[248:249], v242 offset:0
ds_read_b64_tr_b16 a[250:251], v242 offset:1536
v_mfma_f32_16x16x32_bf16 a[60:63], a[252:255], a[0:3], a[60:63]
v_mfma_f32_16x16x32_bf16 a[64:67], a[252:255], a[4:7], a[64:67]
buffer_load_dwordx4 v250, s[20:23], s40 offen offset:2048 lds
v_mfma_f32_16x16x32_bf16 a[68:71], a[252:255], a[8:11], a[68:71]
s_add_u32 m0, m0, 6144
s_add_u32 s40, s40, 196608
v_mfma_f32_16x16x32_bf16 a[72:75], a[252:255], a[12:15], a[72:75]
v_mfma_f32_16x16x32_bf16 a[76:79], a[252:255], a[16:19], a[76:79]
s_waitcnt lgkmcnt(4)
ds_read_b64_tr_b16 a[252:253], v243 offset:0
ds_read_b64_tr_b16 a[254:255], v243 offset:1536
v_mfma_f32_16x16x32_bf16 v[0:3], a[240:243], a[20:23], v[0:3]
buffer_load_dwordx4 v248, s[20:23], s40 offen offset:0 lds
v_mfma_f32_16x16x32_bf16 v[4:7], a[240:243], a[24:27], v[4:7]
v_mfma_f32_16x16x32_bf16 v[8:11], a[240:243], a[28:31], v[8:11]
v_mfma_f32_16x16x32_bf16 v[12:15], a[240:243], a[32:35], v[12:15]
buffer_load_dwordx4 v249, s[20:23], s40 offen offset:1024 lds
v_mfma_f32_16x16x32_bf16 v[16:19], a[240:243], a[36:39], v[16:19]
s_waitcnt lgkmcnt(4)
ds_read_b64_tr_b16 a[240:241], v240 offset:128
ds_read_b64_tr_b16 a[242:243], v240 offset:1664
v_mfma_f32_16x16x32_bf16 v[20:23], a[244:247], a[20:23], v[20:23]
v_mfma_f32_16x16x32_bf16 v[24:27], a[244:247], a[24:27], v[24:27]
buffer_load_dwordx4 v250, s[20:23], s40 offen offset:2048 lds
v_mfma_f32_16x16x32_bf16 v[28:31], a[244:247], a[28:31], v[28:31]
s_add_u32 s35, s35, 393216
s_sub_u32 s40, s35, 7864320
s_min_u32 s35, s35, s40
v_mfma_f32_16x16x32_bf16 v[32:35], a[244:247], a[32:35], v[32:35]
s_add_u32 s31, s31, 24576
s_sub_u32 s41, s31, 147456
s_min_u32 s31, s31, s41
v_mfma_f32_16x16x32_bf16 v[36:39], a[244:247], a[36:39], v[36:39]
s_waitcnt lgkmcnt(4)
ds_read_b64_tr_b16 a[244:245], v241 offset:128
ds_read_b64_tr_b16 a[246:247], v241 offset:1664
v_mfma_f32_16x16x32_bf16 v[40:43], a[248:251], a[20:23], v[40:43]
s_add_u32 m0, s31, s55
s_add_u32 s40, s54, s49
v_mfma_f32_16x16x32_bf16 v[44:47], a[248:251], a[24:27], v[44:47]
buffer_load_dwordx4 v251, s[8:11], s40 offen offset:0 lds
v_mfma_f32_16x16x32_bf16 v[48:51], a[248:251], a[28:31], v[48:51]
s_add_u32 s40, s40, 9216
v_mfma_f32_16x16x32_bf16 v[52:55], a[248:251], a[32:35], v[52:55]
v_mfma_f32_16x16x32_bf16 v[56:59], a[248:251], a[36:39], v[56:59]
s_waitcnt lgkmcnt(4)
ds_read_b64_tr_b16 a[248:249], v242 offset:128
ds_read_b64_tr_b16 a[250:251], v242 offset:1664
v_mfma_f32_16x16x32_bf16 v[60:63], a[252:255], a[20:23], v[60:63]
buffer_load_dwordx4 v251, s[8:11], s40 offen offset:1024 lds
v_mfma_f32_16x16x32_bf16 v[64:67], a[252:255], a[24:27], v[64:67]
s_add_u32 s40, s40, 9216
v_mfma_f32_16x16x32_bf16 v[68:71], a[252:255], a[28:31], v[68:71]
v_mfma_f32_16x16x32_bf16 v[72:75], a[252:255], a[32:35], v[72:75]
buffer_load_dwordx4 v251, s[8:11], s40 offen offset:2048 lds
v_mfma_f32_16x16x32_bf16 v[76:79], a[252:255], a[36:39], v[76:79]
s_waitcnt lgkmcnt(4)
ds_read_b64_tr_b16 a[252:253], v243 offset:128
ds_read_b64_tr_b16 a[254:255], v243 offset:1664
v_mfma_f32_16x16x32_bf16 v[80:83], a[240:243], a[20:23], v[80:83]
s_add_u32 s40, s40, 9216
v_mfma_f32_16x16x32_bf16 v[84:87], a[240:243], a[24:27], v[84:87]
buffer_load_dwordx4 v251, s[8:11], s40 offen offset:3072 lds
v_mfma_f32_16x16x32_bf16 v[88:91], a[240:243], a[28:31], v[88:91]
s_add_u32 m0, m0, 4096
s_add_u32 s40, s40, 13312
v_mfma_f32_16x16x32_bf16 v[92:95], a[240:243], a[32:35], v[92:95]
v_mfma_f32_16x16x32_bf16 v[96:99], a[240:243], a[36:39], v[96:99]
s_waitcnt lgkmcnt(4)
ds_read_b64_tr_b16 a[240:241], v240 offset:256
ds_read_b64_tr_b16 a[242:243], v240 offset:1792
v_mfma_f32_16x16x32_bf16 v[100:103], a[244:247], a[20:23], v[100:103]
buffer_load_dwordx4 v251, s[8:11], s40 offen lds
v_mfma_f32_16x16x32_bf16 v[104:107], a[244:247], a[24:27], v[104:107]
s_add_u32 s54, s54, 128
s_sub_u32 s40, s54, 1280
s_min_u32 s54, s54, s40
v_mfma_f32_16x16x32_bf16 v[108:111], a[244:247], a[28:31], v[108:111]
s_add_u32 s31, s31, 24576
s_sub_u32 s41, s31, 147456
s_min_u32 s31, s31, s41
v_mfma_f32_16x16x32_bf16 v[112:115], a[244:247], a[32:35], v[112:115]
buffer_store_dwordx4 v[234:237], v225, s[24:27], s39 offen sc1
v_mfma_f32_16x16x32_bf16 v[116:119], a[244:247], a[36:39], v[116:119]
s_waitcnt lgkmcnt(4)
ds_read_b64_tr_b16 a[244:245], v241 offset:256
ds_read_b64_tr_b16 a[246:247], v241 offset:1792
v_mfma_f32_16x16x32_bf16 v[120:123], a[248:251], a[20:23], v[120:123]
v_accvgpr_read_b32 v226, a200
v_accvgpr_read_b32 v227, a201
v_mfma_f32_16x16x32_bf16 v[124:127], a[248:251], a[24:27], v[124:127]
v_accvgpr_read_b32 v228, a202
v_accvgpr_read_b32 v229, a203
v_mfma_f32_16x16x32_bf16 v[128:131], a[248:251], a[28:31], v[128:131]
v_mul_f32 v226, v220, v226
v_mul_f32 v227, v220, v227
v_mfma_f32_16x16x32_bf16 v[132:135], a[248:251], a[32:35], v[132:135]
v_mul_f32 v228, v220, v228
v_mul_f32 v229, v220, v229
v_mfma_f32_16x16x32_bf16 v[136:139], a[248:251], a[36:39], v[136:139]
s_waitcnt lgkmcnt(4)
ds_read_b64_tr_b16 a[248:249], v242 offset:256
ds_read_b64_tr_b16 a[250:251], v242 offset:1792
v_mfma_f32_16x16x32_bf16 v[140:143], a[252:255], a[20:23], v[140:143]
v_cvt_pk_bf16_f32 v234, v226, v227
v_cvt_pk_bf16_f32 v235, v228, v229
v_mfma_f32_16x16x32_bf16 v[144:147], a[252:255], a[24:27], v[144:147]
v_accvgpr_read_b32 v230, a220
v_accvgpr_read_b32 v231, a221
v_mfma_f32_16x16x32_bf16 v[148:151], a[252:255], a[28:31], v[148:151]
v_accvgpr_read_b32 v232, a222
v_accvgpr_read_b32 v233, a223
v_mfma_f32_16x16x32_bf16 v[152:155], a[252:255], a[32:35], v[152:155]
v_mul_f32 v230, v220, v230
v_mul_f32 v231, v220, v231
v_mfma_f32_16x16x32_bf16 v[156:159], a[252:255], a[36:39], v[156:159]
s_waitcnt lgkmcnt(4)
ds_read_b64_tr_b16 a[252:253], v243 offset:256
ds_read_b64_tr_b16 a[254:255], v243 offset:1792
v_mfma_f32_16x16x32_bf16 v[160:163], a[240:243], a[20:23], v[160:163]
v_add_u32 v240, s32, v254
v_xor_b32 v241, 32, v240
v_mfma_f32_16x16x32_bf16 v[164:167], a[240:243], a[24:27], v[164:167]
v_xor_b32 v242, 64, v240
v_xor_b32 v243, 64, v241
v_mfma_f32_16x16x32_bf16 v[168:171], a[240:243], a[28:31], v[168:171]
s_add_u32 s32, s32, 24576
s_sub_u32 s42, s32, 147456
s_min_u32 s32, s32, s42
v_mfma_f32_16x16x32_bf16 v[172:175], a[240:243], a[32:35], v[172:175]
v_add_u32 v244, s32, v255
v_mul_f32 v232, v220, v232
v_mfma_f32_16x16x32_bf16 v[176:179], a[240:243], a[36:39], v[176:179]
s_waitcnt lgkmcnt(4)
s_add_u32 s32, s32, 24576
s_sub_u32 s42, s32, 147456
v_mfma_f32_16x16x32_bf16 v[180:183], a[244:247], a[20:23], v[180:183]
s_min_u32 s32, s32, s42
v_mul_f32 v233, v220, v233
v_cvt_pk_bf16_f32 v236, v230, v231
v_mfma_f32_16x16x32_bf16 v[184:187], a[244:247], a[24:27], v[184:187]
v_cvt_pk_bf16_f32 v237, v232, v233
v_mfma_f32_16x16x32_bf16 v[188:191], a[244:247], a[28:31], v[188:191]
s_waitcnt vmcnt(22) lgkmcnt(0)
s_barrier
ds_read_b64_tr_b16 a[240:241], v240 offset:0
v_mfma_f32_16x16x32_bf16 v[192:195], a[244:247], a[32:35], v[192:195]
s_add_u32 m0, s31, s38
ds_read_b64_tr_b16 a[242:243], v240 offset:1536
ds_read_b128 a[0:3], v244 offset:0
v_mfma_f32_16x16x32_bf16 v[196:199], a[244:247], a[36:39], v[196:199]
s_waitcnt lgkmcnt(15)
ds_read_b128 a[4:7], v244 offset:2048
ds_read_b128 a[8:11], v244 offset:4096
v_mfma_f32_16x16x32_bf16 v[200:203], a[248:251], a[20:23], v[200:203]
s_add_u32 s40, s35, s48
ds_read_b128 a[12:15], v244 offset:6144
ds_read_b128 a[16:19], v244 offset:8192
v_mfma_f32_16x16x32_bf16 v[204:207], a[248:251], a[24:27], v[204:207]
s_add_u32 s39, s47, 51200
ds_read_b64_tr_b16 a[244:245], v241 offset:0
ds_read_b64_tr_b16 a[246:247], v241 offset:1536
v_mfma_f32_16x16x32_bf16 v[208:211], a[248:251], a[28:31], v[208:211]
buffer_load_dwordx4 v248, s[20:23], s40 offen offset:0 lds
v_mfma_f32_16x16x32_bf16 v[212:215], a[248:251], a[32:35], v[212:215]
v_mfma_f32_16x16x32_bf16 v[216:219], a[248:251], a[36:39], v[216:219]
s_waitcnt lgkmcnt(15)
ds_read_b64_tr_b16 a[248:249], v242 offset:0
ds_read_b64_tr_b16 a[250:251], v242 offset:1536
v_mfma_f32_16x16x32_bf16 a[60:63], a[252:255], a[20:23], a[60:63]
buffer_load_dwordx4 v249, s[20:23], s40 offen offset:1024 lds
v_mfma_f32_16x16x32_bf16 a[64:67], a[252:255], a[24:27], a[64:67]
v_mfma_f32_16x16x32_bf16 a[68:71], a[252:255], a[28:31], a[68:71]
v_mfma_f32_16x16x32_bf16 a[72:75], a[252:255], a[32:35], a[72:75]
buffer_load_dwordx4 v250, s[20:23], s40 offen offset:2048 lds
v_mfma_f32_16x16x32_bf16 a[76:79], a[252:255], a[36:39], a[76:79]
s_waitcnt lgkmcnt(4)
ds_read_b64_tr_b16 a[252:253], v243 offset:0
ds_read_b64_tr_b16 a[254:255], v243 offset:1536
v_mfma_f32_16x16x32_bf16 v[0:3], a[240:243], a[0:3], v[0:3]
s_add_u32 m0, m0, 6144
s_add_u32 s40, s40, 196608
v_mfma_f32_16x16x32_bf16 v[4:7], a[240:243], a[4:7], v[4:7]
buffer_load_dwordx4 v248, s[20:23], s40 offen offset:0 lds
v_mfma_f32_16x16x32_bf16 v[8:11], a[240:243], a[8:11], v[8:11]
v_mfma_f32_16x16x32_bf16 v[12:15], a[240:243], a[12:15], v[12:15]
v_mfma_f32_16x16x32_bf16 v[16:19], a[240:243], a[16:19], v[16:19]
s_waitcnt lgkmcnt(4)
ds_read_b64_tr_b16 a[240:241], v240 offset:128
ds_read_b64_tr_b16 a[242:243], v240 offset:1664
v_mfma_f32_16x16x32_bf16 v[20:23], a[244:247], a[0:3], v[20:23]
buffer_load_dwordx4 v249, s[20:23], s40 offen offset:1024 lds
v_mfma_f32_16x16x32_bf16 v[24:27], a[244:247], a[4:7], v[24:27]
v_mfma_f32_16x16x32_bf16 v[28:31], a[244:247], a[8:11], v[28:31]
v_mfma_f32_16x16x32_bf16 v[32:35], a[244:247], a[12:15], v[32:35]
buffer_load_dwordx4 v250, s[20:23], s40 offen offset:2048 lds
v_mfma_f32_16x16x32_bf16 v[36:39], a[244:247], a[16:19], v[36:39]
s_waitcnt lgkmcnt(4)
ds_read_b64_tr_b16 a[244:245], v241 offset:128
ds_read_b64_tr_b16 a[246:247], v241 offset:1664
v_mfma_f32_16x16x32_bf16 v[40:43], a[248:251], a[0:3], v[40:43]
s_add_u32 s35, s35, 393216
s_sub_u32 s40, s35, 7864320
s_min_u32 s35, s35, s40
v_mfma_f32_16x16x32_bf16 v[44:47], a[248:251], a[4:7], v[44:47]
s_add_u32 s31, s31, 24576
s_sub_u32 s41, s31, 147456
s_min_u32 s31, s31, s41
v_mfma_f32_16x16x32_bf16 v[48:51], a[248:251], a[8:11], v[48:51]
s_mov_b32 m0, s76
v_mfma_f32_16x16x32_bf16 v[52:55], a[248:251], a[12:15], v[52:55]
buffer_load_dword v238, s[60:63], s59 offen lds
v_mfma_f32_16x16x32_bf16 v[56:59], a[248:251], a[16:19], v[56:59]
s_waitcnt lgkmcnt(4)
ds_read_b64_tr_b16 a[248:249], v242 offset:128
ds_read_b64_tr_b16 a[250:251], v242 offset:1664
v_mfma_f32_16x16x32_bf16 v[60:63], a[252:255], a[0:3], v[60:63]
s_add_u32 s59, s59, 3072
v_xor_b32 v244, 64, v244
v_mfma_f32_16x16x32_bf16 v[64:67], a[252:255], a[4:7], v[64:67]
ds_read_b128 a[20:23], v244 offset:0
ds_read_b128 a[24:27], v244 offset:2048
v_mfma_f32_16x16x32_bf16 v[68:71], a[252:255], a[8:11], v[68:71]
ds_read_b128 a[28:31], v244 offset:4096
ds_read_b128 a[32:35], v244 offset:6144
v_mfma_f32_16x16x32_bf16 v[72:75], a[252:255], a[12:15], v[72:75]
ds_read_b128 a[36:39], v244 offset:8192
v_mfma_f32_16x16x32_bf16 v[76:79], a[252:255], a[16:19], v[76:79]
s_waitcnt lgkmcnt(9)
ds_read_b64_tr_b16 a[252:253], v243 offset:128
ds_read_b64_tr_b16 a[254:255], v243 offset:1664
v_mfma_f32_16x16x32_bf16 v[80:83], a[240:243], a[0:3], v[80:83]
buffer_store_dwordx4 v[234:237], v239, s[24:27], s39 offen offset:0 sc1
v_mfma_f32_16x16x32_bf16 v[84:87], a[240:243], a[4:7], v[84:87]
v_accvgpr_read_b32 v226, a204
v_accvgpr_read_b32 v227, a205
v_mfma_f32_16x16x32_bf16 v[88:91], a[240:243], a[8:11], v[88:91]
v_accvgpr_read_b32 v228, a206
v_accvgpr_read_b32 v229, a207
v_mfma_f32_16x16x32_bf16 v[92:95], a[240:243], a[12:15], v[92:95]
v_mul_f32 v226, v221, v226
v_mul_f32 v227, v221, v227
v_mfma_f32_16x16x32_bf16 v[96:99], a[240:243], a[16:19], v[96:99]
s_waitcnt lgkmcnt(9)
ds_read_b64_tr_b16 a[240:241], v240 offset:256
ds_read_b64_tr_b16 a[242:243], v240 offset:1792
v_mfma_f32_16x16x32_bf16 v[100:103], a[244:247], a[0:3], v[100:103]
v_mul_f32 v228, v221, v228
v_mul_f32 v229, v221, v229
v_mfma_f32_16x16x32_bf16 v[104:107], a[244:247], a[4:7], v[104:107]
v_cvt_pk_bf16_f32 v234, v226, v227
v_cvt_pk_bf16_f32 v235, v228, v229
v_mfma_f32_16x16x32_bf16 v[108:111], a[244:247], a[8:11], v[108:111]
v_accvgpr_read_b32 v230, a224
v_accvgpr_read_b32 v231, a225
v_mfma_f32_16x16x32_bf16 v[112:115], a[244:247], a[12:15], v[112:115]
v_accvgpr_read_b32 v232, a226
v_accvgpr_read_b32 v233, a227
v_mfma_f32_16x16x32_bf16 v[116:119], a[244:247], a[16:19], v[116:119]
s_waitcnt lgkmcnt(9)
ds_read_b64_tr_b16 a[244:245], v241 offset:256
ds_read_b64_tr_b16 a[246:247], v241 offset:1792
v_mfma_f32_16x16x32_bf16 v[120:123], a[248:251], a[0:3], v[120:123]
v_mul_f32 v230, v221, v230
v_mul_f32 v231, v221, v231
v_mfma_f32_16x16x32_bf16 v[124:127], a[248:251], a[4:7], v[124:127]
v_mul_f32 v232, v221, v232
v_mul_f32 v233, v221, v233
v_mfma_f32_16x16x32_bf16 v[128:131], a[248:251], a[8:11], v[128:131]
v_cvt_pk_bf16_f32 v236, v230, v231
v_cvt_pk_bf16_f32 v237, v232, v233
v_mfma_f32_16x16x32_bf16 v[132:135], a[248:251], a[12:15], v[132:135]
buffer_store_dwordx4 v[234:237], v239, s[24:27], s39 offen offset:1024 sc1
v_mfma_f32_16x16x32_bf16 v[136:139], a[248:251], a[16:19], v[136:139]
s_waitcnt lgkmcnt(4)
ds_read_b64_tr_b16 a[248:249], v242 offset:256
ds_read_b64_tr_b16 a[250:251], v242 offset:1792
v_mfma_f32_16x16x32_bf16 v[140:143], a[252:255], a[0:3], v[140:143]
v_accvgpr_read_b32 v226, a208
v_accvgpr_read_b32 v227, a209
v_mfma_f32_16x16x32_bf16 v[144:147], a[252:255], a[4:7], v[144:147]
v_accvgpr_read_b32 v228, a210
v_accvgpr_read_b32 v229, a211
v_mfma_f32_16x16x32_bf16 v[148:151], a[252:255], a[8:11], v[148:151]
v_mul_f32 v226, v222, v226
v_mul_f32 v227, v222, v227
v_mfma_f32_16x16x32_bf16 v[152:155], a[252:255], a[12:15], v[152:155]
v_mul_f32 v228, v222, v228
v_mul_f32 v229, v222, v229
v_mfma_f32_16x16x32_bf16 v[156:159], a[252:255], a[16:19], v[156:159]
s_waitcnt lgkmcnt(4)
ds_read_b64_tr_b16 a[252:253], v243 offset:256
ds_read_b64_tr_b16 a[254:255], v243 offset:1792
v_mfma_f32_16x16x32_bf16 v[160:163], a[240:243], a[0:3], v[160:163]
v_add_u32 v240, s32, v254
v_xor_b32 v241, 32, v240
v_mfma_f32_16x16x32_bf16 v[164:167], a[240:243], a[4:7], v[164:167]
v_xor_b32 v242, 64, v240
v_xor_b32 v243, 64, v241
v_mfma_f32_16x16x32_bf16 v[168:171], a[240:243], a[8:11], v[168:171]
s_add_u32 s32, s32, 24576
s_sub_u32 s42, s32, 147456
s_min_u32 s32, s32, s42
v_mfma_f32_16x16x32_bf16 v[172:175], a[240:243], a[12:15], v[172:175]
v_cvt_pk_bf16_f32 v234, v226, v227
v_cvt_pk_bf16_f32 v235, v228, v229
v_mfma_f32_16x16x32_bf16 v[176:179], a[240:243], a[16:19], v[176:179]
s_waitcnt lgkmcnt(4)
v_accvgpr_read_b32 v230, a228
v_accvgpr_read_b32 v231, a229
v_mfma_f32_16x16x32_bf16 v[180:183], a[244:247], a[0:3], v[180:183]
v_accvgpr_read_b32 v232, a230
v_accvgpr_read_b32 v233, a231
v_mfma_f32_16x16x32_bf16 v[184:187], a[244:247], a[4:7], v[184:187]
v_mul_f32 v230, v222, v230
v_mul_f32 v231, v222, v231
v_mfma_f32_16x16x32_bf16 v[188:191], a[244:247], a[8:11], v[188:191]
s_waitcnt vmcnt(24) lgkmcnt(0)
s_barrier
ds_read_b64_tr_b16 a[240:241], v240 offset:0
v_mfma_f32_16x16x32_bf16 v[192:195], a[244:247], a[12:15], v[192:195]
s_add_u32 m0, s31, s38
s_add_u32 s40, s35, s48
ds_read_b64_tr_b16 a[242:243], v240 offset:1536
v_mfma_f32_16x16x32_bf16 v[196:199], a[244:247], a[16:19], v[196:199]
s_waitcnt lgkmcnt(15)
ds_read_b64_tr_b16 a[244:245], v241 offset:0
ds_read_b64_tr_b16 a[246:247], v241 offset:1536
v_mfma_f32_16x16x32_bf16 v[200:203], a[248:251], a[0:3], v[200:203]
buffer_load_dwordx4 v248, s[20:23], s40 offen offset:0 lds
v_mfma_f32_16x16x32_bf16 v[204:207], a[248:251], a[4:7], v[204:207]
v_mul_f32 v232, v222, v232
v_mul_f32 v233, v222, v233
v_mfma_f32_16x16x32_bf16 v[208:211], a[248:251], a[8:11], v[208:211]
v_cvt_pk_bf16_f32 v236, v230, v231
v_cvt_pk_bf16_f32 v237, v232, v233
v_mfma_f32_16x16x32_bf16 v[212:215], a[248:251], a[12:15], v[212:215]
buffer_load_dwordx4 v249, s[20:23], s40 offen offset:1024 lds
v_mfma_f32_16x16x32_bf16 v[216:219], a[248:251], a[16:19], v[216:219]
s_waitcnt lgkmcnt(15)
ds_read_b64_tr_b16 a[248:249], v242 offset:0
ds_read_b64_tr_b16 a[250:251], v242 offset:1536
v_mfma_f32_16x16x32_bf16 a[60:63], a[252:255], a[0:3], a[60:63]
v_mfma_f32_16x16x32_bf16 a[64:67], a[252:255], a[4:7], a[64:67]
buffer_load_dwordx4 v250, s[20:23], s40 offen offset:2048 lds
v_mfma_f32_16x16x32_bf16 a[68:71], a[252:255], a[8:11], a[68:71]
s_add_u32 m0, m0, 6144
s_add_u32 s40, s40, 196608
v_mfma_f32_16x16x32_bf16 a[72:75], a[252:255], a[12:15], a[72:75]
v_mfma_f32_16x16x32_bf16 a[76:79], a[252:255], a[16:19], a[76:79]
s_waitcnt lgkmcnt(4)
ds_read_b64_tr_b16 a[252:253], v243 offset:0
ds_read_b64_tr_b16 a[254:255], v243 offset:1536
v_mfma_f32_16x16x32_bf16 v[0:3], a[240:243], a[20:23], v[0:3]
buffer_load_dwordx4 v248, s[20:23], s40 offen offset:0 lds
v_mfma_f32_16x16x32_bf16 v[4:7], a[240:243], a[24:27], v[4:7]
v_mfma_f32_16x16x32_bf16 v[8:11], a[240:243], a[28:31], v[8:11]
v_mfma_f32_16x16x32_bf16 v[12:15], a[240:243], a[32:35], v[12:15]
buffer_load_dwordx4 v249, s[20:23], s40 offen offset:1024 lds
v_mfma_f32_16x16x32_bf16 v[16:19], a[240:243], a[36:39], v[16:19]
s_waitcnt lgkmcnt(4)
ds_read_b64_tr_b16 a[240:241], v240 offset:128
ds_read_b64_tr_b16 a[242:243], v240 offset:1664
v_mfma_f32_16x16x32_bf16 v[20:23], a[244:247], a[20:23], v[20:23]
v_mfma_f32_16x16x32_bf16 v[24:27], a[244:247], a[24:27], v[24:27]
buffer_load_dwordx4 v250, s[20:23], s40 offen offset:2048 lds
v_mfma_f32_16x16x32_bf16 v[28:31], a[244:247], a[28:31], v[28:31]
s_add_u32 s35, s35, 393216
s_sub_u32 s40, s35, 7864320
s_min_u32 s35, s35, s40
v_mfma_f32_16x16x32_bf16 v[32:35], a[244:247], a[32:35], v[32:35]
s_add_u32 s31, s31, 24576
s_sub_u32 s41, s31, 147456
s_min_u32 s31, s31, s41
v_mfma_f32_16x16x32_bf16 v[36:39], a[244:247], a[36:39], v[36:39]
s_waitcnt lgkmcnt(4)
ds_read_b64_tr_b16 a[244:245], v241 offset:128
ds_read_b64_tr_b16 a[246:247], v241 offset:1664
v_mfma_f32_16x16x32_bf16 v[40:43], a[248:251], a[20:23], v[40:43]
s_add_u32 m0, s31, s55
s_add_u32 s40, s54, s49
v_mfma_f32_16x16x32_bf16 v[44:47], a[248:251], a[24:27], v[44:47]
buffer_load_dwordx4 v251, s[8:11], s40 offen offset:0 lds
v_mfma_f32_16x16x32_bf16 v[48:51], a[248:251], a[28:31], v[48:51]
s_add_u32 s40, s40, 9216
v_mfma_f32_16x16x32_bf16 v[52:55], a[248:251], a[32:35], v[52:55]
v_mfma_f32_16x16x32_bf16 v[56:59], a[248:251], a[36:39], v[56:59]
s_waitcnt lgkmcnt(4)
ds_read_b64_tr_b16 a[248:249], v242 offset:128
ds_read_b64_tr_b16 a[250:251], v242 offset:1664
v_mfma_f32_16x16x32_bf16 v[60:63], a[252:255], a[20:23], v[60:63]
buffer_load_dwordx4 v251, s[8:11], s40 offen offset:1024 lds
v_mfma_f32_16x16x32_bf16 v[64:67], a[252:255], a[24:27], v[64:67]
s_add_u32 s40, s40, 9216
v_mfma_f32_16x16x32_bf16 v[68:71], a[252:255], a[28:31], v[68:71]
v_mfma_f32_16x16x32_bf16 v[72:75], a[252:255], a[32:35], v[72:75]
buffer_load_dwordx4 v251, s[8:11], s40 offen offset:2048 lds
v_mfma_f32_16x16x32_bf16 v[76:79], a[252:255], a[36:39], v[76:79]
s_waitcnt lgkmcnt(4)
ds_read_b64_tr_b16 a[252:253], v243 offset:128
ds_read_b64_tr_b16 a[254:255], v243 offset:1664
v_mfma_f32_16x16x32_bf16 v[80:83], a[240:243], a[20:23], v[80:83]
s_add_u32 s40, s40, 9216
v_mfma_f32_16x16x32_bf16 v[84:87], a[240:243], a[24:27], v[84:87]
buffer_load_dwordx4 v251, s[8:11], s40 offen offset:3072 lds
v_mfma_f32_16x16x32_bf16 v[88:91], a[240:243], a[28:31], v[88:91]
s_add_u32 m0, m0, 4096
s_add_u32 s40, s40, 13312
v_mfma_f32_16x16x32_bf16 v[92:95], a[240:243], a[32:35], v[92:95]
v_mfma_f32_16x16x32_bf16 v[96:99], a[240:243], a[36:39], v[96:99]
s_waitcnt lgkmcnt(4)
ds_read_b64_tr_b16 a[240:241], v240 offset:256
ds_read_b64_tr_b16 a[242:243], v240 offset:1792
v_mfma_f32_16x16x32_bf16 v[100:103], a[244:247], a[20:23], v[100:103]
buffer_load_dwordx4 v251, s[8:11], s40 offen lds
v_mfma_f32_16x16x32_bf16 v[104:107], a[244:247], a[24:27], v[104:107]
s_add_u32 s54, s54, 128
s_sub_u32 s40, s54, 1280
s_min_u32 s54, s54, s40
v_mfma_f32_16x16x32_bf16 v[108:111], a[244:247], a[28:31], v[108:111]
s_add_u32 s31, s31, 24576
s_sub_u32 s41, s31, 147456
s_min_u32 s31, s31, s41
v_mfma_f32_16x16x32_bf16 v[112:115], a[244:247], a[32:35], v[112:115]
buffer_store_dwordx4 v[234:237], v239, s[24:27], s39 offen offset:2048 sc1
v_mfma_f32_16x16x32_bf16 v[116:119], a[244:247], a[36:39], v[116:119]
s_waitcnt lgkmcnt(4)
ds_read_b64_tr_b16 a[244:245], v241 offset:256
ds_read_b64_tr_b16 a[246:247], v241 offset:1792
v_mfma_f32_16x16x32_bf16 v[120:123], a[248:251], a[20:23], v[120:123]
v_accvgpr_read_b32 v226, a212
v_accvgpr_read_b32 v227, a213
v_mfma_f32_16x16x32_bf16 v[124:127], a[248:251], a[24:27], v[124:127]
v_accvgpr_read_b32 v228, a214
v_accvgpr_read_b32 v229, a215
v_mfma_f32_16x16x32_bf16 v[128:131], a[248:251], a[28:31], v[128:131]
v_mul_f32 v226, v223, v226
v_mul_f32 v227, v223, v227
v_mfma_f32_16x16x32_bf16 v[132:135], a[248:251], a[32:35], v[132:135]
v_mul_f32 v228, v223, v228
v_mul_f32 v229, v223, v229
v_mfma_f32_16x16x32_bf16 v[136:139], a[248:251], a[36:39], v[136:139]
s_waitcnt lgkmcnt(4)
ds_read_b64_tr_b16 a[248:249], v242 offset:256
ds_read_b64_tr_b16 a[250:251], v242 offset:1792
v_mfma_f32_16x16x32_bf16 v[140:143], a[252:255], a[20:23], v[140:143]
v_cvt_pk_bf16_f32 v234, v226, v227
v_cvt_pk_bf16_f32 v235, v228, v229
v_mfma_f32_16x16x32_bf16 v[144:147], a[252:255], a[24:27], v[144:147]
v_accvgpr_read_b32 v230, a232
v_accvgpr_read_b32 v231, a233
v_mfma_f32_16x16x32_bf16 v[148:151], a[252:255], a[28:31], v[148:151]
v_accvgpr_read_b32 v232, a234
v_accvgpr_read_b32 v233, a235
v_mfma_f32_16x16x32_bf16 v[152:155], a[252:255], a[32:35], v[152:155]
v_mul_f32 v230, v223, v230
v_mul_f32 v231, v223, v231
v_mfma_f32_16x16x32_bf16 v[156:159], a[252:255], a[36:39], v[156:159]
s_waitcnt lgkmcnt(4)
ds_read_b64_tr_b16 a[252:253], v243 offset:256
ds_read_b64_tr_b16 a[254:255], v243 offset:1792
v_mfma_f32_16x16x32_bf16 v[160:163], a[240:243], a[20:23], v[160:163]
v_add_u32 v240, s32, v254
v_xor_b32 v241, 32, v240
v_mfma_f32_16x16x32_bf16 v[164:167], a[240:243], a[24:27], v[164:167]
v_xor_b32 v242, 64, v240
v_xor_b32 v243, 64, v241
v_mfma_f32_16x16x32_bf16 v[168:171], a[240:243], a[28:31], v[168:171]
s_add_u32 s32, s32, 24576
s_sub_u32 s42, s32, 147456
s_min_u32 s32, s32, s42
v_mfma_f32_16x16x32_bf16 v[172:175], a[240:243], a[32:35], v[172:175]
v_add_u32 v244, s32, v255
v_mul_f32 v232, v223, v232
v_mfma_f32_16x16x32_bf16 v[176:179], a[240:243], a[36:39], v[176:179]
s_waitcnt lgkmcnt(4)
s_add_u32 s32, s32, 24576
s_sub_u32 s42, s32, 147456
v_mfma_f32_16x16x32_bf16 v[180:183], a[244:247], a[20:23], v[180:183]
s_min_u32 s32, s32, s42
v_mul_f32 v233, v223, v233
v_cvt_pk_bf16_f32 v236, v230, v231
v_mfma_f32_16x16x32_bf16 v[184:187], a[244:247], a[24:27], v[184:187]
v_cvt_pk_bf16_f32 v237, v232, v233
v_mfma_f32_16x16x32_bf16 v[188:191], a[244:247], a[28:31], v[188:191]
s_waitcnt vmcnt(22) lgkmcnt(0)
s_barrier
ds_read_b64_tr_b16 a[240:241], v240 offset:0
v_mfma_f32_16x16x32_bf16 v[192:195], a[244:247], a[32:35], v[192:195]
s_add_u32 m0, s31, s38
ds_read_b64_tr_b16 a[242:243], v240 offset:1536
ds_read_b128 a[0:3], v244 offset:0
v_mfma_f32_16x16x32_bf16 v[196:199], a[244:247], a[36:39], v[196:199]
s_waitcnt lgkmcnt(15)
ds_read_b128 a[4:7], v244 offset:2048
ds_read_b128 a[8:11], v244 offset:4096
v_mfma_f32_16x16x32_bf16 v[200:203], a[248:251], a[20:23], v[200:203]
s_add_u32 s40, s35, s48
ds_read_b128 a[12:15], v244 offset:6144
ds_read_b128 a[16:19], v244 offset:8192
v_mfma_f32_16x16x32_bf16 v[204:207], a[248:251], a[24:27], v[204:207]
ds_read_b64_tr_b16 a[244:245], v241 offset:0
ds_read_b64_tr_b16 a[246:247], v241 offset:1536
v_mfma_f32_16x16x32_bf16 v[208:211], a[248:251], a[28:31], v[208:211]
buffer_load_dwordx4 v248, s[20:23], s40 offen offset:0 lds
v_mfma_f32_16x16x32_bf16 v[212:215], a[248:251], a[32:35], v[212:215]
v_mfma_f32_16x16x32_bf16 v[216:219], a[248:251], a[36:39], v[216:219]
s_waitcnt lgkmcnt(15)
ds_read_b64_tr_b16 a[248:249], v242 offset:0
ds_read_b64_tr_b16 a[250:251], v242 offset:1536
v_mfma_f32_16x16x32_bf16 a[60:63], a[252:255], a[20:23], a[60:63]
buffer_load_dwordx4 v249, s[20:23], s40 offen offset:1024 lds
v_mfma_f32_16x16x32_bf16 a[64:67], a[252:255], a[24:27], a[64:67]
v_mfma_f32_16x16x32_bf16 a[68:71], a[252:255], a[28:31], a[68:71]
v_mfma_f32_16x16x32_bf16 a[72:75], a[252:255], a[32:35], a[72:75]
buffer_load_dwordx4 v250, s[20:23], s40 offen offset:2048 lds
v_mfma_f32_16x16x32_bf16 a[76:79], a[252:255], a[36:39], a[76:79]
s_waitcnt lgkmcnt(4)
ds_read_b64_tr_b16 a[252:253], v243 offset:0
ds_read_b64_tr_b16 a[254:255], v243 offset:1536
v_mfma_f32_16x16x32_bf16 v[0:3], a[240:243], a[0:3], v[0:3]
s_add_u32 m0, m0, 6144
s_add_u32 s40, s40, 196608
v_mfma_f32_16x16x32_bf16 v[4:7], a[240:243], a[4:7], v[4:7]
buffer_load_dwordx4 v248, s[20:23], s40 offen offset:0 lds
v_mfma_f32_16x16x32_bf16 v[8:11], a[240:243], a[8:11], v[8:11]
v_mfma_f32_16x16x32_bf16 v[12:15], a[240:243], a[12:15], v[12:15]
v_mfma_f32_16x16x32_bf16 v[16:19], a[240:243], a[16:19], v[16:19]
s_waitcnt lgkmcnt(4)
ds_read_b64_tr_b16 a[240:241], v240 offset:128
ds_read_b64_tr_b16 a[242:243], v240 offset:1664
v_mfma_f32_16x16x32_bf16 v[20:23], a[244:247], a[0:3], v[20:23]
buffer_load_dwordx4 v249, s[20:23], s40 offen offset:1024 lds
v_mfma_f32_16x16x32_bf16 v[24:27], a[244:247], a[4:7], v[24:27]
v_mfma_f32_16x16x32_bf16 v[28:31], a[244:247], a[8:11], v[28:31]
v_mfma_f32_16x16x32_bf16 v[32:35], a[244:247], a[12:15], v[32:35]
buffer_load_dwordx4 v250, s[20:23], s40 offen offset:2048 lds
v_mfma_f32_16x16x32_bf16 v[36:39], a[244:247], a[16:19], v[36:39]
s_waitcnt lgkmcnt(4)
ds_read_b64_tr_b16 a[244:245], v241 offset:128
ds_read_b64_tr_b16 a[246:247], v241 offset:1664
v_mfma_f32_16x16x32_bf16 v[40:43], a[248:251], a[0:3], v[40:43]
s_add_u32 s35, s35, 393216
s_sub_u32 s40, s35, 7864320
s_min_u32 s35, s35, s40
v_mfma_f32_16x16x32_bf16 v[44:47], a[248:251], a[4:7], v[44:47]
s_add_u32 s31, s31, 24576
s_sub_u32 s41, s31, 147456
s_min_u32 s31, s31, s41
v_mfma_f32_16x16x32_bf16 v[48:51], a[248:251], a[8:11], v[48:51]
s_mov_b32 m0, s76
v_mfma_f32_16x16x32_bf16 v[52:55], a[248:251], a[12:15], v[52:55]
buffer_load_dword v238, s[60:63], s59 offen lds
v_mfma_f32_16x16x32_bf16 v[56:59], a[248:251], a[16:19], v[56:59]
s_waitcnt lgkmcnt(4)
ds_read_b64_tr_b16 a[248:249], v242 offset:128
ds_read_b64_tr_b16 a[250:251], v242 offset:1664
v_mfma_f32_16x16x32_bf16 v[60:63], a[252:255], a[0:3], v[60:63]
s_add_u32 s59, s59, 3072
v_xor_b32 v244, 64, v244
v_mfma_f32_16x16x32_bf16 v[64:67], a[252:255], a[4:7], v[64:67]
ds_read_b128 a[20:23], v244 offset:0
ds_read_b128 a[24:27], v244 offset:2048
v_mfma_f32_16x16x32_bf16 v[68:71], a[252:255], a[8:11], v[68:71]
ds_read_b128 a[28:31], v244 offset:4096
ds_read_b128 a[32:35], v244 offset:6144
v_mfma_f32_16x16x32_bf16 v[72:75], a[252:255], a[12:15], v[72:75]
ds_read_b128 a[36:39], v244 offset:8192
v_mfma_f32_16x16x32_bf16 v[76:79], a[252:255], a[16:19], v[76:79]
s_waitcnt lgkmcnt(9)
ds_read_b64_tr_b16 a[252:253], v243 offset:128
ds_read_b64_tr_b16 a[254:255], v243 offset:1664
v_mfma_f32_16x16x32_bf16 v[80:83], a[240:243], a[0:3], v[80:83]
buffer_store_dwordx4 v[234:237], v239, s[24:27], s39 offen offset:3072 sc1
v_mfma_f32_16x16x32_bf16 v[84:87], a[240:243], a[4:7], v[84:87]
v_accvgpr_read_b32 v226, a216
v_accvgpr_read_b32 v227, a217
v_mfma_f32_16x16x32_bf16 v[88:91], a[240:243], a[8:11], v[88:91]
v_accvgpr_read_b32 v228, a218
v_accvgpr_read_b32 v229, a219
v_mfma_f32_16x16x32_bf16 v[92:95], a[240:243], a[12:15], v[92:95]
v_mul_f32 v226, v224, v226
v_mul_f32 v227, v224, v227
v_mfma_f32_16x16x32_bf16 v[96:99], a[240:243], a[16:19], v[96:99]
s_waitcnt lgkmcnt(9)
ds_read_b64_tr_b16 a[240:241], v240 offset:256
ds_read_b64_tr_b16 a[242:243], v240 offset:1792
v_mfma_f32_16x16x32_bf16 v[100:103], a[244:247], a[0:3], v[100:103]
v_mul_f32 v228, v224, v228
v_mul_f32 v229, v224, v229
v_mfma_f32_16x16x32_bf16 v[104:107], a[244:247], a[4:7], v[104:107]
v_cvt_pk_bf16_f32 v234, v226, v227
v_cvt_pk_bf16_f32 v235, v228, v229
v_mfma_f32_16x16x32_bf16 v[108:111], a[244:247], a[8:11], v[108:111]
v_accvgpr_read_b32 v230, a236
v_accvgpr_read_b32 v231, a237
v_mfma_f32_16x16x32_bf16 v[112:115], a[244:247], a[12:15], v[112:115]
v_accvgpr_read_b32 v232, a238
v_accvgpr_read_b32 v233, a239
v_mfma_f32_16x16x32_bf16 v[116:119], a[244:247], a[16:19], v[116:119]
s_waitcnt lgkmcnt(9)
ds_read_b64_tr_b16 a[244:245], v241 offset:256
ds_read_b64_tr_b16 a[246:247], v241 offset:1792
v_mfma_f32_16x16x32_bf16 v[120:123], a[248:251], a[0:3], v[120:123]
v_mul_f32 v230, v224, v230
v_mul_f32 v231, v224, v231
v_mfma_f32_16x16x32_bf16 v[124:127], a[248:251], a[4:7], v[124:127]
v_mul_f32 v232, v224, v232
v_mul_f32 v233, v224, v233
v_mfma_f32_16x16x32_bf16 v[128:131], a[248:251], a[8:11], v[128:131]
v_cvt_pk_bf16_f32 v236, v230, v231
v_cvt_pk_bf16_f32 v237, v232, v233
v_mfma_f32_16x16x32_bf16 v[132:135], a[248:251], a[12:15], v[132:135]
buffer_store_dwordx4 v[234:237], v225, s[24:27], s39 offen sc1
v_mfma_f32_16x16x32_bf16 v[136:139], a[248:251], a[16:19], v[136:139]
s_waitcnt lgkmcnt(4)
ds_read_b64_tr_b16 a[248:249], v242 offset:256
ds_read_b64_tr_b16 a[250:251], v242 offset:1792
v_mfma_f32_16x16x32_bf16 v[140:143], a[252:255], a[0:3], v[140:143]
s_add_u32 s47, s47, s36
v_mfma_f32_16x16x32_bf16 v[144:147], a[252:255], a[4:7], v[144:147]
v_mfma_f32_16x16x32_bf16 v[148:151], a[252:255], a[8:11], v[148:151]
v_mfma_f32_16x16x32_bf16 v[152:155], a[252:255], a[12:15], v[152:155]
v_mfma_f32_16x16x32_bf16 v[156:159], a[252:255], a[16:19], v[156:159]
s_waitcnt lgkmcnt(4)
ds_read_b64_tr_b16 a[252:253], v243 offset:256
ds_read_b64_tr_b16 a[254:255], v243 offset:1792
v_mfma_f32_16x16x32_bf16 v[160:163], a[240:243], a[0:3], v[160:163]
v_add_u32 v240, s32, v254
v_xor_b32 v241, 32, v240
v_mfma_f32_16x16x32_bf16 v[164:167], a[240:243], a[4:7], v[164:167]
v_xor_b32 v242, 64, v240
v_xor_b32 v243, 64, v241
v_mfma_f32_16x16x32_bf16 v[168:171], a[240:243], a[8:11], v[168:171]
s_add_u32 s32, s32, 24576
s_sub_u32 s42, s32, 147456
s_min_u32 s32, s32, s42
v_mfma_f32_16x16x32_bf16 v[172:175], a[240:243], a[12:15], v[172:175]
v_mfma_f32_16x16x32_bf16 v[176:179], a[240:243], a[16:19], v[176:179]
s_waitcnt lgkmcnt(4)
v_mfma_f32_16x16x32_bf16 v[180:183], a[244:247], a[0:3], v[180:183]
v_mfma_f32_16x16x32_bf16 v[184:187], a[244:247], a[4:7], v[184:187]
v_mfma_f32_16x16x32_bf16 v[188:191], a[244:247], a[8:11], v[188:191]
s_waitcnt vmcnt(24) lgkmcnt(0)
s_barrier
ds_read_b64_tr_b16 a[240:241], v240 offset:0
v_mfma_f32_16x16x32_bf16 v[192:195], a[244:247], a[12:15], v[192:195]
s_add_u32 m0, s31, s38
s_add_u32 s40, s35, s48
ds_read_b64_tr_b16 a[242:243], v240 offset:1536
v_mfma_f32_16x16x32_bf16 v[196:199], a[244:247], a[16:19], v[196:199]
s_waitcnt lgkmcnt(15)
ds_read_b64_tr_b16 a[244:245], v241 offset:0
ds_read_b64_tr_b16 a[246:247], v241 offset:1536
v_mfma_f32_16x16x32_bf16 v[200:203], a[248:251], a[0:3], v[200:203]
buffer_load_dwordx4 v248, s[20:23], s40 offen offset:0 lds
v_mfma_f32_16x16x32_bf16 v[204:207], a[248:251], a[4:7], v[204:207]
v_mfma_f32_16x16x32_bf16 v[208:211], a[248:251], a[8:11], v[208:211]
v_mfma_f32_16x16x32_bf16 v[212:215], a[248:251], a[12:15], v[212:215]
buffer_load_dwordx4 v249, s[20:23], s40 offen offset:1024 lds
v_mfma_f32_16x16x32_bf16 v[216:219], a[248:251], a[16:19], v[216:219]
s_waitcnt lgkmcnt(15)
ds_read_b64_tr_b16 a[248:249], v242 offset:0
ds_read_b64_tr_b16 a[250:251], v242 offset:1536
v_mfma_f32_16x16x32_bf16 a[60:63], a[252:255], a[0:3], a[60:63]
v_mfma_f32_16x16x32_bf16 a[64:67], a[252:255], a[4:7], a[64:67]
buffer_load_dwordx4 v250, s[20:23], s40 offen offset:2048 lds
v_mfma_f32_16x16x32_bf16 a[68:71], a[252:255], a[8:11], a[68:71]
s_add_u32 m0, m0, 6144
s_add_u32 s40, s40, 196608
v_mfma_f32_16x16x32_bf16 a[72:75], a[252:255], a[12:15], a[72:75]
v_mfma_f32_16x16x32_bf16 a[76:79], a[252:255], a[16:19], a[76:79]
s_waitcnt lgkmcnt(4)
ds_read_b64_tr_b16 a[252:253], v243 offset:0
ds_read_b64_tr_b16 a[254:255], v243 offset:1536
v_mfma_f32_16x16x32_bf16 v[0:3], a[240:243], a[20:23], v[0:3]
buffer_load_dwordx4 v248, s[20:23], s40 offen offset:0 lds
v_mfma_f32_16x16x32_bf16 v[4:7], a[240:243], a[24:27], v[4:7]
v_mfma_f32_16x16x32_bf16 v[8:11], a[240:243], a[28:31], v[8:11]
v_mfma_f32_16x16x32_bf16 v[12:15], a[240:243], a[32:35], v[12:15]
buffer_load_dwordx4 v249, s[20:23], s40 offen offset:1024 lds
v_mfma_f32_16x16x32_bf16 v[16:19], a[240:243], a[36:39], v[16:19]
s_waitcnt lgkmcnt(4)
ds_read_b64_tr_b16 a[240:241], v240 offset:128
ds_read_b64_tr_b16 a[242:243], v240 offset:1664
v_mfma_f32_16x16x32_bf16 v[20:23], a[244:247], a[20:23], v[20:23]
v_mfma_f32_16x16x32_bf16 v[24:27], a[244:247], a[24:27], v[24:27]
buffer_load_dwordx4 v250, s[20:23], s40 offen offset:2048 lds
v_mfma_f32_16x16x32_bf16 v[28:31], a[244:247], a[28:31], v[28:31]
s_add_u32 s35, s35, 393216
s_sub_u32 s40, s35, 7864320
s_min_u32 s35, s35, s40
v_mfma_f32_16x16x32_bf16 v[32:35], a[244:247], a[32:35], v[32:35]
s_add_u32 s31, s31, 24576
s_sub_u32 s41, s31, 147456
s_min_u32 s31, s31, s41
v_mfma_f32_16x16x32_bf16 v[36:39], a[244:247], a[36:39], v[36:39]
s_waitcnt lgkmcnt(4)
ds_read_b64_tr_b16 a[244:245], v241 offset:128
ds_read_b64_tr_b16 a[246:247], v241 offset:1664
v_mfma_f32_16x16x32_bf16 v[40:43], a[248:251], a[20:23], v[40:43]
s_add_u32 m0, s31, s55
s_add_u32 s40, s54, s49
v_mfma_f32_16x16x32_bf16 v[44:47], a[248:251], a[24:27], v[44:47]
buffer_load_dwordx4 v251, s[8:11], s40 offen offset:0 lds
v_mfma_f32_16x16x32_bf16 v[48:51], a[248:251], a[28:31], v[48:51]
s_add_u32 s40, s40, 9216
v_mfma_f32_16x16x32_bf16 v[52:55], a[248:251], a[32:35], v[52:55]
v_mfma_f32_16x16x32_bf16 v[56:59], a[248:251], a[36:39], v[56:59]
s_waitcnt lgkmcnt(4)
ds_read_b64_tr_b16 a[248:249], v242 offset:128
ds_read_b64_tr_b16 a[250:251], v242 offset:1664
v_mfma_f32_16x16x32_bf16 v[60:63], a[252:255], a[20:23], v[60:63]
buffer_load_dwordx4 v251, s[8:11], s40 offen offset:1024 lds
v_mfma_f32_16x16x32_bf16 v[64:67], a[252:255], a[24:27], v[64:67]
s_add_u32 s40, s40, 9216
v_mfma_f32_16x16x32_bf16 v[68:71], a[252:255], a[28:31], v[68:71]
v_mfma_f32_16x16x32_bf16 v[72:75], a[252:255], a[32:35], v[72:75]
buffer_load_dwordx4 v251, s[8:11], s40 offen offset:2048 lds
v_mfma_f32_16x16x32_bf16 v[76:79], a[252:255], a[36:39], v[76:79]
s_waitcnt lgkmcnt(4)
ds_read_b64_tr_b16 a[252:253], v243 offset:128
ds_read_b64_tr_b16 a[254:255], v243 offset:1664
v_mfma_f32_16x16x32_bf16 v[80:83], a[240:243], a[20:23], v[80:83]
s_add_u32 s40, s40, 9216
v_mfma_f32_16x16x32_bf16 v[84:87], a[240:243], a[24:27], v[84:87]
buffer_load_dwordx4 v251, s[8:11], s40 offen offset:3072 lds
v_mfma_f32_16x16x32_bf16 v[88:91], a[240:243], a[28:31], v[88:91]
s_add_u32 m0, m0, 4096
s_add_u32 s40, s40, 13312
v_mfma_f32_16x16x32_bf16 v[92:95], a[240:243], a[32:35], v[92:95]
v_mfma_f32_16x16x32_bf16 v[96:99], a[240:243], a[36:39], v[96:99]
s_waitcnt lgkmcnt(4)
ds_read_b64_tr_b16 a[240:241], v240 offset:256
ds_read_b64_tr_b16 a[242:243], v240 offset:1792
v_mfma_f32_16x16x32_bf16 v[100:103], a[244:247], a[20:23], v[100:103]
buffer_load_dwordx4 v251, s[8:11], s40 offen lds
v_mfma_f32_16x16x32_bf16 v[104:107], a[244:247], a[24:27], v[104:107]
s_add_u32 s54, s54, 128
s_sub_u32 s40, s54, 1280
s_min_u32 s54, s54, s40
v_mfma_f32_16x16x32_bf16 v[108:111], a[244:247], a[28:31], v[108:111]
s_add_u32 s31, s31, 24576
s_sub_u32 s41, s31, 147456
s_min_u32 s31, s31, s41
v_mfma_f32_16x16x32_bf16 v[112:115], a[244:247], a[32:35], v[112:115]
v_mfma_f32_16x16x32_bf16 v[116:119], a[244:247], a[36:39], v[116:119]
s_waitcnt lgkmcnt(4)
ds_read_b64_tr_b16 a[244:245], v241 offset:256
ds_read_b64_tr_b16 a[246:247], v241 offset:1792
v_mfma_f32_16x16x32_bf16 v[120:123], a[248:251], a[20:23], v[120:123]
v_mfma_f32_16x16x32_bf16 v[124:127], a[248:251], a[24:27], v[124:127]
v_mfma_f32_16x16x32_bf16 v[128:131], a[248:251], a[28:31], v[128:131]
v_mfma_f32_16x16x32_bf16 v[132:135], a[248:251], a[32:35], v[132:135]
v_mfma_f32_16x16x32_bf16 v[136:139], a[248:251], a[36:39], v[136:139]
s_waitcnt lgkmcnt(4)
ds_read_b64_tr_b16 a[248:249], v242 offset:256
ds_read_b64_tr_b16 a[250:251], v242 offset:1792
v_mfma_f32_16x16x32_bf16 v[140:143], a[252:255], a[20:23], v[140:143]
v_mfma_f32_16x16x32_bf16 v[144:147], a[252:255], a[24:27], v[144:147]
v_mfma_f32_16x16x32_bf16 v[148:151], a[252:255], a[28:31], v[148:151]
v_mfma_f32_16x16x32_bf16 v[152:155], a[252:255], a[32:35], v[152:155]
v_mfma_f32_16x16x32_bf16 v[156:159], a[252:255], a[36:39], v[156:159]
s_waitcnt lgkmcnt(4)
ds_read_b64_tr_b16 a[252:253], v243 offset:256
ds_read_b64_tr_b16 a[254:255], v243 offset:1792
v_mfma_f32_16x16x32_bf16 v[160:163], a[240:243], a[20:23], v[160:163]
v_add_u32 v240, s32, v254
v_xor_b32 v241, 32, v240
v_mfma_f32_16x16x32_bf16 v[164:167], a[240:243], a[24:27], v[164:167]
v_xor_b32 v242, 64, v240
v_xor_b32 v243, 64, v241
v_mfma_f32_16x16x32_bf16 v[168:171], a[240:243], a[28:31], v[168:171]
s_add_u32 s32, s32, 24576
s_sub_u32 s42, s32, 147456
s_min_u32 s32, s32, s42
v_mfma_f32_16x16x32_bf16 v[172:175], a[240:243], a[32:35], v[172:175]
v_add_u32 v244, s32, v255
v_mfma_f32_16x16x32_bf16 v[176:179], a[240:243], a[36:39], v[176:179]
s_waitcnt lgkmcnt(4)
s_add_u32 s32, s32, 24576
s_sub_u32 s42, s32, 147456
v_mfma_f32_16x16x32_bf16 v[180:183], a[244:247], a[20:23], v[180:183]
s_min_u32 s32, s32, s42
v_mfma_f32_16x16x32_bf16 v[184:187], a[244:247], a[24:27], v[184:187]
v_mfma_f32_16x16x32_bf16 v[188:191], a[244:247], a[28:31], v[188:191]
s_waitcnt vmcnt(21) lgkmcnt(0)
s_barrier
ds_read_b64_tr_b16 a[240:241], v240 offset:0
v_mfma_f32_16x16x32_bf16 v[192:195], a[244:247], a[32:35], v[192:195]
s_add_u32 m0, s31, s38
ds_read_b64_tr_b16 a[242:243], v240 offset:1536
ds_read_b128 a[0:3], v244 offset:0
v_mfma_f32_16x16x32_bf16 v[196:199], a[244:247], a[36:39], v[196:199]
s_waitcnt lgkmcnt(15)
ds_read_b128 a[4:7], v244 offset:2048
ds_read_b128 a[8:11], v244 offset:4096
v_mfma_f32_16x16x32_bf16 v[200:203], a[248:251], a[20:23], v[200:203]
s_add_u32 s40, s35, s48
ds_read_b128 a[12:15], v244 offset:6144
ds_read_b128 a[16:19], v244 offset:8192
v_mfma_f32_16x16x32_bf16 v[204:207], a[248:251], a[24:27], v[204:207]
ds_read_b64_tr_b16 a[244:245], v241 offset:0
ds_read_b64_tr_b16 a[246:247], v241 offset:1536
v_mfma_f32_16x16x32_bf16 v[208:211], a[248:251], a[28:31], v[208:211]
buffer_load_dwordx4 v248, s[20:23], s40 offen offset:0 lds
v_mfma_f32_16x16x32_bf16 v[212:215], a[248:251], a[32:35], v[212:215]
v_mfma_f32_16x16x32_bf16 v[216:219], a[248:251], a[36:39], v[216:219]
s_waitcnt lgkmcnt(15)
ds_read_b64_tr_b16 a[248:249], v242 offset:0
ds_read_b64_tr_b16 a[250:251], v242 offset:1536
v_mfma_f32_16x16x32_bf16 a[60:63], a[252:255], a[20:23], a[60:63]
buffer_load_dwordx4 v249, s[20:23], s40 offen offset:1024 lds
v_mfma_f32_16x16x32_bf16 a[64:67], a[252:255], a[24:27], a[64:67]
v_mfma_f32_16x16x32_bf16 a[68:71], a[252:255], a[28:31], a[68:71]
v_mfma_f32_16x16x32_bf16 a[72:75], a[252:255], a[32:35], a[72:75]
buffer_load_dwordx4 v250, s[20:23], s40 offen offset:2048 lds
v_mfma_f32_16x16x32_bf16 a[76:79], a[252:255], a[36:39], a[76:79]
s_waitcnt lgkmcnt(4)
ds_read_b64_tr_b16 a[252:253], v243 offset:0
ds_read_b64_tr_b16 a[254:255], v243 offset:1536
v_mfma_f32_16x16x32_bf16 v[0:3], a[240:243], a[0:3], v[0:3]
s_add_u32 m0, m0, 6144
s_add_u32 s40, s40, 196608
v_mfma_f32_16x16x32_bf16 v[4:7], a[240:243], a[4:7], v[4:7]
buffer_load_dwordx4 v248, s[20:23], s40 offen offset:0 lds
v_mfma_f32_16x16x32_bf16 v[8:11], a[240:243], a[8:11], v[8:11]
v_mfma_f32_16x16x32_bf16 v[12:15], a[240:243], a[12:15], v[12:15]
v_mfma_f32_16x16x32_bf16 v[16:19], a[240:243], a[16:19], v[16:19]
s_waitcnt lgkmcnt(4)
ds_read_b64_tr_b16 a[240:241], v240 offset:128
ds_read_b64_tr_b16 a[242:243], v240 offset:1664
v_mfma_f32_16x16x32_bf16 v[20:23], a[244:247], a[0:3], v[20:23]
buffer_load_dwordx4 v249, s[20:23], s40 offen offset:1024 lds
v_mfma_f32_16x16x32_bf16 v[24:27], a[244:247], a[4:7], v[24:27]
v_mfma_f32_16x16x32_bf16 v[28:31], a[244:247], a[8:11], v[28:31]
v_mfma_f32_16x16x32_bf16 v[32:35], a[244:247], a[12:15], v[32:35]
buffer_load_dwordx4 v250, s[20:23], s40 offen offset:2048 lds
v_mfma_f32_16x16x32_bf16 v[36:39], a[244:247], a[16:19], v[36:39]
s_waitcnt lgkmcnt(4)
ds_read_b64_tr_b16 a[244:245], v241 offset:128
ds_read_b64_tr_b16 a[246:247], v241 offset:1664
v_mfma_f32_16x16x32_bf16 v[40:43], a[248:251], a[0:3], v[40:43]
s_add_u32 s35, s35, 393216
s_sub_u32 s40, s35, 7864320
s_min_u32 s35, s35, s40
v_mfma_f32_16x16x32_bf16 v[44:47], a[248:251], a[4:7], v[44:47]
s_add_u32 s31, s31, 24576
s_sub_u32 s41, s31, 147456
s_min_u32 s31, s31, s41
v_mfma_f32_16x16x32_bf16 v[48:51], a[248:251], a[8:11], v[48:51]
v_mfma_f32_16x16x32_bf16 v[52:55], a[248:251], a[12:15], v[52:55]
v_mfma_f32_16x16x32_bf16 v[56:59], a[248:251], a[16:19], v[56:59]
s_waitcnt lgkmcnt(4)
ds_read_b64_tr_b16 a[248:249], v242 offset:128
ds_read_b64_tr_b16 a[250:251], v242 offset:1664
v_mfma_f32_16x16x32_bf16 v[60:63], a[252:255], a[0:3], v[60:63]
v_xor_b32 v244, 64, v244
v_mfma_f32_16x16x32_bf16 v[64:67], a[252:255], a[4:7], v[64:67]
ds_read_b128 a[20:23], v244 offset:0
ds_read_b128 a[24:27], v244 offset:2048
v_mfma_f32_16x16x32_bf16 v[68:71], a[252:255], a[8:11], v[68:71]
ds_read_b128 a[28:31], v244 offset:4096
ds_read_b128 a[32:35], v244 offset:6144
v_mfma_f32_16x16x32_bf16 v[72:75], a[252:255], a[12:15], v[72:75]
ds_read_b128 a[36:39], v244 offset:8192
v_mfma_f32_16x16x32_bf16 v[76:79], a[252:255], a[16:19], v[76:79]
s_waitcnt lgkmcnt(9)
ds_read_b64_tr_b16 a[252:253], v243 offset:128
ds_read_b64_tr_b16 a[254:255], v243 offset:1664
v_mfma_f32_16x16x32_bf16 v[80:83], a[240:243], a[0:3], v[80:83]
v_mfma_f32_16x16x32_bf16 v[84:87], a[240:243], a[4:7], v[84:87]
v_mfma_f32_16x16x32_bf16 v[88:91], a[240:243], a[8:11], v[88:91]
v_mfma_f32_16x16x32_bf16 v[92:95], a[240:243], a[12:15], v[92:95]
v_mfma_f32_16x16x32_bf16 v[96:99], a[240:243], a[16:19], v[96:99]
s_waitcnt lgkmcnt(9)
ds_read_b64_tr_b16 a[240:241], v240 offset:256
ds_read_b64_tr_b16 a[242:243], v240 offset:1792
v_mfma_f32_16x16x32_bf16 v[100:103], a[244:247], a[0:3], v[100:103]
v_mfma_f32_16x16x32_bf16 v[104:107], a[244:247], a[4:7], v[104:107]
v_mfma_f32_16x16x32_bf16 v[108:111], a[244:247], a[8:11], v[108:111]
v_mfma_f32_16x16x32_bf16 v[112:115], a[244:247], a[12:15], v[112:115]
v_mfma_f32_16x16x32_bf16 v[116:119], a[244:247], a[16:19], v[116:119]
s_waitcnt lgkmcnt(9)
ds_read_b64_tr_b16 a[244:245], v241 offset:256
ds_read_b64_tr_b16 a[246:247], v241 offset:1792
v_mfma_f32_16x16x32_bf16 v[120:123], a[248:251], a[0:3], v[120:123]
v_mfma_f32_16x16x32_bf16 v[124:127], a[248:251], a[4:7], v[124:127]
v_mfma_f32_16x16x32_bf16 v[128:131], a[248:251], a[8:11], v[128:131]
v_mfma_f32_16x16x32_bf16 v[132:135], a[248:251], a[12:15], v[132:135]
v_mfma_f32_16x16x32_bf16 v[136:139], a[248:251], a[16:19], v[136:139]
s_waitcnt lgkmcnt(4)
ds_read_b64_tr_b16 a[248:249], v242 offset:256
ds_read_b64_tr_b16 a[250:251], v242 offset:1792
v_mfma_f32_16x16x32_bf16 v[140:143], a[252:255], a[0:3], v[140:143]
v_mfma_f32_16x16x32_bf16 v[144:147], a[252:255], a[4:7], v[144:147]
v_mfma_f32_16x16x32_bf16 v[148:151], a[252:255], a[8:11], v[148:151]
v_mfma_f32_16x16x32_bf16 v[152:155], a[252:255], a[12:15], v[152:155]
v_mfma_f32_16x16x32_bf16 v[156:159], a[252:255], a[16:19], v[156:159]
s_waitcnt lgkmcnt(4)
ds_read_b64_tr_b16 a[252:253], v243 offset:256
ds_read_b64_tr_b16 a[254:255], v243 offset:1792
v_mfma_f32_16x16x32_bf16 v[160:163], a[240:243], a[0:3], v[160:163]
v_add_u32 v240, s32, v254
v_xor_b32 v241, 32, v240
v_mfma_f32_16x16x32_bf16 v[164:167], a[240:243], a[4:7], v[164:167]
v_xor_b32 v242, 64, v240
v_xor_b32 v243, 64, v241
v_mfma_f32_16x16x32_bf16 v[168:171], a[240:243], a[8:11], v[168:171]
s_add_u32 s32, s32, 24576
s_sub_u32 s42, s32, 147456
s_min_u32 s32, s32, s42
v_mfma_f32_16x16x32_bf16 v[172:175], a[240:243], a[12:15], v[172:175]
v_mfma_f32_16x16x32_bf16 v[176:179], a[240:243], a[16:19], v[176:179]
s_waitcnt lgkmcnt(4)
v_mfma_f32_16x16x32_bf16 v[180:183], a[244:247], a[0:3], v[180:183]
v_mfma_f32_16x16x32_bf16 v[184:187], a[244:247], a[4:7], v[184:187]
v_mfma_f32_16x16x32_bf16 v[188:191], a[244:247], a[8:11], v[188:191]
s_waitcnt vmcnt(20) lgkmcnt(0)
s_barrier
ds_read_b64_tr_b16 a[240:241], v240 offset:0
v_mfma_f32_16x16x32_bf16 v[192:195], a[244:247], a[12:15], v[192:195]
s_add_u32 m0, s31, s38
s_add_u32 s40, s35, s48
ds_read_b64_tr_b16 a[242:243], v240 offset:1536
v_mfma_f32_16x16x32_bf16 v[196:199], a[244:247], a[16:19], v[196:199]
s_waitcnt lgkmcnt(15)
ds_read_b64_tr_b16 a[244:245], v241 offset:0
ds_read_b64_tr_b16 a[246:247], v241 offset:1536
v_mfma_f32_16x16x32_bf16 v[200:203], a[248:251], a[0:3], v[200:203]
buffer_load_dwordx4 v248, s[20:23], s40 offen offset:0 lds
v_mfma_f32_16x16x32_bf16 v[204:207], a[248:251], a[4:7], v[204:207]
v_mfma_f32_16x16x32_bf16 v[208:211], a[248:251], a[8:11], v[208:211]
v_mfma_f32_16x16x32_bf16 v[212:215], a[248:251], a[12:15], v[212:215]
buffer_load_dwordx4 v249, s[20:23], s40 offen offset:1024 lds
v_mfma_f32_16x16x32_bf16 v[216:219], a[248:251], a[16:19], v[216:219]
s_waitcnt lgkmcnt(15)
ds_read_b64_tr_b16 a[248:249], v242 offset:0
ds_read_b64_tr_b16 a[250:251], v242 offset:1536
v_mfma_f32_16x16x32_bf16 a[60:63], a[252:255], a[0:3], a[60:63]
v_mfma_f32_16x16x32_bf16 a[64:67], a[252:255], a[4:7], a[64:67]
buffer_load_dwordx4 v250, s[20:23], s40 offen offset:2048 lds
v_mfma_f32_16x16x32_bf16 a[68:71], a[252:255], a[8:11], a[68:71]
s_add_u32 m0, m0, 6144
s_add_u32 s40, s40, 196608
v_mfma_f32_16x16x32_bf16 a[72:75], a[252:255], a[12:15], a[72:75]
v_mfma_f32_16x16x32_bf16 a[76:79], a[252:255], a[16:19], a[76:79]
s_waitcnt lgkmcnt(4)
ds_read_b64_tr_b16 a[252:253], v243 offset:0
ds_read_b64_tr_b16 a[254:255], v243 offset:1536
v_mfma_f32_16x16x32_bf16 v[0:3], a[240:243], a[20:23], v[0:3]
buffer_load_dwordx4 v248, s[20:23], s40 offen offset:0 lds
v_mfma_f32_16x16x32_bf16 v[4:7], a[240:243], a[24:27], v[4:7]
v_mfma_f32_16x16x32_bf16 v[8:11], a[240:243], a[28:31], v[8:11]
v_mfma_f32_16x16x32_bf16 v[12:15], a[240:243], a[32:35], v[12:15]
buffer_load_dwordx4 v249, s[20:23], s40 offen offset:1024 lds
v_mfma_f32_16x16x32_bf16 v[16:19], a[240:243], a[36:39], v[16:19]
s_waitcnt lgkmcnt(4)
ds_read_b64_tr_b16 a[240:241], v240 offset:128
ds_read_b64_tr_b16 a[242:243], v240 offset:1664
v_mfma_f32_16x16x32_bf16 v[20:23], a[244:247], a[20:23], v[20:23]
v_mfma_f32_16x16x32_bf16 v[24:27], a[244:247], a[24:27], v[24:27]
buffer_load_dwordx4 v250, s[20:23], s40 offen offset:2048 lds
v_mfma_f32_16x16x32_bf16 v[28:31], a[244:247], a[28:31], v[28:31]
s_add_u32 s35, s35, 393216
s_sub_u32 s40, s35, 7864320
s_min_u32 s35, s35, s40
v_mfma_f32_16x16x32_bf16 v[32:35], a[244:247], a[32:35], v[32:35]
s_add_u32 s31, s31, 24576
s_sub_u32 s41, s31, 147456
s_min_u32 s31, s31, s41
v_mfma_f32_16x16x32_bf16 v[36:39], a[244:247], a[36:39], v[36:39]
s_waitcnt lgkmcnt(4)
ds_read_b64_tr_b16 a[244:245], v241 offset:128
ds_read_b64_tr_b16 a[246:247], v241 offset:1664
v_mfma_f32_16x16x32_bf16 v[40:43], a[248:251], a[20:23], v[40:43]
s_add_u32 m0, s31, s55
s_add_u32 s40, s54, s49
v_mfma_f32_16x16x32_bf16 v[44:47], a[248:251], a[24:27], v[44:47]
buffer_load_dwordx4 v251, s[8:11], s40 offen offset:0 lds
v_mfma_f32_16x16x32_bf16 v[48:51], a[248:251], a[28:31], v[48:51]
s_add_u32 s40, s40, 9216
v_mfma_f32_16x16x32_bf16 v[52:55], a[248:251], a[32:35], v[52:55]
v_mfma_f32_16x16x32_bf16 v[56:59], a[248:251], a[36:39], v[56:59]
s_waitcnt lgkmcnt(4)
ds_read_b64_tr_b16 a[248:249], v242 offset:128
ds_read_b64_tr_b16 a[250:251], v242 offset:1664
v_mfma_f32_16x16x32_bf16 v[60:63], a[252:255], a[20:23], v[60:63]
buffer_load_dwordx4 v251, s[8:11], s40 offen offset:1024 lds
v_mfma_f32_16x16x32_bf16 v[64:67], a[252:255], a[24:27], v[64:67]
s_add_u32 s40, s40, 9216
v_mfma_f32_16x16x32_bf16 v[68:71], a[252:255], a[28:31], v[68:71]
v_mfma_f32_16x16x32_bf16 v[72:75], a[252:255], a[32:35], v[72:75]
buffer_load_dwordx4 v251, s[8:11], s40 offen offset:2048 lds
v_mfma_f32_16x16x32_bf16 v[76:79], a[252:255], a[36:39], v[76:79]
s_waitcnt lgkmcnt(4)
ds_read_b64_tr_b16 a[252:253], v243 offset:128
ds_read_b64_tr_b16 a[254:255], v243 offset:1664
v_mfma_f32_16x16x32_bf16 v[80:83], a[240:243], a[20:23], v[80:83]
s_add_u32 s40, s40, 9216
v_mfma_f32_16x16x32_bf16 v[84:87], a[240:243], a[24:27], v[84:87]
buffer_load_dwordx4 v251, s[8:11], s40 offen offset:3072 lds
v_mfma_f32_16x16x32_bf16 v[88:91], a[240:243], a[28:31], v[88:91]
s_add_u32 m0, m0, 4096
s_add_u32 s40, s40, 13312
v_mfma_f32_16x16x32_bf16 v[92:95], a[240:243], a[32:35], v[92:95]
v_mfma_f32_16x16x32_bf16 v[96:99], a[240:243], a[36:39], v[96:99]
s_waitcnt lgkmcnt(4)
ds_read_b64_tr_b16 a[240:241], v240 offset:256
ds_read_b64_tr_b16 a[242:243], v240 offset:1792
v_mfma_f32_16x16x32_bf16 v[100:103], a[244:247], a[20:23], v[100:103]
buffer_load_dwordx4 v251, s[8:11], s40 offen lds
v_mfma_f32_16x16x32_bf16 v[104:107], a[244:247], a[24:27], v[104:107]
s_add_u32 s54, s54, 128
s_sub_u32 s40, s54, 1280
s_min_u32 s54, s54, s40
v_mfma_f32_16x16x32_bf16 v[108:111], a[244:247], a[28:31], v[108:111]
s_add_u32 s31, s31, 24576
s_sub_u32 s41, s31, 147456
s_min_u32 s31, s31, s41
v_mfma_f32_16x16x32_bf16 v[112:115], a[244:247], a[32:35], v[112:115]
v_mfma_f32_16x16x32_bf16 v[116:119], a[244:247], a[36:39], v[116:119]
s_waitcnt lgkmcnt(4)
ds_read_b64_tr_b16 a[244:245], v241 offset:256
ds_read_b64_tr_b16 a[246:247], v241 offset:1792
v_mfma_f32_16x16x32_bf16 v[120:123], a[248:251], a[20:23], v[120:123]
v_mfma_f32_16x16x32_bf16 v[124:127], a[248:251], a[24:27], v[124:127]
v_mfma_f32_16x16x32_bf16 v[128:131], a[248:251], a[28:31], v[128:131]
v_mfma_f32_16x16x32_bf16 v[132:135], a[248:251], a[32:35], v[132:135]
v_mfma_f32_16x16x32_bf16 v[136:139], a[248:251], a[36:39], v[136:139]
s_waitcnt lgkmcnt(4)
ds_read_b64_tr_b16 a[248:249], v242 offset:256
ds_read_b64_tr_b16 a[250:251], v242 offset:1792
v_mfma_f32_16x16x32_bf16 v[140:143], a[252:255], a[20:23], v[140:143]
v_mfma_f32_16x16x32_bf16 v[144:147], a[252:255], a[24:27], v[144:147]
v_mfma_f32_16x16x32_bf16 v[148:151], a[252:255], a[28:31], v[148:151]
v_mfma_f32_16x16x32_bf16 v[152:155], a[252:255], a[32:35], v[152:155]
v_mfma_f32_16x16x32_bf16 v[156:159], a[252:255], a[36:39], v[156:159]
s_waitcnt lgkmcnt(4)
ds_read_b64_tr_b16 a[252:253], v243 offset:256
ds_read_b64_tr_b16 a[254:255], v243 offset:1792
v_mfma_f32_16x16x32_bf16 v[160:163], a[240:243], a[20:23], v[160:163]
v_add_u32 v240, s32, v254
v_xor_b32 v241, 32, v240
v_mfma_f32_16x16x32_bf16 v[164:167], a[240:243], a[24:27], v[164:167]
v_xor_b32 v242, 64, v240
v_xor_b32 v243, 64, v241
v_mfma_f32_16x16x32_bf16 v[168:171], a[240:243], a[28:31], v[168:171]
s_add_u32 s32, s32, 24576
s_sub_u32 s42, s32, 147456
s_min_u32 s32, s32, s42
v_mfma_f32_16x16x32_bf16 v[172:175], a[240:243], a[32:35], v[172:175]
v_add_u32 v244, s32, v255
v_mfma_f32_16x16x32_bf16 v[176:179], a[240:243], a[36:39], v[176:179]
s_waitcnt lgkmcnt(4)
s_add_u32 s32, s32, 24576
s_sub_u32 s42, s32, 147456
v_mfma_f32_16x16x32_bf16 v[180:183], a[244:247], a[20:23], v[180:183]
s_min_u32 s32, s32, s42
v_mfma_f32_16x16x32_bf16 v[184:187], a[244:247], a[24:27], v[184:187]
v_mfma_f32_16x16x32_bf16 v[188:191], a[244:247], a[28:31], v[188:191]
s_waitcnt vmcnt(17) lgkmcnt(0)
s_barrier
ds_read_b64_tr_b16 a[240:241], v240 offset:0
v_mfma_f32_16x16x32_bf16 v[192:195], a[244:247], a[32:35], v[192:195]
s_add_u32 m0, s31, s38
ds_read_b64_tr_b16 a[242:243], v240 offset:1536
ds_read_b128 a[0:3], v244 offset:0
v_mfma_f32_16x16x32_bf16 v[196:199], a[244:247], a[36:39], v[196:199]
s_waitcnt lgkmcnt(15)
ds_read_b128 a[4:7], v244 offset:2048
ds_read_b128 a[8:11], v244 offset:4096
v_mfma_f32_16x16x32_bf16 v[200:203], a[248:251], a[20:23], v[200:203]
s_add_u32 s40, s35, s48
ds_read_b128 a[12:15], v244 offset:6144
ds_read_b128 a[16:19], v244 offset:8192
v_mfma_f32_16x16x32_bf16 v[204:207], a[248:251], a[24:27], v[204:207]
ds_read_b64_tr_b16 a[244:245], v241 offset:0
ds_read_b64_tr_b16 a[246:247], v241 offset:1536
v_mfma_f32_16x16x32_bf16 v[208:211], a[248:251], a[28:31], v[208:211]
buffer_load_dwordx4 v248, s[20:23], s40 offen offset:0 lds
v_mfma_f32_16x16x32_bf16 v[212:215], a[248:251], a[32:35], v[212:215]
v_mfma_f32_16x16x32_bf16 v[216:219], a[248:251], a[36:39], v[216:219]
s_waitcnt lgkmcnt(15)
ds_read_b64_tr_b16 a[248:249], v242 offset:0
ds_read_b64_tr_b16 a[250:251], v242 offset:1536
v_mfma_f32_16x16x32_bf16 a[60:63], a[252:255], a[20:23], a[60:63]
buffer_load_dwordx4 v249, s[20:23], s40 offen offset:1024 lds
v_mfma_f32_16x16x32_bf16 a[64:67], a[252:255], a[24:27], a[64:67]
v_mfma_f32_16x16x32_bf16 a[68:71], a[252:255], a[28:31], a[68:71]
v_mfma_f32_16x16x32_bf16 a[72:75], a[252:255], a[32:35], a[72:75]
buffer_load_dwordx4 v250, s[20:23], s40 offen offset:2048 lds
v_mfma_f32_16x16x32_bf16 a[76:79], a[252:255], a[36:39], a[76:79]
s_waitcnt lgkmcnt(4)
ds_read_b64_tr_b16 a[252:253], v243 offset:0
ds_read_b64_tr_b16 a[254:255], v243 offset:1536
v_mfma_f32_16x16x32_bf16 v[0:3], a[240:243], a[0:3], v[0:3]
s_add_u32 m0, m0, 6144
s_add_u32 s40, s40, 196608
v_mfma_f32_16x16x32_bf16 v[4:7], a[240:243], a[4:7], v[4:7]
buffer_load_dwordx4 v248, s[20:23], s40 offen offset:0 lds
v_mfma_f32_16x16x32_bf16 v[8:11], a[240:243], a[8:11], v[8:11]
v_mfma_f32_16x16x32_bf16 v[12:15], a[240:243], a[12:15], v[12:15]
v_mfma_f32_16x16x32_bf16 v[16:19], a[240:243], a[16:19], v[16:19]
s_waitcnt lgkmcnt(4)
ds_read_b64_tr_b16 a[240:241], v240 offset:128
ds_read_b64_tr_b16 a[242:243], v240 offset:1664
v_mfma_f32_16x16x32_bf16 v[20:23], a[244:247], a[0:3], v[20:23]
buffer_load_dwordx4 v249, s[20:23], s40 offen offset:1024 lds
v_mfma_f32_16x16x32_bf16 v[24:27], a[244:247], a[4:7], v[24:27]
v_mfma_f32_16x16x32_bf16 v[28:31], a[244:247], a[8:11], v[28:31]
v_mfma_f32_16x16x32_bf16 v[32:35], a[244:247], a[12:15], v[32:35]
buffer_load_dwordx4 v250, s[20:23], s40 offen offset:2048 lds
v_mfma_f32_16x16x32_bf16 v[36:39], a[244:247], a[16:19], v[36:39]
s_waitcnt lgkmcnt(4)
ds_read_b64_tr_b16 a[244:245], v241 offset:128
ds_read_b64_tr_b16 a[246:247], v241 offset:1664
v_mfma_f32_16x16x32_bf16 v[40:43], a[248:251], a[0:3], v[40:43]
s_add_u32 s35, s35, 393216
s_sub_u32 s40, s35, 7864320
s_min_u32 s35, s35, s40
v_mfma_f32_16x16x32_bf16 v[44:47], a[248:251], a[4:7], v[44:47]
s_add_u32 s31, s31, 24576
s_sub_u32 s41, s31, 147456
s_min_u32 s31, s31, s41
v_mfma_f32_16x16x32_bf16 v[48:51], a[248:251], a[8:11], v[48:51]
v_mfma_f32_16x16x32_bf16 v[52:55], a[248:251], a[12:15], v[52:55]
v_mfma_f32_16x16x32_bf16 v[56:59], a[248:251], a[16:19], v[56:59]
s_waitcnt lgkmcnt(4)
ds_read_b64_tr_b16 a[248:249], v242 offset:128
ds_read_b64_tr_b16 a[250:251], v242 offset:1664
v_mfma_f32_16x16x32_bf16 v[60:63], a[252:255], a[0:3], v[60:63]
v_xor_b32 v244, 64, v244
v_mfma_f32_16x16x32_bf16 v[64:67], a[252:255], a[4:7], v[64:67]
ds_read_b128 a[20:23], v244 offset:0
ds_read_b128 a[24:27], v244 offset:2048
v_mfma_f32_16x16x32_bf16 v[68:71], a[252:255], a[8:11], v[68:71]
ds_read_b128 a[28:31], v244 offset:4096
ds_read_b128 a[32:35], v244 offset:6144
v_mfma_f32_16x16x32_bf16 v[72:75], a[252:255], a[12:15], v[72:75]
ds_read_b128 a[36:39], v244 offset:8192
v_mfma_f32_16x16x32_bf16 v[76:79], a[252:255], a[16:19], v[76:79]
s_waitcnt lgkmcnt(9)
ds_read_b64_tr_b16 a[252:253], v243 offset:128
ds_read_b64_tr_b16 a[254:255], v243 offset:1664
v_mfma_f32_16x16x32_bf16 v[80:83], a[240:243], a[0:3], v[80:83]
v_mfma_f32_16x16x32_bf16 v[84:87], a[240:243], a[4:7], v[84:87]
v_mfma_f32_16x16x32_bf16 v[88:91], a[240:243], a[8:11], v[88:91]
v_mfma_f32_16x16x32_bf16 v[92:95], a[240:243], a[12:15], v[92:95]
v_mfma_f32_16x16x32_bf16 v[96:99], a[240:243], a[16:19], v[96:99]
s_waitcnt lgkmcnt(9)
ds_read_b64_tr_b16 a[240:241], v240 offset:256
ds_read_b64_tr_b16 a[242:243], v240 offset:1792
v_mfma_f32_16x16x32_bf16 v[100:103], a[244:247], a[0:3], v[100:103]
v_mfma_f32_16x16x32_bf16 v[104:107], a[244:247], a[4:7], v[104:107]
v_mfma_f32_16x16x32_bf16 v[108:111], a[244:247], a[8:11], v[108:111]
v_mfma_f32_16x16x32_bf16 v[112:115], a[244:247], a[12:15], v[112:115]
v_mfma_f32_16x16x32_bf16 v[116:119], a[244:247], a[16:19], v[116:119]
s_waitcnt lgkmcnt(9)
ds_read_b64_tr_b16 a[244:245], v241 offset:256
ds_read_b64_tr_b16 a[246:247], v241 offset:1792
v_mfma_f32_16x16x32_bf16 v[120:123], a[248:251], a[0:3], v[120:123]
v_mfma_f32_16x16x32_bf16 v[124:127], a[248:251], a[4:7], v[124:127]
v_mfma_f32_16x16x32_bf16 v[128:131], a[248:251], a[8:11], v[128:131]
v_mfma_f32_16x16x32_bf16 v[132:135], a[248:251], a[12:15], v[132:135]
v_mfma_f32_16x16x32_bf16 v[136:139], a[248:251], a[16:19], v[136:139]
s_waitcnt lgkmcnt(4)
ds_read_b64_tr_b16 a[248:249], v242 offset:256
ds_read_b64_tr_b16 a[250:251], v242 offset:1792
v_mfma_f32_16x16x32_bf16 v[140:143], a[252:255], a[0:3], v[140:143]
v_mfma_f32_16x16x32_bf16 v[144:147], a[252:255], a[4:7], v[144:147]
v_mfma_f32_16x16x32_bf16 v[148:151], a[252:255], a[8:11], v[148:151]
v_mfma_f32_16x16x32_bf16 v[152:155], a[252:255], a[12:15], v[152:155]
v_mfma_f32_16x16x32_bf16 v[156:159], a[252:255], a[16:19], v[156:159]
s_waitcnt lgkmcnt(4)
ds_read_b64_tr_b16 a[252:253], v243 offset:256
ds_read_b64_tr_b16 a[254:255], v243 offset:1792
v_mfma_f32_16x16x32_bf16 v[160:163], a[240:243], a[0:3], v[160:163]
v_add_u32 v240, s32, v254
v_xor_b32 v241, 32, v240
v_mfma_f32_16x16x32_bf16 v[164:167], a[240:243], a[4:7], v[164:167]
v_xor_b32 v242, 64, v240
v_xor_b32 v243, 64, v241
v_mfma_f32_16x16x32_bf16 v[168:171], a[240:243], a[8:11], v[168:171]
s_add_u32 s32, s32, 24576
s_sub_u32 s42, s32, 147456
s_min_u32 s32, s32, s42
v_mfma_f32_16x16x32_bf16 v[172:175], a[240:243], a[12:15], v[172:175]
v_mfma_f32_16x16x32_bf16 v[176:179], a[240:243], a[16:19], v[176:179]
s_waitcnt lgkmcnt(4)
v_mfma_f32_16x16x32_bf16 v[180:183], a[244:247], a[0:3], v[180:183]
v_mfma_f32_16x16x32_bf16 v[184:187], a[244:247], a[4:7], v[184:187]
v_mfma_f32_16x16x32_bf16 v[188:191], a[244:247], a[8:11], v[188:191]
s_waitcnt vmcnt(17) lgkmcnt(0)
s_barrier
ds_read_b64_tr_b16 a[240:241], v240 offset:0
v_mfma_f32_16x16x32_bf16 v[192:195], a[244:247], a[12:15], v[192:195]
s_add_u32 m0, s31, s37
ds_read_b64_tr_b16 a[242:243], v240 offset:1536
v_mfma_f32_16x16x32_bf16 v[196:199], a[244:247], a[16:19], v[196:199]
s_waitcnt lgkmcnt(15)
ds_read_b64_tr_b16 a[244:245], v241 offset:0
ds_read_b64_tr_b16 a[246:247], v241 offset:1536
v_mfma_f32_16x16x32_bf16 v[200:203], a[248:251], a[0:3], v[200:203]
buffer_load_dwordx4 v245, s[12:15], s33 offen offset:0 nt lds
v_mfma_f32_16x16x32_bf16 v[204:207], a[248:251], a[4:7], v[204:207]
v_mfma_f32_16x16x32_bf16 v[208:211], a[248:251], a[8:11], v[208:211]
v_mfma_f32_16x16x32_bf16 v[212:215], a[248:251], a[12:15], v[212:215]
buffer_load_dwordx4 v246, s[12:15], s33 offen offset:1024 nt lds
v_mfma_f32_16x16x32_bf16 v[216:219], a[248:251], a[16:19], v[216:219]
s_waitcnt lgkmcnt(15)
ds_read_b64_tr_b16 a[248:249], v242 offset:0
ds_read_b64_tr_b16 a[250:251], v242 offset:1536
v_mfma_f32_16x16x32_bf16 a[60:63], a[252:255], a[0:3], a[60:63]
v_mfma_f32_16x16x32_bf16 a[64:67], a[252:255], a[4:7], a[64:67]
buffer_load_dwordx4 v247, s[12:15], s33 offen offset:2048 nt lds
v_mfma_f32_16x16x32_bf16 a[68:71], a[252:255], a[8:11], a[68:71]
s_add_u32 m0, m0, 3072
s_add_u32 s40, s33, 3072
v_mfma_f32_16x16x32_bf16 a[72:75], a[252:255], a[12:15], a[72:75]
v_mfma_f32_16x16x32_bf16 a[76:79], a[252:255], a[16:19], a[76:79]
s_waitcnt lgkmcnt(4)
ds_read_b64_tr_b16 a[252:253], v243 offset:0
ds_read_b64_tr_b16 a[254:255], v243 offset:1536
v_mfma_f32_16x16x32_bf16 v[0:3], a[240:243], a[20:23], v[0:3]
buffer_load_dwordx4 v245, s[12:15], s40 offen offset:0 nt lds
v_mfma_f32_16x16x32_bf16 v[4:7], a[240:243], a[24:27], v[4:7]
v_mfma_f32_16x16x32_bf16 v[8:11], a[240:243], a[28:31], v[8:11]
v_mfma_f32_16x16x32_bf16 v[12:15], a[240:243], a[32:35], v[12:15]
buffer_load_dwordx4 v246, s[12:15], s40 offen offset:1024 nt lds
v_mfma_f32_16x16x32_bf16 v[16:19], a[240:243], a[36:39], v[16:19]
s_waitcnt lgkmcnt(4)
ds_read_b64_tr_b16 a[240:241], v240 offset:128
ds_read_b64_tr_b16 a[242:243], v240 offset:1664
v_mfma_f32_16x16x32_bf16 v[20:23], a[244:247], a[20:23], v[20:23]
v_mfma_f32_16x16x32_bf16 v[24:27], a[244:247], a[24:27], v[24:27]
buffer_load_dwordx4 v247, s[12:15], s40 offen offset:2048 nt lds
v_mfma_f32_16x16x32_bf16 v[28:31], a[244:247], a[28:31], v[28:31]
s_add_u32 s33, s33, 12288
s_add_u32 s31, s31, 24576
s_sub_u32 s41, s31, 147456
v_mfma_f32_16x16x32_bf16 v[32:35], a[244:247], a[32:35], v[32:35]
s_min_u32 s31, s31, s41
s_add_u32 m0, s31, s37
v_mfma_f32_16x16x32_bf16 v[36:39], a[244:247], a[36:39], v[36:39]
s_waitcnt lgkmcnt(4)
ds_read_b64_tr_b16 a[244:245], v241 offset:128
ds_read_b64_tr_b16 a[246:247], v241 offset:1664
v_mfma_f32_16x16x32_bf16 v[40:43], a[248:251], a[20:23], v[40:43]
buffer_load_dwordx4 v245, s[12:15], s33 offen offset:0 nt lds
v_mfma_f32_16x16x32_bf16 v[44:47], a[248:251], a[24:27], v[44:47]
v_mfma_f32_16x16x32_bf16 v[48:51], a[248:251], a[28:31], v[48:51]
v_mfma_f32_16x16x32_bf16 v[52:55], a[248:251], a[32:35], v[52:55]
buffer_load_dwordx4 v246, s[12:15], s33 offen offset:1024 nt lds
v_mfma_f32_16x16x32_bf16 v[56:59], a[248:251], a[36:39], v[56:59]
s_waitcnt lgkmcnt(4)
ds_read_b64_tr_b16 a[248:249], v242 offset:128
ds_read_b64_tr_b16 a[250:251], v242 offset:1664
v_mfma_f32_16x16x32_bf16 v[60:63], a[252:255], a[20:23], v[60:63]
v_mfma_f32_16x16x32_bf16 v[64:67], a[252:255], a[24:27], v[64:67]
buffer_load_dwordx4 v247, s[12:15], s33 offen offset:2048 nt lds
v_mfma_f32_16x16x32_bf16 v[68:71], a[252:255], a[28:31], v[68:71]
s_add_u32 m0, m0, 3072
s_add_u32 s40, s33, 3072
v_mfma_f32_16x16x32_bf16 v[72:75], a[252:255], a[32:35], v[72:75]
v_mfma_f32_16x16x32_bf16 v[76:79], a[252:255], a[36:39], v[76:79]
s_waitcnt lgkmcnt(4)
ds_read_b64_tr_b16 a[252:253], v243 offset:128
ds_read_b64_tr_b16 a[254:255], v243 offset:1664
v_mfma_f32_16x16x32_bf16 v[80:83], a[240:243], a[20:23], v[80:83]
buffer_load_dwordx4 v245, s[12:15], s40 offen offset:0 nt lds
v_mfma_f32_16x16x32_bf16 v[84:87], a[240:243], a[24:27], v[84:87]
v_mfma_f32_16x16x32_bf16 v[88:91], a[240:243], a[28:31], v[88:91]
v_mfma_f32_16x16x32_bf16 v[92:95], a[240:243], a[32:35], v[92:95]
buffer_load_dwordx4 v246, s[12:15], s40 offen offset:1024 nt lds
v_mfma_f32_16x16x32_bf16 v[96:99], a[240:243], a[36:39], v[96:99]
s_waitcnt lgkmcnt(4)
ds_read_b64_tr_b16 a[240:241], v240 offset:256
ds_read_b64_tr_b16 a[242:243], v240 offset:1792
v_mfma_f32_16x16x32_bf16 v[100:103], a[244:247], a[20:23], v[100:103]
v_mfma_f32_16x16x32_bf16 v[104:107], a[244:247], a[24:27], v[104:107]
buffer_load_dwordx4 v247, s[12:15], s40 offen offset:2048 nt lds
v_mfma_f32_16x16x32_bf16 v[108:111], a[244:247], a[28:31], v[108:111]
s_add_u32 s33, s33, 12288
s_add_u32 s31, s31, 24576
s_sub_u32 s41, s31, 147456
v_mfma_f32_16x16x32_bf16 v[112:115], a[244:247], a[32:35], v[112:115]
s_min_u32 s31, s31, s41
v_mfma_f32_16x16x32_bf16 v[116:119], a[244:247], a[36:39], v[116:119]
s_waitcnt lgkmcnt(4)
ds_read_b64_tr_b16 a[244:245], v241 offset:256
ds_read_b64_tr_b16 a[246:247], v241 offset:1792
v_mfma_f32_16x16x32_bf16 v[120:123], a[248:251], a[20:23], v[120:123]
v_mfma_f32_16x16x32_bf16 v[124:127], a[248:251], a[24:27], v[124:127]
v_mfma_f32_16x16x32_bf16 v[128:131], a[248:251], a[28:31], v[128:131]
v_mfma_f32_16x16x32_bf16 v[132:135], a[248:251], a[32:35], v[132:135]
v_mfma_f32_16x16x32_bf16 v[136:139], a[248:251], a[36:39], v[136:139]
s_waitcnt lgkmcnt(4)
ds_read_b64_tr_b16 a[248:249], v242 offset:256
ds_read_b64_tr_b16 a[250:251], v242 offset:1792
v_mfma_f32_16x16x32_bf16 v[140:143], a[252:255], a[20:23], v[140:143]
v_mfma_f32_16x16x32_bf16 v[144:147], a[252:255], a[24:27], v[144:147]
v_mfma_f32_16x16x32_bf16 v[148:151], a[252:255], a[28:31], v[148:151]
v_mfma_f32_16x16x32_bf16 v[152:155], a[252:255], a[32:35], v[152:155]
v_mfma_f32_16x16x32_bf16 v[156:159], a[252:255], a[36:39], v[156:159]
s_waitcnt lgkmcnt(4)
ds_read_b64_tr_b16 a[252:253], v243 offset:256
ds_read_b64_tr_b16 a[254:255], v243 offset:1792
v_mfma_f32_16x16x32_bf16 v[160:163], a[240:243], a[20:23], v[160:163]
v_add_u32 v240, s32, v254
v_xor_b32 v241, 32, v240
v_mfma_f32_16x16x32_bf16 v[164:167], a[240:243], a[24:27], v[164:167]
v_xor_b32 v242, 64, v240
v_xor_b32 v243, 64, v241
v_mfma_f32_16x16x32_bf16 v[168:171], a[240:243], a[28:31], v[168:171]
s_add_u32 s32, s32, 24576
s_sub_u32 s42, s32, 147456
s_min_u32 s32, s32, s42
v_mfma_f32_16x16x32_bf16 v[172:175], a[240:243], a[32:35], v[172:175]
v_add_u32 v244, s32, v255
v_mfma_f32_16x16x32_bf16 v[176:179], a[240:243], a[36:39], v[176:179]
s_waitcnt lgkmcnt(4)
s_add_u32 s32, s32, 24576
s_sub_u32 s42, s32, 147456
v_mfma_f32_16x16x32_bf16 v[180:183], a[244:247], a[20:23], v[180:183]
s_min_u32 s32, s32, s42
v_mfma_f32_16x16x32_bf16 v[184:187], a[244:247], a[24:27], v[184:187]
v_mfma_f32_16x16x32_bf16 v[188:191], a[244:247], a[28:31], v[188:191]
s_waitcnt vmcnt(18) lgkmcnt(0)
s_barrier
ds_read_b64_tr_b16 a[240:241], v240 offset:0
v_mfma_f32_16x16x32_bf16 v[192:195], a[244:247], a[32:35], v[192:195]
s_add_u32 m0, s31, s37
ds_read_b64_tr_b16 a[242:243], v240 offset:1536
ds_read_b128 a[0:3], v244 offset:0
v_mfma_f32_16x16x32_bf16 v[196:199], a[244:247], a[36:39], v[196:199]
s_waitcnt lgkmcnt(15)
ds_read_b128 a[4:7], v244 offset:2048
ds_read_b128 a[8:11], v244 offset:4096
v_mfma_f32_16x16x32_bf16 v[200:203], a[248:251], a[20:23], v[200:203]
ds_read_b128 a[12:15], v244 offset:6144
ds_read_b128 a[16:19], v244 offset:8192
v_mfma_f32_16x16x32_bf16 v[204:207], a[248:251], a[24:27], v[204:207]
ds_read_b64_tr_b16 a[244:245], v241 offset:0
ds_read_b64_tr_b16 a[246:247], v241 offset:1536
v_mfma_f32_16x16x32_bf16 v[208:211], a[248:251], a[28:31], v[208:211]
buffer_load_dwordx4 v245, s[16:19], s34 offen offset:0 nt lds
v_mfma_f32_16x16x32_bf16 v[212:215], a[248:251], a[32:35], v[212:215]
v_mfma_f32_16x16x32_bf16 v[216:219], a[248:251], a[36:39], v[216:219]
s_waitcnt lgkmcnt(15)
ds_read_b64_tr_b16 a[248:249], v242 offset:0
ds_read_b64_tr_b16 a[250:251], v242 offset:1536
v_mfma_f32_16x16x32_bf16 a[60:63], a[252:255], a[20:23], a[60:63]
buffer_load_dwordx4 v246, s[16:19], s34 offen offset:1024 nt lds
v_mfma_f32_16x16x32_bf16 a[64:67], a[252:255], a[24:27], a[64:67]
v_mfma_f32_16x16x32_bf16 a[68:71], a[252:255], a[28:31], a[68:71]
v_mfma_f32_16x16x32_bf16 a[72:75], a[252:255], a[32:35], a[72:75]
buffer_load_dwordx4 v247, s[16:19], s34 offen offset:2048 nt lds
v_mfma_f32_16x16x32_bf16 a[76:79], a[252:255], a[36:39], a[76:79]
s_waitcnt lgkmcnt(4)
ds_read_b64_tr_b16 a[252:253], v243 offset:0
ds_read_b64_tr_b16 a[254:255], v243 offset:1536
v_mfma_f32_16x16x32_bf16 v[0:3], a[240:243], a[0:3], v[0:3]
s_add_u32 m0, m0, 3072
s_add_u32 s40, s34, 3072
v_mfma_f32_16x16x32_bf16 v[4:7], a[240:243], a[4:7], v[4:7]
buffer_load_dwordx4 v245, s[16:19], s40 offen offset:0 nt lds
v_mfma_f32_16x16x32_bf16 v[8:11], a[240:243], a[8:11], v[8:11]
v_mfma_f32_16x16x32_bf16 v[12:15], a[240:243], a[12:15], v[12:15]
v_mfma_f32_16x16x32_bf16 v[16:19], a[240:243], a[16:19], v[16:19]
s_waitcnt lgkmcnt(4)
ds_read_b64_tr_b16 a[240:241], v240 offset:128
ds_read_b64_tr_b16 a[242:243], v240 offset:1664
v_mfma_f32_16x16x32_bf16 v[20:23], a[244:247], a[0:3], v[20:23]
buffer_load_dwordx4 v246, s[16:19], s40 offen offset:1024 nt lds
v_mfma_f32_16x16x32_bf16 v[24:27], a[244:247], a[4:7], v[24:27]
v_mfma_f32_16x16x32_bf16 v[28:31], a[244:247], a[8:11], v[28:31]
v_mfma_f32_16x16x32_bf16 v[32:35], a[244:247], a[12:15], v[32:35]
buffer_load_dwordx4 v247, s[16:19], s40 offen offset:2048 nt lds
v_mfma_f32_16x16x32_bf16 v[36:39], a[244:247], a[16:19], v[36:39]
s_waitcnt lgkmcnt(4)
ds_read_b64_tr_b16 a[244:245], v241 offset:128
ds_read_b64_tr_b16 a[246:247], v241 offset:1664
v_mfma_f32_16x16x32_bf16 v[40:43], a[248:251], a[0:3], v[40:43]
s_add_u32 s34, s34, 12288
s_add_u32 s31, s31, 24576
s_sub_u32 s41, s31, 147456
v_mfma_f32_16x16x32_bf16 v[44:47], a[248:251], a[4:7], v[44:47]
s_min_u32 s31, s31, s41
v_mfma_f32_16x16x32_bf16 v[48:51], a[248:251], a[8:11], v[48:51]
v_mfma_f32_16x16x32_bf16 v[52:55], a[248:251], a[12:15], v[52:55]
v_mfma_f32_16x16x32_bf16 v[56:59], a[248:251], a[16:19], v[56:59]
s_waitcnt lgkmcnt(4)
ds_read_b64_tr_b16 a[248:249], v242 offset:128
ds_read_b64_tr_b16 a[250:251], v242 offset:1664
v_mfma_f32_16x16x32_bf16 v[60:63], a[252:255], a[0:3], v[60:63]
v_xor_b32 v244, 64, v244
v_mfma_f32_16x16x32_bf16 v[64:67], a[252:255], a[4:7], v[64:67]
ds_read_b128 a[20:23], v244 offset:0
ds_read_b128 a[24:27], v244 offset:2048
v_mfma_f32_16x16x32_bf16 v[68:71], a[252:255], a[8:11], v[68:71]
ds_read_b128 a[28:31], v244 offset:4096
ds_read_b128 a[32:35], v244 offset:6144
v_mfma_f32_16x16x32_bf16 v[72:75], a[252:255], a[12:15], v[72:75]
ds_read_b128 a[36:39], v244 offset:8192
v_mfma_f32_16x16x32_bf16 v[76:79], a[252:255], a[16:19], v[76:79]
s_waitcnt lgkmcnt(9)
ds_read_b64_tr_b16 a[252:253], v243 offset:128
ds_read_b64_tr_b16 a[254:255], v243 offset:1664
v_mfma_f32_16x16x32_bf16 v[80:83], a[240:243], a[0:3], v[80:83]
v_mfma_f32_16x16x32_bf16 v[84:87], a[240:243], a[4:7], v[84:87]
v_mfma_f32_16x16x32_bf16 v[88:91], a[240:243], a[8:11], v[88:91]
v_mfma_f32_16x16x32_bf16 v[92:95], a[240:243], a[12:15], v[92:95]
v_mfma_f32_16x16x32_bf16 v[96:99], a[240:243], a[16:19], v[96:99]
s_waitcnt lgkmcnt(9)
ds_read_b64_tr_b16 a[240:241], v240 offset:256
ds_read_b64_tr_b16 a[242:243], v240 offset:1792
v_mfma_f32_16x16x32_bf16 v[100:103], a[244:247], a[0:3], v[100:103]
v_mfma_f32_16x16x32_bf16 v[104:107], a[244:247], a[4:7], v[104:107]
v_mfma_f32_16x16x32_bf16 v[108:111], a[244:247], a[8:11], v[108:111]
v_mfma_f32_16x16x32_bf16 v[112:115], a[244:247], a[12:15], v[112:115]
v_mfma_f32_16x16x32_bf16 v[116:119], a[244:247], a[16:19], v[116:119]
s_waitcnt lgkmcnt(9)
ds_read_b64_tr_b16 a[244:245], v241 offset:256
ds_read_b64_tr_b16 a[246:247], v241 offset:1792
v_mfma_f32_16x16x32_bf16 v[120:123], a[248:251], a[0:3], v[120:123]
v_mfma_f32_16x16x32_bf16 v[124:127], a[248:251], a[4:7], v[124:127]
v_mfma_f32_16x16x32_bf16 v[128:131], a[248:251], a[8:11], v[128:131]
v_mfma_f32_16x16x32_bf16 v[132:135], a[248:251], a[12:15], v[132:135]
v_mfma_f32_16x16x32_bf16 v[136:139], a[248:251], a[16:19], v[136:139]
s_waitcnt lgkmcnt(4)
ds_read_b64_tr_b16 a[248:249], v242 offset:256
ds_read_b64_tr_b16 a[250:251], v242 offset:1792
v_mfma_f32_16x16x32_bf16 v[140:143], a[252:255], a[0:3], v[140:143]
v_mfma_f32_16x16x32_bf16 v[144:147], a[252:255], a[4:7], v[144:147]
v_mfma_f32_16x16x32_bf16 v[148:151], a[252:255], a[8:11], v[148:151]
v_mfma_f32_16x16x32_bf16 v[152:155], a[252:255], a[12:15], v[152:155]
v_mfma_f32_16x16x32_bf16 v[156:159], a[252:255], a[16:19], v[156:159]
s_waitcnt lgkmcnt(4)
ds_read_b64_tr_b16 a[252:253], v243 offset:256
ds_read_b64_tr_b16 a[254:255], v243 offset:1792
v_mfma_f32_16x16x32_bf16 v[160:163], a[240:243], a[0:3], v[160:163]
v_add_u32 v240, s32, v254
v_xor_b32 v241, 32, v240
v_mfma_f32_16x16x32_bf16 v[164:167], a[240:243], a[4:7], v[164:167]
v_xor_b32 v242, 64, v240
v_xor_b32 v243, 64, v241
v_mfma_f32_16x16x32_bf16 v[168:171], a[240:243], a[8:11], v[168:171]
s_add_u32 s32, s32, 24576
s_sub_u32 s42, s32, 147456
s_min_u32 s32, s32, s42
v_mfma_f32_16x16x32_bf16 v[172:175], a[240:243], a[12:15], v[172:175]
v_mfma_f32_16x16x32_bf16 v[176:179], a[240:243], a[16:19], v[176:179]
s_waitcnt lgkmcnt(4)
v_mfma_f32_16x16x32_bf16 v[180:183], a[244:247], a[0:3], v[180:183]
v_mfma_f32_16x16x32_bf16 v[184:187], a[244:247], a[4:7], v[184:187]
v_mfma_f32_16x16x32_bf16 v[188:191], a[244:247], a[8:11], v[188:191]
s_waitcnt vmcnt(18) lgkmcnt(0)
s_barrier
ds_read_b64_tr_b16 a[240:241], v240 offset:0
v_mfma_f32_16x16x32_bf16 v[192:195], a[244:247], a[12:15], v[192:195]
s_add_u32 m0, s31, s37
ds_read_b64_tr_b16 a[242:243], v240 offset:1536
v_mfma_f32_16x16x32_bf16 v[196:199], a[244:247], a[16:19], v[196:199]
s_waitcnt lgkmcnt(15)
ds_read_b64_tr_b16 a[244:245], v241 offset:0
ds_read_b64_tr_b16 a[246:247], v241 offset:1536
v_mfma_f32_16x16x32_bf16 v[200:203], a[248:251], a[0:3], v[200:203]
buffer_load_dwordx4 v245, s[12:15], s33 offen offset:0 nt lds
v_mfma_f32_16x16x32_bf16 v[204:207], a[248:251], a[4:7], v[204:207]
v_mfma_f32_16x16x32_bf16 v[208:211], a[248:251], a[8:11], v[208:211]
v_mfma_f32_16x16x32_bf16 v[212:215], a[248:251], a[12:15], v[212:215]
buffer_load_dwordx4 v246, s[12:15], s33 offen offset:1024 nt lds
v_mfma_f32_16x16x32_bf16 v[216:219], a[248:251], a[16:19], v[216:219]
s_waitcnt lgkmcnt(15)
ds_read_b64_tr_b16 a[248:249], v242 offset:0
ds_read_b64_tr_b16 a[250:251], v242 offset:1536
v_mfma_f32_16x16x32_bf16 a[60:63], a[252:255], a[0:3], a[60:63]
v_mfma_f32_16x16x32_bf16 a[64:67], a[252:255], a[4:7], a[64:67]
buffer_load_dwordx4 v247, s[12:15], s33 offen offset:2048 nt lds
v_mfma_f32_16x16x32_bf16 a[68:71], a[252:255], a[8:11], a[68:71]
s_add_u32 m0, m0, 3072
s_add_u32 s40, s33, 3072
v_mfma_f32_16x16x32_bf16 a[72:75], a[252:255], a[12:15], a[72:75]
v_mfma_f32_16x16x32_bf16 a[76:79], a[252:255], a[16:19], a[76:79]
s_waitcnt lgkmcnt(4)
ds_read_b64_tr_b16 a[252:253], v243 offset:0
ds_read_b64_tr_b16 a[254:255], v243 offset:1536
v_mfma_f32_16x16x32_bf16 v[0:3], a[240:243], a[20:23], v[0:3]
buffer_load_dwordx4 v245, s[12:15], s40 offen offset:0 nt lds
v_mfma_f32_16x16x32_bf16 v[4:7], a[240:243], a[24:27], v[4:7]
v_mfma_f32_16x16x32_bf16 v[8:11], a[240:243], a[28:31], v[8:11]
v_mfma_f32_16x16x32_bf16 v[12:15], a[240:243], a[32:35], v[12:15]
buffer_load_dwordx4 v246, s[12:15], s40 offen offset:1024 nt lds
v_mfma_f32_16x16x32_bf16 v[16:19], a[240:243], a[36:39], v[16:19]
s_waitcnt lgkmcnt(4)
ds_read_b64_tr_b16 a[240:241], v240 offset:128
ds_read_b64_tr_b16 a[242:243], v240 offset:1664
v_mfma_f32_16x16x32_bf16 v[20:23], a[244:247], a[20:23], v[20:23]
v_mfma_f32_16x16x32_bf16 v[24:27], a[244:247], a[24:27], v[24:27]
buffer_load_dwordx4 v247, s[12:15], s40 offen offset:2048 nt lds
v_mfma_f32_16x16x32_bf16 v[28:31], a[244:247], a[28:31], v[28:31]
s_add_u32 s33, s33, 12288
s_add_u32 s31, s31, 24576
s_sub_u32 s41, s31, 147456
v_mfma_f32_16x16x32_bf16 v[32:35], a[244:247], a[32:35], v[32:35]
s_min_u32 s31, s31, s41
s_add_u32 m0, s31, s37
v_mfma_f32_16x16x32_bf16 v[36:39], a[244:247], a[36:39], v[36:39]
s_waitcnt lgkmcnt(4)
ds_read_b64_tr_b16 a[244:245], v241 offset:128
ds_read_b64_tr_b16 a[246:247], v241 offset:1664
v_mfma_f32_16x16x32_bf16 v[40:43], a[248:251], a[20:23], v[40:43]
buffer_load_dwordx4 v245, s[16:19], s34 offen offset:0 nt lds
v_mfma_f32_16x16x32_bf16 v[44:47], a[248:251], a[24:27], v[44:47]
v_mfma_f32_16x16x32_bf16 v[48:51], a[248:251], a[28:31], v[48:51]
v_mfma_f32_16x16x32_bf16 v[52:55], a[248:251], a[32:35], v[52:55]
buffer_load_dwordx4 v246, s[16:19], s34 offen offset:1024 nt lds
v_mfma_f32_16x16x32_bf16 v[56:59], a[248:251], a[36:39], v[56:59]
s_waitcnt lgkmcnt(4)
ds_read_b64_tr_b16 a[248:249], v242 offset:128
ds_read_b64_tr_b16 a[250:251], v242 offset:1664
v_mfma_f32_16x16x32_bf16 v[60:63], a[252:255], a[20:23], v[60:63]
v_mfma_f32_16x16x32_bf16 v[64:67], a[252:255], a[24:27], v[64:67]
buffer_load_dwordx4 v247, s[16:19], s34 offen offset:2048 nt lds
v_mfma_f32_16x16x32_bf16 v[68:71], a[252:255], a[28:31], v[68:71]
s_add_u32 m0, m0, 3072
s_add_u32 s40, s34, 3072
v_mfma_f32_16x16x32_bf16 v[72:75], a[252:255], a[32:35], v[72:75]
v_mfma_f32_16x16x32_bf16 v[76:79], a[252:255], a[36:39], v[76:79]
s_waitcnt lgkmcnt(4)
ds_read_b64_tr_b16 a[252:253], v243 offset:128
ds_read_b64_tr_b16 a[254:255], v243 offset:1664
v_mfma_f32_16x16x32_bf16 v[80:83], a[240:243], a[20:23], v[80:83]
buffer_load_dwordx4 v245, s[16:19], s40 offen offset:0 nt lds
v_mfma_f32_16x16x32_bf16 v[84:87], a[240:243], a[24:27], v[84:87]
v_mfma_f32_16x16x32_bf16 v[88:91], a[240:243], a[28:31], v[88:91]
v_mfma_f32_16x16x32_bf16 v[92:95], a[240:243], a[32:35], v[92:95]
buffer_load_dwordx4 v246, s[16:19], s40 offen offset:1024 nt lds
v_mfma_f32_16x16x32_bf16 v[96:99], a[240:243], a[36:39], v[96:99]
s_waitcnt lgkmcnt(4)
ds_read_b64_tr_b16 a[240:241], v240 offset:256
ds_read_b64_tr_b16 a[242:243], v240 offset:1792
v_mfma_f32_16x16x32_bf16 v[100:103], a[244:247], a[20:23], v[100:103]
v_mfma_f32_16x16x32_bf16 v[104:107], a[244:247], a[24:27], v[104:107]
buffer_load_dwordx4 v247, s[16:19], s40 offen offset:2048 nt lds
v_mfma_f32_16x16x32_bf16 v[108:111], a[244:247], a[28:31], v[108:111]
s_add_u32 s34, s34, 12288
s_add_u32 s31, s31, 24576
s_sub_u32 s41, s31, 147456
v_mfma_f32_16x16x32_bf16 v[112:115], a[244:247], a[32:35], v[112:115]
s_min_u32 s31, s31, s41
v_mfma_f32_16x16x32_bf16 v[116:119], a[244:247], a[36:39], v[116:119]
s_waitcnt lgkmcnt(4)
ds_read_b64_tr_b16 a[244:245], v241 offset:256
ds_read_b64_tr_b16 a[246:247], v241 offset:1792
v_mfma_f32_16x16x32_bf16 v[120:123], a[248:251], a[20:23], v[120:123]
v_mfma_f32_16x16x32_bf16 v[124:127], a[248:251], a[24:27], v[124:127]
v_mfma_f32_16x16x32_bf16 v[128:131], a[248:251], a[28:31], v[128:131]
v_mfma_f32_16x16x32_bf16 v[132:135], a[248:251], a[32:35], v[132:135]
v_mfma_f32_16x16x32_bf16 v[136:139], a[248:251], a[36:39], v[136:139]
s_waitcnt lgkmcnt(4)
ds_read_b64_tr_b16 a[248:249], v242 offset:256
ds_read_b64_tr_b16 a[250:251], v242 offset:1792
v_mfma_f32_16x16x32_bf16 v[140:143], a[252:255], a[20:23], v[140:143]
v_mfma_f32_16x16x32_bf16 v[144:147], a[252:255], a[24:27], v[144:147]
v_mfma_f32_16x16x32_bf16 v[148:151], a[252:255], a[28:31], v[148:151]
v_mfma_f32_16x16x32_bf16 v[152:155], a[252:255], a[32:35], v[152:155]
v_mfma_f32_16x16x32_bf16 v[156:159], a[252:255], a[36:39], v[156:159]
s_waitcnt lgkmcnt(4)
ds_read_b64_tr_b16 a[252:253], v243 offset:256
ds_read_b64_tr_b16 a[254:255], v243 offset:1792
v_mfma_f32_16x16x32_bf16 v[160:163], a[240:243], a[20:23], v[160:163]
v_mfma_f32_16x16x32_bf16 v[164:167], a[240:243], a[24:27], v[164:167]
v_mfma_f32_16x16x32_bf16 v[168:171], a[240:243], a[28:31], v[168:171]
v_mfma_f32_16x16x32_bf16 v[172:175], a[240:243], a[32:35], v[172:175]
v_mfma_f32_16x16x32_bf16 v[176:179], a[240:243], a[36:39], v[176:179]
s_waitcnt lgkmcnt(4)
v_mfma_f32_16x16x32_bf16 v[180:183], a[244:247], a[20:23], v[180:183]
v_mfma_f32_16x16x32_bf16 v[184:187], a[244:247], a[24:27], v[184:187]
v_mfma_f32_16x16x32_bf16 v[188:191], a[244:247], a[28:31], v[188:191]
v_mfma_f32_16x16x32_bf16 v[192:195], a[244:247], a[32:35], v[192:195]
v_mfma_f32_16x16x32_bf16 v[196:199], a[244:247], a[36:39], v[196:199]
s_waitcnt lgkmcnt(2)
v_mfma_f32_16x16x32_bf16 v[200:203], a[248:251], a[20:23], v[200:203]
v_mfma_f32_16x16x32_bf16 v[204:207], a[248:251], a[24:27], v[204:207]
v_mfma_f32_16x16x32_bf16 v[208:211], a[248:251], a[28:31], v[208:211]
v_mfma_f32_16x16x32_bf16 v[212:215], a[248:251], a[32:35], v[212:215]
v_mfma_f32_16x16x32_bf16 v[216:219], a[248:251], a[36:39], v[216:219]
s_waitcnt lgkmcnt(0)
v_mfma_f32_16x16x32_bf16 a[60:63], a[252:255], a[20:23], a[60:63]
v_mfma_f32_16x16x32_bf16 a[64:67], a[252:255], a[24:27], a[64:67]
v_mfma_f32_16x16x32_bf16 a[68:71], a[252:255], a[28:31], a[68:71]
v_mfma_f32_16x16x32_bf16 a[72:75], a[252:255], a[32:35], a[72:75]
v_mfma_f32_16x16x32_bf16 a[76:79], a[252:255], a[36:39], a[76:79]
s_nop 7
v_pk_mul_f32 v[0:1], v[0:1], s[46:47] op_sel_hi:[1,0]
v_pk_mul_f32 v[2:3], v[2:3], s[46:47] op_sel_hi:[1,0]
v_pk_mul_f32 v[20:21], v[20:21], s[46:47] op_sel_hi:[1,0]
v_pk_mul_f32 v[22:23], v[22:23], s[46:47] op_sel_hi:[1,0]
v_cvt_pk_bf16_f32 v0, v0, v1
v_cvt_pk_bf16_f32 v1, v2, v3
v_cvt_pk_bf16_f32 v2, v20, v21
v_cvt_pk_bf16_f32 v3, v22, v23
v_pk_mul_f32 v[4:5], v[4:5], s[46:47] op_sel_hi:[1,0]
v_pk_mul_f32 v[6:7], v[6:7], s[46:47] op_sel_hi:[1,0]
v_pk_mul_f32 v[24:25], v[24:25], s[46:47] op_sel_hi:[1,0]
v_pk_mul_f32 v[26:27], v[26:27], s[46:47] op_sel_hi:[1,0]
v_cvt_pk_bf16_f32 v4, v4, v5
v_cvt_pk_bf16_f32 v5, v6, v7
v_cvt_pk_bf16_f32 v6, v24, v25
v_cvt_pk_bf16_f32 v7, v26, v27
v_permlane16_swap_b32 v0, v2
v_permlane16_swap_b32 v1, v3
v_pk_mul_f32 v[8:9], v[8:9], s[46:47] op_sel_hi:[1,0]
v_pk_mul_f32 v[10:11], v[10:11], s[46:47] op_sel_hi:[1,0]
v_pk_mul_f32 v[28:29], v[28:29], s[46:47] op_sel_hi:[1,0]
v_pk_mul_f32 v[30:31], v[30:31], s[46:47] op_sel_hi:[1,0]
v_cvt_pk_bf16_f32 v8, v8, v9
v_cvt_pk_bf16_f32 v9, v10, v11
v_cvt_pk_bf16_f32 v10, v28, v29
v_cvt_pk_bf16_f32 v11, v30, v31
v_permlane16_swap_b32 v4, v6
v_permlane16_swap_b32 v5, v7
v_pk_mul_f32 v[12:13], v[12:13], s[46:47] op_sel_hi:[1,0]
v_pk_mul_f32 v[14:15], v[14:15], s[46:47] op_sel_hi:[1,0]
v_pk_mul_f32 v[32:33], v[32:33], s[46:47] op_sel_hi:[1,0]
v_pk_mul_f32 v[34:35], v[34:35], s[46:47] op_sel_hi:[1,0]
v_cvt_pk_bf16_f32 v12, v12, v13
v_cvt_pk_bf16_f32 v13, v14, v15
v_cvt_pk_bf16_f32 v14, v32, v33
v_cvt_pk_bf16_f32 v15, v34, v35
v_permlane16_swap_b32 v8, v10
v_permlane16_swap_b32 v9, v11
v_pk_mul_f32 v[16:17], v[16:17], s[46:47] op_sel_hi:[1,0]
v_pk_mul_f32 v[18:19], v[18:19], s[46:47] op_sel_hi:[1,0]
v_pk_mul_f32 v[36:37], v[36:37], s[46:47] op_sel_hi:[1,0]
v_pk_mul_f32 v[38:39], v[38:39], s[46:47] op_sel_hi:[1,0]
v_cvt_pk_bf16_f32 v16, v16, v17
v_cvt_pk_bf16_f32 v17, v18, v19
v_cvt_pk_bf16_f32 v18, v36, v37
v_cvt_pk_bf16_f32 v19, v38, v39
v_permlane16_swap_b32 v12, v14
v_permlane16_swap_b32 v13, v15
v_pk_mul_f32 v[40:41], v[40:41], s[46:47] op_sel_hi:[1,0]
v_pk_mul_f32 v[42:43], v[42:43], s[46:47] op_sel_hi:[1,0]
v_pk_mul_f32 v[60:61], v[60:61], s[46:47] op_sel_hi:[1,0]
v_pk_mul_f32 v[62:63], v[62:63], s[46:47] op_sel_hi:[1,0]
v_cvt_pk_bf16_f32 v20, v40, v41
v_cvt_pk_bf16_f32 v21, v42, v43
v_cvt_pk_bf16_f32 v22, v60, v61
v_cvt_pk_bf16_f32 v23, v62, v63
v_permlane16_swap_b32 v16, v18
v_permlane16_swap_b32 v17, v19
v_pk_mul_f32 v[44:45], v[44:45], s[46:47] op_sel_hi:[1,0]
v_pk_mul_f32 v[46:47], v[46:47], s[46:47] op_sel_hi:[1,0]
v_pk_mul_f32 v[64:65], v[64:65], s[46:47] op_sel_hi:[1,0]
v_pk_mul_f32 v[66:67], v[66:67], s[46:47] op_sel_hi:[1,0]
v_cvt_pk_bf16_f32 v24, v44, v45
v_cvt_pk_bf16_f32 v25, v46, v47
v_cvt_pk_bf16_f32 v26, v64, v65
v_cvt_pk_bf16_f32 v27, v66, v67
v_permlane16_swap_b32 v20, v22
v_permlane16_swap_b32 v21, v23
v_pk_mul_f32 v[48:49], v[48:49], s[46:47] op_sel_hi:[1,0]
v_pk_mul_f32 v[50:51], v[50:51], s[46:47] op_sel_hi:[1,0]
v_pk_mul_f32 v[68:69], v[68:69], s[46:47] op_sel_hi:[1,0]
v_pk_mul_f32 v[70:71], v[70:71], s[46:47] op_sel_hi:[1,0]
v_cvt_pk_bf16_f32 v28, v48, v49
v_cvt_pk_bf16_f32 v29, v50, v51
v_cvt_pk_bf16_f32 v30, v68, v69
v_cvt_pk_bf16_f32 v31, v70, v71
v_permlane16_swap_b32 v24, v26
v_permlane16_swap_b32 v25, v27
v_pk_mul_f32 v[52:53], v[52:53], s[46:47] op_sel_hi:[1,0]
v_pk_mul_f32 v[54:55], v[54:55], s[46:47] op_sel_hi:[1,0]
v_pk_mul_f32 v[72:73], v[72:73], s[46:47] op_sel_hi:[1,0]
v_pk_mul_f32 v[74:75], v[74:75], s[46:47] op_sel_hi:[1,0]
v_cvt_pk_bf16_f32 v32, v52, v53
v_cvt_pk_bf16_f32 v33, v54, v55
v_cvt_pk_bf16_f32 v34, v72, v73
v_cvt_pk_bf16_f32 v35, v74, v75
v_permlane16_swap_b32 v28, v30
v_permlane16_swap_b32 v29, v31
v_pk_mul_f32 v[56:57], v[56:57], s[46:47] op_sel_hi:[1,0]
v_pk_mul_f32 v[58:59], v[58:59], s[46:47] op_sel_hi:[1,0]
v_pk_mul_f32 v[76:77], v[76:77], s[46:47] op_sel_hi:[1,0]
v_pk_mul_f32 v[78:79], v[78:79], s[46:47] op_sel_hi:[1,0]
v_cvt_pk_bf16_f32 v36, v56, v57
v_cvt_pk_bf16_f32 v37, v58, v59
v_cvt_pk_bf16_f32 v38, v76, v77
v_cvt_pk_bf16_f32 v39, v78, v79
v_permlane16_swap_b32 v32, v34
v_permlane16_swap_b32 v33, v35
v_pk_mul_f32 v[80:81], v[80:81], s[46:47] op_sel_hi:[1,0]
v_pk_mul_f32 v[82:83], v[82:83], s[46:47] op_sel_hi:[1,0]
v_pk_mul_f32 v[100:101], v[100:101], s[46:47] op_sel_hi:[1,0]
v_pk_mul_f32 v[102:103], v[102:103], s[46:47] op_sel_hi:[1,0]
v_cvt_pk_bf16_f32 v40, v80, v81
v_cvt_pk_bf16_f32 v41, v82, v83
v_cvt_pk_bf16_f32 v42, v100, v101
v_cvt_pk_bf16_f32 v43, v102, v103
v_permlane16_swap_b32 v36, v38
v_permlane16_swap_b32 v37, v39
v_pk_mul_f32 v[84:85], v[84:85], s[46:47] op_sel_hi:[1,0]
v_pk_mul_f32 v[86:87], v[86:87], s[46:47] op_sel_hi:[1,0]
v_pk_mul_f32 v[104:105], v[104:105], s[46:47] op_sel_hi:[1,0]
v_pk_mul_f32 v[106:107], v[106:107], s[46:47] op_sel_hi:[1,0]
v_cvt_pk_bf16_f32 v44, v84, v85
v_cvt_pk_bf16_f32 v45, v86, v87
v_cvt_pk_bf16_f32 v46, v104, v105
v_cvt_pk_bf16_f32 v47, v106, v107
v_permlane16_swap_b32 v40, v42
v_permlane16_swap_b32 v41, v43
v_pk_mul_f32 v[88:89], v[88:89], s[46:47] op_sel_hi:[1,0]
v_pk_mul_f32 v[90:91], v[90:91], s[46:47] op_sel_hi:[1,0]
v_pk_mul_f32 v[108:109], v[108:109], s[46:47] op_sel_hi:[1,0]
v_pk_mul_f32 v[110:111], v[110:111], s[46:47] op_sel_hi:[1,0]
v_cvt_pk_bf16_f32 v48, v88, v89
v_cvt_pk_bf16_f32 v49, v90, v91
v_cvt_pk_bf16_f32 v50, v108, v109
v_cvt_pk_bf16_f32 v51, v110, v111
v_permlane16_swap_b32 v44, v46
v_permlane16_swap_b32 v45, v47
v_pk_mul_f32 v[92:93], v[92:93], s[46:47] op_sel_hi:[1,0]
v_pk_mul_f32 v[94:95], v[94:95], s[46:47] op_sel_hi:[1,0]
v_pk_mul_f32 v[112:113], v[112:113], s[46:47] op_sel_hi:[1,0]
v_pk_mul_f32 v[114:115], v[114:115], s[46:47] op_sel_hi:[1,0]
v_cvt_pk_bf16_f32 v52, v92, v93
v_cvt_pk_bf16_f32 v53, v94, v95
v_cvt_pk_bf16_f32 v54, v112, v113
v_cvt_pk_bf16_f32 v55, v114, v115
v_permlane16_swap_b32 v48, v50
v_permlane16_swap_b32 v49, v51
v_pk_mul_f32 v[96:97], v[96:97], s[46:47] op_sel_hi:[1,0]
v_pk_mul_f32 v[98:99], v[98:99], s[46:47] op_sel_hi:[1,0]
v_pk_mul_f32 v[116:117], v[116:117], s[46:47] op_sel_hi:[1,0]
v_pk_mul_f32 v[118:119], v[118:119], s[46:47] op_sel_hi:[1,0]
v_cvt_pk_bf16_f32 v56, v96, v97
v_cvt_pk_bf16_f32 v57, v98, v99
v_cvt_pk_bf16_f32 v58, v116, v117
v_cvt_pk_bf16_f32 v59, v118, v119
v_permlane16_swap_b32 v52, v54
v_permlane16_swap_b32 v53, v55
v_pk_mul_f32 v[120:121], v[120:121], s[46:47] op_sel_hi:[1,0]
v_pk_mul_f32 v[122:123], v[122:123], s[46:47] op_sel_hi:[1,0]
v_pk_mul_f32 v[140:141], v[140:141], s[46:47] op_sel_hi:[1,0]
v_pk_mul_f32 v[142:143], v[142:143], s[46:47] op_sel_hi:[1,0]
v_cvt_pk_bf16_f32 v60, v120, v121
v_cvt_pk_bf16_f32 v61, v122, v123
v_cvt_pk_bf16_f32 v62, v140, v141
v_cvt_pk_bf16_f32 v63, v142, v143
v_permlane16_swap_b32 v56, v58
v_permlane16_swap_b32 v57, v59
v_pk_mul_f32 v[124:125], v[124:125], s[46:47] op_sel_hi:[1,0]
v_pk_mul_f32 v[126:127], v[126:127], s[46:47] op_sel_hi:[1,0]
v_pk_mul_f32 v[144:145], v[144:145], s[46:47] op_sel_hi:[1,0]
v_pk_mul_f32 v[146:147], v[146:147], s[46:47] op_sel_hi:[1,0]
v_cvt_pk_bf16_f32 v64, v124, v125
v_cvt_pk_bf16_f32 v65, v126, v127
v_cvt_pk_bf16_f32 v66, v144, v145
v_cvt_pk_bf16_f32 v67, v146, v147
v_permlane16_swap_b32 v60, v62
v_permlane16_swap_b32 v61, v63
v_pk_mul_f32 v[128:129], v[128:129], s[46:47] op_sel_hi:[1,0]
v_pk_mul_f32 v[130:131], v[130:131], s[46:47] op_sel_hi:[1,0]
v_pk_mul_f32 v[148:149], v[148:149], s[46:47] op_sel_hi:[1,0]
v_pk_mul_f32 v[150:151], v[150:151], s[46:47] op_sel_hi:[1,0]
v_cvt_pk_bf16_f32 v68, v128, v129
v_cvt_pk_bf16_f32 v69, v130, v131
v_cvt_pk_bf16_f32 v70, v148, v149
v_cvt_pk_bf16_f32 v71, v150, v151
v_permlane16_swap_b32 v64, v66
v_permlane16_swap_b32 v65, v67
v_pk_mul_f32 v[132:133], v[132:133], s[46:47] op_sel_hi:[1,0]
v_pk_mul_f32 v[134:135], v[134:135], s[46:47] op_sel_hi:[1,0]
v_pk_mul_f32 v[152:153], v[152:153], s[46:47] op_sel_hi:[1,0]
v_pk_mul_f32 v[154:155], v[154:155], s[46:47] op_sel_hi:[1,0]
v_cvt_pk_bf16_f32 v72, v132, v133
v_cvt_pk_bf16_f32 v73, v134, v135
v_cvt_pk_bf16_f32 v74, v152, v153
v_cvt_pk_bf16_f32 v75, v154, v155
v_permlane16_swap_b32 v68, v70
v_permlane16_swap_b32 v69, v71
v_pk_mul_f32 v[136:137], v[136:137], s[46:47] op_sel_hi:[1,0]
v_pk_mul_f32 v[138:139], v[138:139], s[46:47] op_sel_hi:[1,0]
v_pk_mul_f32 v[156:157], v[156:157], s[46:47] op_sel_hi:[1,0]
v_pk_mul_f32 v[158:159], v[158:159], s[46:47] op_sel_hi:[1,0]
v_cvt_pk_bf16_f32 v76, v136, v137
v_cvt_pk_bf16_f32 v77, v138, v139
v_cvt_pk_bf16_f32 v78, v156, v157
v_cvt_pk_bf16_f32 v79, v158, v159
v_permlane16_swap_b32 v72, v74
v_permlane16_swap_b32 v73, v75
v_pk_mul_f32 v[160:161], v[160:161], s[46:47] op_sel_hi:[1,0]
v_pk_mul_f32 v[162:163], v[162:163], s[46:47] op_sel_hi:[1,0]
v_pk_mul_f32 v[180:181], v[180:181], s[46:47] op_sel_hi:[1,0]
v_pk_mul_f32 v[182:183], v[182:183], s[46:47] op_sel_hi:[1,0]
v_cvt_pk_bf16_f32 v80, v160, v161
v_cvt_pk_bf16_f32 v81, v162, v163
v_cvt_pk_bf16_f32 v82, v180, v181
v_cvt_pk_bf16_f32 v83, v182, v183
v_permlane16_swap_b32 v76, v78
v_permlane16_swap_b32 v77, v79
v_pk_mul_f32 v[164:165], v[164:165], s[46:47] op_sel_hi:[1,0]
v_pk_mul_f32 v[166:167], v[166:167], s[46:47] op_sel_hi:[1,0]
v_pk_mul_f32 v[184:185], v[184:185], s[46:47] op_sel_hi:[1,0]
v_pk_mul_f32 v[186:187], v[186:187], s[46:47] op_sel_hi:[1,0]
v_cvt_pk_bf16_f32 v84, v164, v165
v_cvt_pk_bf16_f32 v85, v166, v167
v_cvt_pk_bf16_f32 v86, v184, v185
v_cvt_pk_bf16_f32 v87, v186, v187
v_permlane16_swap_b32 v80, v82
v_permlane16_swap_b32 v81, v83
v_pk_mul_f32 v[168:169], v[168:169], s[46:47] op_sel_hi:[1,0]
v_pk_mul_f32 v[170:171], v[170:171], s[46:47] op_sel_hi:[1,0]
v_pk_mul_f32 v[188:189], v[188:189], s[46:47] op_sel_hi:[1,0]
v_pk_mul_f32 v[190:191], v[190:191], s[46:47] op_sel_hi:[1,0]
v_cvt_pk_bf16_f32 v88, v168, v169
v_cvt_pk_bf16_f32 v89, v170, v171
v_cvt_pk_bf16_f32 v90, v188, v189
v_cvt_pk_bf16_f32 v91, v190, v191
v_permlane16_swap_b32 v84, v86
v_permlane16_swap_b32 v85, v87
v_pk_mul_f32 v[172:173], v[172:173], s[46:47] op_sel_hi:[1,0]
v_pk_mul_f32 v[174:175], v[174:175], s[46:47] op_sel_hi:[1,0]
v_pk_mul_f32 v[192:193], v[192:193], s[46:47] op_sel_hi:[1,0]
v_pk_mul_f32 v[194:195], v[194:195], s[46:47] op_sel_hi:[1,0]
v_cvt_pk_bf16_f32 v92, v172, v173
v_cvt_pk_bf16_f32 v93, v174, v175
v_cvt_pk_bf16_f32 v94, v192, v193
v_cvt_pk_bf16_f32 v95, v194, v195
v_permlane16_swap_b32 v88, v90
v_permlane16_swap_b32 v89, v91
v_pk_mul_f32 v[176:177], v[176:177], s[46:47] op_sel_hi:[1,0]
v_pk_mul_f32 v[178:179], v[178:179], s[46:47] op_sel_hi:[1,0]
v_pk_mul_f32 v[196:197], v[196:197], s[46:47] op_sel_hi:[1,0]
v_pk_mul_f32 v[198:199], v[198:199], s[46:47] op_sel_hi:[1,0]
v_cvt_pk_bf16_f32 v96, v176, v177
v_cvt_pk_bf16_f32 v97, v178, v179
v_cvt_pk_bf16_f32 v98, v196, v197
v_cvt_pk_bf16_f32 v99, v198, v199
v_permlane16_swap_b32 v92, v94
v_permlane16_swap_b32 v93, v95
v_accvgpr_read_b32 v226, a60
v_accvgpr_read_b32 v227, a61
v_accvgpr_read_b32 v228, a62
v_accvgpr_read_b32 v229, a63
v_pk_mul_f32 v[200:201], v[200:201], s[46:47] op_sel_hi:[1,0]
v_pk_mul_f32 v[202:203], v[202:203], s[46:47] op_sel_hi:[1,0]
v_pk_mul_f32 v[226:227], v[226:227], s[46:47] op_sel_hi:[1,0]
v_pk_mul_f32 v[228:229], v[228:229], s[46:47] op_sel_hi:[1,0]
v_cvt_pk_bf16_f32 v100, v200, v201
v_cvt_pk_bf16_f32 v101, v202, v203
v_cvt_pk_bf16_f32 v102, v226, v227
v_cvt_pk_bf16_f32 v103, v228, v229
v_permlane16_swap_b32 v96, v98
v_permlane16_swap_b32 v97, v99
v_accvgpr_read_b32 v230, a64
v_accvgpr_read_b32 v231, a65
v_accvgpr_read_b32 v232, a66
v_accvgpr_read_b32 v233, a67
v_pk_mul_f32 v[204:205], v[204:205], s[46:47] op_sel_hi:[1,0]
v_pk_mul_f32 v[206:207], v[206:207], s[46:47] op_sel_hi:[1,0]
v_pk_mul_f32 v[230:231], v[230:231], s[46:47] op_sel_hi:[1,0]
v_pk_mul_f32 v[232:233], v[232:233], s[46:47] op_sel_hi:[1,0]
v_cvt_pk_bf16_f32 v104, v204, v205
v_cvt_pk_bf16_f32 v105, v206, v207
v_cvt_pk_bf16_f32 v106, v230, v231
v_cvt_pk_bf16_f32 v107, v232, v233
v_permlane16_swap_b32 v100, v102
v_permlane16_swap_b32 v101, v103
v_accvgpr_read_b32 v226, a68
v_accvgpr_read_b32 v227, a69
v_accvgpr_read_b32 v228, a70
v_accvgpr_read_b32 v229, a71
v_pk_mul_f32 v[208:209], v[208:209], s[46:47] op_sel_hi:[1,0]
v_pk_mul_f32 v[210:211], v[210:211], s[46:47] op_sel_hi:[1,0]
v_pk_mul_f32 v[226:227], v[226:227], s[46:47] op_sel_hi:[1,0]
v_pk_mul_f32 v[228:229], v[228:229], s[46:47] op_sel_hi:[1,0]
v_cvt_pk_bf16_f32 v108, v208, v209
v_cvt_pk_bf16_f32 v109, v210, v211
v_cvt_pk_bf16_f32 v110, v226, v227
v_cvt_pk_bf16_f32 v111, v228, v229
v_permlane16_swap_b32 v104, v106
v_permlane16_swap_b32 v105, v107
v_accvgpr_read_b32 v230, a72
v_accvgpr_read_b32 v231, a73
v_accvgpr_read_b32 v232, a74
v_accvgpr_read_b32 v233, a75
v_pk_mul_f32 v[212:213], v[212:213], s[46:47] op_sel_hi:[1,0]
v_pk_mul_f32 v[214:215], v[214:215], s[46:47] op_sel_hi:[1,0]
v_pk_mul_f32 v[230:231], v[230:231], s[46:47] op_sel_hi:[1,0]
v_pk_mul_f32 v[232:233], v[232:233], s[46:47] op_sel_hi:[1,0]
v_cvt_pk_bf16_f32 v112, v212, v213
v_cvt_pk_bf16_f32 v113, v214, v215
v_cvt_pk_bf16_f32 v114, v230, v231
v_cvt_pk_bf16_f32 v115, v232, v233
v_permlane16_swap_b32 v108, v110
v_permlane16_swap_b32 v109, v111
v_accvgpr_read_b32 v226, a76
v_accvgpr_read_b32 v227, a77
v_accvgpr_read_b32 v228, a78
v_accvgpr_read_b32 v229, a79
v_pk_mul_f32 v[216:217], v[216:217], s[46:47] op_sel_hi:[1,0]
v_pk_mul_f32 v[218:219], v[218:219], s[46:47] op_sel_hi:[1,0]
v_pk_mul_f32 v[226:227], v[226:227], s[46:47] op_sel_hi:[1,0]
v_pk_mul_f32 v[228:229], v[228:229], s[46:47] op_sel_hi:[1,0]
v_cvt_pk_bf16_f32 v116, v216, v217
v_cvt_pk_bf16_f32 v117, v218, v219
v_cvt_pk_bf16_f32 v118, v226, v227
v_cvt_pk_bf16_f32 v119, v228, v229
v_permlane16_swap_b32 v112, v114
v_permlane16_swap_b32 v113, v115
s_nop 1
v_permlane16_swap_b32 v116, v118
v_permlane16_swap_b32 v117, v119
s_waitcnt vmcnt(24) lgkmcnt(0)
s_barrier
v_add_u32 v238, s32, v252
v_xor_b32 v239, 64, v238
s_add_u32 s32, s32, 24576
s_sub_u32 s42, s32, 147456
s_min_u32 s32, s32, s42
ds_read_b128 a[240:243], v238 offset:0
ds_read_b128 a[244:247], v239 offset:0
ds_read_b128 a[248:251], v238 offset:128
v_mov_b32 v220, 0
v_mov_b32 v200, 0
v_mov_b32 v201, 0
v_mov_b32 v202, 0
v_mov_b32 v203, 0
v_mov_b32 v221, 0
v_mov_b32 v204, 0
v_mov_b32 v205, 0
v_mov_b32 v206, 0
v_mov_b32 v207, 0
v_mov_b32 v222, 0
v_mov_b32 v208, 0
v_mov_b32 v209, 0
v_mov_b32 v210, 0
v_mov_b32 v211, 0
v_mov_b32 v223, 0
v_mov_b32 v212, 0
v_mov_b32 v213, 0
v_mov_b32 v214, 0
v_mov_b32 v215, 0
v_mov_b32 v224, 0
v_mov_b32 v216, 0
v_mov_b32 v217, 0
v_mov_b32 v218, 0
v_mov_b32 v219, 0
s_waitcnt lgkmcnt(2)
v_mfma_f32_16x16x32_bf16 v[120:123], a[240:243], v[0:3], 0
s_add_u32 m0, s31, s37
ds_read_b128 a[252:255], v239 offset:128
v_mfma_f32_16x16x32_bf16 v[124:127], a[240:243], v[4:7], 0
buffer_load_dwordx4 v245, s[12:15], s33 offen offset:0 nt lds
v_mfma_f32_16x16x32_bf16 v[128:131], a[240:243], v[8:11], 0
v_mfma_f32_16x16x32_bf16 v[132:135], a[240:243], v[12:15], 0
v_mfma_f32_16x16x32_bf16 v[136:139], a[240:243], v[16:19], 0
s_waitcnt lgkmcnt(2)
ds_read_b128 a[240:243], v238 offset:256
v_mfma_f32_16x16x32_bf16 v[120:123], a[244:247], v[20:23], v[120:123]
v_mfma_f32_16x16x32_bf16 v[124:127], a[244:247], v[24:27], v[124:127]
v_mfma_f32_16x16x32_bf16 v[128:131], a[244:247], v[28:31], v[128:131]
buffer_load_dwordx4 v246, s[12:15], s33 offen offset:1024 nt lds
v_mfma_f32_16x16x32_bf16 v[132:135], a[244:247], v[32:35], v[132:135]
v_mfma_f32_16x16x32_bf16 v[136:139], a[244:247], v[36:39], v[136:139]
s_waitcnt lgkmcnt(2)
ds_read_b128 a[244:247], v239 offset:256
v_mfma_f32_16x16x32_bf16 v[120:123], a[248:251], v[40:43], v[120:123]
v_mfma_f32_16x16x32_bf16 v[124:127], a[248:251], v[44:47], v[124:127]
v_mfma_f32_16x16x32_bf16 v[128:131], a[248:251], v[48:51], v[128:131]
v_mfma_f32_16x16x32_bf16 v[132:135], a[248:251], v[52:55], v[132:135]
buffer_load_dwordx4 v247, s[12:15], s33 offen offset:2048 nt lds
v_mfma_f32_16x16x32_bf16 v[136:139], a[248:251], v[56:59], v[136:139]
s_waitcnt lgkmcnt(2)
ds_read_b128 a[248:251], v238 offset:6144
v_mfma_f32_16x16x32_bf16 v[120:123], a[252:255], v[60:63], v[120:123]
s_add_u32 m0, m0, 3072
v_mfma_f32_16x16x32_bf16 v[124:127], a[252:255], v[64:67], v[124:127]
s_add_u32 s40, s33, 3072
v_mfma_f32_16x16x32_bf16 v[128:131], a[252:255], v[68:71], v[128:131]
v_mfma_f32_16x16x32_bf16 v[132:135], a[252:255], v[72:75], v[132:135]
v_mfma_f32_16x16x32_bf16 v[136:139], a[252:255], v[76:79], v[136:139]
s_waitcnt lgkmcnt(2)
ds_read_b128 a[252:255], v239 offset:6144
v_mfma_f32_16x16x32_bf16 v[120:123], a[240:243], v[80:83], v[120:123]
buffer_load_dwordx4 v245, s[12:15], s40 offen offset:0 nt lds
v_mfma_f32_16x16x32_bf16 v[124:127], a[240:243], v[84:87], v[124:127]
v_mfma_f32_16x16x32_bf16 v[128:131], a[240:243], v[88:91], v[128:131]
v_mfma_f32_16x16x32_bf16 v[132:135], a[240:243], v[92:95], v[132:135]
v_mfma_f32_16x16x32_bf16 v[136:139], a[240:243], v[96:99], v[136:139]
s_waitcnt lgkmcnt(2)
ds_read_b128 a[240:243], v238 offset:6272
v_mfma_f32_16x16x32_bf16 v[120:123], a[244:247], v[100:103], v[120:123]
v_mfma_f32_16x16x32_bf16 v[124:127], a[244:247], v[104:107], v[124:127]
buffer_load_dwordx4 v246, s[12:15], s40 offen offset:1024 nt lds
v_mfma_f32_16x16x32_bf16 v[128:131], a[244:247], v[108:111], v[128:131]
v_mfma_f32_16x16x32_bf16 v[132:135], a[244:247], v[112:115], v[132:135]
v_mfma_f32_16x16x32_bf16 v[136:139], a[244:247], v[116:119], v[136:139]
s_waitcnt lgkmcnt(2)
ds_read_b128 a[244:247], v239 offset:6272
v_mfma_f32_16x16x32_bf16 v[140:143], a[248:251], v[0:3], 0
v_mfma_f32_16x16x32_bf16 v[144:147], a[248:251], v[4:7], 0
v_mfma_f32_16x16x32_bf16 v[148:151], a[248:251], v[8:11], 0
buffer_load_dwordx4 v247, s[12:15], s40 offen offset:2048 nt lds
v_mfma_f32_16x16x32_bf16 v[152:155], a[248:251], v[12:15], 0
s_add_u32 s33, s33, 12288
v_mfma_f32_16x16x32_bf16 v[156:159], a[248:251], v[16:19], 0
s_waitcnt lgkmcnt(2)
ds_read_b128 a[248:251], v238 offset:6400
v_mfma_f32_16x16x32_bf16 v[140:143], a[252:255], v[20:23], v[140:143]
s_add_u32 s31, s31, 24576
v_mfma_f32_16x16x32_bf16 v[144:147], a[252:255], v[24:27], v[144:147]
s_sub_u32 s41, s31, 147456
v_mfma_f32_16x16x32_bf16 v[148:151], a[252:255], v[28:31], v[148:151]
s_min_u32 s31, s31, s41
v_mfma_f32_16x16x32_bf16 v[152:155], a[252:255], v[32:35], v[152:155]
v_mfma_f32_16x16x32_bf16 v[156:159], a[252:255], v[36:39], v[156:159]
s_waitcnt lgkmcnt(2)
ds_read_b128 a[252:255], v239 offset:6400
v_mfma_f32_16x16x32_bf16 v[140:143], a[240:243], v[40:43], v[140:143]
v_mfma_f32_16x16x32_bf16 v[144:147], a[240:243], v[44:47], v[144:147]
v_mfma_f32_16x16x32_bf16 v[148:151], a[240:243], v[48:51], v[148:151]
v_mfma_f32_16x16x32_bf16 v[152:155], a[240:243], v[52:55], v[152:155]
v_mfma_f32_16x16x32_bf16 v[156:159], a[240:243], v[56:59], v[156:159]
s_waitcnt lgkmcnt(2)
v_mfma_f32_16x16x32_bf16 v[140:143], a[244:247], v[60:63], v[140:143]
v_mfma_f32_16x16x32_bf16 v[144:147], a[244:247], v[64:67], v[144:147]
v_mfma_f32_16x16x32_bf16 v[148:151], a[244:247], v[68:71], v[148:151]
v_mfma_f32_16x16x32_bf16 v[152:155], a[244:247], v[72:75], v[152:155]
v_mfma_f32_16x16x32_bf16 v[156:159], a[244:247], v[76:79], v[156:159]
s_waitcnt lgkmcnt(1)
v_mfma_f32_16x16x32_bf16 v[140:143], a[248:251], v[80:83], v[140:143]
v_mfma_f32_16x16x32_bf16 v[144:147], a[248:251], v[84:87], v[144:147]
v_mfma_f32_16x16x32_bf16 v[148:151], a[248:251], v[88:91], v[148:151]
v_mfma_f32_16x16x32_bf16 v[152:155], a[248:251], v[92:95], v[152:155]
v_mfma_f32_16x16x32_bf16 v[156:159], a[248:251], v[96:99], v[156:159]
s_waitcnt lgkmcnt(0)
v_mfma_f32_16x16x32_bf16 v[140:143], a[252:255], v[100:103], v[140:143]
v_mfma_f32_16x16x32_bf16 v[144:147], a[252:255], v[104:107], v[144:147]
v_mfma_f32_16x16x32_bf16 v[148:151], a[252:255], v[108:111], v[148:151]
v_mfma_f32_16x16x32_bf16 v[152:155], a[252:255], v[112:115], v[152:155]
v_mfma_f32_16x16x32_bf16 v[156:159], a[252:255], v[116:119], v[156:159]
s_mov_b32 s26, 1966080
s_mov_b32 s36, 122880
s_or_b32 s59, s59, 0x40000000
s_mov_b32 s52, 0xf149f2ca
s_mov_b32 s53, 1
s_call_b64 s[50:51], L_slowF
s_mov_b32 s52, 0
s_mov_b32 s53, 0
s_waitcnt vmcnt(24) lgkmcnt(0)
s_barrier
v_add_u32 v238, s32, v252
v_xor_b32 v239, 64, v238
s_add_u32 s32, s32, 24576
s_sub_u32 s42, s32, 147456
s_min_u32 s32, s32, s42
ds_read_b128 a[240:243], v238 offset:0
ds_read_b128 a[244:247], v239 offset:0
ds_read_b128 a[248:251], v238 offset:128
s_waitcnt lgkmcnt(2)
v_mfma_f32_16x16x32_bf16 v[120:123], a[240:243], v[0:3], v[200:203]
s_add_u32 m0, s31, s37
ds_read_b128 a[252:255], v239 offset:128
v_add_u32 v240, s32, v253
v_mfma_f32_16x16x32_bf16 v[124:127], a[240:243], v[4:7], v[204:207]
s_waitcnt vmcnt(5)
v_xor_b32 v241, 32, v240
v_xor_b32 v242, 64, v240
v_mfma_f32_16x16x32_bf16 v[128:131], a[240:243], v[8:11], v[208:211]
v_xor_b32 v243, 64, v241
v_mfma_f32_16x16x32_bf16 v[132:135], a[240:243], v[12:15], v[212:215]
s_add_u32 s32, s32, 24576
v_mfma_f32_16x16x32_bf16 v[136:139], a[240:243], v[16:19], v[216:219]
s_waitcnt lgkmcnt(2)
ds_read_b128 a[240:243], v238 offset:256
v_mfma_f32_16x16x32_bf16 v[120:123], a[244:247], v[20:23], v[120:123]
s_sub_u32 s42, s32, 147456
v_mfma_f32_16x16x32_bf16 v[124:127], a[244:247], v[24:27], v[124:127]
s_min_u32 s32, s32, s42
v_mfma_f32_16x16x32_bf16 v[128:131], a[244:247], v[28:31], v[128:131]
buffer_load_dwordx4 v245, s[16:19], s34 offen offset:0 nt lds
v_mfma_f32_16x16x32_bf16 v[132:135], a[244:247], v[32:35], v[132:135]
s_waitcnt vmcnt(5)
v_mfma_f32_16x16x32_bf16 v[136:139], a[244:247], v[36:39], v[136:139]
s_waitcnt lgkmcnt(2)
ds_read_b128 a[244:247], v239 offset:256
v_mfma_f32_16x16x32_bf16 v[120:123], a[248:251], v[40:43], v[120:123]
v_mfma_f32_16x16x32_bf16 v[124:127], a[248:251], v[44:47], v[124:127]
v_mfma_f32_16x16x32_bf16 v[128:131], a[248:251], v[48:51], v[128:131]
v_mfma_f32_16x16x32_bf16 v[132:135], a[248:251], v[52:55], v[132:135]
v_mfma_f32_16x16x32_bf16 v[136:139], a[248:251], v[56:59], v[136:139]
s_waitcnt lgkmcnt(2)
ds_read_b128 a[248:251], v238 offset:6144
v_mfma_f32_16x16x32_bf16 v[120:123], a[252:255], v[60:63], v[120:123]
buffer_load_dwordx4 v246, s[16:19], s34 offen offset:1024 nt lds
v_mfma_f32_16x16x32_bf16 v[124:127], a[252:255], v[64:67], v[124:127]
s_waitcnt vmcnt(5)
v_mfma_f32_16x16x32_bf16 v[128:131], a[252:255], v[68:71], v[128:131]
v_mfma_f32_16x16x32_bf16 v[132:135], a[252:255], v[72:75], v[132:135]
v_mfma_f32_16x16x32_bf16 v[136:139], a[252:255], v[76:79], v[136:139]
s_waitcnt lgkmcnt(2)
ds_read_b128 a[252:255], v239 offset:6144
v_mfma_f32_16x16x32_bf16 v[120:123], a[240:243], v[80:83], v[120:123]
v_mfma_f32_16x16x32_bf16 v[124:127], a[240:243], v[84:87], v[124:127]
v_mfma_f32_16x16x32_bf16 v[128:131], a[240:243], v[88:91], v[128:131]
v_mfma_f32_16x16x32_bf16 v[132:135], a[240:243], v[92:95], v[132:135]
buffer_load_dwordx4 v247, s[16:19], s34 offen offset:2048 nt lds
v_mfma_f32_16x16x32_bf16 v[136:139], a[240:243], v[96:99], v[136:139]
s_waitcnt lgkmcnt(2)
ds_read_b128 a[240:243], v238 offset:6272
v_mfma_f32_16x16x32_bf16 v[120:123], a[244:247], v[100:103], v[120:123]
s_add_u32 m0, m0, 3072
v_mfma_f32_16x16x32_bf16 v[124:127], a[244:247], v[104:107], v[124:127]
s_add_u32 s40, s34, 3072
v_mfma_f32_16x16x32_bf16 v[128:131], a[244:247], v[108:111], v[128:131]
s_waitcnt vmcnt(5)
v_mfma_f32_16x16x32_bf16 v[132:135], a[244:247], v[112:115], v[132:135]
v_mfma_f32_16x16x32_bf16 v[136:139], a[244:247], v[116:119], v[136:139]
s_waitcnt lgkmcnt(2)
ds_read_b128 a[244:247], v239 offset:6272
v_mfma_f32_16x16x32_bf16 v[140:143], a[248:251], v[0:3], v[200:203]
v_exp_f32 v230, v120
v_mfma_f32_16x16x32_bf16 v[144:147], a[248:251], v[4:7], v[204:207]
buffer_load_dwordx4 v245, s[16:19], s40 offen offset:0 nt lds
v_mfma_f32_16x16x32_bf16 v[148:151], a[248:251], v[8:11], v[208:211]
s_waitcnt vmcnt(5)
v_exp_f32 v231, v121
v_mfma_f32_16x16x32_bf16 v[152:155], a[248:251], v[12:15], v[212:215]
v_exp_f32 v232, v122
v_mfma_f32_16x16x32_bf16 v[156:159], a[248:251], v[16:19], v[216:219]
s_waitcnt lgkmcnt(2)
ds_read_b128 a[248:251], v238 offset:6400
v_cvt_pk_bf16_f32 v180, v230, v231
v_mfma_f32_16x16x32_bf16 v[140:143], a[252:255], v[20:23], v[140:143]
v_exp_f32 v233, v123
v_mfma_f32_16x16x32_bf16 v[144:147], a[252:255], v[24:27], v[144:147]
v_exp_f32 v234, v124
v_mfma_f32_16x16x32_bf16 v[148:151], a[252:255], v[28:31], v[148:151]
v_exp_f32 v235, v125
v_mfma_f32_16x16x32_bf16 v[152:155], a[252:255], v[32:35], v[152:155]
v_exp_f32 v236, v126
v_mfma_f32_16x16x32_bf16 v[156:159], a[252:255], v[36:39], v[156:159]
s_waitcnt lgkmcnt(2)
ds_read_b128 a[252:255], v239 offset:6400
v_add_f32 v225, v230, v231
v_mfma_f32_16x16x32_bf16 v[140:143], a[240:243], v[40:43], v[140:143]
v_add_u32 v238, s32, v252
v_xor_b32 v239, 64, v238
v_mfma_f32_16x16x32_bf16 v[144:147], a[240:243], v[44:47], v[144:147]
s_add_u32 s32, s32, 24576
v_exp_f32 v237, v127
v_mfma_f32_16x16x32_bf16 v[148:151], a[240:243], v[48:51], v[148:151]
s_sub_u32 s42, s32, 147456
v_cvt_pk_bf16_f32 v181, v232, v233
v_add_f32 v225, v225, v232
v_mfma_f32_16x16x32_bf16 v[152:155], a[240:243], v[52:55], v[152:155]
s_min_u32 s32, s32, s42
v_add_f32 v225, v225, v233
v_cvt_pk_bf16_f32 v184, v234, v235
v_mfma_f32_16x16x32_bf16 v[156:159], a[240:243], v[56:59], v[156:159]
s_waitcnt lgkmcnt(2)
v_exp_f32 v230, v128
v_mfma_f32_16x16x32_bf16 v[140:143], a[244:247], v[60:63], v[140:143]
buffer_load_dwordx4 v246, s[16:19], s40 offen offset:1024 nt lds
v_mfma_f32_16x16x32_bf16 v[144:147], a[244:247], v[64:67], v[144:147]
s_waitcnt vmcnt(5)
v_exp_f32 v231, v129
v_mfma_f32_16x16x32_bf16 v[148:151], a[244:247], v[68:71], v[148:151]
v_exp_f32 v232, v130
v_mfma_f32_16x16x32_bf16 v[152:155], a[244:247], v[72:75], v[152:155]
s_waitcnt vmcnt(63) lgkmcnt(0)
s_barrier
ds_read_b64_tr_b16 a[240:241], v240 offset:0
v_mfma_f32_16x16x32_bf16 v[156:159], a[244:247], v[76:79], v[156:159]
s_waitcnt lgkmcnt(15)
ds_read_b64_tr_b16 a[242:243], v240 offset:6144
ds_read_b64_tr_b16 a[244:245], v241 offset:0
v_mfma_f32_16x16x32_bf16 v[140:143], a[248:251], v[80:83], v[140:143]
ds_read_b64_tr_b16 a[246:247], v241 offset:6144
v_add_f32 v226, v234, v235
v_mfma_f32_16x16x32_bf16 v[144:147], a[248:251], v[84:87], v[144:147]
v_exp_f32 v233, v131
v_mfma_f32_16x16x32_bf16 v[148:151], a[248:251], v[88:91], v[148:151]
v_cvt_pk_bf16_f32 v185, v236, v237
v_add_f32 v226, v226, v236
v_mfma_f32_16x16x32_bf16 v[152:155], a[248:251], v[92:95], v[152:155]
buffer_load_dwordx4 v247, s[16:19], s40 offen offset:2048 nt lds
v_mfma_f32_16x16x32_bf16 v[156:159], a[248:251], v[96:99], v[156:159]
s_waitcnt lgkmcnt(15)
ds_read_b64_tr_b16 a[248:249], v242 offset:0
ds_read_b64_tr_b16 a[250:251], v242 offset:6144
v_mfma_f32_16x16x32_bf16 v[140:143], a[252:255], v[100:103], v[140:143]
s_add_u32 s34, s34, 12288
v_add_f32 v226, v226, v237
v_cvt_pk_bf16_f32 v188, v230, v231
v_mfma_f32_16x16x32_bf16 v[144:147], a[252:255], v[104:107], v[144:147]
s_add_u32 s31, s31, 24576
v_exp_f32 v234, v132
v_mfma_f32_16x16x32_bf16 v[148:151], a[252:255], v[108:111], v[148:151]
s_sub_u32 s41, s31, 147456
v_exp_f32 v235, v133
v_mfma_f32_16x16x32_bf16 v[152:155], a[252:255], v[112:115], v[152:155]
s_min_u32 s31, s31, s41
v_exp_f32 v236, v134
v_mfma_f32_16x16x32_bf16 v[156:159], a[252:255], v[116:119], v[156:159]
s_waitcnt lgkmcnt(4)
ds_read_b64_tr_b16 a[252:253], v243 offset:0
ds_read_b64_tr_b16 a[254:255], v243 offset:6144
v_mfma_f32_16x16x32_bf16 a[0:3], a[240:243], v[160:163], 0
s_add_u32 m0, s31, s37
v_exp_f32 v237, v135
v_mfma_f32_16x16x32_bf16 a[4:7], a[240:243], v[164:167], 0
s_waitcnt vmcnt(5)
v_add_f32 v227, v230, v231
v_cvt_pk_bf16_f32 v189, v232, v233
v_mfma_f32_16x16x32_bf16 a[8:11], a[240:243], v[168:171], 0
buffer_load_dwordx4 v245, s[12:15], s33 offen offset:0 nt lds
v_mfma_f32_16x16x32_bf16 a[12:15], a[240:243], v[172:175], 0
s_waitcnt vmcnt(5)
v_add_f32 v227, v227, v232
v_add_f32 v227, v227, v233
v_mfma_f32_16x16x32_bf16 a[16:19], a[240:243], v[176:179], 0
s_waitcnt lgkmcnt(4)
ds_read_b64_tr_b16 a[240:241], v240 offset:128
ds_read_b64_tr_b16 a[242:243], v240 offset:6272
v_mfma_f32_16x16x32_bf16 a[20:23], a[244:247], v[160:163], 0
v_exp_f32 v230, v136
v_mfma_f32_16x16x32_bf16 a[24:27], a[244:247], v[164:167], 0
v_exp_f32 v231, v137
v_mfma_f32_16x16x32_bf16 a[28:31], a[244:247], v[168:171], 0
v_exp_f32 v232, v138
v_mfma_f32_16x16x32_bf16 a[32:35], a[244:247], v[172:175], 0
v_exp_f32 v233, v139
v_mfma_f32_16x16x32_bf16 a[36:39], a[244:247], v[176:179], 0
s_waitcnt lgkmcnt(4)
ds_read_b64_tr_b16 a[244:245], v241 offset:128
ds_read_b64_tr_b16 a[246:247], v241 offset:6272
v_mfma_f32_16x16x32_bf16 a[40:43], a[248:251], v[160:163], 0
buffer_load_dwordx4 v246, s[12:15], s33 offen offset:1024 nt lds
v_mfma_f32_16x16x32_bf16 a[44:47], a[248:251], v[164:167], 0
s_waitcnt vmcnt(5)
v_cvt_pk_bf16_f32 v192, v234, v235
v_add_f32 v228, v234, v235
v_mfma_f32_16x16x32_bf16 a[48:51], a[248:251], v[168:171], 0
v_cvt_pk_bf16_f32 v193, v236, v237
v_add_f32 v228, v228, v236
v_mfma_f32_16x16x32_bf16 a[52:55], a[248:251], v[172:175], 0
v_add_f32 v228, v228, v237
v_cvt_pk_bf16_f32 v196, v230, v231
v_mfma_f32_16x16x32_bf16 a[56:59], a[248:251], v[176:179], 0
s_waitcnt lgkmcnt(4)
ds_read_b64_tr_b16 a[248:249], v242 offset:128
ds_read_b64_tr_b16 a[250:251], v242 offset:6272
v_mfma_f32_16x16x32_bf16 a[60:63], a[252:255], v[160:163], 0
v_add_f32 v229, v230, v231
v_cvt_pk_bf16_f32 v197, v232, v233
v_mfma_f32_16x16x32_bf16 a[64:67], a[252:255], v[164:167], 0
v_add_f32 v229, v229, v232
v_add_f32 v229, v229, v233
v_mfma_f32_16x16x32_bf16 a[68:71], a[252:255], v[168:171], 0
v_max3_f32 v244, v225, v226, v227
v_max3_f32 v244, v244, v228, v229
v_mfma_f32_16x16x32_bf16 a[72:75], a[252:255], v[172:175], 0
buffer_load_dwordx4 v247, s[12:15], s33 offen offset:2048 nt lds
v_mfma_f32_16x16x32_bf16 a[76:79], a[252:255], v[176:179], 0
s_waitcnt lgkmcnt(4)
ds_read_b64_tr_b16 a[252:253], v243 offset:128
ds_read_b64_tr_b16 a[254:255], v243 offset:6272
v_mfma_f32_16x16x32_bf16 a[80:83], a[240:243], v[160:163], 0
s_add_u32 m0, m0, 3072
v_cmp_ngt_f32 vcc, 2.0, v244
v_mfma_f32_16x16x32_bf16 a[84:87], a[240:243], v[164:167], 0
s_add_u32 s40, s33, 3072
v_mfma_f32_16x16x32_bf16 a[88:91], a[240:243], v[168:171], 0
s_waitcnt vmcnt(5)
v_mfma_f32_16x16x32_bf16 a[92:95], a[240:243], v[172:175], 0
s_cbranch_vccnz L_tr19
L_back19:
v_exp_f32 v234, v140
v_mfma_f32_16x16x32_bf16 a[96:99], a[240:243], v[176:179], 0
s_waitcnt lgkmcnt(4)
ds_read_b64_tr_b16 a[240:241], v240 offset:256
ds_read_b64_tr_b16 a[242:243], v240 offset:6400
v_mfma_f32_16x16x32_bf16 a[100:103], a[244:247], v[160:163], 0
v_exp_f32 v235, v141
v_mfma_f32_16x16x32_bf16 a[104:107], a[244:247], v[164:167], 0
buffer_load_dwordx4 v245, s[12:15], s40 offen offset:0 nt lds
v_mfma_f32_16x16x32_bf16 a[108:111], a[244:247], v[168:171], 0
s_waitcnt vmcnt(5)
v_exp_f32 v236, v142
v_mfma_f32_16x16x32_bf16 a[112:115], a[244:247], v[172:175], 0
v_exp_f32 v237, v143
v_mfma_f32_16x16x32_bf16 a[116:119], a[244:247], v[176:179], 0
s_waitcnt lgkmcnt(4)
ds_read_b64_tr_b16 a[244:245], v241 offset:256
ds_read_b64_tr_b16 a[246:247], v241 offset:6400
v_mfma_f32_16x16x32_bf16 a[120:123], a[248:251], v[160:163], 0
v_exp_f32 v230, v144
v_mfma_f32_16x16x32_bf16 a[124:127], a[248:251], v[164:167], 0
v_exp_f32 v231, v145
v_mfma_f32_16x16x32_bf16 a[128:131], a[248:251], v[168:171], 0
v_exp_f32 v232, v146
v_mfma_f32_16x16x32_bf16 a[132:135], a[248:251], v[172:175], 0
v_exp_f32 v233, v147
v_mfma_f32_16x16x32_bf16 a[136:139], a[248:251], v[176:179], 0
s_waitcnt lgkmcnt(4)
ds_read_b64_tr_b16 a[248:249], v242 offset:256
ds_read_b64_tr_b16 a[250:251], v242 offset:6400
v_mfma_f32_16x16x32_bf16 a[140:143], a[252:255], v[160:163], 0
buffer_load_dwordx4 v246, s[12:15], s40 offen offset:1024 nt lds
v_mfma_f32_16x16x32_bf16 a[144:147], a[252:255], v[164:167], 0
s_waitcnt vmcnt(5)
v_add_f32 v220, v220, v225
v_add_f32 v221, v221, v226
v_mfma_f32_16x16x32_bf16 a[148:151], a[252:255], v[168:171], 0
v_add_f32 v222, v222, v227
v_add_f32 v223, v223, v228
v_mfma_f32_16x16x32_bf16 a[152:155], a[252:255], v[172:175], 0
v_add_f32 v224, v224, v229
v_cvt_pk_bf16_f32 v182, v234, v235
v_mfma_f32_16x16x32_bf16 a[156:159], a[252:255], v[176:179], 0
s_waitcnt lgkmcnt(4)
ds_read_b64_tr_b16 a[252:253], v243 offset:256
ds_read_b64_tr_b16 a[254:255], v243 offset:6400
v_mfma_f32_16x16x32_bf16 a[160:163], a[240:243], v[160:163], 0
v_add_u32 v240, s32, v253
v_xor_b32 v241, 32, v240
v_mfma_f32_16x16x32_bf16 a[164:167], a[240:243], v[164:167], 0
v_xor_b32 v242, 64, v240
v_xor_b32 v243, 64, v241
v_mfma_f32_16x16x32_bf16 a[168:171], a[240:243], v[168:171], 0
s_add_u32 s32, s32, 24576
v_add_f32 v225, v234, v235
v_cvt_pk_bf16_f32 v183, v236, v237
v_mfma_f32_16x16x32_bf16 a[172:175], a[240:243], v[172:175], 0
s_sub_u32 s42, s32, 147456
v_add_f32 v225, v225, v236
v_add_f32 v225, v225, v237
v_mfma_f32_16x16x32_bf16 a[176:179], a[240:243], v[176:179], 0
s_waitcnt lgkmcnt(4)
v_exp_f32 v234, v148
v_mfma_f32_16x16x32_bf16 a[180:183], a[244:247], v[160:163], 0
s_min_u32 s32, s32, s42
v_exp_f32 v235, v149
v_mfma_f32_16x16x32_bf16 a[184:187], a[244:247], v[164:167], 0
buffer_load_dwordx4 v247, s[12:15], s40 offen offset:2048 nt lds
v_mfma_f32_16x16x32_bf16 a[188:191], a[244:247], v[168:171], 0
s_add_u32 s33, s33, 12288
v_exp_f32 v236, v150
v_mfma_f32_16x16x32_bf16 a[192:195], a[244:247], v[172:175], 0
s_waitcnt vmcnt(63) lgkmcnt(0)
s_barrier
ds_read_b128 a[240:243], v238 offset:0
v_mfma_f32_16x16x32_bf16 a[196:199], a[244:247], v[176:179], 0
s_waitcnt lgkmcnt(15)
ds_read_b128 a[244:247], v239 offset:0
v_cvt_pk_bf16_f32 v186, v230, v231
v_mfma_f32_16x16x32_bf16 a[200:203], a[248:251], v[160:163], 0
s_add_u32 s31, s31, 24576
v_exp_f32 v237, v151
v_mfma_f32_16x16x32_bf16 a[204:207], a[248:251], v[164:167], 0
s_sub_u32 s41, s31, 147456
v_add_f32 v226, v230, v231
v_cvt_pk_bf16_f32 v187, v232, v233
v_mfma_f32_16x16x32_bf16 a[208:211], a[248:251], v[168:171], 0
s_min_u32 s31, s31, s41
v_add_f32 v226, v226, v232
v_add_f32 v226, v226, v233
v_mfma_f32_16x16x32_bf16 a[212:215], a[248:251], v[172:175], 0
s_add_u32 m0, s31, s37
v_exp_f32 v230, v152
v_mfma_f32_16x16x32_bf16 a[216:219], a[248:251], v[176:179], 0
s_waitcnt lgkmcnt(15)
ds_read_b128 a[248:251], v238 offset:128
v_cvt_pk_bf16_f32 v190, v234, v235
v_mfma_f32_16x16x32_bf16 a[220:223], a[252:255], v[160:163], 0
s_waitcnt vmcnt(5)
v_exp_f32 v231, v153
v_mfma_f32_16x16x32_bf16 a[224:227], a[252:255], v[164:167], 0
buffer_load_dwordx4 v245, s[16:19], s34 offen offset:0 nt lds
v_mfma_f32_16x16x32_bf16 a[228:231], a[252:255], v[168:171], 0
s_waitcnt vmcnt(5)
v_exp_f32 v232, v154
v_mfma_f32_16x16x32_bf16 a[232:235], a[252:255], v[172:175], 0
v_exp_f32 v233, v155
v_mfma_f32_16x16x32_bf16 a[236:239], a[252:255], v[176:179], 0
s_waitcnt lgkmcnt(2)
ds_read_b128 a[252:255], v239 offset:128
v_add_f32 v227, v234, v235
v_mfma_f32_16x16x32_bf16 v[120:123], a[240:243], v[0:3], v[200:203]
v_cvt_pk_bf16_f32 v191, v236, v237
v_add_f32 v227, v227, v236
v_mfma_f32_16x16x32_bf16 v[124:127], a[240:243], v[4:7], v[204:207]
v_add_f32 v227, v227, v237
v_cvt_pk_bf16_f32 v194, v230, v231
v_mfma_f32_16x16x32_bf16 v[128:131], a[240:243], v[8:11], v[208:211]
v_exp_f32 v234, v156
v_mfma_f32_16x16x32_bf16 v[132:135], a[240:243], v[12:15], v[212:215]
v_exp_f32 v235, v157
v_mfma_f32_16x16x32_bf16 v[136:139], a[240:243], v[16:19], v[216:219]
s_waitcnt lgkmcnt(2)
ds_read_b128 a[240:243], v238 offset:256
v_add_f32 v228, v230, v231
v_mfma_f32_16x16x32_bf16 v[120:123], a[244:247], v[20:23], v[120:123]
buffer_load_dwordx4 v246, s[16:19], s34 offen offset:1024 nt lds
v_mfma_f32_16x16x32_bf16 v[124:127], a[244:247], v[24:27], v[124:127]
s_waitcnt vmcnt(5)
v_exp_f32 v236, v158
v_mfma_f32_16x16x32_bf16 v[128:131], a[244:247], v[28:31], v[128:131]
v_exp_f32 v237, v159
v_mfma_f32_16x16x32_bf16 v[132:135], a[244:247], v[32:35], v[132:135]
v_cvt_pk_bf16_f32 v195, v232, v233
v_add_f32 v228, v228, v232
v_mfma_f32_16x16x32_bf16 v[136:139], a[244:247], v[36:39], v[136:139]
s_waitcnt lgkmcnt(2)
ds_read_b128 a[244:247], v239 offset:256
v_add_f32 v228, v228, v233
v_mfma_f32_16x16x32_bf16 v[120:123], a[248:251], v[40:43], v[120:123]
v_cvt_pk_bf16_f32 v198, v234, v235
v_add_f32 v229, v234, v235
v_mfma_f32_16x16x32_bf16 v[124:127], a[248:251], v[44:47], v[124:127]
v_cvt_pk_bf16_f32 v199, v236, v237
v_add_f32 v229, v229, v236
v_mfma_f32_16x16x32_bf16 v[128:131], a[248:251], v[48:51], v[128:131]
v_add_f32 v229, v229, v237
v_max3_f32 v244, v225, v226, v227
v_mfma_f32_16x16x32_bf16 v[132:135], a[248:251], v[52:55], v[132:135]
buffer_load_dwordx4 v247, s[16:19], s34 offen offset:2048 nt lds
v_mfma_f32_16x16x32_bf16 v[136:139], a[248:251], v[56:59], v[136:139]
s_waitcnt lgkmcnt(2)
ds_read_b128 a[248:251], v238 offset:6144
v_max3_f32 v244, v244, v228, v229
v_mfma_f32_16x16x32_bf16 v[120:123], a[252:255], v[60:63], v[120:123]
s_add_u32 m0, m0, 3072
v_cmp_ngt_f32 vcc, 2.0, v244
v_mfma_f32_16x16x32_bf16 v[124:127], a[252:255], v[64:67], v[124:127]
s_add_u32 s40, s34, 3072
v_mfma_f32_16x16x32_bf16 v[128:131], a[252:255], v[68:71], v[128:131]
s_waitcnt vmcnt(5)
v_mfma_f32_16x16x32_bf16 v[132:135], a[252:255], v[72:75], v[132:135]
v_mfma_f32_16x16x32_bf16 v[136:139], a[252:255], v[76:79], v[136:139]
s_waitcnt lgkmcnt(2)
ds_read_b128 a[252:255], v239 offset:6144
v_mfma_f32_16x16x32_bf16 v[120:123], a[240:243], v[80:83], v[120:123]
v_mfma_f32_16x16x32_bf16 v[124:127], a[240:243], v[84:87], v[124:127]
buffer_load_dwordx4 v245, s[16:19], s40 offen offset:0 nt lds
v_mfma_f32_16x16x32_bf16 v[128:131], a[240:243], v[88:91], v[128:131]
s_waitcnt vmcnt(5)
v_mfma_f32_16x16x32_bf16 v[132:135], a[240:243], v[92:95], v[132:135]
v_mfma_f32_16x16x32_bf16 v[136:139], a[240:243], v[96:99], v[136:139]
s_waitcnt lgkmcnt(2)
ds_read_b128 a[240:243], v238 offset:6272
v_mfma_f32_16x16x32_bf16 v[120:123], a[244:247], v[100:103], v[120:123]
v_mfma_f32_16x16x32_bf16 v[124:127], a[244:247], v[104:107], v[124:127]
v_mfma_f32_16x16x32_bf16 v[128:131], a[244:247], v[108:111], v[128:131]
v_mfma_f32_16x16x32_bf16 v[132:135], a[244:247], v[112:115], v[132:135]
v_mfma_f32_16x16x32_bf16 v[136:139], a[244:247], v[116:119], v[136:139]
s_cbranch_vccnz L_tr20
L_back20:
s_waitcnt lgkmcnt(2)
ds_read_b128 a[244:247], v239 offset:6272
s_cmp_lg_u32 s28, 0
s_cbranch_scc1 L_sig21
v_mov_b32 v230, s45
v_mov_b32 v231, 0
s_waitcnt vmcnt(63)
s_mov_b64 exec, 1
buffer_atomic_add v230, v231, s[72:75], s77 offen sc1
s_mov_b64 exec, -1
L_sig21:
v_mfma_f32_16x16x32_bf16 v[140:143], a[248:251], v[0:3], v[200:203]
buffer_load_dwordx4 v246, s[16:19], s40 offen offset:1024 nt lds
v_mfma_f32_16x16x32_bf16 v[144:147], a[248:251], v[4:7], v[204:207]
s_waitcnt vmcnt(5)
v_exp_f32 v230, v120
v_mfma_f32_16x16x32_bf16 v[148:151], a[248:251], v[8:11], v[208:211]
v_exp_f32 v231, v121
v_mfma_f32_16x16x32_bf16 v[152:155], a[248:251], v[12:15], v[212:215]
v_exp_f32 v232, v122
v_mfma_f32_16x16x32_bf16 v[156:159], a[248:251], v[16:19], v[216:219]
s_waitcnt lgkmcnt(2)
ds_read_b128 a[248:251], v238 offset:6400
v_add_f32 v220, v220, v225
v_mfma_f32_16x16x32_bf16 v[140:143], a[252:255], v[20:23], v[140:143]
v_exp_f32 v233, v123
v_mfma_f32_16x16x32_bf16 v[144:147], a[252:255], v[24:27], v[144:147]
v_exp_f32 v234, v124
v_mfma_f32_16x16x32_bf16 v[148:151], a[252:255], v[28:31], v[148:151]
v_exp_f32 v235, v125
v_mfma_f32_16x16x32_bf16 v[152:155], a[252:255], v[32:35], v[152:155]
buffer_load_dwordx4 v247, s[16:19], s40 offen offset:2048 nt lds
v_mfma_f32_16x16x32_bf16 v[156:159], a[252:255], v[36:39], v[156:159]
s_waitcnt lgkmcnt(2)
ds_read_b128 a[252:255], v239 offset:6400
v_add_f32 v221, v221, v226
v_mfma_f32_16x16x32_bf16 v[140:143], a[240:243], v[40:43], v[140:143]
s_add_u32 s34, s34, 12288
v_add_u32 v238, s32, v252
v_xor_b32 v239, 64, v238
v_mfma_f32_16x16x32_bf16 v[144:147], a[240:243], v[44:47], v[144:147]
s_add_u32 s32, s32, 24576
v_exp_f32 v236, v126
v_mfma_f32_16x16x32_bf16 v[148:151], a[240:243], v[48:51], v[148:151]
s_sub_u32 s42, s32, 147456
v_exp_f32 v237, v127
v_mfma_f32_16x16x32_bf16 v[152:155], a[240:243], v[52:55], v[152:155]
s_min_u32 s32, s32, s42
v_add_f32 v222, v222, v227
v_add_f32 v223, v223, v228
v_mfma_f32_16x16x32_bf16 v[156:159], a[240:243], v[56:59], v[156:159]
s_waitcnt lgkmcnt(2)
v_add_f32 v224, v224, v229
v_cvt_pk_bf16_f32 v160, v230, v231
v_mfma_f32_16x16x32_bf16 v[140:143], a[244:247], v[60:63], v[140:143]
s_add_u32 s31, s31, 24576
v_add_f32 v225, v230, v231
v_cvt_pk_bf16_f32 v161, v232, v233
v_mfma_f32_16x16x32_bf16 v[144:147], a[244:247], v[64:67], v[144:147]
s_sub_u32 s41, s31, 147456
v_add_f32 v225, v225, v232
v_add_f32 v225, v225, v233
v_mfma_f32_16x16x32_bf16 v[148:151], a[244:247], v[68:71], v[148:151]
s_min_u32 s31, s31, s41
v_exp_f32 v230, v128
v_mfma_f32_16x16x32_bf16 v[152:155], a[244:247], v[72:75], v[152:155]
s_waitcnt vmcnt(63) lgkmcnt(0)
s_barrier
ds_read_b64_tr_b16 a[240:241], v240 offset:0
v_mfma_f32_16x16x32_bf16 v[156:159], a[244:247], v[76:79], v[156:159]
s_waitcnt lgkmcnt(15)
ds_read_b64_tr_b16 a[242:243], v240 offset:6144
ds_read_b64_tr_b16 a[244:245], v241 offset:0
v_mfma_f32_16x16x32_bf16 v[140:143], a[248:251], v[80:83], v[140:143]
s_add_u32 m0, s31, s37
ds_read_b64_tr_b16 a[246:247], v241 offset:6144
v_cvt_pk_bf16_f32 v164, v234, v235
v_mfma_f32_16x16x32_bf16 v[144:147], a[248:251], v[84:87], v[144:147]
s_waitcnt vmcnt(5)
v_exp_f32 v231, v129
v_mfma_f32_16x16x32_bf16 v[148:151], a[248:251], v[88:91], v[148:151]
buffer_load_dwordx4 v245, s[12:15], s33 offen offset:0 nt lds
v_mfma_f32_16x16x32_bf16 v[152:155], a[248:251], v[92:95], v[152:155]
s_waitcnt vmcnt(5)
v_exp_f32 v232, v130
v_mfma_f32_16x16x32_bf16 v[156:159], a[248:251], v[96:99], v[156:159]
s_waitcnt lgkmcnt(15)
ds_read_b64_tr_b16 a[248:249], v242 offset:0
ds_read_b64_tr_b16 a[250:251], v242 offset:6144
v_mfma_f32_16x16x32_bf16 v[140:143], a[252:255], v[100:103], v[140:143]
v_exp_f32 v233, v131
v_mfma_f32_16x16x32_bf16 v[144:147], a[252:255], v[104:107], v[144:147]
v_add_f32 v226, v234, v235
v_cvt_pk_bf16_f32 v165, v236, v237
v_mfma_f32_16x16x32_bf16 v[148:151], a[252:255], v[108:111], v[148:151]
v_add_f32 v226, v226, v236
v_add_f32 v226, v226, v237
v_mfma_f32_16x16x32_bf16 v[152:155], a[252:255], v[112:115], v[152:155]
v_exp_f32 v234, v132
v_mfma_f32_16x16x32_bf16 v[156:159], a[252:255], v[116:119], v[156:159]
s_waitcnt lgkmcnt(4)
ds_read_b64_tr_b16 a[252:253], v243 offset:0
ds_read_b64_tr_b16 a[254:255], v243 offset:6144
v_mfma_f32_16x16x32_bf16 a[0:3], a[240:243], v[180:183], a[0:3]
buffer_load_dwordx4 v246, s[12:15], s33 offen offset:1024 nt lds
v_mfma_f32_16x16x32_bf16 a[4:7], a[240:243], v[184:187], a[4:7]
s_waitcnt vmcnt(5)
v_exp_f32 v235, v133
v_mfma_f32_16x16x32_bf16 a[8:11], a[240:243], v[188:191], a[8:11]
v_exp_f32 v236, v134
v_mfma_f32_16x16x32_bf16 a[12:15], a[240:243], v[192:195], a[12:15]
v_exp_f32 v237, v135
v_mfma_f32_16x16x32_bf16 a[16:19], a[240:243], v[196:199], a[16:19]
s_waitcnt lgkmcnt(4)
ds_read_b64_tr_b16 a[240:241], v240 offset:128
ds_read_b64_tr_b16 a[242:243], v240 offset:6272
v_mfma_f32_16x16x32_bf16 a[20:23], a[244:247], v[180:183], a[20:23]
v_cvt_pk_bf16_f32 v168, v230, v231
v_add_f32 v227, v230, v231
v_mfma_f32_16x16x32_bf16 a[24:27], a[244:247], v[184:187], a[24:27]
v_cvt_pk_bf16_f32 v169, v232, v233
v_add_f32 v227, v227, v232
v_mfma_f32_16x16x32_bf16 a[28:31], a[244:247], v[188:191], a[28:31]
v_add_f32 v227, v227, v233
v_cvt_pk_bf16_f32 v172, v234, v235
v_mfma_f32_16x16x32_bf16 a[32:35], a[244:247], v[192:195], a[32:35]
buffer_load_dwordx4 v247, s[12:15], s33 offen offset:2048 nt lds
v_mfma_f32_16x16x32_bf16 a[36:39], a[244:247], v[196:199], a[36:39]
s_waitcnt lgkmcnt(4)
ds_read_b64_tr_b16 a[244:245], v241 offset:128
ds_read_b64_tr_b16 a[246:247], v241 offset:6272
v_mfma_f32_16x16x32_bf16 a[40:43], a[248:251], v[180:183], a[40:43]
s_add_u32 m0, m0, 3072
v_exp_f32 v230, v136
v_mfma_f32_16x16x32_bf16 a[44:47], a[248:251], v[184:187], a[44:47]
s_add_u32 s40, s33, 3072
v_exp_f32 v231, v137
v_mfma_f32_16x16x32_bf16 a[48:51], a[248:251], v[188:191], a[48:51]
s_waitcnt vmcnt(5)
v_exp_f32 v232, v138
v_mfma_f32_16x16x32_bf16 a[52:55], a[248:251], v[192:195], a[52:55]
v_exp_f32 v233, v139
v_mfma_f32_16x16x32_bf16 a[56:59], a[248:251], v[196:199], a[56:59]
s_waitcnt lgkmcnt(4)
ds_read_b64_tr_b16 a[248:249], v242 offset:128
ds_read_b64_tr_b16 a[250:251], v242 offset:6272
v_mfma_f32_16x16x32_bf16 a[60:63], a[252:255], v[180:183], a[60:63]
v_add_f32 v228, v234, v235
v_cvt_pk_bf16_f32 v173, v236, v237
v_mfma_f32_16x16x32_bf16 a[64:67], a[252:255], v[184:187], a[64:67]
buffer_load_dwordx4 v245, s[12:15], s40 offen offset:0 nt lds
v_mfma_f32_16x16x32_bf16 a[68:71], a[252:255], v[188:191], a[68:71]
s_waitcnt vmcnt(5)
v_add_f32 v228, v228, v236
v_add_f32 v228, v228, v237
v_mfma_f32_16x16x32_bf16 a[72:75], a[252:255], v[192:195], a[72:75]
v_cvt_pk_bf16_f32 v176, v230, v231
v_add_f32 v229, v230, v231
v_mfma_f32_16x16x32_bf16 a[76:79], a[252:255], v[196:199], a[76:79]
s_waitcnt lgkmcnt(4)
ds_read_b64_tr_b16 a[252:253], v243 offset:128
ds_read_b64_tr_b16 a[254:255], v243 offset:6272
v_mfma_f32_16x16x32_bf16 a[80:83], a[240:243], v[180:183], a[80:83]
v_cvt_pk_bf16_f32 v177, v232, v233
v_add_f32 v229, v229, v232
v_mfma_f32_16x16x32_bf16 a[84:87], a[240:243], v[184:187], a[84:87]
v_add_f32 v229, v229, v233
v_max3_f32 v244, v225, v226, v227
v_mfma_f32_16x16x32_bf16 a[88:91], a[240:243], v[188:191], a[88:91]
v_max3_f32 v244, v244, v228, v229
v_cmp_ngt_f32 vcc, 2.0, v244
v_mfma_f32_16x16x32_bf16 a[92:95], a[240:243], v[192:195], a[92:95]
s_cbranch_vccnz L_tr23
L_back23:
v_exp_f32 v234, v140
v_mfma_f32_16x16x32_bf16 a[96:99], a[240:243], v[196:199], a[96:99]
s_waitcnt lgkmcnt(4)
ds_read_b64_tr_b16 a[240:241], v240 offset:256
ds_read_b64_tr_b16 a[242:243], v240 offset:6400
v_mfma_f32_16x16x32_bf16 a[100:103], a[244:247], v[180:183], a[100:103]
buffer_load_dwordx4 v246, s[12:15], s40 offen offset:1024 nt lds
v_mfma_f32_16x16x32_bf16 a[104:107], a[244:247], v[184:187], a[104:107]
s_waitcnt vmcnt(5)
v_exp_f32 v235, v141
v_mfma_f32_16x16x32_bf16 a[108:111], a[244:247], v[188:191], a[108:111]
v_exp_f32 v236, v142
v_mfma_f32_16x16x32_bf16 a[112:115], a[244:247], v[192:195], a[112:115]
v_exp_f32 v237, v143
v_mfma_f32_16x16x32_bf16 a[116:119], a[244:247], v[196:199], a[116:119]
s_waitcnt lgkmcnt(4)
ds_read_b64_tr_b16 a[244:245], v241 offset:256
ds_read_b64_tr_b16 a[246:247], v241 offset:6400
v_mfma_f32_16x16x32_bf16 a[120:123], a[248:251], v[180:183], a[120:123]
v_exp_f32 v230, v144
v_mfma_f32_16x16x32_bf16 a[124:127], a[248:251], v[184:187], a[124:127]
v_exp_f32 v231, v145
v_mfma_f32_16x16x32_bf16 a[128:131], a[248:251], v[188:191], a[128:131]
v_exp_f32 v232, v146
v_mfma_f32_16x16x32_bf16 a[132:135], a[248:251], v[192:195], a[132:135]
buffer_load_dwordx4 v247, s[12:15], s40 offen offset:2048 nt lds
v_mfma_f32_16x16x32_bf16 a[136:139], a[248:251], v[196:199], a[136:139]
s_waitcnt lgkmcnt(4)
ds_read_b64_tr_b16 a[248:249], v242 offset:256
ds_read_b64_tr_b16 a[250:251], v242 offset:6400
v_mfma_f32_16x16x32_bf16 a[140:143], a[252:255], v[180:183], a[140:143]
s_add_u32 s33, s33, 12288
v_exp_f32 v233, v147
v_mfma_f32_16x16x32_bf16 a[144:147], a[252:255], v[184:187], a[144:147]
s_add_u32 s31, s31, 24576
v_add_f32 v220, v220, v225
v_add_f32 v221, v221, v226
v_mfma_f32_16x16x32_bf16 a[148:151], a[252:255], v[188:191], a[148:151]
s_sub_u32 s41, s31, 147456
v_add_f32 v222, v222, v227
v_add_f32 v223, v223, v228
v_mfma_f32_16x16x32_bf16 a[152:155], a[252:255], v[192:195], a[152:155]
s_min_u32 s31, s31, s41
v_add_f32 v224, v224, v229
v_cvt_pk_bf16_f32 v162, v234, v235
v_mfma_f32_16x16x32_bf16 a[156:159], a[252:255], v[196:199], a[156:159]
s_waitcnt lgkmcnt(4)
ds_read_b64_tr_b16 a[252:253], v243 offset:256
ds_read_b64_tr_b16 a[254:255], v243 offset:6400
v_mfma_f32_16x16x32_bf16 a[160:163], a[240:243], v[180:183], a[160:163]
v_add_u32 v240, s32, v253
v_xor_b32 v241, 32, v240
v_mfma_f32_16x16x32_bf16 a[164:167], a[240:243], v[184:187], a[164:167]
v_xor_b32 v242, 64, v240
v_xor_b32 v243, 64, v241
v_mfma_f32_16x16x32_bf16 a[168:171], a[240:243], v[188:191], a[168:171]
s_add_u32 s32, s32, 24576
v_add_f32 v225, v234, v235
v_cvt_pk_bf16_f32 v163, v236, v237
v_mfma_f32_16x16x32_bf16 a[172:175], a[240:243], v[192:195], a[172:175]
s_sub_u32 s42, s32, 147456
v_add_f32 v225, v225, v236
v_add_f32 v225, v225, v237
v_mfma_f32_16x16x32_bf16 a[176:179], a[240:243], v[196:199], a[176:179]
s_waitcnt lgkmcnt(4)
v_exp_f32 v234, v148
v_mfma_f32_16x16x32_bf16 a[180:183], a[244:247], v[180:183], a[180:183]
s_min_u32 s32, s32, s42
v_exp_f32 v235, v149
v_mfma_f32_16x16x32_bf16 a[184:187], a[244:247], v[184:187], a[184:187]
v_exp_f32 v236, v150
v_mfma_f32_16x16x32_bf16 a[188:191], a[244:247], v[188:191], a[188:191]
v_exp_f32 v237, v151
v_mfma_f32_16x16x32_bf16 a[192:195], a[244:247], v[192:195], a[192:195]
s_waitcnt vmcnt(63) lgkmcnt(0)
s_barrier
ds_read_b128 a[240:243], v238 offset:0
v_mfma_f32_16x16x32_bf16 a[196:199], a[244:247], v[196:199], a[196:199]
s_waitcnt lgkmcnt(15)
ds_read_b128 a[244:247], v239 offset:0
v_cvt_pk_bf16_f32 v166, v230, v231
v_mfma_f32_16x16x32_bf16 a[200:203], a[248:251], v[180:183], a[200:203]
s_add_u32 m0, s31, s37
v_add_f32 v226, v230, v231
v_cvt_pk_bf16_f32 v167, v232, v233
v_mfma_f32_16x16x32_bf16 a[204:207], a[248:251], v[184:187], a[204:207]
s_waitcnt vmcnt(5)
v_add_f32 v226, v226, v232
v_add_f32 v226, v226, v233
v_mfma_f32_16x16x32_bf16 a[208:211], a[248:251], v[188:191], a[208:211]
buffer_load_dwordx4 v245, s[16:19], s34 offen offset:0 nt lds
v_mfma_f32_16x16x32_bf16 a[212:215], a[248:251], v[192:195], a[212:215]
s_waitcnt vmcnt(5)
v_exp_f32 v230, v152
v_mfma_f32_16x16x32_bf16 a[216:219], a[248:251], v[196:199], a[216:219]
s_waitcnt lgkmcnt(15)
ds_read_b128 a[248:251], v238 offset:128
v_cvt_pk_bf16_f32 v170, v234, v235
v_mfma_f32_16x16x32_bf16 a[220:223], a[252:255], v[180:183], a[220:223]
v_exp_f32 v231, v153
v_mfma_f32_16x16x32_bf16 a[224:227], a[252:255], v[184:187], a[224:227]
v_exp_f32 v232, v154
v_mfma_f32_16x16x32_bf16 a[228:231], a[252:255], v[188:191], a[228:231]
v_exp_f32 v233, v155
v_mfma_f32_16x16x32_bf16 a[232:235], a[252:255], v[192:195], a[232:235]
v_add_f32 v227, v234, v235
v_cvt_pk_bf16_f32 v171, v236, v237
v_mfma_f32_16x16x32_bf16 a[236:239], a[252:255], v[196:199], a[236:239]
s_waitcnt lgkmcnt(2)
ds_read_b128 a[252:255], v239 offset:128
v_add_f32 v227, v227, v236
v_mfma_f32_16x16x32_bf16 v[120:123], a[240:243], v[0:3], v[200:203]
buffer_load_dwordx4 v246, s[16:19], s34 offen offset:1024 nt lds
v_mfma_f32_16x16x32_bf16 v[124:127], a[240:243], v[4:7], v[204:207]
s_waitcnt vmcnt(5)
v_add_f32 v227, v227, v237
v_cvt_pk_bf16_f32 v174, v230, v231
v_mfma_f32_16x16x32_bf16 v[128:131], a[240:243], v[8:11], v[208:211]
v_exp_f32 v234, v156
v_mfma_f32_16x16x32_bf16 v[132:135], a[240:243], v[12:15], v[212:215]
v_exp_f32 v235, v157
v_mfma_f32_16x16x32_bf16 v[136:139], a[240:243], v[16:19], v[216:219]
s_waitcnt lgkmcnt(2)
ds_read_b128 a[240:243], v238 offset:256
v_add_f32 v228, v230, v231
v_mfma_f32_16x16x32_bf16 v[120:123], a[244:247], v[20:23], v[120:123]
v_exp_f32 v236, v158
v_mfma_f32_16x16x32_bf16 v[124:127], a[244:247], v[24:27], v[124:127]
v_exp_f32 v237, v159
v_mfma_f32_16x16x32_bf16 v[128:131], a[244:247], v[28:31], v[128:131]
v_cvt_pk_bf16_f32 v175, v232, v233
v_add_f32 v228, v228, v232
v_mfma_f32_16x16x32_bf16 v[132:135], a[244:247], v[32:35], v[132:135]
buffer_load_dwordx4 v247, s[16:19], s34 offen offset:2048 nt lds
v_mfma_f32_16x16x32_bf16 v[136:139], a[244:247], v[36:39], v[136:139]
s_waitcnt lgkmcnt(2)
ds_read_b128 a[244:247], v239 offset:256
v_add_f32 v228, v228, v233
v_mfma_f32_16x16x32_bf16 v[120:123], a[248:251], v[40:43], v[120:123]
s_add_u32 m0, m0, 3072
v_cvt_pk_bf16_f32 v178, v234, v235
v_add_f32 v229, v234, v235
v_mfma_f32_16x16x32_bf16 v[124:127], a[248:251], v[44:47], v[124:127]
s_add_u32 s40, s34, 3072
v_cvt_pk_bf16_f32 v179, v236, v237
v_add_f32 v229, v229, v236
v_mfma_f32_16x16x32_bf16 v[128:131], a[248:251], v[48:51], v[128:131]
s_waitcnt vmcnt(5)
v_add_f32 v229, v229, v237
v_max3_f32 v244, v225, v226, v227
v_mfma_f32_16x16x32_bf16 v[132:135], a[248:251], v[52:55], v[132:135]
v_max3_f32 v244, v244, v228, v229
v_cmp_ngt_f32 vcc, 2.0, v244
v_mfma_f32_16x16x32_bf16 v[136:139], a[248:251], v[56:59], v[136:139]
s_waitcnt lgkmcnt(2)
ds_read_b128 a[248:251], v238 offset:6144
v_mfma_f32_16x16x32_bf16 v[120:123], a[252:255], v[60:63], v[120:123]
v_mfma_f32_16x16x32_bf16 v[124:127], a[252:255], v[64:67], v[124:127]
buffer_load_dwordx4 v245, s[16:19], s40 offen offset:0 nt lds
v_mfma_f32_16x16x32_bf16 v[128:131], a[252:255], v[68:71], v[128:131]
s_waitcnt vmcnt(5)
v_mfma_f32_16x16x32_bf16 v[132:135], a[252:255], v[72:75], v[132:135]
v_mfma_f32_16x16x32_bf16 v[136:139], a[252:255], v[76:79], v[136:139]
s_waitcnt lgkmcnt(2)
ds_read_b128 a[252:255], v239 offset:6144
v_mfma_f32_16x16x32_bf16 v[120:123], a[240:243], v[80:83], v[120:123]
v_mfma_f32_16x16x32_bf16 v[124:127], a[240:243], v[84:87], v[124:127]
v_mfma_f32_16x16x32_bf16 v[128:131], a[240:243], v[88:91], v[128:131]
v_mfma_f32_16x16x32_bf16 v[132:135], a[240:243], v[92:95], v[132:135]
v_mfma_f32_16x16x32_bf16 v[136:139], a[240:243], v[96:99], v[136:139]
s_waitcnt lgkmcnt(2)
ds_read_b128 a[240:243], v238 offset:6272
v_mfma_f32_16x16x32_bf16 v[120:123], a[244:247], v[100:103], v[120:123]
buffer_load_dwordx4 v246, s[16:19], s40 offen offset:1024 nt lds
v_mfma_f32_16x16x32_bf16 v[124:127], a[244:247], v[104:107], v[124:127]
s_waitcnt vmcnt(5)
v_mfma_f32_16x16x32_bf16 v[128:131], a[244:247], v[108:111], v[128:131]
v_mfma_f32_16x16x32_bf16 v[132:135], a[244:247], v[112:115], v[132:135]
v_mfma_f32_16x16x32_bf16 v[136:139], a[244:247], v[116:119], v[136:139]
s_cbranch_vccnz L_tr24
L_back24:
s_waitcnt lgkmcnt(2)
ds_read_b128 a[244:247], v239 offset:6272
v_mfma_f32_16x16x32_bf16 v[140:143], a[248:251], v[0:3], v[200:203]
v_exp_f32 v230, v120
v_mfma_f32_16x16x32_bf16 v[144:147], a[248:251], v[4:7], v[204:207]
v_exp_f32 v231, v121
v_mfma_f32_16x16x32_bf16 v[148:151], a[248:251], v[8:11], v[208:211]
v_exp_f32 v232, v122
v_mfma_f32_16x16x32_bf16 v[152:155], a[248:251], v[12:15], v[212:215]
buffer_load_dwordx4 v247, s[16:19], s40 offen offset:2048 nt lds
v_mfma_f32_16x16x32_bf16 v[156:159], a[248:251], v[16:19], v[216:219]
s_waitcnt lgkmcnt(2)
ds_read_b128 a[248:251], v238 offset:6400
v_add_f32 v220, v220, v225
v_mfma_f32_16x16x32_bf16 v[140:143], a[252:255], v[20:23], v[140:143]
s_add_u32 s34, s34, 12288
v_exp_f32 v233, v123
v_mfma_f32_16x16x32_bf16 v[144:147], a[252:255], v[24:27], v[144:147]
s_add_u32 s31, s31, 24576
v_exp_f32 v234, v124
v_mfma_f32_16x16x32_bf16 v[148:151], a[252:255], v[28:31], v[148:151]
s_sub_u32 s41, s31, 147456
v_exp_f32 v235, v125
v_mfma_f32_16x16x32_bf16 v[152:155], a[252:255], v[32:35], v[152:155]
s_min_u32 s31, s31, s41
v_exp_f32 v236, v126
v_mfma_f32_16x16x32_bf16 v[156:159], a[252:255], v[36:39], v[156:159]
s_waitcnt lgkmcnt(2)
ds_read_b128 a[252:255], v239 offset:6400
v_add_f32 v221, v221, v226
v_mfma_f32_16x16x32_bf16 v[140:143], a[240:243], v[40:43], v[140:143]
v_add_u32 v238, s32, v252
v_xor_b32 v239, 64, v238
v_mfma_f32_16x16x32_bf16 v[144:147], a[240:243], v[44:47], v[144:147]
s_add_u32 s32, s32, 24576
v_exp_f32 v237, v127
v_mfma_f32_16x16x32_bf16 v[148:151], a[240:243], v[48:51], v[148:151]
s_sub_u32 s42, s32, 147456
v_add_f32 v222, v222, v227
v_add_f32 v223, v223, v228
v_mfma_f32_16x16x32_bf16 v[152:155], a[240:243], v[52:55], v[152:155]
s_min_u32 s32, s32, s42
v_add_f32 v224, v224, v229
v_cvt_pk_bf16_f32 v180, v230, v231
v_mfma_f32_16x16x32_bf16 v[156:159], a[240:243], v[56:59], v[156:159]
s_waitcnt lgkmcnt(2)
v_add_f32 v225, v230, v231
v_cvt_pk_bf16_f32 v181, v232, v233
v_mfma_f32_16x16x32_bf16 v[140:143], a[244:247], v[60:63], v[140:143]
v_add_f32 v225, v225, v232
v_add_f32 v225, v225, v233
v_mfma_f32_16x16x32_bf16 v[144:147], a[244:247], v[64:67], v[144:147]
v_exp_f32 v230, v128
v_mfma_f32_16x16x32_bf16 v[148:151], a[244:247], v[68:71], v[148:151]
v_exp_f32 v231, v129
v_mfma_f32_16x16x32_bf16 v[152:155], a[244:247], v[72:75], v[152:155]
s_waitcnt vmcnt(63) lgkmcnt(0)
s_barrier
ds_read_b64_tr_b16 a[240:241], v240 offset:0
v_mfma_f32_16x16x32_bf16 v[156:159], a[244:247], v[76:79], v[156:159]
s_waitcnt lgkmcnt(15)
ds_read_b64_tr_b16 a[242:243], v240 offset:6144
ds_read_b64_tr_b16 a[244:245], v241 offset:0
v_mfma_f32_16x16x32_bf16 v[140:143], a[248:251], v[80:83], v[140:143]
s_add_u32 m0, s31, s37
ds_read_b64_tr_b16 a[246:247], v241 offset:6144
v_cvt_pk_bf16_f32 v184, v234, v235
v_mfma_f32_16x16x32_bf16 v[144:147], a[248:251], v[84:87], v[144:147]
s_waitcnt vmcnt(5)
v_exp_f32 v232, v130
v_mfma_f32_16x16x32_bf16 v[148:151], a[248:251], v[88:91], v[148:151]
buffer_load_dwordx4 v245, s[12:15], s33 offen offset:0 nt lds
v_mfma_f32_16x16x32_bf16 v[152:155], a[248:251], v[92:95], v[152:155]
s_waitcnt vmcnt(5)
v_exp_f32 v233, v131
v_mfma_f32_16x16x32_bf16 v[156:159], a[248:251], v[96:99], v[156:159]
s_waitcnt lgkmcnt(15)
ds_read_b64_tr_b16 a[248:249], v242 offset:0
ds_read_b64_tr_b16 a[250:251], v242 offset:6144
v_mfma_f32_16x16x32_bf16 v[140:143], a[252:255], v[100:103], v[140:143]
v_add_f32 v226, v234, v235
v_cvt_pk_bf16_f32 v185, v236, v237
v_mfma_f32_16x16x32_bf16 v[144:147], a[252:255], v[104:107], v[144:147]
v_add_f32 v226, v226, v236
v_add_f32 v226, v226, v237
v_mfma_f32_16x16x32_bf16 v[148:151], a[252:255], v[108:111], v[148:151]
v_exp_f32 v234, v132
v_mfma_f32_16x16x32_bf16 v[152:155], a[252:255], v[112:115], v[152:155]
v_exp_f32 v235, v133
v_mfma_f32_16x16x32_bf16 v[156:159], a[252:255], v[116:119], v[156:159]
s_waitcnt lgkmcnt(4)
ds_read_b64_tr_b16 a[252:253], v243 offset:0
ds_read_b64_tr_b16 a[254:255], v243 offset:6144
v_mfma_f32_16x16x32_bf16 a[0:3], a[240:243], v[160:163], a[0:3]
buffer_load_dwordx4 v246, s[12:15], s33 offen offset:1024 nt lds
v_mfma_f32_16x16x32_bf16 a[4:7], a[240:243], v[164:167], a[4:7]
s_waitcnt vmcnt(5)
v_exp_f32 v236, v134
v_mfma_f32_16x16x32_bf16 a[8:11], a[240:243], v[168:171], a[8:11]
v_exp_f32 v237, v135
v_mfma_f32_16x16x32_bf16 a[12:15], a[240:243], v[172:175], a[12:15]
v_cvt_pk_bf16_f32 v188, v230, v231
v_add_f32 v227, v230, v231
v_mfma_f32_16x16x32_bf16 a[16:19], a[240:243], v[176:179], a[16:19]
s_waitcnt lgkmcnt(4)
ds_read_b64_tr_b16 a[240:241], v240 offset:128
ds_read_b64_tr_b16 a[242:243], v240 offset:6272
v_mfma_f32_16x16x32_bf16 a[20:23], a[244:247], v[160:163], a[20:23]
v_cvt_pk_bf16_f32 v189, v232, v233
v_add_f32 v227, v227, v232
v_mfma_f32_16x16x32_bf16 a[24:27], a[244:247], v[164:167], a[24:27]
v_add_f32 v227, v227, v233
v_cvt_pk_bf16_f32 v192, v234, v235
v_mfma_f32_16x16x32_bf16 a[28:31], a[244:247], v[168:171], a[28:31]
v_exp_f32 v230, v136
v_mfma_f32_16x16x32_bf16 a[32:35], a[244:247], v[172:175], a[32:35]
buffer_load_dwordx4 v247, s[12:15], s33 offen offset:2048 nt lds
v_mfma_f32_16x16x32_bf16 a[36:39], a[244:247], v[176:179], a[36:39]
s_waitcnt lgkmcnt(4)
ds_read_b64_tr_b16 a[244:245], v241 offset:128
ds_read_b64_tr_b16 a[246:247], v241 offset:6272
v_mfma_f32_16x16x32_bf16 a[40:43], a[248:251], v[160:163], a[40:43]
s_add_u32 m0, m0, 3072
v_exp_f32 v231, v137
v_mfma_f32_16x16x32_bf16 a[44:47], a[248:251], v[164:167], a[44:47]
s_add_u32 s40, s33, 3072
v_exp_f32 v232, v138
v_mfma_f32_16x16x32_bf16 a[48:51], a[248:251], v[168:171], a[48:51]
s_waitcnt vmcnt(5)
v_exp_f32 v233, v139
v_mfma_f32_16x16x32_bf16 a[52:55], a[248:251], v[172:175], a[52:55]
v_add_f32 v228, v234, v235
v_cvt_pk_bf16_f32 v193, v236, v237
v_mfma_f32_16x16x32_bf16 a[56:59], a[248:251], v[176:179], a[56:59]
s_waitcnt lgkmcnt(4)
ds_read_b64_tr_b16 a[248:249], v242 offset:128
ds_read_b64_tr_b16 a[250:251], v242 offset:6272
v_mfma_f32_16x16x32_bf16 a[60:63], a[252:255], v[160:163], a[60:63]
v_add_f32 v228, v228, v236
v_add_f32 v228, v228, v237
v_mfma_f32_16x16x32_bf16 a[64:67], a[252:255], v[164:167], a[64:67]
buffer_load_dwordx4 v245, s[12:15], s40 offen offset:0 nt lds
v_mfma_f32_16x16x32_bf16 a[68:71], a[252:255], v[168:171], a[68:71]
s_waitcnt vmcnt(5)
v_cvt_pk_bf16_f32 v196, v230, v231
v_add_f32 v229, v230, v231
v_mfma_f32_16x16x32_bf16 a[72:75], a[252:255], v[172:175], a[72:75]
v_cvt_pk_bf16_f32 v197, v232, v233
v_add_f32 v229, v229, v232
v_mfma_f32_16x16x32_bf16 a[76:79], a[252:255], v[176:179], a[76:79]
s_waitcnt lgkmcnt(4)
ds_read_b64_tr_b16 a[252:253], v243 offset:128
ds_read_b64_tr_b16 a[254:255], v243 offset:6272
v_mfma_f32_16x16x32_bf16 a[80:83], a[240:243], v[160:163], a[80:83]
v_add_f32 v229, v229, v233
v_max3_f32 v244, v225, v226, v227
v_mfma_f32_16x16x32_bf16 a[84:87], a[240:243], v[164:167], a[84:87]
v_max3_f32 v244, v244, v228, v229
v_cmp_ngt_f32 vcc, 2.0, v244
v_mfma_f32_16x16x32_bf16 a[88:91], a[240:243], v[168:171], a[88:91]
s_cbranch_vccnz L_tr26
L_back26:
v_exp_f32 v234, v140
v_mfma_f32_16x16x32_bf16 a[92:95], a[240:243], v[172:175], a[92:95]
v_exp_f32 v235, v141
v_mfma_f32_16x16x32_bf16 a[96:99], a[240:243], v[176:179], a[96:99]
s_waitcnt lgkmcnt(4)
ds_read_b64_tr_b16 a[240:241], v240 offset:256
ds_read_b64_tr_b16 a[242:243], v240 offset:6400
v_mfma_f32_16x16x32_bf16 a[100:103], a[244:247], v[160:163], a[100:103]
buffer_load_dwordx4 v246, s[12:15], s40 offen offset:1024 nt lds
v_mfma_f32_16x16x32_bf16 a[104:107], a[244:247], v[164:167], a[104:107]
s_waitcnt vmcnt(5)
v_exp_f32 v236, v142
v_mfma_f32_16x16x32_bf16 a[108:111], a[244:247], v[168:171], a[108:111]
v_exp_f32 v237, v143
v_mfma_f32_16x16x32_bf16 a[112:115], a[244:247], v[172:175], a[112:115]
v_exp_f32 v230, v144
v_mfma_f32_16x16x32_bf16 a[116:119], a[244:247], v[176:179], a[116:119]
s_waitcnt lgkmcnt(4)
ds_read_b64_tr_b16 a[244:245], v241 offset:256
ds_read_b64_tr_b16 a[246:247], v241 offset:6400
v_mfma_f32_16x16x32_bf16 a[120:123], a[248:251], v[160:163], a[120:123]
v_exp_f32 v231, v145
v_mfma_f32_16x16x32_bf16 a[124:127], a[248:251], v[164:167], a[124:127]
v_exp_f32 v232, v146
v_mfma_f32_16x16x32_bf16 a[128:131], a[248:251], v[168:171], a[128:131]
v_exp_f32 v233, v147
v_mfma_f32_16x16x32_bf16 a[132:135], a[248:251], v[172:175], a[132:135]
buffer_load_dwordx4 v247, s[12:15], s40 offen offset:2048 nt lds
v_mfma_f32_16x16x32_bf16 a[136:139], a[248:251], v[176:179], a[136:139]
s_waitcnt lgkmcnt(4)
ds_read_b64_tr_b16 a[248:249], v242 offset:256
ds_read_b64_tr_b16 a[250:251], v242 offset:6400
v_mfma_f32_16x16x32_bf16 a[140:143], a[252:255], v[160:163], a[140:143]
s_add_u32 s33, s33, 12288
v_add_f32 v220, v220, v225
v_add_f32 v221, v221, v226
v_mfma_f32_16x16x32_bf16 a[144:147], a[252:255], v[164:167], a[144:147]
s_add_u32 s31, s31, 24576
v_add_f32 v222, v222, v227
v_add_f32 v223, v223, v228
v_mfma_f32_16x16x32_bf16 a[148:151], a[252:255], v[168:171], a[148:151]
s_sub_u32 s41, s31, 147456
v_add_f32 v224, v224, v229
v_cvt_pk_bf16_f32 v182, v234, v235
v_mfma_f32_16x16x32_bf16 a[152:155], a[252:255], v[172:175], a[152:155]
s_min_u32 s31, s31, s41
v_add_f32 v225, v234, v235
v_cvt_pk_bf16_f32 v183, v236, v237
v_mfma_f32_16x16x32_bf16 a[156:159], a[252:255], v[176:179], a[156:159]
s_waitcnt lgkmcnt(4)
ds_read_b64_tr_b16 a[252:253], v243 offset:256
ds_read_b64_tr_b16 a[254:255], v243 offset:6400
v_mfma_f32_16x16x32_bf16 a[160:163], a[240:243], v[160:163], a[160:163]
v_add_u32 v240, s32, v253
v_xor_b32 v241, 32, v240
v_mfma_f32_16x16x32_bf16 a[164:167], a[240:243], v[164:167], a[164:167]
v_xor_b32 v242, 64, v240
v_xor_b32 v243, 64, v241
v_mfma_f32_16x16x32_bf16 a[168:171], a[240:243], v[168:171], a[168:171]
s_add_u32 s32, s32, 24576
v_add_f32 v225, v225, v236
v_add_f32 v225, v225, v237
v_mfma_f32_16x16x32_bf16 a[172:175], a[240:243], v[172:175], a[172:175]
s_sub_u32 s42, s32, 147456
v_exp_f32 v234, v148
v_mfma_f32_16x16x32_bf16 a[176:179], a[240:243], v[176:179], a[176:179]
s_waitcnt lgkmcnt(4)
v_exp_f32 v235, v149
v_mfma_f32_16x16x32_bf16 a[180:183], a[244:247], v[160:163], a[180:183]
s_min_u32 s32, s32, s42
v_exp_f32 v236, v150
v_mfma_f32_16x16x32_bf16 a[184:187], a[244:247], v[164:167], a[184:187]
v_exp_f32 v237, v151
v_mfma_f32_16x16x32_bf16 a[188:191], a[244:247], v[168:171], a[188:191]
v_cvt_pk_bf16_f32 v186, v230, v231
v_add_f32 v226, v230, v231
v_mfma_f32_16x16x32_bf16 a[192:195], a[244:247], v[172:175], a[192:195]
s_waitcnt vmcnt(63) lgkmcnt(0)
s_barrier
ds_read_b128 a[240:243], v238 offset:0
v_mfma_f32_16x16x32_bf16 a[196:199], a[244:247], v[176:179], a[196:199]
s_waitcnt lgkmcnt(15)
ds_read_b128 a[244:247], v239 offset:0
v_cvt_pk_bf16_f32 v187, v232, v233
v_mfma_f32_16x16x32_bf16 a[200:203], a[248:251], v[160:163], a[200:203]
s_add_u32 m0, s31, s37
v_add_f32 v226, v226, v232
v_add_f32 v226, v226, v233
v_mfma_f32_16x16x32_bf16 a[204:207], a[248:251], v[164:167], a[204:207]
s_waitcnt vmcnt(5)
v_exp_f32 v230, v152
v_mfma_f32_16x16x32_bf16 a[208:211], a[248:251], v[168:171], a[208:211]
buffer_load_dwordx4 v245, s[16:19], s34 offen offset:0 nt lds
v_mfma_f32_16x16x32_bf16 a[212:215], a[248:251], v[172:175], a[212:215]
s_waitcnt vmcnt(5)
v_exp_f32 v231, v153
v_mfma_f32_16x16x32_bf16 a[216:219], a[248:251], v[176:179], a[216:219]
s_waitcnt lgkmcnt(15)
ds_read_b128 a[248:251], v238 offset:128
v_cvt_pk_bf16_f32 v190, v234, v235
v_mfma_f32_16x16x32_bf16 a[220:223], a[252:255], v[160:163], a[220:223]
v_exp_f32 v232, v154
v_mfma_f32_16x16x32_bf16 a[224:227], a[252:255], v[164:167], a[224:227]
v_exp_f32 v233, v155
v_mfma_f32_16x16x32_bf16 a[228:231], a[252:255], v[168:171], a[228:231]
v_add_f32 v227, v234, v235
v_cvt_pk_bf16_f32 v191, v236, v237
v_mfma_f32_16x16x32_bf16 a[232:235], a[252:255], v[172:175], a[232:235]
v_add_f32 v227, v227, v236
v_add_f32 v227, v227, v237
v_mfma_f32_16x16x32_bf16 a[236:239], a[252:255], v[176:179], a[236:239]
s_waitcnt lgkmcnt(2)
ds_read_b128 a[252:255], v239 offset:128
v_cvt_pk_bf16_f32 v194, v230, v231
v_mfma_f32_16x16x32_bf16 v[120:123], a[240:243], v[0:3], v[200:203]
buffer_load_dwordx4 v246, s[16:19], s34 offen offset:1024 nt lds
v_mfma_f32_16x16x32_bf16 v[124:127], a[240:243], v[4:7], v[204:207]
s_waitcnt vmcnt(5)
v_exp_f32 v234, v156
v_mfma_f32_16x16x32_bf16 v[128:131], a[240:243], v[8:11], v[208:211]
v_exp_f32 v235, v157
v_mfma_f32_16x16x32_bf16 v[132:135], a[240:243], v[12:15], v[212:215]
v_exp_f32 v236, v158
v_mfma_f32_16x16x32_bf16 v[136:139], a[240:243], v[16:19], v[216:219]
s_waitcnt lgkmcnt(2)
ds_read_b128 a[240:243], v238 offset:256
v_add_f32 v228, v230, v231
v_mfma_f32_16x16x32_bf16 v[120:123], a[244:247], v[20:23], v[120:123]
v_exp_f32 v237, v159
v_mfma_f32_16x16x32_bf16 v[124:127], a[244:247], v[24:27], v[124:127]
v_cvt_pk_bf16_f32 v195, v232, v233
v_add_f32 v228, v228, v232
v_mfma_f32_16x16x32_bf16 v[128:131], a[244:247], v[28:31], v[128:131]
v_add_f32 v228, v228, v233
v_cvt_pk_bf16_f32 v198, v234, v235
v_mfma_f32_16x16x32_bf16 v[132:135], a[244:247], v[32:35], v[132:135]
buffer_load_dwordx4 v247, s[16:19], s34 offen offset:2048 nt lds
v_mfma_f32_16x16x32_bf16 v[136:139], a[244:247], v[36:39], v[136:139]
s_waitcnt lgkmcnt(2)
ds_read_b128 a[244:247], v239 offset:256
v_add_f32 v229, v234, v235
v_mfma_f32_16x16x32_bf16 v[120:123], a[248:251], v[40:43], v[120:123]
s_add_u32 m0, m0, 3072
v_cvt_pk_bf16_f32 v199, v236, v237
v_add_f32 v229, v229, v236
v_mfma_f32_16x16x32_bf16 v[124:127], a[248:251], v[44:47], v[124:127]
s_add_u32 s40, s34, 3072
v_add_f32 v229, v229, v237
v_max3_f32 v244, v225, v226, v227
v_mfma_f32_16x16x32_bf16 v[128:131], a[248:251], v[48:51], v[128:131]
s_waitcnt vmcnt(5)
v_max3_f32 v244, v244, v228, v229
v_cmp_ngt_f32 vcc, 2.0, v244
v_mfma_f32_16x16x32_bf16 v[132:135], a[248:251], v[52:55], v[132:135]
v_mfma_f32_16x16x32_bf16 v[136:139], a[248:251], v[56:59], v[136:139]
s_waitcnt lgkmcnt(2)
ds_read_b128 a[248:251], v238 offset:6144
v_mfma_f32_16x16x32_bf16 v[120:123], a[252:255], v[60:63], v[120:123]
v_mfma_f32_16x16x32_bf16 v[124:127], a[252:255], v[64:67], v[124:127]
buffer_load_dwordx4 v245, s[16:19], s40 offen offset:0 nt lds
v_mfma_f32_16x16x32_bf16 v[128:131], a[252:255], v[68:71], v[128:131]
s_waitcnt vmcnt(5)
v_mfma_f32_16x16x32_bf16 v[132:135], a[252:255], v[72:75], v[132:135]
v_mfma_f32_16x16x32_bf16 v[136:139], a[252:255], v[76:79], v[136:139]
s_waitcnt lgkmcnt(2)
ds_read_b128 a[252:255], v239 offset:6144
v_mfma_f32_16x16x32_bf16 v[120:123], a[240:243], v[80:83], v[120:123]
v_mfma_f32_16x16x32_bf16 v[124:127], a[240:243], v[84:87], v[124:127]
v_mfma_f32_16x16x32_bf16 v[128:131], a[240:243], v[88:91], v[128:131]
v_mfma_f32_16x16x32_bf16 v[132:135], a[240:243], v[92:95], v[132:135]
v_mfma_f32_16x16x32_bf16 v[136:139], a[240:243], v[96:99], v[136:139]
s_waitcnt lgkmcnt(2)
ds_read_b128 a[240:243], v238 offset:6272
v_mfma_f32_16x16x32_bf16 v[120:123], a[244:247], v[100:103], v[120:123]
buffer_load_dwordx4 v246, s[16:19], s40 offen offset:1024 nt lds
v_mfma_f32_16x16x32_bf16 v[124:127], a[244:247], v[104:107], v[124:127]
s_waitcnt vmcnt(5)
v_mfma_f32_16x16x32_bf16 v[128:131], a[244:247], v[108:111], v[128:131]
v_mfma_f32_16x16x32_bf16 v[132:135], a[244:247], v[112:115], v[132:135]
v_mfma_f32_16x16x32_bf16 v[136:139], a[244:247], v[116:119], v[136:139]
s_cbranch_vccnz L_tr27
L_back27:
s_waitcnt lgkmcnt(2)
ds_read_b128 a[244:247], v239 offset:6272
s_mov_b32 s44, 4
.p2align 3
L_concat_heads__mha_block_cached__gqa_block_cached__near_ridge_kernel_a:
v_mfma_f32_16x16x32_bf16 v[140:143], a[248:251], v[0:3], v[200:203]
v_exp_f32 v230, v120
v_mfma_f32_16x16x32_bf16 v[144:147], a[248:251], v[4:7], v[204:207]
v_exp_f32 v231, v121
v_mfma_f32_16x16x32_bf16 v[148:151], a[248:251], v[8:11], v[208:211]
v_exp_f32 v232, v122
v_mfma_f32_16x16x32_bf16 v[152:155], a[248:251], v[12:15], v[212:215]
buffer_load_dwordx4 v247, s[16:19], s40 offen offset:2048 nt lds
v_mfma_f32_16x16x32_bf16 v[156:159], a[248:251], v[16:19], v[216:219]
s_waitcnt lgkmcnt(2)
ds_read_b128 a[248:251], v238 offset:6400
v_add_f32 v220, v220, v225
v_mfma_f32_16x16x32_bf16 v[140:143], a[252:255], v[20:23], v[140:143]
s_add_u32 s34, s34, 12288
v_exp_f32 v233, v123
v_mfma_f32_16x16x32_bf16 v[144:147], a[252:255], v[24:27], v[144:147]
s_add_u32 s31, s31, 24576
v_exp_f32 v234, v124
v_mfma_f32_16x16x32_bf16 v[148:151], a[252:255], v[28:31], v[148:151]
s_sub_u32 s41, s31, 147456
v_exp_f32 v235, v125
v_mfma_f32_16x16x32_bf16 v[152:155], a[252:255], v[32:35], v[152:155]
s_min_u32 s31, s31, s41
v_exp_f32 v236, v126
v_mfma_f32_16x16x32_bf16 v[156:159], a[252:255], v[36:39], v[156:159]
s_waitcnt lgkmcnt(2)
ds_read_b128 a[252:255], v239 offset:6400
v_add_f32 v221, v221, v226
v_mfma_f32_16x16x32_bf16 v[140:143], a[240:243], v[40:43], v[140:143]
v_add_u32 v238, s32, v252
v_xor_b32 v239, 64, v238
v_mfma_f32_16x16x32_bf16 v[144:147], a[240:243], v[44:47], v[144:147]
s_add_u32 s32, s32, 24576
v_exp_f32 v237, v127
v_mfma_f32_16x16x32_bf16 v[148:151], a[240:243], v[48:51], v[148:151]
s_sub_u32 s42, s32, 147456
v_add_f32 v222, v222, v227
v_add_f32 v223, v223, v228
v_mfma_f32_16x16x32_bf16 v[152:155], a[240:243], v[52:55], v[152:155]
s_min_u32 s32, s32, s42
v_add_f32 v224, v224, v229
v_cvt_pk_bf16_f32 v160, v230, v231
v_mfma_f32_16x16x32_bf16 v[156:159], a[240:243], v[56:59], v[156:159]
s_waitcnt lgkmcnt(2)
v_add_f32 v225, v230, v231
v_cvt_pk_bf16_f32 v161, v232, v233
v_mfma_f32_16x16x32_bf16 v[140:143], a[244:247], v[60:63], v[140:143]
v_add_f32 v225, v225, v232
v_add_f32 v225, v225, v233
v_mfma_f32_16x16x32_bf16 v[144:147], a[244:247], v[64:67], v[144:147]
v_exp_f32 v230, v128
v_mfma_f32_16x16x32_bf16 v[148:151], a[244:247], v[68:71], v[148:151]
v_exp_f32 v231, v129
v_mfma_f32_16x16x32_bf16 v[152:155], a[244:247], v[72:75], v[152:155]
s_waitcnt vmcnt(63) lgkmcnt(0)
s_barrier
ds_read_b64_tr_b16 a[240:241], v240 offset:0
v_mfma_f32_16x16x32_bf16 v[156:159], a[244:247], v[76:79], v[156:159]
s_waitcnt lgkmcnt(15)
ds_read_b64_tr_b16 a[242:243], v240 offset:6144
ds_read_b64_tr_b16 a[244:245], v241 offset:0
v_mfma_f32_16x16x32_bf16 v[140:143], a[248:251], v[80:83], v[140:143]
s_add_u32 m0, s31, s37
ds_read_b64_tr_b16 a[246:247], v241 offset:6144
v_cvt_pk_bf16_f32 v164, v234, v235
v_mfma_f32_16x16x32_bf16 v[144:147], a[248:251], v[84:87], v[144:147]
s_waitcnt vmcnt(5)
v_exp_f32 v232, v130
v_mfma_f32_16x16x32_bf16 v[148:151], a[248:251], v[88:91], v[148:151]
buffer_load_dwordx4 v245, s[12:15], s33 offen offset:0 nt lds
v_mfma_f32_16x16x32_bf16 v[152:155], a[248:251], v[92:95], v[152:155]
s_waitcnt vmcnt(5)
v_exp_f32 v233, v131
v_mfma_f32_16x16x32_bf16 v[156:159], a[248:251], v[96:99], v[156:159]
s_waitcnt lgkmcnt(15)
ds_read_b64_tr_b16 a[248:249], v242 offset:0
ds_read_b64_tr_b16 a[250:251], v242 offset:6144
v_mfma_f32_16x16x32_bf16 v[140:143], a[252:255], v[100:103], v[140:143]
v_add_f32 v226, v234, v235
v_cvt_pk_bf16_f32 v165, v236, v237
v_mfma_f32_16x16x32_bf16 v[144:147], a[252:255], v[104:107], v[144:147]
v_add_f32 v226, v226, v236
v_add_f32 v226, v226, v237
v_mfma_f32_16x16x32_bf16 v[148:151], a[252:255], v[108:111], v[148:151]
v_exp_f32 v234, v132
v_mfma_f32_16x16x32_bf16 v[152:155], a[252:255], v[112:115], v[152:155]
v_exp_f32 v235, v133
v_mfma_f32_16x16x32_bf16 v[156:159], a[252:255], v[116:119], v[156:159]
s_waitcnt lgkmcnt(4)
ds_read_b64_tr_b16 a[252:253], v243 offset:0
ds_read_b64_tr_b16 a[254:255], v243 offset:6144
v_mfma_f32_16x16x32_bf16 a[0:3], a[240:243], v[180:183], a[0:3]
buffer_load_dwordx4 v246, s[12:15], s33 offen offset:1024 nt lds
v_mfma_f32_16x16x32_bf16 a[4:7], a[240:243], v[184:187], a[4:7]
s_waitcnt vmcnt(5)
v_exp_f32 v236, v134
v_mfma_f32_16x16x32_bf16 a[8:11], a[240:243], v[188:191], a[8:11]
v_exp_f32 v237, v135
v_mfma_f32_16x16x32_bf16 a[12:15], a[240:243], v[192:195], a[12:15]
v_cvt_pk_bf16_f32 v168, v230, v231
v_add_f32 v227, v230, v231
v_mfma_f32_16x16x32_bf16 a[16:19], a[240:243], v[196:199], a[16:19]
s_waitcnt lgkmcnt(4)
ds_read_b64_tr_b16 a[240:241], v240 offset:128
ds_read_b64_tr_b16 a[242:243], v240 offset:6272
v_mfma_f32_16x16x32_bf16 a[20:23], a[244:247], v[180:183], a[20:23]
v_cvt_pk_bf16_f32 v169, v232, v233
v_add_f32 v227, v227, v232
v_mfma_f32_16x16x32_bf16 a[24:27], a[244:247], v[184:187], a[24:27]
v_add_f32 v227, v227, v233
v_cvt_pk_bf16_f32 v172, v234, v235
v_mfma_f32_16x16x32_bf16 a[28:31], a[244:247], v[188:191], a[28:31]
v_exp_f32 v230, v136
v_mfma_f32_16x16x32_bf16 a[32:35], a[244:247], v[192:195], a[32:35]
buffer_load_dwordx4 v247, s[12:15], s33 offen offset:2048 nt lds
v_mfma_f32_16x16x32_bf16 a[36:39], a[244:247], v[196:199], a[36:39]
s_waitcnt lgkmcnt(4)
ds_read_b64_tr_b16 a[244:245], v241 offset:128
ds_read_b64_tr_b16 a[246:247], v241 offset:6272
v_mfma_f32_16x16x32_bf16 a[40:43], a[248:251], v[180:183], a[40:43]
s_add_u32 m0, m0, 3072
v_exp_f32 v231, v137
v_mfma_f32_16x16x32_bf16 a[44:47], a[248:251], v[184:187], a[44:47]
s_add_u32 s40, s33, 3072
v_exp_f32 v232, v138
v_mfma_f32_16x16x32_bf16 a[48:51], a[248:251], v[188:191], a[48:51]
s_waitcnt vmcnt(5)
v_exp_f32 v233, v139
v_mfma_f32_16x16x32_bf16 a[52:55], a[248:251], v[192:195], a[52:55]
v_add_f32 v228, v234, v235
v_cvt_pk_bf16_f32 v173, v236, v237
v_mfma_f32_16x16x32_bf16 a[56:59], a[248:251], v[196:199], a[56:59]
s_waitcnt lgkmcnt(4)
ds_read_b64_tr_b16 a[248:249], v242 offset:128
ds_read_b64_tr_b16 a[250:251], v242 offset:6272
v_mfma_f32_16x16x32_bf16 a[60:63], a[252:255], v[180:183], a[60:63]
v_add_f32 v228, v228, v236
v_add_f32 v228, v228, v237
v_mfma_f32_16x16x32_bf16 a[64:67], a[252:255], v[184:187], a[64:67]
buffer_load_dwordx4 v245, s[12:15], s40 offen offset:0 nt lds
v_mfma_f32_16x16x32_bf16 a[68:71], a[252:255], v[188:191], a[68:71]
s_waitcnt vmcnt(5)
v_cvt_pk_bf16_f32 v176, v230, v231
v_add_f32 v229, v230, v231
v_mfma_f32_16x16x32_bf16 a[72:75], a[252:255], v[192:195], a[72:75]
v_cvt_pk_bf16_f32 v177, v232, v233
v_add_f32 v229, v229, v232
v_mfma_f32_16x16x32_bf16 a[76:79], a[252:255], v[196:199], a[76:79]
s_waitcnt lgkmcnt(4)
ds_read_b64_tr_b16 a[252:253], v243 offset:128
ds_read_b64_tr_b16 a[254:255], v243 offset:6272
v_mfma_f32_16x16x32_bf16 a[80:83], a[240:243], v[180:183], a[80:83]
v_add_f32 v229, v229, v233
v_max3_f32 v244, v225, v226, v227
v_mfma_f32_16x16x32_bf16 a[84:87], a[240:243], v[184:187], a[84:87]
v_max3_f32 v244, v244, v228, v229
v_cmp_ngt_f32 vcc, 2.0, v244
v_mfma_f32_16x16x32_bf16 a[88:91], a[240:243], v[188:191], a[88:91]
s_cbranch_vccnz L_tr29
L_back29:
v_exp_f32 v234, v140
v_mfma_f32_16x16x32_bf16 a[92:95], a[240:243], v[192:195], a[92:95]
v_exp_f32 v235, v141
v_mfma_f32_16x16x32_bf16 a[96:99], a[240:243], v[196:199], a[96:99]
s_waitcnt lgkmcnt(4)
ds_read_b64_tr_b16 a[240:241], v240 offset:256
ds_read_b64_tr_b16 a[242:243], v240 offset:6400
v_mfma_f32_16x16x32_bf16 a[100:103], a[244:247], v[180:183], a[100:103]
buffer_load_dwordx4 v246, s[12:15], s40 offen offset:1024 nt lds
v_mfma_f32_16x16x32_bf16 a[104:107], a[244:247], v[184:187], a[104:107]
s_waitcnt vmcnt(5)
v_exp_f32 v236, v142
v_mfma_f32_16x16x32_bf16 a[108:111], a[244:247], v[188:191], a[108:111]
v_exp_f32 v237, v143
v_mfma_f32_16x16x32_bf16 a[112:115], a[244:247], v[192:195], a[112:115]
v_exp_f32 v230, v144
v_mfma_f32_16x16x32_bf16 a[116:119], a[244:247], v[196:199], a[116:119]
s_waitcnt lgkmcnt(4)
ds_read_b64_tr_b16 a[244:245], v241 offset:256
ds_read_b64_tr_b16 a[246:247], v241 offset:6400
v_mfma_f32_16x16x32_bf16 a[120:123], a[248:251], v[180:183], a[120:123]
v_exp_f32 v231, v145
v_mfma_f32_16x16x32_bf16 a[124:127], a[248:251], v[184:187], a[124:127]
v_exp_f32 v232, v146
v_mfma_f32_16x16x32_bf16 a[128:131], a[248:251], v[188:191], a[128:131]
v_exp_f32 v233, v147
v_mfma_f32_16x16x32_bf16 a[132:135], a[248:251], v[192:195], a[132:135]
buffer_load_dwordx4 v247, s[12:15], s40 offen offset:2048 nt lds
v_mfma_f32_16x16x32_bf16 a[136:139], a[248:251], v[196:199], a[136:139]
s_waitcnt lgkmcnt(4)
ds_read_b64_tr_b16 a[248:249], v242 offset:256
ds_read_b64_tr_b16 a[250:251], v242 offset:6400
v_mfma_f32_16x16x32_bf16 a[140:143], a[252:255], v[180:183], a[140:143]
s_add_u32 s33, s33, 12288
v_add_f32 v220, v220, v225
v_add_f32 v221, v221, v226
v_mfma_f32_16x16x32_bf16 a[144:147], a[252:255], v[184:187], a[144:147]
s_add_u32 s31, s31, 24576
v_add_f32 v222, v222, v227
v_add_f32 v223, v223, v228
v_mfma_f32_16x16x32_bf16 a[148:151], a[252:255], v[188:191], a[148:151]
s_sub_u32 s41, s31, 147456
v_add_f32 v224, v224, v229
v_cvt_pk_bf16_f32 v162, v234, v235
v_mfma_f32_16x16x32_bf16 a[152:155], a[252:255], v[192:195], a[152:155]
s_min_u32 s31, s31, s41
v_add_f32 v225, v234, v235
v_cvt_pk_bf16_f32 v163, v236, v237
v_mfma_f32_16x16x32_bf16 a[156:159], a[252:255], v[196:199], a[156:159]
s_waitcnt lgkmcnt(4)
ds_read_b64_tr_b16 a[252:253], v243 offset:256
ds_read_b64_tr_b16 a[254:255], v243 offset:6400
v_mfma_f32_16x16x32_bf16 a[160:163], a[240:243], v[180:183], a[160:163]
v_add_u32 v240, s32, v253
v_xor_b32 v241, 32, v240
v_mfma_f32_16x16x32_bf16 a[164:167], a[240:243], v[184:187], a[164:167]
v_xor_b32 v242, 64, v240
v_xor_b32 v243, 64, v241
v_mfma_f32_16x16x32_bf16 a[168:171], a[240:243], v[188:191], a[168:171]
s_add_u32 s32, s32, 24576
v_add_f32 v225, v225, v236
v_add_f32 v225, v225, v237
v_mfma_f32_16x16x32_bf16 a[172:175], a[240:243], v[192:195], a[172:175]
s_sub_u32 s42, s32, 147456
v_exp_f32 v234, v148
v_mfma_f32_16x16x32_bf16 a[176:179], a[240:243], v[196:199], a[176:179]
s_waitcnt lgkmcnt(4)
v_exp_f32 v235, v149
v_mfma_f32_16x16x32_bf16 a[180:183], a[244:247], v[180:183], a[180:183]
s_min_u32 s32, s32, s42
v_exp_f32 v236, v150
v_mfma_f32_16x16x32_bf16 a[184:187], a[244:247], v[184:187], a[184:187]
v_exp_f32 v237, v151
v_mfma_f32_16x16x32_bf16 a[188:191], a[244:247], v[188:191], a[188:191]
v_cvt_pk_bf16_f32 v166, v230, v231
v_add_f32 v226, v230, v231
v_mfma_f32_16x16x32_bf16 a[192:195], a[244:247], v[192:195], a[192:195]
s_waitcnt vmcnt(63) lgkmcnt(0)
s_barrier
ds_read_b128 a[240:243], v238 offset:0
v_mfma_f32_16x16x32_bf16 a[196:199], a[244:247], v[196:199], a[196:199]
s_waitcnt lgkmcnt(15)
ds_read_b128 a[244:247], v239 offset:0
v_cvt_pk_bf16_f32 v167, v232, v233
v_mfma_f32_16x16x32_bf16 a[200:203], a[248:251], v[180:183], a[200:203]
s_add_u32 m0, s31, s37
v_add_f32 v226, v226, v232
v_add_f32 v226, v226, v233
v_mfma_f32_16x16x32_bf16 a[204:207], a[248:251], v[184:187], a[204:207]
s_waitcnt vmcnt(5)
v_exp_f32 v230, v152
v_mfma_f32_16x16x32_bf16 a[208:211], a[248:251], v[188:191], a[208:211]
buffer_load_dwordx4 v245, s[16:19], s34 offen offset:0 nt lds
v_mfma_f32_16x16x32_bf16 a[212:215], a[248:251], v[192:195], a[212:215]
s_waitcnt vmcnt(5)
v_exp_f32 v231, v153
v_mfma_f32_16x16x32_bf16 a[216:219], a[248:251], v[196:199], a[216:219]
s_waitcnt lgkmcnt(15)
ds_read_b128 a[248:251], v238 offset:128
v_cvt_pk_bf16_f32 v170, v234, v235
v_mfma_f32_16x16x32_bf16 a[220:223], a[252:255], v[180:183], a[220:223]
v_exp_f32 v232, v154
v_mfma_f32_16x16x32_bf16 a[224:227], a[252:255], v[184:187], a[224:227]
v_exp_f32 v233, v155
v_mfma_f32_16x16x32_bf16 a[228:231], a[252:255], v[188:191], a[228:231]
v_add_f32 v227, v234, v235
v_cvt_pk_bf16_f32 v171, v236, v237
v_mfma_f32_16x16x32_bf16 a[232:235], a[252:255], v[192:195], a[232:235]
v_add_f32 v227, v227, v236
v_add_f32 v227, v227, v237
v_mfma_f32_16x16x32_bf16 a[236:239], a[252:255], v[196:199], a[236:239]
s_waitcnt lgkmcnt(2)
ds_read_b128 a[252:255], v239 offset:128
v_cvt_pk_bf16_f32 v174, v230, v231
v_mfma_f32_16x16x32_bf16 v[120:123], a[240:243], v[0:3], v[200:203]
buffer_load_dwordx4 v246, s[16:19], s34 offen offset:1024 nt lds
v_mfma_f32_16x16x32_bf16 v[124:127], a[240:243], v[4:7], v[204:207]
s_waitcnt vmcnt(5)
v_exp_f32 v234, v156
v_mfma_f32_16x16x32_bf16 v[128:131], a[240:243], v[8:11], v[208:211]
v_exp_f32 v235, v157
v_mfma_f32_16x16x32_bf16 v[132:135], a[240:243], v[12:15], v[212:215]
v_exp_f32 v236, v158
v_mfma_f32_16x16x32_bf16 v[136:139], a[240:243], v[16:19], v[216:219]
s_waitcnt lgkmcnt(2)
ds_read_b128 a[240:243], v238 offset:256
v_add_f32 v228, v230, v231
v_mfma_f32_16x16x32_bf16 v[120:123], a[244:247], v[20:23], v[120:123]
v_exp_f32 v237, v159
v_mfma_f32_16x16x32_bf16 v[124:127], a[244:247], v[24:27], v[124:127]
v_cvt_pk_bf16_f32 v175, v232, v233
v_add_f32 v228, v228, v232
v_mfma_f32_16x16x32_bf16 v[128:131], a[244:247], v[28:31], v[128:131]
v_add_f32 v228, v228, v233
v_cvt_pk_bf16_f32 v178, v234, v235
v_mfma_f32_16x16x32_bf16 v[132:135], a[244:247], v[32:35], v[132:135]
buffer_load_dwordx4 v247, s[16:19], s34 offen offset:2048 nt lds
v_mfma_f32_16x16x32_bf16 v[136:139], a[244:247], v[36:39], v[136:139]
s_waitcnt lgkmcnt(2)
ds_read_b128 a[244:247], v239 offset:256
v_add_f32 v229, v234, v235
v_mfma_f32_16x16x32_bf16 v[120:123], a[248:251], v[40:43], v[120:123]
s_add_u32 m0, m0, 3072
v_cvt_pk_bf16_f32 v179, v236, v237
v_add_f32 v229, v229, v236
v_mfma_f32_16x16x32_bf16 v[124:127], a[248:251], v[44:47], v[124:127]
s_add_u32 s40, s34, 3072
v_add_f32 v229, v229, v237
v_max3_f32 v244, v225, v226, v227
v_mfma_f32_16x16x32_bf16 v[128:131], a[248:251], v[48:51], v[128:131]
s_waitcnt vmcnt(5)
v_max3_f32 v244, v244, v228, v229
v_cmp_ngt_f32 vcc, 2.0, v244
v_mfma_f32_16x16x32_bf16 v[132:135], a[248:251], v[52:55], v[132:135]
v_mfma_f32_16x16x32_bf16 v[136:139], a[248:251], v[56:59], v[136:139]
s_waitcnt lgkmcnt(2)
ds_read_b128 a[248:251], v238 offset:6144
v_mfma_f32_16x16x32_bf16 v[120:123], a[252:255], v[60:63], v[120:123]
v_mfma_f32_16x16x32_bf16 v[124:127], a[252:255], v[64:67], v[124:127]
buffer_load_dwordx4 v245, s[16:19], s40 offen offset:0 nt lds
v_mfma_f32_16x16x32_bf16 v[128:131], a[252:255], v[68:71], v[128:131]
s_waitcnt vmcnt(5)
v_mfma_f32_16x16x32_bf16 v[132:135], a[252:255], v[72:75], v[132:135]
v_mfma_f32_16x16x32_bf16 v[136:139], a[252:255], v[76:79], v[136:139]
s_waitcnt lgkmcnt(2)
ds_read_b128 a[252:255], v239 offset:6144
v_mfma_f32_16x16x32_bf16 v[120:123], a[240:243], v[80:83], v[120:123]
v_mfma_f32_16x16x32_bf16 v[124:127], a[240:243], v[84:87], v[124:127]
v_mfma_f32_16x16x32_bf16 v[128:131], a[240:243], v[88:91], v[128:131]
v_mfma_f32_16x16x32_bf16 v[132:135], a[240:243], v[92:95], v[132:135]
v_mfma_f32_16x16x32_bf16 v[136:139], a[240:243], v[96:99], v[136:139]
s_waitcnt lgkmcnt(2)
ds_read_b128 a[240:243], v238 offset:6272
v_mfma_f32_16x16x32_bf16 v[120:123], a[244:247], v[100:103], v[120:123]
buffer_load_dwordx4 v246, s[16:19], s40 offen offset:1024 nt lds
v_mfma_f32_16x16x32_bf16 v[124:127], a[244:247], v[104:107], v[124:127]
s_waitcnt vmcnt(5)
v_mfma_f32_16x16x32_bf16 v[128:131], a[244:247], v[108:111], v[128:131]
v_mfma_f32_16x16x32_bf16 v[132:135], a[244:247], v[112:115], v[132:135]
v_mfma_f32_16x16x32_bf16 v[136:139], a[244:247], v[116:119], v[136:139]
s_cbranch_vccnz L_tr30
L_back30:
s_waitcnt lgkmcnt(2)
ds_read_b128 a[244:247], v239 offset:6272
v_mfma_f32_16x16x32_bf16 v[140:143], a[248:251], v[0:3], v[200:203]
v_exp_f32 v230, v120
v_mfma_f32_16x16x32_bf16 v[144:147], a[248:251], v[4:7], v[204:207]
v_exp_f32 v231, v121
v_mfma_f32_16x16x32_bf16 v[148:151], a[248:251], v[8:11], v[208:211]
v_exp_f32 v232, v122
v_mfma_f32_16x16x32_bf16 v[152:155], a[248:251], v[12:15], v[212:215]
buffer_load_dwordx4 v247, s[16:19], s40 offen offset:2048 nt lds
v_mfma_f32_16x16x32_bf16 v[156:159], a[248:251], v[16:19], v[216:219]
s_waitcnt lgkmcnt(2)
ds_read_b128 a[248:251], v238 offset:6400
v_add_f32 v220, v220, v225
v_mfma_f32_16x16x32_bf16 v[140:143], a[252:255], v[20:23], v[140:143]
s_add_u32 s34, s34, 12288
v_exp_f32 v233, v123
v_mfma_f32_16x16x32_bf16 v[144:147], a[252:255], v[24:27], v[144:147]
s_add_u32 s31, s31, 24576
v_exp_f32 v234, v124
v_mfma_f32_16x16x32_bf16 v[148:151], a[252:255], v[28:31], v[148:151]
s_sub_u32 s41, s31, 147456
v_exp_f32 v235, v125
v_mfma_f32_16x16x32_bf16 v[152:155], a[252:255], v[32:35], v[152:155]
s_min_u32 s31, s31, s41
v_exp_f32 v236, v126
v_mfma_f32_16x16x32_bf16 v[156:159], a[252:255], v[36:39], v[156:159]
s_waitcnt lgkmcnt(2)
ds_read_b128 a[252:255], v239 offset:6400
v_add_f32 v221, v221, v226
v_mfma_f32_16x16x32_bf16 v[140:143], a[240:243], v[40:43], v[140:143]
v_add_u32 v238, s32, v252
v_xor_b32 v239, 64, v238
v_mfma_f32_16x16x32_bf16 v[144:147], a[240:243], v[44:47], v[144:147]
s_add_u32 s32, s32, 24576
v_exp_f32 v237, v127
v_mfma_f32_16x16x32_bf16 v[148:151], a[240:243], v[48:51], v[148:151]
s_sub_u32 s42, s32, 147456
v_add_f32 v222, v222, v227
v_add_f32 v223, v223, v228
v_mfma_f32_16x16x32_bf16 v[152:155], a[240:243], v[52:55], v[152:155]
s_min_u32 s32, s32, s42
v_add_f32 v224, v224, v229
v_cvt_pk_bf16_f32 v180, v230, v231
v_mfma_f32_16x16x32_bf16 v[156:159], a[240:243], v[56:59], v[156:159]
s_waitcnt lgkmcnt(2)
v_add_f32 v225, v230, v231
v_cvt_pk_bf16_f32 v181, v232, v233
v_mfma_f32_16x16x32_bf16 v[140:143], a[244:247], v[60:63], v[140:143]
v_add_f32 v225, v225, v232
v_add_f32 v225, v225, v233
v_mfma_f32_16x16x32_bf16 v[144:147], a[244:247], v[64:67], v[144:147]
v_exp_f32 v230, v128
v_mfma_f32_16x16x32_bf16 v[148:151], a[244:247], v[68:71], v[148:151]
v_exp_f32 v231, v129
v_mfma_f32_16x16x32_bf16 v[152:155], a[244:247], v[72:75], v[152:155]
s_waitcnt vmcnt(63) lgkmcnt(0)
s_barrier
ds_read_b64_tr_b16 a[240:241], v240 offset:0
v_mfma_f32_16x16x32_bf16 v[156:159], a[244:247], v[76:79], v[156:159]
s_waitcnt lgkmcnt(15)
ds_read_b64_tr_b16 a[242:243], v240 offset:6144
ds_read_b64_tr_b16 a[244:245], v241 offset:0
v_mfma_f32_16x16x32_bf16 v[140:143], a[248:251], v[80:83], v[140:143]
s_add_u32 m0, s31, s37
ds_read_b64_tr_b16 a[246:247], v241 offset:6144
v_cvt_pk_bf16_f32 v184, v234, v235
v_mfma_f32_16x16x32_bf16 v[144:147], a[248:251], v[84:87], v[144:147]
s_waitcnt vmcnt(5)
v_exp_f32 v232, v130
v_mfma_f32_16x16x32_bf16 v[148:151], a[248:251], v[88:91], v[148:151]
buffer_load_dwordx4 v245, s[12:15], s33 offen offset:0 nt lds
v_mfma_f32_16x16x32_bf16 v[152:155], a[248:251], v[92:95], v[152:155]
s_waitcnt vmcnt(5)
v_exp_f32 v233, v131
v_mfma_f32_16x16x32_bf16 v[156:159], a[248:251], v[96:99], v[156:159]
s_waitcnt lgkmcnt(15)
ds_read_b64_tr_b16 a[248:249], v242 offset:0
ds_read_b64_tr_b16 a[250:251], v242 offset:6144
v_mfma_f32_16x16x32_bf16 v[140:143], a[252:255], v[100:103], v[140:143]
v_add_f32 v226, v234, v235
v_cvt_pk_bf16_f32 v185, v236, v237
v_mfma_f32_16x16x32_bf16 v[144:147], a[252:255], v[104:107], v[144:147]
v_add_f32 v226, v226, v236
v_add_f32 v226, v226, v237
v_mfma_f32_16x16x32_bf16 v[148:151], a[252:255], v[108:111], v[148:151]
v_exp_f32 v234, v132
v_mfma_f32_16x16x32_bf16 v[152:155], a[252:255], v[112:115], v[152:155]
v_exp_f32 v235, v133
v_mfma_f32_16x16x32_bf16 v[156:159], a[252:255], v[116:119], v[156:159]
s_waitcnt lgkmcnt(4)
ds_read_b64_tr_b16 a[252:253], v243 offset:0
ds_read_b64_tr_b16 a[254:255], v243 offset:6144
v_mfma_f32_16x16x32_bf16 a[0:3], a[240:243], v[160:163], a[0:3]
buffer_load_dwordx4 v246, s[12:15], s33 offen offset:1024 nt lds
v_mfma_f32_16x16x32_bf16 a[4:7], a[240:243], v[164:167], a[4:7]
s_waitcnt vmcnt(5)
v_exp_f32 v236, v134
v_mfma_f32_16x16x32_bf16 a[8:11], a[240:243], v[168:171], a[8:11]
v_exp_f32 v237, v135
v_mfma_f32_16x16x32_bf16 a[12:15], a[240:243], v[172:175], a[12:15]
v_cvt_pk_bf16_f32 v188, v230, v231
v_add_f32 v227, v230, v231
v_mfma_f32_16x16x32_bf16 a[16:19], a[240:243], v[176:179], a[16:19]
s_waitcnt lgkmcnt(4)
ds_read_b64_tr_b16 a[240:241], v240 offset:128
ds_read_b64_tr_b16 a[242:243], v240 offset:6272
v_mfma_f32_16x16x32_bf16 a[20:23], a[244:247], v[160:163], a[20:23]
v_cvt_pk_bf16_f32 v189, v232, v233
v_add_f32 v227, v227, v232
v_mfma_f32_16x16x32_bf16 a[24:27], a[244:247], v[164:167], a[24:27]
v_add_f32 v227, v227, v233
v_cvt_pk_bf16_f32 v192, v234, v235
v_mfma_f32_16x16x32_bf16 a[28:31], a[244:247], v[168:171], a[28:31]
v_exp_f32 v230, v136
v_mfma_f32_16x16x32_bf16 a[32:35], a[244:247], v[172:175], a[32:35]
buffer_load_dwordx4 v247, s[12:15], s33 offen offset:2048 nt lds
v_mfma_f32_16x16x32_bf16 a[36:39], a[244:247], v[176:179], a[36:39]
s_waitcnt lgkmcnt(4)
ds_read_b64_tr_b16 a[244:245], v241 offset:128
ds_read_b64_tr_b16 a[246:247], v241 offset:6272
v_mfma_f32_16x16x32_bf16 a[40:43], a[248:251], v[160:163], a[40:43]
s_add_u32 m0, m0, 3072
v_exp_f32 v231, v137
v_mfma_f32_16x16x32_bf16 a[44:47], a[248:251], v[164:167], a[44:47]
s_add_u32 s40, s33, 3072
v_exp_f32 v232, v138
v_mfma_f32_16x16x32_bf16 a[48:51], a[248:251], v[168:171], a[48:51]
s_waitcnt vmcnt(5)
v_exp_f32 v233, v139
v_mfma_f32_16x16x32_bf16 a[52:55], a[248:251], v[172:175], a[52:55]
v_add_f32 v228, v234, v235
v_cvt_pk_bf16_f32 v193, v236, v237
v_mfma_f32_16x16x32_bf16 a[56:59], a[248:251], v[176:179], a[56:59]
s_waitcnt lgkmcnt(4)
ds_read_b64_tr_b16 a[248:249], v242 offset:128
ds_read_b64_tr_b16 a[250:251], v242 offset:6272
v_mfma_f32_16x16x32_bf16 a[60:63], a[252:255], v[160:163], a[60:63]
v_add_f32 v228, v228, v236
v_add_f32 v228, v228, v237
v_mfma_f32_16x16x32_bf16 a[64:67], a[252:255], v[164:167], a[64:67]
buffer_load_dwordx4 v245, s[12:15], s40 offen offset:0 nt lds
v_mfma_f32_16x16x32_bf16 a[68:71], a[252:255], v[168:171], a[68:71]
s_waitcnt vmcnt(5)
v_cvt_pk_bf16_f32 v196, v230, v231
v_add_f32 v229, v230, v231
v_mfma_f32_16x16x32_bf16 a[72:75], a[252:255], v[172:175], a[72:75]
v_cvt_pk_bf16_f32 v197, v232, v233
v_add_f32 v229, v229, v232
v_mfma_f32_16x16x32_bf16 a[76:79], a[252:255], v[176:179], a[76:79]
s_waitcnt lgkmcnt(4)
ds_read_b64_tr_b16 a[252:253], v243 offset:128
ds_read_b64_tr_b16 a[254:255], v243 offset:6272
v_mfma_f32_16x16x32_bf16 a[80:83], a[240:243], v[160:163], a[80:83]
v_add_f32 v229, v229, v233
v_max3_f32 v244, v225, v226, v227
v_mfma_f32_16x16x32_bf16 a[84:87], a[240:243], v[164:167], a[84:87]
v_max3_f32 v244, v244, v228, v229
v_cmp_ngt_f32 vcc, 2.0, v244
v_mfma_f32_16x16x32_bf16 a[88:91], a[240:243], v[168:171], a[88:91]
s_cbranch_vccnz L_tr31
L_back31:
v_exp_f32 v234, v140
v_mfma_f32_16x16x32_bf16 a[92:95], a[240:243], v[172:175], a[92:95]
v_exp_f32 v235, v141
v_mfma_f32_16x16x32_bf16 a[96:99], a[240:243], v[176:179], a[96:99]
s_waitcnt lgkmcnt(4)
ds_read_b64_tr_b16 a[240:241], v240 offset:256
ds_read_b64_tr_b16 a[242:243], v240 offset:6400
v_mfma_f32_16x16x32_bf16 a[100:103], a[244:247], v[160:163], a[100:103]
buffer_load_dwordx4 v246, s[12:15], s40 offen offset:1024 nt lds
v_mfma_f32_16x16x32_bf16 a[104:107], a[244:247], v[164:167], a[104:107]
s_waitcnt vmcnt(5)
v_exp_f32 v236, v142
v_mfma_f32_16x16x32_bf16 a[108:111], a[244:247], v[168:171], a[108:111]
v_exp_f32 v237, v143
v_mfma_f32_16x16x32_bf16 a[112:115], a[244:247], v[172:175], a[112:115]
v_exp_f32 v230, v144
v_mfma_f32_16x16x32_bf16 a[116:119], a[244:247], v[176:179], a[116:119]
s_waitcnt lgkmcnt(4)
ds_read_b64_tr_b16 a[244:245], v241 offset:256
ds_read_b64_tr_b16 a[246:247], v241 offset:6400
v_mfma_f32_16x16x32_bf16 a[120:123], a[248:251], v[160:163], a[120:123]
v_exp_f32 v231, v145
v_mfma_f32_16x16x32_bf16 a[124:127], a[248:251], v[164:167], a[124:127]
v_exp_f32 v232, v146
v_mfma_f32_16x16x32_bf16 a[128:131], a[248:251], v[168:171], a[128:131]
v_exp_f32 v233, v147
v_mfma_f32_16x16x32_bf16 a[132:135], a[248:251], v[172:175], a[132:135]
buffer_load_dwordx4 v247, s[12:15], s40 offen offset:2048 nt lds
v_mfma_f32_16x16x32_bf16 a[136:139], a[248:251], v[176:179], a[136:139]
s_waitcnt lgkmcnt(4)
ds_read_b64_tr_b16 a[248:249], v242 offset:256
ds_read_b64_tr_b16 a[250:251], v242 offset:6400
v_mfma_f32_16x16x32_bf16 a[140:143], a[252:255], v[160:163], a[140:143]
s_add_u32 s33, s33, 12288
v_add_f32 v220, v220, v225
v_add_f32 v221, v221, v226
v_mfma_f32_16x16x32_bf16 a[144:147], a[252:255], v[164:167], a[144:147]
s_add_u32 s31, s31, 24576
v_add_f32 v222, v222, v227
v_add_f32 v223, v223, v228
v_mfma_f32_16x16x32_bf16 a[148:151], a[252:255], v[168:171], a[148:151]
s_sub_u32 s41, s31, 147456
v_add_f32 v224, v224, v229
v_cvt_pk_bf16_f32 v182, v234, v235
v_mfma_f32_16x16x32_bf16 a[152:155], a[252:255], v[172:175], a[152:155]
s_min_u32 s31, s31, s41
v_add_f32 v225, v234, v235
v_cvt_pk_bf16_f32 v183, v236, v237
v_mfma_f32_16x16x32_bf16 a[156:159], a[252:255], v[176:179], a[156:159]
s_waitcnt lgkmcnt(4)
ds_read_b64_tr_b16 a[252:253], v243 offset:256
ds_read_b64_tr_b16 a[254:255], v243 offset:6400
v_mfma_f32_16x16x32_bf16 a[160:163], a[240:243], v[160:163], a[160:163]
v_add_u32 v240, s32, v253
v_xor_b32 v241, 32, v240
v_mfma_f32_16x16x32_bf16 a[164:167], a[240:243], v[164:167], a[164:167]
v_xor_b32 v242, 64, v240
v_xor_b32 v243, 64, v241
v_mfma_f32_16x16x32_bf16 a[168:171], a[240:243], v[168:171], a[168:171]
s_add_u32 s32, s32, 24576
v_add_f32 v225, v225, v236
v_add_f32 v225, v225, v237
v_mfma_f32_16x16x32_bf16 a[172:175], a[240:243], v[172:175], a[172:175]
s_sub_u32 s42, s32, 147456
v_exp_f32 v234, v148
v_mfma_f32_16x16x32_bf16 a[176:179], a[240:243], v[176:179], a[176:179]
s_waitcnt lgkmcnt(4)
v_exp_f32 v235, v149
v_mfma_f32_16x16x32_bf16 a[180:183], a[244:247], v[160:163], a[180:183]
s_min_u32 s32, s32, s42
v_exp_f32 v236, v150
v_mfma_f32_16x16x32_bf16 a[184:187], a[244:247], v[164:167], a[184:187]
v_exp_f32 v237, v151
v_mfma_f32_16x16x32_bf16 a[188:191], a[244:247], v[168:171], a[188:191]
v_cvt_pk_bf16_f32 v186, v230, v231
v_add_f32 v226, v230, v231
v_mfma_f32_16x16x32_bf16 a[192:195], a[244:247], v[172:175], a[192:195]
s_waitcnt vmcnt(63) lgkmcnt(0)
s_barrier
ds_read_b128 a[240:243], v238 offset:0
v_mfma_f32_16x16x32_bf16 a[196:199], a[244:247], v[176:179], a[196:199]
s_waitcnt lgkmcnt(15)
ds_read_b128 a[244:247], v239 offset:0
v_cvt_pk_bf16_f32 v187, v232, v233
v_mfma_f32_16x16x32_bf16 a[200:203], a[248:251], v[160:163], a[200:203]
s_add_u32 m0, s31, s37
v_add_f32 v226, v226, v232
v_add_f32 v226, v226, v233
v_mfma_f32_16x16x32_bf16 a[204:207], a[248:251], v[164:167], a[204:207]
s_waitcnt vmcnt(5)
v_exp_f32 v230, v152
v_mfma_f32_16x16x32_bf16 a[208:211], a[248:251], v[168:171], a[208:211]
buffer_load_dwordx4 v245, s[16:19], s34 offen offset:0 nt lds
v_mfma_f32_16x16x32_bf16 a[212:215], a[248:251], v[172:175], a[212:215]
s_waitcnt vmcnt(5)
v_exp_f32 v231, v153
v_mfma_f32_16x16x32_bf16 a[216:219], a[248:251], v[176:179], a[216:219]
s_waitcnt lgkmcnt(15)
ds_read_b128 a[248:251], v238 offset:128
v_cvt_pk_bf16_f32 v190, v234, v235
v_mfma_f32_16x16x32_bf16 a[220:223], a[252:255], v[160:163], a[220:223]
v_exp_f32 v232, v154
v_mfma_f32_16x16x32_bf16 a[224:227], a[252:255], v[164:167], a[224:227]
v_exp_f32 v233, v155
v_mfma_f32_16x16x32_bf16 a[228:231], a[252:255], v[168:171], a[228:231]
v_add_f32 v227, v234, v235
v_cvt_pk_bf16_f32 v191, v236, v237
v_mfma_f32_16x16x32_bf16 a[232:235], a[252:255], v[172:175], a[232:235]
v_add_f32 v227, v227, v236
v_add_f32 v227, v227, v237
v_mfma_f32_16x16x32_bf16 a[236:239], a[252:255], v[176:179], a[236:239]
s_waitcnt lgkmcnt(2)
ds_read_b128 a[252:255], v239 offset:128
v_cvt_pk_bf16_f32 v194, v230, v231
v_mfma_f32_16x16x32_bf16 v[120:123], a[240:243], v[0:3], v[200:203]
buffer_load_dwordx4 v246, s[16:19], s34 offen offset:1024 nt lds
v_mfma_f32_16x16x32_bf16 v[124:127], a[240:243], v[4:7], v[204:207]
s_waitcnt vmcnt(5)
v_exp_f32 v234, v156
v_mfma_f32_16x16x32_bf16 v[128:131], a[240:243], v[8:11], v[208:211]
v_exp_f32 v235, v157
v_mfma_f32_16x16x32_bf16 v[132:135], a[240:243], v[12:15], v[212:215]
v_exp_f32 v236, v158
v_mfma_f32_16x16x32_bf16 v[136:139], a[240:243], v[16:19], v[216:219]
s_waitcnt lgkmcnt(2)
ds_read_b128 a[240:243], v238 offset:256
v_add_f32 v228, v230, v231
v_mfma_f32_16x16x32_bf16 v[120:123], a[244:247], v[20:23], v[120:123]
v_exp_f32 v237, v159
v_mfma_f32_16x16x32_bf16 v[124:127], a[244:247], v[24:27], v[124:127]
v_cvt_pk_bf16_f32 v195, v232, v233
v_add_f32 v228, v228, v232
v_mfma_f32_16x16x32_bf16 v[128:131], a[244:247], v[28:31], v[128:131]
v_add_f32 v228, v228, v233
v_cvt_pk_bf16_f32 v198, v234, v235
v_mfma_f32_16x16x32_bf16 v[132:135], a[244:247], v[32:35], v[132:135]
buffer_load_dwordx4 v247, s[16:19], s34 offen offset:2048 nt lds
v_mfma_f32_16x16x32_bf16 v[136:139], a[244:247], v[36:39], v[136:139]
s_waitcnt lgkmcnt(2)
ds_read_b128 a[244:247], v239 offset:256
v_add_f32 v229, v234, v235
v_mfma_f32_16x16x32_bf16 v[120:123], a[248:251], v[40:43], v[120:123]
s_add_u32 m0, m0, 3072
v_cvt_pk_bf16_f32 v199, v236, v237
v_add_f32 v229, v229, v236
v_mfma_f32_16x16x32_bf16 v[124:127], a[248:251], v[44:47], v[124:127]
s_add_u32 s40, s34, 3072
v_add_f32 v229, v229, v237
v_max3_f32 v244, v225, v226, v227
v_mfma_f32_16x16x32_bf16 v[128:131], a[248:251], v[48:51], v[128:131]
s_waitcnt vmcnt(5)
v_max3_f32 v244, v244, v228, v229
v_cmp_ngt_f32 vcc, 2.0, v244
v_mfma_f32_16x16x32_bf16 v[132:135], a[248:251], v[52:55], v[132:135]
v_mfma_f32_16x16x32_bf16 v[136:139], a[248:251], v[56:59], v[136:139]
s_waitcnt lgkmcnt(2)
ds_read_b128 a[248:251], v238 offset:6144
v_mfma_f32_16x16x32_bf16 v[120:123], a[252:255], v[60:63], v[120:123]
v_mfma_f32_16x16x32_bf16 v[124:127], a[252:255], v[64:67], v[124:127]
buffer_load_dwordx4 v245, s[16:19], s40 offen offset:0 nt lds
v_mfma_f32_16x16x32_bf16 v[128:131], a[252:255], v[68:71], v[128:131]
s_waitcnt vmcnt(5)
v_mfma_f32_16x16x32_bf16 v[132:135], a[252:255], v[72:75], v[132:135]
v_mfma_f32_16x16x32_bf16 v[136:139], a[252:255], v[76:79], v[136:139]
s_waitcnt lgkmcnt(2)
ds_read_b128 a[252:255], v239 offset:6144
v_mfma_f32_16x16x32_bf16 v[120:123], a[240:243], v[80:83], v[120:123]
v_mfma_f32_16x16x32_bf16 v[124:127], a[240:243], v[84:87], v[124:127]
v_mfma_f32_16x16x32_bf16 v[128:131], a[240:243], v[88:91], v[128:131]
v_mfma_f32_16x16x32_bf16 v[132:135], a[240:243], v[92:95], v[132:135]
v_mfma_f32_16x16x32_bf16 v[136:139], a[240:243], v[96:99], v[136:139]
s_waitcnt lgkmcnt(2)
ds_read_b128 a[240:243], v238 offset:6272
v_mfma_f32_16x16x32_bf16 v[120:123], a[244:247], v[100:103], v[120:123]
buffer_load_dwordx4 v246, s[16:19], s40 offen offset:1024 nt lds
v_mfma_f32_16x16x32_bf16 v[124:127], a[244:247], v[104:107], v[124:127]
s_waitcnt vmcnt(5)
v_mfma_f32_16x16x32_bf16 v[128:131], a[244:247], v[108:111], v[128:131]
v_mfma_f32_16x16x32_bf16 v[132:135], a[244:247], v[112:115], v[132:135]
v_mfma_f32_16x16x32_bf16 v[136:139], a[244:247], v[116:119], v[136:139]
s_cbranch_vccnz L_tr32
L_back32:
s_waitcnt lgkmcnt(2)
ds_read_b128 a[244:247], v239 offset:6272
s_sub_u32 s44, s44, 1
s_cmp_lg_u32 s44, 0
s_cbranch_scc1 L_concat_heads__mha_block_cached__gqa_block_cached__near_ridge_kernel_a
s_cmp_eq_u32 s45, 1
s_cbranch_scc1 L_concat_heads__mha_block_cached__gqa_block_cached__near_ridge_kernel_tail1
v_mfma_f32_16x16x32_bf16 v[140:143], a[248:251], v[0:3], v[200:203]
v_exp_f32 v230, v120
v_mfma_f32_16x16x32_bf16 v[144:147], a[248:251], v[4:7], v[204:207]
v_exp_f32 v231, v121
v_mfma_f32_16x16x32_bf16 v[148:151], a[248:251], v[8:11], v[208:211]
v_exp_f32 v232, v122
v_mfma_f32_16x16x32_bf16 v[152:155], a[248:251], v[12:15], v[212:215]
buffer_load_dwordx4 v247, s[16:19], s40 offen offset:2048 nt lds
v_mfma_f32_16x16x32_bf16 v[156:159], a[248:251], v[16:19], v[216:219]
s_waitcnt lgkmcnt(2)
ds_read_b128 a[248:251], v238 offset:6400
v_add_f32 v220, v220, v225
v_mfma_f32_16x16x32_bf16 v[140:143], a[252:255], v[20:23], v[140:143]
s_add_u32 s34, s34, 12288
v_exp_f32 v233, v123
v_mfma_f32_16x16x32_bf16 v[144:147], a[252:255], v[24:27], v[144:147]
s_add_u32 s31, s31, 24576
v_exp_f32 v234, v124
v_mfma_f32_16x16x32_bf16 v[148:151], a[252:255], v[28:31], v[148:151]
s_sub_u32 s41, s31, 147456
v_exp_f32 v235, v125
v_mfma_f32_16x16x32_bf16 v[152:155], a[252:255], v[32:35], v[152:155]
s_min_u32 s31, s31, s41
v_exp_f32 v236, v126
v_mfma_f32_16x16x32_bf16 v[156:159], a[252:255], v[36:39], v[156:159]
s_waitcnt lgkmcnt(2)
ds_read_b128 a[252:255], v239 offset:6400
v_add_f32 v221, v221, v226
v_mfma_f32_16x16x32_bf16 v[140:143], a[240:243], v[40:43], v[140:143]
v_add_u32 v238, s32, v252
v_xor_b32 v239, 64, v238
v_mfma_f32_16x16x32_bf16 v[144:147], a[240:243], v[44:47], v[144:147]
s_add_u32 s32, s32, 24576
v_exp_f32 v237, v127
v_mfma_f32_16x16x32_bf16 v[148:151], a[240:243], v[48:51], v[148:151]
s_sub_u32 s42, s32, 147456
v_add_f32 v222, v222, v227
v_add_f32 v223, v223, v228
v_mfma_f32_16x16x32_bf16 v[152:155], a[240:243], v[52:55], v[152:155]
s_min_u32 s32, s32, s42
v_add_f32 v224, v224, v229
v_cvt_pk_bf16_f32 v160, v230, v231
v_mfma_f32_16x16x32_bf16 v[156:159], a[240:243], v[56:59], v[156:159]
s_waitcnt lgkmcnt(2)
v_add_f32 v225, v230, v231
v_cvt_pk_bf16_f32 v161, v232, v233
v_mfma_f32_16x16x32_bf16 v[140:143], a[244:247], v[60:63], v[140:143]
v_add_f32 v225, v225, v232
v_add_f32 v225, v225, v233
v_mfma_f32_16x16x32_bf16 v[144:147], a[244:247], v[64:67], v[144:147]
v_exp_f32 v230, v128
v_mfma_f32_16x16x32_bf16 v[148:151], a[244:247], v[68:71], v[148:151]
v_exp_f32 v231, v129
v_mfma_f32_16x16x32_bf16 v[152:155], a[244:247], v[72:75], v[152:155]
s_waitcnt vmcnt(63) lgkmcnt(0)
s_barrier
ds_read_b64_tr_b16 a[240:241], v240 offset:0
v_mfma_f32_16x16x32_bf16 v[156:159], a[244:247], v[76:79], v[156:159]
s_waitcnt lgkmcnt(15)
ds_read_b64_tr_b16 a[242:243], v240 offset:6144
ds_read_b64_tr_b16 a[244:245], v241 offset:0
v_mfma_f32_16x16x32_bf16 v[140:143], a[248:251], v[80:83], v[140:143]
s_add_u32 m0, s31, s37
ds_read_b64_tr_b16 a[246:247], v241 offset:6144
v_cvt_pk_bf16_f32 v164, v234, v235
v_mfma_f32_16x16x32_bf16 v[144:147], a[248:251], v[84:87], v[144:147]
s_waitcnt vmcnt(5)
v_exp_f32 v232, v130
v_mfma_f32_16x16x32_bf16 v[148:151], a[248:251], v[88:91], v[148:151]
buffer_load_dwordx4 v245, s[12:15], s33 offen offset:0 nt lds
v_mfma_f32_16x16x32_bf16 v[152:155], a[248:251], v[92:95], v[152:155]
s_waitcnt vmcnt(5)
v_exp_f32 v233, v131
v_mfma_f32_16x16x32_bf16 v[156:159], a[248:251], v[96:99], v[156:159]
s_waitcnt lgkmcnt(15)
ds_read_b64_tr_b16 a[248:249], v242 offset:0
ds_read_b64_tr_b16 a[250:251], v242 offset:6144
v_mfma_f32_16x16x32_bf16 v[140:143], a[252:255], v[100:103], v[140:143]
v_add_f32 v226, v234, v235
v_cvt_pk_bf16_f32 v165, v236, v237
v_mfma_f32_16x16x32_bf16 v[144:147], a[252:255], v[104:107], v[144:147]
v_add_f32 v226, v226, v236
v_add_f32 v226, v226, v237
v_mfma_f32_16x16x32_bf16 v[148:151], a[252:255], v[108:111], v[148:151]
v_exp_f32 v234, v132
v_mfma_f32_16x16x32_bf16 v[152:155], a[252:255], v[112:115], v[152:155]
v_exp_f32 v235, v133
v_mfma_f32_16x16x32_bf16 v[156:159], a[252:255], v[116:119], v[156:159]
s_waitcnt lgkmcnt(4)
ds_read_b64_tr_b16 a[252:253], v243 offset:0
ds_read_b64_tr_b16 a[254:255], v243 offset:6144
v_mfma_f32_16x16x32_bf16 a[0:3], a[240:243], v[180:183], a[0:3]
buffer_load_dwordx4 v246, s[12:15], s33 offen offset:1024 nt lds
v_mfma_f32_16x16x32_bf16 a[4:7], a[240:243], v[184:187], a[4:7]
s_waitcnt vmcnt(5)
v_exp_f32 v236, v134
v_mfma_f32_16x16x32_bf16 a[8:11], a[240:243], v[188:191], a[8:11]
v_exp_f32 v237, v135
v_mfma_f32_16x16x32_bf16 a[12:15], a[240:243], v[192:195], a[12:15]
v_cvt_pk_bf16_f32 v168, v230, v231
v_add_f32 v227, v230, v231
v_mfma_f32_16x16x32_bf16 a[16:19], a[240:243], v[196:199], a[16:19]
s_waitcnt lgkmcnt(4)
ds_read_b64_tr_b16 a[240:241], v240 offset:128
ds_read_b64_tr_b16 a[242:243], v240 offset:6272
v_mfma_f32_16x16x32_bf16 a[20:23], a[244:247], v[180:183], a[20:23]
v_cvt_pk_bf16_f32 v169, v232, v233
v_add_f32 v227, v227, v232
v_mfma_f32_16x16x32_bf16 a[24:27], a[244:247], v[184:187], a[24:27]
v_add_f32 v227, v227, v233
v_cvt_pk_bf16_f32 v172, v234, v235
v_mfma_f32_16x16x32_bf16 a[28:31], a[244:247], v[188:191], a[28:31]
v_exp_f32 v230, v136
v_mfma_f32_16x16x32_bf16 a[32:35], a[244:247], v[192:195], a[32:35]
buffer_load_dwordx4 v247, s[12:15], s33 offen offset:2048 nt lds
v_mfma_f32_16x16x32_bf16 a[36:39], a[244:247], v[196:199], a[36:39]
s_waitcnt lgkmcnt(4)
ds_read_b64_tr_b16 a[244:245], v241 offset:128
ds_read_b64_tr_b16 a[246:247], v241 offset:6272
v_mfma_f32_16x16x32_bf16 a[40:43], a[248:251], v[180:183], a[40:43]
s_add_u32 m0, m0, 3072
v_exp_f32 v231, v137
v_mfma_f32_16x16x32_bf16 a[44:47], a[248:251], v[184:187], a[44:47]
s_add_u32 s40, s33, 3072
v_exp_f32 v232, v138
v_mfma_f32_16x16x32_bf16 a[48:51], a[248:251], v[188:191], a[48:51]
s_waitcnt vmcnt(5)
v_exp_f32 v233, v139
v_mfma_f32_16x16x32_bf16 a[52:55], a[248:251], v[192:195], a[52:55]
v_add_f32 v228, v234, v235
v_cvt_pk_bf16_f32 v173, v236, v237
v_mfma_f32_16x16x32_bf16 a[56:59], a[248:251], v[196:199], a[56:59]
s_waitcnt lgkmcnt(4)
ds_read_b64_tr_b16 a[248:249], v242 offset:128
ds_read_b64_tr_b16 a[250:251], v242 offset:6272
v_mfma_f32_16x16x32_bf16 a[60:63], a[252:255], v[180:183], a[60:63]
v_add_f32 v228, v228, v236
v_add_f32 v228, v228, v237
v_mfma_f32_16x16x32_bf16 a[64:67], a[252:255], v[184:187], a[64:67]
buffer_load_dwordx4 v245, s[12:15], s40 offen offset:0 nt lds
v_mfma_f32_16x16x32_bf16 a[68:71], a[252:255], v[188:191], a[68:71]
s_waitcnt vmcnt(5)
v_cvt_pk_bf16_f32 v176, v230, v231
v_add_f32 v229, v230, v231
v_mfma_f32_16x16x32_bf16 a[72:75], a[252:255], v[192:195], a[72:75]
v_cvt_pk_bf16_f32 v177, v232, v233
v_add_f32 v229, v229, v232
v_mfma_f32_16x16x32_bf16 a[76:79], a[252:255], v[196:199], a[76:79]
s_waitcnt lgkmcnt(4)
ds_read_b64_tr_b16 a[252:253], v243 offset:128
ds_read_b64_tr_b16 a[254:255], v243 offset:6272
v_mfma_f32_16x16x32_bf16 a[80:83], a[240:243], v[180:183], a[80:83]
v_add_f32 v229, v229, v233
v_max3_f32 v244, v225, v226, v227
v_mfma_f32_16x16x32_bf16 a[84:87], a[240:243], v[184:187], a[84:87]
v_max3_f32 v244, v244, v228, v229
v_cmp_ngt_f32 vcc, 2.0, v244
v_mfma_f32_16x16x32_bf16 a[88:91], a[240:243], v[188:191], a[88:91]
s_cbranch_vccnz L_tr34
L_back34:
v_exp_f32 v234, v140
v_mfma_f32_16x16x32_bf16 a[92:95], a[240:243], v[192:195], a[92:95]
v_exp_f32 v235, v141
v_mfma_f32_16x16x32_bf16 a[96:99], a[240:243], v[196:199], a[96:99]
s_waitcnt lgkmcnt(4)
ds_read_b64_tr_b16 a[240:241], v240 offset:256
ds_read_b64_tr_b16 a[242:243], v240 offset:6400
v_mfma_f32_16x16x32_bf16 a[100:103], a[244:247], v[180:183], a[100:103]
buffer_load_dwordx4 v246, s[12:15], s40 offen offset:1024 nt lds
v_mfma_f32_16x16x32_bf16 a[104:107], a[244:247], v[184:187], a[104:107]
s_waitcnt vmcnt(5)
v_exp_f32 v236, v142
v_mfma_f32_16x16x32_bf16 a[108:111], a[244:247], v[188:191], a[108:111]
v_exp_f32 v237, v143
v_mfma_f32_16x16x32_bf16 a[112:115], a[244:247], v[192:195], a[112:115]
v_exp_f32 v230, v144
v_mfma_f32_16x16x32_bf16 a[116:119], a[244:247], v[196:199], a[116:119]
s_waitcnt lgkmcnt(4)
ds_read_b64_tr_b16 a[244:245], v241 offset:256
ds_read_b64_tr_b16 a[246:247], v241 offset:6400
v_mfma_f32_16x16x32_bf16 a[120:123], a[248:251], v[180:183], a[120:123]
v_exp_f32 v231, v145
v_mfma_f32_16x16x32_bf16 a[124:127], a[248:251], v[184:187], a[124:127]
v_exp_f32 v232, v146
v_mfma_f32_16x16x32_bf16 a[128:131], a[248:251], v[188:191], a[128:131]
v_exp_f32 v233, v147
v_mfma_f32_16x16x32_bf16 a[132:135], a[248:251], v[192:195], a[132:135]
buffer_load_dwordx4 v247, s[12:15], s40 offen offset:2048 nt lds
v_mfma_f32_16x16x32_bf16 a[136:139], a[248:251], v[196:199], a[136:139]
s_waitcnt lgkmcnt(4)
ds_read_b64_tr_b16 a[248:249], v242 offset:256
ds_read_b64_tr_b16 a[250:251], v242 offset:6400
v_mfma_f32_16x16x32_bf16 a[140:143], a[252:255], v[180:183], a[140:143]
s_add_u32 s33, s33, 208896
v_add_f32 v220, v220, v225
v_add_f32 v221, v221, v226
v_mfma_f32_16x16x32_bf16 a[144:147], a[252:255], v[184:187], a[144:147]
s_add_u32 s31, s31, 24576
v_add_f32 v222, v222, v227
v_add_f32 v223, v223, v228
v_mfma_f32_16x16x32_bf16 a[148:151], a[252:255], v[188:191], a[148:151]
s_sub_u32 s41, s31, 147456
v_add_f32 v224, v224, v229
v_cvt_pk_bf16_f32 v162, v234, v235
v_mfma_f32_16x16x32_bf16 a[152:155], a[252:255], v[192:195], a[152:155]
s_min_u32 s31, s31, s41
v_add_f32 v225, v234, v235
v_cvt_pk_bf16_f32 v163, v236, v237
v_mfma_f32_16x16x32_bf16 a[156:159], a[252:255], v[196:199], a[156:159]
s_waitcnt lgkmcnt(4)
ds_read_b64_tr_b16 a[252:253], v243 offset:256
ds_read_b64_tr_b16 a[254:255], v243 offset:6400
v_mfma_f32_16x16x32_bf16 a[160:163], a[240:243], v[180:183], a[160:163]
v_add_u32 v240, s32, v253
v_xor_b32 v241, 32, v240
v_mfma_f32_16x16x32_bf16 a[164:167], a[240:243], v[184:187], a[164:167]
v_xor_b32 v242, 64, v240
v_xor_b32 v243, 64, v241
v_mfma_f32_16x16x32_bf16 a[168:171], a[240:243], v[188:191], a[168:171]
s_add_u32 s32, s32, 24576
v_add_f32 v225, v225, v236
v_add_f32 v225, v225, v237
v_mfma_f32_16x16x32_bf16 a[172:175], a[240:243], v[192:195], a[172:175]
s_sub_u32 s42, s32, 147456
v_exp_f32 v234, v148
v_mfma_f32_16x16x32_bf16 a[176:179], a[240:243], v[196:199], a[176:179]
s_waitcnt lgkmcnt(4)
v_exp_f32 v235, v149
v_mfma_f32_16x16x32_bf16 a[180:183], a[244:247], v[180:183], a[180:183]
s_min_u32 s32, s32, s42
v_exp_f32 v236, v150
v_mfma_f32_16x16x32_bf16 a[184:187], a[244:247], v[184:187], a[184:187]
v_exp_f32 v237, v151
v_mfma_f32_16x16x32_bf16 a[188:191], a[244:247], v[188:191], a[188:191]
v_cvt_pk_bf16_f32 v166, v230, v231
v_add_f32 v226, v230, v231
v_mfma_f32_16x16x32_bf16 a[192:195], a[244:247], v[192:195], a[192:195]
s_waitcnt vmcnt(63) lgkmcnt(0)
s_barrier
ds_read_b128 a[240:243], v238 offset:0
v_mfma_f32_16x16x32_bf16 a[196:199], a[244:247], v[196:199], a[196:199]
s_waitcnt lgkmcnt(15)
ds_read_b128 a[244:247], v239 offset:0
v_cvt_pk_bf16_f32 v167, v232, v233
v_mfma_f32_16x16x32_bf16 a[200:203], a[248:251], v[180:183], a[200:203]
s_add_u32 m0, s31, s37
v_add_f32 v226, v226, v232
v_add_f32 v226, v226, v233
v_mfma_f32_16x16x32_bf16 a[204:207], a[248:251], v[184:187], a[204:207]
s_waitcnt vmcnt(5)
v_exp_f32 v230, v152
v_mfma_f32_16x16x32_bf16 a[208:211], a[248:251], v[188:191], a[208:211]
buffer_load_dwordx4 v245, s[16:19], s34 offen offset:0 nt lds
v_mfma_f32_16x16x32_bf16 a[212:215], a[248:251], v[192:195], a[212:215]
s_waitcnt vmcnt(5)
v_exp_f32 v231, v153
v_mfma_f32_16x16x32_bf16 a[216:219], a[248:251], v[196:199], a[216:219]
s_waitcnt lgkmcnt(15)
ds_read_b128 a[248:251], v238 offset:128
v_cvt_pk_bf16_f32 v170, v234, v235
v_mfma_f32_16x16x32_bf16 a[220:223], a[252:255], v[180:183], a[220:223]
v_exp_f32 v232, v154
v_mfma_f32_16x16x32_bf16 a[224:227], a[252:255], v[184:187], a[224:227]
v_exp_f32 v233, v155
v_mfma_f32_16x16x32_bf16 a[228:231], a[252:255], v[188:191], a[228:231]
v_add_f32 v227, v234, v235
v_cvt_pk_bf16_f32 v171, v236, v237
v_mfma_f32_16x16x32_bf16 a[232:235], a[252:255], v[192:195], a[232:235]
v_add_f32 v227, v227, v236
v_add_f32 v227, v227, v237
v_mfma_f32_16x16x32_bf16 a[236:239], a[252:255], v[196:199], a[236:239]
s_waitcnt lgkmcnt(2)
ds_read_b128 a[252:255], v239 offset:128
v_cvt_pk_bf16_f32 v174, v230, v231
v_mfma_f32_16x16x32_bf16 v[120:123], a[240:243], v[0:3], v[200:203]
buffer_load_dwordx4 v246, s[16:19], s34 offen offset:1024 nt lds
v_mfma_f32_16x16x32_bf16 v[124:127], a[240:243], v[4:7], v[204:207]
s_waitcnt vmcnt(5)
v_exp_f32 v234, v156
v_mfma_f32_16x16x32_bf16 v[128:131], a[240:243], v[8:11], v[208:211]
v_exp_f32 v235, v157
v_mfma_f32_16x16x32_bf16 v[132:135], a[240:243], v[12:15], v[212:215]
v_exp_f32 v236, v158
v_mfma_f32_16x16x32_bf16 v[136:139], a[240:243], v[16:19], v[216:219]
s_waitcnt lgkmcnt(2)
ds_read_b128 a[240:243], v238 offset:256
v_add_f32 v228, v230, v231
v_mfma_f32_16x16x32_bf16 v[120:123], a[244:247], v[20:23], v[120:123]
v_exp_f32 v237, v159
v_mfma_f32_16x16x32_bf16 v[124:127], a[244:247], v[24:27], v[124:127]
v_cvt_pk_bf16_f32 v175, v232, v233
v_add_f32 v228, v228, v232
v_mfma_f32_16x16x32_bf16 v[128:131], a[244:247], v[28:31], v[128:131]
v_add_f32 v228, v228, v233
v_cvt_pk_bf16_f32 v178, v234, v235
v_mfma_f32_16x16x32_bf16 v[132:135], a[244:247], v[32:35], v[132:135]
buffer_load_dwordx4 v247, s[16:19], s34 offen offset:2048 nt lds
v_mfma_f32_16x16x32_bf16 v[136:139], a[244:247], v[36:39], v[136:139]
s_waitcnt lgkmcnt(2)
ds_read_b128 a[244:247], v239 offset:256
v_add_f32 v229, v234, v235
v_mfma_f32_16x16x32_bf16 v[120:123], a[248:251], v[40:43], v[120:123]
s_add_u32 m0, m0, 3072
v_cvt_pk_bf16_f32 v179, v236, v237
v_add_f32 v229, v229, v236
v_mfma_f32_16x16x32_bf16 v[124:127], a[248:251], v[44:47], v[124:127]
s_add_u32 s40, s34, 3072
v_add_f32 v229, v229, v237
v_max3_f32 v244, v225, v226, v227
v_mfma_f32_16x16x32_bf16 v[128:131], a[248:251], v[48:51], v[128:131]
s_waitcnt vmcnt(5)
v_max3_f32 v244, v244, v228, v229
v_cmp_ngt_f32 vcc, 2.0, v244
v_mfma_f32_16x16x32_bf16 v[132:135], a[248:251], v[52:55], v[132:135]
v_mfma_f32_16x16x32_bf16 v[136:139], a[248:251], v[56:59], v[136:139]
s_waitcnt lgkmcnt(2)
ds_read_b128 a[248:251], v238 offset:6144
v_mfma_f32_16x16x32_bf16 v[120:123], a[252:255], v[60:63], v[120:123]
v_mfma_f32_16x16x32_bf16 v[124:127], a[252:255], v[64:67], v[124:127]
buffer_load_dwordx4 v245, s[16:19], s40 offen offset:0 nt lds
v_mfma_f32_16x16x32_bf16 v[128:131], a[252:255], v[68:71], v[128:131]
s_waitcnt vmcnt(5)
v_mfma_f32_16x16x32_bf16 v[132:135], a[252:255], v[72:75], v[132:135]
v_mfma_f32_16x16x32_bf16 v[136:139], a[252:255], v[76:79], v[136:139]
s_waitcnt lgkmcnt(2)
ds_read_b128 a[252:255], v239 offset:6144
v_mfma_f32_16x16x32_bf16 v[120:123], a[240:243], v[80:83], v[120:123]
v_mfma_f32_16x16x32_bf16 v[124:127], a[240:243], v[84:87], v[124:127]
v_mfma_f32_16x16x32_bf16 v[128:131], a[240:243], v[88:91], v[128:131]
v_mfma_f32_16x16x32_bf16 v[132:135], a[240:243], v[92:95], v[132:135]
v_mfma_f32_16x16x32_bf16 v[136:139], a[240:243], v[96:99], v[136:139]
s_waitcnt lgkmcnt(2)
ds_read_b128 a[240:243], v238 offset:6272
v_mfma_f32_16x16x32_bf16 v[120:123], a[244:247], v[100:103], v[120:123]
buffer_load_dwordx4 v246, s[16:19], s40 offen offset:1024 nt lds
v_mfma_f32_16x16x32_bf16 v[124:127], a[244:247], v[104:107], v[124:127]
s_waitcnt vmcnt(5)
v_mfma_f32_16x16x32_bf16 v[128:131], a[244:247], v[108:111], v[128:131]
v_mfma_f32_16x16x32_bf16 v[132:135], a[244:247], v[112:115], v[132:135]
v_mfma_f32_16x16x32_bf16 v[136:139], a[244:247], v[116:119], v[136:139]
s_cbranch_vccnz L_tr35
L_back35:
s_waitcnt lgkmcnt(2)
ds_read_b128 a[244:247], v239 offset:6272
v_mfma_f32_16x16x32_bf16 v[140:143], a[248:251], v[0:3], v[200:203]
v_exp_f32 v230, v120
v_mfma_f32_16x16x32_bf16 v[144:147], a[248:251], v[4:7], v[204:207]
v_exp_f32 v231, v121
v_mfma_f32_16x16x32_bf16 v[148:151], a[248:251], v[8:11], v[208:211]
v_exp_f32 v232, v122
v_mfma_f32_16x16x32_bf16 v[152:155], a[248:251], v[12:15], v[212:215]
buffer_load_dwordx4 v247, s[16:19], s40 offen offset:2048 nt lds
v_mfma_f32_16x16x32_bf16 v[156:159], a[248:251], v[16:19], v[216:219]
s_waitcnt lgkmcnt(2)
ds_read_b128 a[248:251], v238 offset:6400
v_add_f32 v220, v220, v225
v_mfma_f32_16x16x32_bf16 v[140:143], a[252:255], v[20:23], v[140:143]
s_add_u32 s34, s34, 12288
v_exp_f32 v233, v123
v_mfma_f32_16x16x32_bf16 v[144:147], a[252:255], v[24:27], v[144:147]
s_add_u32 s31, s31, 24576
v_exp_f32 v234, v124
v_mfma_f32_16x16x32_bf16 v[148:151], a[252:255], v[28:31], v[148:151]
s_sub_u32 s41, s31, 147456
v_exp_f32 v235, v125
v_mfma_f32_16x16x32_bf16 v[152:155], a[252:255], v[32:35], v[152:155]
s_min_u32 s31, s31, s41
v_exp_f32 v236, v126
v_mfma_f32_16x16x32_bf16 v[156:159], a[252:255], v[36:39], v[156:159]
s_waitcnt lgkmcnt(2)
ds_read_b128 a[252:255], v239 offset:6400
v_add_f32 v221, v221, v226
v_mfma_f32_16x16x32_bf16 v[140:143], a[240:243], v[40:43], v[140:143]
v_add_u32 v238, s32, v252
v_xor_b32 v239, 64, v238
v_mfma_f32_16x16x32_bf16 v[144:147], a[240:243], v[44:47], v[144:147]
s_add_u32 s32, s32, 24576
v_exp_f32 v237, v127
v_mfma_f32_16x16x32_bf16 v[148:151], a[240:243], v[48:51], v[148:151]
s_sub_u32 s42, s32, 147456
v_add_f32 v222, v222, v227
v_add_f32 v223, v223, v228
v_mfma_f32_16x16x32_bf16 v[152:155], a[240:243], v[52:55], v[152:155]
s_min_u32 s32, s32, s42
v_add_f32 v224, v224, v229
v_cvt_pk_bf16_f32 v180, v230, v231
v_mfma_f32_16x16x32_bf16 v[156:159], a[240:243], v[56:59], v[156:159]
s_waitcnt lgkmcnt(2)
v_add_f32 v225, v230, v231
v_cvt_pk_bf16_f32 v181, v232, v233
v_mfma_f32_16x16x32_bf16 v[140:143], a[244:247], v[60:63], v[140:143]
v_add_f32 v225, v225, v232
v_add_f32 v225, v225, v233
v_mfma_f32_16x16x32_bf16 v[144:147], a[244:247], v[64:67], v[144:147]
v_exp_f32 v230, v128
v_mfma_f32_16x16x32_bf16 v[148:151], a[244:247], v[68:71], v[148:151]
v_exp_f32 v231, v129
v_mfma_f32_16x16x32_bf16 v[152:155], a[244:247], v[72:75], v[152:155]
s_waitcnt vmcnt(63) lgkmcnt(0)
s_barrier
ds_read_b64_tr_b16 a[240:241], v240 offset:0
v_mfma_f32_16x16x32_bf16 v[156:159], a[244:247], v[76:79], v[156:159]
s_waitcnt lgkmcnt(15)
ds_read_b64_tr_b16 a[242:243], v240 offset:6144
ds_read_b64_tr_b16 a[244:245], v241 offset:0
v_mfma_f32_16x16x32_bf16 v[140:143], a[248:251], v[80:83], v[140:143]
s_add_u32 m0, s31, s37
ds_read_b64_tr_b16 a[246:247], v241 offset:6144
v_cvt_pk_bf16_f32 v184, v234, v235
v_mfma_f32_16x16x32_bf16 v[144:147], a[248:251], v[84:87], v[144:147]
s_waitcnt vmcnt(5)
v_exp_f32 v232, v130
v_mfma_f32_16x16x32_bf16 v[148:151], a[248:251], v[88:91], v[148:151]
buffer_load_dwordx4 v245, s[16:19], s34 offen offset:0 nt lds
v_mfma_f32_16x16x32_bf16 v[152:155], a[248:251], v[92:95], v[152:155]
s_waitcnt vmcnt(5)
v_exp_f32 v233, v131
v_mfma_f32_16x16x32_bf16 v[156:159], a[248:251], v[96:99], v[156:159]
s_waitcnt lgkmcnt(15)
ds_read_b64_tr_b16 a[248:249], v242 offset:0
ds_read_b64_tr_b16 a[250:251], v242 offset:6144
v_mfma_f32_16x16x32_bf16 v[140:143], a[252:255], v[100:103], v[140:143]
v_add_f32 v226, v234, v235
v_cvt_pk_bf16_f32 v185, v236, v237
v_mfma_f32_16x16x32_bf16 v[144:147], a[252:255], v[104:107], v[144:147]
v_add_f32 v226, v226, v236
v_add_f32 v226, v226, v237
v_mfma_f32_16x16x32_bf16 v[148:151], a[252:255], v[108:111], v[148:151]
v_exp_f32 v234, v132
v_mfma_f32_16x16x32_bf16 v[152:155], a[252:255], v[112:115], v[152:155]
v_exp_f32 v235, v133
v_mfma_f32_16x16x32_bf16 v[156:159], a[252:255], v[116:119], v[156:159]
s_waitcnt lgkmcnt(4)
ds_read_b64_tr_b16 a[252:253], v243 offset:0
ds_read_b64_tr_b16 a[254:255], v243 offset:6144
v_mfma_f32_16x16x32_bf16 a[0:3], a[240:243], v[160:163], a[0:3]
buffer_load_dwordx4 v246, s[16:19], s34 offen offset:1024 nt lds
v_mfma_f32_16x16x32_bf16 a[4:7], a[240:243], v[164:167], a[4:7]
s_waitcnt vmcnt(5)
v_exp_f32 v236, v134
v_mfma_f32_16x16x32_bf16 a[8:11], a[240:243], v[168:171], a[8:11]
v_exp_f32 v237, v135
v_mfma_f32_16x16x32_bf16 a[12:15], a[240:243], v[172:175], a[12:15]
v_cvt_pk_bf16_f32 v188, v230, v231
v_add_f32 v227, v230, v231
v_mfma_f32_16x16x32_bf16 a[16:19], a[240:243], v[176:179], a[16:19]
s_waitcnt lgkmcnt(4)
ds_read_b64_tr_b16 a[240:241], v240 offset:128
ds_read_b64_tr_b16 a[242:243], v240 offset:6272
v_mfma_f32_16x16x32_bf16 a[20:23], a[244:247], v[160:163], a[20:23]
v_cvt_pk_bf16_f32 v189, v232, v233
v_add_f32 v227, v227, v232
v_mfma_f32_16x16x32_bf16 a[24:27], a[244:247], v[164:167], a[24:27]
v_add_f32 v227, v227, v233
v_cvt_pk_bf16_f32 v192, v234, v235
v_mfma_f32_16x16x32_bf16 a[28:31], a[244:247], v[168:171], a[28:31]
v_exp_f32 v230, v136
v_mfma_f32_16x16x32_bf16 a[32:35], a[244:247], v[172:175], a[32:35]
buffer_load_dwordx4 v247, s[16:19], s34 offen offset:2048 nt lds
v_mfma_f32_16x16x32_bf16 a[36:39], a[244:247], v[176:179], a[36:39]
s_waitcnt lgkmcnt(4)
ds_read_b64_tr_b16 a[244:245], v241 offset:128
ds_read_b64_tr_b16 a[246:247], v241 offset:6272
v_mfma_f32_16x16x32_bf16 a[40:43], a[248:251], v[160:163], a[40:43]
s_add_u32 m0, m0, 3072
v_exp_f32 v231, v137
v_mfma_f32_16x16x32_bf16 a[44:47], a[248:251], v[164:167], a[44:47]
s_add_u32 s40, s34, 3072
v_exp_f32 v232, v138
v_mfma_f32_16x16x32_bf16 a[48:51], a[248:251], v[168:171], a[48:51]
s_waitcnt vmcnt(5)
v_exp_f32 v233, v139
v_mfma_f32_16x16x32_bf16 a[52:55], a[248:251], v[172:175], a[52:55]
v_add_f32 v228, v234, v235
v_cvt_pk_bf16_f32 v193, v236, v237
v_mfma_f32_16x16x32_bf16 a[56:59], a[248:251], v[176:179], a[56:59]
s_waitcnt lgkmcnt(4)
ds_read_b64_tr_b16 a[248:249], v242 offset:128
ds_read_b64_tr_b16 a[250:251], v242 offset:6272
v_mfma_f32_16x16x32_bf16 a[60:63], a[252:255], v[160:163], a[60:63]
v_add_f32 v228, v228, v236
v_add_f32 v228, v228, v237
v_mfma_f32_16x16x32_bf16 a[64:67], a[252:255], v[164:167], a[64:67]
buffer_load_dwordx4 v245, s[16:19], s40 offen offset:0 nt lds
v_mfma_f32_16x16x32_bf16 a[68:71], a[252:255], v[168:171], a[68:71]
s_waitcnt vmcnt(5)
v_cvt_pk_bf16_f32 v196, v230, v231
v_add_f32 v229, v230, v231
v_mfma_f32_16x16x32_bf16 a[72:75], a[252:255], v[172:175], a[72:75]
v_cvt_pk_bf16_f32 v197, v232, v233
v_add_f32 v229, v229, v232
v_mfma_f32_16x16x32_bf16 a[76:79], a[252:255], v[176:179], a[76:79]
s_waitcnt lgkmcnt(4)
ds_read_b64_tr_b16 a[252:253], v243 offset:128
ds_read_b64_tr_b16 a[254:255], v243 offset:6272
v_mfma_f32_16x16x32_bf16 a[80:83], a[240:243], v[160:163], a[80:83]
v_add_f32 v229, v229, v233
v_max3_f32 v244, v225, v226, v227
v_mfma_f32_16x16x32_bf16 a[84:87], a[240:243], v[164:167], a[84:87]
v_max3_f32 v244, v244, v228, v229
v_cmp_ngt_f32 vcc, 2.0, v244
v_mfma_f32_16x16x32_bf16 a[88:91], a[240:243], v[168:171], a[88:91]
s_cbranch_vccnz L_tr37
L_back37:
v_exp_f32 v234, v140
v_mfma_f32_16x16x32_bf16 a[92:95], a[240:243], v[172:175], a[92:95]
v_exp_f32 v235, v141
v_mfma_f32_16x16x32_bf16 a[96:99], a[240:243], v[176:179], a[96:99]
s_waitcnt lgkmcnt(4)
ds_read_b64_tr_b16 a[240:241], v240 offset:256
ds_read_b64_tr_b16 a[242:243], v240 offset:6400
v_mfma_f32_16x16x32_bf16 a[100:103], a[244:247], v[160:163], a[100:103]
buffer_load_dwordx4 v246, s[16:19], s40 offen offset:1024 nt lds
v_mfma_f32_16x16x32_bf16 a[104:107], a[244:247], v[164:167], a[104:107]
s_waitcnt vmcnt(5)
v_exp_f32 v236, v142
v_mfma_f32_16x16x32_bf16 a[108:111], a[244:247], v[168:171], a[108:111]
v_exp_f32 v237, v143
v_mfma_f32_16x16x32_bf16 a[112:115], a[244:247], v[172:175], a[112:115]
v_exp_f32 v230, v144
v_mfma_f32_16x16x32_bf16 a[116:119], a[244:247], v[176:179], a[116:119]
s_waitcnt lgkmcnt(4)
ds_read_b64_tr_b16 a[244:245], v241 offset:256
ds_read_b64_tr_b16 a[246:247], v241 offset:6400
v_mfma_f32_16x16x32_bf16 a[120:123], a[248:251], v[160:163], a[120:123]
v_exp_f32 v231, v145
v_mfma_f32_16x16x32_bf16 a[124:127], a[248:251], v[164:167], a[124:127]
v_exp_f32 v232, v146
v_mfma_f32_16x16x32_bf16 a[128:131], a[248:251], v[168:171], a[128:131]
v_exp_f32 v233, v147
v_mfma_f32_16x16x32_bf16 a[132:135], a[248:251], v[172:175], a[132:135]
buffer_load_dwordx4 v247, s[16:19], s40 offen offset:2048 nt lds
v_mfma_f32_16x16x32_bf16 a[136:139], a[248:251], v[176:179], a[136:139]
s_waitcnt lgkmcnt(4)
ds_read_b64_tr_b16 a[248:249], v242 offset:256
ds_read_b64_tr_b16 a[250:251], v242 offset:6400
v_mfma_f32_16x16x32_bf16 a[140:143], a[252:255], v[160:163], a[140:143]
s_add_u32 s34, s34, 208896
v_add_f32 v220, v220, v225
v_add_f32 v221, v221, v226
v_mfma_f32_16x16x32_bf16 a[144:147], a[252:255], v[164:167], a[144:147]
s_add_u32 s31, s31, 24576
v_add_f32 v222, v222, v227
v_add_f32 v223, v223, v228
v_mfma_f32_16x16x32_bf16 a[148:151], a[252:255], v[168:171], a[148:151]
s_sub_u32 s41, s31, 147456
v_add_f32 v224, v224, v229
v_cvt_pk_bf16_f32 v182, v234, v235
v_mfma_f32_16x16x32_bf16 a[152:155], a[252:255], v[172:175], a[152:155]
s_min_u32 s31, s31, s41
v_add_f32 v225, v234, v235
v_cvt_pk_bf16_f32 v183, v236, v237
v_mfma_f32_16x16x32_bf16 a[156:159], a[252:255], v[176:179], a[156:159]
s_waitcnt lgkmcnt(4)
ds_read_b64_tr_b16 a[252:253], v243 offset:256
ds_read_b64_tr_b16 a[254:255], v243 offset:6400
v_mfma_f32_16x16x32_bf16 a[160:163], a[240:243], v[160:163], a[160:163]
v_add_u32 v240, s32, v253
v_xor_b32 v241, 32, v240
v_mfma_f32_16x16x32_bf16 a[164:167], a[240:243], v[164:167], a[164:167]
v_xor_b32 v242, 64, v240
v_xor_b32 v243, 64, v241
v_mfma_f32_16x16x32_bf16 a[168:171], a[240:243], v[168:171], a[168:171]
s_add_u32 s32, s32, 24576
v_add_f32 v225, v225, v236
v_add_f32 v225, v225, v237
v_mfma_f32_16x16x32_bf16 a[172:175], a[240:243], v[172:175], a[172:175]
s_sub_u32 s42, s32, 147456
v_exp_f32 v234, v148
v_mfma_f32_16x16x32_bf16 a[176:179], a[240:243], v[176:179], a[176:179]
s_waitcnt lgkmcnt(4)
v_exp_f32 v235, v149
v_mfma_f32_16x16x32_bf16 a[180:183], a[244:247], v[160:163], a[180:183]
s_min_u32 s32, s32, s42
v_exp_f32 v236, v150
v_mfma_f32_16x16x32_bf16 a[184:187], a[244:247], v[164:167], a[184:187]
v_exp_f32 v237, v151
v_mfma_f32_16x16x32_bf16 a[188:191], a[244:247], v[168:171], a[188:191]
v_cvt_pk_bf16_f32 v186, v230, v231
v_add_f32 v226, v230, v231
v_mfma_f32_16x16x32_bf16 a[192:195], a[244:247], v[172:175], a[192:195]
s_waitcnt vmcnt(63) lgkmcnt(0)
s_barrier
ds_read_b128 a[240:243], v238 offset:0
v_mfma_f32_16x16x32_bf16 a[196:199], a[244:247], v[176:179], a[196:199]
s_waitcnt lgkmcnt(15)
ds_read_b128 a[244:247], v239 offset:0
v_cvt_pk_bf16_f32 v187, v232, v233
v_mfma_f32_16x16x32_bf16 a[200:203], a[248:251], v[160:163], a[200:203]
s_add_u32 s48, s48, 768
v_add_f32 v226, v226, v232
v_add_f32 v226, v226, v233
v_mfma_f32_16x16x32_bf16 a[204:207], a[248:251], v[164:167], a[204:207]
s_mov_b32 s35, s87
v_exp_f32 v230, v152
v_mfma_f32_16x16x32_bf16 a[208:211], a[248:251], v[168:171], a[208:211]
s_mov_b32 s54, s3
v_exp_f32 v231, v153
v_mfma_f32_16x16x32_bf16 a[212:215], a[248:251], v[172:175], a[212:215]
s_add_u32 m0, s31, s38
v_exp_f32 v232, v154
v_mfma_f32_16x16x32_bf16 a[216:219], a[248:251], v[176:179], a[216:219]
s_waitcnt lgkmcnt(15)
ds_read_b128 a[248:251], v238 offset:128
v_cvt_pk_bf16_f32 v190, v234, v235
v_mfma_f32_16x16x32_bf16 a[220:223], a[252:255], v[160:163], a[220:223]
s_add_u32 s40, s35, s48
v_exp_f32 v233, v155
v_mfma_f32_16x16x32_bf16 a[224:227], a[252:255], v[164:167], a[224:227]
buffer_load_dwordx4 v248, s[20:23], s40 offen offset:0 lds
v_mfma_f32_16x16x32_bf16 a[228:231], a[252:255], v[168:171], a[228:231]
v_add_f32 v227, v234, v235
v_cvt_pk_bf16_f32 v191, v236, v237
v_mfma_f32_16x16x32_bf16 a[232:235], a[252:255], v[172:175], a[232:235]
v_add_f32 v227, v227, v236
v_add_f32 v227, v227, v237
v_mfma_f32_16x16x32_bf16 a[236:239], a[252:255], v[176:179], a[236:239]
s_waitcnt lgkmcnt(2)
ds_read_b128 a[252:255], v239 offset:128
v_cvt_pk_bf16_f32 v194, v230, v231
v_mfma_f32_16x16x32_bf16 v[120:123], a[240:243], v[0:3], v[200:203]
v_exp_f32 v234, v156
v_mfma_f32_16x16x32_bf16 v[124:127], a[240:243], v[4:7], v[204:207]
v_exp_f32 v235, v157
v_mfma_f32_16x16x32_bf16 v[128:131], a[240:243], v[8:11], v[208:211]
v_exp_f32 v236, v158
v_mfma_f32_16x16x32_bf16 v[132:135], a[240:243], v[12:15], v[212:215]
v_exp_f32 v237, v159
v_mfma_f32_16x16x32_bf16 v[136:139], a[240:243], v[16:19], v[216:219]
s_waitcnt lgkmcnt(2)
ds_read_b128 a[240:243], v238 offset:256
v_add_f32 v228, v230, v231
v_mfma_f32_16x16x32_bf16 v[120:123], a[244:247], v[20:23], v[120:123]
buffer_load_dwordx4 v249, s[20:23], s40 offen offset:1024 lds
v_mfma_f32_16x16x32_bf16 v[124:127], a[244:247], v[24:27], v[124:127]
v_cvt_pk_bf16_f32 v195, v232, v233
v_add_f32 v228, v228, v232
v_mfma_f32_16x16x32_bf16 v[128:131], a[244:247], v[28:31], v[128:131]
v_add_f32 v228, v228, v233
v_cvt_pk_bf16_f32 v198, v234, v235
v_mfma_f32_16x16x32_bf16 v[132:135], a[244:247], v[32:35], v[132:135]
v_add_f32 v229, v234, v235
v_cvt_pk_bf16_f32 v199, v236, v237
v_mfma_f32_16x16x32_bf16 v[136:139], a[244:247], v[36:39], v[136:139]
s_waitcnt lgkmcnt(2)
ds_read_b128 a[244:247], v239 offset:256
v_add_f32 v229, v229, v236
v_mfma_f32_16x16x32_bf16 v[120:123], a[248:251], v[40:43], v[120:123]
v_add_f32 v229, v229, v237
v_max3_f32 v244, v225, v226, v227
v_mfma_f32_16x16x32_bf16 v[124:127], a[248:251], v[44:47], v[124:127]
v_max3_f32 v244, v244, v228, v229
v_cmp_ngt_f32 vcc, 2.0, v244
v_mfma_f32_16x16x32_bf16 v[128:131], a[248:251], v[48:51], v[128:131]
v_mfma_f32_16x16x32_bf16 v[132:135], a[248:251], v[52:55], v[132:135]
buffer_load_dwordx4 v250, s[20:23], s40 offen offset:2048 lds
v_mfma_f32_16x16x32_bf16 v[136:139], a[248:251], v[56:59], v[136:139]
s_waitcnt lgkmcnt(2)
ds_read_b128 a[248:251], v238 offset:6144
v_mfma_f32_16x16x32_bf16 v[120:123], a[252:255], v[60:63], v[120:123]
s_add_u32 m0, m0, 6144
v_mfma_f32_16x16x32_bf16 v[124:127], a[252:255], v[64:67], v[124:127]
s_add_u32 s40, s40, 196608
v_mfma_f32_16x16x32_bf16 v[128:131], a[252:255], v[68:71], v[128:131]
v_mfma_f32_16x16x32_bf16 v[132:135], a[252:255], v[72:75], v[132:135]
v_mfma_f32_16x16x32_bf16 v[136:139], a[252:255], v[76:79], v[136:139]
s_waitcnt lgkmcnt(2)
ds_read_b128 a[252:255], v239 offset:6144
v_mfma_f32_16x16x32_bf16 v[120:123], a[240:243], v[80:83], v[120:123]
v_mfma_f32_16x16x32_bf16 v[124:127], a[240:243], v[84:87], v[124:127]
buffer_load_dwordx4 v248, s[20:23], s40 offen offset:0 lds
v_mfma_f32_16x16x32_bf16 v[128:131], a[240:243], v[88:91], v[128:131]
v_mfma_f32_16x16x32_bf16 v[132:135], a[240:243], v[92:95], v[132:135]
v_mfma_f32_16x16x32_bf16 v[136:139], a[240:243], v[96:99], v[136:139]
s_waitcnt lgkmcnt(2)
ds_read_b128 a[240:243], v238 offset:6272
v_mfma_f32_16x16x32_bf16 v[120:123], a[244:247], v[100:103], v[120:123]
v_mfma_f32_16x16x32_bf16 v[124:127], a[244:247], v[104:107], v[124:127]
v_mfma_f32_16x16x32_bf16 v[128:131], a[244:247], v[108:111], v[128:131]
v_mfma_f32_16x16x32_bf16 v[132:135], a[244:247], v[112:115], v[132:135]
v_mfma_f32_16x16x32_bf16 v[136:139], a[244:247], v[116:119], v[136:139]
s_cbranch_vccnz L_tr38
L_back38:
s_waitcnt lgkmcnt(2)
ds_read_b128 a[244:247], v239 offset:6272
v_mfma_f32_16x16x32_bf16 v[140:143], a[248:251], v[0:3], v[200:203]
buffer_load_dwordx4 v249, s[20:23], s40 offen offset:1024 lds
v_mfma_f32_16x16x32_bf16 v[144:147], a[248:251], v[4:7], v[204:207]
v_exp_f32 v230, v120
v_mfma_f32_16x16x32_bf16 v[148:151], a[248:251], v[8:11], v[208:211]
v_exp_f32 v231, v121
v_mfma_f32_16x16x32_bf16 v[152:155], a[248:251], v[12:15], v[212:215]
v_exp_f32 v232, v122
v_mfma_f32_16x16x32_bf16 v[156:159], a[248:251], v[16:19], v[216:219]
s_waitcnt lgkmcnt(2)
ds_read_b128 a[248:251], v238 offset:6400
v_add_f32 v220, v220, v225
v_mfma_f32_16x16x32_bf16 v[140:143], a[252:255], v[20:23], v[140:143]
v_exp_f32 v233, v123
v_mfma_f32_16x16x32_bf16 v[144:147], a[252:255], v[24:27], v[144:147]
v_exp_f32 v234, v124
v_mfma_f32_16x16x32_bf16 v[148:151], a[252:255], v[28:31], v[148:151]
v_exp_f32 v235, v125
v_mfma_f32_16x16x32_bf16 v[152:155], a[252:255], v[32:35], v[152:155]
buffer_load_dwordx4 v250, s[20:23], s40 offen offset:2048 lds
v_mfma_f32_16x16x32_bf16 v[156:159], a[252:255], v[36:39], v[156:159]
s_waitcnt lgkmcnt(2)
ds_read_b128 a[252:255], v239 offset:6400
v_add_f32 v221, v221, v226
v_mfma_f32_16x16x32_bf16 v[140:143], a[240:243], v[40:43], v[140:143]
s_add_u32 s35, s35, 393216
v_add_u32 v238, s32, v252
v_xor_b32 v239, 64, v238
v_mfma_f32_16x16x32_bf16 v[144:147], a[240:243], v[44:47], v[144:147]
s_add_u32 s32, s32, 24576
v_exp_f32 v236, v126
v_mfma_f32_16x16x32_bf16 v[148:151], a[240:243], v[48:51], v[148:151]
s_sub_u32 s42, s32, 147456
v_exp_f32 v237, v127
v_mfma_f32_16x16x32_bf16 v[152:155], a[240:243], v[52:55], v[152:155]
s_min_u32 s32, s32, s42
v_add_f32 v222, v222, v227
v_add_f32 v223, v223, v228
v_mfma_f32_16x16x32_bf16 v[156:159], a[240:243], v[56:59], v[156:159]
s_waitcnt lgkmcnt(2)
v_add_f32 v224, v224, v229
v_cvt_pk_bf16_f32 v160, v230, v231
v_mfma_f32_16x16x32_bf16 v[140:143], a[244:247], v[60:63], v[140:143]
s_sub_u32 s40, s35, 7864320
v_add_f32 v225, v230, v231
v_cvt_pk_bf16_f32 v161, v232, v233
v_mfma_f32_16x16x32_bf16 v[144:147], a[244:247], v[64:67], v[144:147]
s_min_u32 s35, s35, s40
v_add_f32 v225, v225, v232
v_add_f32 v225, v225, v233
v_mfma_f32_16x16x32_bf16 v[148:151], a[244:247], v[68:71], v[148:151]
s_add_u32 s31, s31, 24576
v_exp_f32 v230, v128
v_mfma_f32_16x16x32_bf16 v[152:155], a[244:247], v[72:75], v[152:155]
s_waitcnt vmcnt(63) lgkmcnt(0)
s_barrier
ds_read_b64_tr_b16 a[240:241], v240 offset:0
v_mfma_f32_16x16x32_bf16 v[156:159], a[244:247], v[76:79], v[156:159]
s_waitcnt lgkmcnt(15)
ds_read_b64_tr_b16 a[242:243], v240 offset:6144
ds_read_b64_tr_b16 a[244:245], v241 offset:0
v_mfma_f32_16x16x32_bf16 v[140:143], a[248:251], v[80:83], v[140:143]
s_sub_u32 s41, s31, 147456
ds_read_b64_tr_b16 a[246:247], v241 offset:6144
v_cvt_pk_bf16_f32 v164, v234, v235
v_mfma_f32_16x16x32_bf16 v[144:147], a[248:251], v[84:87], v[144:147]
s_min_u32 s31, s31, s41
v_exp_f32 v231, v129
v_mfma_f32_16x16x32_bf16 v[148:151], a[248:251], v[88:91], v[148:151]
s_add_u32 m0, s31, s55
v_exp_f32 v232, v130
v_mfma_f32_16x16x32_bf16 v[152:155], a[248:251], v[92:95], v[152:155]
s_add_u32 s40, s54, s49
v_exp_f32 v233, v131
v_mfma_f32_16x16x32_bf16 v[156:159], a[248:251], v[96:99], v[156:159]
s_waitcnt lgkmcnt(15)
ds_read_b64_tr_b16 a[248:249], v242 offset:0
ds_read_b64_tr_b16 a[250:251], v242 offset:6144
v_mfma_f32_16x16x32_bf16 v[140:143], a[252:255], v[100:103], v[140:143]
buffer_load_dwordx4 v251, s[8:11], s40 offen offset:0 lds
v_mfma_f32_16x16x32_bf16 v[144:147], a[252:255], v[104:107], v[144:147]
s_add_u32 s40, s40, 9216
v_add_f32 v226, v234, v235
v_cvt_pk_bf16_f32 v165, v236, v237
v_mfma_f32_16x16x32_bf16 v[148:151], a[252:255], v[108:111], v[148:151]
v_add_f32 v226, v226, v236
v_add_f32 v226, v226, v237
v_mfma_f32_16x16x32_bf16 v[152:155], a[252:255], v[112:115], v[152:155]
v_exp_f32 v234, v132
v_mfma_f32_16x16x32_bf16 v[156:159], a[252:255], v[116:119], v[156:159]
s_waitcnt lgkmcnt(4)
ds_read_b64_tr_b16 a[252:253], v243 offset:0
ds_read_b64_tr_b16 a[254:255], v243 offset:6144
v_mfma_f32_16x16x32_bf16 a[0:3], a[240:243], v[180:183], a[0:3]
v_exp_f32 v235, v133
v_mfma_f32_16x16x32_bf16 a[4:7], a[240:243], v[184:187], a[4:7]
v_exp_f32 v236, v134
v_mfma_f32_16x16x32_bf16 a[8:11], a[240:243], v[188:191], a[8:11]
v_exp_f32 v237, v135
v_mfma_f32_16x16x32_bf16 a[12:15], a[240:243], v[192:195], a[12:15]
buffer_load_dwordx4 v251, s[8:11], s40 offen offset:1024 lds
v_mfma_f32_16x16x32_bf16 a[16:19], a[240:243], v[196:199], a[16:19]
s_waitcnt lgkmcnt(4)
ds_read_b64_tr_b16 a[240:241], v240 offset:128
ds_read_b64_tr_b16 a[242:243], v240 offset:6272
v_mfma_f32_16x16x32_bf16 a[20:23], a[244:247], v[180:183], a[20:23]
s_add_u32 s40, s40, 9216
v_cvt_pk_bf16_f32 v168, v230, v231
v_add_f32 v227, v230, v231
v_mfma_f32_16x16x32_bf16 a[24:27], a[244:247], v[184:187], a[24:27]
v_cvt_pk_bf16_f32 v169, v232, v233
v_add_f32 v227, v227, v232
v_mfma_f32_16x16x32_bf16 a[28:31], a[244:247], v[188:191], a[28:31]
v_add_f32 v227, v227, v233
v_cvt_pk_bf16_f32 v172, v234, v235
v_mfma_f32_16x16x32_bf16 a[32:35], a[244:247], v[192:195], a[32:35]
v_exp_f32 v230, v136
v_mfma_f32_16x16x32_bf16 a[36:39], a[244:247], v[196:199], a[36:39]
s_waitcnt lgkmcnt(4)
ds_read_b64_tr_b16 a[244:245], v241 offset:128
ds_read_b64_tr_b16 a[246:247], v241 offset:6272
v_mfma_f32_16x16x32_bf16 a[40:43], a[248:251], v[180:183], a[40:43]
v_exp_f32 v231, v137
v_mfma_f32_16x16x32_bf16 a[44:47], a[248:251], v[184:187], a[44:47]
buffer_load_dwordx4 v251, s[8:11], s40 offen offset:2048 lds
v_mfma_f32_16x16x32_bf16 a[48:51], a[248:251], v[188:191], a[48:51]
s_add_u32 s40, s40, 9216
v_exp_f32 v232, v138
v_mfma_f32_16x16x32_bf16 a[52:55], a[248:251], v[192:195], a[52:55]
v_exp_f32 v233, v139
v_mfma_f32_16x16x32_bf16 a[56:59], a[248:251], v[196:199], a[56:59]
s_waitcnt lgkmcnt(4)
ds_read_b64_tr_b16 a[248:249], v242 offset:128
ds_read_b64_tr_b16 a[250:251], v242 offset:6272
v_mfma_f32_16x16x32_bf16 a[60:63], a[252:255], v[180:183], a[60:63]
v_add_f32 v228, v234, v235
v_cvt_pk_bf16_f32 v173, v236, v237
v_mfma_f32_16x16x32_bf16 a[64:67], a[252:255], v[184:187], a[64:67]
v_add_f32 v228, v228, v236
v_add_f32 v228, v228, v237
v_mfma_f32_16x16x32_bf16 a[68:71], a[252:255], v[188:191], a[68:71]
v_cvt_pk_bf16_f32 v176, v230, v231
v_add_f32 v229, v230, v231
v_mfma_f32_16x16x32_bf16 a[72:75], a[252:255], v[192:195], a[72:75]
v_cvt_pk_bf16_f32 v177, v232, v233
v_add_f32 v229, v229, v232
v_mfma_f32_16x16x32_bf16 a[76:79], a[252:255], v[196:199], a[76:79]
s_waitcnt lgkmcnt(4)
ds_read_b64_tr_b16 a[252:253], v243 offset:128
ds_read_b64_tr_b16 a[254:255], v243 offset:6272
v_mfma_f32_16x16x32_bf16 a[80:83], a[240:243], v[180:183], a[80:83]
buffer_load_dwordx4 v251, s[8:11], s40 offen offset:3072 lds
v_mfma_f32_16x16x32_bf16 a[84:87], a[240:243], v[184:187], a[84:87]
s_add_u32 m0, m0, 4096
v_add_f32 v229, v229, v233
v_max3_f32 v244, v225, v226, v227
v_mfma_f32_16x16x32_bf16 a[88:91], a[240:243], v[188:191], a[88:91]
s_add_u32 s40, s40, 13312
v_max3_f32 v244, v244, v228, v229
v_cmp_ngt_f32 vcc, 2.0, v244
v_mfma_f32_16x16x32_bf16 a[92:95], a[240:243], v[192:195], a[92:95]
s_cbranch_vccnz L_tr40
L_back40:
v_exp_f32 v234, v140
v_mfma_f32_16x16x32_bf16 a[96:99], a[240:243], v[196:199], a[96:99]
s_waitcnt lgkmcnt(4)
ds_read_b64_tr_b16 a[240:241], v240 offset:256
ds_read_b64_tr_b16 a[242:243], v240 offset:6400
v_mfma_f32_16x16x32_bf16 a[100:103], a[244:247], v[180:183], a[100:103]
v_exp_f32 v235, v141
v_mfma_f32_16x16x32_bf16 a[104:107], a[244:247], v[184:187], a[104:107]
v_exp_f32 v236, v142
v_mfma_f32_16x16x32_bf16 a[108:111], a[244:247], v[188:191], a[108:111]
v_exp_f32 v237, v143
v_mfma_f32_16x16x32_bf16 a[112:115], a[244:247], v[192:195], a[112:115]
buffer_load_dwordx4 v251, s[8:11], s40 offen lds
v_mfma_f32_16x16x32_bf16 a[116:119], a[244:247], v[196:199], a[116:119]
s_waitcnt lgkmcnt(4)
ds_read_b64_tr_b16 a[244:245], v241 offset:256
ds_read_b64_tr_b16 a[246:247], v241 offset:6400
v_mfma_f32_16x16x32_bf16 a[120:123], a[248:251], v[180:183], a[120:123]
s_add_u32 s54, s54, 128
v_exp_f32 v230, v144
v_mfma_f32_16x16x32_bf16 a[124:127], a[248:251], v[184:187], a[124:127]
s_sub_u32 s40, s54, 1280
v_exp_f32 v231, v145
v_mfma_f32_16x16x32_bf16 a[128:131], a[248:251], v[188:191], a[128:131]
s_min_u32 s54, s54, s40
v_exp_f32 v232, v146
v_mfma_f32_16x16x32_bf16 a[132:135], a[248:251], v[192:195], a[132:135]
s_add_u32 s31, s31, 24576
v_exp_f32 v233, v147
v_mfma_f32_16x16x32_bf16 a[136:139], a[248:251], v[196:199], a[136:139]
s_waitcnt lgkmcnt(4)
ds_read_b64_tr_b16 a[248:249], v242 offset:256
ds_read_b64_tr_b16 a[250:251], v242 offset:6400
v_mfma_f32_16x16x32_bf16 a[140:143], a[252:255], v[180:183], a[140:143]
s_sub_u32 s41, s31, 147456
v_add_f32 v220, v220, v225
v_add_f32 v221, v221, v226
v_mfma_f32_16x16x32_bf16 a[144:147], a[252:255], v[184:187], a[144:147]
s_min_u32 s31, s31, s41
v_add_f32 v222, v222, v227
v_add_f32 v223, v223, v228
v_mfma_f32_16x16x32_bf16 a[148:151], a[252:255], v[188:191], a[148:151]
v_add_f32 v224, v224, v229
v_cvt_pk_bf16_f32 v162, v234, v235
v_mfma_f32_16x16x32_bf16 a[152:155], a[252:255], v[192:195], a[152:155]
v_add_f32 v225, v234, v235
v_cvt_pk_bf16_f32 v163, v236, v237
v_mfma_f32_16x16x32_bf16 a[156:159], a[252:255], v[196:199], a[156:159]
s_waitcnt lgkmcnt(4)
ds_read_b64_tr_b16 a[252:253], v243 offset:256
ds_read_b64_tr_b16 a[254:255], v243 offset:6400
v_mfma_f32_16x16x32_bf16 a[160:163], a[240:243], v[180:183], a[160:163]
v_add_u32 v240, s32, v253
v_xor_b32 v241, 32, v240
v_mfma_f32_16x16x32_bf16 a[164:167], a[240:243], v[184:187], a[164:167]
v_xor_b32 v242, 64, v240
v_xor_b32 v243, 64, v241
v_mfma_f32_16x16x32_bf16 a[168:171], a[240:243], v[188:191], a[168:171]
s_add_u32 s32, s32, 24576
v_add_f32 v225, v225, v236
v_add_f32 v225, v225, v237
v_mfma_f32_16x16x32_bf16 a[172:175], a[240:243], v[192:195], a[172:175]
s_sub_u32 s42, s32, 147456
v_exp_f32 v234, v148
v_mfma_f32_16x16x32_bf16 a[176:179], a[240:243], v[196:199], a[176:179]
s_waitcnt lgkmcnt(4)
v_exp_f32 v235, v149
v_mfma_f32_16x16x32_bf16 a[180:183], a[244:247], v[180:183], a[180:183]
s_min_u32 s32, s32, s42
v_exp_f32 v236, v150
v_mfma_f32_16x16x32_bf16 a[184:187], a[244:247], v[184:187], a[184:187]
v_exp_f32 v237, v151
v_mfma_f32_16x16x32_bf16 a[188:191], a[244:247], v[188:191], a[188:191]
v_cvt_pk_bf16_f32 v166, v230, v231
v_add_f32 v226, v230, v231
v_mfma_f32_16x16x32_bf16 a[192:195], a[244:247], v[192:195], a[192:195]
s_waitcnt vmcnt(63) lgkmcnt(0)
s_barrier
ds_read_b128 a[240:243], v238 offset:0
v_mfma_f32_16x16x32_bf16 a[196:199], a[244:247], v[196:199], a[196:199]
s_waitcnt lgkmcnt(15)
ds_read_b128 a[244:247], v239 offset:0
v_cvt_pk_bf16_f32 v167, v232, v233
v_mfma_f32_16x16x32_bf16 a[200:203], a[248:251], v[180:183], a[200:203]
s_add_u32 m0, s31, s38
v_add_f32 v226, v226, v232
v_add_f32 v226, v226, v233
v_mfma_f32_16x16x32_bf16 a[204:207], a[248:251], v[184:187], a[204:207]
s_add_u32 s40, s35, s48
v_exp_f32 v230, v152
v_mfma_f32_16x16x32_bf16 a[208:211], a[248:251], v[188:191], a[208:211]
buffer_load_dwordx4 v248, s[20:23], s40 offen offset:0 lds
v_mfma_f32_16x16x32_bf16 a[212:215], a[248:251], v[192:195], a[212:215]
v_exp_f32 v231, v153
v_mfma_f32_16x16x32_bf16 a[216:219], a[248:251], v[196:199], a[216:219]
s_waitcnt lgkmcnt(15)
ds_read_b128 a[248:251], v238 offset:128
v_cvt_pk_bf16_f32 v170, v234, v235
v_mfma_f32_16x16x32_bf16 a[220:223], a[252:255], v[180:183], a[220:223]
v_exp_f32 v232, v154
v_mfma_f32_16x16x32_bf16 a[224:227], a[252:255], v[184:187], a[224:227]
v_exp_f32 v233, v155
v_mfma_f32_16x16x32_bf16 a[228:231], a[252:255], v[188:191], a[228:231]
v_add_f32 v227, v234, v235
v_cvt_pk_bf16_f32 v171, v236, v237
v_mfma_f32_16x16x32_bf16 a[232:235], a[252:255], v[192:195], a[232:235]
v_add_f32 v227, v227, v236
v_add_f32 v227, v227, v237
v_mfma_f32_16x16x32_bf16 a[236:239], a[252:255], v[196:199], a[236:239]
s_waitcnt lgkmcnt(2)
ds_read_b128 a[252:255], v239 offset:128
v_cvt_pk_bf16_f32 v174, v230, v231
v_mfma_f32_16x16x32_bf16 v[120:123], a[240:243], v[0:3], v[200:203]
buffer_load_dwordx4 v249, s[20:23], s40 offen offset:1024 lds
v_mfma_f32_16x16x32_bf16 v[124:127], a[240:243], v[4:7], v[204:207]
v_exp_f32 v234, v156
v_mfma_f32_16x16x32_bf16 v[128:131], a[240:243], v[8:11], v[208:211]
v_exp_f32 v235, v157
v_mfma_f32_16x16x32_bf16 v[132:135], a[240:243], v[12:15], v[212:215]
v_exp_f32 v236, v158
v_mfma_f32_16x16x32_bf16 v[136:139], a[240:243], v[16:19], v[216:219]
s_waitcnt lgkmcnt(2)
ds_read_b128 a[240:243], v238 offset:256
v_add_f32 v228, v230, v231
v_mfma_f32_16x16x32_bf16 v[120:123], a[244:247], v[20:23], v[120:123]
v_exp_f32 v237, v159
v_mfma_f32_16x16x32_bf16 v[124:127], a[244:247], v[24:27], v[124:127]
v_cvt_pk_bf16_f32 v175, v232, v233
v_add_f32 v228, v228, v232
v_mfma_f32_16x16x32_bf16 v[128:131], a[244:247], v[28:31], v[128:131]
v_add_f32 v228, v228, v233
v_cvt_pk_bf16_f32 v178, v234, v235
v_mfma_f32_16x16x32_bf16 v[132:135], a[244:247], v[32:35], v[132:135]
buffer_load_dwordx4 v250, s[20:23], s40 offen offset:2048 lds
v_mfma_f32_16x16x32_bf16 v[136:139], a[244:247], v[36:39], v[136:139]
s_waitcnt lgkmcnt(2)
ds_read_b128 a[244:247], v239 offset:256
v_add_f32 v229, v234, v235
v_mfma_f32_16x16x32_bf16 v[120:123], a[248:251], v[40:43], v[120:123]
s_add_u32 m0, m0, 6144
v_cvt_pk_bf16_f32 v179, v236, v237
v_add_f32 v229, v229, v236
v_mfma_f32_16x16x32_bf16 v[124:127], a[248:251], v[44:47], v[124:127]
s_add_u32 s40, s40, 196608
v_add_f32 v229, v229, v237
v_max3_f32 v244, v225, v226, v227
v_mfma_f32_16x16x32_bf16 v[128:131], a[248:251], v[48:51], v[128:131]
v_max3_f32 v244, v244, v228, v229
v_cmp_ngt_f32 vcc, 2.0, v244
v_mfma_f32_16x16x32_bf16 v[132:135], a[248:251], v[52:55], v[132:135]
v_mfma_f32_16x16x32_bf16 v[136:139], a[248:251], v[56:59], v[136:139]
s_waitcnt lgkmcnt(2)
ds_read_b128 a[248:251], v238 offset:6144
v_mfma_f32_16x16x32_bf16 v[120:123], a[252:255], v[60:63], v[120:123]
v_mfma_f32_16x16x32_bf16 v[124:127], a[252:255], v[64:67], v[124:127]
buffer_load_dwordx4 v248, s[20:23], s40 offen offset:0 lds
v_mfma_f32_16x16x32_bf16 v[128:131], a[252:255], v[68:71], v[128:131]
v_mfma_f32_16x16x32_bf16 v[132:135], a[252:255], v[72:75], v[132:135]
v_mfma_f32_16x16x32_bf16 v[136:139], a[252:255], v[76:79], v[136:139]
s_waitcnt lgkmcnt(2)
ds_read_b128 a[252:255], v239 offset:6144
v_mfma_f32_16x16x32_bf16 v[120:123], a[240:243], v[80:83], v[120:123]
v_mfma_f32_16x16x32_bf16 v[124:127], a[240:243], v[84:87], v[124:127]
v_mfma_f32_16x16x32_bf16 v[128:131], a[240:243], v[88:91], v[128:131]
v_mfma_f32_16x16x32_bf16 v[132:135], a[240:243], v[92:95], v[132:135]
v_mfma_f32_16x16x32_bf16 v[136:139], a[240:243], v[96:99], v[136:139]
s_waitcnt lgkmcnt(2)
ds_read_b128 a[240:243], v238 offset:6272
v_mfma_f32_16x16x32_bf16 v[120:123], a[244:247], v[100:103], v[120:123]
buffer_load_dwordx4 v249, s[20:23], s40 offen offset:1024 lds
v_mfma_f32_16x16x32_bf16 v[124:127], a[244:247], v[104:107], v[124:127]
v_mfma_f32_16x16x32_bf16 v[128:131], a[244:247], v[108:111], v[128:131]
v_mfma_f32_16x16x32_bf16 v[132:135], a[244:247], v[112:115], v[132:135]
v_mfma_f32_16x16x32_bf16 v[136:139], a[244:247], v[116:119], v[136:139]
s_cbranch_vccnz L_tr41
L_back41:
s_waitcnt lgkmcnt(2)
ds_read_b128 a[244:247], v239 offset:6272
v_mfma_f32_16x16x32_bf16 v[140:143], a[248:251], v[0:3], v[200:203]
v_exp_f32 v230, v120
v_add_f32 v220, v220, v225
v_mfma_f32_16x16x32_bf16 v[144:147], a[248:251], v[4:7], v[204:207]
v_exp_f32 v231, v121
v_add_f32 v221, v221, v226
v_mfma_f32_16x16x32_bf16 v[148:151], a[248:251], v[8:11], v[208:211]
v_exp_f32 v232, v122
v_add_f32 v222, v222, v227
v_mfma_f32_16x16x32_bf16 v[152:155], a[248:251], v[12:15], v[212:215]
buffer_load_dwordx4 v250, s[20:23], s40 offen offset:2048 lds
v_add_f32 v223, v223, v228
v_mfma_f32_16x16x32_bf16 v[156:159], a[248:251], v[16:19], v[216:219]
s_waitcnt lgkmcnt(2)
ds_read_b128 a[248:251], v238 offset:6400
v_exp_f32 v233, v123
v_mfma_f32_16x16x32_bf16 v[140:143], a[252:255], v[20:23], v[140:143]
s_add_u32 s35, s35, 393216
v_exp_f32 v234, v124
v_add_f32 v224, v224, v229
v_mfma_f32_16x16x32_bf16 v[144:147], a[252:255], v[24:27], v[144:147]
s_sub_u32 s40, s35, 7864320
v_exp_f32 v235, v125
v_cvt_pk_bf16_f32 v180, v230, v231
v_mfma_f32_16x16x32_bf16 v[148:151], a[252:255], v[28:31], v[148:151]
s_min_u32 s35, s35, s40
v_exp_f32 v236, v126
v_add_f32 v225, v230, v231
v_mfma_f32_16x16x32_bf16 v[152:155], a[252:255], v[32:35], v[152:155]
s_add_u32 s31, s31, 24576
v_exp_f32 v237, v127
v_cvt_pk_bf16_f32 v181, v232, v233
v_mfma_f32_16x16x32_bf16 v[156:159], a[252:255], v[36:39], v[156:159]
s_waitcnt lgkmcnt(2)
ds_read_b128 a[252:255], v239 offset:6400
v_add_f32 v225, v225, v232
v_add_f32 v225, v225, v233
v_mfma_f32_16x16x32_bf16 v[140:143], a[240:243], v[40:43], v[140:143]
s_sub_u32 s41, s31, 147456
v_exp_f32 v230, v128
v_cvt_pk_bf16_f32 v184, v234, v235
v_mfma_f32_16x16x32_bf16 v[144:147], a[240:243], v[44:47], v[144:147]
s_min_u32 s31, s31, s41
v_exp_f32 v231, v129
v_add_f32 v226, v234, v235
v_mfma_f32_16x16x32_bf16 v[148:151], a[240:243], v[48:51], v[148:151]
v_exp_f32 v232, v130
v_cvt_pk_bf16_f32 v185, v236, v237
v_mfma_f32_16x16x32_bf16 v[152:155], a[240:243], v[52:55], v[152:155]
v_exp_f32 v233, v131
v_add_f32 v226, v226, v236
v_mfma_f32_16x16x32_bf16 v[156:159], a[240:243], v[56:59], v[156:159]
s_waitcnt lgkmcnt(2)
v_add_f32 v226, v226, v237
v_cvt_pk_bf16_f32 v188, v230, v231
v_add_f32 v227, v230, v231
v_mfma_f32_16x16x32_bf16 v[140:143], a[244:247], v[60:63], v[140:143]
v_exp_f32 v234, v132
v_cvt_pk_bf16_f32 v189, v232, v233
v_mfma_f32_16x16x32_bf16 v[144:147], a[244:247], v[64:67], v[144:147]
v_exp_f32 v235, v133
v_add_f32 v227, v227, v232
v_mfma_f32_16x16x32_bf16 v[148:151], a[244:247], v[68:71], v[148:151]
v_exp_f32 v236, v134
v_add_f32 v227, v227, v233
v_mfma_f32_16x16x32_bf16 v[152:155], a[244:247], v[72:75], v[152:155]
s_waitcnt vmcnt(63) lgkmcnt(0)
s_barrier
ds_read_b64_tr_b16 a[240:241], v240 offset:0
ds_read_b64_tr_b16 a[242:243], v240 offset:6144
v_mfma_f32_16x16x32_bf16 v[156:159], a[244:247], v[76:79], v[156:159]
s_waitcnt lgkmcnt(15)
ds_read_b64_tr_b16 a[244:245], v241 offset:0
ds_read_b64_tr_b16 a[246:247], v241 offset:6144
v_cvt_pk_bf16_f32 v192, v234, v235
v_mfma_f32_16x16x32_bf16 v[140:143], a[248:251], v[80:83], v[140:143]
s_add_u32 m0, s31, s38
v_exp_f32 v237, v135
v_add_f32 v228, v234, v235
v_mfma_f32_16x16x32_bf16 v[144:147], a[248:251], v[84:87], v[144:147]
s_add_u32 s40, s35, s48
v_exp_f32 v230, v136
v_cvt_pk_bf16_f32 v193, v236, v237
v_mfma_f32_16x16x32_bf16 v[148:151], a[248:251], v[88:91], v[148:151]
buffer_load_dwordx4 v248, s[20:23], s40 offen offset:0 lds
v_add_f32 v228, v228, v236
v_mfma_f32_16x16x32_bf16 v[152:155], a[248:251], v[92:95], v[152:155]
v_exp_f32 v231, v137
v_add_f32 v228, v228, v237
v_mfma_f32_16x16x32_bf16 v[156:159], a[248:251], v[96:99], v[156:159]
s_waitcnt lgkmcnt(15)
ds_read_b64_tr_b16 a[248:249], v242 offset:0
ds_read_b64_tr_b16 a[250:251], v242 offset:6144
v_cvt_pk_bf16_f32 v196, v230, v231
v_mfma_f32_16x16x32_bf16 v[140:143], a[252:255], v[100:103], v[140:143]
v_exp_f32 v232, v138
v_add_f32 v229, v230, v231
v_mfma_f32_16x16x32_bf16 v[144:147], a[252:255], v[104:107], v[144:147]
v_exp_f32 v233, v139
v_mfma_f32_16x16x32_bf16 v[148:151], a[252:255], v[108:111], v[148:151]
v_cvt_pk_bf16_f32 v197, v232, v233
v_add_f32 v229, v229, v232
v_add_f32 v229, v229, v233
v_mfma_f32_16x16x32_bf16 v[152:155], a[252:255], v[112:115], v[152:155]
v_max3_f32 v244, v225, v226, v227
v_max3_f32 v244, v244, v228, v229
v_cmp_ngt_f32 vcc, 2.0, v244
v_mfma_f32_16x16x32_bf16 v[156:159], a[252:255], v[116:119], v[156:159]
s_waitcnt lgkmcnt(4)
ds_read_b64_tr_b16 a[252:253], v243 offset:0
ds_read_b64_tr_b16 a[254:255], v243 offset:6144
v_mfma_f32_16x16x32_bf16 a[0:3], a[240:243], v[160:163], a[0:3]
buffer_load_dwordx4 v249, s[20:23], s40 offen offset:1024 lds
v_mfma_f32_16x16x32_bf16 a[4:7], a[240:243], v[164:167], a[4:7]
v_mfma_f32_16x16x32_bf16 a[8:11], a[240:243], v[168:171], a[8:11]
v_mfma_f32_16x16x32_bf16 a[12:15], a[240:243], v[172:175], a[12:15]
v_mfma_f32_16x16x32_bf16 a[16:19], a[240:243], v[176:179], a[16:19]
s_waitcnt lgkmcnt(4)
ds_read_b64_tr_b16 a[240:241], v240 offset:128
ds_read_b64_tr_b16 a[242:243], v240 offset:6272
v_mfma_f32_16x16x32_bf16 a[20:23], a[244:247], v[160:163], a[20:23]
v_mfma_f32_16x16x32_bf16 a[24:27], a[244:247], v[164:167], a[24:27]
v_mfma_f32_16x16x32_bf16 a[28:31], a[244:247], v[168:171], a[28:31]
v_mfma_f32_16x16x32_bf16 a[32:35], a[244:247], v[172:175], a[32:35]
buffer_load_dwordx4 v250, s[20:23], s40 offen offset:2048 lds
v_mfma_f32_16x16x32_bf16 a[36:39], a[244:247], v[176:179], a[36:39]
s_waitcnt lgkmcnt(4)
ds_read_b64_tr_b16 a[244:245], v241 offset:128
ds_read_b64_tr_b16 a[246:247], v241 offset:6272
v_mfma_f32_16x16x32_bf16 a[40:43], a[248:251], v[160:163], a[40:43]
s_add_u32 m0, m0, 6144
v_mfma_f32_16x16x32_bf16 a[44:47], a[248:251], v[164:167], a[44:47]
s_add_u32 s40, s40, 196608
v_mfma_f32_16x16x32_bf16 a[48:51], a[248:251], v[168:171], a[48:51]
s_cbranch_vccnz L_tr43
L_back43:
v_exp_f32 v234, v140
v_add_f32 v220, v220, v225
v_mfma_f32_16x16x32_bf16 a[52:55], a[248:251], v[172:175], a[52:55]
v_exp_f32 v235, v141
v_add_f32 v221, v221, v226
v_mfma_f32_16x16x32_bf16 a[56:59], a[248:251], v[176:179], a[56:59]
s_waitcnt lgkmcnt(4)
ds_read_b64_tr_b16 a[248:249], v242 offset:128
ds_read_b64_tr_b16 a[250:251], v242 offset:6272
v_add_f32 v222, v222, v227
v_mfma_f32_16x16x32_bf16 a[60:63], a[252:255], v[160:163], a[60:63]
v_exp_f32 v236, v142
v_add_f32 v223, v223, v228
v_mfma_f32_16x16x32_bf16 a[64:67], a[252:255], v[164:167], a[64:67]
buffer_load_dwordx4 v248, s[20:23], s40 offen offset:0 lds
v_add_f32 v224, v224, v229
v_mfma_f32_16x16x32_bf16 a[68:71], a[252:255], v[168:171], a[68:71]
v_exp_f32 v237, v143
v_cvt_pk_bf16_f32 v182, v234, v235
v_mfma_f32_16x16x32_bf16 a[72:75], a[252:255], v[172:175], a[72:75]
v_exp_f32 v230, v144
v_add_f32 v225, v234, v235
v_mfma_f32_16x16x32_bf16 a[76:79], a[252:255], v[176:179], a[76:79]
s_waitcnt lgkmcnt(4)
ds_read_b64_tr_b16 a[252:253], v243 offset:128
ds_read_b64_tr_b16 a[254:255], v243 offset:6272
v_cvt_pk_bf16_f32 v183, v236, v237
v_mfma_f32_16x16x32_bf16 a[80:83], a[240:243], v[160:163], a[80:83]
v_exp_f32 v231, v145
v_add_f32 v225, v225, v236
v_mfma_f32_16x16x32_bf16 a[84:87], a[240:243], v[164:167], a[84:87]
v_exp_f32 v232, v146
v_add_f32 v225, v225, v237
v_mfma_f32_16x16x32_bf16 a[88:91], a[240:243], v[168:171], a[88:91]
v_exp_f32 v233, v147
v_cvt_pk_bf16_f32 v186, v230, v231
v_mfma_f32_16x16x32_bf16 a[92:95], a[240:243], v[172:175], a[92:95]
v_exp_f32 v234, v148
v_add_f32 v226, v230, v231
v_mfma_f32_16x16x32_bf16 a[96:99], a[240:243], v[176:179], a[96:99]
s_waitcnt lgkmcnt(4)
ds_read_b64_tr_b16 a[240:241], v240 offset:256
ds_read_b64_tr_b16 a[242:243], v240 offset:6400
v_cvt_pk_bf16_f32 v187, v232, v233
v_mfma_f32_16x16x32_bf16 a[100:103], a[244:247], v[160:163], a[100:103]
buffer_load_dwordx4 v249, s[20:23], s40 offen offset:1024 lds
v_add_f32 v226, v226, v232
v_mfma_f32_16x16x32_bf16 a[104:107], a[244:247], v[164:167], a[104:107]
v_exp_f32 v235, v149
v_add_f32 v226, v226, v233
v_mfma_f32_16x16x32_bf16 a[108:111], a[244:247], v[168:171], a[108:111]
v_exp_f32 v236, v150
v_cvt_pk_bf16_f32 v190, v234, v235
v_mfma_f32_16x16x32_bf16 a[112:115], a[244:247], v[172:175], a[112:115]
v_exp_f32 v237, v151
v_add_f32 v227, v234, v235
v_mfma_f32_16x16x32_bf16 a[116:119], a[244:247], v[176:179], a[116:119]
s_waitcnt lgkmcnt(4)
ds_read_b64_tr_b16 a[244:245], v241 offset:256
ds_read_b64_tr_b16 a[246:247], v241 offset:6400
v_cvt_pk_bf16_f32 v191, v236, v237
v_mfma_f32_16x16x32_bf16 a[120:123], a[248:251], v[160:163], a[120:123]
v_exp_f32 v230, v152
v_add_f32 v227, v227, v236
v_mfma_f32_16x16x32_bf16 a[124:127], a[248:251], v[164:167], a[124:127]
v_exp_f32 v231, v153
v_add_f32 v227, v227, v237
v_mfma_f32_16x16x32_bf16 a[128:131], a[248:251], v[168:171], a[128:131]
v_exp_f32 v232, v154
v_cvt_pk_bf16_f32 v194, v230, v231
v_mfma_f32_16x16x32_bf16 a[132:135], a[248:251], v[172:175], a[132:135]
buffer_load_dwordx4 v250, s[20:23], s40 offen offset:2048 lds
v_add_f32 v228, v230, v231
v_mfma_f32_16x16x32_bf16 a[136:139], a[248:251], v[176:179], a[136:139]
s_waitcnt lgkmcnt(4)
ds_read_b64_tr_b16 a[248:249], v242 offset:256
ds_read_b64_tr_b16 a[250:251], v242 offset:6400
v_mfma_f32_16x16x32_bf16 a[140:143], a[252:255], v[160:163], a[140:143]
s_add_u32 s35, s35, 393216
v_exp_f32 v233, v155
v_mfma_f32_16x16x32_bf16 a[144:147], a[252:255], v[164:167], a[144:147]
s_sub_u32 s40, s35, 7864320
v_exp_f32 v234, v156
v_cvt_pk_bf16_f32 v195, v232, v233
v_mfma_f32_16x16x32_bf16 a[148:151], a[252:255], v[168:171], a[148:151]
s_min_u32 s35, s35, s40
v_exp_f32 v235, v157
v_add_f32 v228, v228, v232
v_mfma_f32_16x16x32_bf16 a[152:155], a[252:255], v[172:175], a[152:155]
s_add_u32 s31, s31, 24576
v_exp_f32 v236, v158
v_add_f32 v228, v228, v233
v_mfma_f32_16x16x32_bf16 a[156:159], a[252:255], v[176:179], a[156:159]
s_waitcnt lgkmcnt(4)
ds_read_b64_tr_b16 a[252:253], v243 offset:256
ds_read_b64_tr_b16 a[254:255], v243 offset:6400
v_cvt_pk_bf16_f32 v198, v234, v235
v_mfma_f32_16x16x32_bf16 a[160:163], a[240:243], v[160:163], a[160:163]
s_sub_u32 s41, s31, 147456
v_add_u32 v240, s32, v253
v_xor_b32 v241, 32, v240
v_xor_b32 v242, 64, v240
v_mfma_f32_16x16x32_bf16 a[164:167], a[240:243], v[164:167], a[164:167]
s_min_u32 s31, s31, s41
v_xor_b32 v243, 64, v241
v_exp_f32 v237, v159
v_mfma_f32_16x16x32_bf16 a[168:171], a[240:243], v[168:171], a[168:171]
s_add_u32 s32, s32, 24576
v_add_f32 v229, v234, v235
v_cvt_pk_bf16_f32 v199, v236, v237
v_add_f32 v229, v229, v236
v_mfma_f32_16x16x32_bf16 a[172:175], a[240:243], v[172:175], a[172:175]
s_sub_u32 s42, s32, 147456
v_add_f32 v229, v229, v237
v_max3_f32 v244, v225, v226, v227
v_max3_f32 v244, v244, v228, v229
v_mfma_f32_16x16x32_bf16 a[176:179], a[240:243], v[176:179], a[176:179]
s_waitcnt lgkmcnt(4)
v_cmp_ngt_f32 vcc, 2.0, v244
v_mfma_f32_16x16x32_bf16 a[180:183], a[244:247], v[160:163], a[180:183]
s_min_u32 s32, s32, s42
v_mfma_f32_16x16x32_bf16 a[184:187], a[244:247], v[164:167], a[184:187]
v_mfma_f32_16x16x32_bf16 a[188:191], a[244:247], v[168:171], a[188:191]
v_mfma_f32_16x16x32_bf16 a[192:195], a[244:247], v[172:175], a[192:195]
s_waitcnt vmcnt(23) lgkmcnt(0)
s_barrier
ds_read_b64_tr_b16 a[240:241], v240 offset:0
ds_read_b64_tr_b16 a[242:243], v240 offset:6144
v_mfma_f32_16x16x32_bf16 a[196:199], a[244:247], v[176:179], a[196:199]
s_waitcnt lgkmcnt(15)
ds_read_b64_tr_b16 a[244:245], v241 offset:0
ds_read_b64_tr_b16 a[246:247], v241 offset:6144
v_mfma_f32_16x16x32_bf16 a[200:203], a[248:251], v[160:163], a[200:203]
s_add_u32 m0, s31, s55
v_mfma_f32_16x16x32_bf16 a[204:207], a[248:251], v[164:167], a[204:207]
s_add_u32 s40, s54, s49
v_mfma_f32_16x16x32_bf16 a[208:211], a[248:251], v[168:171], a[208:211]
buffer_load_dwordx4 v251, s[8:11], s40 offen offset:0 lds
v_mfma_f32_16x16x32_bf16 a[212:215], a[248:251], v[172:175], a[212:215]
s_add_u32 s40, s40, 9216
v_mfma_f32_16x16x32_bf16 a[216:219], a[248:251], v[176:179], a[216:219]
s_waitcnt lgkmcnt(15)
ds_read_b64_tr_b16 a[248:249], v242 offset:0
ds_read_b64_tr_b16 a[250:251], v242 offset:6144
v_mfma_f32_16x16x32_bf16 a[220:223], a[252:255], v[160:163], a[220:223]
buffer_load_dwordx4 v251, s[8:11], s40 offen offset:1024 lds
v_mfma_f32_16x16x32_bf16 a[224:227], a[252:255], v[164:167], a[224:227]
s_add_u32 s40, s40, 9216
v_mfma_f32_16x16x32_bf16 a[228:231], a[252:255], v[168:171], a[228:231]
v_mfma_f32_16x16x32_bf16 a[232:235], a[252:255], v[172:175], a[232:235]
buffer_load_dwordx4 v251, s[8:11], s40 offen offset:2048 lds
v_mfma_f32_16x16x32_bf16 a[236:239], a[252:255], v[176:179], a[236:239]
s_cbranch_vccnz L_tr44
L_back44:
s_waitcnt lgkmcnt(4)
ds_read_b64_tr_b16 a[252:253], v243 offset:0
ds_read_b64_tr_b16 a[254:255], v243 offset:6144
v_mfma_f32_16x16x32_bf16 a[0:3], a[240:243], v[180:183], a[0:3]
s_add_u32 s40, s40, 9216
v_add_f32 v220, v220, v225
v_add_f32 v221, v221, v226
v_mfma_f32_16x16x32_bf16 a[4:7], a[240:243], v[184:187], a[4:7]
buffer_load_dwordx4 v251, s[8:11], s40 offen offset:3072 lds
v_mfma_f32_16x16x32_bf16 a[8:11], a[240:243], v[188:191], a[8:11]
s_add_u32 m0, m0, 4096
s_add_u32 s40, s40, 13312
v_add_f32 v222, v222, v227
v_mfma_f32_16x16x32_bf16 a[12:15], a[240:243], v[192:195], a[12:15]
v_add_f32 v223, v223, v228
v_add_f32 v224, v224, v229
v_mfma_f32_16x16x32_bf16 a[16:19], a[240:243], v[196:199], a[16:19]
s_waitcnt lgkmcnt(4)
ds_read_b64_tr_b16 a[240:241], v240 offset:128
ds_read_b64_tr_b16 a[242:243], v240 offset:6272
v_mfma_f32_16x16x32_bf16 a[20:23], a[244:247], v[180:183], a[20:23]
buffer_load_dwordx4 v251, s[8:11], s40 offen lds
v_mfma_f32_16x16x32_bf16 a[24:27], a[244:247], v[184:187], a[24:27]
s_add_u32 s54, s54, 128
s_sub_u32 s40, s54, 1280
s_min_u32 s54, s54, s40
v_mfma_f32_16x16x32_bf16 a[28:31], a[244:247], v[188:191], a[28:31]
s_add_u32 s31, s31, 24576
s_sub_u32 s41, s31, 147456
s_min_u32 s31, s31, s41
v_mfma_f32_16x16x32_bf16 a[32:35], a[244:247], v[192:195], a[32:35]
v_mfma_f32_16x16x32_bf16 a[36:39], a[244:247], v[196:199], a[36:39]
s_waitcnt lgkmcnt(4)
ds_read_b64_tr_b16 a[244:245], v241 offset:128
ds_read_b64_tr_b16 a[246:247], v241 offset:6272
v_mfma_f32_16x16x32_bf16 a[40:43], a[248:251], v[180:183], a[40:43]
v_mfma_f32_16x16x32_bf16 a[44:47], a[248:251], v[184:187], a[44:47]
v_mfma_f32_16x16x32_bf16 a[48:51], a[248:251], v[188:191], a[48:51]
v_mfma_f32_16x16x32_bf16 a[52:55], a[248:251], v[192:195], a[52:55]
v_mfma_f32_16x16x32_bf16 a[56:59], a[248:251], v[196:199], a[56:59]
s_waitcnt lgkmcnt(4)
ds_read_b64_tr_b16 a[248:249], v242 offset:128
ds_read_b64_tr_b16 a[250:251], v242 offset:6272
v_mfma_f32_16x16x32_bf16 a[60:63], a[252:255], v[180:183], a[60:63]
v_mfma_f32_16x16x32_bf16 a[64:67], a[252:255], v[184:187], a[64:67]
v_mfma_f32_16x16x32_bf16 a[68:71], a[252:255], v[188:191], a[68:71]
v_mfma_f32_16x16x32_bf16 a[72:75], a[252:255], v[192:195], a[72:75]
v_mfma_f32_16x16x32_bf16 a[76:79], a[252:255], v[196:199], a[76:79]
s_waitcnt lgkmcnt(4)
ds_read_b64_tr_b16 a[252:253], v243 offset:128
ds_read_b64_tr_b16 a[254:255], v243 offset:6272
v_mfma_f32_16x16x32_bf16 a[80:83], a[240:243], v[180:183], a[80:83]
v_mfma_f32_16x16x32_bf16 a[84:87], a[240:243], v[184:187], a[84:87]
v_mfma_f32_16x16x32_bf16 a[88:91], a[240:243], v[188:191], a[88:91]
v_mfma_f32_16x16x32_bf16 a[92:95], a[240:243], v[192:195], a[92:95]
v_mfma_f32_16x16x32_bf16 a[96:99], a[240:243], v[196:199], a[96:99]
s_waitcnt lgkmcnt(4)
ds_read_b64_tr_b16 a[240:241], v240 offset:256
ds_read_b64_tr_b16 a[242:243], v240 offset:6400
v_mfma_f32_16x16x32_bf16 a[100:103], a[244:247], v[180:183], a[100:103]
v_mfma_f32_16x16x32_bf16 a[104:107], a[244:247], v[184:187], a[104:107]
v_mfma_f32_16x16x32_bf16 a[108:111], a[244:247], v[188:191], a[108:111]
v_mfma_f32_16x16x32_bf16 a[112:115], a[244:247], v[192:195], a[112:115]
v_mfma_f32_16x16x32_bf16 a[116:119], a[244:247], v[196:199], a[116:119]
s_waitcnt lgkmcnt(4)
ds_read_b64_tr_b16 a[244:245], v241 offset:256
ds_read_b64_tr_b16 a[246:247], v241 offset:6400
v_mfma_f32_16x16x32_bf16 a[120:123], a[248:251], v[180:183], a[120:123]
v_mfma_f32_16x16x32_bf16 a[124:127], a[248:251], v[184:187], a[124:127]
v_mfma_f32_16x16x32_bf16 a[128:131], a[248:251], v[188:191], a[128:131]
v_mfma_f32_16x16x32_bf16 a[132:135], a[248:251], v[192:195], a[132:135]
v_mfma_f32_16x16x32_bf16 a[136:139], a[248:251], v[196:199], a[136:139]
s_waitcnt lgkmcnt(4)
ds_read_b64_tr_b16 a[248:249], v242 offset:256
ds_read_b64_tr_b16 a[250:251], v242 offset:6400
v_mfma_f32_16x16x32_bf16 a[140:143], a[252:255], v[180:183], a[140:143]
v_mfma_f32_16x16x32_bf16 a[144:147], a[252:255], v[184:187], a[144:147]
v_mfma_f32_16x16x32_bf16 a[148:151], a[252:255], v[188:191], a[148:151]
v_mfma_f32_16x16x32_bf16 a[152:155], a[252:255], v[192:195], a[152:155]
v_mfma_f32_16x16x32_bf16 a[156:159], a[252:255], v[196:199], a[156:159]
s_waitcnt lgkmcnt(4)
ds_read_b64_tr_b16 a[252:253], v243 offset:256
ds_read_b64_tr_b16 a[254:255], v243 offset:6400
v_mfma_f32_16x16x32_bf16 a[160:163], a[240:243], v[180:183], a[160:163]
v_mfma_f32_16x16x32_bf16 a[164:167], a[240:243], v[184:187], a[164:167]
v_mfma_f32_16x16x32_bf16 a[168:171], a[240:243], v[188:191], a[168:171]
v_mfma_f32_16x16x32_bf16 a[172:175], a[240:243], v[192:195], a[172:175]
v_mfma_f32_16x16x32_bf16 a[176:179], a[240:243], v[196:199], a[176:179]
s_waitcnt lgkmcnt(4)
v_mfma_f32_16x16x32_bf16 a[180:183], a[244:247], v[180:183], a[180:183]
v_mfma_f32_16x16x32_bf16 a[184:187], a[244:247], v[184:187], a[184:187]
v_mfma_f32_16x16x32_bf16 a[188:191], a[244:247], v[188:191], a[188:191]
v_mfma_f32_16x16x32_bf16 a[192:195], a[244:247], v[192:195], a[192:195]
v_mfma_f32_16x16x32_bf16 a[196:199], a[244:247], v[196:199], a[196:199]
s_waitcnt lgkmcnt(2)
v_mfma_f32_16x16x32_bf16 a[200:203], a[248:251], v[180:183], a[200:203]
v_mfma_f32_16x16x32_bf16 a[204:207], a[248:251], v[184:187], a[204:207]
v_mfma_f32_16x16x32_bf16 a[208:211], a[248:251], v[188:191], a[208:211]
v_mfma_f32_16x16x32_bf16 a[212:215], a[248:251], v[192:195], a[212:215]
v_mfma_f32_16x16x32_bf16 a[216:219], a[248:251], v[196:199], a[216:219]
s_waitcnt lgkmcnt(0)
v_mfma_f32_16x16x32_bf16 a[220:223], a[252:255], v[180:183], a[220:223]
v_mfma_f32_16x16x32_bf16 a[224:227], a[252:255], v[184:187], a[224:227]
v_mfma_f32_16x16x32_bf16 a[228:231], a[252:255], v[188:191], a[228:231]
v_mfma_f32_16x16x32_bf16 a[232:235], a[252:255], v[192:195], a[232:235]
v_mfma_f32_16x16x32_bf16 a[236:239], a[252:255], v[196:199], a[236:239]
v_mov_b32 v230, v220
v_mov_b32 v231, v221
v_mov_b32 v232, v222
v_mov_b32 v233, v223
v_mov_b32 v234, v224
v_permlane32_swap_b32 v220, v230
v_permlane32_swap_b32 v221, v231
v_permlane32_swap_b32 v222, v232
v_permlane32_swap_b32 v223, v233
v_permlane32_swap_b32 v224, v234
v_add_f32 v220, v220, v230
v_add_f32 v221, v221, v231
v_add_f32 v222, v222, v232
v_add_f32 v223, v223, v233
v_add_f32 v224, v224, v234
v_mov_b32 v230, v220
v_mov_b32 v231, v221
v_mov_b32 v232, v222
v_mov_b32 v233, v223
v_mov_b32 v234, v224
v_permlane16_swap_b32 v220, v230
v_permlane16_swap_b32 v221, v231
v_permlane16_swap_b32 v222, v232
v_permlane16_swap_b32 v223, v233
v_permlane16_swap_b32 v224, v234
v_add_f32 v220, v220, v230
v_add_f32 v221, v221, v231
v_add_f32 v222, v222, v232
v_add_f32 v223, v223, v233
v_add_f32 v224, v224, v234
v_rcp_f32 v220, v220
v_rcp_f32 v221, v221
v_rcp_f32 v222, v222
v_rcp_f32 v223, v223
v_rcp_f32 v224, v224
s_add_u32 s45, s45, 1
s_branch L_concat_heads__mha_block_cached__gqa_block_cached__near_ridge_kernel_unit
L_concat_heads__mha_block_cached__gqa_block_cached__near_ridge_kernel_tail1:
s_mov_b32 s79, m0
v_mov_b32 v230, 0
s_mov_b32 m0, s76
s_nop 0
buffer_load_dword v230, s[72:75], s77 offen sc1 lds
s_mov_b32 m0, s79
v_mbcnt_lo_u32_b32 v230, -1, 0
v_mbcnt_hi_u32_b32 v230, -1, v230
v_lshlrev_b32 v255, 4, v230
s_cmp_eq_u32 s29, 0
s_cselect_b32 s8, s24, s60
s_cselect_b32 s9, s25, s61
s_cselect_b32 s10, s26, s62
s_cbranch_scc0 L_concat_heads__mha_block_cached__gqa_block_cached__near_ridge_kernel_wpat
v_mov_b32 v248, v255
v_mov_b32 v249, v255
v_mov_b32 v250, v255
v_mov_b32 v251, v255
v_add_u32 v254, 4096, v255
s_branch L_concat_heads__mha_block_cached__gqa_block_cached__near_ridge_kernel_wpatd
L_concat_heads__mha_block_cached__gqa_block_cached__near_ridge_kernel_wpat:
v_add_u32 v231, 0, v230
v_mul_u32_u24 v232, 205, v231
v_lshrrev_b32 v232, 12, v232
v_mul_u32_u24 v233, 20, v232
v_sub_u32 v231, v231, v233
v_lshrrev_b32 v233, 1, v232
v_and_b32 v233, 2, v233
v_xor_b32 v231, v231, v233
v_lshlrev_b32 v231, 4, v231
v_mul_u32_u24 v232, 1280, v232
v_add_u32 v231, v231, v232
v_subrev_u32 v248, 0, v231
v_add_u32 v231, 64, v230
v_mul_u32_u24 v232, 205, v231
v_lshrrev_b32 v232, 12, v232
v_mul_u32_u24 v233, 20, v232
v_sub_u32 v231, v231, v233
v_lshrrev_b32 v233, 1, v232
v_and_b32 v233, 2, v233
v_xor_b32 v231, v231, v233
v_lshlrev_b32 v231, 4, v231
v_mul_u32_u24 v232, 1280, v232
v_add_u32 v231, v231, v232
v_subrev_u32 v249, 1024, v231
v_add_u32 v231, 128, v230
v_mul_u32_u24 v232, 205, v231
v_lshrrev_b32 v232, 12, v232
v_mul_u32_u24 v233, 20, v232
v_sub_u32 v231, v231, v233
v_lshrrev_b32 v233, 1, v232
v_and_b32 v233, 2, v233
v_xor_b32 v231, v231, v233
v_lshlrev_b32 v231, 4, v231
v_mul_u32_u24 v232, 1280, v232
v_add_u32 v231, v231, v232
v_subrev_u32 v250, 2048, v231
v_add_u32 v231, 192, v230
v_mul_u32_u24 v232, 205, v231
v_lshrrev_b32 v232, 12, v232
v_mul_u32_u24 v233, 20, v232
v_sub_u32 v231, v231, v233
v_lshrrev_b32 v233, 1, v232
v_and_b32 v233, 2, v233
v_xor_b32 v231, v231, v233
v_lshlrev_b32 v231, 4, v231
v_mul_u32_u24 v232, 1280, v232
v_add_u32 v231, v231, v232
v_subrev_u32 v251, 3072, v231
v_add_u32 v231, 256, v230
v_mul_u32_u24 v232, 205, v231
v_lshrrev_b32 v232, 12, v232
v_mul_u32_u24 v233, 20, v232
v_sub_u32 v231, v231, v233
v_lshrrev_b32 v233, 1, v232
v_and_b32 v233, 2, v233
v_xor_b32 v231, v231, v233
v_lshlrev_b32 v231, 4, v231
v_mul_u32_u24 v232, 1280, v232
v_add_u32 v231, v231, v232
v_subrev_u32 v254, 0, v231
L_concat_heads__mha_block_cached__gqa_block_cached__near_ridge_kernel_wpatd:
s_add_u32 s20, s6, 104857600
s_addc_u32 s21, s7, 0
s_and_b32 s21, s21, 0xffff
s_mov_b32 s22, 13762560
v_mfma_f32_16x16x32_bf16 v[140:143], a[248:251], v[0:3], v[200:203]
v_exp_f32 v230, v120
v_mfma_f32_16x16x32_bf16 v[144:147], a[248:251], v[4:7], v[204:207]
v_exp_f32 v231, v121
v_mfma_f32_16x16x32_bf16 v[148:151], a[248:251], v[8:11], v[208:211]
v_exp_f32 v232, v122
v_mfma_f32_16x16x32_bf16 v[152:155], a[248:251], v[12:15], v[212:215]
buffer_load_dwordx4 v247, s[16:19], s40 offen offset:2048 nt lds
v_mfma_f32_16x16x32_bf16 v[156:159], a[248:251], v[16:19], v[216:219]
s_waitcnt lgkmcnt(2)
ds_read_b128 a[248:251], v238 offset:6400
v_add_f32 v220, v220, v225
v_mfma_f32_16x16x32_bf16 v[140:143], a[252:255], v[20:23], v[140:143]
s_add_u32 s34, s34, 12288
v_exp_f32 v233, v123
v_mfma_f32_16x16x32_bf16 v[144:147], a[252:255], v[24:27], v[144:147]
s_add_u32 s31, s31, 24576
v_exp_f32 v234, v124
v_mfma_f32_16x16x32_bf16 v[148:151], a[252:255], v[28:31], v[148:151]
s_sub_u32 s41, s31, 147456
v_exp_f32 v235, v125
v_mfma_f32_16x16x32_bf16 v[152:155], a[252:255], v[32:35], v[152:155]
s_min_u32 s31, s31, s41
v_exp_f32 v236, v126
v_mfma_f32_16x16x32_bf16 v[156:159], a[252:255], v[36:39], v[156:159]
s_waitcnt lgkmcnt(2)
ds_read_b128 a[252:255], v239 offset:6400
v_add_f32 v221, v221, v226
v_mfma_f32_16x16x32_bf16 v[140:143], a[240:243], v[40:43], v[140:143]
v_add_u32 v238, s32, v252
v_xor_b32 v239, 64, v238
v_mfma_f32_16x16x32_bf16 v[144:147], a[240:243], v[44:47], v[144:147]
s_add_u32 s32, s32, 24576
v_exp_f32 v237, v127
v_mfma_f32_16x16x32_bf16 v[148:151], a[240:243], v[48:51], v[148:151]
s_sub_u32 s42, s32, 147456
v_add_f32 v222, v222, v227
v_add_f32 v223, v223, v228
v_mfma_f32_16x16x32_bf16 v[152:155], a[240:243], v[52:55], v[152:155]
s_min_u32 s32, s32, s42
v_add_f32 v224, v224, v229
v_cvt_pk_bf16_f32 v160, v230, v231
v_mfma_f32_16x16x32_bf16 v[156:159], a[240:243], v[56:59], v[156:159]
s_waitcnt lgkmcnt(2)
v_add_f32 v225, v230, v231
v_cvt_pk_bf16_f32 v161, v232, v233
v_mfma_f32_16x16x32_bf16 v[140:143], a[244:247], v[60:63], v[140:143]
v_add_f32 v225, v225, v232
v_add_f32 v225, v225, v233
v_mfma_f32_16x16x32_bf16 v[144:147], a[244:247], v[64:67], v[144:147]
v_exp_f32 v230, v128
v_mfma_f32_16x16x32_bf16 v[148:151], a[244:247], v[68:71], v[148:151]
v_exp_f32 v231, v129
v_mfma_f32_16x16x32_bf16 v[152:155], a[244:247], v[72:75], v[152:155]
s_waitcnt vmcnt(63) lgkmcnt(0)
s_barrier
ds_read_b64_tr_b16 a[240:241], v240 offset:0
v_mfma_f32_16x16x32_bf16 v[156:159], a[244:247], v[76:79], v[156:159]
s_waitcnt lgkmcnt(15)
ds_read_b64_tr_b16 a[242:243], v240 offset:6144
ds_read_b64_tr_b16 a[244:245], v241 offset:0
v_mfma_f32_16x16x32_bf16 v[140:143], a[248:251], v[80:83], v[140:143]
s_add_u32 m0, s31, s37
ds_read_b64_tr_b16 a[246:247], v241 offset:6144
v_cvt_pk_bf16_f32 v164, v234, v235
v_mfma_f32_16x16x32_bf16 v[144:147], a[248:251], v[84:87], v[144:147]
s_waitcnt vmcnt(5)
v_exp_f32 v232, v130
v_mfma_f32_16x16x32_bf16 v[148:151], a[248:251], v[88:91], v[148:151]
buffer_load_dwordx4 v245, s[12:15], s33 offen offset:0 nt lds
v_mfma_f32_16x16x32_bf16 v[152:155], a[248:251], v[92:95], v[152:155]
s_waitcnt vmcnt(5)
v_exp_f32 v233, v131
v_mfma_f32_16x16x32_bf16 v[156:159], a[248:251], v[96:99], v[156:159]
s_waitcnt lgkmcnt(15)
ds_read_b64_tr_b16 a[248:249], v242 offset:0
ds_read_b64_tr_b16 a[250:251], v242 offset:6144
v_mfma_f32_16x16x32_bf16 v[140:143], a[252:255], v[100:103], v[140:143]
v_add_f32 v226, v234, v235
v_cvt_pk_bf16_f32 v165, v236, v237
v_mfma_f32_16x16x32_bf16 v[144:147], a[252:255], v[104:107], v[144:147]
v_add_f32 v226, v226, v236
v_add_f32 v226, v226, v237
v_mfma_f32_16x16x32_bf16 v[148:151], a[252:255], v[108:111], v[148:151]
v_exp_f32 v234, v132
v_mfma_f32_16x16x32_bf16 v[152:155], a[252:255], v[112:115], v[152:155]
v_exp_f32 v235, v133
v_mfma_f32_16x16x32_bf16 v[156:159], a[252:255], v[116:119], v[156:159]
s_waitcnt lgkmcnt(4)
ds_read_b64_tr_b16 a[252:253], v243 offset:0
ds_read_b64_tr_b16 a[254:255], v243 offset:6144
v_mfma_f32_16x16x32_bf16 a[0:3], a[240:243], v[180:183], a[0:3]
buffer_load_dwordx4 v246, s[12:15], s33 offen offset:1024 nt lds
v_mfma_f32_16x16x32_bf16 a[4:7], a[240:243], v[184:187], a[4:7]
s_waitcnt vmcnt(5)
v_exp_f32 v236, v134
v_mfma_f32_16x16x32_bf16 a[8:11], a[240:243], v[188:191], a[8:11]
v_exp_f32 v237, v135
v_mfma_f32_16x16x32_bf16 a[12:15], a[240:243], v[192:195], a[12:15]
v_cvt_pk_bf16_f32 v168, v230, v231
v_add_f32 v227, v230, v231
v_mfma_f32_16x16x32_bf16 a[16:19], a[240:243], v[196:199], a[16:19]
s_waitcnt lgkmcnt(4)
ds_read_b64_tr_b16 a[240:241], v240 offset:128
ds_read_b64_tr_b16 a[242:243], v240 offset:6272
v_mfma_f32_16x16x32_bf16 a[20:23], a[244:247], v[180:183], a[20:23]
v_cvt_pk_bf16_f32 v169, v232, v233
v_add_f32 v227, v227, v232
v_mfma_f32_16x16x32_bf16 a[24:27], a[244:247], v[184:187], a[24:27]
v_add_f32 v227, v227, v233
v_cvt_pk_bf16_f32 v172, v234, v235
v_mfma_f32_16x16x32_bf16 a[28:31], a[244:247], v[188:191], a[28:31]
v_exp_f32 v230, v136
v_mfma_f32_16x16x32_bf16 a[32:35], a[244:247], v[192:195], a[32:35]
buffer_load_dwordx4 v247, s[12:15], s33 offen offset:2048 nt lds
v_mfma_f32_16x16x32_bf16 a[36:39], a[244:247], v[196:199], a[36:39]
s_waitcnt lgkmcnt(4)
ds_read_b64_tr_b16 a[244:245], v241 offset:128
ds_read_b64_tr_b16 a[246:247], v241 offset:6272
v_mfma_f32_16x16x32_bf16 a[40:43], a[248:251], v[180:183], a[40:43]
s_add_u32 m0, m0, 3072
v_exp_f32 v231, v137
v_mfma_f32_16x16x32_bf16 a[44:47], a[248:251], v[184:187], a[44:47]
s_add_u32 s40, s33, 3072
v_exp_f32 v232, v138
v_mfma_f32_16x16x32_bf16 a[48:51], a[248:251], v[188:191], a[48:51]
s_waitcnt vmcnt(5)
v_exp_f32 v233, v139
v_mfma_f32_16x16x32_bf16 a[52:55], a[248:251], v[192:195], a[52:55]
v_add_f32 v228, v234, v235
v_cvt_pk_bf16_f32 v173, v236, v237
v_mfma_f32_16x16x32_bf16 a[56:59], a[248:251], v[196:199], a[56:59]
s_waitcnt lgkmcnt(4)
ds_read_b64_tr_b16 a[248:249], v242 offset:128
ds_read_b64_tr_b16 a[250:251], v242 offset:6272
v_mfma_f32_16x16x32_bf16 a[60:63], a[252:255], v[180:183], a[60:63]
v_add_f32 v228, v228, v236
v_add_f32 v228, v228, v237
v_mfma_f32_16x16x32_bf16 a[64:67], a[252:255], v[184:187], a[64:67]
buffer_load_dwordx4 v245, s[12:15], s40 offen offset:0 nt lds
v_mfma_f32_16x16x32_bf16 a[68:71], a[252:255], v[188:191], a[68:71]
s_waitcnt vmcnt(5)
v_cvt_pk_bf16_f32 v176, v230, v231
v_add_f32 v229, v230, v231
v_mfma_f32_16x16x32_bf16 a[72:75], a[252:255], v[192:195], a[72:75]
v_cvt_pk_bf16_f32 v177, v232, v233
v_add_f32 v229, v229, v232
v_mfma_f32_16x16x32_bf16 a[76:79], a[252:255], v[196:199], a[76:79]
s_waitcnt lgkmcnt(4)
ds_read_b64_tr_b16 a[252:253], v243 offset:128
ds_read_b64_tr_b16 a[254:255], v243 offset:6272
v_mfma_f32_16x16x32_bf16 a[80:83], a[240:243], v[180:183], a[80:83]
v_add_f32 v229, v229, v233
v_max3_f32 v244, v225, v226, v227
v_mfma_f32_16x16x32_bf16 a[84:87], a[240:243], v[184:187], a[84:87]
v_max3_f32 v244, v244, v228, v229
v_cmp_ngt_f32 vcc, 2.0, v244
v_mfma_f32_16x16x32_bf16 a[88:91], a[240:243], v[188:191], a[88:91]
s_cbranch_vccnz L_tr49
L_back49:
v_exp_f32 v234, v140
v_mfma_f32_16x16x32_bf16 a[92:95], a[240:243], v[192:195], a[92:95]
v_exp_f32 v235, v141
v_mfma_f32_16x16x32_bf16 a[96:99], a[240:243], v[196:199], a[96:99]
s_waitcnt lgkmcnt(4)
ds_read_b64_tr_b16 a[240:241], v240 offset:256
ds_read_b64_tr_b16 a[242:243], v240 offset:6400
v_mfma_f32_16x16x32_bf16 a[100:103], a[244:247], v[180:183], a[100:103]
buffer_load_dwordx4 v246, s[12:15], s40 offen offset:1024 nt lds
v_mfma_f32_16x16x32_bf16 a[104:107], a[244:247], v[184:187], a[104:107]
s_waitcnt vmcnt(5)
v_exp_f32 v236, v142
v_mfma_f32_16x16x32_bf16 a[108:111], a[244:247], v[188:191], a[108:111]
v_exp_f32 v237, v143
v_mfma_f32_16x16x32_bf16 a[112:115], a[244:247], v[192:195], a[112:115]
v_exp_f32 v230, v144
v_mfma_f32_16x16x32_bf16 a[116:119], a[244:247], v[196:199], a[116:119]
s_waitcnt lgkmcnt(4)
ds_read_b64_tr_b16 a[244:245], v241 offset:256
ds_read_b64_tr_b16 a[246:247], v241 offset:6400
v_mfma_f32_16x16x32_bf16 a[120:123], a[248:251], v[180:183], a[120:123]
v_exp_f32 v231, v145
v_mfma_f32_16x16x32_bf16 a[124:127], a[248:251], v[184:187], a[124:127]
v_exp_f32 v232, v146
v_mfma_f32_16x16x32_bf16 a[128:131], a[248:251], v[188:191], a[128:131]
v_exp_f32 v233, v147
v_mfma_f32_16x16x32_bf16 a[132:135], a[248:251], v[192:195], a[132:135]
buffer_load_dwordx4 v247, s[12:15], s40 offen offset:2048 nt lds
v_mfma_f32_16x16x32_bf16 a[136:139], a[248:251], v[196:199], a[136:139]
s_waitcnt lgkmcnt(4)
ds_read_b64_tr_b16 a[248:249], v242 offset:256
ds_read_b64_tr_b16 a[250:251], v242 offset:6400
v_mfma_f32_16x16x32_bf16 a[140:143], a[252:255], v[180:183], a[140:143]
s_add_u32 s33, s33, 208896
v_add_f32 v220, v220, v225
v_add_f32 v221, v221, v226
v_mfma_f32_16x16x32_bf16 a[144:147], a[252:255], v[184:187], a[144:147]
s_add_u32 s31, s31, 24576
v_add_f32 v222, v222, v227
v_add_f32 v223, v223, v228
v_mfma_f32_16x16x32_bf16 a[148:151], a[252:255], v[188:191], a[148:151]
s_sub_u32 s41, s31, 147456
v_add_f32 v224, v224, v229
v_cvt_pk_bf16_f32 v162, v234, v235
v_mfma_f32_16x16x32_bf16 a[152:155], a[252:255], v[192:195], a[152:155]
s_min_u32 s31, s31, s41
v_add_f32 v225, v234, v235
v_cvt_pk_bf16_f32 v163, v236, v237
v_mfma_f32_16x16x32_bf16 a[156:159], a[252:255], v[196:199], a[156:159]
s_waitcnt lgkmcnt(4)
ds_read_b64_tr_b16 a[252:253], v243 offset:256
ds_read_b64_tr_b16 a[254:255], v243 offset:6400
v_mfma_f32_16x16x32_bf16 a[160:163], a[240:243], v[180:183], a[160:163]
v_add_u32 v240, s32, v253
v_xor_b32 v241, 32, v240
v_mfma_f32_16x16x32_bf16 a[164:167], a[240:243], v[184:187], a[164:167]
v_xor_b32 v242, 64, v240
v_xor_b32 v243, 64, v241
v_mfma_f32_16x16x32_bf16 a[168:171], a[240:243], v[188:191], a[168:171]
s_add_u32 s32, s32, 24576
v_add_f32 v225, v225, v236
v_add_f32 v225, v225, v237
v_mfma_f32_16x16x32_bf16 a[172:175], a[240:243], v[192:195], a[172:175]
s_sub_u32 s42, s32, 147456
v_exp_f32 v234, v148
v_mfma_f32_16x16x32_bf16 a[176:179], a[240:243], v[196:199], a[176:179]
s_waitcnt lgkmcnt(4)
v_exp_f32 v235, v149
v_mfma_f32_16x16x32_bf16 a[180:183], a[244:247], v[180:183], a[180:183]
s_min_u32 s32, s32, s42
v_exp_f32 v236, v150
v_mfma_f32_16x16x32_bf16 a[184:187], a[244:247], v[184:187], a[184:187]
v_exp_f32 v237, v151
v_mfma_f32_16x16x32_bf16 a[188:191], a[244:247], v[188:191], a[188:191]
v_cvt_pk_bf16_f32 v166, v230, v231
v_add_f32 v226, v230, v231
v_mfma_f32_16x16x32_bf16 a[192:195], a[244:247], v[192:195], a[192:195]
s_waitcnt vmcnt(63) lgkmcnt(0)
s_barrier
ds_read_b128 a[240:243], v238 offset:0
v_mfma_f32_16x16x32_bf16 a[196:199], a[244:247], v[196:199], a[196:199]
s_waitcnt lgkmcnt(15)
ds_read_b128 a[244:247], v239 offset:0
v_cvt_pk_bf16_f32 v167, v232, v233
v_mfma_f32_16x16x32_bf16 a[200:203], a[248:251], v[180:183], a[200:203]
s_add_u32 m0, s31, s37
v_add_f32 v226, v226, v232
v_add_f32 v226, v226, v233
v_mfma_f32_16x16x32_bf16 a[204:207], a[248:251], v[184:187], a[204:207]
s_waitcnt vmcnt(5)
v_exp_f32 v230, v152
v_mfma_f32_16x16x32_bf16 a[208:211], a[248:251], v[188:191], a[208:211]
buffer_load_dwordx4 v245, s[16:19], s34 offen offset:0 nt lds
v_mfma_f32_16x16x32_bf16 a[212:215], a[248:251], v[192:195], a[212:215]
s_waitcnt vmcnt(5)
v_exp_f32 v231, v153
v_mfma_f32_16x16x32_bf16 a[216:219], a[248:251], v[196:199], a[216:219]
s_waitcnt lgkmcnt(15)
ds_read_b128 a[248:251], v238 offset:128
v_cvt_pk_bf16_f32 v170, v234, v235
v_mfma_f32_16x16x32_bf16 a[220:223], a[252:255], v[180:183], a[220:223]
v_exp_f32 v232, v154
v_mfma_f32_16x16x32_bf16 a[224:227], a[252:255], v[184:187], a[224:227]
v_exp_f32 v233, v155
v_mfma_f32_16x16x32_bf16 a[228:231], a[252:255], v[188:191], a[228:231]
v_add_f32 v227, v234, v235
v_cvt_pk_bf16_f32 v171, v236, v237
v_mfma_f32_16x16x32_bf16 a[232:235], a[252:255], v[192:195], a[232:235]
v_add_f32 v227, v227, v236
v_add_f32 v227, v227, v237
v_mfma_f32_16x16x32_bf16 a[236:239], a[252:255], v[196:199], a[236:239]
s_waitcnt lgkmcnt(2)
ds_read_b128 a[252:255], v239 offset:128
v_cvt_pk_bf16_f32 v174, v230, v231
v_mfma_f32_16x16x32_bf16 v[120:123], a[240:243], v[0:3], v[200:203]
buffer_load_dwordx4 v246, s[16:19], s34 offen offset:1024 nt lds
v_mfma_f32_16x16x32_bf16 v[124:127], a[240:243], v[4:7], v[204:207]
s_waitcnt vmcnt(5)
v_exp_f32 v234, v156
v_mfma_f32_16x16x32_bf16 v[128:131], a[240:243], v[8:11], v[208:211]
v_exp_f32 v235, v157
v_mfma_f32_16x16x32_bf16 v[132:135], a[240:243], v[12:15], v[212:215]
v_exp_f32 v236, v158
v_mfma_f32_16x16x32_bf16 v[136:139], a[240:243], v[16:19], v[216:219]
s_waitcnt lgkmcnt(2)
ds_read_b128 a[240:243], v238 offset:256
v_add_f32 v228, v230, v231
v_mfma_f32_16x16x32_bf16 v[120:123], a[244:247], v[20:23], v[120:123]
v_exp_f32 v237, v159
v_mfma_f32_16x16x32_bf16 v[124:127], a[244:247], v[24:27], v[124:127]
v_cvt_pk_bf16_f32 v175, v232, v233
v_add_f32 v228, v228, v232
v_mfma_f32_16x16x32_bf16 v[128:131], a[244:247], v[28:31], v[128:131]
v_add_f32 v228, v228, v233
v_cvt_pk_bf16_f32 v178, v234, v235
v_mfma_f32_16x16x32_bf16 v[132:135], a[244:247], v[32:35], v[132:135]
buffer_load_dwordx4 v247, s[16:19], s34 offen offset:2048 nt lds
v_mfma_f32_16x16x32_bf16 v[136:139], a[244:247], v[36:39], v[136:139]
s_waitcnt lgkmcnt(2)
ds_read_b128 a[244:247], v239 offset:256
v_add_f32 v229, v234, v235
v_mfma_f32_16x16x32_bf16 v[120:123], a[248:251], v[40:43], v[120:123]
s_add_u32 m0, m0, 3072
v_cvt_pk_bf16_f32 v179, v236, v237
v_add_f32 v229, v229, v236
v_mfma_f32_16x16x32_bf16 v[124:127], a[248:251], v[44:47], v[124:127]
s_add_u32 s40, s34, 3072
v_add_f32 v229, v229, v237
v_max3_f32 v244, v225, v226, v227
v_mfma_f32_16x16x32_bf16 v[128:131], a[248:251], v[48:51], v[128:131]
s_waitcnt vmcnt(5)
v_max3_f32 v244, v244, v228, v229
v_cmp_ngt_f32 vcc, 2.0, v244
v_mfma_f32_16x16x32_bf16 v[132:135], a[248:251], v[52:55], v[132:135]
v_mfma_f32_16x16x32_bf16 v[136:139], a[248:251], v[56:59], v[136:139]
s_waitcnt lgkmcnt(2)
ds_read_b128 a[248:251], v238 offset:6144
v_mfma_f32_16x16x32_bf16 v[120:123], a[252:255], v[60:63], v[120:123]
v_mfma_f32_16x16x32_bf16 v[124:127], a[252:255], v[64:67], v[124:127]
buffer_load_dwordx4 v245, s[16:19], s40 offen offset:0 nt lds
v_mfma_f32_16x16x32_bf16 v[128:131], a[252:255], v[68:71], v[128:131]
s_waitcnt vmcnt(5)
v_mfma_f32_16x16x32_bf16 v[132:135], a[252:255], v[72:75], v[132:135]
v_mfma_f32_16x16x32_bf16 v[136:139], a[252:255], v[76:79], v[136:139]
s_waitcnt lgkmcnt(2)
ds_read_b128 a[252:255], v239 offset:6144
v_mfma_f32_16x16x32_bf16 v[120:123], a[240:243], v[80:83], v[120:123]
v_mfma_f32_16x16x32_bf16 v[124:127], a[240:243], v[84:87], v[124:127]
v_mfma_f32_16x16x32_bf16 v[128:131], a[240:243], v[88:91], v[128:131]
v_mfma_f32_16x16x32_bf16 v[132:135], a[240:243], v[92:95], v[132:135]
v_mfma_f32_16x16x32_bf16 v[136:139], a[240:243], v[96:99], v[136:139]
s_waitcnt lgkmcnt(2)
ds_read_b128 a[240:243], v238 offset:6272
v_mfma_f32_16x16x32_bf16 v[120:123], a[244:247], v[100:103], v[120:123]
buffer_load_dwordx4 v246, s[16:19], s40 offen offset:1024 nt lds
v_mfma_f32_16x16x32_bf16 v[124:127], a[244:247], v[104:107], v[124:127]
s_waitcnt vmcnt(5)
v_mfma_f32_16x16x32_bf16 v[128:131], a[244:247], v[108:111], v[128:131]
v_mfma_f32_16x16x32_bf16 v[132:135], a[244:247], v[112:115], v[132:135]
v_mfma_f32_16x16x32_bf16 v[136:139], a[244:247], v[116:119], v[136:139]
s_cbranch_vccnz L_tr50
L_back50:
s_waitcnt lgkmcnt(2)
ds_read_b128 a[244:247], v239 offset:6272
s_waitcnt vmcnt(63)
v_mov_b32 v232, s76
ds_read_b32 v231, v232
v_mov_b32 v230, 0
s_waitcnt lgkmcnt(0)
s_mov_b32 s43, 0x80000
L_concat_heads__mha_block_cached__gqa_block_cached__near_ridge_kernel_poll0:
v_cmp_gt_u32 vcc, 8, v231
s_sub_u32 s43, s43, 1
s_cmp_eq_u32 s43, 0
s_cbranch_scc1 L_concat_heads__mha_block_cached__gqa_block_cached__near_ridge_kernel_poll0_out
s_cbranch_vccz L_concat_heads__mha_block_cached__gqa_block_cached__near_ridge_kernel_poll0_out
s_sleep 1
buffer_load_dword v231, v230, s[72:75], s77 offen sc1
s_waitcnt vmcnt(0)
s_branch L_concat_heads__mha_block_cached__gqa_block_cached__near_ridge_kernel_poll0
L_concat_heads__mha_block_cached__gqa_block_cached__near_ridge_kernel_poll0_out:
v_mfma_f32_16x16x32_bf16 v[140:143], a[248:251], v[0:3], v[200:203]
v_exp_f32 v230, v120
v_mfma_f32_16x16x32_bf16 v[144:147], a[248:251], v[4:7], v[204:207]
v_exp_f32 v231, v121
v_mfma_f32_16x16x32_bf16 v[148:151], a[248:251], v[8:11], v[208:211]
v_exp_f32 v232, v122
v_mfma_f32_16x16x32_bf16 v[152:155], a[248:251], v[12:15], v[212:215]
buffer_load_dwordx4 v247, s[16:19], s40 offen offset:2048 nt lds
v_mfma_f32_16x16x32_bf16 v[156:159], a[248:251], v[16:19], v[216:219]
s_waitcnt lgkmcnt(15)
ds_read_b128 a[248:251], v238 offset:6400
v_add_f32 v220, v220, v225
v_mfma_f32_16x16x32_bf16 v[140:143], a[252:255], v[20:23], v[140:143]
s_add_u32 s34, s34, 12288
v_exp_f32 v233, v123
v_mfma_f32_16x16x32_bf16 v[144:147], a[252:255], v[24:27], v[144:147]
s_add_u32 s31, s31, 24576
v_exp_f32 v234, v124
v_mfma_f32_16x16x32_bf16 v[148:151], a[252:255], v[28:31], v[148:151]
s_sub_u32 s41, s31, 147456
v_exp_f32 v235, v125
v_mfma_f32_16x16x32_bf16 v[152:155], a[252:255], v[32:35], v[152:155]
s_min_u32 s31, s31, s41
v_exp_f32 v236, v126
v_mfma_f32_16x16x32_bf16 v[156:159], a[252:255], v[36:39], v[156:159]
s_waitcnt lgkmcnt(15)
ds_read_b128 a[252:255], v239 offset:6400
v_add_f32 v221, v221, v226
v_mfma_f32_16x16x32_bf16 v[140:143], a[240:243], v[40:43], v[140:143]
v_add_u32 v238, s32, v252
v_xor_b32 v239, 64, v238
v_mfma_f32_16x16x32_bf16 v[144:147], a[240:243], v[44:47], v[144:147]
s_add_u32 s32, s32, 24576
v_exp_f32 v237, v127
v_mfma_f32_16x16x32_bf16 v[148:151], a[240:243], v[48:51], v[148:151]
s_sub_u32 s42, s32, 147456
v_add_f32 v222, v222, v227
v_add_f32 v223, v223, v228
v_mfma_f32_16x16x32_bf16 v[152:155], a[240:243], v[52:55], v[152:155]
s_min_u32 s32, s32, s42
v_add_f32 v224, v224, v229
v_cvt_pk_bf16_f32 v180, v230, v231
v_mfma_f32_16x16x32_bf16 v[156:159], a[240:243], v[56:59], v[156:159]
s_waitcnt lgkmcnt(15)
v_add_f32 v225, v230, v231
v_cvt_pk_bf16_f32 v181, v232, v233
v_mfma_f32_16x16x32_bf16 v[140:143], a[244:247], v[60:63], v[140:143]
v_add_f32 v225, v225, v232
v_add_f32 v225, v225, v233
v_mfma_f32_16x16x32_bf16 v[144:147], a[244:247], v[64:67], v[144:147]
v_exp_f32 v230, v128
v_mfma_f32_16x16x32_bf16 v[148:151], a[244:247], v[68:71], v[148:151]
v_exp_f32 v231, v129
v_mfma_f32_16x16x32_bf16 v[152:155], a[244:247], v[72:75], v[152:155]
s_waitcnt vmcnt(63) lgkmcnt(0)
s_barrier
ds_read_b64_tr_b16 a[240:241], v240 offset:0
v_mfma_f32_16x16x32_bf16 v[156:159], a[244:247], v[76:79], v[156:159]
s_waitcnt lgkmcnt(15)
ds_read_b64_tr_b16 a[242:243], v240 offset:6144
ds_read_b64_tr_b16 a[244:245], v241 offset:0
v_mfma_f32_16x16x32_bf16 v[140:143], a[248:251], v[80:83], v[140:143]
s_add_u32 m0, s31, s37
ds_read_b64_tr_b16 a[246:247], v241 offset:6144
v_cvt_pk_bf16_f32 v184, v234, v235
v_mfma_f32_16x16x32_bf16 v[144:147], a[248:251], v[84:87], v[144:147]
s_waitcnt vmcnt(5)
v_exp_f32 v232, v130
v_mfma_f32_16x16x32_bf16 v[148:151], a[248:251], v[88:91], v[148:151]
buffer_load_dwordx4 v245, s[16:19], s34 offen offset:0 nt lds
v_mfma_f32_16x16x32_bf16 v[152:155], a[248:251], v[92:95], v[152:155]
s_waitcnt vmcnt(5)
v_exp_f32 v233, v131
v_mfma_f32_16x16x32_bf16 v[156:159], a[248:251], v[96:99], v[156:159]
s_waitcnt lgkmcnt(15)
ds_read_b64_tr_b16 a[248:249], v242 offset:0
ds_read_b64_tr_b16 a[250:251], v242 offset:6144
v_mfma_f32_16x16x32_bf16 v[140:143], a[252:255], v[100:103], v[140:143]
v_add_f32 v226, v234, v235
v_cvt_pk_bf16_f32 v185, v236, v237
v_mfma_f32_16x16x32_bf16 v[144:147], a[252:255], v[104:107], v[144:147]
v_add_f32 v226, v226, v236
v_add_f32 v226, v226, v237
v_mfma_f32_16x16x32_bf16 v[148:151], a[252:255], v[108:111], v[148:151]
v_exp_f32 v234, v132
v_mfma_f32_16x16x32_bf16 v[152:155], a[252:255], v[112:115], v[152:155]
v_exp_f32 v235, v133
v_mfma_f32_16x16x32_bf16 v[156:159], a[252:255], v[116:119], v[156:159]
s_waitcnt lgkmcnt(4)
ds_read_b64_tr_b16 a[252:253], v243 offset:0
ds_read_b64_tr_b16 a[254:255], v243 offset:6144
v_mfma_f32_16x16x32_bf16 a[0:3], a[240:243], v[160:163], a[0:3]
buffer_load_dwordx4 v246, s[16:19], s34 offen offset:1024 nt lds
v_mfma_f32_16x16x32_bf16 a[4:7], a[240:243], v[164:167], a[4:7]
s_waitcnt vmcnt(5)
v_exp_f32 v236, v134
v_mfma_f32_16x16x32_bf16 a[8:11], a[240:243], v[168:171], a[8:11]
v_exp_f32 v237, v135
v_mfma_f32_16x16x32_bf16 a[12:15], a[240:243], v[172:175], a[12:15]
v_cvt_pk_bf16_f32 v188, v230, v231
v_add_f32 v227, v230, v231
v_mfma_f32_16x16x32_bf16 a[16:19], a[240:243], v[176:179], a[16:19]
s_waitcnt lgkmcnt(4)
ds_read_b64_tr_b16 a[240:241], v240 offset:128
ds_read_b64_tr_b16 a[242:243], v240 offset:6272
v_mfma_f32_16x16x32_bf16 a[20:23], a[244:247], v[160:163], a[20:23]
v_cvt_pk_bf16_f32 v189, v232, v233
v_add_f32 v227, v227, v232
v_mfma_f32_16x16x32_bf16 a[24:27], a[244:247], v[164:167], a[24:27]
v_add_f32 v227, v227, v233
v_cvt_pk_bf16_f32 v192, v234, v235
v_mfma_f32_16x16x32_bf16 a[28:31], a[244:247], v[168:171], a[28:31]
v_exp_f32 v230, v136
v_mfma_f32_16x16x32_bf16 a[32:35], a[244:247], v[172:175], a[32:35]
buffer_load_dwordx4 v247, s[16:19], s34 offen offset:2048 nt lds
v_mfma_f32_16x16x32_bf16 a[36:39], a[244:247], v[176:179], a[36:39]
s_waitcnt lgkmcnt(4)
ds_read_b64_tr_b16 a[244:245], v241 offset:128
ds_read_b64_tr_b16 a[246:247], v241 offset:6272
v_mfma_f32_16x16x32_bf16 a[40:43], a[248:251], v[160:163], a[40:43]
s_add_u32 m0, m0, 3072
v_exp_f32 v231, v137
v_mfma_f32_16x16x32_bf16 a[44:47], a[248:251], v[164:167], a[44:47]
s_add_u32 s40, s34, 3072
v_exp_f32 v232, v138
v_mfma_f32_16x16x32_bf16 a[48:51], a[248:251], v[168:171], a[48:51]
s_waitcnt vmcnt(5)
v_exp_f32 v233, v139
v_mfma_f32_16x16x32_bf16 a[52:55], a[248:251], v[172:175], a[52:55]
v_add_f32 v228, v234, v235
v_cvt_pk_bf16_f32 v193, v236, v237
v_mfma_f32_16x16x32_bf16 a[56:59], a[248:251], v[176:179], a[56:59]
s_waitcnt lgkmcnt(4)
ds_read_b64_tr_b16 a[248:249], v242 offset:128
ds_read_b64_tr_b16 a[250:251], v242 offset:6272
v_mfma_f32_16x16x32_bf16 a[60:63], a[252:255], v[160:163], a[60:63]
v_add_f32 v228, v228, v236
v_add_f32 v228, v228, v237
v_mfma_f32_16x16x32_bf16 a[64:67], a[252:255], v[164:167], a[64:67]
buffer_load_dwordx4 v245, s[16:19], s40 offen offset:0 nt lds
v_mfma_f32_16x16x32_bf16 a[68:71], a[252:255], v[168:171], a[68:71]
s_waitcnt vmcnt(5)
v_cvt_pk_bf16_f32 v196, v230, v231
v_add_f32 v229, v230, v231
v_mfma_f32_16x16x32_bf16 a[72:75], a[252:255], v[172:175], a[72:75]
v_cvt_pk_bf16_f32 v197, v232, v233
v_add_f32 v229, v229, v232
v_mfma_f32_16x16x32_bf16 a[76:79], a[252:255], v[176:179], a[76:79]
s_waitcnt lgkmcnt(4)
ds_read_b64_tr_b16 a[252:253], v243 offset:128
ds_read_b64_tr_b16 a[254:255], v243 offset:6272
v_mfma_f32_16x16x32_bf16 a[80:83], a[240:243], v[160:163], a[80:83]
v_add_f32 v229, v229, v233
v_max3_f32 v244, v225, v226, v227
v_mfma_f32_16x16x32_bf16 a[84:87], a[240:243], v[164:167], a[84:87]
v_max3_f32 v244, v244, v228, v229
v_cmp_ngt_f32 vcc, 2.0, v244
v_mfma_f32_16x16x32_bf16 a[88:91], a[240:243], v[168:171], a[88:91]
s_cbranch_vccnz L_tr53
L_back53:
v_exp_f32 v234, v140
v_mfma_f32_16x16x32_bf16 a[92:95], a[240:243], v[172:175], a[92:95]
v_exp_f32 v235, v141
v_mfma_f32_16x16x32_bf16 a[96:99], a[240:243], v[176:179], a[96:99]
s_waitcnt lgkmcnt(4)
ds_read_b64_tr_b16 a[240:241], v240 offset:256
ds_read_b64_tr_b16 a[242:243], v240 offset:6400
v_mfma_f32_16x16x32_bf16 a[100:103], a[244:247], v[160:163], a[100:103]
buffer_load_dwordx4 v246, s[16:19], s40 offen offset:1024 nt lds
v_mfma_f32_16x16x32_bf16 a[104:107], a[244:247], v[164:167], a[104:107]
s_waitcnt vmcnt(5)
v_exp_f32 v236, v142
v_mfma_f32_16x16x32_bf16 a[108:111], a[244:247], v[168:171], a[108:111]
v_exp_f32 v237, v143
v_mfma_f32_16x16x32_bf16 a[112:115], a[244:247], v[172:175], a[112:115]
v_exp_f32 v230, v144
v_mfma_f32_16x16x32_bf16 a[116:119], a[244:247], v[176:179], a[116:119]
s_waitcnt lgkmcnt(4)
ds_read_b64_tr_b16 a[244:245], v241 offset:256
ds_read_b64_tr_b16 a[246:247], v241 offset:6400
v_mfma_f32_16x16x32_bf16 a[120:123], a[248:251], v[160:163], a[120:123]
v_exp_f32 v231, v145
v_mfma_f32_16x16x32_bf16 a[124:127], a[248:251], v[164:167], a[124:127]
v_exp_f32 v232, v146
v_mfma_f32_16x16x32_bf16 a[128:131], a[248:251], v[168:171], a[128:131]
v_exp_f32 v233, v147
v_mfma_f32_16x16x32_bf16 a[132:135], a[248:251], v[172:175], a[132:135]
buffer_load_dwordx4 v247, s[16:19], s40 offen offset:2048 nt lds
v_mfma_f32_16x16x32_bf16 a[136:139], a[248:251], v[176:179], a[136:139]
s_waitcnt lgkmcnt(4)
ds_read_b64_tr_b16 a[248:249], v242 offset:256
ds_read_b64_tr_b16 a[250:251], v242 offset:6400
v_mfma_f32_16x16x32_bf16 a[140:143], a[252:255], v[160:163], a[140:143]
s_add_u32 s34, s34, 208896
v_add_f32 v220, v220, v225
v_add_f32 v221, v221, v226
v_mfma_f32_16x16x32_bf16 a[144:147], a[252:255], v[164:167], a[144:147]
s_add_u32 s31, s31, 24576
v_add_f32 v222, v222, v227
v_add_f32 v223, v223, v228
v_mfma_f32_16x16x32_bf16 a[148:151], a[252:255], v[168:171], a[148:151]
s_sub_u32 s41, s31, 147456
v_add_f32 v224, v224, v229
v_cvt_pk_bf16_f32 v182, v234, v235
v_mfma_f32_16x16x32_bf16 a[152:155], a[252:255], v[172:175], a[152:155]
s_min_u32 s31, s31, s41
v_add_f32 v225, v234, v235
v_cvt_pk_bf16_f32 v183, v236, v237
v_mfma_f32_16x16x32_bf16 a[156:159], a[252:255], v[176:179], a[156:159]
s_waitcnt lgkmcnt(4)
ds_read_b64_tr_b16 a[252:253], v243 offset:256
ds_read_b64_tr_b16 a[254:255], v243 offset:6400
v_mfma_f32_16x16x32_bf16 a[160:163], a[240:243], v[160:163], a[160:163]
v_add_u32 v240, s32, v253
v_xor_b32 v241, 32, v240
v_mfma_f32_16x16x32_bf16 a[164:167], a[240:243], v[164:167], a[164:167]
v_xor_b32 v242, 64, v240
v_xor_b32 v243, 64, v241
v_mfma_f32_16x16x32_bf16 a[168:171], a[240:243], v[168:171], a[168:171]
s_add_u32 s32, s32, 24576
v_add_f32 v225, v225, v236
v_add_f32 v225, v225, v237
v_mfma_f32_16x16x32_bf16 a[172:175], a[240:243], v[172:175], a[172:175]
s_sub_u32 s42, s32, 147456
v_exp_f32 v234, v148
v_mfma_f32_16x16x32_bf16 a[176:179], a[240:243], v[176:179], a[176:179]
s_waitcnt lgkmcnt(4)
v_exp_f32 v235, v149
v_mfma_f32_16x16x32_bf16 a[180:183], a[244:247], v[160:163], a[180:183]
s_min_u32 s32, s32, s42
v_exp_f32 v236, v150
v_mfma_f32_16x16x32_bf16 a[184:187], a[244:247], v[164:167], a[184:187]
v_exp_f32 v237, v151
v_mfma_f32_16x16x32_bf16 a[188:191], a[244:247], v[168:171], a[188:191]
v_cvt_pk_bf16_f32 v186, v230, v231
v_add_f32 v226, v230, v231
v_mfma_f32_16x16x32_bf16 a[192:195], a[244:247], v[172:175], a[192:195]
s_waitcnt vmcnt(63) lgkmcnt(0)
s_barrier
ds_read_b128 a[240:243], v238 offset:0
v_mfma_f32_16x16x32_bf16 a[196:199], a[244:247], v[176:179], a[196:199]
s_waitcnt lgkmcnt(15)
ds_read_b128 a[244:247], v239 offset:0
v_cvt_pk_bf16_f32 v187, v232, v233
v_mfma_f32_16x16x32_bf16 a[200:203], a[248:251], v[160:163], a[200:203]
s_add_u32 m0, s85, 98304
v_add_f32 v226, v226, v232
v_add_f32 v226, v226, v233
v_mfma_f32_16x16x32_bf16 a[204:207], a[248:251], v[164:167], a[204:207]
buffer_load_dwordx4 v248, s[8:11], s82 offen offset:0 sc1 lds
v_mfma_f32_16x16x32_bf16 a[208:211], a[248:251], v[168:171], a[208:211]
v_exp_f32 v230, v152
v_mfma_f32_16x16x32_bf16 a[212:215], a[248:251], v[172:175], a[212:215]
v_exp_f32 v231, v153
v_mfma_f32_16x16x32_bf16 a[216:219], a[248:251], v[176:179], a[216:219]
s_waitcnt lgkmcnt(15)
ds_read_b128 a[248:251], v238 offset:128
v_cvt_pk_bf16_f32 v190, v234, v235
v_mfma_f32_16x16x32_bf16 a[220:223], a[252:255], v[160:163], a[220:223]
v_exp_f32 v232, v154
v_mfma_f32_16x16x32_bf16 a[224:227], a[252:255], v[164:167], a[224:227]
v_exp_f32 v233, v155
v_mfma_f32_16x16x32_bf16 a[228:231], a[252:255], v[168:171], a[228:231]
v_add_f32 v227, v234, v235
v_cvt_pk_bf16_f32 v191, v236, v237
v_mfma_f32_16x16x32_bf16 a[232:235], a[252:255], v[172:175], a[232:235]
v_add_f32 v227, v227, v236
v_add_f32 v227, v227, v237
v_mfma_f32_16x16x32_bf16 a[236:239], a[252:255], v[176:179], a[236:239]
s_waitcnt lgkmcnt(2)
ds_read_b128 a[252:255], v239 offset:128
v_cvt_pk_bf16_f32 v194, v230, v231
v_mfma_f32_16x16x32_bf16 v[120:123], a[240:243], v[0:3], v[200:203]
buffer_load_dwordx4 v249, s[8:11], s82 offen offset:1024 sc1 lds
v_mfma_f32_16x16x32_bf16 v[124:127], a[240:243], v[4:7], v[204:207]
v_exp_f32 v234, v156
v_mfma_f32_16x16x32_bf16 v[128:131], a[240:243], v[8:11], v[208:211]
v_exp_f32 v235, v157
v_mfma_f32_16x16x32_bf16 v[132:135], a[240:243], v[12:15], v[212:215]
v_exp_f32 v236, v158
v_mfma_f32_16x16x32_bf16 v[136:139], a[240:243], v[16:19], v[216:219]
s_waitcnt lgkmcnt(2)
ds_read_b128 a[240:243], v238 offset:256
v_add_f32 v228, v230, v231
v_mfma_f32_16x16x32_bf16 v[120:123], a[244:247], v[20:23], v[120:123]
v_exp_f32 v237, v159
v_mfma_f32_16x16x32_bf16 v[124:127], a[244:247], v[24:27], v[124:127]
v_cvt_pk_bf16_f32 v195, v232, v233
v_add_f32 v228, v228, v232
v_mfma_f32_16x16x32_bf16 v[128:131], a[244:247], v[28:31], v[128:131]
v_add_f32 v228, v228, v233
v_cvt_pk_bf16_f32 v198, v234, v235
v_mfma_f32_16x16x32_bf16 v[132:135], a[244:247], v[32:35], v[132:135]
buffer_load_dwordx4 v250, s[8:11], s82 offen offset:2048 sc1 lds
v_mfma_f32_16x16x32_bf16 v[136:139], a[244:247], v[36:39], v[136:139]
s_waitcnt lgkmcnt(2)
ds_read_b128 a[244:247], v239 offset:256
v_add_f32 v229, v234, v235
v_mfma_f32_16x16x32_bf16 v[120:123], a[248:251], v[40:43], v[120:123]
v_cvt_pk_bf16_f32 v199, v236, v237
v_add_f32 v229, v229, v236
v_mfma_f32_16x16x32_bf16 v[124:127], a[248:251], v[44:47], v[124:127]
v_add_f32 v229, v229, v237
v_max3_f32 v244, v225, v226, v227
v_mfma_f32_16x16x32_bf16 v[128:131], a[248:251], v[48:51], v[128:131]
v_max3_f32 v244, v244, v228, v229
v_cmp_ngt_f32 vcc, 2.0, v244
v_mfma_f32_16x16x32_bf16 v[132:135], a[248:251], v[52:55], v[132:135]
v_mfma_f32_16x16x32_bf16 v[136:139], a[248:251], v[56:59], v[136:139]
s_waitcnt lgkmcnt(2)
ds_read_b128 a[248:251], v238 offset:6144
v_mfma_f32_16x16x32_bf16 v[120:123], a[252:255], v[60:63], v[120:123]
v_mfma_f32_16x16x32_bf16 v[124:127], a[252:255], v[64:67], v[124:127]
buffer_load_dwordx4 v251, s[8:11], s82 offen offset:3072 sc1 lds
v_mfma_f32_16x16x32_bf16 v[128:131], a[252:255], v[68:71], v[128:131]
s_add_u32 m0, s85, 102400
v_mfma_f32_16x16x32_bf16 v[132:135], a[252:255], v[72:75], v[132:135]
v_mfma_f32_16x16x32_bf16 v[136:139], a[252:255], v[76:79], v[136:139]
s_waitcnt lgkmcnt(2)
ds_read_b128 a[252:255], v239 offset:6144
v_mfma_f32_16x16x32_bf16 v[120:123], a[240:243], v[80:83], v[120:123]
v_mfma_f32_16x16x32_bf16 v[124:127], a[240:243], v[84:87], v[124:127]
v_mfma_f32_16x16x32_bf16 v[128:131], a[240:243], v[88:91], v[128:131]
v_mfma_f32_16x16x32_bf16 v[132:135], a[240:243], v[92:95], v[132:135]
v_mfma_f32_16x16x32_bf16 v[136:139], a[240:243], v[96:99], v[136:139]
s_waitcnt lgkmcnt(2)
ds_read_b128 a[240:243], v238 offset:6272
v_mfma_f32_16x16x32_bf16 v[120:123], a[244:247], v[100:103], v[120:123]
buffer_load_dwordx4 v254, s[8:11], s82 offen sc1 lds
v_mfma_f32_16x16x32_bf16 v[124:127], a[244:247], v[104:107], v[124:127]
s_add_u32 s82, s82, s83
v_mfma_f32_16x16x32_bf16 v[128:131], a[244:247], v[108:111], v[128:131]
v_mfma_f32_16x16x32_bf16 v[132:135], a[244:247], v[112:115], v[132:135]
v_mfma_f32_16x16x32_bf16 v[136:139], a[244:247], v[116:119], v[136:139]
s_cbranch_vccnz L_tr54
L_back54:
s_waitcnt lgkmcnt(2)
ds_read_b128 a[244:247], v239 offset:6272
v_mfma_f32_16x16x32_bf16 v[140:143], a[248:251], v[0:3], v[200:203]
v_exp_f32 v230, v120
v_mfma_f32_16x16x32_bf16 v[144:147], a[248:251], v[4:7], v[204:207]
v_exp_f32 v231, v121
v_mfma_f32_16x16x32_bf16 v[148:151], a[248:251], v[8:11], v[208:211]
v_exp_f32 v232, v122
v_mfma_f32_16x16x32_bf16 v[152:155], a[248:251], v[12:15], v[212:215]
v_exp_f32 v233, v123
v_mfma_f32_16x16x32_bf16 v[156:159], a[248:251], v[16:19], v[216:219]
s_waitcnt lgkmcnt(2)
ds_read_b128 a[248:251], v238 offset:6400
v_add_f32 v220, v220, v225
v_mfma_f32_16x16x32_bf16 v[140:143], a[252:255], v[20:23], v[140:143]
v_exp_f32 v234, v124
v_mfma_f32_16x16x32_bf16 v[144:147], a[252:255], v[24:27], v[144:147]
v_exp_f32 v235, v125
v_mfma_f32_16x16x32_bf16 v[148:151], a[252:255], v[28:31], v[148:151]
v_exp_f32 v236, v126
v_mfma_f32_16x16x32_bf16 v[152:155], a[252:255], v[32:35], v[152:155]
v_exp_f32 v237, v127
v_mfma_f32_16x16x32_bf16 v[156:159], a[252:255], v[36:39], v[156:159]
s_waitcnt lgkmcnt(2)
ds_read_b128 a[252:255], v239 offset:6400
v_add_f32 v221, v221, v226
v_mfma_f32_16x16x32_bf16 v[140:143], a[240:243], v[40:43], v[140:143]
v_add_u32 v238, s32, v252
v_xor_b32 v239, 64, v238
v_mfma_f32_16x16x32_bf16 v[144:147], a[240:243], v[44:47], v[144:147]
s_add_u32 s32, s32, 24576
v_add_f32 v222, v222, v227
v_add_f32 v223, v223, v228
v_mfma_f32_16x16x32_bf16 v[148:151], a[240:243], v[48:51], v[148:151]
s_sub_u32 s42, s32, 147456
v_add_f32 v224, v224, v229
v_cvt_pk_bf16_f32 v160, v230, v231
v_mfma_f32_16x16x32_bf16 v[152:155], a[240:243], v[52:55], v[152:155]
s_min_u32 s32, s32, s42
v_add_f32 v225, v230, v231
v_cvt_pk_bf16_f32 v161, v232, v233
v_mfma_f32_16x16x32_bf16 v[156:159], a[240:243], v[56:59], v[156:159]
s_waitcnt lgkmcnt(2)
v_add_f32 v225, v225, v232
v_add_f32 v225, v225, v233
v_mfma_f32_16x16x32_bf16 v[140:143], a[244:247], v[60:63], v[140:143]
v_exp_f32 v230, v128
v_mfma_f32_16x16x32_bf16 v[144:147], a[244:247], v[64:67], v[144:147]
v_exp_f32 v231, v129
v_mfma_f32_16x16x32_bf16 v[148:151], a[244:247], v[68:71], v[148:151]
v_exp_f32 v232, v130
v_mfma_f32_16x16x32_bf16 v[152:155], a[244:247], v[72:75], v[152:155]
s_waitcnt vmcnt(63) lgkmcnt(0)
s_barrier
ds_read_b64_tr_b16 a[240:241], v240 offset:0
v_mfma_f32_16x16x32_bf16 v[156:159], a[244:247], v[76:79], v[156:159]
s_waitcnt lgkmcnt(15)
ds_read_b64_tr_b16 a[242:243], v240 offset:6144
ds_read_b64_tr_b16 a[244:245], v241 offset:0
v_mfma_f32_16x16x32_bf16 v[140:143], a[248:251], v[80:83], v[140:143]
s_add_u32 m0, s85, 122880
ds_read_b64_tr_b16 a[246:247], v241 offset:6144
v_cvt_pk_bf16_f32 v164, v234, v235
v_mfma_f32_16x16x32_bf16 v[144:147], a[248:251], v[84:87], v[144:147]
buffer_load_dwordx4 v248, s[8:11], s82 offen offset:0 sc1 lds
v_mfma_f32_16x16x32_bf16 v[148:151], a[248:251], v[88:91], v[148:151]
v_exp_f32 v233, v131
v_mfma_f32_16x16x32_bf16 v[152:155], a[248:251], v[92:95], v[152:155]
v_add_f32 v226, v234, v235
v_cvt_pk_bf16_f32 v165, v236, v237
v_mfma_f32_16x16x32_bf16 v[156:159], a[248:251], v[96:99], v[156:159]
s_waitcnt lgkmcnt(15)
ds_read_b64_tr_b16 a[248:249], v242 offset:0
ds_read_b64_tr_b16 a[250:251], v242 offset:6144
v_mfma_f32_16x16x32_bf16 v[140:143], a[252:255], v[100:103], v[140:143]
v_add_f32 v226, v226, v236
v_add_f32 v226, v226, v237
v_mfma_f32_16x16x32_bf16 v[144:147], a[252:255], v[104:107], v[144:147]
v_exp_f32 v234, v132
v_mfma_f32_16x16x32_bf16 v[148:151], a[252:255], v[108:111], v[148:151]
v_exp_f32 v235, v133
v_mfma_f32_16x16x32_bf16 v[152:155], a[252:255], v[112:115], v[152:155]
v_exp_f32 v236, v134
v_mfma_f32_16x16x32_bf16 v[156:159], a[252:255], v[116:119], v[156:159]
s_waitcnt lgkmcnt(4)
ds_read_b64_tr_b16 a[252:253], v243 offset:0
ds_read_b64_tr_b16 a[254:255], v243 offset:6144
v_mfma_f32_16x16x32_bf16 a[0:3], a[240:243], v[180:183], a[0:3]
buffer_load_dwordx4 v249, s[8:11], s82 offen offset:1024 sc1 lds
v_mfma_f32_16x16x32_bf16 a[4:7], a[240:243], v[184:187], a[4:7]
v_exp_f32 v237, v135
v_mfma_f32_16x16x32_bf16 a[8:11], a[240:243], v[188:191], a[8:11]
v_cvt_pk_bf16_f32 v168, v230, v231
v_add_f32 v227, v230, v231
v_mfma_f32_16x16x32_bf16 a[12:15], a[240:243], v[192:195], a[12:15]
v_cvt_pk_bf16_f32 v169, v232, v233
v_add_f32 v227, v227, v232
v_mfma_f32_16x16x32_bf16 a[16:19], a[240:243], v[196:199], a[16:19]
s_waitcnt lgkmcnt(4)
ds_read_b64_tr_b16 a[240:241], v240 offset:128
ds_read_b64_tr_b16 a[242:243], v240 offset:6272
v_mfma_f32_16x16x32_bf16 a[20:23], a[244:247], v[180:183], a[20:23]
v_add_f32 v227, v227, v233
v_cvt_pk_bf16_f32 v172, v234, v235
v_mfma_f32_16x16x32_bf16 a[24:27], a[244:247], v[184:187], a[24:27]
v_exp_f32 v230, v136
v_mfma_f32_16x16x32_bf16 a[28:31], a[244:247], v[188:191], a[28:31]
v_exp_f32 v231, v137
v_mfma_f32_16x16x32_bf16 a[32:35], a[244:247], v[192:195], a[32:35]
buffer_load_dwordx4 v250, s[8:11], s82 offen offset:2048 sc1 lds
v_mfma_f32_16x16x32_bf16 a[36:39], a[244:247], v[196:199], a[36:39]
s_waitcnt lgkmcnt(4)
ds_read_b64_tr_b16 a[244:245], v241 offset:128
ds_read_b64_tr_b16 a[246:247], v241 offset:6272
v_mfma_f32_16x16x32_bf16 a[40:43], a[248:251], v[180:183], a[40:43]
v_exp_f32 v232, v138
v_mfma_f32_16x16x32_bf16 a[44:47], a[248:251], v[184:187], a[44:47]
v_exp_f32 v233, v139
v_mfma_f32_16x16x32_bf16 a[48:51], a[248:251], v[188:191], a[48:51]
v_add_f32 v228, v234, v235
v_cvt_pk_bf16_f32 v173, v236, v237
v_mfma_f32_16x16x32_bf16 a[52:55], a[248:251], v[192:195], a[52:55]
v_add_f32 v228, v228, v236
v_add_f32 v228, v228, v237
v_mfma_f32_16x16x32_bf16 a[56:59], a[248:251], v[196:199], a[56:59]
s_waitcnt lgkmcnt(4)
ds_read_b64_tr_b16 a[248:249], v242 offset:128
ds_read_b64_tr_b16 a[250:251], v242 offset:6272
v_mfma_f32_16x16x32_bf16 a[60:63], a[252:255], v[180:183], a[60:63]
v_cvt_pk_bf16_f32 v176, v230, v231
v_add_f32 v229, v230, v231
v_mfma_f32_16x16x32_bf16 a[64:67], a[252:255], v[184:187], a[64:67]
buffer_load_dwordx4 v251, s[8:11], s82 offen offset:3072 sc1 lds
v_mfma_f32_16x16x32_bf16 a[68:71], a[252:255], v[188:191], a[68:71]
s_add_u32 m0, s85, 126976
v_cvt_pk_bf16_f32 v177, v232, v233
v_add_f32 v229, v229, v232
v_mfma_f32_16x16x32_bf16 a[72:75], a[252:255], v[192:195], a[72:75]
v_add_f32 v229, v229, v233
v_max3_f32 v244, v225, v226, v227
v_mfma_f32_16x16x32_bf16 a[76:79], a[252:255], v[196:199], a[76:79]
s_waitcnt lgkmcnt(4)
ds_read_b64_tr_b16 a[252:253], v243 offset:128
ds_read_b64_tr_b16 a[254:255], v243 offset:6272
v_mfma_f32_16x16x32_bf16 a[80:83], a[240:243], v[180:183], a[80:83]
v_max3_f32 v244, v244, v228, v229
v_cmp_ngt_f32 vcc, 2.0, v244
v_mfma_f32_16x16x32_bf16 a[84:87], a[240:243], v[184:187], a[84:87]
s_cbranch_vccnz L_tr56
L_back56:
v_exp_f32 v234, v140
v_mfma_f32_16x16x32_bf16 a[88:91], a[240:243], v[188:191], a[88:91]
v_exp_f32 v235, v141
v_mfma_f32_16x16x32_bf16 a[92:95], a[240:243], v[192:195], a[92:95]
v_exp_f32 v236, v142
v_mfma_f32_16x16x32_bf16 a[96:99], a[240:243], v[196:199], a[96:99]
s_waitcnt lgkmcnt(4)
ds_read_b64_tr_b16 a[240:241], v240 offset:256
ds_read_b64_tr_b16 a[242:243], v240 offset:6400
v_mfma_f32_16x16x32_bf16 a[100:103], a[244:247], v[180:183], a[100:103]
buffer_load_dwordx4 v254, s[8:11], s82 offen sc1 lds
v_mfma_f32_16x16x32_bf16 a[104:107], a[244:247], v[184:187], a[104:107]
s_add_u32 s82, s82, s83
v_exp_f32 v237, v143
v_mfma_f32_16x16x32_bf16 a[108:111], a[244:247], v[188:191], a[108:111]
v_exp_f32 v230, v144
v_mfma_f32_16x16x32_bf16 a[112:115], a[244:247], v[192:195], a[112:115]
v_exp_f32 v231, v145
v_mfma_f32_16x16x32_bf16 a[116:119], a[244:247], v[196:199], a[116:119]
s_waitcnt lgkmcnt(4)
ds_read_b64_tr_b16 a[244:245], v241 offset:256
ds_read_b64_tr_b16 a[246:247], v241 offset:6400
v_mfma_f32_16x16x32_bf16 a[120:123], a[248:251], v[180:183], a[120:123]
v_exp_f32 v232, v146
v_mfma_f32_16x16x32_bf16 a[124:127], a[248:251], v[184:187], a[124:127]
v_exp_f32 v233, v147
v_mfma_f32_16x16x32_bf16 a[128:131], a[248:251], v[188:191], a[128:131]
v_add_f32 v220, v220, v225
v_add_f32 v221, v221, v226
v_mfma_f32_16x16x32_bf16 a[132:135], a[248:251], v[192:195], a[132:135]
v_add_f32 v222, v222, v227
v_add_f32 v223, v223, v228
v_mfma_f32_16x16x32_bf16 a[136:139], a[248:251], v[196:199], a[136:139]
s_waitcnt lgkmcnt(4)
ds_read_b64_tr_b16 a[248:249], v242 offset:256
ds_read_b64_tr_b16 a[250:251], v242 offset:6400
v_mfma_f32_16x16x32_bf16 a[140:143], a[252:255], v[180:183], a[140:143]
v_add_f32 v224, v224, v229
v_cvt_pk_bf16_f32 v162, v234, v235
v_mfma_f32_16x16x32_bf16 a[144:147], a[252:255], v[184:187], a[144:147]
v_add_f32 v225, v234, v235
v_cvt_pk_bf16_f32 v163, v236, v237
v_mfma_f32_16x16x32_bf16 a[148:151], a[252:255], v[188:191], a[148:151]
v_add_f32 v225, v225, v236
v_add_f32 v225, v225, v237
v_mfma_f32_16x16x32_bf16 a[152:155], a[252:255], v[192:195], a[152:155]
v_exp_f32 v234, v148
v_mfma_f32_16x16x32_bf16 a[156:159], a[252:255], v[196:199], a[156:159]
s_waitcnt lgkmcnt(4)
ds_read_b64_tr_b16 a[252:253], v243 offset:256
ds_read_b64_tr_b16 a[254:255], v243 offset:6400
v_mfma_f32_16x16x32_bf16 a[160:163], a[240:243], v[180:183], a[160:163]
v_add_u32 v240, s32, v253
v_xor_b32 v241, 32, v240
v_mfma_f32_16x16x32_bf16 a[164:167], a[240:243], v[184:187], a[164:167]
v_xor_b32 v242, 64, v240
v_xor_b32 v243, 64, v241
v_mfma_f32_16x16x32_bf16 a[168:171], a[240:243], v[188:191], a[168:171]
s_add_u32 s32, s32, 24576
v_exp_f32 v235, v149
v_mfma_f32_16x16x32_bf16 a[172:175], a[240:243], v[192:195], a[172:175]
s_sub_u32 s42, s32, 147456
v_exp_f32 v236, v150
v_mfma_f32_16x16x32_bf16 a[176:179], a[240:243], v[196:199], a[176:179]
s_waitcnt lgkmcnt(4)
v_exp_f32 v237, v151
v_mfma_f32_16x16x32_bf16 a[180:183], a[244:247], v[180:183], a[180:183]
s_min_u32 s32, s32, s42
v_cvt_pk_bf16_f32 v166, v230, v231
v_add_f32 v226, v230, v231
v_mfma_f32_16x16x32_bf16 a[184:187], a[244:247], v[184:187], a[184:187]
v_cvt_pk_bf16_f32 v167, v232, v233
v_add_f32 v226, v226, v232
v_mfma_f32_16x16x32_bf16 a[188:191], a[244:247], v[188:191], a[188:191]
v_add_f32 v226, v226, v233
v_cvt_pk_bf16_f32 v170, v234, v235
v_mfma_f32_16x16x32_bf16 a[192:195], a[244:247], v[192:195], a[192:195]
s_waitcnt vmcnt(63) lgkmcnt(0)
s_barrier
ds_read_b128 a[240:243], v238 offset:0
v_mfma_f32_16x16x32_bf16 a[196:199], a[244:247], v[196:199], a[196:199]
s_waitcnt lgkmcnt(15)
ds_read_b128 a[244:247], v239 offset:0
v_add_f32 v227, v234, v235
v_mfma_f32_16x16x32_bf16 a[200:203], a[248:251], v[180:183], a[200:203]
s_add_u32 m0, s85, 0
v_exp_f32 v230, v152
v_mfma_f32_16x16x32_bf16 a[204:207], a[248:251], v[184:187], a[204:207]
buffer_load_dwordx4 v248, s[8:11], s82 offen offset:0 sc1 lds
v_mfma_f32_16x16x32_bf16 a[208:211], a[248:251], v[188:191], a[208:211]
v_exp_f32 v231, v153
v_mfma_f32_16x16x32_bf16 a[212:215], a[248:251], v[192:195], a[212:215]
v_exp_f32 v232, v154
v_mfma_f32_16x16x32_bf16 a[216:219], a[248:251], v[196:199], a[216:219]
s_waitcnt lgkmcnt(15)
ds_read_b128 a[248:251], v238 offset:128
v_cvt_pk_bf16_f32 v171, v236, v237
v_mfma_f32_16x16x32_bf16 a[220:223], a[252:255], v[180:183], a[220:223]
v_exp_f32 v233, v155
v_mfma_f32_16x16x32_bf16 a[224:227], a[252:255], v[184:187], a[224:227]
v_add_f32 v227, v227, v236
v_add_f32 v227, v227, v237
v_mfma_f32_16x16x32_bf16 a[228:231], a[252:255], v[188:191], a[228:231]
v_exp_f32 v234, v156
v_mfma_f32_16x16x32_bf16 a[232:235], a[252:255], v[192:195], a[232:235]
v_exp_f32 v235, v157
v_mfma_f32_16x16x32_bf16 a[236:239], a[252:255], v[196:199], a[236:239]
s_waitcnt lgkmcnt(2)
ds_read_b128 a[252:255], v239 offset:128
v_cvt_pk_bf16_f32 v174, v230, v231
v_mfma_f32_16x16x32_bf16 v[120:123], a[240:243], v[0:3], v[200:203]
buffer_load_dwordx4 v249, s[8:11], s82 offen offset:1024 sc1 lds
v_mfma_f32_16x16x32_bf16 v[124:127], a[240:243], v[4:7], v[204:207]
v_exp_f32 v236, v158
v_mfma_f32_16x16x32_bf16 v[128:131], a[240:243], v[8:11], v[208:211]
v_exp_f32 v237, v159
v_mfma_f32_16x16x32_bf16 v[132:135], a[240:243], v[12:15], v[212:215]
v_add_f32 v228, v230, v231
v_cvt_pk_bf16_f32 v175, v232, v233
v_mfma_f32_16x16x32_bf16 v[136:139], a[240:243], v[16:19], v[216:219]
s_waitcnt lgkmcnt(2)
ds_read_b128 a[240:243], v238 offset:256
v_add_f32 v228, v228, v232
v_mfma_f32_16x16x32_bf16 v[120:123], a[244:247], v[20:23], v[120:123]
v_add_f32 v228, v228, v233
v_cvt_pk_bf16_f32 v178, v234, v235
v_mfma_f32_16x16x32_bf16 v[124:127], a[244:247], v[24:27], v[124:127]
v_add_f32 v229, v234, v235
v_cvt_pk_bf16_f32 v179, v236, v237
v_mfma_f32_16x16x32_bf16 v[128:131], a[244:247], v[28:31], v[128:131]
v_add_f32 v229, v229, v236
v_add_f32 v229, v229, v237
v_mfma_f32_16x16x32_bf16 v[132:135], a[244:247], v[32:35], v[132:135]
buffer_load_dwordx4 v250, s[8:11], s82 offen offset:2048 sc1 lds
v_mfma_f32_16x16x32_bf16 v[136:139], a[244:247], v[36:39], v[136:139]
s_waitcnt lgkmcnt(2)
ds_read_b128 a[244:247], v239 offset:256
v_max3_f32 v244, v225, v226, v227
v_mfma_f32_16x16x32_bf16 v[120:123], a[248:251], v[40:43], v[120:123]
v_max3_f32 v244, v244, v228, v229
v_cmp_ngt_f32 vcc, 2.0, v244
v_mfma_f32_16x16x32_bf16 v[124:127], a[248:251], v[44:47], v[124:127]
v_mfma_f32_16x16x32_bf16 v[128:131], a[248:251], v[48:51], v[128:131]
v_mfma_f32_16x16x32_bf16 v[132:135], a[248:251], v[52:55], v[132:135]
v_mfma_f32_16x16x32_bf16 v[136:139], a[248:251], v[56:59], v[136:139]
s_waitcnt lgkmcnt(2)
ds_read_b128 a[248:251], v238 offset:6144
v_mfma_f32_16x16x32_bf16 v[120:123], a[252:255], v[60:63], v[120:123]
v_mfma_f32_16x16x32_bf16 v[124:127], a[252:255], v[64:67], v[124:127]
buffer_load_dwordx4 v251, s[8:11], s82 offen offset:3072 sc1 lds
v_mfma_f32_16x16x32_bf16 v[128:131], a[252:255], v[68:71], v[128:131]
s_add_u32 m0, s85, 4096
v_mfma_f32_16x16x32_bf16 v[132:135], a[252:255], v[72:75], v[132:135]
v_mfma_f32_16x16x32_bf16 v[136:139], a[252:255], v[76:79], v[136:139]
s_waitcnt lgkmcnt(2)
ds_read_b128 a[252:255], v239 offset:6144
v_mfma_f32_16x16x32_bf16 v[120:123], a[240:243], v[80:83], v[120:123]
v_mfma_f32_16x16x32_bf16 v[124:127], a[240:243], v[84:87], v[124:127]
v_mfma_f32_16x16x32_bf16 v[128:131], a[240:243], v[88:91], v[128:131]
v_mfma_f32_16x16x32_bf16 v[132:135], a[240:243], v[92:95], v[132:135]
v_mfma_f32_16x16x32_bf16 v[136:139], a[240:243], v[96:99], v[136:139]
s_waitcnt lgkmcnt(2)
ds_read_b128 a[240:243], v238 offset:6272
v_mfma_f32_16x16x32_bf16 v[120:123], a[244:247], v[100:103], v[120:123]
buffer_load_dwordx4 v254, s[8:11], s82 offen sc1 lds
v_mfma_f32_16x16x32_bf16 v[124:127], a[244:247], v[104:107], v[124:127]
s_add_u32 s82, s82, s83
v_mfma_f32_16x16x32_bf16 v[128:131], a[244:247], v[108:111], v[128:131]
v_mfma_f32_16x16x32_bf16 v[132:135], a[244:247], v[112:115], v[132:135]
v_mfma_f32_16x16x32_bf16 v[136:139], a[244:247], v[116:119], v[136:139]
s_cbranch_vccnz L_tr57
L_back57:
s_waitcnt lgkmcnt(2)
ds_read_b128 a[244:247], v239 offset:6272
v_mfma_f32_16x16x32_bf16 v[140:143], a[248:251], v[0:3], v[200:203]
v_exp_f32 v230, v120
v_add_f32 v220, v220, v225
v_mfma_f32_16x16x32_bf16 v[144:147], a[248:251], v[4:7], v[204:207]
v_exp_f32 v231, v121
v_add_f32 v221, v221, v226
v_mfma_f32_16x16x32_bf16 v[148:151], a[248:251], v[8:11], v[208:211]
v_exp_f32 v232, v122
v_add_f32 v222, v222, v227
v_mfma_f32_16x16x32_bf16 v[152:155], a[248:251], v[12:15], v[212:215]
v_exp_f32 v233, v123
v_add_f32 v223, v223, v228
v_mfma_f32_16x16x32_bf16 v[156:159], a[248:251], v[16:19], v[216:219]
s_waitcnt lgkmcnt(2)
ds_read_b128 a[248:251], v238 offset:6400
v_exp_f32 v234, v124
v_mfma_f32_16x16x32_bf16 v[140:143], a[252:255], v[20:23], v[140:143]
v_exp_f32 v235, v125
v_add_f32 v224, v224, v229
v_mfma_f32_16x16x32_bf16 v[144:147], a[252:255], v[24:27], v[144:147]
v_exp_f32 v236, v126
v_cvt_pk_bf16_f32 v180, v230, v231
v_mfma_f32_16x16x32_bf16 v[148:151], a[252:255], v[28:31], v[148:151]
v_exp_f32 v237, v127
v_add_f32 v225, v230, v231
v_mfma_f32_16x16x32_bf16 v[152:155], a[252:255], v[32:35], v[152:155]
v_cvt_pk_bf16_f32 v181, v232, v233
v_add_f32 v225, v225, v232
v_add_f32 v225, v225, v233
v_mfma_f32_16x16x32_bf16 v[156:159], a[252:255], v[36:39], v[156:159]
s_waitcnt lgkmcnt(2)
ds_read_b128 a[252:255], v239 offset:6400
v_exp_f32 v230, v128
v_mfma_f32_16x16x32_bf16 v[140:143], a[240:243], v[40:43], v[140:143]
v_exp_f32 v231, v129
v_cvt_pk_bf16_f32 v184, v234, v235
v_mfma_f32_16x16x32_bf16 v[144:147], a[240:243], v[44:47], v[144:147]
v_exp_f32 v232, v130
v_add_f32 v226, v234, v235
v_mfma_f32_16x16x32_bf16 v[148:151], a[240:243], v[48:51], v[148:151]
v_exp_f32 v233, v131
v_cvt_pk_bf16_f32 v185, v236, v237
v_mfma_f32_16x16x32_bf16 v[152:155], a[240:243], v[52:55], v[152:155]
v_add_f32 v226, v226, v236
v_add_f32 v226, v226, v237
v_cvt_pk_bf16_f32 v188, v230, v231
v_mfma_f32_16x16x32_bf16 v[156:159], a[240:243], v[56:59], v[156:159]
s_waitcnt lgkmcnt(2)
v_exp_f32 v234, v132
v_add_f32 v227, v230, v231
v_mfma_f32_16x16x32_bf16 v[140:143], a[244:247], v[60:63], v[140:143]
v_exp_f32 v235, v133
v_cvt_pk_bf16_f32 v189, v232, v233
v_mfma_f32_16x16x32_bf16 v[144:147], a[244:247], v[64:67], v[144:147]
v_exp_f32 v236, v134
v_add_f32 v227, v227, v232
v_mfma_f32_16x16x32_bf16 v[148:151], a[244:247], v[68:71], v[148:151]
v_exp_f32 v237, v135
v_add_f32 v227, v227, v233
v_mfma_f32_16x16x32_bf16 v[152:155], a[244:247], v[72:75], v[152:155]
s_waitcnt vmcnt(63) lgkmcnt(0)
s_barrier
ds_read_b64_tr_b16 a[240:241], v240 offset:0
ds_read_b64_tr_b16 a[242:243], v240 offset:6144
v_mfma_f32_16x16x32_bf16 v[156:159], a[244:247], v[76:79], v[156:159]
s_waitcnt lgkmcnt(15)
ds_read_b64_tr_b16 a[244:245], v241 offset:0
ds_read_b64_tr_b16 a[246:247], v241 offset:6144
v_cvt_pk_bf16_f32 v192, v234, v235
v_mfma_f32_16x16x32_bf16 v[140:143], a[248:251], v[80:83], v[140:143]
s_add_u32 m0, s85, 24576
v_exp_f32 v230, v136
v_add_f32 v228, v234, v235
v_mfma_f32_16x16x32_bf16 v[144:147], a[248:251], v[84:87], v[144:147]
buffer_load_dwordx4 v248, s[8:11], s82 offen offset:0 sc1 lds
v_cvt_pk_bf16_f32 v193, v236, v237
v_mfma_f32_16x16x32_bf16 v[148:151], a[248:251], v[88:91], v[148:151]
v_exp_f32 v231, v137
v_add_f32 v228, v228, v236
v_mfma_f32_16x16x32_bf16 v[152:155], a[248:251], v[92:95], v[152:155]
v_exp_f32 v232, v138
v_add_f32 v228, v228, v237
v_mfma_f32_16x16x32_bf16 v[156:159], a[248:251], v[96:99], v[156:159]
s_waitcnt lgkmcnt(15)
ds_read_b64_tr_b16 a[248:249], v242 offset:0
ds_read_b64_tr_b16 a[250:251], v242 offset:6144
v_cvt_pk_bf16_f32 v196, v230, v231
v_mfma_f32_16x16x32_bf16 v[140:143], a[252:255], v[100:103], v[140:143]
v_exp_f32 v233, v139
v_add_f32 v229, v230, v231
v_mfma_f32_16x16x32_bf16 v[144:147], a[252:255], v[104:107], v[144:147]
v_cvt_pk_bf16_f32 v197, v232, v233
v_add_f32 v229, v229, v232
v_add_f32 v229, v229, v233
v_mfma_f32_16x16x32_bf16 v[148:151], a[252:255], v[108:111], v[148:151]
v_max3_f32 v244, v225, v226, v227
v_max3_f32 v244, v244, v228, v229
v_cmp_ngt_f32 vcc, 2.0, v244
v_mfma_f32_16x16x32_bf16 v[152:155], a[252:255], v[112:115], v[152:155]
v_mfma_f32_16x16x32_bf16 v[156:159], a[252:255], v[116:119], v[156:159]
s_waitcnt lgkmcnt(4)
ds_read_b64_tr_b16 a[252:253], v243 offset:0
ds_read_b64_tr_b16 a[254:255], v243 offset:6144
v_mfma_f32_16x16x32_bf16 a[0:3], a[240:243], v[160:163], a[0:3]
buffer_load_dwordx4 v249, s[8:11], s82 offen offset:1024 sc1 lds
v_mfma_f32_16x16x32_bf16 a[4:7], a[240:243], v[164:167], a[4:7]
v_mfma_f32_16x16x32_bf16 a[8:11], a[240:243], v[168:171], a[8:11]
v_mfma_f32_16x16x32_bf16 a[12:15], a[240:243], v[172:175], a[12:15]
v_mfma_f32_16x16x32_bf16 a[16:19], a[240:243], v[176:179], a[16:19]
s_waitcnt lgkmcnt(4)
ds_read_b64_tr_b16 a[240:241], v240 offset:128
ds_read_b64_tr_b16 a[242:243], v240 offset:6272
v_mfma_f32_16x16x32_bf16 a[20:23], a[244:247], v[160:163], a[20:23]
v_mfma_f32_16x16x32_bf16 a[24:27], a[244:247], v[164:167], a[24:27]
v_mfma_f32_16x16x32_bf16 a[28:31], a[244:247], v[168:171], a[28:31]
v_mfma_f32_16x16x32_bf16 a[32:35], a[244:247], v[172:175], a[32:35]
buffer_load_dwordx4 v250, s[8:11], s82 offen offset:2048 sc1 lds
v_mfma_f32_16x16x32_bf16 a[36:39], a[244:247], v[176:179], a[36:39]
s_waitcnt lgkmcnt(4)
ds_read_b64_tr_b16 a[244:245], v241 offset:128
ds_read_b64_tr_b16 a[246:247], v241 offset:6272
v_mfma_f32_16x16x32_bf16 a[40:43], a[248:251], v[160:163], a[40:43]
s_cbranch_vccnz L_tr59
L_back59:
v_exp_f32 v234, v140
v_add_f32 v220, v220, v225
v_mfma_f32_16x16x32_bf16 a[44:47], a[248:251], v[164:167], a[44:47]
v_exp_f32 v235, v141
v_add_f32 v221, v221, v226
v_mfma_f32_16x16x32_bf16 a[48:51], a[248:251], v[168:171], a[48:51]
v_exp_f32 v236, v142
v_add_f32 v222, v222, v227
v_mfma_f32_16x16x32_bf16 a[52:55], a[248:251], v[172:175], a[52:55]
v_exp_f32 v237, v143
v_add_f32 v223, v223, v228
v_mfma_f32_16x16x32_bf16 a[56:59], a[248:251], v[176:179], a[56:59]
s_waitcnt lgkmcnt(4)
ds_read_b64_tr_b16 a[248:249], v242 offset:128
ds_read_b64_tr_b16 a[250:251], v242 offset:6272
v_add_f32 v224, v224, v229
v_mfma_f32_16x16x32_bf16 a[60:63], a[252:255], v[160:163], a[60:63]
v_exp_f32 v230, v144
v_cvt_pk_bf16_f32 v182, v234, v235
v_mfma_f32_16x16x32_bf16 a[64:67], a[252:255], v[164:167], a[64:67]
buffer_load_dwordx4 v251, s[8:11], s82 offen offset:3072 sc1 lds
v_add_f32 v225, v234, v235
v_mfma_f32_16x16x32_bf16 a[68:71], a[252:255], v[168:171], a[68:71]
s_add_u32 m0, s85, 28672
v_exp_f32 v231, v145
v_cvt_pk_bf16_f32 v183, v236, v237
v_mfma_f32_16x16x32_bf16 a[72:75], a[252:255], v[172:175], a[72:75]
v_exp_f32 v232, v146
v_add_f32 v225, v225, v236
v_mfma_f32_16x16x32_bf16 a[76:79], a[252:255], v[176:179], a[76:79]
s_waitcnt lgkmcnt(4)
ds_read_b64_tr_b16 a[252:253], v243 offset:128
ds_read_b64_tr_b16 a[254:255], v243 offset:6272
v_add_f32 v225, v225, v237
v_mfma_f32_16x16x32_bf16 a[80:83], a[240:243], v[160:163], a[80:83]
v_exp_f32 v233, v147
v_cvt_pk_bf16_f32 v186, v230, v231
v_mfma_f32_16x16x32_bf16 a[84:87], a[240:243], v[164:167], a[84:87]
v_exp_f32 v234, v148
v_add_f32 v226, v230, v231
v_mfma_f32_16x16x32_bf16 a[88:91], a[240:243], v[168:171], a[88:91]
v_exp_f32 v235, v149
v_cvt_pk_bf16_f32 v187, v232, v233
v_mfma_f32_16x16x32_bf16 a[92:95], a[240:243], v[172:175], a[92:95]
v_exp_f32 v236, v150
v_add_f32 v226, v226, v232
v_mfma_f32_16x16x32_bf16 a[96:99], a[240:243], v[176:179], a[96:99]
s_waitcnt lgkmcnt(4)
ds_read_b64_tr_b16 a[240:241], v240 offset:256
ds_read_b64_tr_b16 a[242:243], v240 offset:6400
v_add_f32 v226, v226, v233
v_mfma_f32_16x16x32_bf16 a[100:103], a[244:247], v[160:163], a[100:103]
buffer_load_dwordx4 v254, s[8:11], s82 offen sc1 lds
v_cvt_pk_bf16_f32 v190, v234, v235
v_mfma_f32_16x16x32_bf16 a[104:107], a[244:247], v[164:167], a[104:107]
s_add_u32 s82, s82, s83
v_exp_f32 v237, v151
v_add_f32 v227, v234, v235
v_mfma_f32_16x16x32_bf16 a[108:111], a[244:247], v[168:171], a[108:111]
v_exp_f32 v230, v152
v_cvt_pk_bf16_f32 v191, v236, v237
v_mfma_f32_16x16x32_bf16 a[112:115], a[244:247], v[172:175], a[112:115]
v_exp_f32 v231, v153
v_add_f32 v227, v227, v236
v_mfma_f32_16x16x32_bf16 a[116:119], a[244:247], v[176:179], a[116:119]
s_waitcnt lgkmcnt(4)
ds_read_b64_tr_b16 a[244:245], v241 offset:256
ds_read_b64_tr_b16 a[246:247], v241 offset:6400
v_add_f32 v227, v227, v237
v_mfma_f32_16x16x32_bf16 a[120:123], a[248:251], v[160:163], a[120:123]
v_exp_f32 v232, v154
v_cvt_pk_bf16_f32 v194, v230, v231
v_mfma_f32_16x16x32_bf16 a[124:127], a[248:251], v[164:167], a[124:127]
v_exp_f32 v233, v155
v_add_f32 v228, v230, v231
v_mfma_f32_16x16x32_bf16 a[128:131], a[248:251], v[168:171], a[128:131]
v_exp_f32 v234, v156
v_cvt_pk_bf16_f32 v195, v232, v233
v_mfma_f32_16x16x32_bf16 a[132:135], a[248:251], v[172:175], a[132:135]
v_exp_f32 v235, v157
v_add_f32 v228, v228, v232
v_mfma_f32_16x16x32_bf16 a[136:139], a[248:251], v[176:179], a[136:139]
s_waitcnt lgkmcnt(4)
ds_read_b64_tr_b16 a[248:249], v242 offset:256
ds_read_b64_tr_b16 a[250:251], v242 offset:6400
v_add_f32 v228, v228, v233
v_mfma_f32_16x16x32_bf16 a[140:143], a[252:255], v[160:163], a[140:143]
v_exp_f32 v236, v158
v_cvt_pk_bf16_f32 v198, v234, v235
v_mfma_f32_16x16x32_bf16 a[144:147], a[252:255], v[164:167], a[144:147]
v_exp_f32 v237, v159
v_add_f32 v229, v234, v235
v_mfma_f32_16x16x32_bf16 a[148:151], a[252:255], v[168:171], a[148:151]
v_cvt_pk_bf16_f32 v199, v236, v237
v_add_f32 v229, v229, v236
v_add_f32 v229, v229, v237
v_mfma_f32_16x16x32_bf16 a[152:155], a[252:255], v[172:175], a[152:155]
v_max3_f32 v244, v225, v226, v227
v_max3_f32 v244, v244, v228, v229
v_cmp_ngt_f32 vcc, 2.0, v244
v_mfma_f32_16x16x32_bf16 a[156:159], a[252:255], v[176:179], a[156:159]
s_waitcnt lgkmcnt(4)
ds_read_b64_tr_b16 a[252:253], v243 offset:256
ds_read_b64_tr_b16 a[254:255], v243 offset:6400
v_mfma_f32_16x16x32_bf16 a[160:163], a[240:243], v[160:163], a[160:163]
v_add_u32 v240, s32, v253
v_xor_b32 v241, 32, v240
v_xor_b32 v242, 64, v240
v_mfma_f32_16x16x32_bf16 a[164:167], a[240:243], v[164:167], a[164:167]
v_xor_b32 v243, 64, v241
v_mfma_f32_16x16x32_bf16 a[168:171], a[240:243], v[168:171], a[168:171]
s_add_u32 s32, s32, 24576
v_mfma_f32_16x16x32_bf16 a[172:175], a[240:243], v[172:175], a[172:175]
s_sub_u32 s42, s32, 147456
v_mfma_f32_16x16x32_bf16 a[176:179], a[240:243], v[176:179], a[176:179]
s_waitcnt lgkmcnt(4)
v_mfma_f32_16x16x32_bf16 a[180:183], a[244:247], v[160:163], a[180:183]
s_min_u32 s32, s32, s42
v_mfma_f32_16x16x32_bf16 a[184:187], a[244:247], v[164:167], a[184:187]
v_mfma_f32_16x16x32_bf16 a[188:191], a[244:247], v[168:171], a[188:191]
v_mfma_f32_16x16x32_bf16 a[192:195], a[244:247], v[172:175], a[192:195]
s_waitcnt vmcnt(20) lgkmcnt(0)
s_barrier
ds_read_b64_tr_b16 a[240:241], v240 offset:0
ds_read_b64_tr_b16 a[242:243], v240 offset:6144
v_mfma_f32_16x16x32_bf16 a[196:199], a[244:247], v[176:179], a[196:199]
s_waitcnt lgkmcnt(15)
ds_read_b64_tr_b16 a[244:245], v241 offset:0
ds_read_b64_tr_b16 a[246:247], v241 offset:6144
v_mfma_f32_16x16x32_bf16 a[200:203], a[248:251], v[160:163], a[200:203]
s_add_u32 m0, s85, 49152
v_mfma_f32_16x16x32_bf16 a[204:207], a[248:251], v[164:167], a[204:207]
buffer_load_dwordx4 v248, s[8:11], s82 offen offset:0 sc1 lds
v_mfma_f32_16x16x32_bf16 a[208:211], a[248:251], v[168:171], a[208:211]
v_mfma_f32_16x16x32_bf16 a[212:215], a[248:251], v[172:175], a[212:215]
v_mfma_f32_16x16x32_bf16 a[216:219], a[248:251], v[176:179], a[216:219]
s_waitcnt lgkmcnt(15)
ds_read_b64_tr_b16 a[248:249], v242 offset:0
ds_read_b64_tr_b16 a[250:251], v242 offset:6144
v_mfma_f32_16x16x32_bf16 a[220:223], a[252:255], v[160:163], a[220:223]
buffer_load_dwordx4 v249, s[8:11], s82 offen offset:1024 sc1 lds
v_mfma_f32_16x16x32_bf16 a[224:227], a[252:255], v[164:167], a[224:227]
v_mfma_f32_16x16x32_bf16 a[228:231], a[252:255], v[168:171], a[228:231]
v_mfma_f32_16x16x32_bf16 a[232:235], a[252:255], v[172:175], a[232:235]
buffer_load_dwordx4 v250, s[8:11], s82 offen offset:2048 sc1 lds
v_mfma_f32_16x16x32_bf16 a[236:239], a[252:255], v[176:179], a[236:239]
s_cbranch_vccnz L_tr60
L_back60:
s_waitcnt lgkmcnt(4)
ds_read_b64_tr_b16 a[252:253], v243 offset:0
ds_read_b64_tr_b16 a[254:255], v243 offset:6144
v_mfma_f32_16x16x32_bf16 a[0:3], a[240:243], v[180:183], a[0:3]
v_add_f32 v220, v220, v225
v_add_f32 v221, v221, v226
v_mfma_f32_16x16x32_bf16 a[4:7], a[240:243], v[184:187], a[4:7]
buffer_load_dwordx4 v251, s[8:11], s82 offen offset:3072 sc1 lds
v_mfma_f32_16x16x32_bf16 a[8:11], a[240:243], v[188:191], a[8:11]
s_add_u32 m0, s85, 53248
v_add_f32 v222, v222, v227
v_add_f32 v223, v223, v228
v_mfma_f32_16x16x32_bf16 a[12:15], a[240:243], v[192:195], a[12:15]
v_add_f32 v224, v224, v229
v_mfma_f32_16x16x32_bf16 a[16:19], a[240:243], v[196:199], a[16:19]
s_waitcnt lgkmcnt(4)
ds_read_b64_tr_b16 a[240:241], v240 offset:128
ds_read_b64_tr_b16 a[242:243], v240 offset:6272
v_mfma_f32_16x16x32_bf16 a[20:23], a[244:247], v[180:183], a[20:23]
buffer_load_dwordx4 v254, s[8:11], s82 offen sc1 lds
v_mfma_f32_16x16x32_bf16 a[24:27], a[244:247], v[184:187], a[24:27]
s_add_u32 s82, s82, s83
v_mfma_f32_16x16x32_bf16 a[28:31], a[244:247], v[188:191], a[28:31]
v_mfma_f32_16x16x32_bf16 a[32:35], a[244:247], v[192:195], a[32:35]
v_mfma_f32_16x16x32_bf16 a[36:39], a[244:247], v[196:199], a[36:39]
s_waitcnt lgkmcnt(4)
ds_read_b64_tr_b16 a[244:245], v241 offset:128
ds_read_b64_tr_b16 a[246:247], v241 offset:6272
v_mfma_f32_16x16x32_bf16 a[40:43], a[248:251], v[180:183], a[40:43]
v_mfma_f32_16x16x32_bf16 a[44:47], a[248:251], v[184:187], a[44:47]
v_mfma_f32_16x16x32_bf16 a[48:51], a[248:251], v[188:191], a[48:51]
v_mfma_f32_16x16x32_bf16 a[52:55], a[248:251], v[192:195], a[52:55]
v_mfma_f32_16x16x32_bf16 a[56:59], a[248:251], v[196:199], a[56:59]
s_waitcnt lgkmcnt(4)
ds_read_b64_tr_b16 a[248:249], v242 offset:128
ds_read_b64_tr_b16 a[250:251], v242 offset:6272
v_mfma_f32_16x16x32_bf16 a[60:63], a[252:255], v[180:183], a[60:63]
v_mfma_f32_16x16x32_bf16 a[64:67], a[252:255], v[184:187], a[64:67]
v_mfma_f32_16x16x32_bf16 a[68:71], a[252:255], v[188:191], a[68:71]
v_mfma_f32_16x16x32_bf16 a[72:75], a[252:255], v[192:195], a[72:75]
v_mfma_f32_16x16x32_bf16 a[76:79], a[252:255], v[196:199], a[76:79]
s_waitcnt lgkmcnt(4)
ds_read_b64_tr_b16 a[252:253], v243 offset:128
ds_read_b64_tr_b16 a[254:255], v243 offset:6272
v_mfma_f32_16x16x32_bf16 a[80:83], a[240:243], v[180:183], a[80:83]
v_mfma_f32_16x16x32_bf16 a[84:87], a[240:243], v[184:187], a[84:87]
v_mfma_f32_16x16x32_bf16 a[88:91], a[240:243], v[188:191], a[88:91]
v_mfma_f32_16x16x32_bf16 a[92:95], a[240:243], v[192:195], a[92:95]
v_mfma_f32_16x16x32_bf16 a[96:99], a[240:243], v[196:199], a[96:99]
s_waitcnt lgkmcnt(4)
ds_read_b64_tr_b16 a[240:241], v240 offset:256
ds_read_b64_tr_b16 a[242:243], v240 offset:6400
v_mfma_f32_16x16x32_bf16 a[100:103], a[244:247], v[180:183], a[100:103]
v_mfma_f32_16x16x32_bf16 a[104:107], a[244:247], v[184:187], a[104:107]
v_mfma_f32_16x16x32_bf16 a[108:111], a[244:247], v[188:191], a[108:111]
v_mfma_f32_16x16x32_bf16 a[112:115], a[244:247], v[192:195], a[112:115]
v_mfma_f32_16x16x32_bf16 a[116:119], a[244:247], v[196:199], a[116:119]
s_waitcnt lgkmcnt(4)
ds_read_b64_tr_b16 a[244:245], v241 offset:256
ds_read_b64_tr_b16 a[246:247], v241 offset:6400
v_mfma_f32_16x16x32_bf16 a[120:123], a[248:251], v[180:183], a[120:123]
v_mfma_f32_16x16x32_bf16 a[124:127], a[248:251], v[184:187], a[124:127]
v_mfma_f32_16x16x32_bf16 a[128:131], a[248:251], v[188:191], a[128:131]
v_mfma_f32_16x16x32_bf16 a[132:135], a[248:251], v[192:195], a[132:135]
v_mfma_f32_16x16x32_bf16 a[136:139], a[248:251], v[196:199], a[136:139]
s_waitcnt lgkmcnt(4)
ds_read_b64_tr_b16 a[248:249], v242 offset:256
ds_read_b64_tr_b16 a[250:251], v242 offset:6400
v_mfma_f32_16x16x32_bf16 a[140:143], a[252:255], v[180:183], a[140:143]
v_mfma_f32_16x16x32_bf16 a[144:147], a[252:255], v[184:187], a[144:147]
v_mfma_f32_16x16x32_bf16 a[148:151], a[252:255], v[188:191], a[148:151]
v_mfma_f32_16x16x32_bf16 a[152:155], a[252:255], v[192:195], a[152:155]
v_mfma_f32_16x16x32_bf16 a[156:159], a[252:255], v[196:199], a[156:159]
s_waitcnt lgkmcnt(4)
ds_read_b64_tr_b16 a[252:253], v243 offset:256
ds_read_b64_tr_b16 a[254:255], v243 offset:6400
v_mfma_f32_16x16x32_bf16 a[160:163], a[240:243], v[180:183], a[160:163]
v_mfma_f32_16x16x32_bf16 a[164:167], a[240:243], v[184:187], a[164:167]
v_mfma_f32_16x16x32_bf16 a[168:171], a[240:243], v[188:191], a[168:171]
v_mfma_f32_16x16x32_bf16 a[172:175], a[240:243], v[192:195], a[172:175]
v_mfma_f32_16x16x32_bf16 a[176:179], a[240:243], v[196:199], a[176:179]
s_waitcnt lgkmcnt(4)
v_mfma_f32_16x16x32_bf16 a[180:183], a[244:247], v[180:183], a[180:183]
v_mfma_f32_16x16x32_bf16 a[184:187], a[244:247], v[184:187], a[184:187]
v_mfma_f32_16x16x32_bf16 a[188:191], a[244:247], v[188:191], a[188:191]
v_mfma_f32_16x16x32_bf16 a[192:195], a[244:247], v[192:195], a[192:195]
v_mfma_f32_16x16x32_bf16 a[196:199], a[244:247], v[196:199], a[196:199]
s_waitcnt lgkmcnt(2)
v_mfma_f32_16x16x32_bf16 a[200:203], a[248:251], v[180:183], a[200:203]
v_mfma_f32_16x16x32_bf16 a[204:207], a[248:251], v[184:187], a[204:207]
v_mfma_f32_16x16x32_bf16 a[208:211], a[248:251], v[188:191], a[208:211]
v_mfma_f32_16x16x32_bf16 a[212:215], a[248:251], v[192:195], a[212:215]
v_mfma_f32_16x16x32_bf16 a[216:219], a[248:251], v[196:199], a[216:219]
s_waitcnt lgkmcnt(0)
v_mfma_f32_16x16x32_bf16 a[220:223], a[252:255], v[180:183], a[220:223]
v_mfma_f32_16x16x32_bf16 a[224:227], a[252:255], v[184:187], a[224:227]
v_mfma_f32_16x16x32_bf16 a[228:231], a[252:255], v[188:191], a[228:231]
v_mfma_f32_16x16x32_bf16 a[232:235], a[252:255], v[192:195], a[232:235]
v_mfma_f32_16x16x32_bf16 a[236:239], a[252:255], v[196:199], a[236:239]
v_mov_b32 v230, v220
v_mov_b32 v231, v221
v_mov_b32 v232, v222
v_mov_b32 v233, v223
v_mov_b32 v234, v224
v_permlane32_swap_b32 v220, v230
v_permlane32_swap_b32 v221, v231
v_permlane32_swap_b32 v222, v232
v_permlane32_swap_b32 v223, v233
v_permlane32_swap_b32 v224, v234
v_add_f32 v220, v220, v230
v_add_f32 v221, v221, v231
v_add_f32 v222, v222, v232
v_add_f32 v223, v223, v233
v_add_f32 v224, v224, v234
v_mov_b32 v230, v220
v_mov_b32 v231, v221
v_mov_b32 v232, v222
v_mov_b32 v233, v223
v_mov_b32 v234, v224
v_permlane16_swap_b32 v220, v230
v_permlane16_swap_b32 v221, v231
v_permlane16_swap_b32 v222, v232
v_permlane16_swap_b32 v223, v233
v_permlane16_swap_b32 v224, v234
v_add_f32 v220, v220, v230
v_add_f32 v221, v221, v231
v_add_f32 v222, v222, v232
v_add_f32 v223, v223, v233
v_add_f32 v224, v224, v234
v_rcp_f32 v220, v220
v_rcp_f32 v221, v221
v_rcp_f32 v222, v222
v_rcp_f32 v223, v223
v_rcp_f32 v224, v224
v_mov_b32 v174, v255
v_add_u32 v175, 4096, v255
v_mov_b32 v194, 0
buffer_load_dword v196, v194, s[20:23], s64 offen sc1
buffer_load_dword v197, v194, s[20:23], s65 offen sc1
s_mul_i32 s43, s30, 5120
v_add_u32 v164, s43, v255
v_lshrrev_b32 v178, 6, v255
v_mul_u32_u24 v179, 320, v178
v_bfe_u32 v180, v255, 4, 2
v_lshl_add_u32 v179, v180, 3, v179
s_mul_i32 s43, s29, 160
s_add_u32 s43, s43, 10240
v_add_u32 v179, s43, v179
v_bfe_u32 v180, v178, 2, 1
v_lshlrev_b32 v180, 5, v180
s_lshl_b32 s43, s29, 1
s_sub_u32 s43, 1, s43
v_mul_lo_u32 v180, v180, s43
v_add_u32 v167, v179, v180
v_sub_u32 v170, v179, v180
v_lshlrev_b32 v178, 3, v255
v_cmp_gt_u32 vcc, 320, v255
v_mov_b32 v179, 0x7ffffff0
s_and_b32 s54, s2, 3
v_cndmask_b32 v198, v179, v178, vcc
v_add_u32 v165, 61440, v164
v_add_u32 v168, 61440, v167
v_add_u32 v171, 61440, v170
v_add_u32 v166, 122880, v164
v_add_u32 v169, 122880, v167
v_add_u32 v172, 122880, v170
s_waitcnt vmcnt(17) lgkmcnt(0)
s_barrier
ds_read_b64_tr_b16 v[100:101], v168 offset:36864
ds_read_b64_tr_b16 v[102:103], v168 offset:41984
ds_read_b64_tr_b16 v[104:105], v171 offset:36896
ds_read_b64_tr_b16 v[106:107], v171 offset:42016
ds_read_b64_tr_b16 v[108:109], v168 offset:36928
ds_read_b64_tr_b16 v[110:111], v168 offset:42048
ds_read_b64_tr_b16 v[112:113], v171 offset:36960
ds_read_b64_tr_b16 v[114:115], v171 offset:42080
ds_read_b64_tr_b16 v[116:117], v168 offset:36992
ds_read_b64_tr_b16 v[118:119], v168 offset:42112
ds_read_b128 v[140:143], v165 offset:36864
ds_read_b128 v[144:147], v165 offset:37888
ds_read_b128 v[148:151], v165 offset:38912
s_waitcnt lgkmcnt(2)
v_mfma_f32_16x16x32_bf16 v[0:3], v[100:103], v[140:143], 0
s_add_u32 m0, s85, 73728
ds_read_b128 v[152:155], v165 offset:39936
ds_read_b128 v[156:159], v165 offset:40960
ds_read_b64_tr_b16 v[120:121], v169 offset:0
v_mfma_f32_16x16x32_bf16 v[4:7], v[104:107], v[140:143], 0
ds_read_b64_tr_b16 v[122:123], v169 offset:5120
ds_read_b64_tr_b16 v[124:125], v172 offset:32
ds_read_b64_tr_b16 v[126:127], v172 offset:5152
v_mfma_f32_16x16x32_bf16 v[8:11], v[108:111], v[140:143], 0
ds_read_b64_tr_b16 v[128:129], v169 offset:64
ds_read_b64_tr_b16 v[130:131], v169 offset:5184
ds_read_b64_tr_b16 v[132:133], v172 offset:96
v_mfma_f32_16x16x32_bf16 v[12:15], v[112:115], v[140:143], 0
ds_read_b64_tr_b16 v[134:135], v172 offset:5216
ds_read_b64_tr_b16 v[136:137], v169 offset:128
ds_read_b64_tr_b16 v[138:139], v169 offset:5248
v_mfma_f32_16x16x32_bf16 v[16:19], v[116:119], v[140:143], 0
s_waitcnt lgkmcnt(13)
ds_read_b128 v[160:163], v166 offset:0
ds_read_b128 v[140:143], v166 offset:1024
v_accvgpr_read_b32 v178, a0
v_mfma_f32_16x16x32_bf16 v[20:23], v[100:103], v[144:147], 0
buffer_load_dwordx4 v248, s[8:11], s82 offen offset:0 sc1 lds
v_accvgpr_read_b32 v179, a1
v_mfma_f32_16x16x32_bf16 v[24:27], v[104:107], v[144:147], 0
buffer_load_dwordx4 v249, s[8:11], s82 offen offset:1024 sc1 lds
v_accvgpr_read_b32 v180, a2
v_mfma_f32_16x16x32_bf16 v[28:31], v[108:111], v[144:147], 0
buffer_load_dwordx4 v250, s[8:11], s82 offen offset:2048 sc1 lds
v_accvgpr_read_b32 v181, a3
v_mfma_f32_16x16x32_bf16 v[32:35], v[112:115], v[144:147], 0
buffer_load_dwordx4 v251, s[8:11], s82 offen offset:3072 sc1 lds
v_mul_f32 v178, v220, v178
v_mfma_f32_16x16x32_bf16 v[36:39], v[116:119], v[144:147], 0
s_waitcnt lgkmcnt(14)
s_add_u32 m0, s85, 77824
ds_read_b128 v[144:147], v166 offset:2048
v_mul_f32 v179, v220, v179
v_mfma_f32_16x16x32_bf16 v[40:43], v[100:103], v[148:151], 0
buffer_load_dwordx4 v254, s[8:11], s82 offen sc1 lds
v_mul_f32 v180, v220, v180
v_mfma_f32_16x16x32_bf16 v[44:47], v[104:107], v[148:151], 0
s_add_u32 s82, s82, s83
s_add_u32 m0, s85, 143360
v_mul_f32 v181, v220, v181
v_cvt_pk_bf16_f32 v186, v178, v179
v_mfma_f32_16x16x32_bf16 v[48:51], v[108:111], v[148:151], 0
buffer_load_dwordx4 v248, s[8:11], s82 offen offset:0 sc1 lds
v_cvt_pk_bf16_f32 v187, v180, v181
v_mfma_f32_16x16x32_bf16 v[52:55], v[112:115], v[148:151], 0
buffer_load_dwordx4 v249, s[8:11], s82 offen offset:1024 sc1 lds
v_accvgpr_read_b32 v182, a20
v_mfma_f32_16x16x32_bf16 v[56:59], v[116:119], v[148:151], 0
s_waitcnt lgkmcnt(14)
ds_read_b128 v[148:151], v166 offset:3072
v_accvgpr_read_b32 v183, a21
v_accvgpr_read_b32 v184, a22
v_mfma_f32_16x16x32_bf16 v[60:63], v[100:103], v[152:155], 0
buffer_load_dwordx4 v250, s[8:11], s82 offen offset:2048 sc1 lds
v_accvgpr_read_b32 v185, a23
v_mfma_f32_16x16x32_bf16 v[64:67], v[104:107], v[152:155], 0
buffer_load_dwordx4 v251, s[8:11], s82 offen offset:3072 sc1 lds
v_mul_f32 v182, v220, v182
v_mfma_f32_16x16x32_bf16 v[68:71], v[108:111], v[152:155], 0
s_add_u32 m0, s85, 147456
v_mul_f32 v183, v220, v183
v_mul_f32 v184, v220, v184
v_mul_f32 v185, v220, v185
v_mfma_f32_16x16x32_bf16 v[72:75], v[112:115], v[152:155], 0
buffer_load_dwordx4 v254, s[8:11], s82 offen sc1 lds
v_cvt_pk_bf16_f32 v188, v182, v183
v_mfma_f32_16x16x32_bf16 v[76:79], v[116:119], v[152:155], 0
s_waitcnt lgkmcnt(14)
s_add_u32 s82, s82, s83
ds_read_b128 v[152:155], v166 offset:4096
v_cvt_pk_bf16_f32 v189, v184, v185
v_mfma_f32_16x16x32_bf16 v[80:83], v[100:103], v[156:159], 0
s_add_u32 s39, s47, 0
v_mfma_f32_16x16x32_bf16 v[84:87], v[104:107], v[156:159], 0
buffer_store_dwordx4 v[186:189], v174, s[24:27], s39 offen offset:0 sc1
v_accvgpr_read_b32 v178, a4
v_mfma_f32_16x16x32_bf16 v[88:91], v[108:111], v[156:159], 0
v_accvgpr_read_b32 v179, a5
v_accvgpr_read_b32 v180, a6
v_accvgpr_read_b32 v181, a7
v_mfma_f32_16x16x32_bf16 v[92:95], v[112:115], v[156:159], 0
v_mul_f32 v178, v221, v178
v_mul_f32 v179, v221, v179
v_mul_f32 v180, v221, v180
v_mfma_f32_16x16x32_bf16 v[96:99], v[116:119], v[156:159], 0
s_waitcnt lgkmcnt(4)
v_mul_f32 v181, v221, v181
v_cvt_pk_bf16_f32 v190, v178, v179
v_cvt_pk_bf16_f32 v191, v180, v181
v_mfma_f32_16x16x32_bf16 v[0:3], v[120:123], v[160:163], v[0:3]
v_accvgpr_read_b32 v182, a24
v_accvgpr_read_b32 v183, a25
v_accvgpr_read_b32 v184, a26
v_mfma_f32_16x16x32_bf16 v[4:7], v[124:127], v[160:163], v[4:7]
v_accvgpr_read_b32 v185, a27
v_mul_f32 v182, v221, v182
v_mul_f32 v183, v221, v183
v_mfma_f32_16x16x32_bf16 v[8:11], v[128:131], v[160:163], v[8:11]
v_mul_f32 v184, v221, v184
v_mul_f32 v185, v221, v185
v_cvt_pk_bf16_f32 v192, v182, v183
v_mfma_f32_16x16x32_bf16 v[12:15], v[132:135], v[160:163], v[12:15]
v_cvt_pk_bf16_f32 v193, v184, v185
v_mfma_f32_16x16x32_bf16 v[16:19], v[136:139], v[160:163], v[16:19]
s_waitcnt lgkmcnt(3)
v_mfma_f32_16x16x32_bf16 v[20:23], v[120:123], v[140:143], v[20:23]
buffer_store_dwordx4 v[190:193], v174, s[24:27], s39 offen offset:1024 sc1
v_accvgpr_read_b32 v178, a8
v_mfma_f32_16x16x32_bf16 v[24:27], v[124:127], v[140:143], v[24:27]
v_accvgpr_read_b32 v179, a9
v_accvgpr_read_b32 v180, a10
v_accvgpr_read_b32 v181, a11
v_mfma_f32_16x16x32_bf16 v[28:31], v[128:131], v[140:143], v[28:31]
v_mul_f32 v178, v222, v178
v_mul_f32 v179, v222, v179
v_mul_f32 v180, v222, v180
v_mfma_f32_16x16x32_bf16 v[32:35], v[132:135], v[140:143], v[32:35]
s_waitcnt vmcnt(19) lgkmcnt(0)
s_barrier
ds_read_b64_tr_b16 v[100:101], v167 offset:0
ds_read_b64_tr_b16 v[102:103], v167 offset:5120
v_mfma_f32_16x16x32_bf16 v[36:39], v[136:139], v[140:143], v[36:39]
s_waitcnt lgkmcnt(15)
ds_read_b64_tr_b16 v[104:105], v170 offset:32
ds_read_b64_tr_b16 v[106:107], v170 offset:5152
ds_read_b64_tr_b16 v[108:109], v167 offset:64
v_mfma_f32_16x16x32_bf16 v[40:43], v[120:123], v[144:147], v[40:43]
s_add_u32 m0, s85, 102400
ds_read_b64_tr_b16 v[110:111], v167 offset:5184
ds_read_b64_tr_b16 v[112:113], v170 offset:96
ds_read_b64_tr_b16 v[114:115], v170 offset:5216
v_mfma_f32_16x16x32_bf16 v[44:47], v[124:127], v[144:147], v[44:47]
ds_read_b64_tr_b16 v[116:117], v167 offset:128
ds_read_b64_tr_b16 v[118:119], v167 offset:5248
ds_read_b128 v[156:159], v164 offset:0
v_mfma_f32_16x16x32_bf16 v[48:51], v[128:131], v[144:147], v[48:51]
ds_read_b128 v[160:163], v164 offset:1024
ds_read_b128 v[140:143], v164 offset:2048
v_mul_f32 v181, v222, v181
v_mfma_f32_16x16x32_bf16 v[52:55], v[132:135], v[144:147], v[52:55]
buffer_load_dwordx4 v248, s[8:11], s82 offen offset:0 sc1 lds
v_cvt_pk_bf16_f32 v186, v178, v179
v_mfma_f32_16x16x32_bf16 v[56:59], v[136:139], v[144:147], v[56:59]
s_waitcnt lgkmcnt(15)
ds_read_b128 v[144:147], v164 offset:3072
v_cvt_pk_bf16_f32 v187, v180, v181
v_accvgpr_read_b32 v182, a28
v_mfma_f32_16x16x32_bf16 v[60:63], v[120:123], v[148:151], v[60:63]
buffer_load_dwordx4 v249, s[8:11], s82 offen offset:1024 sc1 lds
v_accvgpr_read_b32 v183, a29
v_mfma_f32_16x16x32_bf16 v[64:67], v[124:127], v[148:151], v[64:67]
buffer_load_dwordx4 v250, s[8:11], s82 offen offset:2048 sc1 lds
v_accvgpr_read_b32 v184, a30
v_mfma_f32_16x16x32_bf16 v[68:71], v[128:131], v[148:151], v[68:71]
buffer_load_dwordx4 v251, s[8:11], s82 offen offset:3072 sc1 lds
v_accvgpr_read_b32 v185, a31
v_mfma_f32_16x16x32_bf16 v[72:75], v[132:135], v[148:151], v[72:75]
s_add_u32 m0, s85, 106496
v_mul_f32 v182, v222, v182
v_mul_f32 v183, v222, v183
v_mul_f32 v184, v222, v184
v_mfma_f32_16x16x32_bf16 v[76:79], v[136:139], v[148:151], v[76:79]
s_waitcnt lgkmcnt(15)
ds_read_b128 v[148:151], v164 offset:4096
v_mul_f32 v185, v222, v185
v_cvt_pk_bf16_f32 v188, v182, v183
v_mfma_f32_16x16x32_bf16 v[80:83], v[120:123], v[152:155], v[80:83]
buffer_load_dwordx4 v254, s[8:11], s82 offen sc1 lds
v_cvt_pk_bf16_f32 v189, v184, v185
v_mfma_f32_16x16x32_bf16 v[84:87], v[124:127], v[152:155], v[84:87]
s_add_u32 s82, s82, s83
s_add_u32 m0, s85, 122880
v_mfma_f32_16x16x32_bf16 v[88:91], v[128:131], v[152:155], v[88:91]
buffer_load_dwordx4 v248, s[8:11], s82 offen offset:0 sc1 lds
v_mfma_f32_16x16x32_bf16 v[92:95], v[132:135], v[152:155], v[92:95]
buffer_load_dwordx4 v249, s[8:11], s82 offen offset:1024 sc1 lds
v_mfma_f32_16x16x32_bf16 v[96:99], v[136:139], v[152:155], v[96:99]
s_waitcnt lgkmcnt(4)
v_mfma_f32_16x16x32_bf16 v[0:3], v[100:103], v[156:159], v[0:3]
ds_read_b64_tr_b16 v[120:121], v167 offset:24576
ds_read_b64_tr_b16 v[122:123], v167 offset:29696
ds_read_b64_tr_b16 v[124:125], v170 offset:24608
v_mfma_f32_16x16x32_bf16 v[4:7], v[104:107], v[156:159], v[4:7]
ds_read_b64_tr_b16 v[126:127], v170 offset:29728
ds_read_b64_tr_b16 v[128:129], v167 offset:24640
ds_read_b64_tr_b16 v[130:131], v167 offset:29760
v_mfma_f32_16x16x32_bf16 v[8:11], v[108:111], v[156:159], v[8:11]
ds_read_b64_tr_b16 v[132:133], v170 offset:24672
ds_read_b64_tr_b16 v[134:135], v170 offset:29792
ds_read_b64_tr_b16 v[136:137], v167 offset:24704
v_mfma_f32_16x16x32_bf16 v[12:15], v[112:115], v[156:159], v[12:15]
ds_read_b64_tr_b16 v[138:139], v167 offset:29824
ds_read_b128 v[152:155], v164 offset:24576
v_mfma_f32_16x16x32_bf16 v[16:19], v[116:119], v[156:159], v[16:19]
s_waitcnt lgkmcnt(14)
ds_read_b128 v[156:159], v164 offset:25600
v_mfma_f32_16x16x32_bf16 v[20:23], v[100:103], v[160:163], v[20:23]
buffer_load_dwordx4 v250, s[8:11], s82 offen offset:2048 sc1 lds
v_mfma_f32_16x16x32_bf16 v[24:27], v[104:107], v[160:163], v[24:27]
buffer_load_dwordx4 v251, s[8:11], s82 offen offset:3072 sc1 lds
v_mfma_f32_16x16x32_bf16 v[28:31], v[108:111], v[160:163], v[28:31]
s_add_u32 m0, s85, 126976
v_mfma_f32_16x16x32_bf16 v[32:35], v[112:115], v[160:163], v[32:35]
buffer_load_dwordx4 v254, s[8:11], s82 offen sc1 lds
v_mfma_f32_16x16x32_bf16 v[36:39], v[116:119], v[160:163], v[36:39]
s_waitcnt lgkmcnt(14)
s_add_u32 s82, s82, s83
ds_read_b128 v[160:163], v164 offset:26624
v_mfma_f32_16x16x32_bf16 v[40:43], v[100:103], v[140:143], v[40:43]
buffer_store_dwordx4 v[186:189], v174, s[24:27], s39 offen offset:2048 sc1
v_accvgpr_read_b32 v178, a12
v_mfma_f32_16x16x32_bf16 v[44:47], v[104:107], v[140:143], v[44:47]
v_accvgpr_read_b32 v179, a13
v_accvgpr_read_b32 v180, a14
v_accvgpr_read_b32 v181, a15
v_mfma_f32_16x16x32_bf16 v[48:51], v[108:111], v[140:143], v[48:51]
v_mul_f32 v178, v223, v178
v_mul_f32 v179, v223, v179
v_mul_f32 v180, v223, v180
v_mfma_f32_16x16x32_bf16 v[52:55], v[112:115], v[140:143], v[52:55]
v_mul_f32 v181, v223, v181
v_cvt_pk_bf16_f32 v190, v178, v179
v_cvt_pk_bf16_f32 v191, v180, v181
v_mfma_f32_16x16x32_bf16 v[56:59], v[116:119], v[140:143], v[56:59]
s_waitcnt lgkmcnt(14)
ds_read_b128 v[140:143], v164 offset:27648
v_accvgpr_read_b32 v182, a32
v_accvgpr_read_b32 v183, a33
v_mfma_f32_16x16x32_bf16 v[60:63], v[100:103], v[144:147], v[60:63]
v_accvgpr_read_b32 v184, a34
v_accvgpr_read_b32 v185, a35
v_mul_f32 v182, v223, v182
v_mfma_f32_16x16x32_bf16 v[64:67], v[104:107], v[144:147], v[64:67]
v_mul_f32 v183, v223, v183
v_mul_f32 v184, v223, v184
v_mul_f32 v185, v223, v185
v_mfma_f32_16x16x32_bf16 v[68:71], v[108:111], v[144:147], v[68:71]
v_cvt_pk_bf16_f32 v192, v182, v183
v_cvt_pk_bf16_f32 v193, v184, v185
v_mfma_f32_16x16x32_bf16 v[72:75], v[112:115], v[144:147], v[72:75]
buffer_store_dwordx4 v[190:193], v174, s[24:27], s39 offen offset:3072 sc1
v_accvgpr_read_b32 v178, a16
v_mfma_f32_16x16x32_bf16 v[76:79], v[116:119], v[144:147], v[76:79]
s_waitcnt lgkmcnt(14)
ds_read_b128 v[144:147], v164 offset:28672
v_accvgpr_read_b32 v179, a17
v_accvgpr_read_b32 v180, a18
v_mfma_f32_16x16x32_bf16 v[80:83], v[100:103], v[148:151], v[80:83]
v_accvgpr_read_b32 v181, a19
v_mul_f32 v178, v224, v178
v_mul_f32 v179, v224, v179
v_mfma_f32_16x16x32_bf16 v[84:87], v[104:107], v[148:151], v[84:87]
v_mul_f32 v180, v224, v180
v_mul_f32 v181, v224, v181
v_cvt_pk_bf16_f32 v186, v178, v179
v_mfma_f32_16x16x32_bf16 v[88:91], v[108:111], v[148:151], v[88:91]
v_cvt_pk_bf16_f32 v187, v180, v181
v_accvgpr_read_b32 v182, a36
v_accvgpr_read_b32 v183, a37
v_mfma_f32_16x16x32_bf16 v[92:95], v[112:115], v[148:151], v[92:95]
v_accvgpr_read_b32 v184, a38
v_accvgpr_read_b32 v185, a39
v_mul_f32 v182, v224, v182
v_mfma_f32_16x16x32_bf16 v[96:99], v[116:119], v[148:151], v[96:99]
s_waitcnt lgkmcnt(4)
v_mul_f32 v183, v224, v183
v_mul_f32 v184, v224, v184
v_mul_f32 v185, v224, v185
v_mfma_f32_16x16x32_bf16 v[0:3], v[120:123], v[152:155], v[0:3]
v_cvt_pk_bf16_f32 v188, v182, v183
v_cvt_pk_bf16_f32 v189, v184, v185
v_mfma_f32_16x16x32_bf16 v[4:7], v[124:127], v[152:155], v[4:7]
buffer_store_dwordx4 v[186:189], v175, s[24:27], s39 offen sc1
v_accvgpr_read_b32 v178, a40
v_mfma_f32_16x16x32_bf16 v[8:11], v[128:131], v[152:155], v[8:11]
v_accvgpr_read_b32 v179, a41
v_accvgpr_read_b32 v180, a42
v_accvgpr_read_b32 v181, a43
v_mfma_f32_16x16x32_bf16 v[12:15], v[132:135], v[152:155], v[12:15]
v_mul_f32 v178, v220, v178
v_mul_f32 v179, v220, v179
v_mul_f32 v180, v220, v180
v_mfma_f32_16x16x32_bf16 v[16:19], v[136:139], v[152:155], v[16:19]
s_waitcnt lgkmcnt(3)
v_mul_f32 v181, v220, v181
v_cvt_pk_bf16_f32 v190, v178, v179
v_cvt_pk_bf16_f32 v191, v180, v181
v_mfma_f32_16x16x32_bf16 v[20:23], v[120:123], v[156:159], v[20:23]
v_accvgpr_read_b32 v182, a60
v_accvgpr_read_b32 v183, a61
v_accvgpr_read_b32 v184, a62
v_mfma_f32_16x16x32_bf16 v[24:27], v[124:127], v[156:159], v[24:27]
v_accvgpr_read_b32 v185, a63
v_mul_f32 v182, v220, v182
v_mul_f32 v183, v220, v183
v_mfma_f32_16x16x32_bf16 v[28:31], v[128:131], v[156:159], v[28:31]
v_mul_f32 v184, v220, v184
v_mul_f32 v185, v220, v185
v_cvt_pk_bf16_f32 v192, v182, v183
v_mfma_f32_16x16x32_bf16 v[32:35], v[132:135], v[156:159], v[32:35]
s_waitcnt vmcnt(20) lgkmcnt(0)
s_barrier
ds_read_b64_tr_b16 v[100:101], v167 offset:49152
ds_read_b64_tr_b16 v[102:103], v167 offset:54272
v_mfma_f32_16x16x32_bf16 v[36:39], v[136:139], v[156:159], v[36:39]
s_waitcnt lgkmcnt(15)
ds_read_b64_tr_b16 v[104:105], v170 offset:49184
ds_read_b64_tr_b16 v[106:107], v170 offset:54304
ds_read_b64_tr_b16 v[108:109], v167 offset:49216
v_mfma_f32_16x16x32_bf16 v[40:43], v[120:123], v[160:163], v[40:43]
s_add_u32 m0, s85, 0
ds_read_b64_tr_b16 v[110:111], v167 offset:54336
ds_read_b64_tr_b16 v[112:113], v170 offset:49248
ds_read_b64_tr_b16 v[114:115], v170 offset:54368
v_mfma_f32_16x16x32_bf16 v[44:47], v[124:127], v[160:163], v[44:47]
ds_read_b64_tr_b16 v[116:117], v167 offset:49280
ds_read_b64_tr_b16 v[118:119], v167 offset:54400
ds_read_b128 v[148:151], v164 offset:49152
v_mfma_f32_16x16x32_bf16 v[48:51], v[128:131], v[160:163], v[48:51]
ds_read_b128 v[152:155], v164 offset:50176
ds_read_b128 v[156:159], v164 offset:51200
v_cvt_pk_bf16_f32 v193, v184, v185
v_mfma_f32_16x16x32_bf16 v[52:55], v[132:135], v[160:163], v[52:55]
buffer_load_dwordx4 v248, s[8:11], s82 offen offset:0 sc1 lds
v_mfma_f32_16x16x32_bf16 v[56:59], v[136:139], v[160:163], v[56:59]
s_waitcnt lgkmcnt(15)
s_add_u32 s39, s47, 10240
ds_read_b128 v[160:163], v164 offset:52224
v_mfma_f32_16x16x32_bf16 v[60:63], v[120:123], v[140:143], v[60:63]
buffer_load_dwordx4 v249, s[8:11], s82 offen offset:1024 sc1 lds
v_mfma_f32_16x16x32_bf16 v[64:67], v[124:127], v[140:143], v[64:67]
buffer_load_dwordx4 v250, s[8:11], s82 offen offset:2048 sc1 lds
v_mfma_f32_16x16x32_bf16 v[68:71], v[128:131], v[140:143], v[68:71]
buffer_load_dwordx4 v251, s[8:11], s82 offen offset:3072 sc1 lds
v_mfma_f32_16x16x32_bf16 v[72:75], v[132:135], v[140:143], v[72:75]
s_add_u32 m0, s85, 4096
v_mfma_f32_16x16x32_bf16 v[76:79], v[136:139], v[140:143], v[76:79]
s_waitcnt lgkmcnt(15)
ds_read_b128 v[140:143], v164 offset:53248
v_mfma_f32_16x16x32_bf16 v[80:83], v[120:123], v[144:147], v[80:83]
buffer_load_dwordx4 v254, s[8:11], s82 offen sc1 lds
v_mfma_f32_16x16x32_bf16 v[84:87], v[124:127], v[144:147], v[84:87]
s_add_u32 s82, s82, s83
s_add_u32 m0, s85, 20480
v_mfma_f32_16x16x32_bf16 v[88:91], v[128:131], v[144:147], v[88:91]
buffer_load_dwordx4 v248, s[8:11], s82 offen offset:0 sc1 lds
v_mfma_f32_16x16x32_bf16 v[92:95], v[132:135], v[144:147], v[92:95]
buffer_load_dwordx4 v249, s[8:11], s82 offen offset:1024 sc1 lds
v_mfma_f32_16x16x32_bf16 v[96:99], v[136:139], v[144:147], v[96:99]
s_waitcnt lgkmcnt(4)
v_mfma_f32_16x16x32_bf16 v[0:3], v[100:103], v[148:151], v[0:3]
ds_read_b64_tr_b16 v[120:121], v168 offset:12288
ds_read_b64_tr_b16 v[122:123], v168 offset:17408
ds_read_b64_tr_b16 v[124:125], v171 offset:12320
v_mfma_f32_16x16x32_bf16 v[4:7], v[104:107], v[148:151], v[4:7]
ds_read_b64_tr_b16 v[126:127], v171 offset:17440
ds_read_b64_tr_b16 v[128:129], v168 offset:12352
ds_read_b64_tr_b16 v[130:131], v168 offset:17472
v_mfma_f32_16x16x32_bf16 v[8:11], v[108:111], v[148:151], v[8:11]
ds_read_b64_tr_b16 v[132:133], v171 offset:12384
ds_read_b64_tr_b16 v[134:135], v171 offset:17504
ds_read_b64_tr_b16 v[136:137], v168 offset:12416
v_mfma_f32_16x16x32_bf16 v[12:15], v[112:115], v[148:151], v[12:15]
ds_read_b64_tr_b16 v[138:139], v168 offset:17536
ds_read_b128 v[144:147], v165 offset:12288
v_mfma_f32_16x16x32_bf16 v[16:19], v[116:119], v[148:151], v[16:19]
s_waitcnt lgkmcnt(14)
ds_read_b128 v[148:151], v165 offset:13312
v_mfma_f32_16x16x32_bf16 v[20:23], v[100:103], v[152:155], v[20:23]
buffer_load_dwordx4 v250, s[8:11], s82 offen offset:2048 sc1 lds
v_mfma_f32_16x16x32_bf16 v[24:27], v[104:107], v[152:155], v[24:27]
buffer_load_dwordx4 v251, s[8:11], s82 offen offset:3072 sc1 lds
v_mfma_f32_16x16x32_bf16 v[28:31], v[108:111], v[152:155], v[28:31]
s_add_u32 m0, s85, 24576
v_mfma_f32_16x16x32_bf16 v[32:35], v[112:115], v[152:155], v[32:35]
buffer_load_dwordx4 v254, s[8:11], s82 offen sc1 lds
v_mfma_f32_16x16x32_bf16 v[36:39], v[116:119], v[152:155], v[36:39]
s_waitcnt lgkmcnt(14)
s_add_u32 s82, s82, s83
ds_read_b128 v[152:155], v165 offset:14336
v_mfma_f32_16x16x32_bf16 v[40:43], v[100:103], v[156:159], v[40:43]
buffer_store_dwordx4 v[190:193], v174, s[24:27], s39 offen offset:0 sc1
v_accvgpr_read_b32 v178, a44
v_mfma_f32_16x16x32_bf16 v[44:47], v[104:107], v[156:159], v[44:47]
v_accvgpr_read_b32 v179, a45
v_accvgpr_read_b32 v180, a46
v_accvgpr_read_b32 v181, a47
v_mfma_f32_16x16x32_bf16 v[48:51], v[108:111], v[156:159], v[48:51]
v_mul_f32 v178, v221, v178
v_mul_f32 v179, v221, v179
v_mul_f32 v180, v221, v180
v_mfma_f32_16x16x32_bf16 v[52:55], v[112:115], v[156:159], v[52:55]
v_mul_f32 v181, v221, v181
v_cvt_pk_bf16_f32 v186, v178, v179
v_cvt_pk_bf16_f32 v187, v180, v181
v_mfma_f32_16x16x32_bf16 v[56:59], v[116:119], v[156:159], v[56:59]
s_waitcnt lgkmcnt(14)
ds_read_b128 v[156:159], v165 offset:15360
v_accvgpr_read_b32 v182, a64
v_accvgpr_read_b32 v183, a65
v_mfma_f32_16x16x32_bf16 v[60:63], v[100:103], v[160:163], v[60:63]
v_accvgpr_read_b32 v184, a66
v_accvgpr_read_b32 v185, a67
v_mul_f32 v182, v221, v182
v_mfma_f32_16x16x32_bf16 v[64:67], v[104:107], v[160:163], v[64:67]
v_mul_f32 v183, v221, v183
v_mul_f32 v184, v221, v184
v_mul_f32 v185, v221, v185
v_mfma_f32_16x16x32_bf16 v[68:71], v[108:111], v[160:163], v[68:71]
v_cvt_pk_bf16_f32 v188, v182, v183
v_cvt_pk_bf16_f32 v189, v184, v185
v_mfma_f32_16x16x32_bf16 v[72:75], v[112:115], v[160:163], v[72:75]
buffer_store_dwordx4 v[186:189], v174, s[24:27], s39 offen offset:1024 sc1
v_accvgpr_read_b32 v178, a48
v_mfma_f32_16x16x32_bf16 v[76:79], v[116:119], v[160:163], v[76:79]
s_waitcnt lgkmcnt(14)
ds_read_b128 v[160:163], v165 offset:16384
v_accvgpr_read_b32 v179, a49
v_accvgpr_read_b32 v180, a50
v_mfma_f32_16x16x32_bf16 v[80:83], v[100:103], v[140:143], v[80:83]
v_accvgpr_read_b32 v181, a51
v_mul_f32 v178, v222, v178
v_mul_f32 v179, v222, v179
v_mfma_f32_16x16x32_bf16 v[84:87], v[104:107], v[140:143], v[84:87]
v_mul_f32 v180, v222, v180
v_mul_f32 v181, v222, v181
v_cvt_pk_bf16_f32 v190, v178, v179
v_mfma_f32_16x16x32_bf16 v[88:91], v[108:111], v[140:143], v[88:91]
v_cvt_pk_bf16_f32 v191, v180, v181
v_accvgpr_read_b32 v182, a68
v_accvgpr_read_b32 v183, a69
v_mfma_f32_16x16x32_bf16 v[92:95], v[112:115], v[140:143], v[92:95]
v_accvgpr_read_b32 v184, a70
v_accvgpr_read_b32 v185, a71
v_mul_f32 v182, v222, v182
v_mfma_f32_16x16x32_bf16 v[96:99], v[116:119], v[140:143], v[96:99]
s_waitcnt lgkmcnt(4)
v_mul_f32 v183, v222, v183
v_mul_f32 v184, v222, v184
v_mul_f32 v185, v222, v185
v_mfma_f32_16x16x32_bf16 v[0:3], v[120:123], v[144:147], v[0:3]
v_cvt_pk_bf16_f32 v192, v182, v183
v_cvt_pk_bf16_f32 v193, v184, v185
v_mfma_f32_16x16x32_bf16 v[4:7], v[124:127], v[144:147], v[4:7]
buffer_store_dwordx4 v[190:193], v174, s[24:27], s39 offen offset:2048 sc1
v_accvgpr_read_b32 v178, a52
v_mfma_f32_16x16x32_bf16 v[8:11], v[128:131], v[144:147], v[8:11]
v_accvgpr_read_b32 v179, a53
v_accvgpr_read_b32 v180, a54
v_accvgpr_read_b32 v181, a55
v_mfma_f32_16x16x32_bf16 v[12:15], v[132:135], v[144:147], v[12:15]
v_mul_f32 v178, v223, v178
v_mul_f32 v179, v223, v179
v_mul_f32 v180, v223, v180
v_mfma_f32_16x16x32_bf16 v[16:19], v[136:139], v[144:147], v[16:19]
s_waitcnt lgkmcnt(3)
v_mul_f32 v181, v223, v181
v_cvt_pk_bf16_f32 v186, v178, v179
v_cvt_pk_bf16_f32 v187, v180, v181
v_mfma_f32_16x16x32_bf16 v[20:23], v[120:123], v[148:151], v[20:23]
v_accvgpr_read_b32 v182, a72
v_accvgpr_read_b32 v183, a73
v_accvgpr_read_b32 v184, a74
v_mfma_f32_16x16x32_bf16 v[24:27], v[124:127], v[148:151], v[24:27]
v_accvgpr_read_b32 v185, a75
v_mul_f32 v182, v223, v182
v_mul_f32 v183, v223, v183
v_mfma_f32_16x16x32_bf16 v[28:31], v[128:131], v[148:151], v[28:31]
v_mul_f32 v184, v223, v184
v_mul_f32 v185, v223, v185
v_cvt_pk_bf16_f32 v188, v182, v183
v_mfma_f32_16x16x32_bf16 v[32:35], v[132:135], v[148:151], v[32:35]
s_waitcnt vmcnt(21) lgkmcnt(0)
s_barrier
ds_read_b64_tr_b16 v[100:101], v169 offset:20480
ds_read_b64_tr_b16 v[102:103], v169 offset:25600
v_mfma_f32_16x16x32_bf16 v[36:39], v[136:139], v[148:151], v[36:39]
s_waitcnt lgkmcnt(15)
ds_read_b64_tr_b16 v[104:105], v172 offset:20512
ds_read_b64_tr_b16 v[106:107], v172 offset:25632
ds_read_b64_tr_b16 v[108:109], v169 offset:20544
v_mfma_f32_16x16x32_bf16 v[40:43], v[120:123], v[152:155], v[40:43]
s_add_u32 m0, s85, 40960
ds_read_b64_tr_b16 v[110:111], v169 offset:25664
ds_read_b64_tr_b16 v[112:113], v172 offset:20576
ds_read_b64_tr_b16 v[114:115], v172 offset:25696
v_mfma_f32_16x16x32_bf16 v[44:47], v[124:127], v[152:155], v[44:47]
ds_read_b64_tr_b16 v[116:117], v169 offset:20608
ds_read_b64_tr_b16 v[118:119], v169 offset:25728
ds_read_b128 v[140:143], v166 offset:20480
v_mfma_f32_16x16x32_bf16 v[48:51], v[128:131], v[152:155], v[48:51]
ds_read_b128 v[144:147], v166 offset:21504
ds_read_b128 v[148:151], v166 offset:22528
v_cvt_pk_bf16_f32 v189, v184, v185
v_mfma_f32_16x16x32_bf16 v[52:55], v[132:135], v[152:155], v[52:55]
buffer_load_dwordx4 v248, s[8:11], s82 offen offset:0 sc1 lds
v_mfma_f32_16x16x32_bf16 v[56:59], v[136:139], v[152:155], v[56:59]
s_waitcnt lgkmcnt(15)
ds_read_b128 v[152:155], v166 offset:23552
v_mfma_f32_16x16x32_bf16 v[60:63], v[120:123], v[156:159], v[60:63]
buffer_load_dwordx4 v249, s[8:11], s82 offen offset:1024 sc1 lds
v_mfma_f32_16x16x32_bf16 v[64:67], v[124:127], v[156:159], v[64:67]
buffer_load_dwordx4 v250, s[8:11], s82 offen offset:2048 sc1 lds
v_mfma_f32_16x16x32_bf16 v[68:71], v[128:131], v[156:159], v[68:71]
buffer_load_dwordx4 v251, s[8:11], s82 offen offset:3072 sc1 lds
v_mfma_f32_16x16x32_bf16 v[72:75], v[132:135], v[156:159], v[72:75]
s_add_u32 m0, s85, 45056
v_mfma_f32_16x16x32_bf16 v[76:79], v[136:139], v[156:159], v[76:79]
s_waitcnt lgkmcnt(15)
ds_read_b128 v[156:159], v166 offset:24576
v_mfma_f32_16x16x32_bf16 v[80:83], v[120:123], v[160:163], v[80:83]
buffer_load_dwordx4 v254, s[8:11], s82 offen sc1 lds
v_mfma_f32_16x16x32_bf16 v[84:87], v[124:127], v[160:163], v[84:87]
s_add_u32 s66, s66, 1
s_and_b32 s66, s66, 3
s_mul_i32 s40, s66, 24
s_add_u32 s40, s40, 0
v_mfma_f32_16x16x32_bf16 v[88:91], v[128:131], v[160:163], v[88:91]
s_mul_i32 s40, s40, s83
s_add_u32 s82, s67, s40
s_add_u32 m0, s85, 61440
v_mfma_f32_16x16x32_bf16 v[92:95], v[132:135], v[160:163], v[92:95]
buffer_load_dwordx4 v248, s[8:11], s82 offen offset:0 sc1 lds
v_mfma_f32_16x16x32_bf16 v[96:99], v[136:139], v[160:163], v[96:99]
s_waitcnt lgkmcnt(4)
v_mfma_f32_16x16x32_bf16 v[0:3], v[100:103], v[140:143], v[0:3]
ds_read_b64_tr_b16 v[120:121], v168 offset:40960
ds_read_b64_tr_b16 v[122:123], v168 offset:46080
ds_read_b64_tr_b16 v[124:125], v171 offset:40992
v_mfma_f32_16x16x32_bf16 v[4:7], v[104:107], v[140:143], v[4:7]
ds_read_b64_tr_b16 v[126:127], v171 offset:46112
ds_read_b64_tr_b16 v[128:129], v168 offset:41024
ds_read_b64_tr_b16 v[130:131], v168 offset:46144
v_mfma_f32_16x16x32_bf16 v[8:11], v[108:111], v[140:143], v[8:11]
ds_read_b64_tr_b16 v[132:133], v171 offset:41056
ds_read_b64_tr_b16 v[134:135], v171 offset:46176
ds_read_b64_tr_b16 v[136:137], v168 offset:41088
v_mfma_f32_16x16x32_bf16 v[12:15], v[112:115], v[140:143], v[12:15]
ds_read_b64_tr_b16 v[138:139], v168 offset:46208
ds_read_b128 v[160:163], v165 offset:40960
v_mfma_f32_16x16x32_bf16 v[16:19], v[116:119], v[140:143], v[16:19]
s_waitcnt lgkmcnt(14)
ds_read_b128 v[140:143], v165 offset:41984
v_mfma_f32_16x16x32_bf16 v[20:23], v[100:103], v[144:147], v[20:23]
buffer_load_dwordx4 v249, s[8:11], s82 offen offset:1024 sc1 lds
v_mfma_f32_16x16x32_bf16 v[24:27], v[104:107], v[144:147], v[24:27]
buffer_load_dwordx4 v250, s[8:11], s82 offen offset:2048 sc1 lds
v_mfma_f32_16x16x32_bf16 v[28:31], v[108:111], v[144:147], v[28:31]
buffer_load_dwordx4 v251, s[8:11], s82 offen offset:3072 sc1 lds
v_mfma_f32_16x16x32_bf16 v[32:35], v[112:115], v[144:147], v[32:35]
s_add_u32 m0, s85, 65536
v_mfma_f32_16x16x32_bf16 v[36:39], v[116:119], v[144:147], v[36:39]
s_waitcnt lgkmcnt(14)
ds_read_b128 v[144:147], v165 offset:43008
v_mfma_f32_16x16x32_bf16 v[40:43], v[100:103], v[148:151], v[40:43]
buffer_load_dwordx4 v254, s[8:11], s82 offen sc1 lds
v_mfma_f32_16x16x32_bf16 v[44:47], v[104:107], v[148:151], v[44:47]
s_add_u32 s82, s82, s83
s_add_u32 m0, s85, 81920
v_mfma_f32_16x16x32_bf16 v[48:51], v[108:111], v[148:151], v[48:51]
buffer_load_dwordx4 v248, s[8:11], s82 offen offset:0 sc1 lds
v_mfma_f32_16x16x32_bf16 v[52:55], v[112:115], v[148:151], v[52:55]
buffer_load_dwordx4 v249, s[8:11], s82 offen offset:1024 sc1 lds
v_mfma_f32_16x16x32_bf16 v[56:59], v[116:119], v[148:151], v[56:59]
s_waitcnt lgkmcnt(14)
ds_read_b128 v[148:151], v165 offset:44032
v_mfma_f32_16x16x32_bf16 v[60:63], v[100:103], v[152:155], v[60:63]
buffer_load_dwordx4 v250, s[8:11], s82 offen offset:2048 sc1 lds
v_mfma_f32_16x16x32_bf16 v[64:67], v[104:107], v[152:155], v[64:67]
buffer_load_dwordx4 v251, s[8:11], s82 offen offset:3072 sc1 lds
v_mfma_f32_16x16x32_bf16 v[68:71], v[108:111], v[152:155], v[68:71]
s_add_u32 m0, s85, 86016
v_mfma_f32_16x16x32_bf16 v[72:75], v[112:115], v[152:155], v[72:75]
buffer_load_dwordx4 v254, s[8:11], s82 offen sc1 lds
v_mfma_f32_16x16x32_bf16 v[76:79], v[116:119], v[152:155], v[76:79]
s_waitcnt lgkmcnt(14)
s_add_u32 s82, s82, s83
ds_read_b128 v[152:155], v165 offset:45056
v_mfma_f32_16x16x32_bf16 v[80:83], v[100:103], v[156:159], v[80:83]
buffer_store_dwordx4 v[186:189], v174, s[24:27], s39 offen offset:3072 sc1
v_accvgpr_read_b32 v178, a56
v_mfma_f32_16x16x32_bf16 v[84:87], v[104:107], v[156:159], v[84:87]
v_accvgpr_read_b32 v179, a57
v_accvgpr_read_b32 v180, a58
v_accvgpr_read_b32 v181, a59
v_mfma_f32_16x16x32_bf16 v[88:91], v[108:111], v[156:159], v[88:91]
v_mul_f32 v178, v224, v178
v_mul_f32 v179, v224, v179
v_mul_f32 v180, v224, v180
v_mfma_f32_16x16x32_bf16 v[92:95], v[112:115], v[156:159], v[92:95]
v_mul_f32 v181, v224, v181
v_cvt_pk_bf16_f32 v190, v178, v179
v_cvt_pk_bf16_f32 v191, v180, v181
v_mfma_f32_16x16x32_bf16 v[96:99], v[116:119], v[156:159], v[96:99]
s_waitcnt lgkmcnt(4)
v_accvgpr_read_b32 v182, a76
v_accvgpr_read_b32 v183, a77
v_accvgpr_read_b32 v184, a78
v_mfma_f32_16x16x32_bf16 v[0:3], v[120:123], v[160:163], v[0:3]
v_accvgpr_read_b32 v185, a79
v_mul_f32 v182, v224, v182
v_mul_f32 v183, v224, v183
v_mfma_f32_16x16x32_bf16 v[4:7], v[124:127], v[160:163], v[4:7]
v_mul_f32 v184, v224, v184
v_mul_f32 v185, v224, v185
v_cvt_pk_bf16_f32 v192, v182, v183
v_mfma_f32_16x16x32_bf16 v[8:11], v[128:131], v[160:163], v[8:11]
v_cvt_pk_bf16_f32 v193, v184, v185
v_mfma_f32_16x16x32_bf16 v[12:15], v[132:135], v[160:163], v[12:15]
buffer_store_dwordx4 v[190:193], v175, s[24:27], s39 offen sc1
v_accvgpr_read_b32 v178, a80
v_mfma_f32_16x16x32_bf16 v[16:19], v[136:139], v[160:163], v[16:19]
s_waitcnt lgkmcnt(3)
v_accvgpr_read_b32 v179, a81
v_accvgpr_read_b32 v180, a82
v_accvgpr_read_b32 v181, a83
v_mfma_f32_16x16x32_bf16 v[20:23], v[120:123], v[140:143], v[20:23]
v_mul_f32 v178, v220, v178
v_mul_f32 v179, v220, v179
v_mul_f32 v180, v220, v180
v_mfma_f32_16x16x32_bf16 v[24:27], v[124:127], v[140:143], v[24:27]
v_mul_f32 v181, v220, v181
v_cvt_pk_bf16_f32 v186, v178, v179
v_cvt_pk_bf16_f32 v187, v180, v181
v_mfma_f32_16x16x32_bf16 v[28:31], v[128:131], v[140:143], v[28:31]
v_accvgpr_read_b32 v182, a100
v_accvgpr_read_b32 v183, a101
v_accvgpr_read_b32 v184, a102
v_mfma_f32_16x16x32_bf16 v[32:35], v[132:135], v[140:143], v[32:35]
s_waitcnt vmcnt(25) lgkmcnt(0)
s_barrier
ds_read_b64_tr_b16 v[100:101], v169 offset:0
ds_read_b64_tr_b16 v[102:103], v169 offset:5120
v_mfma_f32_16x16x32_bf16 v[36:39], v[136:139], v[140:143], v[36:39]
s_waitcnt lgkmcnt(15)
ds_read_b64_tr_b16 v[104:105], v172 offset:32
ds_read_b64_tr_b16 v[106:107], v172 offset:5152
ds_read_b64_tr_b16 v[108:109], v169 offset:64
v_mfma_f32_16x16x32_bf16 v[40:43], v[120:123], v[144:147], v[40:43]
s_add_u32 m0, s85, 102400
ds_read_b64_tr_b16 v[110:111], v169 offset:5184
ds_read_b64_tr_b16 v[112:113], v172 offset:96
ds_read_b64_tr_b16 v[114:115], v172 offset:5216
v_mfma_f32_16x16x32_bf16 v[44:47], v[124:127], v[144:147], v[44:47]
ds_read_b64_tr_b16 v[116:117], v169 offset:128
ds_read_b64_tr_b16 v[118:119], v169 offset:5248
ds_read_b128 v[156:159], v166 offset:0
v_mfma_f32_16x16x32_bf16 v[48:51], v[128:131], v[144:147], v[48:51]
ds_read_b128 v[160:163], v166 offset:1024
ds_read_b128 v[140:143], v166 offset:2048
v_accvgpr_read_b32 v185, a103
v_mfma_f32_16x16x32_bf16 v[52:55], v[132:135], v[144:147], v[52:55]
buffer_load_dwordx4 v248, s[8:11], s82 offen offset:0 sc1 lds
v_mul_f32 v182, v220, v182
v_mfma_f32_16x16x32_bf16 v[56:59], v[136:139], v[144:147], v[56:59]
s_waitcnt lgkmcnt(15)
ds_read_b128 v[144:147], v166 offset:3072
v_mul_f32 v183, v220, v183
v_mul_f32 v184, v220, v184
v_mfma_f32_16x16x32_bf16 v[60:63], v[120:123], v[148:151], v[60:63]
buffer_load_dwordx4 v249, s[8:11], s82 offen offset:1024 sc1 lds
v_mul_f32 v185, v220, v185
v_mfma_f32_16x16x32_bf16 v[64:67], v[124:127], v[148:151], v[64:67]
buffer_load_dwordx4 v250, s[8:11], s82 offen offset:2048 sc1 lds
v_cvt_pk_bf16_f32 v188, v182, v183
v_mfma_f32_16x16x32_bf16 v[68:71], v[128:131], v[148:151], v[68:71]
buffer_load_dwordx4 v251, s[8:11], s82 offen offset:3072 sc1 lds
v_cvt_pk_bf16_f32 v189, v184, v185
v_mfma_f32_16x16x32_bf16 v[72:75], v[132:135], v[148:151], v[72:75]
s_add_u32 m0, s85, 106496
s_add_u32 s39, s47, 20480
v_mfma_f32_16x16x32_bf16 v[76:79], v[136:139], v[148:151], v[76:79]
s_waitcnt lgkmcnt(15)
ds_read_b128 v[148:151], v166 offset:4096
v_mfma_f32_16x16x32_bf16 v[80:83], v[120:123], v[152:155], v[80:83]
buffer_load_dwordx4 v254, s[8:11], s82 offen sc1 lds
v_mfma_f32_16x16x32_bf16 v[84:87], v[124:127], v[152:155], v[84:87]
s_add_u32 s82, s82, s83
s_add_u32 m0, s85, 143360
v_mfma_f32_16x16x32_bf16 v[88:91], v[128:131], v[152:155], v[88:91]
buffer_load_dwordx4 v248, s[8:11], s82 offen offset:0 sc1 lds
v_mfma_f32_16x16x32_bf16 v[92:95], v[132:135], v[152:155], v[92:95]
buffer_load_dwordx4 v249, s[8:11], s82 offen offset:1024 sc1 lds
v_mfma_f32_16x16x32_bf16 v[96:99], v[136:139], v[152:155], v[96:99]
s_waitcnt lgkmcnt(4)
v_mfma_f32_16x16x32_bf16 v[0:3], v[100:103], v[156:159], v[0:3]
ds_read_b64_tr_b16 v[120:121], v167 offset:0
ds_read_b64_tr_b16 v[122:123], v167 offset:5120
ds_read_b64_tr_b16 v[124:125], v170 offset:32
v_mfma_f32_16x16x32_bf16 v[4:7], v[104:107], v[156:159], v[4:7]
ds_read_b64_tr_b16 v[126:127], v170 offset:5152
ds_read_b64_tr_b16 v[128:129], v167 offset:64
ds_read_b64_tr_b16 v[130:131], v167 offset:5184
v_mfma_f32_16x16x32_bf16 v[8:11], v[108:111], v[156:159], v[8:11]
ds_read_b64_tr_b16 v[132:133], v170 offset:96
ds_read_b64_tr_b16 v[134:135], v170 offset:5216
ds_read_b64_tr_b16 v[136:137], v167 offset:128
v_mfma_f32_16x16x32_bf16 v[12:15], v[112:115], v[156:159], v[12:15]
ds_read_b64_tr_b16 v[138:139], v167 offset:5248
ds_read_b128 v[152:155], v164 offset:0
v_mfma_f32_16x16x32_bf16 v[16:19], v[116:119], v[156:159], v[16:19]
s_waitcnt lgkmcnt(14)
ds_read_b128 v[156:159], v164 offset:1024
v_mfma_f32_16x16x32_bf16 v[20:23], v[100:103], v[160:163], v[20:23]
buffer_load_dwordx4 v250, s[8:11], s82 offen offset:2048 sc1 lds
v_mfma_f32_16x16x32_bf16 v[24:27], v[104:107], v[160:163], v[24:27]
buffer_load_dwordx4 v251, s[8:11], s82 offen offset:3072 sc1 lds
v_mfma_f32_16x16x32_bf16 v[28:31], v[108:111], v[160:163], v[28:31]
s_add_u32 m0, s85, 147456
v_mfma_f32_16x16x32_bf16 v[32:35], v[112:115], v[160:163], v[32:35]
buffer_load_dwordx4 v254, s[8:11], s82 offen sc1 lds
v_mfma_f32_16x16x32_bf16 v[36:39], v[116:119], v[160:163], v[36:39]
s_waitcnt lgkmcnt(14)
s_add_u32 s82, s82, s83
ds_read_b128 v[160:163], v164 offset:2048
v_mfma_f32_16x16x32_bf16 v[40:43], v[100:103], v[140:143], v[40:43]
buffer_store_dwordx4 v[186:189], v174, s[24:27], s39 offen offset:0 sc1
v_accvgpr_read_b32 v178, a84
v_mfma_f32_16x16x32_bf16 v[44:47], v[104:107], v[140:143], v[44:47]
v_accvgpr_read_b32 v179, a85
v_accvgpr_read_b32 v180, a86
v_accvgpr_read_b32 v181, a87
v_mfma_f32_16x16x32_bf16 v[48:51], v[108:111], v[140:143], v[48:51]
v_mul_f32 v178, v221, v178
v_mul_f32 v179, v221, v179
v_mul_f32 v180, v221, v180
v_mfma_f32_16x16x32_bf16 v[52:55], v[112:115], v[140:143], v[52:55]
v_mul_f32 v181, v221, v181
v_cvt_pk_bf16_f32 v190, v178, v179
v_cvt_pk_bf16_f32 v191, v180, v181
v_mfma_f32_16x16x32_bf16 v[56:59], v[116:119], v[140:143], v[56:59]
s_waitcnt lgkmcnt(14)
ds_read_b128 v[140:143], v164 offset:3072
v_accvgpr_read_b32 v182, a104
v_accvgpr_read_b32 v183, a105
v_mfma_f32_16x16x32_bf16 v[60:63], v[100:103], v[144:147], v[60:63]
v_accvgpr_read_b32 v184, a106
v_accvgpr_read_b32 v185, a107
v_mul_f32 v182, v221, v182
v_mfma_f32_16x16x32_bf16 v[64:67], v[104:107], v[144:147], v[64:67]
v_mul_f32 v183, v221, v183
v_mul_f32 v184, v221, v184
v_mul_f32 v185, v221, v185
v_mfma_f32_16x16x32_bf16 v[68:71], v[108:111], v[144:147], v[68:71]
v_cvt_pk_bf16_f32 v192, v182, v183
v_cvt_pk_bf16_f32 v193, v184, v185
v_mfma_f32_16x16x32_bf16 v[72:75], v[112:115], v[144:147], v[72:75]
buffer_store_dwordx4 v[190:193], v174, s[24:27], s39 offen offset:1024 sc1
v_accvgpr_read_b32 v178, a88
v_mfma_f32_16x16x32_bf16 v[76:79], v[116:119], v[144:147], v[76:79]
s_waitcnt lgkmcnt(14)
ds_read_b128 v[144:147], v164 offset:4096
v_accvgpr_read_b32 v179, a89
v_accvgpr_read_b32 v180, a90
v_mfma_f32_16x16x32_bf16 v[80:83], v[100:103], v[148:151], v[80:83]
v_accvgpr_read_b32 v181, a91
v_mul_f32 v178, v222, v178
v_mul_f32 v179, v222, v179
v_mfma_f32_16x16x32_bf16 v[84:87], v[104:107], v[148:151], v[84:87]
v_mul_f32 v180, v222, v180
v_mul_f32 v181, v222, v181
v_cvt_pk_bf16_f32 v186, v178, v179
v_mfma_f32_16x16x32_bf16 v[88:91], v[108:111], v[148:151], v[88:91]
v_cvt_pk_bf16_f32 v187, v180, v181
v_accvgpr_read_b32 v182, a108
v_accvgpr_read_b32 v183, a109
v_mfma_f32_16x16x32_bf16 v[92:95], v[112:115], v[148:151], v[92:95]
v_accvgpr_read_b32 v184, a110
v_accvgpr_read_b32 v185, a111
v_mul_f32 v182, v222, v182
v_mfma_f32_16x16x32_bf16 v[96:99], v[116:119], v[148:151], v[96:99]
s_waitcnt lgkmcnt(4)
v_mul_f32 v183, v222, v183
v_mul_f32 v184, v222, v184
v_mul_f32 v185, v222, v185
v_mfma_f32_16x16x32_bf16 v[0:3], v[120:123], v[152:155], v[0:3]
v_cvt_pk_bf16_f32 v188, v182, v183
v_cvt_pk_bf16_f32 v189, v184, v185
v_mfma_f32_16x16x32_bf16 v[4:7], v[124:127], v[152:155], v[4:7]
buffer_store_dwordx4 v[186:189], v174, s[24:27], s39 offen offset:2048 sc1
v_accvgpr_read_b32 v178, a92
v_mfma_f32_16x16x32_bf16 v[8:11], v[128:131], v[152:155], v[8:11]
v_accvgpr_read_b32 v179, a93
v_accvgpr_read_b32 v180, a94
v_accvgpr_read_b32 v181, a95
v_mfma_f32_16x16x32_bf16 v[12:15], v[132:135], v[152:155], v[12:15]
v_mul_f32 v178, v223, v178
v_mul_f32 v179, v223, v179
v_mul_f32 v180, v223, v180
v_mfma_f32_16x16x32_bf16 v[16:19], v[136:139], v[152:155], v[16:19]
s_waitcnt lgkmcnt(3)
v_mul_f32 v181, v223, v181
v_cvt_pk_bf16_f32 v190, v178, v179
v_cvt_pk_bf16_f32 v191, v180, v181
v_mfma_f32_16x16x32_bf16 v[20:23], v[120:123], v[156:159], v[20:23]
v_accvgpr_read_b32 v182, a112
v_accvgpr_read_b32 v183, a113
v_accvgpr_read_b32 v184, a114
v_mfma_f32_16x16x32_bf16 v[24:27], v[124:127], v[156:159], v[24:27]
v_accvgpr_read_b32 v185, a115
v_mul_f32 v182, v223, v182
v_mul_f32 v183, v223, v183
v_mfma_f32_16x16x32_bf16 v[28:31], v[128:131], v[156:159], v[28:31]
v_mul_f32 v184, v223, v184
v_mul_f32 v185, v223, v185
v_cvt_pk_bf16_f32 v192, v182, v183
v_mfma_f32_16x16x32_bf16 v[32:35], v[132:135], v[156:159], v[32:35]
s_waitcnt vmcnt(25) lgkmcnt(0)
s_barrier
ds_read_b64_tr_b16 v[100:101], v167 offset:20480
ds_read_b64_tr_b16 v[102:103], v167 offset:25600
v_mfma_f32_16x16x32_bf16 v[36:39], v[136:139], v[156:159], v[36:39]
s_waitcnt lgkmcnt(15)
ds_read_b64_tr_b16 v[104:105], v170 offset:20512
ds_read_b64_tr_b16 v[106:107], v170 offset:25632
ds_read_b64_tr_b16 v[108:109], v167 offset:20544
v_mfma_f32_16x16x32_bf16 v[40:43], v[120:123], v[160:163], v[40:43]
s_add_u32 m0, s85, 0
ds_read_b64_tr_b16 v[110:111], v167 offset:25664
ds_read_b64_tr_b16 v[112:113], v170 offset:20576
ds_read_b64_tr_b16 v[114:115], v170 offset:25696
v_mfma_f32_16x16x32_bf16 v[44:47], v[124:127], v[160:163], v[44:47]
ds_read_b64_tr_b16 v[116:117], v167 offset:20608
ds_read_b64_tr_b16 v[118:119], v167 offset:25728
ds_read_b128 v[148:151], v164 offset:20480
v_mfma_f32_16x16x32_bf16 v[48:51], v[128:131], v[160:163], v[48:51]
ds_read_b128 v[152:155], v164 offset:21504
ds_read_b128 v[156:159], v164 offset:22528
v_cvt_pk_bf16_f32 v193, v184, v185
v_mfma_f32_16x16x32_bf16 v[52:55], v[132:135], v[160:163], v[52:55]
buffer_load_dwordx4 v248, s[8:11], s82 offen offset:0 sc1 lds
v_mfma_f32_16x16x32_bf16 v[56:59], v[136:139], v[160:163], v[56:59]
s_waitcnt lgkmcnt(15)
ds_read_b128 v[160:163], v164 offset:23552
v_mfma_f32_16x16x32_bf16 v[60:63], v[120:123], v[140:143], v[60:63]
buffer_load_dwordx4 v249, s[8:11], s82 offen offset:1024 sc1 lds
v_mfma_f32_16x16x32_bf16 v[64:67], v[124:127], v[140:143], v[64:67]
buffer_load_dwordx4 v250, s[8:11], s82 offen offset:2048 sc1 lds
v_mfma_f32_16x16x32_bf16 v[68:71], v[128:131], v[140:143], v[68:71]
buffer_load_dwordx4 v251, s[8:11], s82 offen offset:3072 sc1 lds
v_mfma_f32_16x16x32_bf16 v[72:75], v[132:135], v[140:143], v[72:75]
s_add_u32 m0, s85, 4096
v_mfma_f32_16x16x32_bf16 v[76:79], v[136:139], v[140:143], v[76:79]
s_waitcnt lgkmcnt(15)
ds_read_b128 v[140:143], v164 offset:24576
v_mfma_f32_16x16x32_bf16 v[80:83], v[120:123], v[144:147], v[80:83]
buffer_load_dwordx4 v254, s[8:11], s82 offen sc1 lds
v_mfma_f32_16x16x32_bf16 v[84:87], v[124:127], v[144:147], v[84:87]
s_add_u32 s82, s82, s83
s_add_u32 m0, s85, 122880
v_mfma_f32_16x16x32_bf16 v[88:91], v[128:131], v[144:147], v[88:91]
buffer_load_dwordx4 v248, s[8:11], s82 offen offset:0 sc1 lds
v_mfma_f32_16x16x32_bf16 v[92:95], v[132:135], v[144:147], v[92:95]
buffer_load_dwordx4 v249, s[8:11], s82 offen offset:1024 sc1 lds
v_mfma_f32_16x16x32_bf16 v[96:99], v[136:139], v[144:147], v[96:99]
s_waitcnt lgkmcnt(4)
v_mfma_f32_16x16x32_bf16 v[0:3], v[100:103], v[148:151], v[0:3]
ds_read_b64_tr_b16 v[120:121], v167 offset:40960
ds_read_b64_tr_b16 v[122:123], v167 offset:46080
ds_read_b64_tr_b16 v[124:125], v170 offset:40992
v_mfma_f32_16x16x32_bf16 v[4:7], v[104:107], v[148:151], v[4:7]
ds_read_b64_tr_b16 v[126:127], v170 offset:46112
ds_read_b64_tr_b16 v[128:129], v167 offset:41024
ds_read_b64_tr_b16 v[130:131], v167 offset:46144
v_mfma_f32_16x16x32_bf16 v[8:11], v[108:111], v[148:151], v[8:11]
ds_read_b64_tr_b16 v[132:133], v170 offset:41056
ds_read_b64_tr_b16 v[134:135], v170 offset:46176
ds_read_b64_tr_b16 v[136:137], v167 offset:41088
v_mfma_f32_16x16x32_bf16 v[12:15], v[112:115], v[148:151], v[12:15]
ds_read_b64_tr_b16 v[138:139], v167 offset:46208
ds_read_b128 v[144:147], v164 offset:40960
v_mfma_f32_16x16x32_bf16 v[16:19], v[116:119], v[148:151], v[16:19]
s_waitcnt lgkmcnt(14)
ds_read_b128 v[148:151], v164 offset:41984
v_mfma_f32_16x16x32_bf16 v[20:23], v[100:103], v[152:155], v[20:23]
buffer_load_dwordx4 v250, s[8:11], s82 offen offset:2048 sc1 lds
v_mfma_f32_16x16x32_bf16 v[24:27], v[104:107], v[152:155], v[24:27]
buffer_load_dwordx4 v251, s[8:11], s82 offen offset:3072 sc1 lds
v_mfma_f32_16x16x32_bf16 v[28:31], v[108:111], v[152:155], v[28:31]
s_add_u32 m0, s85, 126976
v_mfma_f32_16x16x32_bf16 v[32:35], v[112:115], v[152:155], v[32:35]
buffer_load_dwordx4 v254, s[8:11], s82 offen sc1 lds
v_mfma_f32_16x16x32_bf16 v[36:39], v[116:119], v[152:155], v[36:39]
s_waitcnt lgkmcnt(14)
s_add_u32 s82, s82, s83
ds_read_b128 v[152:155], v164 offset:43008
v_mfma_f32_16x16x32_bf16 v[40:43], v[100:103], v[156:159], v[40:43]
buffer_store_dwordx4 v[190:193], v174, s[24:27], s39 offen offset:3072 sc1
v_accvgpr_read_b32 v178, a96
v_mfma_f32_16x16x32_bf16 v[44:47], v[104:107], v[156:159], v[44:47]
v_accvgpr_read_b32 v179, a97
v_accvgpr_read_b32 v180, a98
v_accvgpr_read_b32 v181, a99
v_mfma_f32_16x16x32_bf16 v[48:51], v[108:111], v[156:159], v[48:51]
v_mul_f32 v178, v224, v178
v_mul_f32 v179, v224, v179
v_mul_f32 v180, v224, v180
v_mfma_f32_16x16x32_bf16 v[52:55], v[112:115], v[156:159], v[52:55]
v_mul_f32 v181, v224, v181
v_cvt_pk_bf16_f32 v186, v178, v179
v_cvt_pk_bf16_f32 v187, v180, v181
v_mfma_f32_16x16x32_bf16 v[56:59], v[116:119], v[156:159], v[56:59]
s_waitcnt lgkmcnt(14)
ds_read_b128 v[156:159], v164 offset:44032
v_accvgpr_read_b32 v182, a116
v_accvgpr_read_b32 v183, a117
v_mfma_f32_16x16x32_bf16 v[60:63], v[100:103], v[160:163], v[60:63]
v_accvgpr_read_b32 v184, a118
v_accvgpr_read_b32 v185, a119
v_mul_f32 v182, v224, v182
v_mfma_f32_16x16x32_bf16 v[64:67], v[104:107], v[160:163], v[64:67]
v_mul_f32 v183, v224, v183
v_mul_f32 v184, v224, v184
v_mul_f32 v185, v224, v185
v_mfma_f32_16x16x32_bf16 v[68:71], v[108:111], v[160:163], v[68:71]
v_cvt_pk_bf16_f32 v188, v182, v183
v_cvt_pk_bf16_f32 v189, v184, v185
v_mfma_f32_16x16x32_bf16 v[72:75], v[112:115], v[160:163], v[72:75]
buffer_store_dwordx4 v[186:189], v175, s[24:27], s39 offen sc1
v_accvgpr_read_b32 v178, a120
v_mfma_f32_16x16x32_bf16 v[76:79], v[116:119], v[160:163], v[76:79]
s_waitcnt lgkmcnt(14)
ds_read_b128 v[160:163], v164 offset:45056
v_accvgpr_read_b32 v179, a121
v_accvgpr_read_b32 v180, a122
v_mfma_f32_16x16x32_bf16 v[80:83], v[100:103], v[140:143], v[80:83]
v_accvgpr_read_b32 v181, a123
v_mul_f32 v178, v220, v178
v_mul_f32 v179, v220, v179
v_mfma_f32_16x16x32_bf16 v[84:87], v[104:107], v[140:143], v[84:87]
v_mul_f32 v180, v220, v180
v_mul_f32 v181, v220, v181
v_cvt_pk_bf16_f32 v190, v178, v179
v_mfma_f32_16x16x32_bf16 v[88:91], v[108:111], v[140:143], v[88:91]
v_cvt_pk_bf16_f32 v191, v180, v181
v_accvgpr_read_b32 v182, a140
v_accvgpr_read_b32 v183, a141
v_mfma_f32_16x16x32_bf16 v[92:95], v[112:115], v[140:143], v[92:95]
v_accvgpr_read_b32 v184, a142
v_accvgpr_read_b32 v185, a143
v_mul_f32 v182, v220, v182
v_mfma_f32_16x16x32_bf16 v[96:99], v[116:119], v[140:143], v[96:99]
s_waitcnt lgkmcnt(4)
v_mul_f32 v183, v220, v183
v_mul_f32 v184, v220, v184
v_mul_f32 v185, v220, v185
v_mfma_f32_16x16x32_bf16 v[0:3], v[120:123], v[144:147], v[0:3]
v_cvt_pk_bf16_f32 v192, v182, v183
v_cvt_pk_bf16_f32 v193, v184, v185
v_mfma_f32_16x16x32_bf16 v[4:7], v[124:127], v[144:147], v[4:7]
s_add_u32 s39, s47, 30720
v_mfma_f32_16x16x32_bf16 v[8:11], v[128:131], v[144:147], v[8:11]
buffer_store_dwordx4 v[190:193], v174, s[24:27], s39 offen offset:0 sc1
v_accvgpr_read_b32 v178, a124
v_mfma_f32_16x16x32_bf16 v[12:15], v[132:135], v[144:147], v[12:15]
v_accvgpr_read_b32 v179, a125
v_accvgpr_read_b32 v180, a126
v_accvgpr_read_b32 v181, a127
v_mfma_f32_16x16x32_bf16 v[16:19], v[136:139], v[144:147], v[16:19]
s_waitcnt lgkmcnt(3)
v_mul_f32 v178, v221, v178
v_mul_f32 v179, v221, v179
v_mul_f32 v180, v221, v180
v_mfma_f32_16x16x32_bf16 v[20:23], v[120:123], v[148:151], v[20:23]
v_mul_f32 v181, v221, v181
v_cvt_pk_bf16_f32 v186, v178, v179
v_cvt_pk_bf16_f32 v187, v180, v181
v_mfma_f32_16x16x32_bf16 v[24:27], v[124:127], v[148:151], v[24:27]
v_accvgpr_read_b32 v182, a144
v_accvgpr_read_b32 v183, a145
v_accvgpr_read_b32 v184, a146
v_mfma_f32_16x16x32_bf16 v[28:31], v[128:131], v[148:151], v[28:31]
v_accvgpr_read_b32 v185, a147
v_mul_f32 v182, v221, v182
v_mul_f32 v183, v221, v183
v_mfma_f32_16x16x32_bf16 v[32:35], v[132:135], v[148:151], v[32:35]
s_waitcnt vmcnt(28) lgkmcnt(0)
s_barrier
ds_read_b64_tr_b16 v[100:101], v168 offset:0
ds_read_b64_tr_b16 v[102:103], v168 offset:5120
v_mfma_f32_16x16x32_bf16 v[36:39], v[136:139], v[148:151], v[36:39]
s_waitcnt lgkmcnt(15)
ds_read_b64_tr_b16 v[104:105], v171 offset:32
ds_read_b64_tr_b16 v[106:107], v171 offset:5152
ds_read_b64_tr_b16 v[108:109], v168 offset:64
v_mfma_f32_16x16x32_bf16 v[40:43], v[120:123], v[152:155], v[40:43]
s_add_u32 m0, s85, 20480
ds_read_b64_tr_b16 v[110:111], v168 offset:5184
ds_read_b64_tr_b16 v[112:113], v171 offset:96
ds_read_b64_tr_b16 v[114:115], v171 offset:5216
v_mfma_f32_16x16x32_bf16 v[44:47], v[124:127], v[152:155], v[44:47]
ds_read_b64_tr_b16 v[116:117], v168 offset:128
ds_read_b64_tr_b16 v[118:119], v168 offset:5248
ds_read_b128 v[140:143], v165 offset:0
v_mfma_f32_16x16x32_bf16 v[48:51], v[128:131], v[152:155], v[48:51]
ds_read_b128 v[144:147], v165 offset:1024
ds_read_b128 v[148:151], v165 offset:2048
v_mul_f32 v184, v221, v184
v_mfma_f32_16x16x32_bf16 v[52:55], v[132:135], v[152:155], v[52:55]
buffer_load_dwordx4 v248, s[8:11], s82 offen offset:0 sc1 lds
v_mul_f32 v185, v221, v185
v_mfma_f32_16x16x32_bf16 v[56:59], v[136:139], v[152:155], v[56:59]
s_waitcnt lgkmcnt(15)
ds_read_b128 v[152:155], v165 offset:3072
v_cvt_pk_bf16_f32 v188, v182, v183
v_cvt_pk_bf16_f32 v189, v184, v185
v_mfma_f32_16x16x32_bf16 v[60:63], v[120:123], v[156:159], v[60:63]
buffer_load_dwordx4 v249, s[8:11], s82 offen offset:1024 sc1 lds
v_mfma_f32_16x16x32_bf16 v[64:67], v[124:127], v[156:159], v[64:67]
buffer_load_dwordx4 v250, s[8:11], s82 offen offset:2048 sc1 lds
v_mfma_f32_16x16x32_bf16 v[68:71], v[128:131], v[156:159], v[68:71]
buffer_load_dwordx4 v251, s[8:11], s82 offen offset:3072 sc1 lds
v_mfma_f32_16x16x32_bf16 v[72:75], v[132:135], v[156:159], v[72:75]
s_add_u32 m0, s85, 24576
v_mfma_f32_16x16x32_bf16 v[76:79], v[136:139], v[156:159], v[76:79]
s_waitcnt lgkmcnt(15)
ds_read_b128 v[156:159], v165 offset:4096
v_mfma_f32_16x16x32_bf16 v[80:83], v[120:123], v[160:163], v[80:83]
buffer_load_dwordx4 v254, s[8:11], s82 offen sc1 lds
v_mfma_f32_16x16x32_bf16 v[84:87], v[124:127], v[160:163], v[84:87]
s_add_u32 s82, s82, s83
s_add_u32 m0, s85, 40960
v_mfma_f32_16x16x32_bf16 v[88:91], v[128:131], v[160:163], v[88:91]
buffer_load_dwordx4 v248, s[8:11], s82 offen offset:0 sc1 lds
v_mfma_f32_16x16x32_bf16 v[92:95], v[132:135], v[160:163], v[92:95]
buffer_load_dwordx4 v249, s[8:11], s82 offen offset:1024 sc1 lds
v_mfma_f32_16x16x32_bf16 v[96:99], v[136:139], v[160:163], v[96:99]
s_waitcnt lgkmcnt(4)
v_mfma_f32_16x16x32_bf16 v[0:3], v[100:103], v[140:143], v[0:3]
ds_read_b64_tr_b16 v[120:121], v168 offset:20480
ds_read_b64_tr_b16 v[122:123], v168 offset:25600
ds_read_b64_tr_b16 v[124:125], v171 offset:20512
v_mfma_f32_16x16x32_bf16 v[4:7], v[104:107], v[140:143], v[4:7]
ds_read_b64_tr_b16 v[126:127], v171 offset:25632
ds_read_b64_tr_b16 v[128:129], v168 offset:20544
ds_read_b64_tr_b16 v[130:131], v168 offset:25664
v_mfma_f32_16x16x32_bf16 v[8:11], v[108:111], v[140:143], v[8:11]
ds_read_b64_tr_b16 v[132:133], v171 offset:20576
ds_read_b64_tr_b16 v[134:135], v171 offset:25696
ds_read_b64_tr_b16 v[136:137], v168 offset:20608
v_mfma_f32_16x16x32_bf16 v[12:15], v[112:115], v[140:143], v[12:15]
ds_read_b64_tr_b16 v[138:139], v168 offset:25728
ds_read_b128 v[160:163], v165 offset:20480
v_mfma_f32_16x16x32_bf16 v[16:19], v[116:119], v[140:143], v[16:19]
s_waitcnt lgkmcnt(14)
ds_read_b128 v[140:143], v165 offset:21504
v_mfma_f32_16x16x32_bf16 v[20:23], v[100:103], v[144:147], v[20:23]
buffer_load_dwordx4 v250, s[8:11], s82 offen offset:2048 sc1 lds
v_mfma_f32_16x16x32_bf16 v[24:27], v[104:107], v[144:147], v[24:27]
buffer_load_dwordx4 v251, s[8:11], s82 offen offset:3072 sc1 lds
v_mfma_f32_16x16x32_bf16 v[28:31], v[108:111], v[144:147], v[28:31]
s_add_u32 m0, s85, 45056
v_mfma_f32_16x16x32_bf16 v[32:35], v[112:115], v[144:147], v[32:35]
buffer_load_dwordx4 v254, s[8:11], s82 offen sc1 lds
v_mfma_f32_16x16x32_bf16 v[36:39], v[116:119], v[144:147], v[36:39]
s_waitcnt lgkmcnt(14)
s_add_u32 s82, s82, s83
ds_read_b128 v[144:147], v165 offset:22528
v_mfma_f32_16x16x32_bf16 v[40:43], v[100:103], v[148:151], v[40:43]
buffer_store_dwordx4 v[186:189], v174, s[24:27], s39 offen offset:1024 sc1
v_accvgpr_read_b32 v178, a128
v_mfma_f32_16x16x32_bf16 v[44:47], v[104:107], v[148:151], v[44:47]
v_accvgpr_read_b32 v179, a129
v_accvgpr_read_b32 v180, a130
v_accvgpr_read_b32 v181, a131
v_mfma_f32_16x16x32_bf16 v[48:51], v[108:111], v[148:151], v[48:51]
v_mul_f32 v178, v222, v178
v_mul_f32 v179, v222, v179
v_mul_f32 v180, v222, v180
v_mfma_f32_16x16x32_bf16 v[52:55], v[112:115], v[148:151], v[52:55]
v_mul_f32 v181, v222, v181
v_cvt_pk_bf16_f32 v190, v178, v179
v_cvt_pk_bf16_f32 v191, v180, v181
v_mfma_f32_16x16x32_bf16 v[56:59], v[116:119], v[148:151], v[56:59]
s_waitcnt lgkmcnt(14)
ds_read_b128 v[148:151], v165 offset:23552
v_accvgpr_read_b32 v182, a148
v_accvgpr_read_b32 v183, a149
v_mfma_f32_16x16x32_bf16 v[60:63], v[100:103], v[152:155], v[60:63]
v_accvgpr_read_b32 v184, a150
v_accvgpr_read_b32 v185, a151
v_mul_f32 v182, v222, v182
v_mfma_f32_16x16x32_bf16 v[64:67], v[104:107], v[152:155], v[64:67]
v_mul_f32 v183, v222, v183
v_mul_f32 v184, v222, v184
v_mul_f32 v185, v222, v185
v_mfma_f32_16x16x32_bf16 v[68:71], v[108:111], v[152:155], v[68:71]
v_cvt_pk_bf16_f32 v192, v182, v183
v_cvt_pk_bf16_f32 v193, v184, v185
v_mfma_f32_16x16x32_bf16 v[72:75], v[112:115], v[152:155], v[72:75]
buffer_store_dwordx4 v[190:193], v174, s[24:27], s39 offen offset:2048 sc1
v_accvgpr_read_b32 v178, a132
v_mfma_f32_16x16x32_bf16 v[76:79], v[116:119], v[152:155], v[76:79]
s_waitcnt lgkmcnt(14)
ds_read_b128 v[152:155], v165 offset:24576
v_accvgpr_read_b32 v179, a133
v_accvgpr_read_b32 v180, a134
v_mfma_f32_16x16x32_bf16 v[80:83], v[100:103], v[156:159], v[80:83]
v_accvgpr_read_b32 v181, a135
v_mul_f32 v178, v223, v178
v_mul_f32 v179, v223, v179
v_mfma_f32_16x16x32_bf16 v[84:87], v[104:107], v[156:159], v[84:87]
v_mul_f32 v180, v223, v180
v_mul_f32 v181, v223, v181
v_cvt_pk_bf16_f32 v186, v178, v179
v_mfma_f32_16x16x32_bf16 v[88:91], v[108:111], v[156:159], v[88:91]
v_cvt_pk_bf16_f32 v187, v180, v181
v_accvgpr_read_b32 v182, a152
v_accvgpr_read_b32 v183, a153
v_mfma_f32_16x16x32_bf16 v[92:95], v[112:115], v[156:159], v[92:95]
v_accvgpr_read_b32 v184, a154
v_accvgpr_read_b32 v185, a155
v_mul_f32 v182, v223, v182
v_mfma_f32_16x16x32_bf16 v[96:99], v[116:119], v[156:159], v[96:99]
s_waitcnt lgkmcnt(4)
v_mul_f32 v183, v223, v183
v_mul_f32 v184, v223, v184
v_mul_f32 v185, v223, v185
v_mfma_f32_16x16x32_bf16 v[0:3], v[120:123], v[160:163], v[0:3]
v_cvt_pk_bf16_f32 v188, v182, v183
v_cvt_pk_bf16_f32 v189, v184, v185
v_mfma_f32_16x16x32_bf16 v[4:7], v[124:127], v[160:163], v[4:7]
buffer_store_dwordx4 v[186:189], v174, s[24:27], s39 offen offset:3072 sc1
v_accvgpr_read_b32 v178, a136
v_mfma_f32_16x16x32_bf16 v[8:11], v[128:131], v[160:163], v[8:11]
v_accvgpr_read_b32 v179, a137
v_accvgpr_read_b32 v180, a138
v_accvgpr_read_b32 v181, a139
v_mfma_f32_16x16x32_bf16 v[12:15], v[132:135], v[160:163], v[12:15]
v_mul_f32 v178, v224, v178
v_mul_f32 v179, v224, v179
v_mul_f32 v180, v224, v180
v_mfma_f32_16x16x32_bf16 v[16:19], v[136:139], v[160:163], v[16:19]
s_waitcnt lgkmcnt(3)
v_mul_f32 v181, v224, v181
v_cvt_pk_bf16_f32 v190, v178, v179
v_cvt_pk_bf16_f32 v191, v180, v181
v_mfma_f32_16x16x32_bf16 v[20:23], v[120:123], v[140:143], v[20:23]
v_accvgpr_read_b32 v182, a156
v_accvgpr_read_b32 v183, a157
v_accvgpr_read_b32 v184, a158
v_mfma_f32_16x16x32_bf16 v[24:27], v[124:127], v[140:143], v[24:27]
v_accvgpr_read_b32 v185, a159
v_mul_f32 v182, v224, v182
v_mul_f32 v183, v224, v183
v_mfma_f32_16x16x32_bf16 v[28:31], v[128:131], v[140:143], v[28:31]
v_mul_f32 v184, v224, v184
v_mul_f32 v185, v224, v185
v_cvt_pk_bf16_f32 v192, v182, v183
v_mfma_f32_16x16x32_bf16 v[32:35], v[132:135], v[140:143], v[32:35]
s_waitcnt vmcnt(29) lgkmcnt(0)
s_barrier
ds_read_b64_tr_b16 v[100:101], v168 offset:40960
ds_read_b64_tr_b16 v[102:103], v168 offset:46080
v_mfma_f32_16x16x32_bf16 v[36:39], v[136:139], v[140:143], v[36:39]
s_waitcnt lgkmcnt(15)
ds_read_b64_tr_b16 v[104:105], v171 offset:40992
ds_read_b64_tr_b16 v[106:107], v171 offset:46112
ds_read_b64_tr_b16 v[108:109], v168 offset:41024
v_mfma_f32_16x16x32_bf16 v[40:43], v[120:123], v[144:147], v[40:43]
s_add_u32 m0, s85, 61440
ds_read_b64_tr_b16 v[110:111], v168 offset:46144
ds_read_b64_tr_b16 v[112:113], v171 offset:41056
ds_read_b64_tr_b16 v[114:115], v171 offset:46176
v_mfma_f32_16x16x32_bf16 v[44:47], v[124:127], v[144:147], v[44:47]
ds_read_b64_tr_b16 v[116:117], v168 offset:41088
ds_read_b64_tr_b16 v[118:119], v168 offset:46208
ds_read_b128 v[156:159], v165 offset:40960
v_mfma_f32_16x16x32_bf16 v[48:51], v[128:131], v[144:147], v[48:51]
ds_read_b128 v[160:163], v165 offset:41984
ds_read_b128 v[140:143], v165 offset:43008
v_cvt_pk_bf16_f32 v193, v184, v185
v_mfma_f32_16x16x32_bf16 v[52:55], v[132:135], v[144:147], v[52:55]
buffer_load_dwordx4 v248, s[8:11], s82 offen offset:0 sc1 lds
v_mfma_f32_16x16x32_bf16 v[56:59], v[136:139], v[144:147], v[56:59]
s_waitcnt lgkmcnt(15)
ds_read_b128 v[144:147], v165 offset:44032
v_mfma_f32_16x16x32_bf16 v[60:63], v[120:123], v[148:151], v[60:63]
buffer_load_dwordx4 v249, s[8:11], s82 offen offset:1024 sc1 lds
v_mfma_f32_16x16x32_bf16 v[64:67], v[124:127], v[148:151], v[64:67]
buffer_load_dwordx4 v250, s[8:11], s82 offen offset:2048 sc1 lds
v_mfma_f32_16x16x32_bf16 v[68:71], v[128:131], v[148:151], v[68:71]
buffer_load_dwordx4 v251, s[8:11], s82 offen offset:3072 sc1 lds
v_mfma_f32_16x16x32_bf16 v[72:75], v[132:135], v[148:151], v[72:75]
s_add_u32 m0, s85, 65536
v_mfma_f32_16x16x32_bf16 v[76:79], v[136:139], v[148:151], v[76:79]
s_waitcnt lgkmcnt(15)
ds_read_b128 v[148:151], v165 offset:45056
v_mfma_f32_16x16x32_bf16 v[80:83], v[120:123], v[152:155], v[80:83]
buffer_load_dwordx4 v254, s[8:11], s82 offen sc1 lds
v_mfma_f32_16x16x32_bf16 v[84:87], v[124:127], v[152:155], v[84:87]
s_add_u32 s82, s82, s83
s_add_u32 m0, s85, 81920
v_mfma_f32_16x16x32_bf16 v[88:91], v[128:131], v[152:155], v[88:91]
buffer_load_dwordx4 v248, s[8:11], s82 offen offset:0 sc1 lds
v_mfma_f32_16x16x32_bf16 v[92:95], v[132:135], v[152:155], v[92:95]
buffer_load_dwordx4 v249, s[8:11], s82 offen offset:1024 sc1 lds
v_mfma_f32_16x16x32_bf16 v[96:99], v[136:139], v[152:155], v[96:99]
s_waitcnt lgkmcnt(4)
v_mfma_f32_16x16x32_bf16 v[0:3], v[100:103], v[156:159], v[0:3]
ds_read_b64_tr_b16 v[120:121], v169 offset:20480
ds_read_b64_tr_b16 v[122:123], v169 offset:25600
ds_read_b64_tr_b16 v[124:125], v172 offset:20512
v_mfma_f32_16x16x32_bf16 v[4:7], v[104:107], v[156:159], v[4:7]
ds_read_b64_tr_b16 v[126:127], v172 offset:25632
ds_read_b64_tr_b16 v[128:129], v169 offset:20544
ds_read_b64_tr_b16 v[130:131], v169 offset:25664
v_mfma_f32_16x16x32_bf16 v[8:11], v[108:111], v[156:159], v[8:11]
ds_read_b64_tr_b16 v[132:133], v172 offset:20576
ds_read_b64_tr_b16 v[134:135], v172 offset:25696
ds_read_b64_tr_b16 v[136:137], v169 offset:20608
v_mfma_f32_16x16x32_bf16 v[12:15], v[112:115], v[156:159], v[12:15]
ds_read_b64_tr_b16 v[138:139], v169 offset:25728
ds_read_b128 v[152:155], v166 offset:20480
v_mfma_f32_16x16x32_bf16 v[16:19], v[116:119], v[156:159], v[16:19]
s_waitcnt lgkmcnt(14)
ds_read_b128 v[156:159], v166 offset:21504
v_mfma_f32_16x16x32_bf16 v[20:23], v[100:103], v[160:163], v[20:23]
buffer_load_dwordx4 v250, s[8:11], s82 offen offset:2048 sc1 lds
v_mfma_f32_16x16x32_bf16 v[24:27], v[104:107], v[160:163], v[24:27]
buffer_load_dwordx4 v251, s[8:11], s82 offen offset:3072 sc1 lds
v_mfma_f32_16x16x32_bf16 v[28:31], v[108:111], v[160:163], v[28:31]
s_add_u32 m0, s85, 86016
v_mfma_f32_16x16x32_bf16 v[32:35], v[112:115], v[160:163], v[32:35]
buffer_load_dwordx4 v254, s[8:11], s82 offen sc1 lds
v_mfma_f32_16x16x32_bf16 v[36:39], v[116:119], v[160:163], v[36:39]
s_waitcnt lgkmcnt(14)
s_add_u32 s82, s82, s83
ds_read_b128 v[160:163], v166 offset:22528
v_mfma_f32_16x16x32_bf16 v[40:43], v[100:103], v[140:143], v[40:43]
buffer_store_dwordx4 v[190:193], v175, s[24:27], s39 offen sc1
v_accvgpr_read_b32 v178, a160
v_mfma_f32_16x16x32_bf16 v[44:47], v[104:107], v[140:143], v[44:47]
v_accvgpr_read_b32 v179, a161
v_accvgpr_read_b32 v180, a162
v_accvgpr_read_b32 v181, a163
v_mfma_f32_16x16x32_bf16 v[48:51], v[108:111], v[140:143], v[48:51]
v_mul_f32 v178, v220, v178
v_mul_f32 v179, v220, v179
v_mul_f32 v180, v220, v180
v_mfma_f32_16x16x32_bf16 v[52:55], v[112:115], v[140:143], v[52:55]
v_mul_f32 v181, v220, v181
v_cvt_pk_bf16_f32 v186, v178, v179
v_cvt_pk_bf16_f32 v187, v180, v181
v_mfma_f32_16x16x32_bf16 v[56:59], v[116:119], v[140:143], v[56:59]
s_waitcnt lgkmcnt(14)
ds_read_b128 v[140:143], v166 offset:23552
v_accvgpr_read_b32 v182, a180
v_accvgpr_read_b32 v183, a181
v_mfma_f32_16x16x32_bf16 v[60:63], v[100:103], v[144:147], v[60:63]
v_accvgpr_read_b32 v184, a182
v_accvgpr_read_b32 v185, a183
v_mul_f32 v182, v220, v182
v_mfma_f32_16x16x32_bf16 v[64:67], v[104:107], v[144:147], v[64:67]
v_mul_f32 v183, v220, v183
v_mul_f32 v184, v220, v184
v_mul_f32 v185, v220, v185
v_mfma_f32_16x16x32_bf16 v[68:71], v[108:111], v[144:147], v[68:71]
v_cvt_pk_bf16_f32 v188, v182, v183
v_cvt_pk_bf16_f32 v189, v184, v185
v_mfma_f32_16x16x32_bf16 v[72:75], v[112:115], v[144:147], v[72:75]
s_add_u32 s39, s47, 40960
v_mfma_f32_16x16x32_bf16 v[76:79], v[116:119], v[144:147], v[76:79]
s_waitcnt lgkmcnt(14)
ds_read_b128 v[144:147], v166 offset:24576
v_mfma_f32_16x16x32_bf16 v[80:83], v[100:103], v[148:151], v[80:83]
buffer_store_dwordx4 v[186:189], v174, s[24:27], s39 offen offset:0 sc1
v_accvgpr_read_b32 v178, a164
v_mfma_f32_16x16x32_bf16 v[84:87], v[104:107], v[148:151], v[84:87]
v_accvgpr_read_b32 v179, a165
v_accvgpr_read_b32 v180, a166
v_accvgpr_read_b32 v181, a167
v_mfma_f32_16x16x32_bf16 v[88:91], v[108:111], v[148:151], v[88:91]
v_mul_f32 v178, v221, v178
v_mul_f32 v179, v221, v179
v_mul_f32 v180, v221, v180
v_mfma_f32_16x16x32_bf16 v[92:95], v[112:115], v[148:151], v[92:95]
v_mul_f32 v181, v221, v181
v_cvt_pk_bf16_f32 v190, v178, v179
v_cvt_pk_bf16_f32 v191, v180, v181
v_mfma_f32_16x16x32_bf16 v[96:99], v[116:119], v[148:151], v[96:99]
s_waitcnt lgkmcnt(4)
v_accvgpr_read_b32 v182, a184
v_accvgpr_read_b32 v183, a185
v_accvgpr_read_b32 v184, a186
v_mfma_f32_16x16x32_bf16 v[0:3], v[120:123], v[152:155], v[0:3]
v_accvgpr_read_b32 v185, a187
v_mul_f32 v182, v221, v182
v_mul_f32 v183, v221, v183
v_mfma_f32_16x16x32_bf16 v[4:7], v[124:127], v[152:155], v[4:7]
v_mul_f32 v184, v221, v184
v_mul_f32 v185, v221, v185
v_cvt_pk_bf16_f32 v192, v182, v183
v_mfma_f32_16x16x32_bf16 v[8:11], v[128:131], v[152:155], v[8:11]
v_cvt_pk_bf16_f32 v193, v184, v185
v_mfma_f32_16x16x32_bf16 v[12:15], v[132:135], v[152:155], v[12:15]
buffer_store_dwordx4 v[190:193], v174, s[24:27], s39 offen offset:1024 sc1
v_accvgpr_read_b32 v178, a168
v_mfma_f32_16x16x32_bf16 v[16:19], v[136:139], v[152:155], v[16:19]
s_waitcnt lgkmcnt(3)
v_accvgpr_read_b32 v179, a169
v_accvgpr_read_b32 v180, a170
v_accvgpr_read_b32 v181, a171
v_mfma_f32_16x16x32_bf16 v[20:23], v[120:123], v[156:159], v[20:23]
v_mul_f32 v178, v222, v178
v_mul_f32 v179, v222, v179
v_mul_f32 v180, v222, v180
v_mfma_f32_16x16x32_bf16 v[24:27], v[124:127], v[156:159], v[24:27]
v_mul_f32 v181, v222, v181
v_cvt_pk_bf16_f32 v186, v178, v179
v_cvt_pk_bf16_f32 v187, v180, v181
v_mfma_f32_16x16x32_bf16 v[28:31], v[128:131], v[156:159], v[28:31]
v_accvgpr_read_b32 v182, a188
v_accvgpr_read_b32 v183, a189
v_accvgpr_read_b32 v184, a190
v_mfma_f32_16x16x32_bf16 v[32:35], v[132:135], v[156:159], v[32:35]
s_waitcnt vmcnt(29) lgkmcnt(0)
s_barrier
ds_read_b64_tr_b16 v[100:101], v167 offset:0
ds_read_b64_tr_b16 v[102:103], v167 offset:5120
v_mfma_f32_16x16x32_bf16 v[36:39], v[136:139], v[156:159], v[36:39]
s_waitcnt lgkmcnt(15)
ds_read_b64_tr_b16 v[104:105], v170 offset:32
ds_read_b64_tr_b16 v[106:107], v170 offset:5152
ds_read_b64_tr_b16 v[108:109], v167 offset:64
v_mfma_f32_16x16x32_bf16 v[40:43], v[120:123], v[160:163], v[40:43]
s_add_u32 m0, s85, 102400
ds_read_b64_tr_b16 v[110:111], v167 offset:5184
ds_read_b64_tr_b16 v[112:113], v170 offset:96
ds_read_b64_tr_b16 v[114:115], v170 offset:5216
v_mfma_f32_16x16x32_bf16 v[44:47], v[124:127], v[160:163], v[44:47]
ds_read_b64_tr_b16 v[116:117], v167 offset:128
ds_read_b64_tr_b16 v[118:119], v167 offset:5248
ds_read_b128 v[148:151], v164 offset:0
v_mfma_f32_16x16x32_bf16 v[48:51], v[128:131], v[160:163], v[48:51]
ds_read_b128 v[152:155], v164 offset:1024
ds_read_b128 v[156:159], v164 offset:2048
v_accvgpr_read_b32 v185, a191
v_mfma_f32_16x16x32_bf16 v[52:55], v[132:135], v[160:163], v[52:55]
buffer_load_dwordx4 v248, s[8:11], s82 offen offset:0 sc1 lds
v_mul_f32 v182, v222, v182
v_mfma_f32_16x16x32_bf16 v[56:59], v[136:139], v[160:163], v[56:59]
s_waitcnt lgkmcnt(15)
ds_read_b128 v[160:163], v164 offset:3072
v_mul_f32 v183, v222, v183
v_mul_f32 v184, v222, v184
v_mfma_f32_16x16x32_bf16 v[60:63], v[120:123], v[140:143], v[60:63]
buffer_load_dwordx4 v249, s[8:11], s82 offen offset:1024 sc1 lds
v_mul_f32 v185, v222, v185
v_mfma_f32_16x16x32_bf16 v[64:67], v[124:127], v[140:143], v[64:67]
buffer_load_dwordx4 v250, s[8:11], s82 offen offset:2048 sc1 lds
v_cvt_pk_bf16_f32 v188, v182, v183
v_mfma_f32_16x16x32_bf16 v[68:71], v[128:131], v[140:143], v[68:71]
buffer_load_dwordx4 v251, s[8:11], s82 offen offset:3072 sc1 lds
v_cvt_pk_bf16_f32 v189, v184, v185
v_mfma_f32_16x16x32_bf16 v[72:75], v[132:135], v[140:143], v[72:75]
s_add_u32 m0, s85, 106496
v_mfma_f32_16x16x32_bf16 v[76:79], v[136:139], v[140:143], v[76:79]
s_waitcnt lgkmcnt(15)
ds_read_b128 v[140:143], v164 offset:4096
v_mfma_f32_16x16x32_bf16 v[80:83], v[120:123], v[144:147], v[80:83]
buffer_load_dwordx4 v254, s[8:11], s82 offen sc1 lds
v_mfma_f32_16x16x32_bf16 v[84:87], v[124:127], v[144:147], v[84:87]
s_add_u32 s82, s82, s83
s_add_u32 m0, s85, 143360
v_mfma_f32_16x16x32_bf16 v[88:91], v[128:131], v[144:147], v[88:91]
buffer_load_dwordx4 v248, s[8:11], s82 offen offset:0 sc1 lds
v_mfma_f32_16x16x32_bf16 v[92:95], v[132:135], v[144:147], v[92:95]
buffer_load_dwordx4 v249, s[8:11], s82 offen offset:1024 sc1 lds
v_mfma_f32_16x16x32_bf16 v[96:99], v[136:139], v[144:147], v[96:99]
s_waitcnt lgkmcnt(4)
v_mfma_f32_16x16x32_bf16 v[0:3], v[100:103], v[148:151], v[0:3]
ds_read_b64_tr_b16 v[120:121], v169 offset:0
ds_read_b64_tr_b16 v[122:123], v169 offset:5120
ds_read_b64_tr_b16 v[124:125], v172 offset:32
v_mfma_f32_16x16x32_bf16 v[4:7], v[104:107], v[148:151], v[4:7]
ds_read_b64_tr_b16 v[126:127], v172 offset:5152
ds_read_b64_tr_b16 v[128:129], v169 offset:64
ds_read_b64_tr_b16 v[130:131], v169 offset:5184
v_mfma_f32_16x16x32_bf16 v[8:11], v[108:111], v[148:151], v[8:11]
ds_read_b64_tr_b16 v[132:133], v172 offset:96
ds_read_b64_tr_b16 v[134:135], v172 offset:5216
ds_read_b64_tr_b16 v[136:137], v169 offset:128
v_mfma_f32_16x16x32_bf16 v[12:15], v[112:115], v[148:151], v[12:15]
ds_read_b64_tr_b16 v[138:139], v169 offset:5248
ds_read_b128 v[144:147], v166 offset:0
v_mfma_f32_16x16x32_bf16 v[16:19], v[116:119], v[148:151], v[16:19]
s_waitcnt lgkmcnt(14)
ds_read_b128 v[148:151], v166 offset:1024
v_mfma_f32_16x16x32_bf16 v[20:23], v[100:103], v[152:155], v[20:23]
buffer_load_dwordx4 v250, s[8:11], s82 offen offset:2048 sc1 lds
v_mfma_f32_16x16x32_bf16 v[24:27], v[104:107], v[152:155], v[24:27]
buffer_load_dwordx4 v251, s[8:11], s82 offen offset:3072 sc1 lds
v_mfma_f32_16x16x32_bf16 v[28:31], v[108:111], v[152:155], v[28:31]
s_add_u32 m0, s85, 147456
v_mfma_f32_16x16x32_bf16 v[32:35], v[112:115], v[152:155], v[32:35]
buffer_load_dwordx4 v254, s[8:11], s82 offen sc1 lds
v_mfma_f32_16x16x32_bf16 v[36:39], v[116:119], v[152:155], v[36:39]
s_waitcnt lgkmcnt(14)
s_add_u32 s66, s66, 1
s_and_b32 s66, s66, 3
ds_read_b128 v[152:155], v166 offset:2048
v_mfma_f32_16x16x32_bf16 v[40:43], v[100:103], v[156:159], v[40:43]
s_mul_i32 s40, s66, 24
s_add_u32 s40, s40, 0
s_mul_i32 s40, s40, s83
s_add_u32 s82, s67, s40
v_mfma_f32_16x16x32_bf16 v[44:47], v[104:107], v[156:159], v[44:47]
buffer_store_dwordx4 v[186:189], v174, s[24:27], s39 offen offset:2048 sc1
v_accvgpr_read_b32 v178, a172
v_mfma_f32_16x16x32_bf16 v[48:51], v[108:111], v[156:159], v[48:51]
v_accvgpr_read_b32 v179, a173
v_accvgpr_read_b32 v180, a174
v_accvgpr_read_b32 v181, a175
v_mfma_f32_16x16x32_bf16 v[52:55], v[112:115], v[156:159], v[52:55]
v_mul_f32 v178, v223, v178
v_mul_f32 v179, v223, v179
v_mul_f32 v180, v223, v180
v_mfma_f32_16x16x32_bf16 v[56:59], v[116:119], v[156:159], v[56:59]
s_waitcnt lgkmcnt(14)
ds_read_b128 v[156:159], v166 offset:3072
v_mul_f32 v181, v223, v181
v_cvt_pk_bf16_f32 v190, v178, v179
v_mfma_f32_16x16x32_bf16 v[60:63], v[100:103], v[160:163], v[60:63]
v_cvt_pk_bf16_f32 v191, v180, v181
v_accvgpr_read_b32 v182, a192
v_accvgpr_read_b32 v183, a193
v_mfma_f32_16x16x32_bf16 v[64:67], v[104:107], v[160:163], v[64:67]
v_accvgpr_read_b32 v184, a194
v_accvgpr_read_b32 v185, a195
v_mul_f32 v182, v223, v182
v_mfma_f32_16x16x32_bf16 v[68:71], v[108:111], v[160:163], v[68:71]
v_mul_f32 v183, v223, v183
v_mul_f32 v184, v223, v184
v_mul_f32 v185, v223, v185
v_mfma_f32_16x16x32_bf16 v[72:75], v[112:115], v[160:163], v[72:75]
v_cvt_pk_bf16_f32 v192, v182, v183
v_cvt_pk_bf16_f32 v193, v184, v185
v_mfma_f32_16x16x32_bf16 v[76:79], v[116:119], v[160:163], v[76:79]
s_waitcnt lgkmcnt(14)
ds_read_b128 v[160:163], v166 offset:4096
v_mfma_f32_16x16x32_bf16 v[80:83], v[100:103], v[140:143], v[80:83]
buffer_store_dwordx4 v[190:193], v174, s[24:27], s39 offen offset:3072 sc1
v_accvgpr_read_b32 v178, a176
v_mfma_f32_16x16x32_bf16 v[84:87], v[104:107], v[140:143], v[84:87]
v_accvgpr_read_b32 v179, a177
v_accvgpr_read_b32 v180, a178
v_accvgpr_read_b32 v181, a179
v_mfma_f32_16x16x32_bf16 v[88:91], v[108:111], v[140:143], v[88:91]
v_mul_f32 v178, v224, v178
v_mul_f32 v179, v224, v179
v_mul_f32 v180, v224, v180
v_mfma_f32_16x16x32_bf16 v[92:95], v[112:115], v[140:143], v[92:95]
v_mul_f32 v181, v224, v181
v_cvt_pk_bf16_f32 v186, v178, v179
v_cvt_pk_bf16_f32 v187, v180, v181
v_mfma_f32_16x16x32_bf16 v[96:99], v[116:119], v[140:143], v[96:99]
s_waitcnt lgkmcnt(4)
v_accvgpr_read_b32 v182, a196
v_accvgpr_read_b32 v183, a197
v_accvgpr_read_b32 v184, a198
v_mfma_f32_16x16x32_bf16 v[0:3], v[120:123], v[144:147], v[0:3]
v_accvgpr_read_b32 v185, a199
v_mul_f32 v182, v224, v182
v_mul_f32 v183, v224, v183
v_mfma_f32_16x16x32_bf16 v[4:7], v[124:127], v[144:147], v[4:7]
v_mul_f32 v184, v224, v184
v_mul_f32 v185, v224, v185
v_cvt_pk_bf16_f32 v188, v182, v183
v_mfma_f32_16x16x32_bf16 v[8:11], v[128:131], v[144:147], v[8:11]
v_cvt_pk_bf16_f32 v189, v184, v185
v_mfma_f32_16x16x32_bf16 v[12:15], v[132:135], v[144:147], v[12:15]
buffer_store_dwordx4 v[186:189], v175, s[24:27], s39 offen sc1
v_accvgpr_read_b32 v178, a200
v_mfma_f32_16x16x32_bf16 v[16:19], v[136:139], v[144:147], v[16:19]
s_waitcnt lgkmcnt(3)
v_accvgpr_read_b32 v179, a201
v_accvgpr_read_b32 v180, a202
v_accvgpr_read_b32 v181, a203
v_mfma_f32_16x16x32_bf16 v[20:23], v[120:123], v[148:151], v[20:23]
v_mul_f32 v178, v220, v178
v_mul_f32 v179, v220, v179
v_mul_f32 v180, v220, v180
v_mfma_f32_16x16x32_bf16 v[24:27], v[124:127], v[148:151], v[24:27]
v_mul_f32 v181, v220, v181
v_cvt_pk_bf16_f32 v190, v178, v179
v_cvt_pk_bf16_f32 v191, v180, v181
v_mfma_f32_16x16x32_bf16 v[28:31], v[128:131], v[148:151], v[28:31]
v_accvgpr_read_b32 v182, a220
v_accvgpr_read_b32 v183, a221
v_accvgpr_read_b32 v184, a222
v_mfma_f32_16x16x32_bf16 v[32:35], v[132:135], v[148:151], v[32:35]
s_waitcnt vmcnt(29) lgkmcnt(0)
s_barrier
ds_read_b64_tr_b16 v[100:101], v167 offset:20480
ds_read_b64_tr_b16 v[102:103], v167 offset:25600
v_mfma_f32_16x16x32_bf16 v[36:39], v[136:139], v[148:151], v[36:39]
s_waitcnt lgkmcnt(15)
ds_read_b64_tr_b16 v[104:105], v170 offset:20512
ds_read_b64_tr_b16 v[106:107], v170 offset:25632
ds_read_b64_tr_b16 v[108:109], v167 offset:20544
v_mfma_f32_16x16x32_bf16 v[40:43], v[120:123], v[152:155], v[40:43]
s_add_u32 m0, s85, 0
ds_read_b64_tr_b16 v[110:111], v167 offset:25664
ds_read_b64_tr_b16 v[112:113], v170 offset:20576
ds_read_b64_tr_b16 v[114:115], v170 offset:25696
v_mfma_f32_16x16x32_bf16 v[44:47], v[124:127], v[152:155], v[44:47]
ds_read_b64_tr_b16 v[116:117], v167 offset:20608
ds_read_b64_tr_b16 v[118:119], v167 offset:25728
ds_read_b128 v[140:143], v164 offset:20480
v_mfma_f32_16x16x32_bf16 v[48:51], v[128:131], v[152:155], v[48:51]
ds_read_b128 v[144:147], v164 offset:21504
ds_read_b128 v[148:151], v164 offset:22528
v_accvgpr_read_b32 v185, a223
v_mfma_f32_16x16x32_bf16 v[52:55], v[132:135], v[152:155], v[52:55]
buffer_load_dwordx4 v248, s[8:11], s82 offen offset:0 sc1 lds
v_mul_f32 v182, v220, v182
v_mfma_f32_16x16x32_bf16 v[56:59], v[136:139], v[152:155], v[56:59]
s_waitcnt lgkmcnt(15)
ds_read_b128 v[152:155], v164 offset:23552
v_mul_f32 v183, v220, v183
v_mul_f32 v184, v220, v184
v_mfma_f32_16x16x32_bf16 v[60:63], v[120:123], v[156:159], v[60:63]
buffer_load_dwordx4 v249, s[8:11], s82 offen offset:1024 sc1 lds
v_mul_f32 v185, v220, v185
v_mfma_f32_16x16x32_bf16 v[64:67], v[124:127], v[156:159], v[64:67]
buffer_load_dwordx4 v250, s[8:11], s82 offen offset:2048 sc1 lds
v_cvt_pk_bf16_f32 v192, v182, v183
v_mfma_f32_16x16x32_bf16 v[68:71], v[128:131], v[156:159], v[68:71]
buffer_load_dwordx4 v251, s[8:11], s82 offen offset:3072 sc1 lds
v_cvt_pk_bf16_f32 v193, v184, v185
v_mfma_f32_16x16x32_bf16 v[72:75], v[132:135], v[156:159], v[72:75]
s_add_u32 m0, s85, 4096
s_add_u32 s39, s47, 51200
v_mfma_f32_16x16x32_bf16 v[76:79], v[136:139], v[156:159], v[76:79]
s_waitcnt lgkmcnt(15)
ds_read_b128 v[156:159], v164 offset:24576
v_mfma_f32_16x16x32_bf16 v[80:83], v[120:123], v[160:163], v[80:83]
buffer_load_dwordx4 v254, s[8:11], s82 offen sc1 lds
v_mfma_f32_16x16x32_bf16 v[84:87], v[124:127], v[160:163], v[84:87]
s_add_u32 s82, s82, s83
s_add_u32 m0, s85, 122880
v_mfma_f32_16x16x32_bf16 v[88:91], v[128:131], v[160:163], v[88:91]
buffer_load_dwordx4 v248, s[8:11], s82 offen offset:0 sc1 lds
v_mfma_f32_16x16x32_bf16 v[92:95], v[132:135], v[160:163], v[92:95]
buffer_load_dwordx4 v249, s[8:11], s82 offen offset:1024 sc1 lds
v_mfma_f32_16x16x32_bf16 v[96:99], v[136:139], v[160:163], v[96:99]
s_waitcnt lgkmcnt(4)
v_mfma_f32_16x16x32_bf16 v[0:3], v[100:103], v[140:143], v[0:3]
ds_read_b64_tr_b16 v[120:121], v167 offset:40960
ds_read_b64_tr_b16 v[122:123], v167 offset:46080
ds_read_b64_tr_b16 v[124:125], v170 offset:40992
v_mfma_f32_16x16x32_bf16 v[4:7], v[104:107], v[140:143], v[4:7]
ds_read_b64_tr_b16 v[126:127], v170 offset:46112
ds_read_b64_tr_b16 v[128:129], v167 offset:41024
ds_read_b64_tr_b16 v[130:131], v167 offset:46144
v_mfma_f32_16x16x32_bf16 v[8:11], v[108:111], v[140:143], v[8:11]
ds_read_b64_tr_b16 v[132:133], v170 offset:41056
ds_read_b64_tr_b16 v[134:135], v170 offset:46176
ds_read_b64_tr_b16 v[136:137], v167 offset:41088
v_mfma_f32_16x16x32_bf16 v[12:15], v[112:115], v[140:143], v[12:15]
ds_read_b64_tr_b16 v[138:139], v167 offset:46208
ds_read_b128 v[160:163], v164 offset:40960
v_mfma_f32_16x16x32_bf16 v[16:19], v[116:119], v[140:143], v[16:19]
s_waitcnt lgkmcnt(14)
ds_read_b128 v[140:143], v164 offset:41984
v_mfma_f32_16x16x32_bf16 v[20:23], v[100:103], v[144:147], v[20:23]
buffer_load_dwordx4 v250, s[8:11], s82 offen offset:2048 sc1 lds
v_mfma_f32_16x16x32_bf16 v[24:27], v[104:107], v[144:147], v[24:27]
buffer_load_dwordx4 v251, s[8:11], s82 offen offset:3072 sc1 lds
v_mfma_f32_16x16x32_bf16 v[28:31], v[108:111], v[144:147], v[28:31]
s_add_u32 m0, s85, 126976
v_mfma_f32_16x16x32_bf16 v[32:35], v[112:115], v[144:147], v[32:35]
buffer_load_dwordx4 v254, s[8:11], s82 offen sc1 lds
v_mfma_f32_16x16x32_bf16 v[36:39], v[116:119], v[144:147], v[36:39]
s_waitcnt lgkmcnt(14)
s_add_u32 s82, s82, s83
ds_read_b128 v[144:147], v164 offset:43008
v_mfma_f32_16x16x32_bf16 v[40:43], v[100:103], v[148:151], v[40:43]
buffer_store_dwordx4 v[190:193], v174, s[24:27], s39 offen offset:0 sc1
v_accvgpr_read_b32 v178, a204
v_mfma_f32_16x16x32_bf16 v[44:47], v[104:107], v[148:151], v[44:47]
v_accvgpr_read_b32 v179, a205
v_accvgpr_read_b32 v180, a206
v_accvgpr_read_b32 v181, a207
v_mfma_f32_16x16x32_bf16 v[48:51], v[108:111], v[148:151], v[48:51]
v_mul_f32 v178, v221, v178
v_mul_f32 v179, v221, v179
v_mul_f32 v180, v221, v180
v_mfma_f32_16x16x32_bf16 v[52:55], v[112:115], v[148:151], v[52:55]
v_mul_f32 v181, v221, v181
v_cvt_pk_bf16_f32 v186, v178, v179
v_cvt_pk_bf16_f32 v187, v180, v181
v_mfma_f32_16x16x32_bf16 v[56:59], v[116:119], v[148:151], v[56:59]
s_waitcnt lgkmcnt(14)
ds_read_b128 v[148:151], v164 offset:44032
v_accvgpr_read_b32 v182, a224
v_accvgpr_read_b32 v183, a225
v_mfma_f32_16x16x32_bf16 v[60:63], v[100:103], v[152:155], v[60:63]
v_accvgpr_read_b32 v184, a226
v_accvgpr_read_b32 v185, a227
v_mul_f32 v182, v221, v182
v_mfma_f32_16x16x32_bf16 v[64:67], v[104:107], v[152:155], v[64:67]
v_mul_f32 v183, v221, v183
v_mul_f32 v184, v221, v184
v_mul_f32 v185, v221, v185
v_mfma_f32_16x16x32_bf16 v[68:71], v[108:111], v[152:155], v[68:71]
v_cvt_pk_bf16_f32 v188, v182, v183
v_cvt_pk_bf16_f32 v189, v184, v185
v_mfma_f32_16x16x32_bf16 v[72:75], v[112:115], v[152:155], v[72:75]
buffer_store_dwordx4 v[186:189], v174, s[24:27], s39 offen offset:1024 sc1
v_accvgpr_read_b32 v178, a208
v_mfma_f32_16x16x32_bf16 v[76:79], v[116:119], v[152:155], v[76:79]
s_waitcnt lgkmcnt(14)
ds_read_b128 v[152:155], v164 offset:45056
v_accvgpr_read_b32 v179, a209
v_accvgpr_read_b32 v180, a210
v_mfma_f32_16x16x32_bf16 v[80:83], v[100:103], v[156:159], v[80:83]
v_accvgpr_read_b32 v181, a211
v_mul_f32 v178, v222, v178
v_mul_f32 v179, v222, v179
v_mfma_f32_16x16x32_bf16 v[84:87], v[104:107], v[156:159], v[84:87]
v_mul_f32 v180, v222, v180
v_mul_f32 v181, v222, v181
v_cvt_pk_bf16_f32 v190, v178, v179
v_mfma_f32_16x16x32_bf16 v[88:91], v[108:111], v[156:159], v[88:91]
v_cvt_pk_bf16_f32 v191, v180, v181
v_accvgpr_read_b32 v182, a228
v_accvgpr_read_b32 v183, a229
v_mfma_f32_16x16x32_bf16 v[92:95], v[112:115], v[156:159], v[92:95]
v_accvgpr_read_b32 v184, a230
v_accvgpr_read_b32 v185, a231
v_mul_f32 v182, v222, v182
v_mfma_f32_16x16x32_bf16 v[96:99], v[116:119], v[156:159], v[96:99]
s_waitcnt lgkmcnt(4)
v_mul_f32 v183, v222, v183
v_mul_f32 v184, v222, v184
v_mul_f32 v185, v222, v185
v_mfma_f32_16x16x32_bf16 v[0:3], v[120:123], v[160:163], v[0:3]
v_cvt_pk_bf16_f32 v192, v182, v183
v_cvt_pk_bf16_f32 v193, v184, v185
v_mfma_f32_16x16x32_bf16 v[4:7], v[124:127], v[160:163], v[4:7]
buffer_store_dwordx4 v[190:193], v174, s[24:27], s39 offen offset:2048 sc1
v_accvgpr_read_b32 v178, a212
v_mfma_f32_16x16x32_bf16 v[8:11], v[128:131], v[160:163], v[8:11]
v_accvgpr_read_b32 v179, a213
v_accvgpr_read_b32 v180, a214
v_accvgpr_read_b32 v181, a215
v_mfma_f32_16x16x32_bf16 v[12:15], v[132:135], v[160:163], v[12:15]
v_mul_f32 v178, v223, v178
v_mul_f32 v179, v223, v179
v_mul_f32 v180, v223, v180
v_mfma_f32_16x16x32_bf16 v[16:19], v[136:139], v[160:163], v[16:19]
s_waitcnt lgkmcnt(3)
v_mul_f32 v181, v223, v181
v_cvt_pk_bf16_f32 v186, v178, v179
v_cvt_pk_bf16_f32 v187, v180, v181
v_mfma_f32_16x16x32_bf16 v[20:23], v[120:123], v[140:143], v[20:23]
v_accvgpr_read_b32 v182, a232
v_accvgpr_read_b32 v183, a233
v_accvgpr_read_b32 v184, a234
v_mfma_f32_16x16x32_bf16 v[24:27], v[124:127], v[140:143], v[24:27]
v_accvgpr_read_b32 v185, a235
v_mul_f32 v182, v223, v182
v_mul_f32 v183, v223, v183
v_mfma_f32_16x16x32_bf16 v[28:31], v[128:131], v[140:143], v[28:31]
v_mul_f32 v184, v223, v184
v_mul_f32 v185, v223, v185
v_cvt_pk_bf16_f32 v188, v182, v183
v_mfma_f32_16x16x32_bf16 v[32:35], v[132:135], v[140:143], v[32:35]
s_waitcnt vmcnt(29) lgkmcnt(0)
s_barrier
ds_read_b64_tr_b16 v[100:101], v168 offset:0
ds_read_b64_tr_b16 v[102:103], v168 offset:5120
v_mfma_f32_16x16x32_bf16 v[36:39], v[136:139], v[140:143], v[36:39]
s_waitcnt lgkmcnt(15)
ds_read_b64_tr_b16 v[104:105], v171 offset:32
ds_read_b64_tr_b16 v[106:107], v171 offset:5152
ds_read_b64_tr_b16 v[108:109], v168 offset:64
v_mfma_f32_16x16x32_bf16 v[40:43], v[120:123], v[144:147], v[40:43]
s_add_u32 m0, s85, 20480
ds_read_b64_tr_b16 v[110:111], v168 offset:5184
ds_read_b64_tr_b16 v[112:113], v171 offset:96
ds_read_b64_tr_b16 v[114:115], v171 offset:5216
v_mfma_f32_16x16x32_bf16 v[44:47], v[124:127], v[144:147], v[44:47]
ds_read_b64_tr_b16 v[116:117], v168 offset:128
ds_read_b64_tr_b16 v[118:119], v168 offset:5248
ds_read_b128 v[156:159], v165 offset:0
v_mfma_f32_16x16x32_bf16 v[48:51], v[128:131], v[144:147], v[48:51]
ds_read_b128 v[160:163], v165 offset:1024
ds_read_b128 v[140:143], v165 offset:2048
v_cvt_pk_bf16_f32 v189, v184, v185
v_mfma_f32_16x16x32_bf16 v[52:55], v[132:135], v[144:147], v[52:55]
buffer_load_dwordx4 v248, s[8:11], s82 offen offset:0 sc1 lds
v_mfma_f32_16x16x32_bf16 v[56:59], v[136:139], v[144:147], v[56:59]
s_waitcnt lgkmcnt(15)
ds_read_b128 v[144:147], v165 offset:3072
v_mfma_f32_16x16x32_bf16 v[60:63], v[120:123], v[148:151], v[60:63]
buffer_load_dwordx4 v249, s[8:11], s82 offen offset:1024 sc1 lds
v_mfma_f32_16x16x32_bf16 v[64:67], v[124:127], v[148:151], v[64:67]
buffer_load_dwordx4 v250, s[8:11], s82 offen offset:2048 sc1 lds
v_mfma_f32_16x16x32_bf16 v[68:71], v[128:131], v[148:151], v[68:71]
buffer_load_dwordx4 v251, s[8:11], s82 offen offset:3072 sc1 lds
v_mfma_f32_16x16x32_bf16 v[72:75], v[132:135], v[148:151], v[72:75]
s_add_u32 m0, s85, 24576
v_mfma_f32_16x16x32_bf16 v[76:79], v[136:139], v[148:151], v[76:79]
s_waitcnt lgkmcnt(15)
ds_read_b128 v[148:151], v165 offset:4096
v_mfma_f32_16x16x32_bf16 v[80:83], v[120:123], v[152:155], v[80:83]
buffer_load_dwordx4 v254, s[8:11], s82 offen sc1 lds
v_mfma_f32_16x16x32_bf16 v[84:87], v[124:127], v[152:155], v[84:87]
s_add_u32 s82, s82, s83
s_add_u32 m0, s85, 40960
v_mfma_f32_16x16x32_bf16 v[88:91], v[128:131], v[152:155], v[88:91]
buffer_load_dwordx4 v248, s[8:11], s82 offen offset:0 sc1 lds
v_mfma_f32_16x16x32_bf16 v[92:95], v[132:135], v[152:155], v[92:95]
buffer_load_dwordx4 v249, s[8:11], s82 offen offset:1024 sc1 lds
v_mfma_f32_16x16x32_bf16 v[96:99], v[136:139], v[152:155], v[96:99]
s_waitcnt lgkmcnt(4)
v_mfma_f32_16x16x32_bf16 v[0:3], v[100:103], v[156:159], v[0:3]
ds_read_b64_tr_b16 v[120:121], v168 offset:20480
ds_read_b64_tr_b16 v[122:123], v168 offset:25600
ds_read_b64_tr_b16 v[124:125], v171 offset:20512
v_mfma_f32_16x16x32_bf16 v[4:7], v[104:107], v[156:159], v[4:7]
ds_read_b64_tr_b16 v[126:127], v171 offset:25632
ds_read_b64_tr_b16 v[128:129], v168 offset:20544
ds_read_b64_tr_b16 v[130:131], v168 offset:25664
v_mfma_f32_16x16x32_bf16 v[8:11], v[108:111], v[156:159], v[8:11]
ds_read_b64_tr_b16 v[132:133], v171 offset:20576
ds_read_b64_tr_b16 v[134:135], v171 offset:25696
ds_read_b64_tr_b16 v[136:137], v168 offset:20608
v_mfma_f32_16x16x32_bf16 v[12:15], v[112:115], v[156:159], v[12:15]
ds_read_b64_tr_b16 v[138:139], v168 offset:25728
ds_read_b128 v[152:155], v165 offset:20480
v_mfma_f32_16x16x32_bf16 v[16:19], v[116:119], v[156:159], v[16:19]
s_waitcnt lgkmcnt(14)
ds_read_b128 v[156:159], v165 offset:21504
v_mfma_f32_16x16x32_bf16 v[20:23], v[100:103], v[160:163], v[20:23]
buffer_load_dwordx4 v250, s[8:11], s82 offen offset:2048 sc1 lds
v_mfma_f32_16x16x32_bf16 v[24:27], v[104:107], v[160:163], v[24:27]
buffer_load_dwordx4 v251, s[8:11], s82 offen offset:3072 sc1 lds
v_mfma_f32_16x16x32_bf16 v[28:31], v[108:111], v[160:163], v[28:31]
s_add_u32 m0, s85, 45056
v_mfma_f32_16x16x32_bf16 v[32:35], v[112:115], v[160:163], v[32:35]
buffer_load_dwordx4 v254, s[8:11], s82 offen sc1 lds
v_mfma_f32_16x16x32_bf16 v[36:39], v[116:119], v[160:163], v[36:39]
s_waitcnt lgkmcnt(14)
s_add_u32 s82, s82, s83
ds_read_b128 v[160:163], v165 offset:22528
v_mfma_f32_16x16x32_bf16 v[40:43], v[100:103], v[140:143], v[40:43]
buffer_store_dwordx4 v[186:189], v174, s[24:27], s39 offen offset:3072 sc1
v_accvgpr_read_b32 v178, a216
v_mfma_f32_16x16x32_bf16 v[44:47], v[104:107], v[140:143], v[44:47]
v_accvgpr_read_b32 v179, a217
v_accvgpr_read_b32 v180, a218
v_accvgpr_read_b32 v181, a219
v_mfma_f32_16x16x32_bf16 v[48:51], v[108:111], v[140:143], v[48:51]
v_mul_f32 v178, v224, v178
v_mul_f32 v179, v224, v179
v_mul_f32 v180, v224, v180
v_mfma_f32_16x16x32_bf16 v[52:55], v[112:115], v[140:143], v[52:55]
v_mul_f32 v181, v224, v181
v_cvt_pk_bf16_f32 v190, v178, v179
v_cvt_pk_bf16_f32 v191, v180, v181
v_mfma_f32_16x16x32_bf16 v[56:59], v[116:119], v[140:143], v[56:59]
s_waitcnt lgkmcnt(14)
ds_read_b128 v[140:143], v165 offset:23552
v_accvgpr_read_b32 v182, a236
v_accvgpr_read_b32 v183, a237
v_mfma_f32_16x16x32_bf16 v[60:63], v[100:103], v[144:147], v[60:63]
v_accvgpr_read_b32 v184, a238
v_accvgpr_read_b32 v185, a239
v_mul_f32 v182, v224, v182
v_mfma_f32_16x16x32_bf16 v[64:67], v[104:107], v[144:147], v[64:67]
v_mul_f32 v183, v224, v183
v_mul_f32 v184, v224, v184
v_mul_f32 v185, v224, v185
v_mfma_f32_16x16x32_bf16 v[68:71], v[108:111], v[144:147], v[68:71]
v_cvt_pk_bf16_f32 v192, v182, v183
v_cvt_pk_bf16_f32 v193, v184, v185
v_mfma_f32_16x16x32_bf16 v[72:75], v[112:115], v[144:147], v[72:75]
buffer_store_dwordx4 v[190:193], v175, s[24:27], s39 offen sc1
v_mfma_f32_16x16x32_bf16 v[76:79], v[116:119], v[144:147], v[76:79]
s_waitcnt lgkmcnt(14)
ds_read_b128 v[144:147], v165 offset:24576
v_mfma_f32_16x16x32_bf16 v[80:83], v[100:103], v[148:151], v[80:83]
v_mfma_f32_16x16x32_bf16 v[84:87], v[104:107], v[148:151], v[84:87]
v_mfma_f32_16x16x32_bf16 v[88:91], v[108:111], v[148:151], v[88:91]
v_mfma_f32_16x16x32_bf16 v[92:95], v[112:115], v[148:151], v[92:95]
v_mfma_f32_16x16x32_bf16 v[96:99], v[116:119], v[148:151], v[96:99]
s_waitcnt lgkmcnt(4)
v_mfma_f32_16x16x32_bf16 v[0:3], v[120:123], v[152:155], v[0:3]
v_mfma_f32_16x16x32_bf16 v[4:7], v[124:127], v[152:155], v[4:7]
v_mfma_f32_16x16x32_bf16 v[8:11], v[128:131], v[152:155], v[8:11]
v_mfma_f32_16x16x32_bf16 v[12:15], v[132:135], v[152:155], v[12:15]
v_mfma_f32_16x16x32_bf16 v[16:19], v[136:139], v[152:155], v[16:19]
s_waitcnt lgkmcnt(3)
v_mfma_f32_16x16x32_bf16 v[20:23], v[120:123], v[156:159], v[20:23]
v_mfma_f32_16x16x32_bf16 v[24:27], v[124:127], v[156:159], v[24:27]
v_mfma_f32_16x16x32_bf16 v[28:31], v[128:131], v[156:159], v[28:31]
v_mfma_f32_16x16x32_bf16 v[32:35], v[132:135], v[156:159], v[32:35]
s_waitcnt vmcnt(28) lgkmcnt(0)
s_barrier
ds_read_b64_tr_b16 v[100:101], v168 offset:40960
ds_read_b64_tr_b16 v[102:103], v168 offset:46080
v_mfma_f32_16x16x32_bf16 v[36:39], v[136:139], v[156:159], v[36:39]
s_waitcnt lgkmcnt(15)
ds_read_b64_tr_b16 v[104:105], v171 offset:40992
ds_read_b64_tr_b16 v[106:107], v171 offset:46112
ds_read_b64_tr_b16 v[108:109], v168 offset:41024
v_mfma_f32_16x16x32_bf16 v[40:43], v[120:123], v[160:163], v[40:43]
s_add_u32 m0, s85, 61440
ds_read_b64_tr_b16 v[110:111], v168 offset:46144
ds_read_b64_tr_b16 v[112:113], v171 offset:41056
ds_read_b64_tr_b16 v[114:115], v171 offset:46176
v_mfma_f32_16x16x32_bf16 v[44:47], v[124:127], v[160:163], v[44:47]
ds_read_b64_tr_b16 v[116:117], v168 offset:41088
ds_read_b64_tr_b16 v[118:119], v168 offset:46208
ds_read_b128 v[148:151], v165 offset:40960
v_mfma_f32_16x16x32_bf16 v[48:51], v[128:131], v[160:163], v[48:51]
ds_read_b128 v[152:155], v165 offset:41984
ds_read_b128 v[156:159], v165 offset:43008
v_mfma_f32_16x16x32_bf16 v[52:55], v[132:135], v[160:163], v[52:55]
buffer_load_dwordx4 v248, s[8:11], s82 offen offset:0 sc1 lds
v_mfma_f32_16x16x32_bf16 v[56:59], v[136:139], v[160:163], v[56:59]
s_waitcnt lgkmcnt(15)
ds_read_b128 v[160:163], v165 offset:44032
v_mfma_f32_16x16x32_bf16 v[60:63], v[120:123], v[140:143], v[60:63]
buffer_load_dwordx4 v249, s[8:11], s82 offen offset:1024 sc1 lds
v_mfma_f32_16x16x32_bf16 v[64:67], v[124:127], v[140:143], v[64:67]
buffer_load_dwordx4 v250, s[8:11], s82 offen offset:2048 sc1 lds
v_mfma_f32_16x16x32_bf16 v[68:71], v[128:131], v[140:143], v[68:71]
buffer_load_dwordx4 v251, s[8:11], s82 offen offset:3072 sc1 lds
v_mfma_f32_16x16x32_bf16 v[72:75], v[132:135], v[140:143], v[72:75]
s_add_u32 m0, s85, 65536
v_mfma_f32_16x16x32_bf16 v[76:79], v[136:139], v[140:143], v[76:79]
s_waitcnt lgkmcnt(15)
ds_read_b128 v[140:143], v165 offset:45056
v_mfma_f32_16x16x32_bf16 v[80:83], v[120:123], v[144:147], v[80:83]
buffer_load_dwordx4 v254, s[8:11], s82 offen sc1 lds
v_mfma_f32_16x16x32_bf16 v[84:87], v[124:127], v[144:147], v[84:87]
s_add_u32 s82, s82, s83
s_add_u32 m0, s85, 81920
v_mfma_f32_16x16x32_bf16 v[88:91], v[128:131], v[144:147], v[88:91]
buffer_load_dwordx4 v248, s[8:11], s82 offen offset:0 sc1 lds
v_mfma_f32_16x16x32_bf16 v[92:95], v[132:135], v[144:147], v[92:95]
buffer_load_dwordx4 v249, s[8:11], s82 offen offset:1024 sc1 lds
v_mfma_f32_16x16x32_bf16 v[96:99], v[136:139], v[144:147], v[96:99]
s_waitcnt lgkmcnt(4)
v_mfma_f32_16x16x32_bf16 v[0:3], v[100:103], v[148:151], v[0:3]
ds_read_b64_tr_b16 v[120:121], v169 offset:20480
ds_read_b64_tr_b16 v[122:123], v169 offset:25600
ds_read_b64_tr_b16 v[124:125], v172 offset:20512
v_mfma_f32_16x16x32_bf16 v[4:7], v[104:107], v[148:151], v[4:7]
ds_read_b64_tr_b16 v[126:127], v172 offset:25632
ds_read_b64_tr_b16 v[128:129], v169 offset:20544
ds_read_b64_tr_b16 v[130:131], v169 offset:25664
v_mfma_f32_16x16x32_bf16 v[8:11], v[108:111], v[148:151], v[8:11]
ds_read_b64_tr_b16 v[132:133], v172 offset:20576
ds_read_b64_tr_b16 v[134:135], v172 offset:25696
ds_read_b64_tr_b16 v[136:137], v169 offset:20608
v_mfma_f32_16x16x32_bf16 v[12:15], v[112:115], v[148:151], v[12:15]
ds_read_b64_tr_b16 v[138:139], v169 offset:25728
ds_read_b128 v[144:147], v166 offset:20480
v_mfma_f32_16x16x32_bf16 v[16:19], v[116:119], v[148:151], v[16:19]
s_waitcnt lgkmcnt(14)
ds_read_b128 v[148:151], v166 offset:21504
v_mfma_f32_16x16x32_bf16 v[20:23], v[100:103], v[152:155], v[20:23]
buffer_load_dwordx4 v250, s[8:11], s82 offen offset:2048 sc1 lds
v_mfma_f32_16x16x32_bf16 v[24:27], v[104:107], v[152:155], v[24:27]
buffer_load_dwordx4 v251, s[8:11], s82 offen offset:3072 sc1 lds
v_mfma_f32_16x16x32_bf16 v[28:31], v[108:111], v[152:155], v[28:31]
s_add_u32 m0, s85, 86016
v_mfma_f32_16x16x32_bf16 v[32:35], v[112:115], v[152:155], v[32:35]
buffer_load_dwordx4 v254, s[8:11], s82 offen sc1 lds
v_mfma_f32_16x16x32_bf16 v[36:39], v[116:119], v[152:155], v[36:39]
s_waitcnt lgkmcnt(14)
s_add_u32 s82, s82, s83
ds_read_b128 v[152:155], v166 offset:22528
v_mfma_f32_16x16x32_bf16 v[40:43], v[100:103], v[156:159], v[40:43]
v_mfma_f32_16x16x32_bf16 v[44:47], v[104:107], v[156:159], v[44:47]
v_mfma_f32_16x16x32_bf16 v[48:51], v[108:111], v[156:159], v[48:51]
v_mfma_f32_16x16x32_bf16 v[52:55], v[112:115], v[156:159], v[52:55]
v_mfma_f32_16x16x32_bf16 v[56:59], v[116:119], v[156:159], v[56:59]
s_waitcnt lgkmcnt(14)
ds_read_b128 v[156:159], v166 offset:23552
v_mfma_f32_16x16x32_bf16 v[60:63], v[100:103], v[160:163], v[60:63]
v_mfma_f32_16x16x32_bf16 v[64:67], v[104:107], v[160:163], v[64:67]
v_mfma_f32_16x16x32_bf16 v[68:71], v[108:111], v[160:163], v[68:71]
v_mfma_f32_16x16x32_bf16 v[72:75], v[112:115], v[160:163], v[72:75]
v_mfma_f32_16x16x32_bf16 v[76:79], v[116:119], v[160:163], v[76:79]
s_waitcnt lgkmcnt(14)
ds_read_b128 v[160:163], v166 offset:24576
v_mfma_f32_16x16x32_bf16 v[80:83], v[100:103], v[140:143], v[80:83]
v_mfma_f32_16x16x32_bf16 v[84:87], v[104:107], v[140:143], v[84:87]
v_mfma_f32_16x16x32_bf16 v[88:91], v[108:111], v[140:143], v[88:91]
v_mfma_f32_16x16x32_bf16 v[92:95], v[112:115], v[140:143], v[92:95]
v_mfma_f32_16x16x32_bf16 v[96:99], v[116:119], v[140:143], v[96:99]
s_waitcnt lgkmcnt(4)
v_mfma_f32_16x16x32_bf16 v[0:3], v[120:123], v[144:147], v[0:3]
v_mfma_f32_16x16x32_bf16 v[4:7], v[124:127], v[144:147], v[4:7]
v_mfma_f32_16x16x32_bf16 v[8:11], v[128:131], v[144:147], v[8:11]
v_mfma_f32_16x16x32_bf16 v[12:15], v[132:135], v[144:147], v[12:15]
v_mfma_f32_16x16x32_bf16 v[16:19], v[136:139], v[144:147], v[16:19]
s_waitcnt lgkmcnt(3)
v_mfma_f32_16x16x32_bf16 v[20:23], v[120:123], v[148:151], v[20:23]
v_mfma_f32_16x16x32_bf16 v[24:27], v[124:127], v[148:151], v[24:27]
v_mfma_f32_16x16x32_bf16 v[28:31], v[128:131], v[148:151], v[28:31]
v_mfma_f32_16x16x32_bf16 v[32:35], v[132:135], v[148:151], v[32:35]
s_waitcnt vmcnt(25) lgkmcnt(0)
s_barrier
ds_read_b64_tr_b16 v[100:101], v167 offset:0
ds_read_b64_tr_b16 v[102:103], v167 offset:5120
v_mfma_f32_16x16x32_bf16 v[36:39], v[136:139], v[148:151], v[36:39]
s_waitcnt lgkmcnt(15)
ds_read_b64_tr_b16 v[104:105], v170 offset:32
ds_read_b64_tr_b16 v[106:107], v170 offset:5152
ds_read_b64_tr_b16 v[108:109], v167 offset:64
v_mfma_f32_16x16x32_bf16 v[40:43], v[120:123], v[152:155], v[40:43]
s_add_u32 m0, s85, 102400
ds_read_b64_tr_b16 v[110:111], v167 offset:5184
ds_read_b64_tr_b16 v[112:113], v170 offset:96
ds_read_b64_tr_b16 v[114:115], v170 offset:5216
v_mfma_f32_16x16x32_bf16 v[44:47], v[124:127], v[152:155], v[44:47]
ds_read_b64_tr_b16 v[116:117], v167 offset:128
ds_read_b64_tr_b16 v[118:119], v167 offset:5248
ds_read_b128 v[140:143], v164 offset:0
v_mfma_f32_16x16x32_bf16 v[48:51], v[128:131], v[152:155], v[48:51]
ds_read_b128 v[144:147], v164 offset:1024
ds_read_b128 v[148:151], v164 offset:2048
v_mfma_f32_16x16x32_bf16 v[52:55], v[132:135], v[152:155], v[52:55]
buffer_load_dwordx4 v248, s[8:11], s82 offen offset:0 sc1 lds
v_mfma_f32_16x16x32_bf16 v[56:59], v[136:139], v[152:155], v[56:59]
s_waitcnt lgkmcnt(15)
ds_read_b128 v[152:155], v164 offset:3072
v_mfma_f32_16x16x32_bf16 v[60:63], v[120:123], v[156:159], v[60:63]
buffer_load_dwordx4 v249, s[8:11], s82 offen offset:1024 sc1 lds
v_mfma_f32_16x16x32_bf16 v[64:67], v[124:127], v[156:159], v[64:67]
buffer_load_dwordx4 v250, s[8:11], s82 offen offset:2048 sc1 lds
v_mfma_f32_16x16x32_bf16 v[68:71], v[128:131], v[156:159], v[68:71]
buffer_load_dwordx4 v251, s[8:11], s82 offen offset:3072 sc1 lds
v_mfma_f32_16x16x32_bf16 v[72:75], v[132:135], v[156:159], v[72:75]
s_add_u32 m0, s85, 106496
v_mfma_f32_16x16x32_bf16 v[76:79], v[136:139], v[156:159], v[76:79]
s_waitcnt lgkmcnt(15)
ds_read_b128 v[156:159], v164 offset:4096
v_mfma_f32_16x16x32_bf16 v[80:83], v[120:123], v[160:163], v[80:83]
buffer_load_dwordx4 v254, s[8:11], s82 offen sc1 lds
v_mfma_f32_16x16x32_bf16 v[84:87], v[124:127], v[160:163], v[84:87]
s_add_u32 s82, s82, s83
s_add_u32 m0, s85, 143360
v_mfma_f32_16x16x32_bf16 v[88:91], v[128:131], v[160:163], v[88:91]
buffer_load_dwordx4 v248, s[8:11], s82 offen offset:0 sc1 lds
v_mfma_f32_16x16x32_bf16 v[92:95], v[132:135], v[160:163], v[92:95]
buffer_load_dwordx4 v249, s[8:11], s82 offen offset:1024 sc1 lds
v_mfma_f32_16x16x32_bf16 v[96:99], v[136:139], v[160:163], v[96:99]
s_waitcnt lgkmcnt(4)
v_mfma_f32_16x16x32_bf16 v[0:3], v[100:103], v[140:143], v[0:3]
ds_read_b64_tr_b16 v[120:121], v169 offset:0
ds_read_b64_tr_b16 v[122:123], v169 offset:5120
ds_read_b64_tr_b16 v[124:125], v172 offset:32
v_mfma_f32_16x16x32_bf16 v[4:7], v[104:107], v[140:143], v[4:7]
ds_read_b64_tr_b16 v[126:127], v172 offset:5152
ds_read_b64_tr_b16 v[128:129], v169 offset:64
ds_read_b64_tr_b16 v[130:131], v169 offset:5184
v_mfma_f32_16x16x32_bf16 v[8:11], v[108:111], v[140:143], v[8:11]
ds_read_b64_tr_b16 v[132:133], v172 offset:96
ds_read_b64_tr_b16 v[134:135], v172 offset:5216
ds_read_b64_tr_b16 v[136:137], v169 offset:128
v_mfma_f32_16x16x32_bf16 v[12:15], v[112:115], v[140:143], v[12:15]
ds_read_b64_tr_b16 v[138:139], v169 offset:5248
ds_read_b128 v[160:163], v166 offset:0
v_mfma_f32_16x16x32_bf16 v[16:19], v[116:119], v[140:143], v[16:19]
s_waitcnt lgkmcnt(14)
ds_read_b128 v[140:143], v166 offset:1024
v_mfma_f32_16x16x32_bf16 v[20:23], v[100:103], v[144:147], v[20:23]
buffer_load_dwordx4 v250, s[8:11], s82 offen offset:2048 sc1 lds
v_mfma_f32_16x16x32_bf16 v[24:27], v[104:107], v[144:147], v[24:27]
buffer_load_dwordx4 v251, s[8:11], s82 offen offset:3072 sc1 lds
v_mfma_f32_16x16x32_bf16 v[28:31], v[108:111], v[144:147], v[28:31]
s_add_u32 m0, s85, 147456
v_mfma_f32_16x16x32_bf16 v[32:35], v[112:115], v[144:147], v[32:35]
buffer_load_dwordx4 v254, s[8:11], s82 offen sc1 lds
v_mfma_f32_16x16x32_bf16 v[36:39], v[116:119], v[144:147], v[36:39]
s_waitcnt lgkmcnt(14)
s_add_u32 s82, s82, s83
ds_read_b128 v[144:147], v166 offset:2048
v_mfma_f32_16x16x32_bf16 v[40:43], v[100:103], v[148:151], v[40:43]
v_mfma_f32_16x16x32_bf16 v[44:47], v[104:107], v[148:151], v[44:47]
v_mfma_f32_16x16x32_bf16 v[48:51], v[108:111], v[148:151], v[48:51]
v_mfma_f32_16x16x32_bf16 v[52:55], v[112:115], v[148:151], v[52:55]
v_mfma_f32_16x16x32_bf16 v[56:59], v[116:119], v[148:151], v[56:59]
s_waitcnt lgkmcnt(14)
ds_read_b128 v[148:151], v166 offset:3072
v_mfma_f32_16x16x32_bf16 v[60:63], v[100:103], v[152:155], v[60:63]
v_mfma_f32_16x16x32_bf16 v[64:67], v[104:107], v[152:155], v[64:67]
v_mfma_f32_16x16x32_bf16 v[68:71], v[108:111], v[152:155], v[68:71]
v_mfma_f32_16x16x32_bf16 v[72:75], v[112:115], v[152:155], v[72:75]
v_mfma_f32_16x16x32_bf16 v[76:79], v[116:119], v[152:155], v[76:79]
s_waitcnt lgkmcnt(14)
ds_read_b128 v[152:155], v166 offset:4096
v_mfma_f32_16x16x32_bf16 v[80:83], v[100:103], v[156:159], v[80:83]
v_mfma_f32_16x16x32_bf16 v[84:87], v[104:107], v[156:159], v[84:87]
v_mfma_f32_16x16x32_bf16 v[88:91], v[108:111], v[156:159], v[88:91]
v_mfma_f32_16x16x32_bf16 v[92:95], v[112:115], v[156:159], v[92:95]
v_mfma_f32_16x16x32_bf16 v[96:99], v[116:119], v[156:159], v[96:99]
s_waitcnt lgkmcnt(4)
v_mfma_f32_16x16x32_bf16 v[0:3], v[120:123], v[160:163], v[0:3]
v_mfma_f32_16x16x32_bf16 v[4:7], v[124:127], v[160:163], v[4:7]
v_mfma_f32_16x16x32_bf16 v[8:11], v[128:131], v[160:163], v[8:11]
v_mfma_f32_16x16x32_bf16 v[12:15], v[132:135], v[160:163], v[12:15]
v_mfma_f32_16x16x32_bf16 v[16:19], v[136:139], v[160:163], v[16:19]
s_waitcnt lgkmcnt(3)
v_mfma_f32_16x16x32_bf16 v[20:23], v[120:123], v[140:143], v[20:23]
v_mfma_f32_16x16x32_bf16 v[24:27], v[124:127], v[140:143], v[24:27]
v_mfma_f32_16x16x32_bf16 v[28:31], v[128:131], v[140:143], v[28:31]
v_mfma_f32_16x16x32_bf16 v[32:35], v[132:135], v[140:143], v[32:35]
s_waitcnt vmcnt(22) lgkmcnt(0)
s_barrier
ds_read_b64_tr_b16 v[100:101], v167 offset:20480
ds_read_b64_tr_b16 v[102:103], v167 offset:25600
v_mfma_f32_16x16x32_bf16 v[36:39], v[136:139], v[140:143], v[36:39]
s_waitcnt lgkmcnt(15)
ds_read_b64_tr_b16 v[104:105], v170 offset:20512
ds_read_b64_tr_b16 v[106:107], v170 offset:25632
ds_read_b64_tr_b16 v[108:109], v167 offset:20544
v_mfma_f32_16x16x32_bf16 v[40:43], v[120:123], v[144:147], v[40:43]
s_add_u32 m0, s85, 0
ds_read_b64_tr_b16 v[110:111], v167 offset:25664
ds_read_b64_tr_b16 v[112:113], v170 offset:20576
ds_read_b64_tr_b16 v[114:115], v170 offset:25696
v_mfma_f32_16x16x32_bf16 v[44:47], v[124:127], v[144:147], v[44:47]
ds_read_b64_tr_b16 v[116:117], v167 offset:20608
ds_read_b64_tr_b16 v[118:119], v167 offset:25728
ds_read_b128 v[156:159], v164 offset:20480
v_mfma_f32_16x16x32_bf16 v[48:51], v[128:131], v[144:147], v[48:51]
ds_read_b128 v[160:163], v164 offset:21504
ds_read_b128 v[140:143], v164 offset:22528
v_mfma_f32_16x16x32_bf16 v[52:55], v[132:135], v[144:147], v[52:55]
buffer_load_dwordx4 v248, s[8:11], s82 offen offset:0 sc1 lds
v_mfma_f32_16x16x32_bf16 v[56:59], v[136:139], v[144:147], v[56:59]
s_waitcnt lgkmcnt(15)
ds_read_b128 v[144:147], v164 offset:23552
v_mfma_f32_16x16x32_bf16 v[60:63], v[120:123], v[148:151], v[60:63]
buffer_load_dwordx4 v249, s[8:11], s82 offen offset:1024 sc1 lds
v_mfma_f32_16x16x32_bf16 v[64:67], v[124:127], v[148:151], v[64:67]
buffer_load_dwordx4 v250, s[8:11], s82 offen offset:2048 sc1 lds
v_mfma_f32_16x16x32_bf16 v[68:71], v[128:131], v[148:151], v[68:71]
buffer_load_dwordx4 v251, s[8:11], s82 offen offset:3072 sc1 lds
v_mfma_f32_16x16x32_bf16 v[72:75], v[132:135], v[148:151], v[72:75]
s_add_u32 m0, s85, 4096
v_mfma_f32_16x16x32_bf16 v[76:79], v[136:139], v[148:151], v[76:79]
s_waitcnt lgkmcnt(15)
ds_read_b128 v[148:151], v164 offset:24576
v_mfma_f32_16x16x32_bf16 v[80:83], v[120:123], v[152:155], v[80:83]
buffer_load_dwordx4 v254, s[8:11], s82 offen sc1 lds
v_mfma_f32_16x16x32_bf16 v[84:87], v[124:127], v[152:155], v[84:87]
s_add_u32 s82, s82, s83
s_add_u32 m0, s85, 122880
v_mfma_f32_16x16x32_bf16 v[88:91], v[128:131], v[152:155], v[88:91]
buffer_load_dwordx4 v248, s[8:11], s82 offen offset:0 sc1 lds
v_mfma_f32_16x16x32_bf16 v[92:95], v[132:135], v[152:155], v[92:95]
buffer_load_dwordx4 v249, s[8:11], s82 offen offset:1024 sc1 lds
v_mfma_f32_16x16x32_bf16 v[96:99], v[136:139], v[152:155], v[96:99]
s_waitcnt lgkmcnt(4)
s_waitcnt vmcnt(27)
s_barrier
s_add_u32 s43, s77, 4
s_cmp_lg_u32 s28, 0
s_cbranch_scc1 L_concat_heads__mha_block_cached__gqa_block_cached__near_ridge_kernel_sig1
v_mov_b32 v178, 1
v_mov_b32 v179, 0
s_waitcnt vmcnt(63)
s_mov_b64 exec, 1
buffer_atomic_add v178, v179, s[72:75], s43 offen sc1
s_mov_b64 exec, -1
L_concat_heads__mha_block_cached__gqa_block_cached__near_ridge_kernel_sig1:
v_mfma_f32_16x16x32_bf16 v[0:3], v[100:103], v[156:159], v[0:3]
ds_read_b64_tr_b16 v[120:121], v167 offset:40960
ds_read_b64_tr_b16 v[122:123], v167 offset:46080
ds_read_b64_tr_b16 v[124:125], v170 offset:40992
v_mfma_f32_16x16x32_bf16 v[4:7], v[104:107], v[156:159], v[4:7]
ds_read_b64_tr_b16 v[126:127], v170 offset:46112
ds_read_b64_tr_b16 v[128:129], v167 offset:41024
ds_read_b64_tr_b16 v[130:131], v167 offset:46144
v_mfma_f32_16x16x32_bf16 v[8:11], v[108:111], v[156:159], v[8:11]
ds_read_b64_tr_b16 v[132:133], v170 offset:41056
ds_read_b64_tr_b16 v[134:135], v170 offset:46176
ds_read_b64_tr_b16 v[136:137], v167 offset:41088
v_mfma_f32_16x16x32_bf16 v[12:15], v[112:115], v[156:159], v[12:15]
ds_read_b64_tr_b16 v[138:139], v167 offset:46208
ds_read_b128 v[152:155], v164 offset:40960
v_mfma_f32_16x16x32_bf16 v[16:19], v[116:119], v[156:159], v[16:19]
s_waitcnt lgkmcnt(14)
ds_read_b128 v[156:159], v164 offset:41984
v_mfma_f32_16x16x32_bf16 v[20:23], v[100:103], v[160:163], v[20:23]
buffer_load_dwordx4 v250, s[8:11], s82 offen offset:2048 sc1 lds
v_mfma_f32_16x16x32_bf16 v[24:27], v[104:107], v[160:163], v[24:27]
v_mfma_f32_16x16x32_bf16 v[28:31], v[108:111], v[160:163], v[28:31]
v_mfma_f32_16x16x32_bf16 v[32:35], v[112:115], v[160:163], v[32:35]
buffer_load_dwordx4 v251, s[8:11], s82 offen offset:3072 sc1 lds
v_mfma_f32_16x16x32_bf16 v[36:39], v[116:119], v[160:163], v[36:39]
s_waitcnt lgkmcnt(14)
s_add_u32 m0, s85, 126976
ds_read_b128 v[160:163], v164 offset:43008
v_mfma_f32_16x16x32_bf16 v[40:43], v[100:103], v[140:143], v[40:43]
v_mfma_f32_16x16x32_bf16 v[44:47], v[104:107], v[140:143], v[44:47]
buffer_load_dwordx4 v254, s[8:11], s82 offen sc1 lds
v_mfma_f32_16x16x32_bf16 v[48:51], v[108:111], v[140:143], v[48:51]
s_add_u32 s82, s82, s83
v_mfma_f32_16x16x32_bf16 v[52:55], v[112:115], v[140:143], v[52:55]
v_mfma_f32_16x16x32_bf16 v[56:59], v[116:119], v[140:143], v[56:59]
s_waitcnt lgkmcnt(14)
ds_read_b128 v[140:143], v164 offset:44032
v_mfma_f32_16x16x32_bf16 v[60:63], v[100:103], v[144:147], v[60:63]
v_mfma_f32_16x16x32_bf16 v[64:67], v[104:107], v[144:147], v[64:67]
v_mfma_f32_16x16x32_bf16 v[68:71], v[108:111], v[144:147], v[68:71]
v_mfma_f32_16x16x32_bf16 v[72:75], v[112:115], v[144:147], v[72:75]
v_mfma_f32_16x16x32_bf16 v[76:79], v[116:119], v[144:147], v[76:79]
s_waitcnt lgkmcnt(14)
ds_read_b128 v[144:147], v164 offset:45056
v_mfma_f32_16x16x32_bf16 v[80:83], v[100:103], v[148:151], v[80:83]
v_mfma_f32_16x16x32_bf16 v[84:87], v[104:107], v[148:151], v[84:87]
v_mfma_f32_16x16x32_bf16 v[88:91], v[108:111], v[148:151], v[88:91]
v_mfma_f32_16x16x32_bf16 v[92:95], v[112:115], v[148:151], v[92:95]
v_mfma_f32_16x16x32_bf16 v[96:99], v[116:119], v[148:151], v[96:99]
s_waitcnt lgkmcnt(4)
v_mfma_f32_16x16x32_bf16 v[0:3], v[120:123], v[152:155], v[0:3]
v_mfma_f32_16x16x32_bf16 v[4:7], v[124:127], v[152:155], v[4:7]
v_mfma_f32_16x16x32_bf16 v[8:11], v[128:131], v[152:155], v[8:11]
v_mfma_f32_16x16x32_bf16 v[12:15], v[132:135], v[152:155], v[12:15]
v_mfma_f32_16x16x32_bf16 v[16:19], v[136:139], v[152:155], v[16:19]
s_waitcnt lgkmcnt(3)
v_mfma_f32_16x16x32_bf16 v[20:23], v[120:123], v[156:159], v[20:23]
v_mfma_f32_16x16x32_bf16 v[24:27], v[124:127], v[156:159], v[24:27]
v_mfma_f32_16x16x32_bf16 v[28:31], v[128:131], v[156:159], v[28:31]
v_mfma_f32_16x16x32_bf16 v[32:35], v[132:135], v[156:159], v[32:35]
s_waitcnt vmcnt(20) lgkmcnt(0)
s_barrier
ds_read_b64_tr_b16 v[100:101], v168 offset:0
ds_read_b64_tr_b16 v[102:103], v168 offset:5120
v_mfma_f32_16x16x32_bf16 v[36:39], v[136:139], v[156:159], v[36:39]
s_waitcnt lgkmcnt(15)
ds_read_b64_tr_b16 v[104:105], v171 offset:32
ds_read_b64_tr_b16 v[106:107], v171 offset:5152
ds_read_b64_tr_b16 v[108:109], v168 offset:64
v_mfma_f32_16x16x32_bf16 v[40:43], v[120:123], v[160:163], v[40:43]
s_add_u32 m0, s85, 20480
ds_read_b64_tr_b16 v[110:111], v168 offset:5184
ds_read_b64_tr_b16 v[112:113], v171 offset:96
ds_read_b64_tr_b16 v[114:115], v171 offset:5216
v_mfma_f32_16x16x32_bf16 v[44:47], v[124:127], v[160:163], v[44:47]
ds_read_b64_tr_b16 v[116:117], v168 offset:128
ds_read_b64_tr_b16 v[118:119], v168 offset:5248
ds_read_b128 v[148:151], v165 offset:0
v_mfma_f32_16x16x32_bf16 v[48:51], v[128:131], v[160:163], v[48:51]
ds_read_b128 v[152:155], v165 offset:1024
ds_read_b128 v[156:159], v165 offset:2048
v_mfma_f32_16x16x32_bf16 v[52:55], v[132:135], v[160:163], v[52:55]
buffer_load_dwordx4 v248, s[8:11], s82 offen offset:0 sc1 lds
v_mfma_f32_16x16x32_bf16 v[56:59], v[136:139], v[160:163], v[56:59]
s_waitcnt lgkmcnt(15)
ds_read_b128 v[160:163], v165 offset:3072
v_mfma_f32_16x16x32_bf16 v[60:63], v[120:123], v[140:143], v[60:63]
v_mfma_f32_16x16x32_bf16 v[64:67], v[124:127], v[140:143], v[64:67]
buffer_load_dwordx4 v249, s[8:11], s82 offen offset:1024 sc1 lds
v_mfma_f32_16x16x32_bf16 v[68:71], v[128:131], v[140:143], v[68:71]
v_mfma_f32_16x16x32_bf16 v[72:75], v[132:135], v[140:143], v[72:75]
v_mfma_f32_16x16x32_bf16 v[76:79], v[136:139], v[140:143], v[76:79]
s_waitcnt lgkmcnt(15)
ds_read_b128 v[140:143], v165 offset:4096
v_mfma_f32_16x16x32_bf16 v[80:83], v[120:123], v[144:147], v[80:83]
buffer_load_dwordx4 v250, s[8:11], s82 offen offset:2048 sc1 lds
v_mfma_f32_16x16x32_bf16 v[84:87], v[124:127], v[144:147], v[84:87]
v_mfma_f32_16x16x32_bf16 v[88:91], v[128:131], v[144:147], v[88:91]
v_mfma_f32_16x16x32_bf16 v[92:95], v[132:135], v[144:147], v[92:95]
buffer_load_dwordx4 v251, s[8:11], s82 offen offset:3072 sc1 lds
v_mfma_f32_16x16x32_bf16 v[96:99], v[136:139], v[144:147], v[96:99]
s_waitcnt lgkmcnt(4)
s_add_u32 m0, s85, 24576
v_mfma_f32_16x16x32_bf16 v[0:3], v[100:103], v[148:151], v[0:3]
ds_read_b64_tr_b16 v[120:121], v168 offset:20480
ds_read_b64_tr_b16 v[122:123], v168 offset:25600
v_mfma_f32_16x16x32_bf16 v[4:7], v[104:107], v[148:151], v[4:7]
ds_read_b64_tr_b16 v[124:125], v171 offset:20512
ds_read_b64_tr_b16 v[126:127], v171 offset:25632
v_mfma_f32_16x16x32_bf16 v[8:11], v[108:111], v[148:151], v[8:11]
ds_read_b64_tr_b16 v[128:129], v168 offset:20544
ds_read_b64_tr_b16 v[130:131], v168 offset:25664
v_mfma_f32_16x16x32_bf16 v[12:15], v[112:115], v[148:151], v[12:15]
ds_read_b64_tr_b16 v[132:133], v171 offset:20576
ds_read_b64_tr_b16 v[134:135], v171 offset:25696
v_mfma_f32_16x16x32_bf16 v[16:19], v[116:119], v[148:151], v[16:19]
s_waitcnt lgkmcnt(11)
ds_read_b64_tr_b16 v[136:137], v168 offset:20608
ds_read_b64_tr_b16 v[138:139], v168 offset:25728
v_mfma_f32_16x16x32_bf16 v[20:23], v[100:103], v[152:155], v[20:23]
ds_read_b128 v[144:147], v165 offset:20480
ds_read_b128 v[148:151], v165 offset:21504
v_mfma_f32_16x16x32_bf16 v[24:27], v[104:107], v[152:155], v[24:27]
buffer_load_dwordx4 v254, s[8:11], s82 offen sc1 lds
v_mfma_f32_16x16x32_bf16 v[28:31], v[108:111], v[152:155], v[28:31]
s_add_u32 s82, s82, s83
s_add_u32 m0, s85, 40960
v_mfma_f32_16x16x32_bf16 v[32:35], v[112:115], v[152:155], v[32:35]
v_mfma_f32_16x16x32_bf16 v[36:39], v[116:119], v[152:155], v[36:39]
s_waitcnt lgkmcnt(14)
ds_read_b128 v[152:155], v165 offset:22528
v_mfma_f32_16x16x32_bf16 v[40:43], v[100:103], v[156:159], v[40:43]
buffer_load_dwordx4 v248, s[8:11], s82 offen offset:0 sc1 lds
v_mfma_f32_16x16x32_bf16 v[44:47], v[104:107], v[156:159], v[44:47]
v_mfma_f32_16x16x32_bf16 v[48:51], v[108:111], v[156:159], v[48:51]
v_mfma_f32_16x16x32_bf16 v[52:55], v[112:115], v[156:159], v[52:55]
buffer_load_dwordx4 v249, s[8:11], s82 offen offset:1024 sc1 lds
v_mfma_f32_16x16x32_bf16 v[56:59], v[116:119], v[156:159], v[56:59]
s_waitcnt lgkmcnt(14)
ds_read_b128 v[156:159], v165 offset:23552
v_mfma_f32_16x16x32_bf16 v[60:63], v[100:103], v[160:163], v[60:63]
v_mfma_f32_16x16x32_bf16 v[64:67], v[104:107], v[160:163], v[64:67]
buffer_load_dwordx4 v250, s[8:11], s82 offen offset:2048 sc1 lds
v_mfma_f32_16x16x32_bf16 v[68:71], v[108:111], v[160:163], v[68:71]
v_mfma_f32_16x16x32_bf16 v[72:75], v[112:115], v[160:163], v[72:75]
v_mfma_f32_16x16x32_bf16 v[76:79], v[116:119], v[160:163], v[76:79]
s_waitcnt lgkmcnt(14)
ds_read_b128 v[160:163], v165 offset:24576
v_mfma_f32_16x16x32_bf16 v[80:83], v[100:103], v[140:143], v[80:83]
buffer_load_dwordx4 v251, s[8:11], s82 offen offset:3072 sc1 lds
v_mfma_f32_16x16x32_bf16 v[84:87], v[104:107], v[140:143], v[84:87]
s_add_u32 m0, s85, 45056
v_mfma_f32_16x16x32_bf16 v[88:91], v[108:111], v[140:143], v[88:91]
v_mfma_f32_16x16x32_bf16 v[92:95], v[112:115], v[140:143], v[92:95]
buffer_load_dwordx4 v254, s[8:11], s82 offen sc1 lds
v_mfma_f32_16x16x32_bf16 v[96:99], v[116:119], v[140:143], v[96:99]
s_waitcnt lgkmcnt(4)
s_add_u32 s66, s66, 1
s_and_b32 s66, s66, 3
v_mfma_f32_16x16x32_bf16 v[0:3], v[120:123], v[144:147], v[0:3]
s_mul_i32 s40, s66, 24
s_add_u32 s40, s40, 0
s_mul_i32 s40, s40, s83
v_mfma_f32_16x16x32_bf16 v[4:7], v[124:127], v[144:147], v[4:7]
s_add_u32 s82, s67, s40
v_mfma_f32_16x16x32_bf16 v[8:11], v[128:131], v[144:147], v[8:11]
v_mfma_f32_16x16x32_bf16 v[12:15], v[132:135], v[144:147], v[12:15]
v_mfma_f32_16x16x32_bf16 v[16:19], v[136:139], v[144:147], v[16:19]
s_waitcnt lgkmcnt(3)
v_mfma_f32_16x16x32_bf16 v[20:23], v[120:123], v[148:151], v[20:23]
v_mfma_f32_16x16x32_bf16 v[24:27], v[124:127], v[148:151], v[24:27]
v_mfma_f32_16x16x32_bf16 v[28:31], v[128:131], v[148:151], v[28:31]
v_mfma_f32_16x16x32_bf16 v[32:35], v[132:135], v[148:151], v[32:35]
s_waitcnt vmcnt(20) lgkmcnt(0)
s_barrier
ds_read_b64_tr_b16 v[100:101], v168 offset:40960
v_mfma_f32_16x16x32_bf16 v[36:39], v[136:139], v[148:151], v[36:39]
s_waitcnt lgkmcnt(15)
ds_read_b64_tr_b16 v[102:103], v168 offset:46080
ds_read_b64_tr_b16 v[104:105], v171 offset:40992
v_mfma_f32_16x16x32_bf16 v[40:43], v[120:123], v[152:155], v[40:43]
s_add_u32 m0, s85, 61440
ds_read_b64_tr_b16 v[106:107], v171 offset:46112
ds_read_b64_tr_b16 v[108:109], v168 offset:41024
v_mfma_f32_16x16x32_bf16 v[44:47], v[124:127], v[152:155], v[44:47]
ds_read_b64_tr_b16 v[110:111], v168 offset:46144
ds_read_b64_tr_b16 v[112:113], v171 offset:41056
v_mfma_f32_16x16x32_bf16 v[48:51], v[128:131], v[152:155], v[48:51]
ds_read_b64_tr_b16 v[114:115], v171 offset:46176
ds_read_b64_tr_b16 v[116:117], v168 offset:41088
v_mfma_f32_16x16x32_bf16 v[52:55], v[132:135], v[152:155], v[52:55]
ds_read_b64_tr_b16 v[118:119], v168 offset:46208
ds_read_b128 v[140:143], v165 offset:40960
v_mfma_f32_16x16x32_bf16 v[56:59], v[136:139], v[152:155], v[56:59]
s_waitcnt lgkmcnt(15)
ds_read_b128 v[144:147], v165 offset:41984
ds_read_b128 v[148:151], v165 offset:43008
v_mfma_f32_16x16x32_bf16 v[60:63], v[120:123], v[156:159], v[60:63]
ds_read_b128 v[152:155], v165 offset:44032
v_mfma_f32_16x16x32_bf16 v[64:67], v[124:127], v[156:159], v[64:67]
buffer_load_dwordx4 v248, s[8:11], s82 offen offset:0 sc1 lds
v_mfma_f32_16x16x32_bf16 v[68:71], v[128:131], v[156:159], v[68:71]
v_mfma_f32_16x16x32_bf16 v[72:75], v[132:135], v[156:159], v[72:75]
v_mfma_f32_16x16x32_bf16 v[76:79], v[136:139], v[156:159], v[76:79]
s_waitcnt lgkmcnt(15)
ds_read_b128 v[156:159], v165 offset:45056
v_mfma_f32_16x16x32_bf16 v[80:83], v[120:123], v[160:163], v[80:83]
buffer_load_dwordx4 v249, s[8:11], s82 offen offset:1024 sc1 lds
v_mfma_f32_16x16x32_bf16 v[84:87], v[124:127], v[160:163], v[84:87]
v_mfma_f32_16x16x32_bf16 v[88:91], v[128:131], v[160:163], v[88:91]
v_mfma_f32_16x16x32_bf16 v[92:95], v[132:135], v[160:163], v[92:95]
buffer_load_dwordx4 v250, s[8:11], s82 offen offset:2048 sc1 lds
v_mfma_f32_16x16x32_bf16 v[96:99], v[136:139], v[160:163], v[96:99]
s_waitcnt lgkmcnt(4)
v_mfma_f32_16x16x32_bf16 v[0:3], v[100:103], v[140:143], v[0:3]
ds_read_b64_tr_b16 v[120:121], v169 offset:20480
ds_read_b64_tr_b16 v[122:123], v169 offset:25600
v_mfma_f32_16x16x32_bf16 v[4:7], v[104:107], v[140:143], v[4:7]
ds_read_b64_tr_b16 v[124:125], v172 offset:20512
ds_read_b64_tr_b16 v[126:127], v172 offset:25632
v_mfma_f32_16x16x32_bf16 v[8:11], v[108:111], v[140:143], v[8:11]
ds_read_b64_tr_b16 v[128:129], v169 offset:20544
ds_read_b64_tr_b16 v[130:131], v169 offset:25664
v_mfma_f32_16x16x32_bf16 v[12:15], v[112:115], v[140:143], v[12:15]
ds_read_b64_tr_b16 v[132:133], v172 offset:20576
ds_read_b64_tr_b16 v[134:135], v172 offset:25696
v_mfma_f32_16x16x32_bf16 v[16:19], v[116:119], v[140:143], v[16:19]
s_waitcnt lgkmcnt(11)
ds_read_b64_tr_b16 v[136:137], v169 offset:20608
ds_read_b64_tr_b16 v[138:139], v169 offset:25728
v_mfma_f32_16x16x32_bf16 v[20:23], v[100:103], v[144:147], v[20:23]
ds_read_b128 v[160:163], v166 offset:20480
ds_read_b128 v[140:143], v166 offset:21504
v_mfma_f32_16x16x32_bf16 v[24:27], v[104:107], v[144:147], v[24:27]
buffer_load_dwordx4 v251, s[8:11], s82 offen offset:3072 sc1 lds
v_mfma_f32_16x16x32_bf16 v[28:31], v[108:111], v[144:147], v[28:31]
s_add_u32 m0, s85, 65536
v_mfma_f32_16x16x32_bf16 v[32:35], v[112:115], v[144:147], v[32:35]
v_mfma_f32_16x16x32_bf16 v[36:39], v[116:119], v[144:147], v[36:39]
s_waitcnt lgkmcnt(14)
ds_read_b128 v[144:147], v166 offset:22528
v_mfma_f32_16x16x32_bf16 v[40:43], v[100:103], v[148:151], v[40:43]
buffer_load_dwordx4 v254, s[8:11], s82 offen sc1 lds
v_mfma_f32_16x16x32_bf16 v[44:47], v[104:107], v[148:151], v[44:47]
s_add_u32 s82, s82, s83
s_add_u32 m0, s85, 81920
v_mfma_f32_16x16x32_bf16 v[48:51], v[108:111], v[148:151], v[48:51]
v_mfma_f32_16x16x32_bf16 v[52:55], v[112:115], v[148:151], v[52:55]
buffer_load_dwordx4 v248, s[8:11], s82 offen offset:0 sc1 lds
v_mfma_f32_16x16x32_bf16 v[56:59], v[116:119], v[148:151], v[56:59]
s_waitcnt lgkmcnt(14)
ds_read_b128 v[148:151], v166 offset:23552
v_mfma_f32_16x16x32_bf16 v[60:63], v[100:103], v[152:155], v[60:63]
v_mfma_f32_16x16x32_bf16 v[64:67], v[104:107], v[152:155], v[64:67]
buffer_load_dwordx4 v249, s[8:11], s82 offen offset:1024 sc1 lds
v_mfma_f32_16x16x32_bf16 v[68:71], v[108:111], v[152:155], v[68:71]
v_mfma_f32_16x16x32_bf16 v[72:75], v[112:115], v[152:155], v[72:75]
v_mfma_f32_16x16x32_bf16 v[76:79], v[116:119], v[152:155], v[76:79]
s_waitcnt lgkmcnt(14)
ds_read_b128 v[152:155], v166 offset:24576
v_mfma_f32_16x16x32_bf16 v[80:83], v[100:103], v[156:159], v[80:83]
buffer_load_dwordx4 v250, s[8:11], s82 offen offset:2048 sc1 lds
v_mfma_f32_16x16x32_bf16 v[84:87], v[104:107], v[156:159], v[84:87]
v_mfma_f32_16x16x32_bf16 v[88:91], v[108:111], v[156:159], v[88:91]
v_mfma_f32_16x16x32_bf16 v[92:95], v[112:115], v[156:159], v[92:95]
buffer_load_dwordx4 v251, s[8:11], s82 offen offset:3072 sc1 lds
v_mfma_f32_16x16x32_bf16 v[96:99], v[116:119], v[156:159], v[96:99]
s_waitcnt lgkmcnt(4)
s_add_u32 m0, s85, 86016
v_mfma_f32_16x16x32_bf16 v[0:3], v[120:123], v[160:163], v[0:3]
v_mfma_f32_16x16x32_bf16 v[4:7], v[124:127], v[160:163], v[4:7]
buffer_load_dwordx4 v254, s[8:11], s82 offen sc1 lds
v_mfma_f32_16x16x32_bf16 v[8:11], v[128:131], v[160:163], v[8:11]
s_add_u32 s82, s82, s83
v_mfma_f32_16x16x32_bf16 v[12:15], v[132:135], v[160:163], v[12:15]
v_mfma_f32_16x16x32_bf16 v[16:19], v[136:139], v[160:163], v[16:19]
s_waitcnt lgkmcnt(3)
v_mfma_f32_16x16x32_bf16 v[20:23], v[120:123], v[140:143], v[20:23]
v_mfma_f32_16x16x32_bf16 v[24:27], v[124:127], v[140:143], v[24:27]
v_mfma_f32_16x16x32_bf16 v[28:31], v[128:131], v[140:143], v[28:31]
v_mfma_f32_16x16x32_bf16 v[32:35], v[132:135], v[140:143], v[32:35]
s_waitcnt vmcnt(20) lgkmcnt(0)
s_barrier
ds_read_b64_tr_b16 v[100:101], v167 offset:0
v_mfma_f32_16x16x32_bf16 v[36:39], v[136:139], v[140:143], v[36:39]
s_waitcnt lgkmcnt(15)
ds_read_b64_tr_b16 v[102:103], v167 offset:5120
ds_read_b64_tr_b16 v[104:105], v170 offset:32
v_mfma_f32_16x16x32_bf16 v[40:43], v[120:123], v[144:147], v[40:43]
s_add_u32 m0, s85, 102400
ds_read_b64_tr_b16 v[106:107], v170 offset:5152
ds_read_b64_tr_b16 v[108:109], v167 offset:64
v_mfma_f32_16x16x32_bf16 v[44:47], v[124:127], v[144:147], v[44:47]
ds_read_b64_tr_b16 v[110:111], v167 offset:5184
ds_read_b64_tr_b16 v[112:113], v170 offset:96
v_mfma_f32_16x16x32_bf16 v[48:51], v[128:131], v[144:147], v[48:51]
ds_read_b64_tr_b16 v[114:115], v170 offset:5216
ds_read_b64_tr_b16 v[116:117], v167 offset:128
v_mfma_f32_16x16x32_bf16 v[52:55], v[132:135], v[144:147], v[52:55]
ds_read_b64_tr_b16 v[118:119], v167 offset:5248
ds_read_b128 v[156:159], v164 offset:0
v_mfma_f32_16x16x32_bf16 v[56:59], v[136:139], v[144:147], v[56:59]
s_waitcnt lgkmcnt(15)
ds_read_b128 v[160:163], v164 offset:1024
ds_read_b128 v[140:143], v164 offset:2048
v_mfma_f32_16x16x32_bf16 v[60:63], v[120:123], v[148:151], v[60:63]
ds_read_b128 v[144:147], v164 offset:3072
v_mfma_f32_16x16x32_bf16 v[64:67], v[124:127], v[148:151], v[64:67]
buffer_load_dwordx4 v248, s[8:11], s82 offen offset:0 sc1 lds
v_mfma_f32_16x16x32_bf16 v[68:71], v[128:131], v[148:151], v[68:71]
v_mfma_f32_16x16x32_bf16 v[72:75], v[132:135], v[148:151], v[72:75]
v_mfma_f32_16x16x32_bf16 v[76:79], v[136:139], v[148:151], v[76:79]
s_waitcnt lgkmcnt(15)
ds_read_b128 v[148:151], v164 offset:4096
v_mfma_f32_16x16x32_bf16 v[80:83], v[120:123], v[152:155], v[80:83]
buffer_load_dwordx4 v249, s[8:11], s82 offen offset:1024 sc1 lds
v_mfma_f32_16x16x32_bf16 v[84:87], v[124:127], v[152:155], v[84:87]
v_mfma_f32_16x16x32_bf16 v[88:91], v[128:131], v[152:155], v[88:91]
v_mfma_f32_16x16x32_bf16 v[92:95], v[132:135], v[152:155], v[92:95]
buffer_load_dwordx4 v250, s[8:11], s82 offen offset:2048 sc1 lds
v_mfma_f32_16x16x32_bf16 v[96:99], v[136:139], v[152:155], v[96:99]
s_waitcnt lgkmcnt(4)
v_mfma_f32_16x16x32_bf16 v[0:3], v[100:103], v[156:159], v[0:3]
ds_read_b64_tr_b16 v[120:121], v169 offset:0
ds_read_b64_tr_b16 v[122:123], v169 offset:5120
v_mfma_f32_16x16x32_bf16 v[4:7], v[104:107], v[156:159], v[4:7]
ds_read_b64_tr_b16 v[124:125], v172 offset:32
ds_read_b64_tr_b16 v[126:127], v172 offset:5152
v_mfma_f32_16x16x32_bf16 v[8:11], v[108:111], v[156:159], v[8:11]
ds_read_b64_tr_b16 v[128:129], v169 offset:64
ds_read_b64_tr_b16 v[130:131], v169 offset:5184
v_mfma_f32_16x16x32_bf16 v[12:15], v[112:115], v[156:159], v[12:15]
ds_read_b64_tr_b16 v[132:133], v172 offset:96
ds_read_b64_tr_b16 v[134:135], v172 offset:5216
v_mfma_f32_16x16x32_bf16 v[16:19], v[116:119], v[156:159], v[16:19]
s_waitcnt lgkmcnt(11)
ds_read_b64_tr_b16 v[136:137], v169 offset:128
ds_read_b64_tr_b16 v[138:139], v169 offset:5248
v_mfma_f32_16x16x32_bf16 v[20:23], v[100:103], v[160:163], v[20:23]
ds_read_b128 v[152:155], v166 offset:0
ds_read_b128 v[156:159], v166 offset:1024
v_mfma_f32_16x16x32_bf16 v[24:27], v[104:107], v[160:163], v[24:27]
buffer_load_dwordx4 v251, s[8:11], s82 offen offset:3072 sc1 lds
v_mfma_f32_16x16x32_bf16 v[28:31], v[108:111], v[160:163], v[28:31]
s_add_u32 m0, s85, 106496
v_mfma_f32_16x16x32_bf16 v[32:35], v[112:115], v[160:163], v[32:35]
v_mfma_f32_16x16x32_bf16 v[36:39], v[116:119], v[160:163], v[36:39]
s_waitcnt lgkmcnt(14)
ds_read_b128 v[160:163], v166 offset:2048
v_mfma_f32_16x16x32_bf16 v[40:43], v[100:103], v[140:143], v[40:43]
buffer_load_dwordx4 v254, s[8:11], s82 offen sc1 lds
v_mfma_f32_16x16x32_bf16 v[44:47], v[104:107], v[140:143], v[44:47]
s_add_u32 s82, s82, s83
s_add_u32 m0, s85, 143360
v_mfma_f32_16x16x32_bf16 v[48:51], v[108:111], v[140:143], v[48:51]
v_mfma_f32_16x16x32_bf16 v[52:55], v[112:115], v[140:143], v[52:55]
buffer_load_dwordx4 v248, s[8:11], s82 offen offset:0 sc1 lds
v_mfma_f32_16x16x32_bf16 v[56:59], v[116:119], v[140:143], v[56:59]
s_waitcnt lgkmcnt(14)
ds_read_b128 v[140:143], v166 offset:3072
v_mfma_f32_16x16x32_bf16 v[60:63], v[100:103], v[144:147], v[60:63]
v_mfma_f32_16x16x32_bf16 v[64:67], v[104:107], v[144:147], v[64:67]
buffer_load_dwordx4 v249, s[8:11], s82 offen offset:1024 sc1 lds
v_mfma_f32_16x16x32_bf16 v[68:71], v[108:111], v[144:147], v[68:71]
v_mfma_f32_16x16x32_bf16 v[72:75], v[112:115], v[144:147], v[72:75]
v_mfma_f32_16x16x32_bf16 v[76:79], v[116:119], v[144:147], v[76:79]
s_waitcnt lgkmcnt(14)
ds_read_b128 v[144:147], v166 offset:4096
v_mfma_f32_16x16x32_bf16 v[80:83], v[100:103], v[148:151], v[80:83]
buffer_load_dwordx4 v250, s[8:11], s82 offen offset:2048 sc1 lds
v_mfma_f32_16x16x32_bf16 v[84:87], v[104:107], v[148:151], v[84:87]
v_mfma_f32_16x16x32_bf16 v[88:91], v[108:111], v[148:151], v[88:91]
v_mfma_f32_16x16x32_bf16 v[92:95], v[112:115], v[148:151], v[92:95]
buffer_load_dwordx4 v251, s[8:11], s82 offen offset:3072 sc1 lds
v_mfma_f32_16x16x32_bf16 v[96:99], v[116:119], v[148:151], v[96:99]
s_waitcnt lgkmcnt(4)
s_add_u32 m0, s85, 147456
v_mfma_f32_16x16x32_bf16 v[0:3], v[120:123], v[152:155], v[0:3]
v_mfma_f32_16x16x32_bf16 v[4:7], v[124:127], v[152:155], v[4:7]
buffer_load_dwordx4 v254, s[8:11], s82 offen sc1 lds
v_mfma_f32_16x16x32_bf16 v[8:11], v[128:131], v[152:155], v[8:11]
s_add_u32 s82, s82, s83
v_mfma_f32_16x16x32_bf16 v[12:15], v[132:135], v[152:155], v[12:15]
v_mfma_f32_16x16x32_bf16 v[16:19], v[136:139], v[152:155], v[16:19]
s_waitcnt lgkmcnt(3)
v_mfma_f32_16x16x32_bf16 v[20:23], v[120:123], v[156:159], v[20:23]
v_mfma_f32_16x16x32_bf16 v[24:27], v[124:127], v[156:159], v[24:27]
v_mfma_f32_16x16x32_bf16 v[28:31], v[128:131], v[156:159], v[28:31]
v_mfma_f32_16x16x32_bf16 v[32:35], v[132:135], v[156:159], v[32:35]
s_waitcnt vmcnt(20) lgkmcnt(0)
s_barrier
ds_read_b64_tr_b16 v[100:101], v167 offset:20480
v_mfma_f32_16x16x32_bf16 v[36:39], v[136:139], v[156:159], v[36:39]
s_waitcnt lgkmcnt(15)
ds_read_b64_tr_b16 v[102:103], v167 offset:25600
ds_read_b64_tr_b16 v[104:105], v170 offset:20512
v_mfma_f32_16x16x32_bf16 v[40:43], v[120:123], v[160:163], v[40:43]
s_add_u32 m0, s85, 0
ds_read_b64_tr_b16 v[106:107], v170 offset:25632
ds_read_b64_tr_b16 v[108:109], v167 offset:20544
v_mfma_f32_16x16x32_bf16 v[44:47], v[124:127], v[160:163], v[44:47]
ds_read_b64_tr_b16 v[110:111], v167 offset:25664
ds_read_b64_tr_b16 v[112:113], v170 offset:20576
v_mfma_f32_16x16x32_bf16 v[48:51], v[128:131], v[160:163], v[48:51]
ds_read_b64_tr_b16 v[114:115], v170 offset:25696
ds_read_b64_tr_b16 v[116:117], v167 offset:20608
v_mfma_f32_16x16x32_bf16 v[52:55], v[132:135], v[160:163], v[52:55]
ds_read_b64_tr_b16 v[118:119], v167 offset:25728
ds_read_b128 v[148:151], v164 offset:20480
v_mfma_f32_16x16x32_bf16 v[56:59], v[136:139], v[160:163], v[56:59]
s_waitcnt lgkmcnt(15)
ds_read_b128 v[152:155], v164 offset:21504
ds_read_b128 v[156:159], v164 offset:22528
v_mfma_f32_16x16x32_bf16 v[60:63], v[120:123], v[140:143], v[60:63]
ds_read_b128 v[160:163], v164 offset:23552
v_mfma_f32_16x16x32_bf16 v[64:67], v[124:127], v[140:143], v[64:67]
buffer_load_dwordx4 v248, s[8:11], s82 offen offset:0 sc1 lds
v_mfma_f32_16x16x32_bf16 v[68:71], v[128:131], v[140:143], v[68:71]
v_mfma_f32_16x16x32_bf16 v[72:75], v[132:135], v[140:143], v[72:75]
v_mfma_f32_16x16x32_bf16 v[76:79], v[136:139], v[140:143], v[76:79]
s_waitcnt lgkmcnt(15)
ds_read_b128 v[140:143], v164 offset:24576
v_mfma_f32_16x16x32_bf16 v[80:83], v[120:123], v[144:147], v[80:83]
buffer_load_dwordx4 v249, s[8:11], s82 offen offset:1024 sc1 lds
v_mfma_f32_16x16x32_bf16 v[84:87], v[124:127], v[144:147], v[84:87]
v_mfma_f32_16x16x32_bf16 v[88:91], v[128:131], v[144:147], v[88:91]
v_mfma_f32_16x16x32_bf16 v[92:95], v[132:135], v[144:147], v[92:95]
buffer_load_dwordx4 v250, s[8:11], s82 offen offset:2048 sc1 lds
v_mfma_f32_16x16x32_bf16 v[96:99], v[136:139], v[144:147], v[96:99]
s_waitcnt lgkmcnt(4)
s_add_u32 s78, s77, 4
buffer_load_dword v195, v194, s[72:75], s78 offen sc1
v_mfma_f32_16x16x32_bf16 v[0:3], v[100:103], v[148:151], v[0:3]
ds_read_b64_tr_b16 v[120:121], v167 offset:40960
ds_read_b64_tr_b16 v[122:123], v167 offset:46080
v_mfma_f32_16x16x32_bf16 v[4:7], v[104:107], v[148:151], v[4:7]
ds_read_b64_tr_b16 v[124:125], v170 offset:40992
ds_read_b64_tr_b16 v[126:127], v170 offset:46112
v_mfma_f32_16x16x32_bf16 v[8:11], v[108:111], v[148:151], v[8:11]
ds_read_b64_tr_b16 v[128:129], v167 offset:41024
ds_read_b64_tr_b16 v[130:131], v167 offset:46144
v_mfma_f32_16x16x32_bf16 v[12:15], v[112:115], v[148:151], v[12:15]
ds_read_b64_tr_b16 v[132:133], v170 offset:41056
ds_read_b64_tr_b16 v[134:135], v170 offset:46176
v_mfma_f32_16x16x32_bf16 v[16:19], v[116:119], v[148:151], v[16:19]
s_waitcnt lgkmcnt(11)
ds_read_b64_tr_b16 v[136:137], v167 offset:41088
ds_read_b64_tr_b16 v[138:139], v167 offset:46208
v_mfma_f32_16x16x32_bf16 v[20:23], v[100:103], v[152:155], v[20:23]
ds_read_b128 v[144:147], v164 offset:40960
ds_read_b128 v[148:151], v164 offset:41984
v_mfma_f32_16x16x32_bf16 v[24:27], v[104:107], v[152:155], v[24:27]
buffer_load_dwordx4 v251, s[8:11], s82 offen offset:3072 sc1 lds
v_mfma_f32_16x16x32_bf16 v[28:31], v[108:111], v[152:155], v[28:31]
s_add_u32 m0, s85, 4096
v_mfma_f32_16x16x32_bf16 v[32:35], v[112:115], v[152:155], v[32:35]
v_mfma_f32_16x16x32_bf16 v[36:39], v[116:119], v[152:155], v[36:39]
s_waitcnt lgkmcnt(14)
ds_read_b128 v[152:155], v164 offset:43008
v_mfma_f32_16x16x32_bf16 v[40:43], v[100:103], v[156:159], v[40:43]
buffer_load_dwordx4 v254, s[8:11], s82 offen sc1 lds
v_mfma_f32_16x16x32_bf16 v[44:47], v[104:107], v[156:159], v[44:47]
s_add_u32 s82, s82, s83
s_add_u32 m0, s85, 122880
v_mfma_f32_16x16x32_bf16 v[48:51], v[108:111], v[156:159], v[48:51]
v_mfma_f32_16x16x32_bf16 v[52:55], v[112:115], v[156:159], v[52:55]
buffer_load_dwordx4 v248, s[8:11], s82 offen offset:0 sc1 lds
v_mfma_f32_16x16x32_bf16 v[56:59], v[116:119], v[156:159], v[56:59]
s_waitcnt lgkmcnt(14)
ds_read_b128 v[156:159], v164 offset:44032
v_mfma_f32_16x16x32_bf16 v[60:63], v[100:103], v[160:163], v[60:63]
v_mfma_f32_16x16x32_bf16 v[64:67], v[104:107], v[160:163], v[64:67]
buffer_load_dwordx4 v249, s[8:11], s82 offen offset:1024 sc1 lds
v_mfma_f32_16x16x32_bf16 v[68:71], v[108:111], v[160:163], v[68:71]
v_mfma_f32_16x16x32_bf16 v[72:75], v[112:115], v[160:163], v[72:75]
v_mfma_f32_16x16x32_bf16 v[76:79], v[116:119], v[160:163], v[76:79]
s_waitcnt lgkmcnt(14)
ds_read_b128 v[160:163], v164 offset:45056
v_mfma_f32_16x16x32_bf16 v[80:83], v[100:103], v[140:143], v[80:83]
buffer_load_dwordx4 v250, s[8:11], s82 offen offset:2048 sc1 lds
v_mfma_f32_16x16x32_bf16 v[84:87], v[104:107], v[140:143], v[84:87]
v_mfma_f32_16x16x32_bf16 v[88:91], v[108:111], v[140:143], v[88:91]
v_mfma_f32_16x16x32_bf16 v[92:95], v[112:115], v[140:143], v[92:95]
buffer_load_dwordx4 v251, s[8:11], s82 offen offset:3072 sc1 lds
v_mfma_f32_16x16x32_bf16 v[96:99], v[116:119], v[140:143], v[96:99]
s_waitcnt lgkmcnt(4)
s_add_u32 m0, s85, 126976
v_mfma_f32_16x16x32_bf16 v[0:3], v[120:123], v[144:147], v[0:3]
v_mfma_f32_16x16x32_bf16 v[4:7], v[124:127], v[144:147], v[4:7]
buffer_load_dwordx4 v254, s[8:11], s82 offen sc1 lds
v_mfma_f32_16x16x32_bf16 v[8:11], v[128:131], v[144:147], v[8:11]
s_add_u32 s82, s82, s83
v_mfma_f32_16x16x32_bf16 v[12:15], v[132:135], v[144:147], v[12:15]
v_mfma_f32_16x16x32_bf16 v[16:19], v[136:139], v[144:147], v[16:19]
s_waitcnt lgkmcnt(3)
v_mfma_f32_16x16x32_bf16 v[20:23], v[120:123], v[148:151], v[20:23]
v_mfma_f32_16x16x32_bf16 v[24:27], v[124:127], v[148:151], v[24:27]
v_mfma_f32_16x16x32_bf16 v[28:31], v[128:131], v[148:151], v[28:31]
v_mfma_f32_16x16x32_bf16 v[32:35], v[132:135], v[148:151], v[32:35]
s_waitcnt vmcnt(21) lgkmcnt(0)
s_barrier
ds_read_b64_tr_b16 v[100:101], v168 offset:0
v_mfma_f32_16x16x32_bf16 v[36:39], v[136:139], v[148:151], v[36:39]
s_waitcnt lgkmcnt(15)
ds_read_b64_tr_b16 v[102:103], v168 offset:5120
ds_read_b64_tr_b16 v[104:105], v171 offset:32
v_mfma_f32_16x16x32_bf16 v[40:43], v[120:123], v[152:155], v[40:43]
s_add_u32 m0, s85, 20480
ds_read_b64_tr_b16 v[106:107], v171 offset:5152
ds_read_b64_tr_b16 v[108:109], v168 offset:64
v_mfma_f32_16x16x32_bf16 v[44:47], v[124:127], v[152:155], v[44:47]
ds_read_b64_tr_b16 v[110:111], v168 offset:5184
ds_read_b64_tr_b16 v[112:113], v171 offset:96
v_mfma_f32_16x16x32_bf16 v[48:51], v[128:131], v[152:155], v[48:51]
ds_read_b64_tr_b16 v[114:115], v171 offset:5216
ds_read_b64_tr_b16 v[116:117], v168 offset:128
v_mfma_f32_16x16x32_bf16 v[52:55], v[132:135], v[152:155], v[52:55]
ds_read_b64_tr_b16 v[118:119], v168 offset:5248
ds_read_b128 v[140:143], v165 offset:0
v_mfma_f32_16x16x32_bf16 v[56:59], v[136:139], v[152:155], v[56:59]
s_waitcnt lgkmcnt(15)
ds_read_b128 v[144:147], v165 offset:1024
ds_read_b128 v[148:151], v165 offset:2048
v_mfma_f32_16x16x32_bf16 v[60:63], v[120:123], v[156:159], v[60:63]
ds_read_b128 v[152:155], v165 offset:3072
v_mfma_f32_16x16x32_bf16 v[64:67], v[124:127], v[156:159], v[64:67]
buffer_load_dwordx4 v248, s[8:11], s82 offen offset:0 sc1 lds
v_mfma_f32_16x16x32_bf16 v[68:71], v[128:131], v[156:159], v[68:71]
v_mfma_f32_16x16x32_bf16 v[72:75], v[132:135], v[156:159], v[72:75]
v_mfma_f32_16x16x32_bf16 v[76:79], v[136:139], v[156:159], v[76:79]
s_waitcnt lgkmcnt(15)
ds_read_b128 v[156:159], v165 offset:4096
v_mfma_f32_16x16x32_bf16 v[80:83], v[120:123], v[160:163], v[80:83]
buffer_load_dwordx4 v249, s[8:11], s82 offen offset:1024 sc1 lds
v_mfma_f32_16x16x32_bf16 v[84:87], v[124:127], v[160:163], v[84:87]
v_mfma_f32_16x16x32_bf16 v[88:91], v[128:131], v[160:163], v[88:91]
v_mfma_f32_16x16x32_bf16 v[92:95], v[132:135], v[160:163], v[92:95]
buffer_load_dwordx4 v250, s[8:11], s82 offen offset:2048 sc1 lds
v_mfma_f32_16x16x32_bf16 v[96:99], v[136:139], v[160:163], v[96:99]
s_waitcnt lgkmcnt(4)
v_mfma_f32_16x16x32_bf16 v[0:3], v[100:103], v[140:143], v[0:3]
ds_read_b64_tr_b16 v[120:121], v168 offset:20480
ds_read_b64_tr_b16 v[122:123], v168 offset:25600
v_mfma_f32_16x16x32_bf16 v[4:7], v[104:107], v[140:143], v[4:7]
ds_read_b64_tr_b16 v[124:125], v171 offset:20512
ds_read_b64_tr_b16 v[126:127], v171 offset:25632
v_mfma_f32_16x16x32_bf16 v[8:11], v[108:111], v[140:143], v[8:11]
ds_read_b64_tr_b16 v[128:129], v168 offset:20544
ds_read_b64_tr_b16 v[130:131], v168 offset:25664
v_mfma_f32_16x16x32_bf16 v[12:15], v[112:115], v[140:143], v[12:15]
ds_read_b64_tr_b16 v[132:133], v171 offset:20576
ds_read_b64_tr_b16 v[134:135], v171 offset:25696
v_mfma_f32_16x16x32_bf16 v[16:19], v[116:119], v[140:143], v[16:19]
s_waitcnt lgkmcnt(11)
ds_read_b64_tr_b16 v[136:137], v168 offset:20608
ds_read_b64_tr_b16 v[138:139], v168 offset:25728
v_mfma_f32_16x16x32_bf16 v[20:23], v[100:103], v[144:147], v[20:23]
ds_read_b128 v[160:163], v165 offset:20480
ds_read_b128 v[140:143], v165 offset:21504
v_mfma_f32_16x16x32_bf16 v[24:27], v[104:107], v[144:147], v[24:27]
buffer_load_dwordx4 v251, s[8:11], s82 offen offset:3072 sc1 lds
v_mfma_f32_16x16x32_bf16 v[28:31], v[108:111], v[144:147], v[28:31]
s_add_u32 m0, s85, 24576
v_mfma_f32_16x16x32_bf16 v[32:35], v[112:115], v[144:147], v[32:35]
v_mfma_f32_16x16x32_bf16 v[36:39], v[116:119], v[144:147], v[36:39]
s_waitcnt lgkmcnt(14)
ds_read_b128 v[144:147], v165 offset:22528
v_mfma_f32_16x16x32_bf16 v[40:43], v[100:103], v[148:151], v[40:43]
buffer_load_dwordx4 v254, s[8:11], s82 offen sc1 lds
v_mfma_f32_16x16x32_bf16 v[44:47], v[104:107], v[148:151], v[44:47]
s_add_u32 s82, s82, s83
s_add_u32 m0, s85, 40960
v_mfma_f32_16x16x32_bf16 v[48:51], v[108:111], v[148:151], v[48:51]
v_mfma_f32_16x16x32_bf16 v[52:55], v[112:115], v[148:151], v[52:55]
buffer_load_dwordx4 v248, s[8:11], s82 offen offset:0 sc1 lds
v_mfma_f32_16x16x32_bf16 v[56:59], v[116:119], v[148:151], v[56:59]
s_waitcnt lgkmcnt(14)
ds_read_b128 v[148:151], v165 offset:23552
v_mfma_f32_16x16x32_bf16 v[60:63], v[100:103], v[152:155], v[60:63]
v_mfma_f32_16x16x32_bf16 v[64:67], v[104:107], v[152:155], v[64:67]
buffer_load_dwordx4 v249, s[8:11], s82 offen offset:1024 sc1 lds
v_mfma_f32_16x16x32_bf16 v[68:71], v[108:111], v[152:155], v[68:71]
v_mfma_f32_16x16x32_bf16 v[72:75], v[112:115], v[152:155], v[72:75]
v_mfma_f32_16x16x32_bf16 v[76:79], v[116:119], v[152:155], v[76:79]
s_waitcnt lgkmcnt(14)
ds_read_b128 v[152:155], v165 offset:24576
v_mfma_f32_16x16x32_bf16 v[80:83], v[100:103], v[156:159], v[80:83]
buffer_load_dwordx4 v250, s[8:11], s82 offen offset:2048 sc1 lds
v_mfma_f32_16x16x32_bf16 v[84:87], v[104:107], v[156:159], v[84:87]
v_mfma_f32_16x16x32_bf16 v[88:91], v[108:111], v[156:159], v[88:91]
v_mfma_f32_16x16x32_bf16 v[92:95], v[112:115], v[156:159], v[92:95]
buffer_load_dwordx4 v251, s[8:11], s82 offen offset:3072 sc1 lds
v_mfma_f32_16x16x32_bf16 v[96:99], v[116:119], v[156:159], v[96:99]
s_waitcnt lgkmcnt(4)
s_add_u32 m0, s85, 45056
v_mfma_f32_16x16x32_bf16 v[0:3], v[120:123], v[160:163], v[0:3]
v_mfma_f32_16x16x32_bf16 v[4:7], v[124:127], v[160:163], v[4:7]
buffer_load_dwordx4 v254, s[8:11], s82 offen sc1 lds
v_mfma_f32_16x16x32_bf16 v[8:11], v[128:131], v[160:163], v[8:11]
s_add_u32 s82, s82, s83
v_mfma_f32_16x16x32_bf16 v[12:15], v[132:135], v[160:163], v[12:15]
v_mfma_f32_16x16x32_bf16 v[16:19], v[136:139], v[160:163], v[16:19]
s_waitcnt lgkmcnt(3)
v_mfma_f32_16x16x32_bf16 v[20:23], v[120:123], v[140:143], v[20:23]
v_mfma_f32_16x16x32_bf16 v[24:27], v[124:127], v[140:143], v[24:27]
v_mfma_f32_16x16x32_bf16 v[28:31], v[128:131], v[140:143], v[28:31]
v_mfma_f32_16x16x32_bf16 v[32:35], v[132:135], v[140:143], v[32:35]
s_waitcnt vmcnt(21) lgkmcnt(0)
s_barrier
ds_read_b64_tr_b16 v[100:101], v168 offset:40960
v_mfma_f32_16x16x32_bf16 v[36:39], v[136:139], v[140:143], v[36:39]
s_waitcnt lgkmcnt(15)
ds_read_b64_tr_b16 v[102:103], v168 offset:46080
ds_read_b64_tr_b16 v[104:105], v171 offset:40992
v_mfma_f32_16x16x32_bf16 v[40:43], v[120:123], v[144:147], v[40:43]
s_add_u32 m0, s85, 61440
ds_read_b64_tr_b16 v[106:107], v171 offset:46112
ds_read_b64_tr_b16 v[108:109], v168 offset:41024
v_mfma_f32_16x16x32_bf16 v[44:47], v[124:127], v[144:147], v[44:47]
ds_read_b64_tr_b16 v[110:111], v168 offset:46144
ds_read_b64_tr_b16 v[112:113], v171 offset:41056
v_mfma_f32_16x16x32_bf16 v[48:51], v[128:131], v[144:147], v[48:51]
ds_read_b64_tr_b16 v[114:115], v171 offset:46176
ds_read_b64_tr_b16 v[116:117], v168 offset:41088
v_mfma_f32_16x16x32_bf16 v[52:55], v[132:135], v[144:147], v[52:55]
ds_read_b64_tr_b16 v[118:119], v168 offset:46208
ds_read_b128 v[156:159], v165 offset:40960
v_mfma_f32_16x16x32_bf16 v[56:59], v[136:139], v[144:147], v[56:59]
s_waitcnt lgkmcnt(15)
ds_read_b128 v[160:163], v165 offset:41984
ds_read_b128 v[140:143], v165 offset:43008
v_mfma_f32_16x16x32_bf16 v[60:63], v[120:123], v[148:151], v[60:63]
ds_read_b128 v[144:147], v165 offset:44032
v_mfma_f32_16x16x32_bf16 v[64:67], v[124:127], v[148:151], v[64:67]
buffer_load_dwordx4 v248, s[8:11], s82 offen offset:0 sc1 lds
v_mfma_f32_16x16x32_bf16 v[68:71], v[128:131], v[148:151], v[68:71]
v_mfma_f32_16x16x32_bf16 v[72:75], v[132:135], v[148:151], v[72:75]
v_mfma_f32_16x16x32_bf16 v[76:79], v[136:139], v[148:151], v[76:79]
s_waitcnt lgkmcnt(15)
ds_read_b128 v[148:151], v165 offset:45056
v_mfma_f32_16x16x32_bf16 v[80:83], v[120:123], v[152:155], v[80:83]
buffer_load_dwordx4 v249, s[8:11], s82 offen offset:1024 sc1 lds
v_mfma_f32_16x16x32_bf16 v[84:87], v[124:127], v[152:155], v[84:87]
v_mfma_f32_16x16x32_bf16 v[88:91], v[128:131], v[152:155], v[88:91]
v_mfma_f32_16x16x32_bf16 v[92:95], v[132:135], v[152:155], v[92:95]
buffer_load_dwordx4 v250, s[8:11], s82 offen offset:2048 sc1 lds
v_mfma_f32_16x16x32_bf16 v[96:99], v[136:139], v[152:155], v[96:99]
s_waitcnt lgkmcnt(4)
s_waitcnt vmcnt(20)
s_mov_b32 s43, 0x80000
L_concat_heads__mha_block_cached__gqa_block_cached__near_ridge_kernel_poll1:
v_cmp_gt_u32 vcc, 8, v195
s_sub_u32 s43, s43, 1
s_cmp_eq_u32 s43, 0
s_cbranch_scc1 L_concat_heads__mha_block_cached__gqa_block_cached__near_ridge_kernel_poll1_out
s_cbranch_vccz L_concat_heads__mha_block_cached__gqa_block_cached__near_ridge_kernel_poll1_out
s_sleep 1
buffer_load_dword v195, v194, s[72:75], s78 offen sc1
s_waitcnt vmcnt(0)
s_branch L_concat_heads__mha_block_cached__gqa_block_cached__near_ridge_kernel_poll1
L_concat_heads__mha_block_cached__gqa_block_cached__near_ridge_kernel_poll1_out:
v_mfma_f32_16x16x32_bf16 v[0:3], v[100:103], v[156:159], v[0:3]
ds_read_b64_tr_b16 v[120:121], v169 offset:20480
ds_read_b64_tr_b16 v[122:123], v169 offset:25600
v_mfma_f32_16x16x32_bf16 v[4:7], v[104:107], v[156:159], v[4:7]
ds_read_b64_tr_b16 v[124:125], v172 offset:20512
ds_read_b64_tr_b16 v[126:127], v172 offset:25632
v_mfma_f32_16x16x32_bf16 v[8:11], v[108:111], v[156:159], v[8:11]
ds_read_b64_tr_b16 v[128:129], v169 offset:20544
ds_read_b64_tr_b16 v[130:131], v169 offset:25664
v_mfma_f32_16x16x32_bf16 v[12:15], v[112:115], v[156:159], v[12:15]
ds_read_b64_tr_b16 v[132:133], v172 offset:20576
ds_read_b64_tr_b16 v[134:135], v172 offset:25696
v_mfma_f32_16x16x32_bf16 v[16:19], v[116:119], v[156:159], v[16:19]
s_waitcnt lgkmcnt(11)
ds_read_b64_tr_b16 v[136:137], v169 offset:20608
ds_read_b64_tr_b16 v[138:139], v169 offset:25728
v_mfma_f32_16x16x32_bf16 v[20:23], v[100:103], v[160:163], v[20:23]
ds_read_b128 v[152:155], v166 offset:20480
ds_read_b128 v[156:159], v166 offset:21504
v_mfma_f32_16x16x32_bf16 v[24:27], v[104:107], v[160:163], v[24:27]
buffer_load_dwordx4 v251, s[8:11], s82 offen offset:3072 sc1 lds
v_mfma_f32_16x16x32_bf16 v[28:31], v[108:111], v[160:163], v[28:31]
s_add_u32 m0, s85, 65536
v_mfma_f32_16x16x32_bf16 v[32:35], v[112:115], v[160:163], v[32:35]
v_mfma_f32_16x16x32_bf16 v[36:39], v[116:119], v[160:163], v[36:39]
s_waitcnt lgkmcnt(14)
ds_read_b128 v[160:163], v166 offset:22528
v_mfma_f32_16x16x32_bf16 v[40:43], v[100:103], v[140:143], v[40:43]
buffer_load_dwordx4 v254, s[8:11], s82 offen sc1 lds
v_mfma_f32_16x16x32_bf16 v[44:47], v[104:107], v[140:143], v[44:47]
s_add_u32 s82, s82, s83
s_add_u32 m0, s85, 81920
v_mfma_f32_16x16x32_bf16 v[48:51], v[108:111], v[140:143], v[48:51]
v_mfma_f32_16x16x32_bf16 v[52:55], v[112:115], v[140:143], v[52:55]
buffer_load_dwordx4 v248, s[8:11], s82 offen offset:0 sc1 lds
v_mfma_f32_16x16x32_bf16 v[56:59], v[116:119], v[140:143], v[56:59]
s_waitcnt lgkmcnt(14)
ds_read_b128 v[140:143], v166 offset:23552
v_mfma_f32_16x16x32_bf16 v[60:63], v[100:103], v[144:147], v[60:63]
v_mfma_f32_16x16x32_bf16 v[64:67], v[104:107], v[144:147], v[64:67]
buffer_load_dwordx4 v249, s[8:11], s82 offen offset:1024 sc1 lds
v_mfma_f32_16x16x32_bf16 v[68:71], v[108:111], v[144:147], v[68:71]
v_mfma_f32_16x16x32_bf16 v[72:75], v[112:115], v[144:147], v[72:75]
v_mfma_f32_16x16x32_bf16 v[76:79], v[116:119], v[144:147], v[76:79]
s_waitcnt lgkmcnt(14)
ds_read_b128 v[144:147], v166 offset:24576
v_mfma_f32_16x16x32_bf16 v[80:83], v[100:103], v[148:151], v[80:83]
buffer_load_dwordx4 v250, s[8:11], s82 offen offset:2048 sc1 lds
v_mfma_f32_16x16x32_bf16 v[84:87], v[104:107], v[148:151], v[84:87]
v_mfma_f32_16x16x32_bf16 v[88:91], v[108:111], v[148:151], v[88:91]
v_mfma_f32_16x16x32_bf16 v[92:95], v[112:115], v[148:151], v[92:95]
buffer_load_dwordx4 v251, s[8:11], s82 offen offset:3072 sc1 lds
v_mfma_f32_16x16x32_bf16 v[96:99], v[116:119], v[148:151], v[96:99]
s_waitcnt lgkmcnt(4)
s_add_u32 m0, s85, 86016
v_mfma_f32_16x16x32_bf16 v[0:3], v[120:123], v[152:155], v[0:3]
v_mfma_f32_16x16x32_bf16 v[4:7], v[124:127], v[152:155], v[4:7]
buffer_load_dwordx4 v254, s[8:11], s82 offen sc1 lds
v_mfma_f32_16x16x32_bf16 v[8:11], v[128:131], v[152:155], v[8:11]
s_add_u32 s82, s82, s83
v_mfma_f32_16x16x32_bf16 v[12:15], v[132:135], v[152:155], v[12:15]
v_mfma_f32_16x16x32_bf16 v[16:19], v[136:139], v[152:155], v[16:19]
s_waitcnt lgkmcnt(3)
v_mfma_f32_16x16x32_bf16 v[20:23], v[120:123], v[156:159], v[20:23]
v_mfma_f32_16x16x32_bf16 v[24:27], v[124:127], v[156:159], v[24:27]
v_mfma_f32_16x16x32_bf16 v[28:31], v[128:131], v[156:159], v[28:31]
v_mfma_f32_16x16x32_bf16 v[32:35], v[132:135], v[156:159], v[32:35]
s_waitcnt vmcnt(20) lgkmcnt(0)
s_barrier
ds_read_b64_tr_b16 v[100:101], v167 offset:0
v_mfma_f32_16x16x32_bf16 v[36:39], v[136:139], v[156:159], v[36:39]
s_waitcnt lgkmcnt(15)
ds_read_b64_tr_b16 v[102:103], v167 offset:5120
ds_read_b64_tr_b16 v[104:105], v170 offset:32
v_mfma_f32_16x16x32_bf16 v[40:43], v[120:123], v[160:163], v[40:43]
s_add_u32 m0, s85, 102400
ds_read_b64_tr_b16 v[106:107], v170 offset:5152
ds_read_b64_tr_b16 v[108:109], v167 offset:64
v_mfma_f32_16x16x32_bf16 v[44:47], v[124:127], v[160:163], v[44:47]
ds_read_b64_tr_b16 v[110:111], v167 offset:5184
ds_read_b64_tr_b16 v[112:113], v170 offset:96
v_mfma_f32_16x16x32_bf16 v[48:51], v[128:131], v[160:163], v[48:51]
ds_read_b64_tr_b16 v[114:115], v170 offset:5216
ds_read_b64_tr_b16 v[116:117], v167 offset:128
v_mfma_f32_16x16x32_bf16 v[52:55], v[132:135], v[160:163], v[52:55]
ds_read_b64_tr_b16 v[118:119], v167 offset:5248
ds_read_b128 v[148:151], v164 offset:0
v_mfma_f32_16x16x32_bf16 v[56:59], v[136:139], v[160:163], v[56:59]
s_waitcnt lgkmcnt(15)
ds_read_b128 v[152:155], v164 offset:1024
ds_read_b128 v[156:159], v164 offset:2048
v_mfma_f32_16x16x32_bf16 v[60:63], v[120:123], v[140:143], v[60:63]
ds_read_b128 v[160:163], v164 offset:3072
v_mfma_f32_16x16x32_bf16 v[64:67], v[124:127], v[140:143], v[64:67]
buffer_load_dwordx4 v248, s[8:11], s82 offen offset:0 sc1 lds
v_mfma_f32_16x16x32_bf16 v[68:71], v[128:131], v[140:143], v[68:71]
v_mfma_f32_16x16x32_bf16 v[72:75], v[132:135], v[140:143], v[72:75]
v_mfma_f32_16x16x32_bf16 v[76:79], v[136:139], v[140:143], v[76:79]
s_waitcnt lgkmcnt(15)
ds_read_b128 v[140:143], v164 offset:4096
v_mfma_f32_16x16x32_bf16 v[80:83], v[120:123], v[144:147], v[80:83]
buffer_load_dwordx4 v249, s[8:11], s82 offen offset:1024 sc1 lds
v_mfma_f32_16x16x32_bf16 v[84:87], v[124:127], v[144:147], v[84:87]
v_mfma_f32_16x16x32_bf16 v[88:91], v[128:131], v[144:147], v[88:91]
v_mfma_f32_16x16x32_bf16 v[92:95], v[132:135], v[144:147], v[92:95]
buffer_load_dwordx4 v250, s[8:11], s82 offen offset:2048 sc1 lds
v_mfma_f32_16x16x32_bf16 v[96:99], v[136:139], v[144:147], v[96:99]
s_waitcnt lgkmcnt(4)
v_mfma_f32_16x16x32_bf16 v[0:3], v[100:103], v[148:151], v[0:3]
ds_read_b64_tr_b16 v[120:121], v169 offset:0
ds_read_b64_tr_b16 v[122:123], v169 offset:5120
v_mfma_f32_16x16x32_bf16 v[4:7], v[104:107], v[148:151], v[4:7]
ds_read_b64_tr_b16 v[124:125], v172 offset:32
ds_read_b64_tr_b16 v[126:127], v172 offset:5152
v_mfma_f32_16x16x32_bf16 v[8:11], v[108:111], v[148:151], v[8:11]
ds_read_b64_tr_b16 v[128:129], v169 offset:64
ds_read_b64_tr_b16 v[130:131], v169 offset:5184
v_mfma_f32_16x16x32_bf16 v[12:15], v[112:115], v[148:151], v[12:15]
ds_read_b64_tr_b16 v[132:133], v172 offset:96
ds_read_b64_tr_b16 v[134:135], v172 offset:5216
v_mfma_f32_16x16x32_bf16 v[16:19], v[116:119], v[148:151], v[16:19]
s_waitcnt lgkmcnt(11)
ds_read_b64_tr_b16 v[136:137], v169 offset:128
ds_read_b64_tr_b16 v[138:139], v169 offset:5248
v_mfma_f32_16x16x32_bf16 v[20:23], v[100:103], v[152:155], v[20:23]
ds_read_b128 v[144:147], v166 offset:0
ds_read_b128 v[148:151], v166 offset:1024
v_mfma_f32_16x16x32_bf16 v[24:27], v[104:107], v[152:155], v[24:27]
buffer_load_dwordx4 v251, s[8:11], s82 offen offset:3072 sc1 lds
v_mfma_f32_16x16x32_bf16 v[28:31], v[108:111], v[152:155], v[28:31]
s_add_u32 m0, s85, 106496
v_mfma_f32_16x16x32_bf16 v[32:35], v[112:115], v[152:155], v[32:35]
v_mfma_f32_16x16x32_bf16 v[36:39], v[116:119], v[152:155], v[36:39]
s_waitcnt lgkmcnt(14)
ds_read_b128 v[152:155], v166 offset:2048
v_mfma_f32_16x16x32_bf16 v[40:43], v[100:103], v[156:159], v[40:43]
buffer_load_dwordx4 v254, s[8:11], s82 offen sc1 lds
v_mfma_f32_16x16x32_bf16 v[44:47], v[104:107], v[156:159], v[44:47]
s_add_u32 s82, s82, s83
s_add_u32 m0, s85, 143360
v_mfma_f32_16x16x32_bf16 v[48:51], v[108:111], v[156:159], v[48:51]
v_mfma_f32_16x16x32_bf16 v[52:55], v[112:115], v[156:159], v[52:55]
buffer_load_dwordx4 v248, s[8:11], s82 offen offset:0 sc1 lds
v_mfma_f32_16x16x32_bf16 v[56:59], v[116:119], v[156:159], v[56:59]
s_waitcnt lgkmcnt(14)
ds_read_b128 v[156:159], v166 offset:3072
v_mfma_f32_16x16x32_bf16 v[60:63], v[100:103], v[160:163], v[60:63]
v_mfma_f32_16x16x32_bf16 v[64:67], v[104:107], v[160:163], v[64:67]
buffer_load_dwordx4 v249, s[8:11], s82 offen offset:1024 sc1 lds
v_mfma_f32_16x16x32_bf16 v[68:71], v[108:111], v[160:163], v[68:71]
v_mfma_f32_16x16x32_bf16 v[72:75], v[112:115], v[160:163], v[72:75]
v_mfma_f32_16x16x32_bf16 v[76:79], v[116:119], v[160:163], v[76:79]
s_waitcnt lgkmcnt(14)
ds_read_b128 v[160:163], v166 offset:4096
v_mfma_f32_16x16x32_bf16 v[80:83], v[100:103], v[140:143], v[80:83]
buffer_load_dwordx4 v250, s[8:11], s82 offen offset:2048 sc1 lds
v_mfma_f32_16x16x32_bf16 v[84:87], v[104:107], v[140:143], v[84:87]
v_mfma_f32_16x16x32_bf16 v[88:91], v[108:111], v[140:143], v[88:91]
v_mfma_f32_16x16x32_bf16 v[92:95], v[112:115], v[140:143], v[92:95]
buffer_load_dwordx4 v251, s[8:11], s82 offen offset:3072 sc1 lds
v_mfma_f32_16x16x32_bf16 v[96:99], v[116:119], v[140:143], v[96:99]
s_waitcnt lgkmcnt(4)
s_add_u32 m0, s85, 147456
v_mfma_f32_16x16x32_bf16 v[0:3], v[120:123], v[144:147], v[0:3]
v_mfma_f32_16x16x32_bf16 v[4:7], v[124:127], v[144:147], v[4:7]
buffer_load_dwordx4 v254, s[8:11], s82 offen sc1 lds
v_mfma_f32_16x16x32_bf16 v[8:11], v[128:131], v[144:147], v[8:11]
s_add_u32 s66, s66, 1
s_and_b32 s66, s66, 3
s_mul_i32 s40, s66, 24
v_mfma_f32_16x16x32_bf16 v[12:15], v[132:135], v[144:147], v[12:15]
s_add_u32 s40, s40, 12
s_mul_i32 s40, s40, s83
s_add_u32 s82, s67, s40
v_mfma_f32_16x16x32_bf16 v[16:19], v[136:139], v[144:147], v[16:19]
s_waitcnt lgkmcnt(3)
v_mfma_f32_16x16x32_bf16 v[20:23], v[120:123], v[148:151], v[20:23]
v_mfma_f32_16x16x32_bf16 v[24:27], v[124:127], v[148:151], v[24:27]
v_mfma_f32_16x16x32_bf16 v[28:31], v[128:131], v[148:151], v[28:31]
v_mfma_f32_16x16x32_bf16 v[32:35], v[132:135], v[148:151], v[32:35]
s_waitcnt vmcnt(20) lgkmcnt(0)
s_barrier
ds_read_b64_tr_b16 v[100:101], v167 offset:20480
v_mfma_f32_16x16x32_bf16 v[36:39], v[136:139], v[148:151], v[36:39]
s_waitcnt lgkmcnt(15)
ds_read_b64_tr_b16 v[102:103], v167 offset:25600
ds_read_b64_tr_b16 v[104:105], v170 offset:20512
v_mfma_f32_16x16x32_bf16 v[40:43], v[120:123], v[152:155], v[40:43]
s_add_u32 m0, s85, 0
ds_read_b64_tr_b16 v[106:107], v170 offset:25632
ds_read_b64_tr_b16 v[108:109], v167 offset:20544
v_mfma_f32_16x16x32_bf16 v[44:47], v[124:127], v[152:155], v[44:47]
ds_read_b64_tr_b16 v[110:111], v167 offset:25664
ds_read_b64_tr_b16 v[112:113], v170 offset:20576
v_mfma_f32_16x16x32_bf16 v[48:51], v[128:131], v[152:155], v[48:51]
ds_read_b64_tr_b16 v[114:115], v170 offset:25696
ds_read_b64_tr_b16 v[116:117], v167 offset:20608
v_mfma_f32_16x16x32_bf16 v[52:55], v[132:135], v[152:155], v[52:55]
ds_read_b64_tr_b16 v[118:119], v167 offset:25728
ds_read_b128 v[140:143], v164 offset:20480
v_mfma_f32_16x16x32_bf16 v[56:59], v[136:139], v[152:155], v[56:59]
s_waitcnt lgkmcnt(15)
ds_read_b128 v[144:147], v164 offset:21504
ds_read_b128 v[148:151], v164 offset:22528
v_mfma_f32_16x16x32_bf16 v[60:63], v[120:123], v[156:159], v[60:63]
ds_read_b128 v[152:155], v164 offset:23552
v_mfma_f32_16x16x32_bf16 v[64:67], v[124:127], v[156:159], v[64:67]
buffer_load_dwordx4 v248, s[8:11], s82 offen offset:0 sc1 lds
v_mfma_f32_16x16x32_bf16 v[68:71], v[128:131], v[156:159], v[68:71]
v_mfma_f32_16x16x32_bf16 v[72:75], v[132:135], v[156:159], v[72:75]
v_mfma_f32_16x16x32_bf16 v[76:79], v[136:139], v[156:159], v[76:79]
s_waitcnt lgkmcnt(15)
ds_read_b128 v[156:159], v164 offset:24576
v_mfma_f32_16x16x32_bf16 v[80:83], v[120:123], v[160:163], v[80:83]
buffer_load_dwordx4 v249, s[8:11], s82 offen offset:1024 sc1 lds
v_mfma_f32_16x16x32_bf16 v[84:87], v[124:127], v[160:163], v[84:87]
v_mfma_f32_16x16x32_bf16 v[88:91], v[128:131], v[160:163], v[88:91]
v_mfma_f32_16x16x32_bf16 v[92:95], v[132:135], v[160:163], v[92:95]
buffer_load_dwordx4 v250, s[8:11], s82 offen offset:2048 sc1 lds
v_mfma_f32_16x16x32_bf16 v[96:99], v[136:139], v[160:163], v[96:99]
s_waitcnt lgkmcnt(4)
v_mfma_f32_16x16x32_bf16 v[0:3], v[100:103], v[140:143], v[0:3]
ds_read_b64_tr_b16 v[120:121], v167 offset:40960
ds_read_b64_tr_b16 v[122:123], v167 offset:46080
v_mfma_f32_16x16x32_bf16 v[4:7], v[104:107], v[140:143], v[4:7]
ds_read_b64_tr_b16 v[124:125], v170 offset:40992
ds_read_b64_tr_b16 v[126:127], v170 offset:46112
v_mfma_f32_16x16x32_bf16 v[8:11], v[108:111], v[140:143], v[8:11]
ds_read_b64_tr_b16 v[128:129], v167 offset:41024
ds_read_b64_tr_b16 v[130:131], v167 offset:46144
v_mfma_f32_16x16x32_bf16 v[12:15], v[112:115], v[140:143], v[12:15]
ds_read_b64_tr_b16 v[132:133], v170 offset:41056
ds_read_b64_tr_b16 v[134:135], v170 offset:46176
v_mfma_f32_16x16x32_bf16 v[16:19], v[116:119], v[140:143], v[16:19]
s_waitcnt lgkmcnt(11)
ds_read_b64_tr_b16 v[136:137], v167 offset:41088
ds_read_b64_tr_b16 v[138:139], v167 offset:46208
v_mfma_f32_16x16x32_bf16 v[20:23], v[100:103], v[144:147], v[20:23]
ds_read_b128 v[160:163], v164 offset:40960
ds_read_b128 v[140:143], v164 offset:41984
v_mfma_f32_16x16x32_bf16 v[24:27], v[104:107], v[144:147], v[24:27]
buffer_load_dwordx4 v251, s[8:11], s82 offen offset:3072 sc1 lds
v_mfma_f32_16x16x32_bf16 v[28:31], v[108:111], v[144:147], v[28:31]
s_add_u32 m0, s85, 4096
v_mfma_f32_16x16x32_bf16 v[32:35], v[112:115], v[144:147], v[32:35]
v_mfma_f32_16x16x32_bf16 v[36:39], v[116:119], v[144:147], v[36:39]
s_waitcnt lgkmcnt(14)
ds_read_b128 v[144:147], v164 offset:43008
v_mfma_f32_16x16x32_bf16 v[40:43], v[100:103], v[148:151], v[40:43]
buffer_load_dwordx4 v254, s[8:11], s82 offen sc1 lds
v_mfma_f32_16x16x32_bf16 v[44:47], v[104:107], v[148:151], v[44:47]
s_add_u32 s82, s82, s83
s_add_u32 m0, s85, 122880
v_mfma_f32_16x16x32_bf16 v[48:51], v[108:111], v[148:151], v[48:51]
v_mfma_f32_16x16x32_bf16 v[52:55], v[112:115], v[148:151], v[52:55]
buffer_load_dwordx4 v248, s[8:11], s82 offen offset:0 sc1 lds
v_mfma_f32_16x16x32_bf16 v[56:59], v[116:119], v[148:151], v[56:59]
s_waitcnt lgkmcnt(14)
ds_read_b128 v[148:151], v164 offset:44032
v_mfma_f32_16x16x32_bf16 v[60:63], v[100:103], v[152:155], v[60:63]
v_mfma_f32_16x16x32_bf16 v[64:67], v[104:107], v[152:155], v[64:67]
buffer_load_dwordx4 v249, s[8:11], s82 offen offset:1024 sc1 lds
v_mfma_f32_16x16x32_bf16 v[68:71], v[108:111], v[152:155], v[68:71]
v_mfma_f32_16x16x32_bf16 v[72:75], v[112:115], v[152:155], v[72:75]
v_mfma_f32_16x16x32_bf16 v[76:79], v[116:119], v[152:155], v[76:79]
s_waitcnt lgkmcnt(14)
ds_read_b128 v[152:155], v164 offset:45056
v_mfma_f32_16x16x32_bf16 v[80:83], v[100:103], v[156:159], v[80:83]
buffer_load_dwordx4 v250, s[8:11], s82 offen offset:2048 sc1 lds
v_mfma_f32_16x16x32_bf16 v[84:87], v[104:107], v[156:159], v[84:87]
v_mfma_f32_16x16x32_bf16 v[88:91], v[108:111], v[156:159], v[88:91]
v_mfma_f32_16x16x32_bf16 v[92:95], v[112:115], v[156:159], v[92:95]
buffer_load_dwordx4 v251, s[8:11], s82 offen offset:3072 sc1 lds
v_mfma_f32_16x16x32_bf16 v[96:99], v[116:119], v[156:159], v[96:99]
s_waitcnt lgkmcnt(4)
s_add_u32 m0, s85, 126976
v_mfma_f32_16x16x32_bf16 v[0:3], v[120:123], v[160:163], v[0:3]
v_mfma_f32_16x16x32_bf16 v[4:7], v[124:127], v[160:163], v[4:7]
buffer_load_dwordx4 v254, s[8:11], s82 offen sc1 lds
v_mfma_f32_16x16x32_bf16 v[8:11], v[128:131], v[160:163], v[8:11]
s_add_u32 s82, s82, s83
v_mfma_f32_16x16x32_bf16 v[12:15], v[132:135], v[160:163], v[12:15]
v_mfma_f32_16x16x32_bf16 v[16:19], v[136:139], v[160:163], v[16:19]
s_waitcnt lgkmcnt(3)
v_mfma_f32_16x16x32_bf16 v[20:23], v[120:123], v[140:143], v[20:23]
v_mfma_f32_16x16x32_bf16 v[24:27], v[124:127], v[140:143], v[24:27]
v_mfma_f32_16x16x32_bf16 v[28:31], v[128:131], v[140:143], v[28:31]
v_mfma_f32_16x16x32_bf16 v[32:35], v[132:135], v[140:143], v[32:35]
s_waitcnt vmcnt(20) lgkmcnt(0)
s_barrier
ds_read_b64_tr_b16 v[100:101], v168 offset:0
v_mfma_f32_16x16x32_bf16 v[36:39], v[136:139], v[140:143], v[36:39]
s_waitcnt lgkmcnt(15)
ds_read_b64_tr_b16 v[102:103], v168 offset:5120
ds_read_b64_tr_b16 v[104:105], v171 offset:32
v_mfma_f32_16x16x32_bf16 v[40:43], v[120:123], v[144:147], v[40:43]
s_add_u32 m0, s85, 20480
ds_read_b64_tr_b16 v[106:107], v171 offset:5152
ds_read_b64_tr_b16 v[108:109], v168 offset:64
v_mfma_f32_16x16x32_bf16 v[44:47], v[124:127], v[144:147], v[44:47]
ds_read_b64_tr_b16 v[110:111], v168 offset:5184
ds_read_b64_tr_b16 v[112:113], v171 offset:96
v_mfma_f32_16x16x32_bf16 v[48:51], v[128:131], v[144:147], v[48:51]
ds_read_b64_tr_b16 v[114:115], v171 offset:5216
ds_read_b64_tr_b16 v[116:117], v168 offset:128
v_mfma_f32_16x16x32_bf16 v[52:55], v[132:135], v[144:147], v[52:55]
ds_read_b64_tr_b16 v[118:119], v168 offset:5248
ds_read_b128 v[156:159], v165 offset:0
v_mfma_f32_16x16x32_bf16 v[56:59], v[136:139], v[144:147], v[56:59]
s_waitcnt lgkmcnt(15)
ds_read_b128 v[160:163], v165 offset:1024
ds_read_b128 v[140:143], v165 offset:2048
v_mfma_f32_16x16x32_bf16 v[60:63], v[120:123], v[148:151], v[60:63]
ds_read_b128 v[144:147], v165 offset:3072
v_mfma_f32_16x16x32_bf16 v[64:67], v[124:127], v[148:151], v[64:67]
buffer_load_dwordx4 v248, s[8:11], s82 offen offset:0 sc1 lds
v_mfma_f32_16x16x32_bf16 v[68:71], v[128:131], v[148:151], v[68:71]
v_mfma_f32_16x16x32_bf16 v[72:75], v[132:135], v[148:151], v[72:75]
v_mfma_f32_16x16x32_bf16 v[76:79], v[136:139], v[148:151], v[76:79]
s_waitcnt lgkmcnt(15)
ds_read_b128 v[148:151], v165 offset:4096
v_mfma_f32_16x16x32_bf16 v[80:83], v[120:123], v[152:155], v[80:83]
buffer_load_dwordx4 v249, s[8:11], s82 offen offset:1024 sc1 lds
v_mfma_f32_16x16x32_bf16 v[84:87], v[124:127], v[152:155], v[84:87]
v_mfma_f32_16x16x32_bf16 v[88:91], v[128:131], v[152:155], v[88:91]
v_mfma_f32_16x16x32_bf16 v[92:95], v[132:135], v[152:155], v[92:95]
buffer_load_dwordx4 v250, s[8:11], s82 offen offset:2048 sc1 lds
v_mfma_f32_16x16x32_bf16 v[96:99], v[136:139], v[152:155], v[96:99]
s_waitcnt lgkmcnt(4)
v_mfma_f32_16x16x32_bf16 v[0:3], v[100:103], v[156:159], v[0:3]
ds_read_b64_tr_b16 v[120:121], v168 offset:20480
ds_read_b64_tr_b16 v[122:123], v168 offset:25600
v_mfma_f32_16x16x32_bf16 v[4:7], v[104:107], v[156:159], v[4:7]
ds_read_b64_tr_b16 v[124:125], v171 offset:20512
ds_read_b64_tr_b16 v[126:127], v171 offset:25632
v_mfma_f32_16x16x32_bf16 v[8:11], v[108:111], v[156:159], v[8:11]
ds_read_b64_tr_b16 v[128:129], v168 offset:20544
ds_read_b64_tr_b16 v[130:131], v168 offset:25664
v_mfma_f32_16x16x32_bf16 v[12:15], v[112:115], v[156:159], v[12:15]
ds_read_b64_tr_b16 v[132:133], v171 offset:20576
ds_read_b64_tr_b16 v[134:135], v171 offset:25696
v_mfma_f32_16x16x32_bf16 v[16:19], v[116:119], v[156:159], v[16:19]
s_waitcnt lgkmcnt(11)
ds_read_b64_tr_b16 v[136:137], v168 offset:20608
ds_read_b64_tr_b16 v[138:139], v168 offset:25728
v_mfma_f32_16x16x32_bf16 v[20:23], v[100:103], v[160:163], v[20:23]
ds_read_b128 v[152:155], v165 offset:20480
ds_read_b128 v[156:159], v165 offset:21504
v_mfma_f32_16x16x32_bf16 v[24:27], v[104:107], v[160:163], v[24:27]
buffer_load_dwordx4 v251, s[8:11], s82 offen offset:3072 sc1 lds
v_mfma_f32_16x16x32_bf16 v[28:31], v[108:111], v[160:163], v[28:31]
s_add_u32 m0, s85, 24576
v_mfma_f32_16x16x32_bf16 v[32:35], v[112:115], v[160:163], v[32:35]
v_mfma_f32_16x16x32_bf16 v[36:39], v[116:119], v[160:163], v[36:39]
s_waitcnt lgkmcnt(14)
ds_read_b128 v[160:163], v165 offset:22528
v_mfma_f32_16x16x32_bf16 v[40:43], v[100:103], v[140:143], v[40:43]
buffer_load_dwordx4 v254, s[8:11], s82 offen sc1 lds
v_mfma_f32_16x16x32_bf16 v[44:47], v[104:107], v[140:143], v[44:47]
s_add_u32 s82, s82, s83
s_add_u32 m0, s85, 40960
v_mfma_f32_16x16x32_bf16 v[48:51], v[108:111], v[140:143], v[48:51]
v_mfma_f32_16x16x32_bf16 v[52:55], v[112:115], v[140:143], v[52:55]
buffer_load_dwordx4 v248, s[8:11], s82 offen offset:0 sc1 lds
v_mfma_f32_16x16x32_bf16 v[56:59], v[116:119], v[140:143], v[56:59]
s_waitcnt lgkmcnt(14)
ds_read_b128 v[140:143], v165 offset:23552
v_mfma_f32_16x16x32_bf16 v[60:63], v[100:103], v[144:147], v[60:63]
v_mfma_f32_16x16x32_bf16 v[64:67], v[104:107], v[144:147], v[64:67]
buffer_load_dwordx4 v249, s[8:11], s82 offen offset:1024 sc1 lds
v_mfma_f32_16x16x32_bf16 v[68:71], v[108:111], v[144:147], v[68:71]
v_mfma_f32_16x16x32_bf16 v[72:75], v[112:115], v[144:147], v[72:75]
v_mfma_f32_16x16x32_bf16 v[76:79], v[116:119], v[144:147], v[76:79]
s_waitcnt lgkmcnt(14)
ds_read_b128 v[144:147], v165 offset:24576
v_mfma_f32_16x16x32_bf16 v[80:83], v[100:103], v[148:151], v[80:83]
buffer_load_dwordx4 v250, s[8:11], s82 offen offset:2048 sc1 lds
v_mfma_f32_16x16x32_bf16 v[84:87], v[104:107], v[148:151], v[84:87]
v_mfma_f32_16x16x32_bf16 v[88:91], v[108:111], v[148:151], v[88:91]
v_mfma_f32_16x16x32_bf16 v[92:95], v[112:115], v[148:151], v[92:95]
buffer_load_dwordx4 v251, s[8:11], s82 offen offset:3072 sc1 lds
v_mfma_f32_16x16x32_bf16 v[96:99], v[116:119], v[148:151], v[96:99]
s_waitcnt lgkmcnt(4)
s_add_u32 m0, s85, 45056
v_mfma_f32_16x16x32_bf16 v[0:3], v[120:123], v[152:155], v[0:3]
v_mfma_f32_16x16x32_bf16 v[4:7], v[124:127], v[152:155], v[4:7]
buffer_load_dwordx4 v254, s[8:11], s82 offen sc1 lds
v_mfma_f32_16x16x32_bf16 v[8:11], v[128:131], v[152:155], v[8:11]
s_add_u32 s82, s82, s83
v_mfma_f32_16x16x32_bf16 v[12:15], v[132:135], v[152:155], v[12:15]
v_mfma_f32_16x16x32_bf16 v[16:19], v[136:139], v[152:155], v[16:19]
s_waitcnt lgkmcnt(3)
v_mfma_f32_16x16x32_bf16 v[20:23], v[120:123], v[156:159], v[20:23]
v_mfma_f32_16x16x32_bf16 v[24:27], v[124:127], v[156:159], v[24:27]
v_mfma_f32_16x16x32_bf16 v[28:31], v[128:131], v[156:159], v[28:31]
v_mfma_f32_16x16x32_bf16 v[32:35], v[132:135], v[156:159], v[32:35]
s_waitcnt vmcnt(20) lgkmcnt(0)
s_barrier
ds_read_b64_tr_b16 v[100:101], v168 offset:40960
v_mfma_f32_16x16x32_bf16 v[36:39], v[136:139], v[156:159], v[36:39]
s_waitcnt lgkmcnt(15)
ds_read_b64_tr_b16 v[102:103], v168 offset:46080
ds_read_b64_tr_b16 v[104:105], v171 offset:40992
v_mfma_f32_16x16x32_bf16 v[40:43], v[120:123], v[160:163], v[40:43]
s_add_u32 m0, s85, 61440
ds_read_b64_tr_b16 v[106:107], v171 offset:46112
ds_read_b64_tr_b16 v[108:109], v168 offset:41024
v_mfma_f32_16x16x32_bf16 v[44:47], v[124:127], v[160:163], v[44:47]
ds_read_b64_tr_b16 v[110:111], v168 offset:46144
ds_read_b64_tr_b16 v[112:113], v171 offset:41056
v_mfma_f32_16x16x32_bf16 v[48:51], v[128:131], v[160:163], v[48:51]
ds_read_b64_tr_b16 v[114:115], v171 offset:46176
ds_read_b64_tr_b16 v[116:117], v168 offset:41088
v_mfma_f32_16x16x32_bf16 v[52:55], v[132:135], v[160:163], v[52:55]
ds_read_b64_tr_b16 v[118:119], v168 offset:46208
ds_read_b128 v[148:151], v165 offset:40960
v_mfma_f32_16x16x32_bf16 v[56:59], v[136:139], v[160:163], v[56:59]
s_waitcnt lgkmcnt(15)
ds_read_b128 v[152:155], v165 offset:41984
ds_read_b128 v[156:159], v165 offset:43008
v_mfma_f32_16x16x32_bf16 v[60:63], v[120:123], v[140:143], v[60:63]
ds_read_b128 v[160:163], v165 offset:44032
v_mfma_f32_16x16x32_bf16 v[64:67], v[124:127], v[140:143], v[64:67]
buffer_load_dwordx4 v248, s[8:11], s82 offen offset:0 sc1 lds
v_mfma_f32_16x16x32_bf16 v[68:71], v[128:131], v[140:143], v[68:71]
v_mfma_f32_16x16x32_bf16 v[72:75], v[132:135], v[140:143], v[72:75]
v_mfma_f32_16x16x32_bf16 v[76:79], v[136:139], v[140:143], v[76:79]
s_waitcnt lgkmcnt(15)
ds_read_b128 v[140:143], v165 offset:45056
v_mfma_f32_16x16x32_bf16 v[80:83], v[120:123], v[144:147], v[80:83]
buffer_load_dwordx4 v249, s[8:11], s82 offen offset:1024 sc1 lds
v_mfma_f32_16x16x32_bf16 v[84:87], v[124:127], v[144:147], v[84:87]
v_mfma_f32_16x16x32_bf16 v[88:91], v[128:131], v[144:147], v[88:91]
v_mfma_f32_16x16x32_bf16 v[92:95], v[132:135], v[144:147], v[92:95]
buffer_load_dwordx4 v250, s[8:11], s82 offen offset:2048 sc1 lds
v_mfma_f32_16x16x32_bf16 v[96:99], v[136:139], v[144:147], v[96:99]
s_waitcnt lgkmcnt(4)
v_mfma_f32_16x16x32_bf16 v[0:3], v[100:103], v[148:151], v[0:3]
ds_read_b64_tr_b16 v[120:121], v169 offset:20480
ds_read_b64_tr_b16 v[122:123], v169 offset:25600
v_mfma_f32_16x16x32_bf16 v[4:7], v[104:107], v[148:151], v[4:7]
ds_read_b64_tr_b16 v[124:125], v172 offset:20512
ds_read_b64_tr_b16 v[126:127], v172 offset:25632
v_mfma_f32_16x16x32_bf16 v[8:11], v[108:111], v[148:151], v[8:11]
ds_read_b64_tr_b16 v[128:129], v169 offset:20544
ds_read_b64_tr_b16 v[130:131], v169 offset:25664
v_mfma_f32_16x16x32_bf16 v[12:15], v[112:115], v[148:151], v[12:15]
ds_read_b64_tr_b16 v[132:133], v172 offset:20576
ds_read_b64_tr_b16 v[134:135], v172 offset:25696
v_mfma_f32_16x16x32_bf16 v[16:19], v[116:119], v[148:151], v[16:19]
s_waitcnt lgkmcnt(11)
ds_read_b64_tr_b16 v[136:137], v169 offset:20608
ds_read_b64_tr_b16 v[138:139], v169 offset:25728
v_mfma_f32_16x16x32_bf16 v[20:23], v[100:103], v[152:155], v[20:23]
ds_read_b128 v[144:147], v166 offset:20480
ds_read_b128 v[148:151], v166 offset:21504
v_mfma_f32_16x16x32_bf16 v[24:27], v[104:107], v[152:155], v[24:27]
buffer_load_dwordx4 v251, s[8:11], s82 offen offset:3072 sc1 lds
v_mfma_f32_16x16x32_bf16 v[28:31], v[108:111], v[152:155], v[28:31]
s_add_u32 m0, s85, 65536
v_mfma_f32_16x16x32_bf16 v[32:35], v[112:115], v[152:155], v[32:35]
v_mfma_f32_16x16x32_bf16 v[36:39], v[116:119], v[152:155], v[36:39]
s_waitcnt lgkmcnt(14)
ds_read_b128 v[152:155], v166 offset:22528
v_mfma_f32_16x16x32_bf16 v[40:43], v[100:103], v[156:159], v[40:43]
buffer_load_dwordx4 v254, s[8:11], s82 offen sc1 lds
v_mfma_f32_16x16x32_bf16 v[44:47], v[104:107], v[156:159], v[44:47]
s_add_u32 s82, s82, s83
s_add_u32 m0, s85, 81920
v_mfma_f32_16x16x32_bf16 v[48:51], v[108:111], v[156:159], v[48:51]
v_mfma_f32_16x16x32_bf16 v[52:55], v[112:115], v[156:159], v[52:55]
buffer_load_dwordx4 v248, s[8:11], s82 offen offset:0 sc1 lds
v_mfma_f32_16x16x32_bf16 v[56:59], v[116:119], v[156:159], v[56:59]
s_waitcnt lgkmcnt(14)
ds_read_b128 v[156:159], v166 offset:23552
v_mfma_f32_16x16x32_bf16 v[60:63], v[100:103], v[160:163], v[60:63]
v_mfma_f32_16x16x32_bf16 v[64:67], v[104:107], v[160:163], v[64:67]
buffer_load_dwordx4 v249, s[8:11], s82 offen offset:1024 sc1 lds
v_mfma_f32_16x16x32_bf16 v[68:71], v[108:111], v[160:163], v[68:71]
v_mfma_f32_16x16x32_bf16 v[72:75], v[112:115], v[160:163], v[72:75]
v_mfma_f32_16x16x32_bf16 v[76:79], v[116:119], v[160:163], v[76:79]
s_waitcnt lgkmcnt(14)
ds_read_b128 v[160:163], v166 offset:24576
v_mfma_f32_16x16x32_bf16 v[80:83], v[100:103], v[140:143], v[80:83]
buffer_load_dwordx4 v250, s[8:11], s82 offen offset:2048 sc1 lds
v_mfma_f32_16x16x32_bf16 v[84:87], v[104:107], v[140:143], v[84:87]
v_mfma_f32_16x16x32_bf16 v[88:91], v[108:111], v[140:143], v[88:91]
v_mfma_f32_16x16x32_bf16 v[92:95], v[112:115], v[140:143], v[92:95]
buffer_load_dwordx4 v251, s[8:11], s82 offen offset:3072 sc1 lds
v_mfma_f32_16x16x32_bf16 v[96:99], v[116:119], v[140:143], v[96:99]
s_waitcnt lgkmcnt(4)
s_add_u32 m0, s85, 86016
v_mfma_f32_16x16x32_bf16 v[0:3], v[120:123], v[144:147], v[0:3]
v_mfma_f32_16x16x32_bf16 v[4:7], v[124:127], v[144:147], v[4:7]
buffer_load_dwordx4 v254, s[8:11], s82 offen sc1 lds
v_mfma_f32_16x16x32_bf16 v[8:11], v[128:131], v[144:147], v[8:11]
s_add_u32 s82, s82, s83
v_mfma_f32_16x16x32_bf16 v[12:15], v[132:135], v[144:147], v[12:15]
v_mfma_f32_16x16x32_bf16 v[16:19], v[136:139], v[144:147], v[16:19]
s_waitcnt lgkmcnt(3)
v_mfma_f32_16x16x32_bf16 v[20:23], v[120:123], v[148:151], v[20:23]
v_mfma_f32_16x16x32_bf16 v[24:27], v[124:127], v[148:151], v[24:27]
v_mfma_f32_16x16x32_bf16 v[28:31], v[128:131], v[148:151], v[28:31]
v_mfma_f32_16x16x32_bf16 v[32:35], v[132:135], v[148:151], v[32:35]
s_waitcnt vmcnt(20) lgkmcnt(0)
s_barrier
ds_read_b64_tr_b16 v[100:101], v167 offset:0
v_mfma_f32_16x16x32_bf16 v[36:39], v[136:139], v[148:151], v[36:39]
s_waitcnt lgkmcnt(15)
ds_read_b64_tr_b16 v[102:103], v167 offset:5120
ds_read_b64_tr_b16 v[104:105], v170 offset:32
v_mfma_f32_16x16x32_bf16 v[40:43], v[120:123], v[152:155], v[40:43]
s_add_u32 m0, s85, 102400
ds_read_b64_tr_b16 v[106:107], v170 offset:5152
ds_read_b64_tr_b16 v[108:109], v167 offset:64
v_mfma_f32_16x16x32_bf16 v[44:47], v[124:127], v[152:155], v[44:47]
ds_read_b64_tr_b16 v[110:111], v167 offset:5184
ds_read_b64_tr_b16 v[112:113], v170 offset:96
v_mfma_f32_16x16x32_bf16 v[48:51], v[128:131], v[152:155], v[48:51]
ds_read_b64_tr_b16 v[114:115], v170 offset:5216
ds_read_b64_tr_b16 v[116:117], v167 offset:128
v_mfma_f32_16x16x32_bf16 v[52:55], v[132:135], v[152:155], v[52:55]
ds_read_b64_tr_b16 v[118:119], v167 offset:5248
ds_read_b128 v[140:143], v164 offset:0
v_mfma_f32_16x16x32_bf16 v[56:59], v[136:139], v[152:155], v[56:59]
s_waitcnt lgkmcnt(15)
ds_read_b128 v[144:147], v164 offset:1024
ds_read_b128 v[148:151], v164 offset:2048
v_mfma_f32_16x16x32_bf16 v[60:63], v[120:123], v[156:159], v[60:63]
ds_read_b128 v[152:155], v164 offset:3072
v_mfma_f32_16x16x32_bf16 v[64:67], v[124:127], v[156:159], v[64:67]
buffer_load_dwordx4 v248, s[8:11], s82 offen offset:0 sc1 lds
v_mfma_f32_16x16x32_bf16 v[68:71], v[128:131], v[156:159], v[68:71]
v_mfma_f32_16x16x32_bf16 v[72:75], v[132:135], v[156:159], v[72:75]
v_mfma_f32_16x16x32_bf16 v[76:79], v[136:139], v[156:159], v[76:79]
s_waitcnt lgkmcnt(15)
ds_read_b128 v[156:159], v164 offset:4096
v_mfma_f32_16x16x32_bf16 v[80:83], v[120:123], v[160:163], v[80:83]
buffer_load_dwordx4 v249, s[8:11], s82 offen offset:1024 sc1 lds
v_mfma_f32_16x16x32_bf16 v[84:87], v[124:127], v[160:163], v[84:87]
v_mfma_f32_16x16x32_bf16 v[88:91], v[128:131], v[160:163], v[88:91]
v_mfma_f32_16x16x32_bf16 v[92:95], v[132:135], v[160:163], v[92:95]
buffer_load_dwordx4 v250, s[8:11], s82 offen offset:2048 sc1 lds
v_mfma_f32_16x16x32_bf16 v[96:99], v[136:139], v[160:163], v[96:99]
s_waitcnt lgkmcnt(4)
v_mfma_f32_16x16x32_bf16 v[0:3], v[100:103], v[140:143], v[0:3]
ds_read_b64_tr_b16 v[120:121], v169 offset:0
ds_read_b64_tr_b16 v[122:123], v169 offset:5120
v_mfma_f32_16x16x32_bf16 v[4:7], v[104:107], v[140:143], v[4:7]
ds_read_b64_tr_b16 v[124:125], v172 offset:32
ds_read_b64_tr_b16 v[126:127], v172 offset:5152
v_mfma_f32_16x16x32_bf16 v[8:11], v[108:111], v[140:143], v[8:11]
ds_read_b64_tr_b16 v[128:129], v169 offset:64
ds_read_b64_tr_b16 v[130:131], v169 offset:5184
v_mfma_f32_16x16x32_bf16 v[12:15], v[112:115], v[140:143], v[12:15]
ds_read_b64_tr_b16 v[132:133], v172 offset:96
ds_read_b64_tr_b16 v[134:135], v172 offset:5216
v_mfma_f32_16x16x32_bf16 v[16:19], v[116:119], v[140:143], v[16:19]
s_waitcnt lgkmcnt(11)
ds_read_b64_tr_b16 v[136:137], v169 offset:128
ds_read_b64_tr_b16 v[138:139], v169 offset:5248
v_mfma_f32_16x16x32_bf16 v[20:23], v[100:103], v[144:147], v[20:23]
ds_read_b128 v[160:163], v166 offset:0
ds_read_b128 v[140:143], v166 offset:1024
v_mfma_f32_16x16x32_bf16 v[24:27], v[104:107], v[144:147], v[24:27]
buffer_load_dwordx4 v251, s[8:11], s82 offen offset:3072 sc1 lds
v_mfma_f32_16x16x32_bf16 v[28:31], v[108:111], v[144:147], v[28:31]
s_add_u32 m0, s85, 106496
v_mfma_f32_16x16x32_bf16 v[32:35], v[112:115], v[144:147], v[32:35]
v_mfma_f32_16x16x32_bf16 v[36:39], v[116:119], v[144:147], v[36:39]
s_waitcnt lgkmcnt(14)
ds_read_b128 v[144:147], v166 offset:2048
v_mfma_f32_16x16x32_bf16 v[40:43], v[100:103], v[148:151], v[40:43]
buffer_load_dwordx4 v254, s[8:11], s82 offen sc1 lds
v_mfma_f32_16x16x32_bf16 v[44:47], v[104:107], v[148:151], v[44:47]
s_add_u32 s82, s82, s83
s_add_u32 m0, s85, 143360
v_mfma_f32_16x16x32_bf16 v[48:51], v[108:111], v[148:151], v[48:51]
v_mfma_f32_16x16x32_bf16 v[52:55], v[112:115], v[148:151], v[52:55]
buffer_load_dwordx4 v248, s[8:11], s82 offen offset:0 sc1 lds
v_mfma_f32_16x16x32_bf16 v[56:59], v[116:119], v[148:151], v[56:59]
s_waitcnt lgkmcnt(14)
ds_read_b128 v[148:151], v166 offset:3072
v_mfma_f32_16x16x32_bf16 v[60:63], v[100:103], v[152:155], v[60:63]
v_mfma_f32_16x16x32_bf16 v[64:67], v[104:107], v[152:155], v[64:67]
buffer_load_dwordx4 v249, s[8:11], s82 offen offset:1024 sc1 lds
v_mfma_f32_16x16x32_bf16 v[68:71], v[108:111], v[152:155], v[68:71]
v_mfma_f32_16x16x32_bf16 v[72:75], v[112:115], v[152:155], v[72:75]
v_mfma_f32_16x16x32_bf16 v[76:79], v[116:119], v[152:155], v[76:79]
s_waitcnt lgkmcnt(14)
ds_read_b128 v[152:155], v166 offset:4096
v_mfma_f32_16x16x32_bf16 v[80:83], v[100:103], v[156:159], v[80:83]
buffer_load_dwordx4 v250, s[8:11], s82 offen offset:2048 sc1 lds
v_mfma_f32_16x16x32_bf16 v[84:87], v[104:107], v[156:159], v[84:87]
v_mfma_f32_16x16x32_bf16 v[88:91], v[108:111], v[156:159], v[88:91]
v_mfma_f32_16x16x32_bf16 v[92:95], v[112:115], v[156:159], v[92:95]
buffer_load_dwordx4 v251, s[8:11], s82 offen offset:3072 sc1 lds
v_mfma_f32_16x16x32_bf16 v[96:99], v[116:119], v[156:159], v[96:99]
s_waitcnt lgkmcnt(4)
s_add_u32 m0, s85, 147456
v_mfma_f32_16x16x32_bf16 v[0:3], v[120:123], v[160:163], v[0:3]
v_mfma_f32_16x16x32_bf16 v[4:7], v[124:127], v[160:163], v[4:7]
buffer_load_dwordx4 v254, s[8:11], s82 offen sc1 lds
v_mfma_f32_16x16x32_bf16 v[8:11], v[128:131], v[160:163], v[8:11]
s_add_u32 s82, s82, s83
v_mfma_f32_16x16x32_bf16 v[12:15], v[132:135], v[160:163], v[12:15]
v_mfma_f32_16x16x32_bf16 v[16:19], v[136:139], v[160:163], v[16:19]
s_waitcnt lgkmcnt(3)
v_mfma_f32_16x16x32_bf16 v[20:23], v[120:123], v[140:143], v[20:23]
v_mfma_f32_16x16x32_bf16 v[24:27], v[124:127], v[140:143], v[24:27]
v_mfma_f32_16x16x32_bf16 v[28:31], v[128:131], v[140:143], v[28:31]
v_mfma_f32_16x16x32_bf16 v[32:35], v[132:135], v[140:143], v[32:35]
s_waitcnt vmcnt(20) lgkmcnt(0)
s_barrier
ds_read_b64_tr_b16 v[100:101], v167 offset:20480
v_mfma_f32_16x16x32_bf16 v[36:39], v[136:139], v[140:143], v[36:39]
s_waitcnt lgkmcnt(15)
ds_read_b64_tr_b16 v[102:103], v167 offset:25600
ds_read_b64_tr_b16 v[104:105], v170 offset:20512
v_mfma_f32_16x16x32_bf16 v[40:43], v[120:123], v[144:147], v[40:43]
s_add_u32 m0, s85, 0
ds_read_b64_tr_b16 v[106:107], v170 offset:25632
ds_read_b64_tr_b16 v[108:109], v167 offset:20544
v_mfma_f32_16x16x32_bf16 v[44:47], v[124:127], v[144:147], v[44:47]
ds_read_b64_tr_b16 v[110:111], v167 offset:25664
ds_read_b64_tr_b16 v[112:113], v170 offset:20576
v_mfma_f32_16x16x32_bf16 v[48:51], v[128:131], v[144:147], v[48:51]
ds_read_b64_tr_b16 v[114:115], v170 offset:25696
ds_read_b64_tr_b16 v[116:117], v167 offset:20608
v_mfma_f32_16x16x32_bf16 v[52:55], v[132:135], v[144:147], v[52:55]
ds_read_b64_tr_b16 v[118:119], v167 offset:25728
ds_read_b128 v[156:159], v164 offset:20480
v_mfma_f32_16x16x32_bf16 v[56:59], v[136:139], v[144:147], v[56:59]
s_waitcnt lgkmcnt(15)
ds_read_b128 v[160:163], v164 offset:21504
ds_read_b128 v[140:143], v164 offset:22528
v_mfma_f32_16x16x32_bf16 v[60:63], v[120:123], v[148:151], v[60:63]
ds_read_b128 v[144:147], v164 offset:23552
v_mfma_f32_16x16x32_bf16 v[64:67], v[124:127], v[148:151], v[64:67]
buffer_load_dwordx4 v248, s[8:11], s82 offen offset:0 sc1 lds
v_mfma_f32_16x16x32_bf16 v[68:71], v[128:131], v[148:151], v[68:71]
v_mfma_f32_16x16x32_bf16 v[72:75], v[132:135], v[148:151], v[72:75]
v_mfma_f32_16x16x32_bf16 v[76:79], v[136:139], v[148:151], v[76:79]
s_waitcnt lgkmcnt(15)
ds_read_b128 v[148:151], v164 offset:24576
v_mfma_f32_16x16x32_bf16 v[80:83], v[120:123], v[152:155], v[80:83]
buffer_load_dwordx4 v249, s[8:11], s82 offen offset:1024 sc1 lds
v_mfma_f32_16x16x32_bf16 v[84:87], v[124:127], v[152:155], v[84:87]
v_mfma_f32_16x16x32_bf16 v[88:91], v[128:131], v[152:155], v[88:91]
v_mfma_f32_16x16x32_bf16 v[92:95], v[132:135], v[152:155], v[92:95]
buffer_load_dwordx4 v250, s[8:11], s82 offen offset:2048 sc1 lds
v_mfma_f32_16x16x32_bf16 v[96:99], v[136:139], v[152:155], v[96:99]
s_waitcnt lgkmcnt(4)
v_mfma_f32_16x16x32_bf16 v[0:3], v[100:103], v[156:159], v[0:3]
ds_read_b64_tr_b16 v[120:121], v167 offset:40960
ds_read_b64_tr_b16 v[122:123], v167 offset:46080
v_mfma_f32_16x16x32_bf16 v[4:7], v[104:107], v[156:159], v[4:7]
ds_read_b64_tr_b16 v[124:125], v170 offset:40992
ds_read_b64_tr_b16 v[126:127], v170 offset:46112
v_mfma_f32_16x16x32_bf16 v[8:11], v[108:111], v[156:159], v[8:11]
ds_read_b64_tr_b16 v[128:129], v167 offset:41024
ds_read_b64_tr_b16 v[130:131], v167 offset:46144
v_mfma_f32_16x16x32_bf16 v[12:15], v[112:115], v[156:159], v[12:15]
ds_read_b64_tr_b16 v[132:133], v170 offset:41056
ds_read_b64_tr_b16 v[134:135], v170 offset:46176
v_mfma_f32_16x16x32_bf16 v[16:19], v[116:119], v[156:159], v[16:19]
s_waitcnt lgkmcnt(11)
ds_read_b64_tr_b16 v[136:137], v167 offset:41088
ds_read_b64_tr_b16 v[138:139], v167 offset:46208
v_mfma_f32_16x16x32_bf16 v[20:23], v[100:103], v[160:163], v[20:23]
ds_read_b128 v[152:155], v164 offset:40960
ds_read_b128 v[156:159], v164 offset:41984
v_mfma_f32_16x16x32_bf16 v[24:27], v[104:107], v[160:163], v[24:27]
buffer_load_dwordx4 v251, s[8:11], s82 offen offset:3072 sc1 lds
v_mfma_f32_16x16x32_bf16 v[28:31], v[108:111], v[160:163], v[28:31]
s_add_u32 m0, s85, 4096
v_mfma_f32_16x16x32_bf16 v[32:35], v[112:115], v[160:163], v[32:35]
v_mfma_f32_16x16x32_bf16 v[36:39], v[116:119], v[160:163], v[36:39]
s_waitcnt lgkmcnt(14)
ds_read_b128 v[160:163], v164 offset:43008
v_mfma_f32_16x16x32_bf16 v[40:43], v[100:103], v[140:143], v[40:43]
buffer_load_dwordx4 v254, s[8:11], s82 offen sc1 lds
v_mfma_f32_16x16x32_bf16 v[44:47], v[104:107], v[140:143], v[44:47]
s_add_u32 s82, s82, s83
s_add_u32 m0, s85, 122880
v_mfma_f32_16x16x32_bf16 v[48:51], v[108:111], v[140:143], v[48:51]
v_mfma_f32_16x16x32_bf16 v[52:55], v[112:115], v[140:143], v[52:55]
buffer_load_dwordx4 v248, s[8:11], s82 offen offset:0 sc1 lds
v_mfma_f32_16x16x32_bf16 v[56:59], v[116:119], v[140:143], v[56:59]
s_waitcnt lgkmcnt(14)
ds_read_b128 v[140:143], v164 offset:44032
v_mfma_f32_16x16x32_bf16 v[60:63], v[100:103], v[144:147], v[60:63]
v_mfma_f32_16x16x32_bf16 v[64:67], v[104:107], v[144:147], v[64:67]
buffer_load_dwordx4 v249, s[8:11], s82 offen offset:1024 sc1 lds
v_mfma_f32_16x16x32_bf16 v[68:71], v[108:111], v[144:147], v[68:71]
v_mfma_f32_16x16x32_bf16 v[72:75], v[112:115], v[144:147], v[72:75]
v_mfma_f32_16x16x32_bf16 v[76:79], v[116:119], v[144:147], v[76:79]
s_waitcnt lgkmcnt(14)
ds_read_b128 v[144:147], v164 offset:45056
v_mfma_f32_16x16x32_bf16 v[80:83], v[100:103], v[148:151], v[80:83]
buffer_load_dwordx4 v250, s[8:11], s82 offen offset:2048 sc1 lds
v_mfma_f32_16x16x32_bf16 v[84:87], v[104:107], v[148:151], v[84:87]
v_mfma_f32_16x16x32_bf16 v[88:91], v[108:111], v[148:151], v[88:91]
v_mfma_f32_16x16x32_bf16 v[92:95], v[112:115], v[148:151], v[92:95]
buffer_load_dwordx4 v251, s[8:11], s82 offen offset:3072 sc1 lds
v_mfma_f32_16x16x32_bf16 v[96:99], v[116:119], v[148:151], v[96:99]
s_waitcnt lgkmcnt(4)
s_add_u32 m0, s85, 126976
v_mfma_f32_16x16x32_bf16 v[0:3], v[120:123], v[152:155], v[0:3]
v_mfma_f32_16x16x32_bf16 v[4:7], v[124:127], v[152:155], v[4:7]
buffer_load_dwordx4 v254, s[8:11], s82 offen sc1 lds
v_mfma_f32_16x16x32_bf16 v[8:11], v[128:131], v[152:155], v[8:11]
s_add_u32 s82, s82, s83
v_mfma_f32_16x16x32_bf16 v[12:15], v[132:135], v[152:155], v[12:15]
v_mfma_f32_16x16x32_bf16 v[16:19], v[136:139], v[152:155], v[16:19]
s_waitcnt lgkmcnt(3)
v_mfma_f32_16x16x32_bf16 v[20:23], v[120:123], v[156:159], v[20:23]
v_mfma_f32_16x16x32_bf16 v[24:27], v[124:127], v[156:159], v[24:27]
v_mfma_f32_16x16x32_bf16 v[28:31], v[128:131], v[156:159], v[28:31]
v_mfma_f32_16x16x32_bf16 v[32:35], v[132:135], v[156:159], v[32:35]
s_waitcnt vmcnt(20) lgkmcnt(0)
s_barrier
ds_read_b64_tr_b16 v[100:101], v168 offset:0
v_mfma_f32_16x16x32_bf16 v[36:39], v[136:139], v[156:159], v[36:39]
s_waitcnt lgkmcnt(15)
ds_read_b64_tr_b16 v[102:103], v168 offset:5120
ds_read_b64_tr_b16 v[104:105], v171 offset:32
v_mfma_f32_16x16x32_bf16 v[40:43], v[120:123], v[160:163], v[40:43]
s_add_u32 m0, s85, 20480
ds_read_b64_tr_b16 v[106:107], v171 offset:5152
ds_read_b64_tr_b16 v[108:109], v168 offset:64
v_mfma_f32_16x16x32_bf16 v[44:47], v[124:127], v[160:163], v[44:47]
ds_read_b64_tr_b16 v[110:111], v168 offset:5184
ds_read_b64_tr_b16 v[112:113], v171 offset:96
v_mfma_f32_16x16x32_bf16 v[48:51], v[128:131], v[160:163], v[48:51]
ds_read_b64_tr_b16 v[114:115], v171 offset:5216
ds_read_b64_tr_b16 v[116:117], v168 offset:128
v_mfma_f32_16x16x32_bf16 v[52:55], v[132:135], v[160:163], v[52:55]
ds_read_b64_tr_b16 v[118:119], v168 offset:5248
ds_read_b128 v[148:151], v165 offset:0
v_mfma_f32_16x16x32_bf16 v[56:59], v[136:139], v[160:163], v[56:59]
s_waitcnt lgkmcnt(15)
ds_read_b128 v[152:155], v165 offset:1024
ds_read_b128 v[156:159], v165 offset:2048
v_mfma_f32_16x16x32_bf16 v[60:63], v[120:123], v[140:143], v[60:63]
ds_read_b128 v[160:163], v165 offset:3072
v_mfma_f32_16x16x32_bf16 v[64:67], v[124:127], v[140:143], v[64:67]
buffer_load_dwordx4 v248, s[8:11], s82 offen offset:0 sc1 lds
v_mfma_f32_16x16x32_bf16 v[68:71], v[128:131], v[140:143], v[68:71]
v_mfma_f32_16x16x32_bf16 v[72:75], v[132:135], v[140:143], v[72:75]
v_mfma_f32_16x16x32_bf16 v[76:79], v[136:139], v[140:143], v[76:79]
s_waitcnt lgkmcnt(15)
ds_read_b128 v[140:143], v165 offset:4096
v_mfma_f32_16x16x32_bf16 v[80:83], v[120:123], v[144:147], v[80:83]
buffer_load_dwordx4 v249, s[8:11], s82 offen offset:1024 sc1 lds
v_mfma_f32_16x16x32_bf16 v[84:87], v[124:127], v[144:147], v[84:87]
v_mfma_f32_16x16x32_bf16 v[88:91], v[128:131], v[144:147], v[88:91]
v_mfma_f32_16x16x32_bf16 v[92:95], v[132:135], v[144:147], v[92:95]
buffer_load_dwordx4 v250, s[8:11], s82 offen offset:2048 sc1 lds
v_mfma_f32_16x16x32_bf16 v[96:99], v[136:139], v[144:147], v[96:99]
s_waitcnt lgkmcnt(4)
v_mfma_f32_16x16x32_bf16 v[0:3], v[100:103], v[148:151], v[0:3]
ds_read_b64_tr_b16 v[120:121], v168 offset:20480
ds_read_b64_tr_b16 v[122:123], v168 offset:25600
v_mfma_f32_16x16x32_bf16 v[4:7], v[104:107], v[148:151], v[4:7]
ds_read_b64_tr_b16 v[124:125], v171 offset:20512
ds_read_b64_tr_b16 v[126:127], v171 offset:25632
v_mfma_f32_16x16x32_bf16 v[8:11], v[108:111], v[148:151], v[8:11]
ds_read_b64_tr_b16 v[128:129], v168 offset:20544
ds_read_b64_tr_b16 v[130:131], v168 offset:25664
v_mfma_f32_16x16x32_bf16 v[12:15], v[112:115], v[148:151], v[12:15]
ds_read_b64_tr_b16 v[132:133], v171 offset:20576
ds_read_b64_tr_b16 v[134:135], v171 offset:25696
v_mfma_f32_16x16x32_bf16 v[16:19], v[116:119], v[148:151], v[16:19]
s_waitcnt lgkmcnt(11)
ds_read_b64_tr_b16 v[136:137], v168 offset:20608
ds_read_b64_tr_b16 v[138:139], v168 offset:25728
v_mfma_f32_16x16x32_bf16 v[20:23], v[100:103], v[152:155], v[20:23]
ds_read_b128 v[144:147], v165 offset:20480
ds_read_b128 v[148:151], v165 offset:21504
v_mfma_f32_16x16x32_bf16 v[24:27], v[104:107], v[152:155], v[24:27]
buffer_load_dwordx4 v251, s[8:11], s82 offen offset:3072 sc1 lds
v_mfma_f32_16x16x32_bf16 v[28:31], v[108:111], v[152:155], v[28:31]
s_add_u32 m0, s85, 24576
v_mfma_f32_16x16x32_bf16 v[32:35], v[112:115], v[152:155], v[32:35]
v_mfma_f32_16x16x32_bf16 v[36:39], v[116:119], v[152:155], v[36:39]
s_waitcnt lgkmcnt(14)
ds_read_b128 v[152:155], v165 offset:22528
v_mfma_f32_16x16x32_bf16 v[40:43], v[100:103], v[156:159], v[40:43]
buffer_load_dwordx4 v254, s[8:11], s82 offen sc1 lds
v_mfma_f32_16x16x32_bf16 v[44:47], v[104:107], v[156:159], v[44:47]
s_add_u32 s82, s82, s83
s_add_u32 m0, s85, 40960
v_mfma_f32_16x16x32_bf16 v[48:51], v[108:111], v[156:159], v[48:51]
v_mfma_f32_16x16x32_bf16 v[52:55], v[112:115], v[156:159], v[52:55]
buffer_load_dwordx4 v248, s[8:11], s82 offen offset:0 sc1 lds
v_mfma_f32_16x16x32_bf16 v[56:59], v[116:119], v[156:159], v[56:59]
s_waitcnt lgkmcnt(14)
ds_read_b128 v[156:159], v165 offset:23552
v_mfma_f32_16x16x32_bf16 v[60:63], v[100:103], v[160:163], v[60:63]
v_mfma_f32_16x16x32_bf16 v[64:67], v[104:107], v[160:163], v[64:67]
buffer_load_dwordx4 v249, s[8:11], s82 offen offset:1024 sc1 lds
v_mfma_f32_16x16x32_bf16 v[68:71], v[108:111], v[160:163], v[68:71]
v_mfma_f32_16x16x32_bf16 v[72:75], v[112:115], v[160:163], v[72:75]
v_mfma_f32_16x16x32_bf16 v[76:79], v[116:119], v[160:163], v[76:79]
s_waitcnt lgkmcnt(14)
ds_read_b128 v[160:163], v165 offset:24576
v_mfma_f32_16x16x32_bf16 v[80:83], v[100:103], v[140:143], v[80:83]
buffer_load_dwordx4 v250, s[8:11], s82 offen offset:2048 sc1 lds
v_mfma_f32_16x16x32_bf16 v[84:87], v[104:107], v[140:143], v[84:87]
v_mfma_f32_16x16x32_bf16 v[88:91], v[108:111], v[140:143], v[88:91]
v_mfma_f32_16x16x32_bf16 v[92:95], v[112:115], v[140:143], v[92:95]
buffer_load_dwordx4 v251, s[8:11], s82 offen offset:3072 sc1 lds
v_mfma_f32_16x16x32_bf16 v[96:99], v[116:119], v[140:143], v[96:99]
s_waitcnt lgkmcnt(4)
s_add_u32 m0, s85, 45056
v_mfma_f32_16x16x32_bf16 v[0:3], v[120:123], v[144:147], v[0:3]
v_mfma_f32_16x16x32_bf16 v[4:7], v[124:127], v[144:147], v[4:7]
buffer_load_dwordx4 v254, s[8:11], s82 offen sc1 lds
v_mfma_f32_16x16x32_bf16 v[8:11], v[128:131], v[144:147], v[8:11]
s_add_u32 s66, s66, 1
s_and_b32 s66, s66, 3
s_mul_i32 s40, s66, 24
v_mfma_f32_16x16x32_bf16 v[12:15], v[132:135], v[144:147], v[12:15]
s_add_u32 s40, s40, 12
s_mul_i32 s40, s40, s83
s_add_u32 s82, s67, s40
v_mfma_f32_16x16x32_bf16 v[16:19], v[136:139], v[144:147], v[16:19]
s_waitcnt lgkmcnt(3)
v_mfma_f32_16x16x32_bf16 v[20:23], v[120:123], v[148:151], v[20:23]
v_mfma_f32_16x16x32_bf16 v[24:27], v[124:127], v[148:151], v[24:27]
v_mfma_f32_16x16x32_bf16 v[28:31], v[128:131], v[148:151], v[28:31]
v_mfma_f32_16x16x32_bf16 v[32:35], v[132:135], v[148:151], v[32:35]
s_waitcnt vmcnt(20) lgkmcnt(0)
s_barrier
ds_read_b64_tr_b16 v[100:101], v168 offset:40960
v_mfma_f32_16x16x32_bf16 v[36:39], v[136:139], v[148:151], v[36:39]
s_waitcnt lgkmcnt(15)
ds_read_b64_tr_b16 v[102:103], v168 offset:46080
ds_read_b64_tr_b16 v[104:105], v171 offset:40992
v_mfma_f32_16x16x32_bf16 v[40:43], v[120:123], v[152:155], v[40:43]
s_add_u32 m0, s85, 61440
ds_read_b64_tr_b16 v[106:107], v171 offset:46112
ds_read_b64_tr_b16 v[108:109], v168 offset:41024
v_mfma_f32_16x16x32_bf16 v[44:47], v[124:127], v[152:155], v[44:47]
ds_read_b64_tr_b16 v[110:111], v168 offset:46144
ds_read_b64_tr_b16 v[112:113], v171 offset:41056
v_mfma_f32_16x16x32_bf16 v[48:51], v[128:131], v[152:155], v[48:51]
ds_read_b64_tr_b16 v[114:115], v171 offset:46176
ds_read_b64_tr_b16 v[116:117], v168 offset:41088
v_mfma_f32_16x16x32_bf16 v[52:55], v[132:135], v[152:155], v[52:55]
ds_read_b64_tr_b16 v[118:119], v168 offset:46208
ds_read_b128 v[140:143], v165 offset:40960
v_mfma_f32_16x16x32_bf16 v[56:59], v[136:139], v[152:155], v[56:59]
s_waitcnt lgkmcnt(15)
ds_read_b128 v[144:147], v165 offset:41984
ds_read_b128 v[148:151], v165 offset:43008
v_mfma_f32_16x16x32_bf16 v[60:63], v[120:123], v[156:159], v[60:63]
ds_read_b128 v[152:155], v165 offset:44032
v_mfma_f32_16x16x32_bf16 v[64:67], v[124:127], v[156:159], v[64:67]
buffer_load_dwordx4 v248, s[8:11], s82 offen offset:0 sc1 lds
v_mfma_f32_16x16x32_bf16 v[68:71], v[128:131], v[156:159], v[68:71]
v_mfma_f32_16x16x32_bf16 v[72:75], v[132:135], v[156:159], v[72:75]
v_mfma_f32_16x16x32_bf16 v[76:79], v[136:139], v[156:159], v[76:79]
s_waitcnt lgkmcnt(15)
ds_read_b128 v[156:159], v165 offset:45056
v_mfma_f32_16x16x32_bf16 v[80:83], v[120:123], v[160:163], v[80:83]
buffer_load_dwordx4 v249, s[8:11], s82 offen offset:1024 sc1 lds
v_mfma_f32_16x16x32_bf16 v[84:87], v[124:127], v[160:163], v[84:87]
v_mfma_f32_16x16x32_bf16 v[88:91], v[128:131], v[160:163], v[88:91]
v_mfma_f32_16x16x32_bf16 v[92:95], v[132:135], v[160:163], v[92:95]
buffer_load_dwordx4 v250, s[8:11], s82 offen offset:2048 sc1 lds
v_mfma_f32_16x16x32_bf16 v[96:99], v[136:139], v[160:163], v[96:99]
s_waitcnt lgkmcnt(4)
v_mfma_f32_16x16x32_bf16 v[0:3], v[100:103], v[140:143], v[0:3]
ds_read_b64_tr_b16 v[120:121], v169 offset:20480
ds_read_b64_tr_b16 v[122:123], v169 offset:25600
v_mfma_f32_16x16x32_bf16 v[4:7], v[104:107], v[140:143], v[4:7]
ds_read_b64_tr_b16 v[124:125], v172 offset:20512
ds_read_b64_tr_b16 v[126:127], v172 offset:25632
v_mfma_f32_16x16x32_bf16 v[8:11], v[108:111], v[140:143], v[8:11]
ds_read_b64_tr_b16 v[128:129], v169 offset:20544
ds_read_b64_tr_b16 v[130:131], v169 offset:25664
v_mfma_f32_16x16x32_bf16 v[12:15], v[112:115], v[140:143], v[12:15]
ds_read_b64_tr_b16 v[132:133], v172 offset:20576
ds_read_b64_tr_b16 v[134:135], v172 offset:25696
v_mfma_f32_16x16x32_bf16 v[16:19], v[116:119], v[140:143], v[16:19]
s_waitcnt lgkmcnt(11)
ds_read_b64_tr_b16 v[136:137], v169 offset:20608
ds_read_b64_tr_b16 v[138:139], v169 offset:25728
v_mfma_f32_16x16x32_bf16 v[20:23], v[100:103], v[144:147], v[20:23]
ds_read_b128 v[160:163], v166 offset:20480
ds_read_b128 v[140:143], v166 offset:21504
v_mfma_f32_16x16x32_bf16 v[24:27], v[104:107], v[144:147], v[24:27]
buffer_load_dwordx4 v251, s[8:11], s82 offen offset:3072 sc1 lds
v_mfma_f32_16x16x32_bf16 v[28:31], v[108:111], v[144:147], v[28:31]
s_add_u32 m0, s85, 65536
v_mfma_f32_16x16x32_bf16 v[32:35], v[112:115], v[144:147], v[32:35]
v_mfma_f32_16x16x32_bf16 v[36:39], v[116:119], v[144:147], v[36:39]
s_waitcnt lgkmcnt(14)
ds_read_b128 v[144:147], v166 offset:22528
v_mfma_f32_16x16x32_bf16 v[40:43], v[100:103], v[148:151], v[40:43]
buffer_load_dwordx4 v254, s[8:11], s82 offen sc1 lds
v_mfma_f32_16x16x32_bf16 v[44:47], v[104:107], v[148:151], v[44:47]
s_add_u32 s82, s82, s83
s_add_u32 m0, s85, 81920
v_mfma_f32_16x16x32_bf16 v[48:51], v[108:111], v[148:151], v[48:51]
v_mfma_f32_16x16x32_bf16 v[52:55], v[112:115], v[148:151], v[52:55]
buffer_load_dwordx4 v248, s[8:11], s82 offen offset:0 sc1 lds
v_mfma_f32_16x16x32_bf16 v[56:59], v[116:119], v[148:151], v[56:59]
s_waitcnt lgkmcnt(14)
ds_read_b128 v[148:151], v166 offset:23552
v_mfma_f32_16x16x32_bf16 v[60:63], v[100:103], v[152:155], v[60:63]
v_mfma_f32_16x16x32_bf16 v[64:67], v[104:107], v[152:155], v[64:67]
buffer_load_dwordx4 v249, s[8:11], s82 offen offset:1024 sc1 lds
v_mfma_f32_16x16x32_bf16 v[68:71], v[108:111], v[152:155], v[68:71]
v_mfma_f32_16x16x32_bf16 v[72:75], v[112:115], v[152:155], v[72:75]
v_mfma_f32_16x16x32_bf16 v[76:79], v[116:119], v[152:155], v[76:79]
s_waitcnt lgkmcnt(14)
ds_read_b128 v[152:155], v166 offset:24576
v_mfma_f32_16x16x32_bf16 v[80:83], v[100:103], v[156:159], v[80:83]
buffer_load_dwordx4 v250, s[8:11], s82 offen offset:2048 sc1 lds
v_mfma_f32_16x16x32_bf16 v[84:87], v[104:107], v[156:159], v[84:87]
v_mfma_f32_16x16x32_bf16 v[88:91], v[108:111], v[156:159], v[88:91]
v_mfma_f32_16x16x32_bf16 v[92:95], v[112:115], v[156:159], v[92:95]
buffer_load_dwordx4 v251, s[8:11], s82 offen offset:3072 sc1 lds
v_mfma_f32_16x16x32_bf16 v[96:99], v[116:119], v[156:159], v[96:99]
s_waitcnt lgkmcnt(4)
s_add_u32 m0, s85, 86016
v_mfma_f32_16x16x32_bf16 v[0:3], v[120:123], v[160:163], v[0:3]
v_mfma_f32_16x16x32_bf16 v[4:7], v[124:127], v[160:163], v[4:7]
buffer_load_dwordx4 v254, s[8:11], s82 offen sc1 lds
v_mfma_f32_16x16x32_bf16 v[8:11], v[128:131], v[160:163], v[8:11]
s_add_u32 s82, s82, s83
v_mfma_f32_16x16x32_bf16 v[12:15], v[132:135], v[160:163], v[12:15]
v_mfma_f32_16x16x32_bf16 v[16:19], v[136:139], v[160:163], v[16:19]
s_waitcnt lgkmcnt(3)
v_mfma_f32_16x16x32_bf16 v[20:23], v[120:123], v[140:143], v[20:23]
v_mfma_f32_16x16x32_bf16 v[24:27], v[124:127], v[140:143], v[24:27]
v_mfma_f32_16x16x32_bf16 v[28:31], v[128:131], v[140:143], v[28:31]
v_mfma_f32_16x16x32_bf16 v[32:35], v[132:135], v[140:143], v[32:35]
s_waitcnt vmcnt(20) lgkmcnt(0)
s_barrier
ds_read_b64_tr_b16 v[100:101], v167 offset:0
v_mfma_f32_16x16x32_bf16 v[36:39], v[136:139], v[140:143], v[36:39]
s_waitcnt lgkmcnt(15)
ds_read_b64_tr_b16 v[102:103], v167 offset:5120
ds_read_b64_tr_b16 v[104:105], v170 offset:32
v_mfma_f32_16x16x32_bf16 v[40:43], v[120:123], v[144:147], v[40:43]
s_add_u32 m0, s85, 102400
ds_read_b64_tr_b16 v[106:107], v170 offset:5152
ds_read_b64_tr_b16 v[108:109], v167 offset:64
v_mfma_f32_16x16x32_bf16 v[44:47], v[124:127], v[144:147], v[44:47]
ds_read_b64_tr_b16 v[110:111], v167 offset:5184
ds_read_b64_tr_b16 v[112:113], v170 offset:96
v_mfma_f32_16x16x32_bf16 v[48:51], v[128:131], v[144:147], v[48:51]
ds_read_b64_tr_b16 v[114:115], v170 offset:5216
ds_read_b64_tr_b16 v[116:117], v167 offset:128
v_mfma_f32_16x16x32_bf16 v[52:55], v[132:135], v[144:147], v[52:55]
ds_read_b64_tr_b16 v[118:119], v167 offset:5248
ds_read_b128 v[156:159], v164 offset:0
v_mfma_f32_16x16x32_bf16 v[56:59], v[136:139], v[144:147], v[56:59]
s_waitcnt lgkmcnt(15)
ds_read_b128 v[160:163], v164 offset:1024
ds_read_b128 v[140:143], v164 offset:2048
v_mfma_f32_16x16x32_bf16 v[60:63], v[120:123], v[148:151], v[60:63]
ds_read_b128 v[144:147], v164 offset:3072
v_mfma_f32_16x16x32_bf16 v[64:67], v[124:127], v[148:151], v[64:67]
buffer_load_dwordx4 v248, s[8:11], s82 offen offset:0 sc1 lds
v_mfma_f32_16x16x32_bf16 v[68:71], v[128:131], v[148:151], v[68:71]
v_mfma_f32_16x16x32_bf16 v[72:75], v[132:135], v[148:151], v[72:75]
v_mfma_f32_16x16x32_bf16 v[76:79], v[136:139], v[148:151], v[76:79]
s_waitcnt lgkmcnt(15)
ds_read_b128 v[148:151], v164 offset:4096
v_mfma_f32_16x16x32_bf16 v[80:83], v[120:123], v[152:155], v[80:83]
buffer_load_dwordx4 v249, s[8:11], s82 offen offset:1024 sc1 lds
v_mfma_f32_16x16x32_bf16 v[84:87], v[124:127], v[152:155], v[84:87]
v_mfma_f32_16x16x32_bf16 v[88:91], v[128:131], v[152:155], v[88:91]
v_mfma_f32_16x16x32_bf16 v[92:95], v[132:135], v[152:155], v[92:95]
buffer_load_dwordx4 v250, s[8:11], s82 offen offset:2048 sc1 lds
v_mfma_f32_16x16x32_bf16 v[96:99], v[136:139], v[152:155], v[96:99]
s_waitcnt lgkmcnt(4)
v_mfma_f32_16x16x32_bf16 v[0:3], v[100:103], v[156:159], v[0:3]
ds_read_b64_tr_b16 v[120:121], v169 offset:0
ds_read_b64_tr_b16 v[122:123], v169 offset:5120
v_mfma_f32_16x16x32_bf16 v[4:7], v[104:107], v[156:159], v[4:7]
ds_read_b64_tr_b16 v[124:125], v172 offset:32
ds_read_b64_tr_b16 v[126:127], v172 offset:5152
v_mfma_f32_16x16x32_bf16 v[8:11], v[108:111], v[156:159], v[8:11]
ds_read_b64_tr_b16 v[128:129], v169 offset:64
ds_read_b64_tr_b16 v[130:131], v169 offset:5184
v_mfma_f32_16x16x32_bf16 v[12:15], v[112:115], v[156:159], v[12:15]
ds_read_b64_tr_b16 v[132:133], v172 offset:96
ds_read_b64_tr_b16 v[134:135], v172 offset:5216
v_mfma_f32_16x16x32_bf16 v[16:19], v[116:119], v[156:159], v[16:19]
s_waitcnt lgkmcnt(11)
ds_read_b64_tr_b16 v[136:137], v169 offset:128
ds_read_b64_tr_b16 v[138:139], v169 offset:5248
v_mfma_f32_16x16x32_bf16 v[20:23], v[100:103], v[160:163], v[20:23]
ds_read_b128 v[152:155], v166 offset:0
ds_read_b128 v[156:159], v166 offset:1024
v_mfma_f32_16x16x32_bf16 v[24:27], v[104:107], v[160:163], v[24:27]
buffer_load_dwordx4 v251, s[8:11], s82 offen offset:3072 sc1 lds
v_mfma_f32_16x16x32_bf16 v[28:31], v[108:111], v[160:163], v[28:31]
s_add_u32 m0, s85, 106496
v_mfma_f32_16x16x32_bf16 v[32:35], v[112:115], v[160:163], v[32:35]
v_mfma_f32_16x16x32_bf16 v[36:39], v[116:119], v[160:163], v[36:39]
s_waitcnt lgkmcnt(14)
ds_read_b128 v[160:163], v166 offset:2048
v_mfma_f32_16x16x32_bf16 v[40:43], v[100:103], v[140:143], v[40:43]
buffer_load_dwordx4 v254, s[8:11], s82 offen sc1 lds
v_mfma_f32_16x16x32_bf16 v[44:47], v[104:107], v[140:143], v[44:47]
s_add_u32 s82, s82, s83
s_add_u32 m0, s85, 143360
v_mfma_f32_16x16x32_bf16 v[48:51], v[108:111], v[140:143], v[48:51]
v_mfma_f32_16x16x32_bf16 v[52:55], v[112:115], v[140:143], v[52:55]
buffer_load_dwordx4 v248, s[8:11], s82 offen offset:0 sc1 lds
v_mfma_f32_16x16x32_bf16 v[56:59], v[116:119], v[140:143], v[56:59]
s_waitcnt lgkmcnt(14)
ds_read_b128 v[140:143], v166 offset:3072
v_mfma_f32_16x16x32_bf16 v[60:63], v[100:103], v[144:147], v[60:63]
v_mfma_f32_16x16x32_bf16 v[64:67], v[104:107], v[144:147], v[64:67]
buffer_load_dwordx4 v249, s[8:11], s82 offen offset:1024 sc1 lds
v_mfma_f32_16x16x32_bf16 v[68:71], v[108:111], v[144:147], v[68:71]
v_mfma_f32_16x16x32_bf16 v[72:75], v[112:115], v[144:147], v[72:75]
v_mfma_f32_16x16x32_bf16 v[76:79], v[116:119], v[144:147], v[76:79]
s_waitcnt lgkmcnt(14)
ds_read_b128 v[144:147], v166 offset:4096
v_mfma_f32_16x16x32_bf16 v[80:83], v[100:103], v[148:151], v[80:83]
buffer_load_dwordx4 v250, s[8:11], s82 offen offset:2048 sc1 lds
v_mfma_f32_16x16x32_bf16 v[84:87], v[104:107], v[148:151], v[84:87]
v_mfma_f32_16x16x32_bf16 v[88:91], v[108:111], v[148:151], v[88:91]
v_mfma_f32_16x16x32_bf16 v[92:95], v[112:115], v[148:151], v[92:95]
buffer_load_dwordx4 v251, s[8:11], s82 offen offset:3072 sc1 lds
v_mfma_f32_16x16x32_bf16 v[96:99], v[116:119], v[148:151], v[96:99]
s_waitcnt lgkmcnt(4)
s_add_u32 m0, s85, 147456
v_mfma_f32_16x16x32_bf16 v[0:3], v[120:123], v[152:155], v[0:3]
v_mfma_f32_16x16x32_bf16 v[4:7], v[124:127], v[152:155], v[4:7]
buffer_load_dwordx4 v254, s[8:11], s82 offen sc1 lds
v_mfma_f32_16x16x32_bf16 v[8:11], v[128:131], v[152:155], v[8:11]
s_add_u32 s82, s82, s83
v_mfma_f32_16x16x32_bf16 v[12:15], v[132:135], v[152:155], v[12:15]
v_mfma_f32_16x16x32_bf16 v[16:19], v[136:139], v[152:155], v[16:19]
s_waitcnt lgkmcnt(3)
v_mfma_f32_16x16x32_bf16 v[20:23], v[120:123], v[156:159], v[20:23]
v_mfma_f32_16x16x32_bf16 v[24:27], v[124:127], v[156:159], v[24:27]
v_mfma_f32_16x16x32_bf16 v[28:31], v[128:131], v[156:159], v[28:31]
v_mfma_f32_16x16x32_bf16 v[32:35], v[132:135], v[156:159], v[32:35]
s_waitcnt vmcnt(20) lgkmcnt(0)
s_barrier
ds_read_b64_tr_b16 v[100:101], v167 offset:20480
v_mfma_f32_16x16x32_bf16 v[36:39], v[136:139], v[156:159], v[36:39]
s_waitcnt lgkmcnt(15)
ds_read_b64_tr_b16 v[102:103], v167 offset:25600
ds_read_b64_tr_b16 v[104:105], v170 offset:20512
v_mfma_f32_16x16x32_bf16 v[40:43], v[120:123], v[160:163], v[40:43]
s_add_u32 m0, s85, 0
ds_read_b64_tr_b16 v[106:107], v170 offset:25632
ds_read_b64_tr_b16 v[108:109], v167 offset:20544
v_mfma_f32_16x16x32_bf16 v[44:47], v[124:127], v[160:163], v[44:47]
ds_read_b64_tr_b16 v[110:111], v167 offset:25664
ds_read_b64_tr_b16 v[112:113], v170 offset:20576
v_mfma_f32_16x16x32_bf16 v[48:51], v[128:131], v[160:163], v[48:51]
ds_read_b64_tr_b16 v[114:115], v170 offset:25696
ds_read_b64_tr_b16 v[116:117], v167 offset:20608
v_mfma_f32_16x16x32_bf16 v[52:55], v[132:135], v[160:163], v[52:55]
ds_read_b64_tr_b16 v[118:119], v167 offset:25728
ds_read_b128 v[148:151], v164 offset:20480
v_mfma_f32_16x16x32_bf16 v[56:59], v[136:139], v[160:163], v[56:59]
s_waitcnt lgkmcnt(15)
ds_read_b128 v[152:155], v164 offset:21504
ds_read_b128 v[156:159], v164 offset:22528
v_mfma_f32_16x16x32_bf16 v[60:63], v[120:123], v[140:143], v[60:63]
ds_read_b128 v[160:163], v164 offset:23552
v_mfma_f32_16x16x32_bf16 v[64:67], v[124:127], v[140:143], v[64:67]
buffer_load_dwordx4 v248, s[8:11], s82 offen offset:0 sc1 lds
v_mfma_f32_16x16x32_bf16 v[68:71], v[128:131], v[140:143], v[68:71]
v_mfma_f32_16x16x32_bf16 v[72:75], v[132:135], v[140:143], v[72:75]
v_mfma_f32_16x16x32_bf16 v[76:79], v[136:139], v[140:143], v[76:79]
s_waitcnt lgkmcnt(15)
ds_read_b128 v[140:143], v164 offset:24576
v_mfma_f32_16x16x32_bf16 v[80:83], v[120:123], v[144:147], v[80:83]
buffer_load_dwordx4 v249, s[8:11], s82 offen offset:1024 sc1 lds
v_mfma_f32_16x16x32_bf16 v[84:87], v[124:127], v[144:147], v[84:87]
v_mfma_f32_16x16x32_bf16 v[88:91], v[128:131], v[144:147], v[88:91]
v_mfma_f32_16x16x32_bf16 v[92:95], v[132:135], v[144:147], v[92:95]
buffer_load_dwordx4 v250, s[8:11], s82 offen offset:2048 sc1 lds
v_mfma_f32_16x16x32_bf16 v[96:99], v[136:139], v[144:147], v[96:99]
s_waitcnt lgkmcnt(4)
v_mfma_f32_16x16x32_bf16 v[0:3], v[100:103], v[148:151], v[0:3]
ds_read_b64_tr_b16 v[120:121], v167 offset:40960
ds_read_b64_tr_b16 v[122:123], v167 offset:46080
v_mfma_f32_16x16x32_bf16 v[4:7], v[104:107], v[148:151], v[4:7]
ds_read_b64_tr_b16 v[124:125], v170 offset:40992
ds_read_b64_tr_b16 v[126:127], v170 offset:46112
v_mfma_f32_16x16x32_bf16 v[8:11], v[108:111], v[148:151], v[8:11]
ds_read_b64_tr_b16 v[128:129], v167 offset:41024
ds_read_b64_tr_b16 v[130:131], v167 offset:46144
v_mfma_f32_16x16x32_bf16 v[12:15], v[112:115], v[148:151], v[12:15]
ds_read_b64_tr_b16 v[132:133], v170 offset:41056
ds_read_b64_tr_b16 v[134:135], v170 offset:46176
v_mfma_f32_16x16x32_bf16 v[16:19], v[116:119], v[148:151], v[16:19]
s_waitcnt lgkmcnt(11)
ds_read_b64_tr_b16 v[136:137], v167 offset:41088
ds_read_b64_tr_b16 v[138:139], v167 offset:46208
v_mfma_f32_16x16x32_bf16 v[20:23], v[100:103], v[152:155], v[20:23]
ds_read_b128 v[144:147], v164 offset:40960
ds_read_b128 v[148:151], v164 offset:41984
v_mfma_f32_16x16x32_bf16 v[24:27], v[104:107], v[152:155], v[24:27]
buffer_load_dwordx4 v251, s[8:11], s82 offen offset:3072 sc1 lds
v_mfma_f32_16x16x32_bf16 v[28:31], v[108:111], v[152:155], v[28:31]
s_add_u32 m0, s85, 4096
v_mfma_f32_16x16x32_bf16 v[32:35], v[112:115], v[152:155], v[32:35]
v_mfma_f32_16x16x32_bf16 v[36:39], v[116:119], v[152:155], v[36:39]
s_waitcnt lgkmcnt(14)
ds_read_b128 v[152:155], v164 offset:43008
v_mfma_f32_16x16x32_bf16 v[40:43], v[100:103], v[156:159], v[40:43]
buffer_load_dwordx4 v254, s[8:11], s82 offen sc1 lds
v_mfma_f32_16x16x32_bf16 v[44:47], v[104:107], v[156:159], v[44:47]
s_add_u32 s82, s82, s83
s_add_u32 m0, s85, 122880
v_mfma_f32_16x16x32_bf16 v[48:51], v[108:111], v[156:159], v[48:51]
v_mfma_f32_16x16x32_bf16 v[52:55], v[112:115], v[156:159], v[52:55]
buffer_load_dwordx4 v248, s[8:11], s82 offen offset:0 sc1 lds
v_mfma_f32_16x16x32_bf16 v[56:59], v[116:119], v[156:159], v[56:59]
s_waitcnt lgkmcnt(14)
ds_read_b128 v[156:159], v164 offset:44032
v_mfma_f32_16x16x32_bf16 v[60:63], v[100:103], v[160:163], v[60:63]
v_mfma_f32_16x16x32_bf16 v[64:67], v[104:107], v[160:163], v[64:67]
buffer_load_dwordx4 v249, s[8:11], s82 offen offset:1024 sc1 lds
v_mfma_f32_16x16x32_bf16 v[68:71], v[108:111], v[160:163], v[68:71]
v_mfma_f32_16x16x32_bf16 v[72:75], v[112:115], v[160:163], v[72:75]
v_mfma_f32_16x16x32_bf16 v[76:79], v[116:119], v[160:163], v[76:79]
s_waitcnt lgkmcnt(14)
ds_read_b128 v[160:163], v164 offset:45056
v_mfma_f32_16x16x32_bf16 v[80:83], v[100:103], v[140:143], v[80:83]
buffer_load_dwordx4 v250, s[8:11], s82 offen offset:2048 sc1 lds
v_mfma_f32_16x16x32_bf16 v[84:87], v[104:107], v[140:143], v[84:87]
v_mfma_f32_16x16x32_bf16 v[88:91], v[108:111], v[140:143], v[88:91]
v_mfma_f32_16x16x32_bf16 v[92:95], v[112:115], v[140:143], v[92:95]
buffer_load_dwordx4 v251, s[8:11], s82 offen offset:3072 sc1 lds
v_mfma_f32_16x16x32_bf16 v[96:99], v[116:119], v[140:143], v[96:99]
s_waitcnt lgkmcnt(4)
s_add_u32 m0, s85, 126976
v_mfma_f32_16x16x32_bf16 v[0:3], v[120:123], v[144:147], v[0:3]
v_mfma_f32_16x16x32_bf16 v[4:7], v[124:127], v[144:147], v[4:7]
buffer_load_dwordx4 v254, s[8:11], s82 offen sc1 lds
v_mfma_f32_16x16x32_bf16 v[8:11], v[128:131], v[144:147], v[8:11]
s_add_u32 s82, s82, s83
v_mfma_f32_16x16x32_bf16 v[12:15], v[132:135], v[144:147], v[12:15]
v_mfma_f32_16x16x32_bf16 v[16:19], v[136:139], v[144:147], v[16:19]
s_waitcnt lgkmcnt(3)
v_mfma_f32_16x16x32_bf16 v[20:23], v[120:123], v[148:151], v[20:23]
v_mfma_f32_16x16x32_bf16 v[24:27], v[124:127], v[148:151], v[24:27]
v_mfma_f32_16x16x32_bf16 v[28:31], v[128:131], v[148:151], v[28:31]
v_mfma_f32_16x16x32_bf16 v[32:35], v[132:135], v[148:151], v[32:35]
s_waitcnt vmcnt(20) lgkmcnt(0)
s_barrier
ds_read_b64_tr_b16 v[100:101], v168 offset:0
v_mfma_f32_16x16x32_bf16 v[36:39], v[136:139], v[148:151], v[36:39]
s_waitcnt lgkmcnt(15)
ds_read_b64_tr_b16 v[102:103], v168 offset:5120
ds_read_b64_tr_b16 v[104:105], v171 offset:32
v_mfma_f32_16x16x32_bf16 v[40:43], v[120:123], v[152:155], v[40:43]
s_add_u32 m0, s85, 20480
ds_read_b64_tr_b16 v[106:107], v171 offset:5152
ds_read_b64_tr_b16 v[108:109], v168 offset:64
v_mfma_f32_16x16x32_bf16 v[44:47], v[124:127], v[152:155], v[44:47]
ds_read_b64_tr_b16 v[110:111], v168 offset:5184
ds_read_b64_tr_b16 v[112:113], v171 offset:96
v_mfma_f32_16x16x32_bf16 v[48:51], v[128:131], v[152:155], v[48:51]
ds_read_b64_tr_b16 v[114:115], v171 offset:5216
ds_read_b64_tr_b16 v[116:117], v168 offset:128
v_mfma_f32_16x16x32_bf16 v[52:55], v[132:135], v[152:155], v[52:55]
ds_read_b64_tr_b16 v[118:119], v168 offset:5248
ds_read_b128 v[140:143], v165 offset:0
v_mfma_f32_16x16x32_bf16 v[56:59], v[136:139], v[152:155], v[56:59]
s_waitcnt lgkmcnt(15)
ds_read_b128 v[144:147], v165 offset:1024
ds_read_b128 v[148:151], v165 offset:2048
v_mfma_f32_16x16x32_bf16 v[60:63], v[120:123], v[156:159], v[60:63]
ds_read_b128 v[152:155], v165 offset:3072
v_mfma_f32_16x16x32_bf16 v[64:67], v[124:127], v[156:159], v[64:67]
buffer_load_dwordx4 v248, s[8:11], s82 offen offset:0 sc1 lds
v_mfma_f32_16x16x32_bf16 v[68:71], v[128:131], v[156:159], v[68:71]
v_mfma_f32_16x16x32_bf16 v[72:75], v[132:135], v[156:159], v[72:75]
v_mfma_f32_16x16x32_bf16 v[76:79], v[136:139], v[156:159], v[76:79]
s_waitcnt lgkmcnt(15)
ds_read_b128 v[156:159], v165 offset:4096
v_mfma_f32_16x16x32_bf16 v[80:83], v[120:123], v[160:163], v[80:83]
buffer_load_dwordx4 v249, s[8:11], s82 offen offset:1024 sc1 lds
v_mfma_f32_16x16x32_bf16 v[84:87], v[124:127], v[160:163], v[84:87]
v_mfma_f32_16x16x32_bf16 v[88:91], v[128:131], v[160:163], v[88:91]
v_mfma_f32_16x16x32_bf16 v[92:95], v[132:135], v[160:163], v[92:95]
buffer_load_dwordx4 v250, s[8:11], s82 offen offset:2048 sc1 lds
v_mfma_f32_16x16x32_bf16 v[96:99], v[136:139], v[160:163], v[96:99]
s_waitcnt lgkmcnt(4)
v_mfma_f32_16x16x32_bf16 v[0:3], v[100:103], v[140:143], v[0:3]
ds_read_b64_tr_b16 v[120:121], v168 offset:20480
ds_read_b64_tr_b16 v[122:123], v168 offset:25600
v_mfma_f32_16x16x32_bf16 v[4:7], v[104:107], v[140:143], v[4:7]
ds_read_b64_tr_b16 v[124:125], v171 offset:20512
ds_read_b64_tr_b16 v[126:127], v171 offset:25632
v_mfma_f32_16x16x32_bf16 v[8:11], v[108:111], v[140:143], v[8:11]
ds_read_b64_tr_b16 v[128:129], v168 offset:20544
ds_read_b64_tr_b16 v[130:131], v168 offset:25664
v_mfma_f32_16x16x32_bf16 v[12:15], v[112:115], v[140:143], v[12:15]
ds_read_b64_tr_b16 v[132:133], v171 offset:20576
ds_read_b64_tr_b16 v[134:135], v171 offset:25696
v_mfma_f32_16x16x32_bf16 v[16:19], v[116:119], v[140:143], v[16:19]
s_waitcnt lgkmcnt(11)
ds_read_b64_tr_b16 v[136:137], v168 offset:20608
ds_read_b64_tr_b16 v[138:139], v168 offset:25728
v_mfma_f32_16x16x32_bf16 v[20:23], v[100:103], v[144:147], v[20:23]
ds_read_b128 v[160:163], v165 offset:20480
ds_read_b128 v[140:143], v165 offset:21504
v_mfma_f32_16x16x32_bf16 v[24:27], v[104:107], v[144:147], v[24:27]
buffer_load_dwordx4 v251, s[8:11], s82 offen offset:3072 sc1 lds
v_mfma_f32_16x16x32_bf16 v[28:31], v[108:111], v[144:147], v[28:31]
s_add_u32 m0, s85, 24576
v_mfma_f32_16x16x32_bf16 v[32:35], v[112:115], v[144:147], v[32:35]
v_mfma_f32_16x16x32_bf16 v[36:39], v[116:119], v[144:147], v[36:39]
s_waitcnt lgkmcnt(14)
ds_read_b128 v[144:147], v165 offset:22528
v_mfma_f32_16x16x32_bf16 v[40:43], v[100:103], v[148:151], v[40:43]
buffer_load_dwordx4 v254, s[8:11], s82 offen sc1 lds
v_mfma_f32_16x16x32_bf16 v[44:47], v[104:107], v[148:151], v[44:47]
s_add_u32 s82, s82, s83
s_add_u32 m0, s85, 40960
v_mfma_f32_16x16x32_bf16 v[48:51], v[108:111], v[148:151], v[48:51]
v_mfma_f32_16x16x32_bf16 v[52:55], v[112:115], v[148:151], v[52:55]
buffer_load_dwordx4 v248, s[8:11], s82 offen offset:0 sc1 lds
v_mfma_f32_16x16x32_bf16 v[56:59], v[116:119], v[148:151], v[56:59]
s_waitcnt lgkmcnt(14)
ds_read_b128 v[148:151], v165 offset:23552
v_mfma_f32_16x16x32_bf16 v[60:63], v[100:103], v[152:155], v[60:63]
v_mfma_f32_16x16x32_bf16 v[64:67], v[104:107], v[152:155], v[64:67]
buffer_load_dwordx4 v249, s[8:11], s82 offen offset:1024 sc1 lds
v_mfma_f32_16x16x32_bf16 v[68:71], v[108:111], v[152:155], v[68:71]
v_mfma_f32_16x16x32_bf16 v[72:75], v[112:115], v[152:155], v[72:75]
v_mfma_f32_16x16x32_bf16 v[76:79], v[116:119], v[152:155], v[76:79]
s_waitcnt lgkmcnt(14)
ds_read_b128 v[152:155], v165 offset:24576
v_mfma_f32_16x16x32_bf16 v[80:83], v[100:103], v[156:159], v[80:83]
buffer_load_dwordx4 v250, s[8:11], s82 offen offset:2048 sc1 lds
v_mfma_f32_16x16x32_bf16 v[84:87], v[104:107], v[156:159], v[84:87]
v_mfma_f32_16x16x32_bf16 v[88:91], v[108:111], v[156:159], v[88:91]
v_mfma_f32_16x16x32_bf16 v[92:95], v[112:115], v[156:159], v[92:95]
buffer_load_dwordx4 v251, s[8:11], s82 offen offset:3072 sc1 lds
v_mfma_f32_16x16x32_bf16 v[96:99], v[116:119], v[156:159], v[96:99]
s_waitcnt lgkmcnt(4)
s_add_u32 m0, s85, 45056
v_mfma_f32_16x16x32_bf16 v[0:3], v[120:123], v[160:163], v[0:3]
v_mfma_f32_16x16x32_bf16 v[4:7], v[124:127], v[160:163], v[4:7]
buffer_load_dwordx4 v254, s[8:11], s82 offen sc1 lds
v_mfma_f32_16x16x32_bf16 v[8:11], v[128:131], v[160:163], v[8:11]
s_add_u32 s82, s82, s83
v_mfma_f32_16x16x32_bf16 v[12:15], v[132:135], v[160:163], v[12:15]
v_mfma_f32_16x16x32_bf16 v[16:19], v[136:139], v[160:163], v[16:19]
s_waitcnt lgkmcnt(3)
v_mfma_f32_16x16x32_bf16 v[20:23], v[120:123], v[140:143], v[20:23]
v_mfma_f32_16x16x32_bf16 v[24:27], v[124:127], v[140:143], v[24:27]
v_mfma_f32_16x16x32_bf16 v[28:31], v[128:131], v[140:143], v[28:31]
v_mfma_f32_16x16x32_bf16 v[32:35], v[132:135], v[140:143], v[32:35]
s_waitcnt vmcnt(20) lgkmcnt(0)
s_barrier
ds_read_b64_tr_b16 v[100:101], v168 offset:40960
v_mfma_f32_16x16x32_bf16 v[36:39], v[136:139], v[140:143], v[36:39]
s_waitcnt lgkmcnt(15)
ds_read_b64_tr_b16 v[102:103], v168 offset:46080
ds_read_b64_tr_b16 v[104:105], v171 offset:40992
v_mfma_f32_16x16x32_bf16 v[40:43], v[120:123], v[144:147], v[40:43]
s_add_u32 m0, s85, 61440
ds_read_b64_tr_b16 v[106:107], v171 offset:46112
ds_read_b64_tr_b16 v[108:109], v168 offset:41024
v_mfma_f32_16x16x32_bf16 v[44:47], v[124:127], v[144:147], v[44:47]
ds_read_b64_tr_b16 v[110:111], v168 offset:46144
ds_read_b64_tr_b16 v[112:113], v171 offset:41056
v_mfma_f32_16x16x32_bf16 v[48:51], v[128:131], v[144:147], v[48:51]
ds_read_b64_tr_b16 v[114:115], v171 offset:46176
ds_read_b64_tr_b16 v[116:117], v168 offset:41088
v_mfma_f32_16x16x32_bf16 v[52:55], v[132:135], v[144:147], v[52:55]
ds_read_b64_tr_b16 v[118:119], v168 offset:46208
ds_read_b128 v[156:159], v165 offset:40960
v_mfma_f32_16x16x32_bf16 v[56:59], v[136:139], v[144:147], v[56:59]
s_waitcnt lgkmcnt(15)
ds_read_b128 v[160:163], v165 offset:41984
ds_read_b128 v[140:143], v165 offset:43008
v_mfma_f32_16x16x32_bf16 v[60:63], v[120:123], v[148:151], v[60:63]
ds_read_b128 v[144:147], v165 offset:44032
v_mfma_f32_16x16x32_bf16 v[64:67], v[124:127], v[148:151], v[64:67]
buffer_load_dwordx4 v248, s[8:11], s82 offen offset:0 sc1 lds
v_mfma_f32_16x16x32_bf16 v[68:71], v[128:131], v[148:151], v[68:71]
v_mfma_f32_16x16x32_bf16 v[72:75], v[132:135], v[148:151], v[72:75]
v_mfma_f32_16x16x32_bf16 v[76:79], v[136:139], v[148:151], v[76:79]
s_waitcnt lgkmcnt(15)
ds_read_b128 v[148:151], v165 offset:45056
v_mfma_f32_16x16x32_bf16 v[80:83], v[120:123], v[152:155], v[80:83]
buffer_load_dwordx4 v249, s[8:11], s82 offen offset:1024 sc1 lds
v_mfma_f32_16x16x32_bf16 v[84:87], v[124:127], v[152:155], v[84:87]
v_mfma_f32_16x16x32_bf16 v[88:91], v[128:131], v[152:155], v[88:91]
v_mfma_f32_16x16x32_bf16 v[92:95], v[132:135], v[152:155], v[92:95]
buffer_load_dwordx4 v250, s[8:11], s82 offen offset:2048 sc1 lds
v_mfma_f32_16x16x32_bf16 v[96:99], v[136:139], v[152:155], v[96:99]
s_waitcnt lgkmcnt(4)
v_mfma_f32_16x16x32_bf16 v[0:3], v[100:103], v[156:159], v[0:3]
ds_read_b64_tr_b16 v[120:121], v169 offset:20480
ds_read_b64_tr_b16 v[122:123], v169 offset:25600
v_mfma_f32_16x16x32_bf16 v[4:7], v[104:107], v[156:159], v[4:7]
ds_read_b64_tr_b16 v[124:125], v172 offset:20512
ds_read_b64_tr_b16 v[126:127], v172 offset:25632
v_mfma_f32_16x16x32_bf16 v[8:11], v[108:111], v[156:159], v[8:11]
ds_read_b64_tr_b16 v[128:129], v169 offset:20544
ds_read_b64_tr_b16 v[130:131], v169 offset:25664
v_mfma_f32_16x16x32_bf16 v[12:15], v[112:115], v[156:159], v[12:15]
ds_read_b64_tr_b16 v[132:133], v172 offset:20576
ds_read_b64_tr_b16 v[134:135], v172 offset:25696
v_mfma_f32_16x16x32_bf16 v[16:19], v[116:119], v[156:159], v[16:19]
s_waitcnt lgkmcnt(11)
ds_read_b64_tr_b16 v[136:137], v169 offset:20608
ds_read_b64_tr_b16 v[138:139], v169 offset:25728
v_mfma_f32_16x16x32_bf16 v[20:23], v[100:103], v[160:163], v[20:23]
ds_read_b128 v[152:155], v166 offset:20480
ds_read_b128 v[156:159], v166 offset:21504
v_mfma_f32_16x16x32_bf16 v[24:27], v[104:107], v[160:163], v[24:27]
buffer_load_dwordx4 v251, s[8:11], s82 offen offset:3072 sc1 lds
v_mfma_f32_16x16x32_bf16 v[28:31], v[108:111], v[160:163], v[28:31]
s_add_u32 m0, s85, 65536
v_mfma_f32_16x16x32_bf16 v[32:35], v[112:115], v[160:163], v[32:35]
v_mfma_f32_16x16x32_bf16 v[36:39], v[116:119], v[160:163], v[36:39]
s_waitcnt lgkmcnt(14)
ds_read_b128 v[160:163], v166 offset:22528
v_mfma_f32_16x16x32_bf16 v[40:43], v[100:103], v[140:143], v[40:43]
buffer_load_dwordx4 v254, s[8:11], s82 offen sc1 lds
v_mfma_f32_16x16x32_bf16 v[44:47], v[104:107], v[140:143], v[44:47]
s_add_u32 s82, s82, s83
s_add_u32 m0, s85, 81920
v_mfma_f32_16x16x32_bf16 v[48:51], v[108:111], v[140:143], v[48:51]
v_mfma_f32_16x16x32_bf16 v[52:55], v[112:115], v[140:143], v[52:55]
buffer_load_dwordx4 v248, s[8:11], s82 offen offset:0 sc1 lds
v_mfma_f32_16x16x32_bf16 v[56:59], v[116:119], v[140:143], v[56:59]
s_waitcnt lgkmcnt(14)
ds_read_b128 v[140:143], v166 offset:23552
v_mfma_f32_16x16x32_bf16 v[60:63], v[100:103], v[144:147], v[60:63]
v_mfma_f32_16x16x32_bf16 v[64:67], v[104:107], v[144:147], v[64:67]
buffer_load_dwordx4 v249, s[8:11], s82 offen offset:1024 sc1 lds
v_mfma_f32_16x16x32_bf16 v[68:71], v[108:111], v[144:147], v[68:71]
v_mfma_f32_16x16x32_bf16 v[72:75], v[112:115], v[144:147], v[72:75]
v_mfma_f32_16x16x32_bf16 v[76:79], v[116:119], v[144:147], v[76:79]
s_waitcnt lgkmcnt(14)
ds_read_b128 v[144:147], v166 offset:24576
v_mfma_f32_16x16x32_bf16 v[80:83], v[100:103], v[148:151], v[80:83]
buffer_load_dwordx4 v250, s[8:11], s82 offen offset:2048 sc1 lds
v_mfma_f32_16x16x32_bf16 v[84:87], v[104:107], v[148:151], v[84:87]
v_mfma_f32_16x16x32_bf16 v[88:91], v[108:111], v[148:151], v[88:91]
v_mfma_f32_16x16x32_bf16 v[92:95], v[112:115], v[148:151], v[92:95]
buffer_load_dwordx4 v251, s[8:11], s82 offen offset:3072 sc1 lds
v_mfma_f32_16x16x32_bf16 v[96:99], v[116:119], v[148:151], v[96:99]
s_waitcnt lgkmcnt(4)
s_add_u32 m0, s85, 86016
v_mfma_f32_16x16x32_bf16 v[0:3], v[120:123], v[152:155], v[0:3]
v_mfma_f32_16x16x32_bf16 v[4:7], v[124:127], v[152:155], v[4:7]
buffer_load_dwordx4 v254, s[8:11], s82 offen sc1 lds
v_mfma_f32_16x16x32_bf16 v[8:11], v[128:131], v[152:155], v[8:11]
s_add_u32 s82, s82, s83
v_mfma_f32_16x16x32_bf16 v[12:15], v[132:135], v[152:155], v[12:15]
v_mfma_f32_16x16x32_bf16 v[16:19], v[136:139], v[152:155], v[16:19]
s_waitcnt lgkmcnt(3)
v_mfma_f32_16x16x32_bf16 v[20:23], v[120:123], v[156:159], v[20:23]
v_mfma_f32_16x16x32_bf16 v[24:27], v[124:127], v[156:159], v[24:27]
v_mfma_f32_16x16x32_bf16 v[28:31], v[128:131], v[156:159], v[28:31]
v_mfma_f32_16x16x32_bf16 v[32:35], v[132:135], v[156:159], v[32:35]
s_waitcnt vmcnt(20) lgkmcnt(0)
s_barrier
ds_read_b64_tr_b16 v[100:101], v167 offset:0
v_mfma_f32_16x16x32_bf16 v[36:39], v[136:139], v[156:159], v[36:39]
s_waitcnt lgkmcnt(15)
ds_read_b64_tr_b16 v[102:103], v167 offset:5120
ds_read_b64_tr_b16 v[104:105], v170 offset:32
v_mfma_f32_16x16x32_bf16 v[40:43], v[120:123], v[160:163], v[40:43]
s_add_u32 m0, s85, 102400
ds_read_b64_tr_b16 v[106:107], v170 offset:5152
ds_read_b64_tr_b16 v[108:109], v167 offset:64
v_mfma_f32_16x16x32_bf16 v[44:47], v[124:127], v[160:163], v[44:47]
ds_read_b64_tr_b16 v[110:111], v167 offset:5184
ds_read_b64_tr_b16 v[112:113], v170 offset:96
v_mfma_f32_16x16x32_bf16 v[48:51], v[128:131], v[160:163], v[48:51]
ds_read_b64_tr_b16 v[114:115], v170 offset:5216
ds_read_b64_tr_b16 v[116:117], v167 offset:128
v_mfma_f32_16x16x32_bf16 v[52:55], v[132:135], v[160:163], v[52:55]
ds_read_b64_tr_b16 v[118:119], v167 offset:5248
ds_read_b128 v[148:151], v164 offset:0
v_mfma_f32_16x16x32_bf16 v[56:59], v[136:139], v[160:163], v[56:59]
s_waitcnt lgkmcnt(15)
ds_read_b128 v[152:155], v164 offset:1024
ds_read_b128 v[156:159], v164 offset:2048
v_mfma_f32_16x16x32_bf16 v[60:63], v[120:123], v[140:143], v[60:63]
ds_read_b128 v[160:163], v164 offset:3072
v_mfma_f32_16x16x32_bf16 v[64:67], v[124:127], v[140:143], v[64:67]
buffer_load_dwordx4 v248, s[8:11], s82 offen offset:0 sc1 lds
v_mfma_f32_16x16x32_bf16 v[68:71], v[128:131], v[140:143], v[68:71]
v_mfma_f32_16x16x32_bf16 v[72:75], v[132:135], v[140:143], v[72:75]
v_mfma_f32_16x16x32_bf16 v[76:79], v[136:139], v[140:143], v[76:79]
s_waitcnt lgkmcnt(15)
ds_read_b128 v[140:143], v164 offset:4096
v_mfma_f32_16x16x32_bf16 v[80:83], v[120:123], v[144:147], v[80:83]
buffer_load_dwordx4 v249, s[8:11], s82 offen offset:1024 sc1 lds
v_mfma_f32_16x16x32_bf16 v[84:87], v[124:127], v[144:147], v[84:87]
v_mfma_f32_16x16x32_bf16 v[88:91], v[128:131], v[144:147], v[88:91]
v_mfma_f32_16x16x32_bf16 v[92:95], v[132:135], v[144:147], v[92:95]
buffer_load_dwordx4 v250, s[8:11], s82 offen offset:2048 sc1 lds
v_mfma_f32_16x16x32_bf16 v[96:99], v[136:139], v[144:147], v[96:99]
s_waitcnt lgkmcnt(4)
v_mfma_f32_16x16x32_bf16 v[0:3], v[100:103], v[148:151], v[0:3]
ds_read_b64_tr_b16 v[120:121], v169 offset:0
ds_read_b64_tr_b16 v[122:123], v169 offset:5120
v_mfma_f32_16x16x32_bf16 v[4:7], v[104:107], v[148:151], v[4:7]
ds_read_b64_tr_b16 v[124:125], v172 offset:32
ds_read_b64_tr_b16 v[126:127], v172 offset:5152
v_mfma_f32_16x16x32_bf16 v[8:11], v[108:111], v[148:151], v[8:11]
ds_read_b64_tr_b16 v[128:129], v169 offset:64
ds_read_b64_tr_b16 v[130:131], v169 offset:5184
v_mfma_f32_16x16x32_bf16 v[12:15], v[112:115], v[148:151], v[12:15]
ds_read_b64_tr_b16 v[132:133], v172 offset:96
ds_read_b64_tr_b16 v[134:135], v172 offset:5216
v_mfma_f32_16x16x32_bf16 v[16:19], v[116:119], v[148:151], v[16:19]
s_waitcnt lgkmcnt(11)
ds_read_b64_tr_b16 v[136:137], v169 offset:128
ds_read_b64_tr_b16 v[138:139], v169 offset:5248
v_mfma_f32_16x16x32_bf16 v[20:23], v[100:103], v[152:155], v[20:23]
ds_read_b128 v[144:147], v166 offset:0
ds_read_b128 v[148:151], v166 offset:1024
v_mfma_f32_16x16x32_bf16 v[24:27], v[104:107], v[152:155], v[24:27]
buffer_load_dwordx4 v251, s[8:11], s82 offen offset:3072 sc1 lds
v_mfma_f32_16x16x32_bf16 v[28:31], v[108:111], v[152:155], v[28:31]
s_add_u32 m0, s85, 106496
v_mfma_f32_16x16x32_bf16 v[32:35], v[112:115], v[152:155], v[32:35]
v_mfma_f32_16x16x32_bf16 v[36:39], v[116:119], v[152:155], v[36:39]
s_waitcnt lgkmcnt(14)
ds_read_b128 v[152:155], v166 offset:2048
v_mfma_f32_16x16x32_bf16 v[40:43], v[100:103], v[156:159], v[40:43]
buffer_load_dwordx4 v254, s[8:11], s82 offen sc1 lds
v_mfma_f32_16x16x32_bf16 v[44:47], v[104:107], v[156:159], v[44:47]
s_add_u32 s82, s82, s83
s_add_u32 m0, s85, 143360
v_mfma_f32_16x16x32_bf16 v[48:51], v[108:111], v[156:159], v[48:51]
v_mfma_f32_16x16x32_bf16 v[52:55], v[112:115], v[156:159], v[52:55]
buffer_load_dwordx4 v248, s[8:11], s82 offen offset:0 sc1 lds
v_mfma_f32_16x16x32_bf16 v[56:59], v[116:119], v[156:159], v[56:59]
s_waitcnt lgkmcnt(14)
ds_read_b128 v[156:159], v166 offset:3072
v_mfma_f32_16x16x32_bf16 v[60:63], v[100:103], v[160:163], v[60:63]
v_mfma_f32_16x16x32_bf16 v[64:67], v[104:107], v[160:163], v[64:67]
buffer_load_dwordx4 v249, s[8:11], s82 offen offset:1024 sc1 lds
v_mfma_f32_16x16x32_bf16 v[68:71], v[108:111], v[160:163], v[68:71]
v_mfma_f32_16x16x32_bf16 v[72:75], v[112:115], v[160:163], v[72:75]
v_mfma_f32_16x16x32_bf16 v[76:79], v[116:119], v[160:163], v[76:79]
s_waitcnt lgkmcnt(14)
ds_read_b128 v[160:163], v166 offset:4096
v_mfma_f32_16x16x32_bf16 v[80:83], v[100:103], v[140:143], v[80:83]
buffer_load_dwordx4 v250, s[8:11], s82 offen offset:2048 sc1 lds
v_mfma_f32_16x16x32_bf16 v[84:87], v[104:107], v[140:143], v[84:87]
v_mfma_f32_16x16x32_bf16 v[88:91], v[108:111], v[140:143], v[88:91]
v_mfma_f32_16x16x32_bf16 v[92:95], v[112:115], v[140:143], v[92:95]
buffer_load_dwordx4 v251, s[8:11], s82 offen offset:3072 sc1 lds
v_mfma_f32_16x16x32_bf16 v[96:99], v[116:119], v[140:143], v[96:99]
s_waitcnt lgkmcnt(4)
s_add_u32 m0, s85, 147456
v_mfma_f32_16x16x32_bf16 v[0:3], v[120:123], v[144:147], v[0:3]
v_mfma_f32_16x16x32_bf16 v[4:7], v[124:127], v[144:147], v[4:7]
buffer_load_dwordx4 v254, s[8:11], s82 offen sc1 lds
v_mfma_f32_16x16x32_bf16 v[8:11], v[128:131], v[144:147], v[8:11]
s_add_u32 s66, s66, 1
s_and_b32 s66, s66, 3
s_mul_i32 s40, s66, 24
v_mfma_f32_16x16x32_bf16 v[12:15], v[132:135], v[144:147], v[12:15]
s_add_u32 s40, s40, 12
s_mul_i32 s40, s40, s83
s_add_u32 s82, s67, s40
v_mfma_f32_16x16x32_bf16 v[16:19], v[136:139], v[144:147], v[16:19]
s_waitcnt lgkmcnt(3)
v_mfma_f32_16x16x32_bf16 v[20:23], v[120:123], v[148:151], v[20:23]
v_mfma_f32_16x16x32_bf16 v[24:27], v[124:127], v[148:151], v[24:27]
v_mfma_f32_16x16x32_bf16 v[28:31], v[128:131], v[148:151], v[28:31]
v_mfma_f32_16x16x32_bf16 v[32:35], v[132:135], v[148:151], v[32:35]
s_waitcnt vmcnt(20) lgkmcnt(0)
s_barrier
ds_read_b64_tr_b16 v[100:101], v167 offset:20480
v_mfma_f32_16x16x32_bf16 v[36:39], v[136:139], v[148:151], v[36:39]
s_waitcnt lgkmcnt(15)
ds_read_b64_tr_b16 v[102:103], v167 offset:25600
ds_read_b64_tr_b16 v[104:105], v170 offset:20512
v_mfma_f32_16x16x32_bf16 v[40:43], v[120:123], v[152:155], v[40:43]
s_add_u32 m0, s85, 0
ds_read_b64_tr_b16 v[106:107], v170 offset:25632
ds_read_b64_tr_b16 v[108:109], v167 offset:20544
v_mfma_f32_16x16x32_bf16 v[44:47], v[124:127], v[152:155], v[44:47]
ds_read_b64_tr_b16 v[110:111], v167 offset:25664
ds_read_b64_tr_b16 v[112:113], v170 offset:20576
v_mfma_f32_16x16x32_bf16 v[48:51], v[128:131], v[152:155], v[48:51]
ds_read_b64_tr_b16 v[114:115], v170 offset:25696
ds_read_b64_tr_b16 v[116:117], v167 offset:20608
v_mfma_f32_16x16x32_bf16 v[52:55], v[132:135], v[152:155], v[52:55]
ds_read_b64_tr_b16 v[118:119], v167 offset:25728
ds_read_b128 v[140:143], v164 offset:20480
v_mfma_f32_16x16x32_bf16 v[56:59], v[136:139], v[152:155], v[56:59]
s_waitcnt lgkmcnt(15)
ds_read_b128 v[144:147], v164 offset:21504
ds_read_b128 v[148:151], v164 offset:22528
v_mfma_f32_16x16x32_bf16 v[60:63], v[120:123], v[156:159], v[60:63]
ds_read_b128 v[152:155], v164 offset:23552
v_mfma_f32_16x16x32_bf16 v[64:67], v[124:127], v[156:159], v[64:67]
buffer_load_dwordx4 v248, s[8:11], s82 offen offset:0 sc1 lds
v_mfma_f32_16x16x32_bf16 v[68:71], v[128:131], v[156:159], v[68:71]
v_mfma_f32_16x16x32_bf16 v[72:75], v[132:135], v[156:159], v[72:75]
v_mfma_f32_16x16x32_bf16 v[76:79], v[136:139], v[156:159], v[76:79]
s_waitcnt lgkmcnt(15)
ds_read_b128 v[156:159], v164 offset:24576
v_mfma_f32_16x16x32_bf16 v[80:83], v[120:123], v[160:163], v[80:83]
buffer_load_dwordx4 v249, s[8:11], s82 offen offset:1024 sc1 lds
v_mfma_f32_16x16x32_bf16 v[84:87], v[124:127], v[160:163], v[84:87]
v_mfma_f32_16x16x32_bf16 v[88:91], v[128:131], v[160:163], v[88:91]
v_mfma_f32_16x16x32_bf16 v[92:95], v[132:135], v[160:163], v[92:95]
buffer_load_dwordx4 v250, s[8:11], s82 offen offset:2048 sc1 lds
v_mfma_f32_16x16x32_bf16 v[96:99], v[136:139], v[160:163], v[96:99]
s_waitcnt lgkmcnt(4)
v_mfma_f32_16x16x32_bf16 v[0:3], v[100:103], v[140:143], v[0:3]
ds_read_b64_tr_b16 v[120:121], v167 offset:40960
ds_read_b64_tr_b16 v[122:123], v167 offset:46080
v_mfma_f32_16x16x32_bf16 v[4:7], v[104:107], v[140:143], v[4:7]
ds_read_b64_tr_b16 v[124:125], v170 offset:40992
ds_read_b64_tr_b16 v[126:127], v170 offset:46112
v_mfma_f32_16x16x32_bf16 v[8:11], v[108:111], v[140:143], v[8:11]
ds_read_b64_tr_b16 v[128:129], v167 offset:41024
ds_read_b64_tr_b16 v[130:131], v167 offset:46144
v_mfma_f32_16x16x32_bf16 v[12:15], v[112:115], v[140:143], v[12:15]
ds_read_b64_tr_b16 v[132:133], v170 offset:41056
ds_read_b64_tr_b16 v[134:135], v170 offset:46176
v_mfma_f32_16x16x32_bf16 v[16:19], v[116:119], v[140:143], v[16:19]
s_waitcnt lgkmcnt(11)
ds_read_b64_tr_b16 v[136:137], v167 offset:41088
ds_read_b64_tr_b16 v[138:139], v167 offset:46208
v_mfma_f32_16x16x32_bf16 v[20:23], v[100:103], v[144:147], v[20:23]
ds_read_b128 v[160:163], v164 offset:40960
ds_read_b128 v[140:143], v164 offset:41984
v_mfma_f32_16x16x32_bf16 v[24:27], v[104:107], v[144:147], v[24:27]
buffer_load_dwordx4 v251, s[8:11], s82 offen offset:3072 sc1 lds
v_mfma_f32_16x16x32_bf16 v[28:31], v[108:111], v[144:147], v[28:31]
s_add_u32 m0, s85, 4096
v_mfma_f32_16x16x32_bf16 v[32:35], v[112:115], v[144:147], v[32:35]
v_mfma_f32_16x16x32_bf16 v[36:39], v[116:119], v[144:147], v[36:39]
s_waitcnt lgkmcnt(14)
ds_read_b128 v[144:147], v164 offset:43008
v_mfma_f32_16x16x32_bf16 v[40:43], v[100:103], v[148:151], v[40:43]
buffer_load_dwordx4 v254, s[8:11], s82 offen sc1 lds
v_mfma_f32_16x16x32_bf16 v[44:47], v[104:107], v[148:151], v[44:47]
s_add_u32 s82, s82, s83
s_add_u32 m0, s85, 122880
v_mfma_f32_16x16x32_bf16 v[48:51], v[108:111], v[148:151], v[48:51]
v_mfma_f32_16x16x32_bf16 v[52:55], v[112:115], v[148:151], v[52:55]
buffer_load_dwordx4 v248, s[8:11], s82 offen offset:0 sc1 lds
v_mfma_f32_16x16x32_bf16 v[56:59], v[116:119], v[148:151], v[56:59]
s_waitcnt lgkmcnt(14)
ds_read_b128 v[148:151], v164 offset:44032
v_mfma_f32_16x16x32_bf16 v[60:63], v[100:103], v[152:155], v[60:63]
v_mfma_f32_16x16x32_bf16 v[64:67], v[104:107], v[152:155], v[64:67]
buffer_load_dwordx4 v249, s[8:11], s82 offen offset:1024 sc1 lds
v_mfma_f32_16x16x32_bf16 v[68:71], v[108:111], v[152:155], v[68:71]
v_mfma_f32_16x16x32_bf16 v[72:75], v[112:115], v[152:155], v[72:75]
v_mfma_f32_16x16x32_bf16 v[76:79], v[116:119], v[152:155], v[76:79]
s_waitcnt lgkmcnt(14)
ds_read_b128 v[152:155], v164 offset:45056
v_mfma_f32_16x16x32_bf16 v[80:83], v[100:103], v[156:159], v[80:83]
buffer_load_dwordx4 v250, s[8:11], s82 offen offset:2048 sc1 lds
v_mfma_f32_16x16x32_bf16 v[84:87], v[104:107], v[156:159], v[84:87]
v_mfma_f32_16x16x32_bf16 v[88:91], v[108:111], v[156:159], v[88:91]
v_mfma_f32_16x16x32_bf16 v[92:95], v[112:115], v[156:159], v[92:95]
buffer_load_dwordx4 v251, s[8:11], s82 offen offset:3072 sc1 lds
v_mfma_f32_16x16x32_bf16 v[96:99], v[116:119], v[156:159], v[96:99]
s_waitcnt lgkmcnt(4)
s_add_u32 m0, s85, 126976
v_mfma_f32_16x16x32_bf16 v[0:3], v[120:123], v[160:163], v[0:3]
v_mfma_f32_16x16x32_bf16 v[4:7], v[124:127], v[160:163], v[4:7]
buffer_load_dwordx4 v254, s[8:11], s82 offen sc1 lds
v_mfma_f32_16x16x32_bf16 v[8:11], v[128:131], v[160:163], v[8:11]
s_add_u32 s82, s82, s83
v_mfma_f32_16x16x32_bf16 v[12:15], v[132:135], v[160:163], v[12:15]
v_mfma_f32_16x16x32_bf16 v[16:19], v[136:139], v[160:163], v[16:19]
s_waitcnt lgkmcnt(3)
v_mfma_f32_16x16x32_bf16 v[20:23], v[120:123], v[140:143], v[20:23]
v_mfma_f32_16x16x32_bf16 v[24:27], v[124:127], v[140:143], v[24:27]
v_mfma_f32_16x16x32_bf16 v[28:31], v[128:131], v[140:143], v[28:31]
v_mfma_f32_16x16x32_bf16 v[32:35], v[132:135], v[140:143], v[32:35]
s_waitcnt vmcnt(20) lgkmcnt(0)
s_barrier
ds_read_b64_tr_b16 v[100:101], v168 offset:0
v_mfma_f32_16x16x32_bf16 v[36:39], v[136:139], v[140:143], v[36:39]
s_waitcnt lgkmcnt(15)
ds_read_b64_tr_b16 v[102:103], v168 offset:5120
ds_read_b64_tr_b16 v[104:105], v171 offset:32
v_mfma_f32_16x16x32_bf16 v[40:43], v[120:123], v[144:147], v[40:43]
s_add_u32 m0, s85, 20480
ds_read_b64_tr_b16 v[106:107], v171 offset:5152
ds_read_b64_tr_b16 v[108:109], v168 offset:64
v_mfma_f32_16x16x32_bf16 v[44:47], v[124:127], v[144:147], v[44:47]
ds_read_b64_tr_b16 v[110:111], v168 offset:5184
ds_read_b64_tr_b16 v[112:113], v171 offset:96
v_mfma_f32_16x16x32_bf16 v[48:51], v[128:131], v[144:147], v[48:51]
ds_read_b64_tr_b16 v[114:115], v171 offset:5216
ds_read_b64_tr_b16 v[116:117], v168 offset:128
v_mfma_f32_16x16x32_bf16 v[52:55], v[132:135], v[144:147], v[52:55]
ds_read_b64_tr_b16 v[118:119], v168 offset:5248
ds_read_b128 v[156:159], v165 offset:0
v_mfma_f32_16x16x32_bf16 v[56:59], v[136:139], v[144:147], v[56:59]
s_waitcnt lgkmcnt(15)
ds_read_b128 v[160:163], v165 offset:1024
ds_read_b128 v[140:143], v165 offset:2048
v_mfma_f32_16x16x32_bf16 v[60:63], v[120:123], v[148:151], v[60:63]
ds_read_b128 v[144:147], v165 offset:3072
v_mfma_f32_16x16x32_bf16 v[64:67], v[124:127], v[148:151], v[64:67]
buffer_load_dwordx4 v248, s[8:11], s82 offen offset:0 sc1 lds
v_mfma_f32_16x16x32_bf16 v[68:71], v[128:131], v[148:151], v[68:71]
v_mfma_f32_16x16x32_bf16 v[72:75], v[132:135], v[148:151], v[72:75]
v_mfma_f32_16x16x32_bf16 v[76:79], v[136:139], v[148:151], v[76:79]
s_waitcnt lgkmcnt(15)
ds_read_b128 v[148:151], v165 offset:4096
v_mfma_f32_16x16x32_bf16 v[80:83], v[120:123], v[152:155], v[80:83]
buffer_load_dwordx4 v249, s[8:11], s82 offen offset:1024 sc1 lds
v_mfma_f32_16x16x32_bf16 v[84:87], v[124:127], v[152:155], v[84:87]
v_mfma_f32_16x16x32_bf16 v[88:91], v[128:131], v[152:155], v[88:91]
v_mfma_f32_16x16x32_bf16 v[92:95], v[132:135], v[152:155], v[92:95]
buffer_load_dwordx4 v250, s[8:11], s82 offen offset:2048 sc1 lds
v_mfma_f32_16x16x32_bf16 v[96:99], v[136:139], v[152:155], v[96:99]
s_waitcnt lgkmcnt(4)
v_mfma_f32_16x16x32_bf16 v[0:3], v[100:103], v[156:159], v[0:3]
ds_read_b64_tr_b16 v[120:121], v168 offset:20480
ds_read_b64_tr_b16 v[122:123], v168 offset:25600
v_mfma_f32_16x16x32_bf16 v[4:7], v[104:107], v[156:159], v[4:7]
ds_read_b64_tr_b16 v[124:125], v171 offset:20512
ds_read_b64_tr_b16 v[126:127], v171 offset:25632
v_mfma_f32_16x16x32_bf16 v[8:11], v[108:111], v[156:159], v[8:11]
ds_read_b64_tr_b16 v[128:129], v168 offset:20544
ds_read_b64_tr_b16 v[130:131], v168 offset:25664
v_mfma_f32_16x16x32_bf16 v[12:15], v[112:115], v[156:159], v[12:15]
ds_read_b64_tr_b16 v[132:133], v171 offset:20576
ds_read_b64_tr_b16 v[134:135], v171 offset:25696
v_mfma_f32_16x16x32_bf16 v[16:19], v[116:119], v[156:159], v[16:19]
s_waitcnt lgkmcnt(11)
ds_read_b64_tr_b16 v[136:137], v168 offset:20608
ds_read_b64_tr_b16 v[138:139], v168 offset:25728
v_mfma_f32_16x16x32_bf16 v[20:23], v[100:103], v[160:163], v[20:23]
ds_read_b128 v[152:155], v165 offset:20480
ds_read_b128 v[156:159], v165 offset:21504
v_mfma_f32_16x16x32_bf16 v[24:27], v[104:107], v[160:163], v[24:27]
buffer_load_dwordx4 v251, s[8:11], s82 offen offset:3072 sc1 lds
v_mfma_f32_16x16x32_bf16 v[28:31], v[108:111], v[160:163], v[28:31]
s_add_u32 m0, s85, 24576
v_mfma_f32_16x16x32_bf16 v[32:35], v[112:115], v[160:163], v[32:35]
v_mfma_f32_16x16x32_bf16 v[36:39], v[116:119], v[160:163], v[36:39]
s_waitcnt lgkmcnt(14)
ds_read_b128 v[160:163], v165 offset:22528
v_mfma_f32_16x16x32_bf16 v[40:43], v[100:103], v[140:143], v[40:43]
buffer_load_dwordx4 v254, s[8:11], s82 offen sc1 lds
v_mfma_f32_16x16x32_bf16 v[44:47], v[104:107], v[140:143], v[44:47]
s_add_u32 s82, s82, s83
s_add_u32 m0, s85, 40960
v_mfma_f32_16x16x32_bf16 v[48:51], v[108:111], v[140:143], v[48:51]
v_mfma_f32_16x16x32_bf16 v[52:55], v[112:115], v[140:143], v[52:55]
buffer_load_dwordx4 v248, s[8:11], s82 offen offset:0 sc1 lds
v_mfma_f32_16x16x32_bf16 v[56:59], v[116:119], v[140:143], v[56:59]
s_waitcnt lgkmcnt(14)
ds_read_b128 v[140:143], v165 offset:23552
v_mfma_f32_16x16x32_bf16 v[60:63], v[100:103], v[144:147], v[60:63]
v_mfma_f32_16x16x32_bf16 v[64:67], v[104:107], v[144:147], v[64:67]
buffer_load_dwordx4 v249, s[8:11], s82 offen offset:1024 sc1 lds
v_mfma_f32_16x16x32_bf16 v[68:71], v[108:111], v[144:147], v[68:71]
v_mfma_f32_16x16x32_bf16 v[72:75], v[112:115], v[144:147], v[72:75]
v_mfma_f32_16x16x32_bf16 v[76:79], v[116:119], v[144:147], v[76:79]
s_waitcnt lgkmcnt(14)
ds_read_b128 v[144:147], v165 offset:24576
v_mfma_f32_16x16x32_bf16 v[80:83], v[100:103], v[148:151], v[80:83]
buffer_load_dwordx4 v250, s[8:11], s82 offen offset:2048 sc1 lds
v_mfma_f32_16x16x32_bf16 v[84:87], v[104:107], v[148:151], v[84:87]
v_mfma_f32_16x16x32_bf16 v[88:91], v[108:111], v[148:151], v[88:91]
v_mfma_f32_16x16x32_bf16 v[92:95], v[112:115], v[148:151], v[92:95]
buffer_load_dwordx4 v251, s[8:11], s82 offen offset:3072 sc1 lds
v_mfma_f32_16x16x32_bf16 v[96:99], v[116:119], v[148:151], v[96:99]
s_waitcnt lgkmcnt(4)
s_add_u32 m0, s85, 45056
v_mfma_f32_16x16x32_bf16 v[0:3], v[120:123], v[152:155], v[0:3]
v_mfma_f32_16x16x32_bf16 v[4:7], v[124:127], v[152:155], v[4:7]
buffer_load_dwordx4 v254, s[8:11], s82 offen sc1 lds
v_mfma_f32_16x16x32_bf16 v[8:11], v[128:131], v[152:155], v[8:11]
s_add_u32 s82, s82, s83
v_mfma_f32_16x16x32_bf16 v[12:15], v[132:135], v[152:155], v[12:15]
v_mfma_f32_16x16x32_bf16 v[16:19], v[136:139], v[152:155], v[16:19]
s_waitcnt lgkmcnt(3)
v_mfma_f32_16x16x32_bf16 v[20:23], v[120:123], v[156:159], v[20:23]
v_mfma_f32_16x16x32_bf16 v[24:27], v[124:127], v[156:159], v[24:27]
v_mfma_f32_16x16x32_bf16 v[28:31], v[128:131], v[156:159], v[28:31]
v_mfma_f32_16x16x32_bf16 v[32:35], v[132:135], v[156:159], v[32:35]
s_waitcnt vmcnt(20) lgkmcnt(0)
s_barrier
ds_read_b64_tr_b16 v[100:101], v168 offset:40960
v_mfma_f32_16x16x32_bf16 v[36:39], v[136:139], v[156:159], v[36:39]
s_waitcnt lgkmcnt(15)
ds_read_b64_tr_b16 v[102:103], v168 offset:46080
ds_read_b64_tr_b16 v[104:105], v171 offset:40992
v_mfma_f32_16x16x32_bf16 v[40:43], v[120:123], v[160:163], v[40:43]
s_add_u32 m0, s85, 61440
ds_read_b64_tr_b16 v[106:107], v171 offset:46112
ds_read_b64_tr_b16 v[108:109], v168 offset:41024
v_mfma_f32_16x16x32_bf16 v[44:47], v[124:127], v[160:163], v[44:47]
ds_read_b64_tr_b16 v[110:111], v168 offset:46144
ds_read_b64_tr_b16 v[112:113], v171 offset:41056
v_mfma_f32_16x16x32_bf16 v[48:51], v[128:131], v[160:163], v[48:51]
ds_read_b64_tr_b16 v[114:115], v171 offset:46176
ds_read_b64_tr_b16 v[116:117], v168 offset:41088
v_mfma_f32_16x16x32_bf16 v[52:55], v[132:135], v[160:163], v[52:55]
ds_read_b64_tr_b16 v[118:119], v168 offset:46208
ds_read_b128 v[148:151], v165 offset:40960
v_mfma_f32_16x16x32_bf16 v[56:59], v[136:139], v[160:163], v[56:59]
s_waitcnt lgkmcnt(15)
ds_read_b128 v[152:155], v165 offset:41984
ds_read_b128 v[156:159], v165 offset:43008
v_mfma_f32_16x16x32_bf16 v[60:63], v[120:123], v[140:143], v[60:63]
ds_read_b128 v[160:163], v165 offset:44032
v_mfma_f32_16x16x32_bf16 v[64:67], v[124:127], v[140:143], v[64:67]
buffer_load_dwordx4 v248, s[8:11], s82 offen offset:0 sc1 lds
v_mfma_f32_16x16x32_bf16 v[68:71], v[128:131], v[140:143], v[68:71]
v_mfma_f32_16x16x32_bf16 v[72:75], v[132:135], v[140:143], v[72:75]
v_mfma_f32_16x16x32_bf16 v[76:79], v[136:139], v[140:143], v[76:79]
s_waitcnt lgkmcnt(15)
ds_read_b128 v[140:143], v165 offset:45056
v_mfma_f32_16x16x32_bf16 v[80:83], v[120:123], v[144:147], v[80:83]
buffer_load_dwordx4 v249, s[8:11], s82 offen offset:1024 sc1 lds
v_mfma_f32_16x16x32_bf16 v[84:87], v[124:127], v[144:147], v[84:87]
v_mfma_f32_16x16x32_bf16 v[88:91], v[128:131], v[144:147], v[88:91]
v_mfma_f32_16x16x32_bf16 v[92:95], v[132:135], v[144:147], v[92:95]
buffer_load_dwordx4 v250, s[8:11], s82 offen offset:2048 sc1 lds
v_mfma_f32_16x16x32_bf16 v[96:99], v[136:139], v[144:147], v[96:99]
s_waitcnt lgkmcnt(4)
v_mfma_f32_16x16x32_bf16 v[0:3], v[100:103], v[148:151], v[0:3]
ds_read_b64_tr_b16 v[120:121], v169 offset:20480
ds_read_b64_tr_b16 v[122:123], v169 offset:25600
v_mfma_f32_16x16x32_bf16 v[4:7], v[104:107], v[148:151], v[4:7]
ds_read_b64_tr_b16 v[124:125], v172 offset:20512
ds_read_b64_tr_b16 v[126:127], v172 offset:25632
v_mfma_f32_16x16x32_bf16 v[8:11], v[108:111], v[148:151], v[8:11]
ds_read_b64_tr_b16 v[128:129], v169 offset:20544
ds_read_b64_tr_b16 v[130:131], v169 offset:25664
v_mfma_f32_16x16x32_bf16 v[12:15], v[112:115], v[148:151], v[12:15]
ds_read_b64_tr_b16 v[132:133], v172 offset:20576
ds_read_b64_tr_b16 v[134:135], v172 offset:25696
v_mfma_f32_16x16x32_bf16 v[16:19], v[116:119], v[148:151], v[16:19]
s_waitcnt lgkmcnt(11)
ds_read_b64_tr_b16 v[136:137], v169 offset:20608
ds_read_b64_tr_b16 v[138:139], v169 offset:25728
v_mfma_f32_16x16x32_bf16 v[20:23], v[100:103], v[152:155], v[20:23]
ds_read_b128 v[144:147], v166 offset:20480
ds_read_b128 v[148:151], v166 offset:21504
v_mfma_f32_16x16x32_bf16 v[24:27], v[104:107], v[152:155], v[24:27]
buffer_load_dwordx4 v251, s[8:11], s82 offen offset:3072 sc1 lds
v_mfma_f32_16x16x32_bf16 v[28:31], v[108:111], v[152:155], v[28:31]
s_add_u32 m0, s85, 65536
v_mfma_f32_16x16x32_bf16 v[32:35], v[112:115], v[152:155], v[32:35]
v_mfma_f32_16x16x32_bf16 v[36:39], v[116:119], v[152:155], v[36:39]
s_waitcnt lgkmcnt(14)
ds_read_b128 v[152:155], v166 offset:22528
v_mfma_f32_16x16x32_bf16 v[40:43], v[100:103], v[156:159], v[40:43]
buffer_load_dwordx4 v254, s[8:11], s82 offen sc1 lds
v_mfma_f32_16x16x32_bf16 v[44:47], v[104:107], v[156:159], v[44:47]
s_add_u32 s82, s82, s83
s_add_u32 m0, s85, 81920
v_mfma_f32_16x16x32_bf16 v[48:51], v[108:111], v[156:159], v[48:51]
v_mfma_f32_16x16x32_bf16 v[52:55], v[112:115], v[156:159], v[52:55]
buffer_load_dwordx4 v248, s[8:11], s82 offen offset:0 sc1 lds
v_mfma_f32_16x16x32_bf16 v[56:59], v[116:119], v[156:159], v[56:59]
s_waitcnt lgkmcnt(14)
ds_read_b128 v[156:159], v166 offset:23552
v_mfma_f32_16x16x32_bf16 v[60:63], v[100:103], v[160:163], v[60:63]
v_mfma_f32_16x16x32_bf16 v[64:67], v[104:107], v[160:163], v[64:67]
buffer_load_dwordx4 v249, s[8:11], s82 offen offset:1024 sc1 lds
v_mfma_f32_16x16x32_bf16 v[68:71], v[108:111], v[160:163], v[68:71]
v_mfma_f32_16x16x32_bf16 v[72:75], v[112:115], v[160:163], v[72:75]
v_mfma_f32_16x16x32_bf16 v[76:79], v[116:119], v[160:163], v[76:79]
s_waitcnt lgkmcnt(14)
ds_read_b128 v[160:163], v166 offset:24576
v_mfma_f32_16x16x32_bf16 v[80:83], v[100:103], v[140:143], v[80:83]
buffer_load_dwordx4 v250, s[8:11], s82 offen offset:2048 sc1 lds
v_mfma_f32_16x16x32_bf16 v[84:87], v[104:107], v[140:143], v[84:87]
v_mfma_f32_16x16x32_bf16 v[88:91], v[108:111], v[140:143], v[88:91]
v_mfma_f32_16x16x32_bf16 v[92:95], v[112:115], v[140:143], v[92:95]
buffer_load_dwordx4 v251, s[8:11], s82 offen offset:3072 sc1 lds
v_mfma_f32_16x16x32_bf16 v[96:99], v[116:119], v[140:143], v[96:99]
s_waitcnt lgkmcnt(4)
s_add_u32 m0, s85, 86016
v_mfma_f32_16x16x32_bf16 v[0:3], v[120:123], v[144:147], v[0:3]
v_mfma_f32_16x16x32_bf16 v[4:7], v[124:127], v[144:147], v[4:7]
buffer_load_dwordx4 v254, s[8:11], s82 offen sc1 lds
v_mfma_f32_16x16x32_bf16 v[8:11], v[128:131], v[144:147], v[8:11]
s_add_u32 s82, s82, s83
v_mfma_f32_16x16x32_bf16 v[12:15], v[132:135], v[144:147], v[12:15]
v_mfma_f32_16x16x32_bf16 v[16:19], v[136:139], v[144:147], v[16:19]
s_waitcnt lgkmcnt(3)
v_mfma_f32_16x16x32_bf16 v[20:23], v[120:123], v[148:151], v[20:23]
v_mfma_f32_16x16x32_bf16 v[24:27], v[124:127], v[148:151], v[24:27]
v_mfma_f32_16x16x32_bf16 v[28:31], v[128:131], v[148:151], v[28:31]
v_mfma_f32_16x16x32_bf16 v[32:35], v[132:135], v[148:151], v[32:35]
s_waitcnt vmcnt(20) lgkmcnt(0)
s_barrier
ds_read_b64_tr_b16 v[100:101], v167 offset:0
v_mfma_f32_16x16x32_bf16 v[36:39], v[136:139], v[148:151], v[36:39]
s_waitcnt lgkmcnt(15)
ds_read_b64_tr_b16 v[102:103], v167 offset:5120
ds_read_b64_tr_b16 v[104:105], v170 offset:32
v_mfma_f32_16x16x32_bf16 v[40:43], v[120:123], v[152:155], v[40:43]
s_add_u32 m0, s85, 102400
ds_read_b64_tr_b16 v[106:107], v170 offset:5152
ds_read_b64_tr_b16 v[108:109], v167 offset:64
v_mfma_f32_16x16x32_bf16 v[44:47], v[124:127], v[152:155], v[44:47]
ds_read_b64_tr_b16 v[110:111], v167 offset:5184
ds_read_b64_tr_b16 v[112:113], v170 offset:96
v_mfma_f32_16x16x32_bf16 v[48:51], v[128:131], v[152:155], v[48:51]
ds_read_b64_tr_b16 v[114:115], v170 offset:5216
ds_read_b64_tr_b16 v[116:117], v167 offset:128
v_mfma_f32_16x16x32_bf16 v[52:55], v[132:135], v[152:155], v[52:55]
ds_read_b64_tr_b16 v[118:119], v167 offset:5248
ds_read_b128 v[140:143], v164 offset:0
v_mfma_f32_16x16x32_bf16 v[56:59], v[136:139], v[152:155], v[56:59]
s_waitcnt lgkmcnt(15)
ds_read_b128 v[144:147], v164 offset:1024
ds_read_b128 v[148:151], v164 offset:2048
v_mfma_f32_16x16x32_bf16 v[60:63], v[120:123], v[156:159], v[60:63]
ds_read_b128 v[152:155], v164 offset:3072
v_mfma_f32_16x16x32_bf16 v[64:67], v[124:127], v[156:159], v[64:67]
buffer_load_dwordx4 v248, s[8:11], s82 offen offset:0 sc1 lds
v_mfma_f32_16x16x32_bf16 v[68:71], v[128:131], v[156:159], v[68:71]
v_mfma_f32_16x16x32_bf16 v[72:75], v[132:135], v[156:159], v[72:75]
v_mfma_f32_16x16x32_bf16 v[76:79], v[136:139], v[156:159], v[76:79]
s_waitcnt lgkmcnt(15)
ds_read_b128 v[156:159], v164 offset:4096
v_mfma_f32_16x16x32_bf16 v[80:83], v[120:123], v[160:163], v[80:83]
buffer_load_dwordx4 v249, s[8:11], s82 offen offset:1024 sc1 lds
v_mfma_f32_16x16x32_bf16 v[84:87], v[124:127], v[160:163], v[84:87]
v_mfma_f32_16x16x32_bf16 v[88:91], v[128:131], v[160:163], v[88:91]
v_mfma_f32_16x16x32_bf16 v[92:95], v[132:135], v[160:163], v[92:95]
buffer_load_dwordx4 v250, s[8:11], s82 offen offset:2048 sc1 lds
v_mfma_f32_16x16x32_bf16 v[96:99], v[136:139], v[160:163], v[96:99]
s_waitcnt lgkmcnt(4)
v_mfma_f32_16x16x32_bf16 v[0:3], v[100:103], v[140:143], v[0:3]
ds_read_b64_tr_b16 v[120:121], v169 offset:0
ds_read_b64_tr_b16 v[122:123], v169 offset:5120
v_mfma_f32_16x16x32_bf16 v[4:7], v[104:107], v[140:143], v[4:7]
ds_read_b64_tr_b16 v[124:125], v172 offset:32
ds_read_b64_tr_b16 v[126:127], v172 offset:5152
v_mfma_f32_16x16x32_bf16 v[8:11], v[108:111], v[140:143], v[8:11]
ds_read_b64_tr_b16 v[128:129], v169 offset:64
ds_read_b64_tr_b16 v[130:131], v169 offset:5184
v_mfma_f32_16x16x32_bf16 v[12:15], v[112:115], v[140:143], v[12:15]
ds_read_b64_tr_b16 v[132:133], v172 offset:96
ds_read_b64_tr_b16 v[134:135], v172 offset:5216
v_mfma_f32_16x16x32_bf16 v[16:19], v[116:119], v[140:143], v[16:19]
s_waitcnt lgkmcnt(11)
ds_read_b64_tr_b16 v[136:137], v169 offset:128
ds_read_b64_tr_b16 v[138:139], v169 offset:5248
v_mfma_f32_16x16x32_bf16 v[20:23], v[100:103], v[144:147], v[20:23]
ds_read_b128 v[160:163], v166 offset:0
ds_read_b128 v[140:143], v166 offset:1024
v_mfma_f32_16x16x32_bf16 v[24:27], v[104:107], v[144:147], v[24:27]
buffer_load_dwordx4 v251, s[8:11], s82 offen offset:3072 sc1 lds
v_mfma_f32_16x16x32_bf16 v[28:31], v[108:111], v[144:147], v[28:31]
s_add_u32 m0, s85, 106496
v_mfma_f32_16x16x32_bf16 v[32:35], v[112:115], v[144:147], v[32:35]
v_mfma_f32_16x16x32_bf16 v[36:39], v[116:119], v[144:147], v[36:39]
s_waitcnt lgkmcnt(14)
ds_read_b128 v[144:147], v166 offset:2048
v_mfma_f32_16x16x32_bf16 v[40:43], v[100:103], v[148:151], v[40:43]
buffer_load_dwordx4 v254, s[8:11], s82 offen sc1 lds
v_mfma_f32_16x16x32_bf16 v[44:47], v[104:107], v[148:151], v[44:47]
s_add_u32 s82, s82, s83
s_add_u32 m0, s85, 143360
v_mfma_f32_16x16x32_bf16 v[48:51], v[108:111], v[148:151], v[48:51]
v_mfma_f32_16x16x32_bf16 v[52:55], v[112:115], v[148:151], v[52:55]
buffer_load_dwordx4 v248, s[8:11], s82 offen offset:0 sc1 lds
v_mfma_f32_16x16x32_bf16 v[56:59], v[116:119], v[148:151], v[56:59]
s_waitcnt lgkmcnt(14)
ds_read_b128 v[148:151], v166 offset:3072
v_mfma_f32_16x16x32_bf16 v[60:63], v[100:103], v[152:155], v[60:63]
v_mfma_f32_16x16x32_bf16 v[64:67], v[104:107], v[152:155], v[64:67]
buffer_load_dwordx4 v249, s[8:11], s82 offen offset:1024 sc1 lds
v_mfma_f32_16x16x32_bf16 v[68:71], v[108:111], v[152:155], v[68:71]
v_mfma_f32_16x16x32_bf16 v[72:75], v[112:115], v[152:155], v[72:75]
v_mfma_f32_16x16x32_bf16 v[76:79], v[116:119], v[152:155], v[76:79]
s_waitcnt lgkmcnt(14)
ds_read_b128 v[152:155], v166 offset:4096
v_mfma_f32_16x16x32_bf16 v[80:83], v[100:103], v[156:159], v[80:83]
buffer_load_dwordx4 v250, s[8:11], s82 offen offset:2048 sc1 lds
v_mfma_f32_16x16x32_bf16 v[84:87], v[104:107], v[156:159], v[84:87]
v_mfma_f32_16x16x32_bf16 v[88:91], v[108:111], v[156:159], v[88:91]
v_mfma_f32_16x16x32_bf16 v[92:95], v[112:115], v[156:159], v[92:95]
buffer_load_dwordx4 v251, s[8:11], s82 offen offset:3072 sc1 lds
v_mfma_f32_16x16x32_bf16 v[96:99], v[116:119], v[156:159], v[96:99]
s_waitcnt lgkmcnt(4)
s_add_u32 m0, s85, 147456
v_mfma_f32_16x16x32_bf16 v[0:3], v[120:123], v[160:163], v[0:3]
v_mfma_f32_16x16x32_bf16 v[4:7], v[124:127], v[160:163], v[4:7]
buffer_load_dwordx4 v254, s[8:11], s82 offen sc1 lds
v_mfma_f32_16x16x32_bf16 v[8:11], v[128:131], v[160:163], v[8:11]
s_add_u32 s82, s82, s83
v_mfma_f32_16x16x32_bf16 v[12:15], v[132:135], v[160:163], v[12:15]
v_mfma_f32_16x16x32_bf16 v[16:19], v[136:139], v[160:163], v[16:19]
s_waitcnt lgkmcnt(3)
v_mfma_f32_16x16x32_bf16 v[20:23], v[120:123], v[140:143], v[20:23]
v_mfma_f32_16x16x32_bf16 v[24:27], v[124:127], v[140:143], v[24:27]
v_mfma_f32_16x16x32_bf16 v[28:31], v[128:131], v[140:143], v[28:31]
v_mfma_f32_16x16x32_bf16 v[32:35], v[132:135], v[140:143], v[32:35]
s_waitcnt vmcnt(20) lgkmcnt(0)
s_barrier
ds_read_b64_tr_b16 v[100:101], v167 offset:20480
v_mfma_f32_16x16x32_bf16 v[36:39], v[136:139], v[140:143], v[36:39]
s_waitcnt lgkmcnt(15)
ds_read_b64_tr_b16 v[102:103], v167 offset:25600
ds_read_b64_tr_b16 v[104:105], v170 offset:20512
v_mfma_f32_16x16x32_bf16 v[40:43], v[120:123], v[144:147], v[40:43]
s_add_u32 m0, s85, 0
ds_read_b64_tr_b16 v[106:107], v170 offset:25632
ds_read_b64_tr_b16 v[108:109], v167 offset:20544
v_mfma_f32_16x16x32_bf16 v[44:47], v[124:127], v[144:147], v[44:47]
ds_read_b64_tr_b16 v[110:111], v167 offset:25664
ds_read_b64_tr_b16 v[112:113], v170 offset:20576
v_mfma_f32_16x16x32_bf16 v[48:51], v[128:131], v[144:147], v[48:51]
ds_read_b64_tr_b16 v[114:115], v170 offset:25696
ds_read_b64_tr_b16 v[116:117], v167 offset:20608
v_mfma_f32_16x16x32_bf16 v[52:55], v[132:135], v[144:147], v[52:55]
ds_read_b64_tr_b16 v[118:119], v167 offset:25728
ds_read_b128 v[156:159], v164 offset:20480
v_mfma_f32_16x16x32_bf16 v[56:59], v[136:139], v[144:147], v[56:59]
s_waitcnt lgkmcnt(15)
ds_read_b128 v[160:163], v164 offset:21504
ds_read_b128 v[140:143], v164 offset:22528
v_mfma_f32_16x16x32_bf16 v[60:63], v[120:123], v[148:151], v[60:63]
ds_read_b128 v[144:147], v164 offset:23552
v_mfma_f32_16x16x32_bf16 v[64:67], v[124:127], v[148:151], v[64:67]
buffer_load_dwordx4 v248, s[8:11], s82 offen offset:0 sc1 lds
v_mfma_f32_16x16x32_bf16 v[68:71], v[128:131], v[148:151], v[68:71]
v_mfma_f32_16x16x32_bf16 v[72:75], v[132:135], v[148:151], v[72:75]
v_mfma_f32_16x16x32_bf16 v[76:79], v[136:139], v[148:151], v[76:79]
s_waitcnt lgkmcnt(15)
ds_read_b128 v[148:151], v164 offset:24576
v_mfma_f32_16x16x32_bf16 v[80:83], v[120:123], v[152:155], v[80:83]
buffer_load_dwordx4 v249, s[8:11], s82 offen offset:1024 sc1 lds
v_mfma_f32_16x16x32_bf16 v[84:87], v[124:127], v[152:155], v[84:87]
v_mfma_f32_16x16x32_bf16 v[88:91], v[128:131], v[152:155], v[88:91]
v_mfma_f32_16x16x32_bf16 v[92:95], v[132:135], v[152:155], v[92:95]
buffer_load_dwordx4 v250, s[8:11], s82 offen offset:2048 sc1 lds
v_mfma_f32_16x16x32_bf16 v[96:99], v[136:139], v[152:155], v[96:99]
s_waitcnt lgkmcnt(4)
v_mfma_f32_16x16x32_bf16 v[0:3], v[100:103], v[156:159], v[0:3]
ds_read_b64_tr_b16 v[120:121], v167 offset:40960
ds_read_b64_tr_b16 v[122:123], v167 offset:46080
v_mfma_f32_16x16x32_bf16 v[4:7], v[104:107], v[156:159], v[4:7]
ds_read_b64_tr_b16 v[124:125], v170 offset:40992
ds_read_b64_tr_b16 v[126:127], v170 offset:46112
v_mfma_f32_16x16x32_bf16 v[8:11], v[108:111], v[156:159], v[8:11]
ds_read_b64_tr_b16 v[128:129], v167 offset:41024
ds_read_b64_tr_b16 v[130:131], v167 offset:46144
v_mfma_f32_16x16x32_bf16 v[12:15], v[112:115], v[156:159], v[12:15]
ds_read_b64_tr_b16 v[132:133], v170 offset:41056
ds_read_b64_tr_b16 v[134:135], v170 offset:46176
v_mfma_f32_16x16x32_bf16 v[16:19], v[116:119], v[156:159], v[16:19]
s_waitcnt lgkmcnt(11)
ds_read_b64_tr_b16 v[136:137], v167 offset:41088
ds_read_b64_tr_b16 v[138:139], v167 offset:46208
v_mfma_f32_16x16x32_bf16 v[20:23], v[100:103], v[160:163], v[20:23]
ds_read_b128 v[152:155], v164 offset:40960
ds_read_b128 v[156:159], v164 offset:41984
v_mfma_f32_16x16x32_bf16 v[24:27], v[104:107], v[160:163], v[24:27]
buffer_load_dwordx4 v251, s[8:11], s82 offen offset:3072 sc1 lds
v_mfma_f32_16x16x32_bf16 v[28:31], v[108:111], v[160:163], v[28:31]
s_add_u32 m0, s85, 4096
v_mfma_f32_16x16x32_bf16 v[32:35], v[112:115], v[160:163], v[32:35]
v_mfma_f32_16x16x32_bf16 v[36:39], v[116:119], v[160:163], v[36:39]
s_waitcnt lgkmcnt(14)
ds_read_b128 v[160:163], v164 offset:43008
v_mfma_f32_16x16x32_bf16 v[40:43], v[100:103], v[140:143], v[40:43]
buffer_load_dwordx4 v254, s[8:11], s82 offen sc1 lds
v_mfma_f32_16x16x32_bf16 v[44:47], v[104:107], v[140:143], v[44:47]
s_add_u32 s82, s82, s83
s_add_u32 m0, s85, 122880
v_mfma_f32_16x16x32_bf16 v[48:51], v[108:111], v[140:143], v[48:51]
v_mfma_f32_16x16x32_bf16 v[52:55], v[112:115], v[140:143], v[52:55]
buffer_load_dwordx4 v248, s[8:11], s82 offen offset:0 sc1 lds
v_mfma_f32_16x16x32_bf16 v[56:59], v[116:119], v[140:143], v[56:59]
s_waitcnt lgkmcnt(14)
ds_read_b128 v[140:143], v164 offset:44032
v_mfma_f32_16x16x32_bf16 v[60:63], v[100:103], v[144:147], v[60:63]
v_mfma_f32_16x16x32_bf16 v[64:67], v[104:107], v[144:147], v[64:67]
buffer_load_dwordx4 v249, s[8:11], s82 offen offset:1024 sc1 lds
v_mfma_f32_16x16x32_bf16 v[68:71], v[108:111], v[144:147], v[68:71]
v_mfma_f32_16x16x32_bf16 v[72:75], v[112:115], v[144:147], v[72:75]
v_mfma_f32_16x16x32_bf16 v[76:79], v[116:119], v[144:147], v[76:79]
s_waitcnt lgkmcnt(14)
ds_read_b128 v[144:147], v164 offset:45056
v_mfma_f32_16x16x32_bf16 v[80:83], v[100:103], v[148:151], v[80:83]
buffer_load_dwordx4 v250, s[8:11], s82 offen offset:2048 sc1 lds
v_mfma_f32_16x16x32_bf16 v[84:87], v[104:107], v[148:151], v[84:87]
v_mfma_f32_16x16x32_bf16 v[88:91], v[108:111], v[148:151], v[88:91]
v_mfma_f32_16x16x32_bf16 v[92:95], v[112:115], v[148:151], v[92:95]
buffer_load_dwordx4 v251, s[8:11], s82 offen offset:3072 sc1 lds
v_mfma_f32_16x16x32_bf16 v[96:99], v[116:119], v[148:151], v[96:99]
s_waitcnt lgkmcnt(4)
s_add_u32 m0, s85, 126976
v_mfma_f32_16x16x32_bf16 v[0:3], v[120:123], v[152:155], v[0:3]
v_mfma_f32_16x16x32_bf16 v[4:7], v[124:127], v[152:155], v[4:7]
buffer_load_dwordx4 v254, s[8:11], s82 offen sc1 lds
v_mfma_f32_16x16x32_bf16 v[8:11], v[128:131], v[152:155], v[8:11]
s_add_u32 s82, s82, s83
v_mfma_f32_16x16x32_bf16 v[12:15], v[132:135], v[152:155], v[12:15]
v_mfma_f32_16x16x32_bf16 v[16:19], v[136:139], v[152:155], v[16:19]
s_waitcnt lgkmcnt(3)
v_mfma_f32_16x16x32_bf16 v[20:23], v[120:123], v[156:159], v[20:23]
v_mfma_f32_16x16x32_bf16 v[24:27], v[124:127], v[156:159], v[24:27]
v_mfma_f32_16x16x32_bf16 v[28:31], v[128:131], v[156:159], v[28:31]
v_mfma_f32_16x16x32_bf16 v[32:35], v[132:135], v[156:159], v[32:35]
s_waitcnt vmcnt(20) lgkmcnt(0)
s_barrier
ds_read_b64_tr_b16 v[100:101], v168 offset:0
v_mfma_f32_16x16x32_bf16 v[36:39], v[136:139], v[156:159], v[36:39]
s_waitcnt lgkmcnt(15)
ds_read_b64_tr_b16 v[102:103], v168 offset:5120
ds_read_b64_tr_b16 v[104:105], v171 offset:32
v_mfma_f32_16x16x32_bf16 v[40:43], v[120:123], v[160:163], v[40:43]
s_add_u32 m0, s85, 20480
ds_read_b64_tr_b16 v[106:107], v171 offset:5152
ds_read_b64_tr_b16 v[108:109], v168 offset:64
v_mfma_f32_16x16x32_bf16 v[44:47], v[124:127], v[160:163], v[44:47]
ds_read_b64_tr_b16 v[110:111], v168 offset:5184
ds_read_b64_tr_b16 v[112:113], v171 offset:96
v_mfma_f32_16x16x32_bf16 v[48:51], v[128:131], v[160:163], v[48:51]
ds_read_b64_tr_b16 v[114:115], v171 offset:5216
ds_read_b64_tr_b16 v[116:117], v168 offset:128
v_mfma_f32_16x16x32_bf16 v[52:55], v[132:135], v[160:163], v[52:55]
ds_read_b64_tr_b16 v[118:119], v168 offset:5248
ds_read_b128 v[148:151], v165 offset:0
v_mfma_f32_16x16x32_bf16 v[56:59], v[136:139], v[160:163], v[56:59]
s_waitcnt lgkmcnt(15)
ds_read_b128 v[152:155], v165 offset:1024
ds_read_b128 v[156:159], v165 offset:2048
v_mfma_f32_16x16x32_bf16 v[60:63], v[120:123], v[140:143], v[60:63]
ds_read_b128 v[160:163], v165 offset:3072
v_mfma_f32_16x16x32_bf16 v[64:67], v[124:127], v[140:143], v[64:67]
buffer_load_dwordx4 v248, s[8:11], s82 offen offset:0 sc1 lds
v_mfma_f32_16x16x32_bf16 v[68:71], v[128:131], v[140:143], v[68:71]
v_mfma_f32_16x16x32_bf16 v[72:75], v[132:135], v[140:143], v[72:75]
v_mfma_f32_16x16x32_bf16 v[76:79], v[136:139], v[140:143], v[76:79]
s_waitcnt lgkmcnt(15)
ds_read_b128 v[140:143], v165 offset:4096
v_mfma_f32_16x16x32_bf16 v[80:83], v[120:123], v[144:147], v[80:83]
buffer_load_dwordx4 v249, s[8:11], s82 offen offset:1024 sc1 lds
v_mfma_f32_16x16x32_bf16 v[84:87], v[124:127], v[144:147], v[84:87]
v_mfma_f32_16x16x32_bf16 v[88:91], v[128:131], v[144:147], v[88:91]
v_mfma_f32_16x16x32_bf16 v[92:95], v[132:135], v[144:147], v[92:95]
buffer_load_dwordx4 v250, s[8:11], s82 offen offset:2048 sc1 lds
v_mfma_f32_16x16x32_bf16 v[96:99], v[136:139], v[144:147], v[96:99]
s_waitcnt lgkmcnt(4)
v_mfma_f32_16x16x32_bf16 v[0:3], v[100:103], v[148:151], v[0:3]
ds_read_b64_tr_b16 v[120:121], v168 offset:20480
ds_read_b64_tr_b16 v[122:123], v168 offset:25600
v_mfma_f32_16x16x32_bf16 v[4:7], v[104:107], v[148:151], v[4:7]
ds_read_b64_tr_b16 v[124:125], v171 offset:20512
ds_read_b64_tr_b16 v[126:127], v171 offset:25632
v_mfma_f32_16x16x32_bf16 v[8:11], v[108:111], v[148:151], v[8:11]
ds_read_b64_tr_b16 v[128:129], v168 offset:20544
ds_read_b64_tr_b16 v[130:131], v168 offset:25664
v_mfma_f32_16x16x32_bf16 v[12:15], v[112:115], v[148:151], v[12:15]
ds_read_b64_tr_b16 v[132:133], v171 offset:20576
ds_read_b64_tr_b16 v[134:135], v171 offset:25696
v_mfma_f32_16x16x32_bf16 v[16:19], v[116:119], v[148:151], v[16:19]
s_waitcnt lgkmcnt(11)
ds_read_b64_tr_b16 v[136:137], v168 offset:20608
ds_read_b64_tr_b16 v[138:139], v168 offset:25728
v_mfma_f32_16x16x32_bf16 v[20:23], v[100:103], v[152:155], v[20:23]
ds_read_b128 v[144:147], v165 offset:20480
ds_read_b128 v[148:151], v165 offset:21504
v_mfma_f32_16x16x32_bf16 v[24:27], v[104:107], v[152:155], v[24:27]
buffer_load_dwordx4 v251, s[8:11], s82 offen offset:3072 sc1 lds
v_mfma_f32_16x16x32_bf16 v[28:31], v[108:111], v[152:155], v[28:31]
s_add_u32 m0, s85, 24576
v_mfma_f32_16x16x32_bf16 v[32:35], v[112:115], v[152:155], v[32:35]
v_mfma_f32_16x16x32_bf16 v[36:39], v[116:119], v[152:155], v[36:39]
s_waitcnt lgkmcnt(14)
ds_read_b128 v[152:155], v165 offset:22528
v_mfma_f32_16x16x32_bf16 v[40:43], v[100:103], v[156:159], v[40:43]
buffer_load_dwordx4 v254, s[8:11], s82 offen sc1 lds
v_mfma_f32_16x16x32_bf16 v[44:47], v[104:107], v[156:159], v[44:47]
s_add_u32 s82, s82, s83
s_add_u32 m0, s85, 40960
v_mfma_f32_16x16x32_bf16 v[48:51], v[108:111], v[156:159], v[48:51]
v_mfma_f32_16x16x32_bf16 v[52:55], v[112:115], v[156:159], v[52:55]
buffer_load_dwordx4 v248, s[8:11], s82 offen offset:0 sc1 lds
v_mfma_f32_16x16x32_bf16 v[56:59], v[116:119], v[156:159], v[56:59]
s_waitcnt lgkmcnt(14)
ds_read_b128 v[156:159], v165 offset:23552
v_mfma_f32_16x16x32_bf16 v[60:63], v[100:103], v[160:163], v[60:63]
v_mfma_f32_16x16x32_bf16 v[64:67], v[104:107], v[160:163], v[64:67]
buffer_load_dwordx4 v249, s[8:11], s82 offen offset:1024 sc1 lds
v_mfma_f32_16x16x32_bf16 v[68:71], v[108:111], v[160:163], v[68:71]
v_mfma_f32_16x16x32_bf16 v[72:75], v[112:115], v[160:163], v[72:75]
v_mfma_f32_16x16x32_bf16 v[76:79], v[116:119], v[160:163], v[76:79]
s_waitcnt lgkmcnt(14)
ds_read_b128 v[160:163], v165 offset:24576
v_mfma_f32_16x16x32_bf16 v[80:83], v[100:103], v[140:143], v[80:83]
buffer_load_dwordx4 v250, s[8:11], s82 offen offset:2048 sc1 lds
v_mfma_f32_16x16x32_bf16 v[84:87], v[104:107], v[140:143], v[84:87]
v_mfma_f32_16x16x32_bf16 v[88:91], v[108:111], v[140:143], v[88:91]
v_mfma_f32_16x16x32_bf16 v[92:95], v[112:115], v[140:143], v[92:95]
buffer_load_dwordx4 v251, s[8:11], s82 offen offset:3072 sc1 lds
v_mfma_f32_16x16x32_bf16 v[96:99], v[116:119], v[140:143], v[96:99]
s_waitcnt lgkmcnt(4)
s_add_u32 m0, s85, 45056
v_mfma_f32_16x16x32_bf16 v[0:3], v[120:123], v[144:147], v[0:3]
v_mfma_f32_16x16x32_bf16 v[4:7], v[124:127], v[144:147], v[4:7]
buffer_load_dwordx4 v254, s[8:11], s82 offen sc1 lds
v_mfma_f32_16x16x32_bf16 v[8:11], v[128:131], v[144:147], v[8:11]
s_add_u32 s66, s66, 1
s_and_b32 s66, s66, 3
s_mul_i32 s40, s66, 24
v_mfma_f32_16x16x32_bf16 v[12:15], v[132:135], v[144:147], v[12:15]
s_add_u32 s40, s40, 12
s_mul_i32 s40, s40, s83
s_add_u32 s82, s67, s40
v_mfma_f32_16x16x32_bf16 v[16:19], v[136:139], v[144:147], v[16:19]
s_waitcnt lgkmcnt(3)
v_mfma_f32_16x16x32_bf16 v[20:23], v[120:123], v[148:151], v[20:23]
v_mfma_f32_16x16x32_bf16 v[24:27], v[124:127], v[148:151], v[24:27]
v_mfma_f32_16x16x32_bf16 v[28:31], v[128:131], v[148:151], v[28:31]
v_mfma_f32_16x16x32_bf16 v[32:35], v[132:135], v[148:151], v[32:35]
s_waitcnt vmcnt(20) lgkmcnt(0)
s_barrier
ds_read_b64_tr_b16 v[100:101], v168 offset:40960
v_mfma_f32_16x16x32_bf16 v[36:39], v[136:139], v[148:151], v[36:39]
s_waitcnt lgkmcnt(15)
ds_read_b64_tr_b16 v[102:103], v168 offset:46080
ds_read_b64_tr_b16 v[104:105], v171 offset:40992
v_mfma_f32_16x16x32_bf16 v[40:43], v[120:123], v[152:155], v[40:43]
s_add_u32 m0, s85, 61440
ds_read_b64_tr_b16 v[106:107], v171 offset:46112
ds_read_b64_tr_b16 v[108:109], v168 offset:41024
v_mfma_f32_16x16x32_bf16 v[44:47], v[124:127], v[152:155], v[44:47]
ds_read_b64_tr_b16 v[110:111], v168 offset:46144
ds_read_b64_tr_b16 v[112:113], v171 offset:41056
v_mfma_f32_16x16x32_bf16 v[48:51], v[128:131], v[152:155], v[48:51]
ds_read_b64_tr_b16 v[114:115], v171 offset:46176
ds_read_b64_tr_b16 v[116:117], v168 offset:41088
v_mfma_f32_16x16x32_bf16 v[52:55], v[132:135], v[152:155], v[52:55]
ds_read_b64_tr_b16 v[118:119], v168 offset:46208
ds_read_b128 v[140:143], v165 offset:40960
v_mfma_f32_16x16x32_bf16 v[56:59], v[136:139], v[152:155], v[56:59]
s_waitcnt lgkmcnt(15)
ds_read_b128 v[144:147], v165 offset:41984
ds_read_b128 v[148:151], v165 offset:43008
v_mfma_f32_16x16x32_bf16 v[60:63], v[120:123], v[156:159], v[60:63]
ds_read_b128 v[152:155], v165 offset:44032
v_mfma_f32_16x16x32_bf16 v[64:67], v[124:127], v[156:159], v[64:67]
buffer_load_dwordx4 v248, s[8:11], s82 offen offset:0 sc1 lds
v_mfma_f32_16x16x32_bf16 v[68:71], v[128:131], v[156:159], v[68:71]
v_mfma_f32_16x16x32_bf16 v[72:75], v[132:135], v[156:159], v[72:75]
v_mfma_f32_16x16x32_bf16 v[76:79], v[136:139], v[156:159], v[76:79]
s_waitcnt lgkmcnt(15)
ds_read_b128 v[156:159], v165 offset:45056
v_mfma_f32_16x16x32_bf16 v[80:83], v[120:123], v[160:163], v[80:83]
buffer_load_dwordx4 v249, s[8:11], s82 offen offset:1024 sc1 lds
v_mfma_f32_16x16x32_bf16 v[84:87], v[124:127], v[160:163], v[84:87]
v_mfma_f32_16x16x32_bf16 v[88:91], v[128:131], v[160:163], v[88:91]
v_mfma_f32_16x16x32_bf16 v[92:95], v[132:135], v[160:163], v[92:95]
buffer_load_dwordx4 v250, s[8:11], s82 offen offset:2048 sc1 lds
v_mfma_f32_16x16x32_bf16 v[96:99], v[136:139], v[160:163], v[96:99]
s_waitcnt lgkmcnt(4)
v_mfma_f32_16x16x32_bf16 v[0:3], v[100:103], v[140:143], v[0:3]
ds_read_b64_tr_b16 v[120:121], v169 offset:20480
ds_read_b64_tr_b16 v[122:123], v169 offset:25600
v_mfma_f32_16x16x32_bf16 v[4:7], v[104:107], v[140:143], v[4:7]
ds_read_b64_tr_b16 v[124:125], v172 offset:20512
ds_read_b64_tr_b16 v[126:127], v172 offset:25632
v_mfma_f32_16x16x32_bf16 v[8:11], v[108:111], v[140:143], v[8:11]
ds_read_b64_tr_b16 v[128:129], v169 offset:20544
ds_read_b64_tr_b16 v[130:131], v169 offset:25664
v_mfma_f32_16x16x32_bf16 v[12:15], v[112:115], v[140:143], v[12:15]
ds_read_b64_tr_b16 v[132:133], v172 offset:20576
ds_read_b64_tr_b16 v[134:135], v172 offset:25696
v_mfma_f32_16x16x32_bf16 v[16:19], v[116:119], v[140:143], v[16:19]
s_waitcnt lgkmcnt(11)
ds_read_b64_tr_b16 v[136:137], v169 offset:20608
ds_read_b64_tr_b16 v[138:139], v169 offset:25728
v_mfma_f32_16x16x32_bf16 v[20:23], v[100:103], v[144:147], v[20:23]
ds_read_b128 v[160:163], v166 offset:20480
ds_read_b128 v[140:143], v166 offset:21504
v_mfma_f32_16x16x32_bf16 v[24:27], v[104:107], v[144:147], v[24:27]
buffer_load_dwordx4 v251, s[8:11], s82 offen offset:3072 sc1 lds
v_mfma_f32_16x16x32_bf16 v[28:31], v[108:111], v[144:147], v[28:31]
s_add_u32 m0, s85, 65536
v_mfma_f32_16x16x32_bf16 v[32:35], v[112:115], v[144:147], v[32:35]
v_mfma_f32_16x16x32_bf16 v[36:39], v[116:119], v[144:147], v[36:39]
s_waitcnt lgkmcnt(14)
ds_read_b128 v[144:147], v166 offset:22528
v_mfma_f32_16x16x32_bf16 v[40:43], v[100:103], v[148:151], v[40:43]
buffer_load_dwordx4 v254, s[8:11], s82 offen sc1 lds
v_mfma_f32_16x16x32_bf16 v[44:47], v[104:107], v[148:151], v[44:47]
s_add_u32 s82, s82, s83
s_add_u32 m0, s85, 81920
v_mfma_f32_16x16x32_bf16 v[48:51], v[108:111], v[148:151], v[48:51]
v_mfma_f32_16x16x32_bf16 v[52:55], v[112:115], v[148:151], v[52:55]
buffer_load_dwordx4 v248, s[8:11], s82 offen offset:0 sc1 lds
v_mfma_f32_16x16x32_bf16 v[56:59], v[116:119], v[148:151], v[56:59]
s_waitcnt lgkmcnt(14)
ds_read_b128 v[148:151], v166 offset:23552
v_mfma_f32_16x16x32_bf16 v[60:63], v[100:103], v[152:155], v[60:63]
v_mfma_f32_16x16x32_bf16 v[64:67], v[104:107], v[152:155], v[64:67]
buffer_load_dwordx4 v249, s[8:11], s82 offen offset:1024 sc1 lds
v_mfma_f32_16x16x32_bf16 v[68:71], v[108:111], v[152:155], v[68:71]
v_mfma_f32_16x16x32_bf16 v[72:75], v[112:115], v[152:155], v[72:75]
v_mfma_f32_16x16x32_bf16 v[76:79], v[116:119], v[152:155], v[76:79]
s_waitcnt lgkmcnt(14)
ds_read_b128 v[152:155], v166 offset:24576
v_mfma_f32_16x16x32_bf16 v[80:83], v[100:103], v[156:159], v[80:83]
buffer_load_dwordx4 v250, s[8:11], s82 offen offset:2048 sc1 lds
v_mfma_f32_16x16x32_bf16 v[84:87], v[104:107], v[156:159], v[84:87]
v_mfma_f32_16x16x32_bf16 v[88:91], v[108:111], v[156:159], v[88:91]
v_mfma_f32_16x16x32_bf16 v[92:95], v[112:115], v[156:159], v[92:95]
buffer_load_dwordx4 v251, s[8:11], s82 offen offset:3072 sc1 lds
v_mfma_f32_16x16x32_bf16 v[96:99], v[116:119], v[156:159], v[96:99]
s_waitcnt lgkmcnt(4)
s_add_u32 m0, s85, 86016
v_mfma_f32_16x16x32_bf16 v[0:3], v[120:123], v[160:163], v[0:3]
v_mfma_f32_16x16x32_bf16 v[4:7], v[124:127], v[160:163], v[4:7]
buffer_load_dwordx4 v254, s[8:11], s82 offen sc1 lds
v_mfma_f32_16x16x32_bf16 v[8:11], v[128:131], v[160:163], v[8:11]
s_add_u32 s82, s82, s83
v_mfma_f32_16x16x32_bf16 v[12:15], v[132:135], v[160:163], v[12:15]
v_mfma_f32_16x16x32_bf16 v[16:19], v[136:139], v[160:163], v[16:19]
s_waitcnt lgkmcnt(3)
v_mfma_f32_16x16x32_bf16 v[20:23], v[120:123], v[140:143], v[20:23]
v_mfma_f32_16x16x32_bf16 v[24:27], v[124:127], v[140:143], v[24:27]
v_mfma_f32_16x16x32_bf16 v[28:31], v[128:131], v[140:143], v[28:31]
v_mfma_f32_16x16x32_bf16 v[32:35], v[132:135], v[140:143], v[32:35]
s_waitcnt vmcnt(20) lgkmcnt(0)
s_barrier
ds_read_b64_tr_b16 v[100:101], v167 offset:0
v_mfma_f32_16x16x32_bf16 v[36:39], v[136:139], v[140:143], v[36:39]
s_waitcnt lgkmcnt(15)
ds_read_b64_tr_b16 v[102:103], v167 offset:5120
ds_read_b64_tr_b16 v[104:105], v170 offset:32
v_mfma_f32_16x16x32_bf16 v[40:43], v[120:123], v[144:147], v[40:43]
s_add_u32 m0, s85, 102400
ds_read_b64_tr_b16 v[106:107], v170 offset:5152
ds_read_b64_tr_b16 v[108:109], v167 offset:64
v_mfma_f32_16x16x32_bf16 v[44:47], v[124:127], v[144:147], v[44:47]
ds_read_b64_tr_b16 v[110:111], v167 offset:5184
ds_read_b64_tr_b16 v[112:113], v170 offset:96
v_mfma_f32_16x16x32_bf16 v[48:51], v[128:131], v[144:147], v[48:51]
ds_read_b64_tr_b16 v[114:115], v170 offset:5216
ds_read_b64_tr_b16 v[116:117], v167 offset:128
v_mfma_f32_16x16x32_bf16 v[52:55], v[132:135], v[144:147], v[52:55]
ds_read_b64_tr_b16 v[118:119], v167 offset:5248
ds_read_b128 v[156:159], v164 offset:0
v_mfma_f32_16x16x32_bf16 v[56:59], v[136:139], v[144:147], v[56:59]
s_waitcnt lgkmcnt(15)
ds_read_b128 v[160:163], v164 offset:1024
ds_read_b128 v[140:143], v164 offset:2048
v_mfma_f32_16x16x32_bf16 v[60:63], v[120:123], v[148:151], v[60:63]
ds_read_b128 v[144:147], v164 offset:3072
v_mfma_f32_16x16x32_bf16 v[64:67], v[124:127], v[148:151], v[64:67]
buffer_load_dwordx4 v248, s[8:11], s82 offen offset:0 sc1 lds
v_mfma_f32_16x16x32_bf16 v[68:71], v[128:131], v[148:151], v[68:71]
v_mfma_f32_16x16x32_bf16 v[72:75], v[132:135], v[148:151], v[72:75]
v_mfma_f32_16x16x32_bf16 v[76:79], v[136:139], v[148:151], v[76:79]
s_waitcnt lgkmcnt(15)
ds_read_b128 v[148:151], v164 offset:4096
v_mfma_f32_16x16x32_bf16 v[80:83], v[120:123], v[152:155], v[80:83]
buffer_load_dwordx4 v249, s[8:11], s82 offen offset:1024 sc1 lds
v_mfma_f32_16x16x32_bf16 v[84:87], v[124:127], v[152:155], v[84:87]
v_mfma_f32_16x16x32_bf16 v[88:91], v[128:131], v[152:155], v[88:91]
v_mfma_f32_16x16x32_bf16 v[92:95], v[132:135], v[152:155], v[92:95]
buffer_load_dwordx4 v250, s[8:11], s82 offen offset:2048 sc1 lds
v_mfma_f32_16x16x32_bf16 v[96:99], v[136:139], v[152:155], v[96:99]
s_waitcnt lgkmcnt(4)
v_mfma_f32_16x16x32_bf16 v[0:3], v[100:103], v[156:159], v[0:3]
ds_read_b64_tr_b16 v[120:121], v169 offset:0
ds_read_b64_tr_b16 v[122:123], v169 offset:5120
v_mfma_f32_16x16x32_bf16 v[4:7], v[104:107], v[156:159], v[4:7]
ds_read_b64_tr_b16 v[124:125], v172 offset:32
ds_read_b64_tr_b16 v[126:127], v172 offset:5152
v_mfma_f32_16x16x32_bf16 v[8:11], v[108:111], v[156:159], v[8:11]
ds_read_b64_tr_b16 v[128:129], v169 offset:64
ds_read_b64_tr_b16 v[130:131], v169 offset:5184
v_mfma_f32_16x16x32_bf16 v[12:15], v[112:115], v[156:159], v[12:15]
ds_read_b64_tr_b16 v[132:133], v172 offset:96
ds_read_b64_tr_b16 v[134:135], v172 offset:5216
v_mfma_f32_16x16x32_bf16 v[16:19], v[116:119], v[156:159], v[16:19]
s_waitcnt lgkmcnt(11)
ds_read_b64_tr_b16 v[136:137], v169 offset:128
ds_read_b64_tr_b16 v[138:139], v169 offset:5248
v_mfma_f32_16x16x32_bf16 v[20:23], v[100:103], v[160:163], v[20:23]
ds_read_b128 v[152:155], v166 offset:0
ds_read_b128 v[156:159], v166 offset:1024
v_mfma_f32_16x16x32_bf16 v[24:27], v[104:107], v[160:163], v[24:27]
buffer_load_dwordx4 v251, s[8:11], s82 offen offset:3072 sc1 lds
v_mfma_f32_16x16x32_bf16 v[28:31], v[108:111], v[160:163], v[28:31]
s_add_u32 m0, s85, 106496
v_mfma_f32_16x16x32_bf16 v[32:35], v[112:115], v[160:163], v[32:35]
v_mfma_f32_16x16x32_bf16 v[36:39], v[116:119], v[160:163], v[36:39]
s_waitcnt lgkmcnt(14)
ds_read_b128 v[160:163], v166 offset:2048
v_mfma_f32_16x16x32_bf16 v[40:43], v[100:103], v[140:143], v[40:43]
buffer_load_dwordx4 v254, s[8:11], s82 offen sc1 lds
v_mfma_f32_16x16x32_bf16 v[44:47], v[104:107], v[140:143], v[44:47]
s_add_u32 s82, s82, s83
s_add_u32 m0, s85, 143360
v_mfma_f32_16x16x32_bf16 v[48:51], v[108:111], v[140:143], v[48:51]
v_mfma_f32_16x16x32_bf16 v[52:55], v[112:115], v[140:143], v[52:55]
buffer_load_dwordx4 v248, s[8:11], s82 offen offset:0 sc1 lds
v_mfma_f32_16x16x32_bf16 v[56:59], v[116:119], v[140:143], v[56:59]
s_waitcnt lgkmcnt(14)
ds_read_b128 v[140:143], v166 offset:3072
v_mfma_f32_16x16x32_bf16 v[60:63], v[100:103], v[144:147], v[60:63]
v_mfma_f32_16x16x32_bf16 v[64:67], v[104:107], v[144:147], v[64:67]
buffer_load_dwordx4 v249, s[8:11], s82 offen offset:1024 sc1 lds
v_mfma_f32_16x16x32_bf16 v[68:71], v[108:111], v[144:147], v[68:71]
v_mfma_f32_16x16x32_bf16 v[72:75], v[112:115], v[144:147], v[72:75]
v_mfma_f32_16x16x32_bf16 v[76:79], v[116:119], v[144:147], v[76:79]
s_waitcnt lgkmcnt(14)
ds_read_b128 v[144:147], v166 offset:4096
v_mfma_f32_16x16x32_bf16 v[80:83], v[100:103], v[148:151], v[80:83]
buffer_load_dwordx4 v250, s[8:11], s82 offen offset:2048 sc1 lds
v_mfma_f32_16x16x32_bf16 v[84:87], v[104:107], v[148:151], v[84:87]
v_mfma_f32_16x16x32_bf16 v[88:91], v[108:111], v[148:151], v[88:91]
v_mfma_f32_16x16x32_bf16 v[92:95], v[112:115], v[148:151], v[92:95]
buffer_load_dwordx4 v251, s[8:11], s82 offen offset:3072 sc1 lds
v_mfma_f32_16x16x32_bf16 v[96:99], v[116:119], v[148:151], v[96:99]
s_waitcnt lgkmcnt(4)
s_add_u32 m0, s85, 147456
v_mfma_f32_16x16x32_bf16 v[0:3], v[120:123], v[152:155], v[0:3]
v_mfma_f32_16x16x32_bf16 v[4:7], v[124:127], v[152:155], v[4:7]
buffer_load_dwordx4 v254, s[8:11], s82 offen sc1 lds
v_mfma_f32_16x16x32_bf16 v[8:11], v[128:131], v[152:155], v[8:11]
s_add_u32 s82, s82, s83
v_mfma_f32_16x16x32_bf16 v[12:15], v[132:135], v[152:155], v[12:15]
v_mfma_f32_16x16x32_bf16 v[16:19], v[136:139], v[152:155], v[16:19]
s_waitcnt lgkmcnt(3)
v_mfma_f32_16x16x32_bf16 v[20:23], v[120:123], v[156:159], v[20:23]
v_mfma_f32_16x16x32_bf16 v[24:27], v[124:127], v[156:159], v[24:27]
v_mfma_f32_16x16x32_bf16 v[28:31], v[128:131], v[156:159], v[28:31]
v_mfma_f32_16x16x32_bf16 v[32:35], v[132:135], v[156:159], v[32:35]
s_waitcnt vmcnt(20) lgkmcnt(0)
s_barrier
ds_read_b64_tr_b16 v[100:101], v167 offset:20480
v_mfma_f32_16x16x32_bf16 v[36:39], v[136:139], v[156:159], v[36:39]
s_waitcnt lgkmcnt(15)
ds_read_b64_tr_b16 v[102:103], v167 offset:25600
ds_read_b64_tr_b16 v[104:105], v170 offset:20512
v_mfma_f32_16x16x32_bf16 v[40:43], v[120:123], v[160:163], v[40:43]
s_add_u32 m0, s85, 0
ds_read_b64_tr_b16 v[106:107], v170 offset:25632
ds_read_b64_tr_b16 v[108:109], v167 offset:20544
v_mfma_f32_16x16x32_bf16 v[44:47], v[124:127], v[160:163], v[44:47]
ds_read_b64_tr_b16 v[110:111], v167 offset:25664
ds_read_b64_tr_b16 v[112:113], v170 offset:20576
v_mfma_f32_16x16x32_bf16 v[48:51], v[128:131], v[160:163], v[48:51]
ds_read_b64_tr_b16 v[114:115], v170 offset:25696
ds_read_b64_tr_b16 v[116:117], v167 offset:20608
v_mfma_f32_16x16x32_bf16 v[52:55], v[132:135], v[160:163], v[52:55]
ds_read_b64_tr_b16 v[118:119], v167 offset:25728
ds_read_b128 v[148:151], v164 offset:20480
v_mfma_f32_16x16x32_bf16 v[56:59], v[136:139], v[160:163], v[56:59]
s_waitcnt lgkmcnt(15)
ds_read_b128 v[152:155], v164 offset:21504
ds_read_b128 v[156:159], v164 offset:22528
v_mfma_f32_16x16x32_bf16 v[60:63], v[120:123], v[140:143], v[60:63]
ds_read_b128 v[160:163], v164 offset:23552
v_mfma_f32_16x16x32_bf16 v[64:67], v[124:127], v[140:143], v[64:67]
buffer_load_dwordx4 v248, s[8:11], s82 offen offset:0 sc1 lds
v_mfma_f32_16x16x32_bf16 v[68:71], v[128:131], v[140:143], v[68:71]
v_mfma_f32_16x16x32_bf16 v[72:75], v[132:135], v[140:143], v[72:75]
v_mfma_f32_16x16x32_bf16 v[76:79], v[136:139], v[140:143], v[76:79]
s_waitcnt lgkmcnt(15)
ds_read_b128 v[140:143], v164 offset:24576
v_mfma_f32_16x16x32_bf16 v[80:83], v[120:123], v[144:147], v[80:83]
buffer_load_dwordx4 v249, s[8:11], s82 offen offset:1024 sc1 lds
v_mfma_f32_16x16x32_bf16 v[84:87], v[124:127], v[144:147], v[84:87]
v_mfma_f32_16x16x32_bf16 v[88:91], v[128:131], v[144:147], v[88:91]
v_mfma_f32_16x16x32_bf16 v[92:95], v[132:135], v[144:147], v[92:95]
buffer_load_dwordx4 v250, s[8:11], s82 offen offset:2048 sc1 lds
v_mfma_f32_16x16x32_bf16 v[96:99], v[136:139], v[144:147], v[96:99]
s_waitcnt lgkmcnt(4)
v_mfma_f32_16x16x32_bf16 v[0:3], v[100:103], v[148:151], v[0:3]
ds_read_b64_tr_b16 v[120:121], v167 offset:40960
ds_read_b64_tr_b16 v[122:123], v167 offset:46080
v_mfma_f32_16x16x32_bf16 v[4:7], v[104:107], v[148:151], v[4:7]
ds_read_b64_tr_b16 v[124:125], v170 offset:40992
ds_read_b64_tr_b16 v[126:127], v170 offset:46112
v_mfma_f32_16x16x32_bf16 v[8:11], v[108:111], v[148:151], v[8:11]
ds_read_b64_tr_b16 v[128:129], v167 offset:41024
ds_read_b64_tr_b16 v[130:131], v167 offset:46144
v_mfma_f32_16x16x32_bf16 v[12:15], v[112:115], v[148:151], v[12:15]
ds_read_b64_tr_b16 v[132:133], v170 offset:41056
ds_read_b64_tr_b16 v[134:135], v170 offset:46176
v_mfma_f32_16x16x32_bf16 v[16:19], v[116:119], v[148:151], v[16:19]
s_waitcnt lgkmcnt(11)
ds_read_b64_tr_b16 v[136:137], v167 offset:41088
ds_read_b64_tr_b16 v[138:139], v167 offset:46208
v_mfma_f32_16x16x32_bf16 v[20:23], v[100:103], v[152:155], v[20:23]
ds_read_b128 v[144:147], v164 offset:40960
ds_read_b128 v[148:151], v164 offset:41984
v_mfma_f32_16x16x32_bf16 v[24:27], v[104:107], v[152:155], v[24:27]
buffer_load_dwordx4 v251, s[8:11], s82 offen offset:3072 sc1 lds
v_mfma_f32_16x16x32_bf16 v[28:31], v[108:111], v[152:155], v[28:31]
s_add_u32 m0, s85, 4096
v_mfma_f32_16x16x32_bf16 v[32:35], v[112:115], v[152:155], v[32:35]
v_mfma_f32_16x16x32_bf16 v[36:39], v[116:119], v[152:155], v[36:39]
s_waitcnt lgkmcnt(14)
ds_read_b128 v[152:155], v164 offset:43008
v_mfma_f32_16x16x32_bf16 v[40:43], v[100:103], v[156:159], v[40:43]
buffer_load_dwordx4 v254, s[8:11], s82 offen sc1 lds
v_mfma_f32_16x16x32_bf16 v[44:47], v[104:107], v[156:159], v[44:47]
s_add_u32 s82, s82, s83
s_add_u32 m0, s85, 122880
v_mfma_f32_16x16x32_bf16 v[48:51], v[108:111], v[156:159], v[48:51]
v_mfma_f32_16x16x32_bf16 v[52:55], v[112:115], v[156:159], v[52:55]
buffer_load_dwordx4 v248, s[8:11], s82 offen offset:0 sc1 lds
v_mfma_f32_16x16x32_bf16 v[56:59], v[116:119], v[156:159], v[56:59]
s_waitcnt lgkmcnt(14)
ds_read_b128 v[156:159], v164 offset:44032
v_mfma_f32_16x16x32_bf16 v[60:63], v[100:103], v[160:163], v[60:63]
v_mfma_f32_16x16x32_bf16 v[64:67], v[104:107], v[160:163], v[64:67]
buffer_load_dwordx4 v249, s[8:11], s82 offen offset:1024 sc1 lds
v_mfma_f32_16x16x32_bf16 v[68:71], v[108:111], v[160:163], v[68:71]
v_mfma_f32_16x16x32_bf16 v[72:75], v[112:115], v[160:163], v[72:75]
v_mfma_f32_16x16x32_bf16 v[76:79], v[116:119], v[160:163], v[76:79]
s_waitcnt lgkmcnt(14)
ds_read_b128 v[160:163], v164 offset:45056
v_mfma_f32_16x16x32_bf16 v[80:83], v[100:103], v[140:143], v[80:83]
buffer_load_dwordx4 v250, s[8:11], s82 offen offset:2048 sc1 lds
v_mfma_f32_16x16x32_bf16 v[84:87], v[104:107], v[140:143], v[84:87]
v_mfma_f32_16x16x32_bf16 v[88:91], v[108:111], v[140:143], v[88:91]
v_mfma_f32_16x16x32_bf16 v[92:95], v[112:115], v[140:143], v[92:95]
buffer_load_dwordx4 v251, s[8:11], s82 offen offset:3072 sc1 lds
v_mfma_f32_16x16x32_bf16 v[96:99], v[116:119], v[140:143], v[96:99]
s_waitcnt lgkmcnt(4)
s_add_u32 m0, s85, 126976
v_mfma_f32_16x16x32_bf16 v[0:3], v[120:123], v[144:147], v[0:3]
v_mfma_f32_16x16x32_bf16 v[4:7], v[124:127], v[144:147], v[4:7]
buffer_load_dwordx4 v254, s[8:11], s82 offen sc1 lds
v_mfma_f32_16x16x32_bf16 v[8:11], v[128:131], v[144:147], v[8:11]
s_add_u32 s82, s82, s83
v_mfma_f32_16x16x32_bf16 v[12:15], v[132:135], v[144:147], v[12:15]
v_mfma_f32_16x16x32_bf16 v[16:19], v[136:139], v[144:147], v[16:19]
s_waitcnt lgkmcnt(3)
v_mfma_f32_16x16x32_bf16 v[20:23], v[120:123], v[148:151], v[20:23]
v_mfma_f32_16x16x32_bf16 v[24:27], v[124:127], v[148:151], v[24:27]
v_mfma_f32_16x16x32_bf16 v[28:31], v[128:131], v[148:151], v[28:31]
v_mfma_f32_16x16x32_bf16 v[32:35], v[132:135], v[148:151], v[32:35]
s_waitcnt vmcnt(20) lgkmcnt(0)
s_barrier
ds_read_b64_tr_b16 v[100:101], v168 offset:0
v_mfma_f32_16x16x32_bf16 v[36:39], v[136:139], v[148:151], v[36:39]
s_waitcnt lgkmcnt(15)
ds_read_b64_tr_b16 v[102:103], v168 offset:5120
ds_read_b64_tr_b16 v[104:105], v171 offset:32
v_mfma_f32_16x16x32_bf16 v[40:43], v[120:123], v[152:155], v[40:43]
s_add_u32 m0, s85, 20480
ds_read_b64_tr_b16 v[106:107], v171 offset:5152
ds_read_b64_tr_b16 v[108:109], v168 offset:64
v_mfma_f32_16x16x32_bf16 v[44:47], v[124:127], v[152:155], v[44:47]
ds_read_b64_tr_b16 v[110:111], v168 offset:5184
ds_read_b64_tr_b16 v[112:113], v171 offset:96
v_mfma_f32_16x16x32_bf16 v[48:51], v[128:131], v[152:155], v[48:51]
ds_read_b64_tr_b16 v[114:115], v171 offset:5216
ds_read_b64_tr_b16 v[116:117], v168 offset:128
v_mfma_f32_16x16x32_bf16 v[52:55], v[132:135], v[152:155], v[52:55]
ds_read_b64_tr_b16 v[118:119], v168 offset:5248
ds_read_b128 v[140:143], v165 offset:0
v_mfma_f32_16x16x32_bf16 v[56:59], v[136:139], v[152:155], v[56:59]
s_waitcnt lgkmcnt(15)
ds_read_b128 v[144:147], v165 offset:1024
ds_read_b128 v[148:151], v165 offset:2048
v_mfma_f32_16x16x32_bf16 v[60:63], v[120:123], v[156:159], v[60:63]
ds_read_b128 v[152:155], v165 offset:3072
v_mfma_f32_16x16x32_bf16 v[64:67], v[124:127], v[156:159], v[64:67]
buffer_load_dwordx4 v248, s[8:11], s82 offen offset:0 sc1 lds
v_mfma_f32_16x16x32_bf16 v[68:71], v[128:131], v[156:159], v[68:71]
v_mfma_f32_16x16x32_bf16 v[72:75], v[132:135], v[156:159], v[72:75]
v_mfma_f32_16x16x32_bf16 v[76:79], v[136:139], v[156:159], v[76:79]
s_waitcnt lgkmcnt(15)
ds_read_b128 v[156:159], v165 offset:4096
v_mfma_f32_16x16x32_bf16 v[80:83], v[120:123], v[160:163], v[80:83]
buffer_load_dwordx4 v249, s[8:11], s82 offen offset:1024 sc1 lds
v_mfma_f32_16x16x32_bf16 v[84:87], v[124:127], v[160:163], v[84:87]
v_mfma_f32_16x16x32_bf16 v[88:91], v[128:131], v[160:163], v[88:91]
v_mfma_f32_16x16x32_bf16 v[92:95], v[132:135], v[160:163], v[92:95]
buffer_load_dwordx4 v250, s[8:11], s82 offen offset:2048 sc1 lds
v_mfma_f32_16x16x32_bf16 v[96:99], v[136:139], v[160:163], v[96:99]
s_waitcnt lgkmcnt(4)
v_mfma_f32_16x16x32_bf16 v[0:3], v[100:103], v[140:143], v[0:3]
ds_read_b64_tr_b16 v[120:121], v168 offset:20480
ds_read_b64_tr_b16 v[122:123], v168 offset:25600
v_mfma_f32_16x16x32_bf16 v[4:7], v[104:107], v[140:143], v[4:7]
ds_read_b64_tr_b16 v[124:125], v171 offset:20512
ds_read_b64_tr_b16 v[126:127], v171 offset:25632
v_mfma_f32_16x16x32_bf16 v[8:11], v[108:111], v[140:143], v[8:11]
ds_read_b64_tr_b16 v[128:129], v168 offset:20544
ds_read_b64_tr_b16 v[130:131], v168 offset:25664
v_mfma_f32_16x16x32_bf16 v[12:15], v[112:115], v[140:143], v[12:15]
ds_read_b64_tr_b16 v[132:133], v171 offset:20576
ds_read_b64_tr_b16 v[134:135], v171 offset:25696
v_mfma_f32_16x16x32_bf16 v[16:19], v[116:119], v[140:143], v[16:19]
s_waitcnt lgkmcnt(11)
ds_read_b64_tr_b16 v[136:137], v168 offset:20608
ds_read_b64_tr_b16 v[138:139], v168 offset:25728
v_mfma_f32_16x16x32_bf16 v[20:23], v[100:103], v[144:147], v[20:23]
ds_read_b128 v[160:163], v165 offset:20480
ds_read_b128 v[140:143], v165 offset:21504
v_mfma_f32_16x16x32_bf16 v[24:27], v[104:107], v[144:147], v[24:27]
buffer_load_dwordx4 v251, s[8:11], s82 offen offset:3072 sc1 lds
v_mfma_f32_16x16x32_bf16 v[28:31], v[108:111], v[144:147], v[28:31]
s_add_u32 m0, s85, 24576
v_mfma_f32_16x16x32_bf16 v[32:35], v[112:115], v[144:147], v[32:35]
v_mfma_f32_16x16x32_bf16 v[36:39], v[116:119], v[144:147], v[36:39]
s_waitcnt lgkmcnt(14)
ds_read_b128 v[144:147], v165 offset:22528
v_mfma_f32_16x16x32_bf16 v[40:43], v[100:103], v[148:151], v[40:43]
buffer_load_dwordx4 v254, s[8:11], s82 offen sc1 lds
v_mfma_f32_16x16x32_bf16 v[44:47], v[104:107], v[148:151], v[44:47]
s_add_u32 s82, s82, s83
s_add_u32 m0, s85, 40960
v_mfma_f32_16x16x32_bf16 v[48:51], v[108:111], v[148:151], v[48:51]
v_mfma_f32_16x16x32_bf16 v[52:55], v[112:115], v[148:151], v[52:55]
buffer_load_dwordx4 v248, s[8:11], s82 offen offset:0 sc1 lds
v_mfma_f32_16x16x32_bf16 v[56:59], v[116:119], v[148:151], v[56:59]
s_waitcnt lgkmcnt(14)
ds_read_b128 v[148:151], v165 offset:23552
v_mfma_f32_16x16x32_bf16 v[60:63], v[100:103], v[152:155], v[60:63]
v_mfma_f32_16x16x32_bf16 v[64:67], v[104:107], v[152:155], v[64:67]
buffer_load_dwordx4 v249, s[8:11], s82 offen offset:1024 sc1 lds
v_mfma_f32_16x16x32_bf16 v[68:71], v[108:111], v[152:155], v[68:71]
v_mfma_f32_16x16x32_bf16 v[72:75], v[112:115], v[152:155], v[72:75]
v_mfma_f32_16x16x32_bf16 v[76:79], v[116:119], v[152:155], v[76:79]
s_waitcnt lgkmcnt(14)
ds_read_b128 v[152:155], v165 offset:24576
v_mfma_f32_16x16x32_bf16 v[80:83], v[100:103], v[156:159], v[80:83]
buffer_load_dwordx4 v250, s[8:11], s82 offen offset:2048 sc1 lds
v_mfma_f32_16x16x32_bf16 v[84:87], v[104:107], v[156:159], v[84:87]
v_mfma_f32_16x16x32_bf16 v[88:91], v[108:111], v[156:159], v[88:91]
v_mfma_f32_16x16x32_bf16 v[92:95], v[112:115], v[156:159], v[92:95]
buffer_load_dwordx4 v251, s[8:11], s82 offen offset:3072 sc1 lds
v_mfma_f32_16x16x32_bf16 v[96:99], v[116:119], v[156:159], v[96:99]
s_waitcnt lgkmcnt(4)
s_add_u32 m0, s85, 45056
v_mfma_f32_16x16x32_bf16 v[0:3], v[120:123], v[160:163], v[0:3]
v_mfma_f32_16x16x32_bf16 v[4:7], v[124:127], v[160:163], v[4:7]
buffer_load_dwordx4 v254, s[8:11], s82 offen sc1 lds
v_mfma_f32_16x16x32_bf16 v[8:11], v[128:131], v[160:163], v[8:11]
s_add_u32 s82, s82, s83
v_mfma_f32_16x16x32_bf16 v[12:15], v[132:135], v[160:163], v[12:15]
v_mfma_f32_16x16x32_bf16 v[16:19], v[136:139], v[160:163], v[16:19]
s_waitcnt lgkmcnt(3)
v_mfma_f32_16x16x32_bf16 v[20:23], v[120:123], v[140:143], v[20:23]
v_mfma_f32_16x16x32_bf16 v[24:27], v[124:127], v[140:143], v[24:27]
v_mfma_f32_16x16x32_bf16 v[28:31], v[128:131], v[140:143], v[28:31]
v_mfma_f32_16x16x32_bf16 v[32:35], v[132:135], v[140:143], v[32:35]
s_waitcnt vmcnt(20) lgkmcnt(0)
s_barrier
ds_read_b64_tr_b16 v[100:101], v168 offset:40960
v_mfma_f32_16x16x32_bf16 v[36:39], v[136:139], v[140:143], v[36:39]
s_waitcnt lgkmcnt(15)
ds_read_b64_tr_b16 v[102:103], v168 offset:46080
ds_read_b64_tr_b16 v[104:105], v171 offset:40992
v_mfma_f32_16x16x32_bf16 v[40:43], v[120:123], v[144:147], v[40:43]
s_add_u32 m0, s85, 61440
ds_read_b64_tr_b16 v[106:107], v171 offset:46112
ds_read_b64_tr_b16 v[108:109], v168 offset:41024
v_mfma_f32_16x16x32_bf16 v[44:47], v[124:127], v[144:147], v[44:47]
ds_read_b64_tr_b16 v[110:111], v168 offset:46144
ds_read_b64_tr_b16 v[112:113], v171 offset:41056
v_mfma_f32_16x16x32_bf16 v[48:51], v[128:131], v[144:147], v[48:51]
ds_read_b64_tr_b16 v[114:115], v171 offset:46176
ds_read_b64_tr_b16 v[116:117], v168 offset:41088
v_mfma_f32_16x16x32_bf16 v[52:55], v[132:135], v[144:147], v[52:55]
ds_read_b64_tr_b16 v[118:119], v168 offset:46208
ds_read_b128 v[156:159], v165 offset:40960
v_mfma_f32_16x16x32_bf16 v[56:59], v[136:139], v[144:147], v[56:59]
s_waitcnt lgkmcnt(15)
ds_read_b128 v[160:163], v165 offset:41984
ds_read_b128 v[140:143], v165 offset:43008
v_mfma_f32_16x16x32_bf16 v[60:63], v[120:123], v[148:151], v[60:63]
ds_read_b128 v[144:147], v165 offset:44032
v_mfma_f32_16x16x32_bf16 v[64:67], v[124:127], v[148:151], v[64:67]
buffer_load_dwordx4 v248, s[8:11], s82 offen offset:0 sc1 lds
v_mfma_f32_16x16x32_bf16 v[68:71], v[128:131], v[148:151], v[68:71]
v_mfma_f32_16x16x32_bf16 v[72:75], v[132:135], v[148:151], v[72:75]
v_mfma_f32_16x16x32_bf16 v[76:79], v[136:139], v[148:151], v[76:79]
s_waitcnt lgkmcnt(15)
ds_read_b128 v[148:151], v165 offset:45056
v_mfma_f32_16x16x32_bf16 v[80:83], v[120:123], v[152:155], v[80:83]
buffer_load_dwordx4 v249, s[8:11], s82 offen offset:1024 sc1 lds
v_mfma_f32_16x16x32_bf16 v[84:87], v[124:127], v[152:155], v[84:87]
v_mfma_f32_16x16x32_bf16 v[88:91], v[128:131], v[152:155], v[88:91]
v_mfma_f32_16x16x32_bf16 v[92:95], v[132:135], v[152:155], v[92:95]
buffer_load_dwordx4 v250, s[8:11], s82 offen offset:2048 sc1 lds
v_mfma_f32_16x16x32_bf16 v[96:99], v[136:139], v[152:155], v[96:99]
s_waitcnt lgkmcnt(4)
v_mfma_f32_16x16x32_bf16 v[0:3], v[100:103], v[156:159], v[0:3]
ds_read_b64_tr_b16 v[120:121], v169 offset:20480
ds_read_b64_tr_b16 v[122:123], v169 offset:25600
v_mfma_f32_16x16x32_bf16 v[4:7], v[104:107], v[156:159], v[4:7]
ds_read_b64_tr_b16 v[124:125], v172 offset:20512
ds_read_b64_tr_b16 v[126:127], v172 offset:25632
v_mfma_f32_16x16x32_bf16 v[8:11], v[108:111], v[156:159], v[8:11]
ds_read_b64_tr_b16 v[128:129], v169 offset:20544
ds_read_b64_tr_b16 v[130:131], v169 offset:25664
v_mfma_f32_16x16x32_bf16 v[12:15], v[112:115], v[156:159], v[12:15]
ds_read_b64_tr_b16 v[132:133], v172 offset:20576
ds_read_b64_tr_b16 v[134:135], v172 offset:25696
v_mfma_f32_16x16x32_bf16 v[16:19], v[116:119], v[156:159], v[16:19]
s_waitcnt lgkmcnt(11)
ds_read_b64_tr_b16 v[136:137], v169 offset:20608
ds_read_b64_tr_b16 v[138:139], v169 offset:25728
v_mfma_f32_16x16x32_bf16 v[20:23], v[100:103], v[160:163], v[20:23]
ds_read_b128 v[152:155], v166 offset:20480
ds_read_b128 v[156:159], v166 offset:21504
v_mfma_f32_16x16x32_bf16 v[24:27], v[104:107], v[160:163], v[24:27]
buffer_load_dwordx4 v251, s[8:11], s82 offen offset:3072 sc1 lds
v_mfma_f32_16x16x32_bf16 v[28:31], v[108:111], v[160:163], v[28:31]
s_add_u32 m0, s85, 65536
v_mfma_f32_16x16x32_bf16 v[32:35], v[112:115], v[160:163], v[32:35]
v_mfma_f32_16x16x32_bf16 v[36:39], v[116:119], v[160:163], v[36:39]
s_waitcnt lgkmcnt(14)
ds_read_b128 v[160:163], v166 offset:22528
v_mfma_f32_16x16x32_bf16 v[40:43], v[100:103], v[140:143], v[40:43]
buffer_load_dwordx4 v254, s[8:11], s82 offen sc1 lds
v_mfma_f32_16x16x32_bf16 v[44:47], v[104:107], v[140:143], v[44:47]
s_add_u32 s82, s82, s83
s_add_u32 m0, s85, 81920
v_mfma_f32_16x16x32_bf16 v[48:51], v[108:111], v[140:143], v[48:51]
v_mfma_f32_16x16x32_bf16 v[52:55], v[112:115], v[140:143], v[52:55]
buffer_load_dwordx4 v248, s[8:11], s82 offen offset:0 sc1 lds
v_mfma_f32_16x16x32_bf16 v[56:59], v[116:119], v[140:143], v[56:59]
s_waitcnt lgkmcnt(14)
ds_read_b128 v[140:143], v166 offset:23552
v_mfma_f32_16x16x32_bf16 v[60:63], v[100:103], v[144:147], v[60:63]
v_mfma_f32_16x16x32_bf16 v[64:67], v[104:107], v[144:147], v[64:67]
buffer_load_dwordx4 v249, s[8:11], s82 offen offset:1024 sc1 lds
v_mfma_f32_16x16x32_bf16 v[68:71], v[108:111], v[144:147], v[68:71]
v_mfma_f32_16x16x32_bf16 v[72:75], v[112:115], v[144:147], v[72:75]
v_mfma_f32_16x16x32_bf16 v[76:79], v[116:119], v[144:147], v[76:79]
s_waitcnt lgkmcnt(14)
ds_read_b128 v[144:147], v166 offset:24576
v_mfma_f32_16x16x32_bf16 v[80:83], v[100:103], v[148:151], v[80:83]
buffer_load_dwordx4 v250, s[8:11], s82 offen offset:2048 sc1 lds
v_mfma_f32_16x16x32_bf16 v[84:87], v[104:107], v[148:151], v[84:87]
v_mfma_f32_16x16x32_bf16 v[88:91], v[108:111], v[148:151], v[88:91]
v_mfma_f32_16x16x32_bf16 v[92:95], v[112:115], v[148:151], v[92:95]
buffer_load_dwordx4 v251, s[8:11], s82 offen offset:3072 sc1 lds
v_mfma_f32_16x16x32_bf16 v[96:99], v[116:119], v[148:151], v[96:99]
s_waitcnt lgkmcnt(4)
s_add_u32 m0, s85, 86016
v_mfma_f32_16x16x32_bf16 v[0:3], v[120:123], v[152:155], v[0:3]
v_mfma_f32_16x16x32_bf16 v[4:7], v[124:127], v[152:155], v[4:7]
buffer_load_dwordx4 v254, s[8:11], s82 offen sc1 lds
v_mfma_f32_16x16x32_bf16 v[8:11], v[128:131], v[152:155], v[8:11]
s_add_u32 s82, s82, s83
v_mfma_f32_16x16x32_bf16 v[12:15], v[132:135], v[152:155], v[12:15]
v_mfma_f32_16x16x32_bf16 v[16:19], v[136:139], v[152:155], v[16:19]
s_waitcnt lgkmcnt(3)
v_mfma_f32_16x16x32_bf16 v[20:23], v[120:123], v[156:159], v[20:23]
v_mfma_f32_16x16x32_bf16 v[24:27], v[124:127], v[156:159], v[24:27]
v_mfma_f32_16x16x32_bf16 v[28:31], v[128:131], v[156:159], v[28:31]
v_mfma_f32_16x16x32_bf16 v[32:35], v[132:135], v[156:159], v[32:35]
s_waitcnt vmcnt(20) lgkmcnt(0)
s_barrier
ds_read_b64_tr_b16 v[100:101], v167 offset:0
v_mfma_f32_16x16x32_bf16 v[36:39], v[136:139], v[156:159], v[36:39]
s_waitcnt lgkmcnt(15)
ds_read_b64_tr_b16 v[102:103], v167 offset:5120
ds_read_b64_tr_b16 v[104:105], v170 offset:32
v_mfma_f32_16x16x32_bf16 v[40:43], v[120:123], v[160:163], v[40:43]
s_add_u32 m0, s85, 102400
ds_read_b64_tr_b16 v[106:107], v170 offset:5152
ds_read_b64_tr_b16 v[108:109], v167 offset:64
v_mfma_f32_16x16x32_bf16 v[44:47], v[124:127], v[160:163], v[44:47]
ds_read_b64_tr_b16 v[110:111], v167 offset:5184
ds_read_b64_tr_b16 v[112:113], v170 offset:96
v_mfma_f32_16x16x32_bf16 v[48:51], v[128:131], v[160:163], v[48:51]
ds_read_b64_tr_b16 v[114:115], v170 offset:5216
ds_read_b64_tr_b16 v[116:117], v167 offset:128
v_mfma_f32_16x16x32_bf16 v[52:55], v[132:135], v[160:163], v[52:55]
ds_read_b64_tr_b16 v[118:119], v167 offset:5248
ds_read_b128 v[148:151], v164 offset:0
v_mfma_f32_16x16x32_bf16 v[56:59], v[136:139], v[160:163], v[56:59]
s_waitcnt lgkmcnt(15)
ds_read_b128 v[152:155], v164 offset:1024
ds_read_b128 v[156:159], v164 offset:2048
v_mfma_f32_16x16x32_bf16 v[60:63], v[120:123], v[140:143], v[60:63]
ds_read_b128 v[160:163], v164 offset:3072
v_mfma_f32_16x16x32_bf16 v[64:67], v[124:127], v[140:143], v[64:67]
buffer_load_dwordx4 v248, s[8:11], s82 offen offset:0 sc1 lds
v_mfma_f32_16x16x32_bf16 v[68:71], v[128:131], v[140:143], v[68:71]
v_mfma_f32_16x16x32_bf16 v[72:75], v[132:135], v[140:143], v[72:75]
v_mfma_f32_16x16x32_bf16 v[76:79], v[136:139], v[140:143], v[76:79]
s_waitcnt lgkmcnt(15)
ds_read_b128 v[140:143], v164 offset:4096
v_mfma_f32_16x16x32_bf16 v[80:83], v[120:123], v[144:147], v[80:83]
buffer_load_dwordx4 v249, s[8:11], s82 offen offset:1024 sc1 lds
v_mfma_f32_16x16x32_bf16 v[84:87], v[124:127], v[144:147], v[84:87]
v_mfma_f32_16x16x32_bf16 v[88:91], v[128:131], v[144:147], v[88:91]
v_mfma_f32_16x16x32_bf16 v[92:95], v[132:135], v[144:147], v[92:95]
buffer_load_dwordx4 v250, s[8:11], s82 offen offset:2048 sc1 lds
v_mfma_f32_16x16x32_bf16 v[96:99], v[136:139], v[144:147], v[96:99]
s_waitcnt lgkmcnt(4)
v_mfma_f32_16x16x32_bf16 v[0:3], v[100:103], v[148:151], v[0:3]
ds_read_b64_tr_b16 v[120:121], v169 offset:0
ds_read_b64_tr_b16 v[122:123], v169 offset:5120
v_mfma_f32_16x16x32_bf16 v[4:7], v[104:107], v[148:151], v[4:7]
ds_read_b64_tr_b16 v[124:125], v172 offset:32
ds_read_b64_tr_b16 v[126:127], v172 offset:5152
v_mfma_f32_16x16x32_bf16 v[8:11], v[108:111], v[148:151], v[8:11]
ds_read_b64_tr_b16 v[128:129], v169 offset:64
ds_read_b64_tr_b16 v[130:131], v169 offset:5184
v_mfma_f32_16x16x32_bf16 v[12:15], v[112:115], v[148:151], v[12:15]
ds_read_b64_tr_b16 v[132:133], v172 offset:96
ds_read_b64_tr_b16 v[134:135], v172 offset:5216
v_mfma_f32_16x16x32_bf16 v[16:19], v[116:119], v[148:151], v[16:19]
s_waitcnt lgkmcnt(11)
ds_read_b64_tr_b16 v[136:137], v169 offset:128
ds_read_b64_tr_b16 v[138:139], v169 offset:5248
v_mfma_f32_16x16x32_bf16 v[20:23], v[100:103], v[152:155], v[20:23]
ds_read_b128 v[144:147], v166 offset:0
ds_read_b128 v[148:151], v166 offset:1024
v_mfma_f32_16x16x32_bf16 v[24:27], v[104:107], v[152:155], v[24:27]
buffer_load_dwordx4 v251, s[8:11], s82 offen offset:3072 sc1 lds
v_mfma_f32_16x16x32_bf16 v[28:31], v[108:111], v[152:155], v[28:31]
s_add_u32 m0, s85, 106496
v_mfma_f32_16x16x32_bf16 v[32:35], v[112:115], v[152:155], v[32:35]
v_mfma_f32_16x16x32_bf16 v[36:39], v[116:119], v[152:155], v[36:39]
s_waitcnt lgkmcnt(14)
ds_read_b128 v[152:155], v166 offset:2048
v_mfma_f32_16x16x32_bf16 v[40:43], v[100:103], v[156:159], v[40:43]
buffer_load_dwordx4 v254, s[8:11], s82 offen sc1 lds
v_mfma_f32_16x16x32_bf16 v[44:47], v[104:107], v[156:159], v[44:47]
s_add_u32 s82, s82, s83
s_add_u32 m0, s85, 143360
v_mfma_f32_16x16x32_bf16 v[48:51], v[108:111], v[156:159], v[48:51]
v_mfma_f32_16x16x32_bf16 v[52:55], v[112:115], v[156:159], v[52:55]
buffer_load_dwordx4 v248, s[8:11], s82 offen offset:0 sc1 lds
v_mfma_f32_16x16x32_bf16 v[56:59], v[116:119], v[156:159], v[56:59]
s_waitcnt lgkmcnt(14)
ds_read_b128 v[156:159], v166 offset:3072
v_mfma_f32_16x16x32_bf16 v[60:63], v[100:103], v[160:163], v[60:63]
v_mfma_f32_16x16x32_bf16 v[64:67], v[104:107], v[160:163], v[64:67]
buffer_load_dwordx4 v249, s[8:11], s82 offen offset:1024 sc1 lds
v_mfma_f32_16x16x32_bf16 v[68:71], v[108:111], v[160:163], v[68:71]
v_mfma_f32_16x16x32_bf16 v[72:75], v[112:115], v[160:163], v[72:75]
v_mfma_f32_16x16x32_bf16 v[76:79], v[116:119], v[160:163], v[76:79]
s_waitcnt lgkmcnt(14)
ds_read_b128 v[160:163], v166 offset:4096
v_mfma_f32_16x16x32_bf16 v[80:83], v[100:103], v[140:143], v[80:83]
buffer_load_dwordx4 v250, s[8:11], s82 offen offset:2048 sc1 lds
v_mfma_f32_16x16x32_bf16 v[84:87], v[104:107], v[140:143], v[84:87]
v_mfma_f32_16x16x32_bf16 v[88:91], v[108:111], v[140:143], v[88:91]
v_mfma_f32_16x16x32_bf16 v[92:95], v[112:115], v[140:143], v[92:95]
buffer_load_dwordx4 v251, s[8:11], s82 offen offset:3072 sc1 lds
v_mfma_f32_16x16x32_bf16 v[96:99], v[116:119], v[140:143], v[96:99]
s_waitcnt lgkmcnt(4)
s_add_u32 m0, s85, 147456
v_mfma_f32_16x16x32_bf16 v[0:3], v[120:123], v[144:147], v[0:3]
v_mfma_f32_16x16x32_bf16 v[4:7], v[124:127], v[144:147], v[4:7]
buffer_load_dwordx4 v254, s[8:11], s82 offen sc1 lds
v_mfma_f32_16x16x32_bf16 v[8:11], v[128:131], v[144:147], v[8:11]
s_add_u32 s66, s66, 1
s_and_b32 s66, s66, 3
s_mul_i32 s40, s66, 24
v_mfma_f32_16x16x32_bf16 v[12:15], v[132:135], v[144:147], v[12:15]
s_add_u32 s40, s40, 24
s_mul_i32 s40, s40, s83
s_add_u32 s82, s67, s40
v_mfma_f32_16x16x32_bf16 v[16:19], v[136:139], v[144:147], v[16:19]
s_waitcnt lgkmcnt(3)
v_mfma_f32_16x16x32_bf16 v[20:23], v[120:123], v[148:151], v[20:23]
v_mfma_f32_16x16x32_bf16 v[24:27], v[124:127], v[148:151], v[24:27]
v_mfma_f32_16x16x32_bf16 v[28:31], v[128:131], v[148:151], v[28:31]
v_mfma_f32_16x16x32_bf16 v[32:35], v[132:135], v[148:151], v[32:35]
s_waitcnt vmcnt(20) lgkmcnt(0)
s_barrier
ds_read_b64_tr_b16 v[100:101], v167 offset:20480
v_mfma_f32_16x16x32_bf16 v[36:39], v[136:139], v[148:151], v[36:39]
s_waitcnt lgkmcnt(15)
ds_read_b64_tr_b16 v[102:103], v167 offset:25600
ds_read_b64_tr_b16 v[104:105], v170 offset:20512
v_mfma_f32_16x16x32_bf16 v[40:43], v[120:123], v[152:155], v[40:43]
ds_read_b64_tr_b16 v[106:107], v170 offset:25632
ds_read_b64_tr_b16 v[108:109], v167 offset:20544
v_mfma_f32_16x16x32_bf16 v[44:47], v[124:127], v[152:155], v[44:47]
ds_read_b64_tr_b16 v[110:111], v167 offset:25664
ds_read_b64_tr_b16 v[112:113], v170 offset:20576
v_mfma_f32_16x16x32_bf16 v[48:51], v[128:131], v[152:155], v[48:51]
ds_read_b64_tr_b16 v[114:115], v170 offset:25696
ds_read_b64_tr_b16 v[116:117], v167 offset:20608
v_mfma_f32_16x16x32_bf16 v[52:55], v[132:135], v[152:155], v[52:55]
ds_read_b64_tr_b16 v[118:119], v167 offset:25728
ds_read_b128 v[140:143], v164 offset:20480
v_mfma_f32_16x16x32_bf16 v[56:59], v[136:139], v[152:155], v[56:59]
s_waitcnt lgkmcnt(15)
ds_read_b128 v[144:147], v164 offset:21504
ds_read_b128 v[148:151], v164 offset:22528
v_mfma_f32_16x16x32_bf16 v[60:63], v[120:123], v[156:159], v[60:63]
ds_read_b128 v[152:155], v164 offset:23552
v_mfma_f32_16x16x32_bf16 v[64:67], v[124:127], v[156:159], v[64:67]
v_mfma_f32_16x16x32_bf16 v[68:71], v[128:131], v[156:159], v[68:71]
v_mfma_f32_16x16x32_bf16 v[72:75], v[132:135], v[156:159], v[72:75]
v_mfma_f32_16x16x32_bf16 v[76:79], v[136:139], v[156:159], v[76:79]
s_waitcnt lgkmcnt(15)
ds_read_b128 v[156:159], v164 offset:24576
v_mfma_f32_16x16x32_bf16 v[80:83], v[120:123], v[160:163], v[80:83]
v_mfma_f32_16x16x32_bf16 v[84:87], v[124:127], v[160:163], v[84:87]
v_mfma_f32_16x16x32_bf16 v[88:91], v[128:131], v[160:163], v[88:91]
v_mfma_f32_16x16x32_bf16 v[92:95], v[132:135], v[160:163], v[92:95]
v_mfma_f32_16x16x32_bf16 v[96:99], v[136:139], v[160:163], v[96:99]
s_waitcnt lgkmcnt(4)
v_mfma_f32_16x16x32_bf16 v[0:3], v[100:103], v[140:143], v[0:3]
ds_read_b64_tr_b16 v[120:121], v167 offset:40960
ds_read_b64_tr_b16 v[122:123], v167 offset:46080
v_mfma_f32_16x16x32_bf16 v[4:7], v[104:107], v[140:143], v[4:7]
ds_read_b64_tr_b16 v[124:125], v170 offset:40992
ds_read_b64_tr_b16 v[126:127], v170 offset:46112
v_mfma_f32_16x16x32_bf16 v[8:11], v[108:111], v[140:143], v[8:11]
ds_read_b64_tr_b16 v[128:129], v167 offset:41024
ds_read_b64_tr_b16 v[130:131], v167 offset:46144
v_mfma_f32_16x16x32_bf16 v[12:15], v[112:115], v[140:143], v[12:15]
ds_read_b64_tr_b16 v[132:133], v170 offset:41056
ds_read_b64_tr_b16 v[134:135], v170 offset:46176
v_mfma_f32_16x16x32_bf16 v[16:19], v[116:119], v[140:143], v[16:19]
s_waitcnt lgkmcnt(11)
ds_read_b64_tr_b16 v[136:137], v167 offset:41088
ds_read_b64_tr_b16 v[138:139], v167 offset:46208
v_mfma_f32_16x16x32_bf16 v[20:23], v[100:103], v[144:147], v[20:23]
ds_read_b128 v[160:163], v164 offset:40960
ds_read_b128 v[140:143], v164 offset:41984
v_mfma_f32_16x16x32_bf16 v[24:27], v[104:107], v[144:147], v[24:27]
v_mfma_f32_16x16x32_bf16 v[28:31], v[108:111], v[144:147], v[28:31]
v_mfma_f32_16x16x32_bf16 v[32:35], v[112:115], v[144:147], v[32:35]
v_mfma_f32_16x16x32_bf16 v[36:39], v[116:119], v[144:147], v[36:39]
s_waitcnt lgkmcnt(14)
ds_read_b128 v[144:147], v164 offset:43008
v_mfma_f32_16x16x32_bf16 v[40:43], v[100:103], v[148:151], v[40:43]
v_mfma_f32_16x16x32_bf16 v[44:47], v[104:107], v[148:151], v[44:47]
v_mfma_f32_16x16x32_bf16 v[48:51], v[108:111], v[148:151], v[48:51]
v_mfma_f32_16x16x32_bf16 v[52:55], v[112:115], v[148:151], v[52:55]
v_mfma_f32_16x16x32_bf16 v[56:59], v[116:119], v[148:151], v[56:59]
s_waitcnt lgkmcnt(14)
ds_read_b128 v[148:151], v164 offset:44032
v_mfma_f32_16x16x32_bf16 v[60:63], v[100:103], v[152:155], v[60:63]
v_mfma_f32_16x16x32_bf16 v[64:67], v[104:107], v[152:155], v[64:67]
v_mfma_f32_16x16x32_bf16 v[68:71], v[108:111], v[152:155], v[68:71]
v_mfma_f32_16x16x32_bf16 v[72:75], v[112:115], v[152:155], v[72:75]
v_mfma_f32_16x16x32_bf16 v[76:79], v[116:119], v[152:155], v[76:79]
s_waitcnt lgkmcnt(14)
ds_read_b128 v[152:155], v164 offset:45056
v_mfma_f32_16x16x32_bf16 v[80:83], v[100:103], v[156:159], v[80:83]
v_mfma_f32_16x16x32_bf16 v[84:87], v[104:107], v[156:159], v[84:87]
v_mfma_f32_16x16x32_bf16 v[88:91], v[108:111], v[156:159], v[88:91]
v_mfma_f32_16x16x32_bf16 v[92:95], v[112:115], v[156:159], v[92:95]
v_mfma_f32_16x16x32_bf16 v[96:99], v[116:119], v[156:159], v[96:99]
s_waitcnt lgkmcnt(4)
v_mfma_f32_16x16x32_bf16 v[0:3], v[120:123], v[160:163], v[0:3]
v_mfma_f32_16x16x32_bf16 v[4:7], v[124:127], v[160:163], v[4:7]
v_mfma_f32_16x16x32_bf16 v[8:11], v[128:131], v[160:163], v[8:11]
v_mfma_f32_16x16x32_bf16 v[12:15], v[132:135], v[160:163], v[12:15]
v_mfma_f32_16x16x32_bf16 v[16:19], v[136:139], v[160:163], v[16:19]
s_waitcnt lgkmcnt(3)
v_mfma_f32_16x16x32_bf16 v[20:23], v[120:123], v[140:143], v[20:23]
v_mfma_f32_16x16x32_bf16 v[24:27], v[124:127], v[140:143], v[24:27]
v_mfma_f32_16x16x32_bf16 v[28:31], v[128:131], v[140:143], v[28:31]
v_mfma_f32_16x16x32_bf16 v[32:35], v[132:135], v[140:143], v[32:35]
s_waitcnt vmcnt(10) lgkmcnt(0)
s_barrier
ds_read_b64_tr_b16 v[100:101], v168 offset:0
v_mfma_f32_16x16x32_bf16 v[36:39], v[136:139], v[140:143], v[36:39]
s_waitcnt lgkmcnt(15)
ds_read_b64_tr_b16 v[102:103], v168 offset:5120
ds_read_b64_tr_b16 v[104:105], v171 offset:32
v_mfma_f32_16x16x32_bf16 v[40:43], v[120:123], v[144:147], v[40:43]
ds_read_b64_tr_b16 v[106:107], v171 offset:5152
ds_read_b64_tr_b16 v[108:109], v168 offset:64
v_mfma_f32_16x16x32_bf16 v[44:47], v[124:127], v[144:147], v[44:47]
ds_read_b64_tr_b16 v[110:111], v168 offset:5184
ds_read_b64_tr_b16 v[112:113], v171 offset:96
v_mfma_f32_16x16x32_bf16 v[48:51], v[128:131], v[144:147], v[48:51]
ds_read_b64_tr_b16 v[114:115], v171 offset:5216
ds_read_b64_tr_b16 v[116:117], v168 offset:128
v_mfma_f32_16x16x32_bf16 v[52:55], v[132:135], v[144:147], v[52:55]
ds_read_b64_tr_b16 v[118:119], v168 offset:5248
ds_read_b128 v[156:159], v165 offset:0
v_mfma_f32_16x16x32_bf16 v[56:59], v[136:139], v[144:147], v[56:59]
s_waitcnt lgkmcnt(15)
ds_read_b128 v[160:163], v165 offset:1024
ds_read_b128 v[140:143], v165 offset:2048
v_mfma_f32_16x16x32_bf16 v[60:63], v[120:123], v[148:151], v[60:63]
ds_read_b128 v[144:147], v165 offset:3072
v_mfma_f32_16x16x32_bf16 v[64:67], v[124:127], v[148:151], v[64:67]
v_mfma_f32_16x16x32_bf16 v[68:71], v[128:131], v[148:151], v[68:71]
v_mfma_f32_16x16x32_bf16 v[72:75], v[132:135], v[148:151], v[72:75]
v_mfma_f32_16x16x32_bf16 v[76:79], v[136:139], v[148:151], v[76:79]
s_waitcnt lgkmcnt(15)
ds_read_b128 v[148:151], v165 offset:4096
v_mfma_f32_16x16x32_bf16 v[80:83], v[120:123], v[152:155], v[80:83]
v_mfma_f32_16x16x32_bf16 v[84:87], v[124:127], v[152:155], v[84:87]
v_mfma_f32_16x16x32_bf16 v[88:91], v[128:131], v[152:155], v[88:91]
v_mfma_f32_16x16x32_bf16 v[92:95], v[132:135], v[152:155], v[92:95]
v_mfma_f32_16x16x32_bf16 v[96:99], v[136:139], v[152:155], v[96:99]
s_waitcnt lgkmcnt(4)
v_mfma_f32_16x16x32_bf16 v[0:3], v[100:103], v[156:159], v[0:3]
ds_read_b64_tr_b16 v[120:121], v168 offset:20480
ds_read_b64_tr_b16 v[122:123], v168 offset:25600
v_mfma_f32_16x16x32_bf16 v[4:7], v[104:107], v[156:159], v[4:7]
ds_read_b64_tr_b16 v[124:125], v171 offset:20512
ds_read_b64_tr_b16 v[126:127], v171 offset:25632
v_mfma_f32_16x16x32_bf16 v[8:11], v[108:111], v[156:159], v[8:11]
ds_read_b64_tr_b16 v[128:129], v168 offset:20544
ds_read_b64_tr_b16 v[130:131], v168 offset:25664
v_mfma_f32_16x16x32_bf16 v[12:15], v[112:115], v[156:159], v[12:15]
ds_read_b64_tr_b16 v[132:133], v171 offset:20576
ds_read_b64_tr_b16 v[134:135], v171 offset:25696
v_mfma_f32_16x16x32_bf16 v[16:19], v[116:119], v[156:159], v[16:19]
s_waitcnt lgkmcnt(11)
ds_read_b64_tr_b16 v[136:137], v168 offset:20608
ds_read_b64_tr_b16 v[138:139], v168 offset:25728
v_mfma_f32_16x16x32_bf16 v[20:23], v[100:103], v[160:163], v[20:23]
ds_read_b128 v[152:155], v165 offset:20480
ds_read_b128 v[156:159], v165 offset:21504
v_mfma_f32_16x16x32_bf16 v[24:27], v[104:107], v[160:163], v[24:27]
v_mfma_f32_16x16x32_bf16 v[28:31], v[108:111], v[160:163], v[28:31]
v_mfma_f32_16x16x32_bf16 v[32:35], v[112:115], v[160:163], v[32:35]
v_mfma_f32_16x16x32_bf16 v[36:39], v[116:119], v[160:163], v[36:39]
s_waitcnt lgkmcnt(14)
ds_read_b128 v[160:163], v165 offset:22528
v_mfma_f32_16x16x32_bf16 v[40:43], v[100:103], v[140:143], v[40:43]
v_mfma_f32_16x16x32_bf16 v[44:47], v[104:107], v[140:143], v[44:47]
v_mfma_f32_16x16x32_bf16 v[48:51], v[108:111], v[140:143], v[48:51]
v_mfma_f32_16x16x32_bf16 v[52:55], v[112:115], v[140:143], v[52:55]
v_mfma_f32_16x16x32_bf16 v[56:59], v[116:119], v[140:143], v[56:59]
s_waitcnt lgkmcnt(14)
ds_read_b128 v[140:143], v165 offset:23552
v_mfma_f32_16x16x32_bf16 v[60:63], v[100:103], v[144:147], v[60:63]
v_mfma_f32_16x16x32_bf16 v[64:67], v[104:107], v[144:147], v[64:67]
v_mfma_f32_16x16x32_bf16 v[68:71], v[108:111], v[144:147], v[68:71]
v_mfma_f32_16x16x32_bf16 v[72:75], v[112:115], v[144:147], v[72:75]
v_mfma_f32_16x16x32_bf16 v[76:79], v[116:119], v[144:147], v[76:79]
s_waitcnt lgkmcnt(14)
ds_read_b128 v[144:147], v165 offset:24576
v_mfma_f32_16x16x32_bf16 v[80:83], v[100:103], v[148:151], v[80:83]
v_mfma_f32_16x16x32_bf16 v[84:87], v[104:107], v[148:151], v[84:87]
v_mfma_f32_16x16x32_bf16 v[88:91], v[108:111], v[148:151], v[88:91]
v_mfma_f32_16x16x32_bf16 v[92:95], v[112:115], v[148:151], v[92:95]
v_mfma_f32_16x16x32_bf16 v[96:99], v[116:119], v[148:151], v[96:99]
s_waitcnt lgkmcnt(4)
v_mfma_f32_16x16x32_bf16 v[0:3], v[120:123], v[152:155], v[0:3]
v_mfma_f32_16x16x32_bf16 v[4:7], v[124:127], v[152:155], v[4:7]
v_mfma_f32_16x16x32_bf16 v[8:11], v[128:131], v[152:155], v[8:11]
v_mfma_f32_16x16x32_bf16 v[12:15], v[132:135], v[152:155], v[12:15]
v_mfma_f32_16x16x32_bf16 v[16:19], v[136:139], v[152:155], v[16:19]
s_waitcnt lgkmcnt(3)
v_mfma_f32_16x16x32_bf16 v[20:23], v[120:123], v[156:159], v[20:23]
v_mfma_f32_16x16x32_bf16 v[24:27], v[124:127], v[156:159], v[24:27]
v_mfma_f32_16x16x32_bf16 v[28:31], v[128:131], v[156:159], v[28:31]
v_mfma_f32_16x16x32_bf16 v[32:35], v[132:135], v[156:159], v[32:35]
s_waitcnt vmcnt(0) lgkmcnt(0)
s_barrier
ds_read_b64_tr_b16 v[100:101], v168 offset:40960
v_mfma_f32_16x16x32_bf16 v[36:39], v[136:139], v[156:159], v[36:39]
s_waitcnt lgkmcnt(15)
ds_read_b64_tr_b16 v[102:103], v168 offset:46080
ds_read_b64_tr_b16 v[104:105], v171 offset:40992
v_mfma_f32_16x16x32_bf16 v[40:43], v[120:123], v[160:163], v[40:43]
ds_read_b64_tr_b16 v[106:107], v171 offset:46112
ds_read_b64_tr_b16 v[108:109], v168 offset:41024
v_mfma_f32_16x16x32_bf16 v[44:47], v[124:127], v[160:163], v[44:47]
ds_read_b64_tr_b16 v[110:111], v168 offset:46144
ds_read_b64_tr_b16 v[112:113], v171 offset:41056
v_mfma_f32_16x16x32_bf16 v[48:51], v[128:131], v[160:163], v[48:51]
ds_read_b64_tr_b16 v[114:115], v171 offset:46176
ds_read_b64_tr_b16 v[116:117], v168 offset:41088
v_mfma_f32_16x16x32_bf16 v[52:55], v[132:135], v[160:163], v[52:55]
ds_read_b64_tr_b16 v[118:119], v168 offset:46208
ds_read_b128 v[148:151], v165 offset:40960
v_mfma_f32_16x16x32_bf16 v[56:59], v[136:139], v[160:163], v[56:59]
s_waitcnt lgkmcnt(15)
ds_read_b128 v[152:155], v165 offset:41984
ds_read_b128 v[156:159], v165 offset:43008
v_mfma_f32_16x16x32_bf16 v[60:63], v[120:123], v[140:143], v[60:63]
ds_read_b128 v[160:163], v165 offset:44032
v_mfma_f32_16x16x32_bf16 v[64:67], v[124:127], v[140:143], v[64:67]
v_mfma_f32_16x16x32_bf16 v[68:71], v[128:131], v[140:143], v[68:71]
v_mfma_f32_16x16x32_bf16 v[72:75], v[132:135], v[140:143], v[72:75]
v_mfma_f32_16x16x32_bf16 v[76:79], v[136:139], v[140:143], v[76:79]
s_waitcnt lgkmcnt(15)
ds_read_b128 v[140:143], v165 offset:45056
v_mfma_f32_16x16x32_bf16 v[80:83], v[120:123], v[144:147], v[80:83]
v_mfma_f32_16x16x32_bf16 v[84:87], v[124:127], v[144:147], v[84:87]
v_mfma_f32_16x16x32_bf16 v[88:91], v[128:131], v[144:147], v[88:91]
v_mfma_f32_16x16x32_bf16 v[92:95], v[132:135], v[144:147], v[92:95]
v_mfma_f32_16x16x32_bf16 v[96:99], v[136:139], v[144:147], v[96:99]
s_waitcnt lgkmcnt(4)
v_mfma_f32_16x16x32_bf16 v[0:3], v[100:103], v[148:151], v[0:3]
ds_read_b64_tr_b16 v[120:121], v169 offset:20480
ds_read_b64_tr_b16 v[122:123], v169 offset:25600
v_mfma_f32_16x16x32_bf16 v[4:7], v[104:107], v[148:151], v[4:7]
ds_read_b64_tr_b16 v[124:125], v172 offset:20512
ds_read_b64_tr_b16 v[126:127], v172 offset:25632
v_mfma_f32_16x16x32_bf16 v[8:11], v[108:111], v[148:151], v[8:11]
ds_read_b64_tr_b16 v[128:129], v169 offset:20544
ds_read_b64_tr_b16 v[130:131], v169 offset:25664
v_mfma_f32_16x16x32_bf16 v[12:15], v[112:115], v[148:151], v[12:15]
ds_read_b64_tr_b16 v[132:133], v172 offset:20576
ds_read_b64_tr_b16 v[134:135], v172 offset:25696
v_mfma_f32_16x16x32_bf16 v[16:19], v[116:119], v[148:151], v[16:19]
s_waitcnt lgkmcnt(11)
ds_read_b64_tr_b16 v[136:137], v169 offset:20608
ds_read_b64_tr_b16 v[138:139], v169 offset:25728
v_mfma_f32_16x16x32_bf16 v[20:23], v[100:103], v[152:155], v[20:23]
ds_read_b128 v[144:147], v166 offset:20480
ds_read_b128 v[148:151], v166 offset:21504
v_mfma_f32_16x16x32_bf16 v[24:27], v[104:107], v[152:155], v[24:27]
v_mfma_f32_16x16x32_bf16 v[28:31], v[108:111], v[152:155], v[28:31]
v_mfma_f32_16x16x32_bf16 v[32:35], v[112:115], v[152:155], v[32:35]
v_mfma_f32_16x16x32_bf16 v[36:39], v[116:119], v[152:155], v[36:39]
s_waitcnt lgkmcnt(14)
ds_read_b128 v[152:155], v166 offset:22528
v_mfma_f32_16x16x32_bf16 v[40:43], v[100:103], v[156:159], v[40:43]
v_mfma_f32_16x16x32_bf16 v[44:47], v[104:107], v[156:159], v[44:47]
v_mfma_f32_16x16x32_bf16 v[48:51], v[108:111], v[156:159], v[48:51]
v_mfma_f32_16x16x32_bf16 v[52:55], v[112:115], v[156:159], v[52:55]
v_mfma_f32_16x16x32_bf16 v[56:59], v[116:119], v[156:159], v[56:59]
s_waitcnt lgkmcnt(14)
ds_read_b128 v[156:159], v166 offset:23552
v_mfma_f32_16x16x32_bf16 v[60:63], v[100:103], v[160:163], v[60:63]
v_mfma_f32_16x16x32_bf16 v[64:67], v[104:107], v[160:163], v[64:67]
v_mfma_f32_16x16x32_bf16 v[68:71], v[108:111], v[160:163], v[68:71]
v_mfma_f32_16x16x32_bf16 v[72:75], v[112:115], v[160:163], v[72:75]
v_mfma_f32_16x16x32_bf16 v[76:79], v[116:119], v[160:163], v[76:79]
s_waitcnt lgkmcnt(14)
ds_read_b128 v[160:163], v166 offset:24576
v_mfma_f32_16x16x32_bf16 v[80:83], v[100:103], v[140:143], v[80:83]
v_mfma_f32_16x16x32_bf16 v[84:87], v[104:107], v[140:143], v[84:87]
v_mfma_f32_16x16x32_bf16 v[88:91], v[108:111], v[140:143], v[88:91]
v_mfma_f32_16x16x32_bf16 v[92:95], v[112:115], v[140:143], v[92:95]
v_mfma_f32_16x16x32_bf16 v[96:99], v[116:119], v[140:143], v[96:99]
s_waitcnt lgkmcnt(4)
v_mfma_f32_16x16x32_bf16 v[0:3], v[120:123], v[144:147], v[0:3]
v_mfma_f32_16x16x32_bf16 v[4:7], v[124:127], v[144:147], v[4:7]
v_mfma_f32_16x16x32_bf16 v[8:11], v[128:131], v[144:147], v[8:11]
v_mfma_f32_16x16x32_bf16 v[12:15], v[132:135], v[144:147], v[12:15]
v_mfma_f32_16x16x32_bf16 v[16:19], v[136:139], v[144:147], v[16:19]
s_waitcnt lgkmcnt(3)
v_mfma_f32_16x16x32_bf16 v[20:23], v[120:123], v[148:151], v[20:23]
v_mfma_f32_16x16x32_bf16 v[24:27], v[124:127], v[148:151], v[24:27]
v_mfma_f32_16x16x32_bf16 v[28:31], v[128:131], v[148:151], v[28:31]
v_mfma_f32_16x16x32_bf16 v[32:35], v[132:135], v[148:151], v[32:35]
v_mfma_f32_16x16x32_bf16 v[36:39], v[136:139], v[148:151], v[36:39]
s_waitcnt lgkmcnt(2)
v_mfma_f32_16x16x32_bf16 v[40:43], v[120:123], v[152:155], v[40:43]
v_mfma_f32_16x16x32_bf16 v[44:47], v[124:127], v[152:155], v[44:47]
v_mfma_f32_16x16x32_bf16 v[48:51], v[128:131], v[152:155], v[48:51]
v_mfma_f32_16x16x32_bf16 v[52:55], v[132:135], v[152:155], v[52:55]
v_mfma_f32_16x16x32_bf16 v[56:59], v[136:139], v[152:155], v[56:59]
s_waitcnt lgkmcnt(1)
v_mfma_f32_16x16x32_bf16 v[60:63], v[120:123], v[156:159], v[60:63]
v_mfma_f32_16x16x32_bf16 v[64:67], v[124:127], v[156:159], v[64:67]
v_mfma_f32_16x16x32_bf16 v[68:71], v[128:131], v[156:159], v[68:71]
v_mfma_f32_16x16x32_bf16 v[72:75], v[132:135], v[156:159], v[72:75]
v_mfma_f32_16x16x32_bf16 v[76:79], v[136:139], v[156:159], v[76:79]
s_waitcnt lgkmcnt(0)
v_mfma_f32_16x16x32_bf16 v[80:83], v[120:123], v[160:163], v[80:83]
v_mfma_f32_16x16x32_bf16 v[84:87], v[124:127], v[160:163], v[84:87]
v_mfma_f32_16x16x32_bf16 v[88:91], v[128:131], v[160:163], v[88:91]
v_mfma_f32_16x16x32_bf16 v[92:95], v[132:135], v[160:163], v[92:95]
v_mfma_f32_16x16x32_bf16 v[96:99], v[136:139], v[160:163], v[96:99]
v_add_u32 v176, 8192, v174
v_add_u32 v177, 12288, v174
v_add_u32 v196, 1, v196
v_add_u32 v197, 1, v197
v_lshrrev_b32 v200, 4, v174
v_and_b32 v201, 15, v200
v_lshrrev_b32 v200, 4, v200
v_lshlrev_b32 v200, 3, v200
v_mul_u32_u24 v201, 2560, v201
v_add_u32 v200, v200, v201
s_cmp_ge_u32 s56, 4
s_cbranch_scc1 L_concat_heads__mha_block_cached__gqa_block_cached__near_ridge_kernel_ex1
buffer_store_dwordx4 v[52:55], v174, s[20:23], s57 offen offset:0 sc1
buffer_store_dwordx4 v[56:59], v174, s[20:23], s57 offen offset:1024 sc1
buffer_store_dwordx4 v[60:63], v174, s[20:23], s57 offen offset:2048 sc1
buffer_store_dwordx4 v[64:67], v174, s[20:23], s57 offen offset:3072 sc1
buffer_store_dwordx4 v[68:71], v175, s[20:23], s57 offen offset:0 sc1
buffer_store_dwordx4 v[72:75], v175, s[20:23], s57 offen offset:1024 sc1
buffer_store_dwordx4 v[76:79], v175, s[20:23], s57 offen offset:2048 sc1
buffer_store_dwordx4 v[80:83], v175, s[20:23], s57 offen offset:3072 sc1
buffer_store_dwordx4 v[84:87], v176, s[20:23], s57 offen offset:0 sc1
buffer_store_dwordx4 v[88:91], v176, s[20:23], s57 offen offset:1024 sc1
buffer_store_dwordx4 v[92:95], v176, s[20:23], s57 offen offset:2048 sc1
buffer_store_dwordx4 v[96:99], v176, s[20:23], s57 offen offset:3072 sc1
s_waitcnt vmcnt(0)
s_mov_b64 exec, 1
buffer_store_dword v196, v194, s[20:23], s64 offen sc1
s_mov_b64 exec, -1
buffer_load_dword v195, v194, s[20:23], s65 offen sc1
s_waitcnt vmcnt(0)
s_mov_b32 s43, 0x80000
L_concat_heads__mha_block_cached__gqa_block_cached__near_ridge_kernel_pollx0:
v_cmp_ne_u32 vcc, v197, v195
s_sub_u32 s43, s43, 1
s_cmp_eq_u32 s43, 0
s_cbranch_scc1 L_concat_heads__mha_block_cached__gqa_block_cached__near_ridge_kernel_pollx0_out
s_cbranch_vccz L_concat_heads__mha_block_cached__gqa_block_cached__near_ridge_kernel_pollx0_out
s_sleep 1
buffer_load_dword v195, v194, s[20:23], s65 offen sc1
s_waitcnt vmcnt(0)
s_branch L_concat_heads__mha_block_cached__gqa_block_cached__near_ridge_kernel_pollx0
L_concat_heads__mha_block_cached__gqa_block_cached__near_ridge_kernel_pollx0_out:
buffer_load_dwordx4 v[100:103], v174, s[20:23], s58 offen offset:0 sc1
buffer_load_dwordx4 v[104:107], v174, s[20:23], s58 offen offset:1024 sc1
buffer_load_dwordx4 v[108:111], v174, s[20:23], s58 offen offset:2048 sc1
buffer_load_dwordx4 v[112:115], v174, s[20:23], s58 offen offset:3072 sc1
buffer_load_dwordx4 v[116:119], v175, s[20:23], s58 offen offset:0 sc1
buffer_load_dwordx4 v[120:123], v175, s[20:23], s58 offen offset:1024 sc1
buffer_load_dwordx4 v[124:127], v175, s[20:23], s58 offen offset:2048 sc1
buffer_load_dwordx4 v[128:131], v175, s[20:23], s58 offen offset:3072 sc1
buffer_load_dwordx4 v[132:135], v176, s[20:23], s58 offen offset:0 sc1
buffer_load_dwordx4 v[136:139], v176, s[20:23], s58 offen offset:1024 sc1
buffer_load_dwordx4 v[140:143], v176, s[20:23], s58 offen offset:2048 sc1
buffer_load_dwordx4 v[144:147], v176, s[20:23], s58 offen offset:3072 sc1
buffer_load_dwordx4 v[148:151], v177, s[20:23], s58 offen offset:0 sc1
s_add_u32 s40, s84, 0
s_waitcnt vmcnt(12)
v_pk_add_f32 v[0:1], v[0:1], v[100:101]
v_pk_add_f32 v[2:3], v[2:3], v[102:103]
v_cvt_pk_bf16_f32 v0, v0, v1
v_cvt_pk_bf16_f32 v1, v2, v3
buffer_store_dwordx2 v[0:1], v200, s[68:71], s40 offen offset:0
s_waitcnt vmcnt(12)
v_pk_add_f32 v[4:5], v[4:5], v[104:105]
v_pk_add_f32 v[6:7], v[6:7], v[106:107]
v_cvt_pk_bf16_f32 v4, v4, v5
v_cvt_pk_bf16_f32 v5, v6, v7
buffer_store_dwordx2 v[4:5], v200, s[68:71], s40 offen offset:32
s_waitcnt vmcnt(12)
v_pk_add_f32 v[8:9], v[8:9], v[108:109]
v_pk_add_f32 v[10:11], v[10:11], v[110:111]
v_cvt_pk_bf16_f32 v8, v8, v9
v_cvt_pk_bf16_f32 v9, v10, v11
buffer_store_dwordx2 v[8:9], v200, s[68:71], s40 offen offset:64
s_waitcnt vmcnt(12)
v_pk_add_f32 v[12:13], v[12:13], v[112:113]
v_pk_add_f32 v[14:15], v[14:15], v[114:115]
v_cvt_pk_bf16_f32 v12, v12, v13
v_cvt_pk_bf16_f32 v13, v14, v15
buffer_store_dwordx2 v[12:13], v200, s[68:71], s40 offen offset:96
s_waitcnt vmcnt(12)
v_pk_add_f32 v[16:17], v[16:17], v[116:117]
v_pk_add_f32 v[18:19], v[18:19], v[118:119]
v_cvt_pk_bf16_f32 v16, v16, v17
v_cvt_pk_bf16_f32 v17, v18, v19
buffer_store_dwordx2 v[16:17], v200, s[68:71], s40 offen offset:128
s_add_u32 s40, s84, 40960
s_waitcnt vmcnt(12)
v_pk_add_f32 v[20:21], v[20:21], v[120:121]
v_pk_add_f32 v[22:23], v[22:23], v[122:123]
v_cvt_pk_bf16_f32 v20, v20, v21
v_cvt_pk_bf16_f32 v21, v22, v23
buffer_store_dwordx2 v[20:21], v200, s[68:71], s40 offen offset:0
s_waitcnt vmcnt(12)
v_pk_add_f32 v[24:25], v[24:25], v[124:125]
v_pk_add_f32 v[26:27], v[26:27], v[126:127]
v_cvt_pk_bf16_f32 v24, v24, v25
v_cvt_pk_bf16_f32 v25, v26, v27
buffer_store_dwordx2 v[24:25], v200, s[68:71], s40 offen offset:32
s_waitcnt vmcnt(12)
v_pk_add_f32 v[28:29], v[28:29], v[128:129]
v_pk_add_f32 v[30:31], v[30:31], v[130:131]
v_cvt_pk_bf16_f32 v28, v28, v29
v_cvt_pk_bf16_f32 v29, v30, v31
buffer_store_dwordx2 v[28:29], v200, s[68:71], s40 offen offset:64
s_waitcnt vmcnt(12)
v_pk_add_f32 v[32:33], v[32:33], v[132:133]
v_pk_add_f32 v[34:35], v[34:35], v[134:135]
v_cvt_pk_bf16_f32 v32, v32, v33
v_cvt_pk_bf16_f32 v33, v34, v35
buffer_store_dwordx2 v[32:33], v200, s[68:71], s40 offen offset:96
s_waitcnt vmcnt(12)
v_pk_add_f32 v[36:37], v[36:37], v[136:137]
v_pk_add_f32 v[38:39], v[38:39], v[138:139]
v_cvt_pk_bf16_f32 v36, v36, v37
v_cvt_pk_bf16_f32 v37, v38, v39
buffer_store_dwordx2 v[36:37], v200, s[68:71], s40 offen offset:128
s_add_u32 s40, s84, 81920
s_waitcnt vmcnt(12)
v_pk_add_f32 v[40:41], v[40:41], v[140:141]
v_pk_add_f32 v[42:43], v[42:43], v[142:143]
v_cvt_pk_bf16_f32 v40, v40, v41
v_cvt_pk_bf16_f32 v41, v42, v43
buffer_store_dwordx2 v[40:41], v200, s[68:71], s40 offen offset:0
s_waitcnt vmcnt(12)
v_pk_add_f32 v[44:45], v[44:45], v[144:145]
v_pk_add_f32 v[46:47], v[46:47], v[146:147]
v_cvt_pk_bf16_f32 v44, v44, v45
v_cvt_pk_bf16_f32 v45, v46, v47
buffer_store_dwordx2 v[44:45], v200, s[68:71], s40 offen offset:32
s_waitcnt vmcnt(12)
v_pk_add_f32 v[48:49], v[48:49], v[148:149]
v_pk_add_f32 v[50:51], v[50:51], v[150:151]
v_cvt_pk_bf16_f32 v48, v48, v49
v_cvt_pk_bf16_f32 v49, v50, v51
buffer_store_dwordx2 v[48:49], v200, s[68:71], s40 offen offset:64
s_branch L_concat_heads__mha_block_cached__gqa_block_cached__near_ridge_kernel_exdone
L_concat_heads__mha_block_cached__gqa_block_cached__near_ridge_kernel_ex1:
buffer_store_dwordx4 v[0:3], v174, s[20:23], s57 offen offset:0 sc1
buffer_store_dwordx4 v[4:7], v174, s[20:23], s57 offen offset:1024 sc1
buffer_store_dwordx4 v[8:11], v174, s[20:23], s57 offen offset:2048 sc1
buffer_store_dwordx4 v[12:15], v174, s[20:23], s57 offen offset:3072 sc1
buffer_store_dwordx4 v[16:19], v175, s[20:23], s57 offen offset:0 sc1
buffer_store_dwordx4 v[20:23], v175, s[20:23], s57 offen offset:1024 sc1
buffer_store_dwordx4 v[24:27], v175, s[20:23], s57 offen offset:2048 sc1
buffer_store_dwordx4 v[28:31], v175, s[20:23], s57 offen offset:3072 sc1
buffer_store_dwordx4 v[32:35], v176, s[20:23], s57 offen offset:0 sc1
buffer_store_dwordx4 v[36:39], v176, s[20:23], s57 offen offset:1024 sc1
buffer_store_dwordx4 v[40:43], v176, s[20:23], s57 offen offset:2048 sc1
buffer_store_dwordx4 v[44:47], v176, s[20:23], s57 offen offset:3072 sc1
buffer_store_dwordx4 v[48:51], v177, s[20:23], s57 offen offset:0 sc1
s_waitcnt vmcnt(0)
s_mov_b64 exec, 1
buffer_store_dword v196, v194, s[20:23], s64 offen sc1
s_mov_b64 exec, -1
buffer_load_dword v195, v194, s[20:23], s65 offen sc1
s_waitcnt vmcnt(0)
s_mov_b32 s43, 0x80000
L_concat_heads__mha_block_cached__gqa_block_cached__near_ridge_kernel_pollx1:
v_cmp_ne_u32 vcc, v197, v195
s_sub_u32 s43, s43, 1
s_cmp_eq_u32 s43, 0
s_cbranch_scc1 L_concat_heads__mha_block_cached__gqa_block_cached__near_ridge_kernel_pollx1_out
s_cbranch_vccz L_concat_heads__mha_block_cached__gqa_block_cached__near_ridge_kernel_pollx1_out
s_sleep 1
buffer_load_dword v195, v194, s[20:23], s65 offen sc1
s_waitcnt vmcnt(0)
s_branch L_concat_heads__mha_block_cached__gqa_block_cached__near_ridge_kernel_pollx1
L_concat_heads__mha_block_cached__gqa_block_cached__near_ridge_kernel_pollx1_out:
buffer_load_dwordx4 v[100:103], v174, s[20:23], s58 offen offset:0 sc1
buffer_load_dwordx4 v[104:107], v174, s[20:23], s58 offen offset:1024 sc1
buffer_load_dwordx4 v[108:111], v174, s[20:23], s58 offen offset:2048 sc1
buffer_load_dwordx4 v[112:115], v174, s[20:23], s58 offen offset:3072 sc1
buffer_load_dwordx4 v[116:119], v175, s[20:23], s58 offen offset:0 sc1
buffer_load_dwordx4 v[120:123], v175, s[20:23], s58 offen offset:1024 sc1
buffer_load_dwordx4 v[124:127], v175, s[20:23], s58 offen offset:2048 sc1
buffer_load_dwordx4 v[128:131], v175, s[20:23], s58 offen offset:3072 sc1
buffer_load_dwordx4 v[132:135], v176, s[20:23], s58 offen offset:0 sc1
buffer_load_dwordx4 v[136:139], v176, s[20:23], s58 offen offset:1024 sc1
buffer_load_dwordx4 v[140:143], v176, s[20:23], s58 offen offset:2048 sc1
buffer_load_dwordx4 v[144:147], v176, s[20:23], s58 offen offset:3072 sc1
s_add_u32 s40, s84, 81920
s_waitcnt vmcnt(11)
v_pk_add_f32 v[52:53], v[52:53], v[100:101]
v_pk_add_f32 v[54:55], v[54:55], v[102:103]
v_cvt_pk_bf16_f32 v52, v52, v53
v_cvt_pk_bf16_f32 v53, v54, v55
buffer_store_dwordx2 v[52:53], v200, s[68:71], s40 offen offset:96
s_waitcnt vmcnt(11)
v_pk_add_f32 v[56:57], v[56:57], v[104:105]
v_pk_add_f32 v[58:59], v[58:59], v[106:107]
v_cvt_pk_bf16_f32 v56, v56, v57
v_cvt_pk_bf16_f32 v57, v58, v59
buffer_store_dwordx2 v[56:57], v200, s[68:71], s40 offen offset:128
s_add_u32 s40, s84, 122880
s_waitcnt vmcnt(11)
v_pk_add_f32 v[60:61], v[60:61], v[108:109]
v_pk_add_f32 v[62:63], v[62:63], v[110:111]
v_cvt_pk_bf16_f32 v60, v60, v61
v_cvt_pk_bf16_f32 v61, v62, v63
buffer_store_dwordx2 v[60:61], v200, s[68:71], s40 offen offset:0
s_waitcnt vmcnt(11)
v_pk_add_f32 v[64:65], v[64:65], v[112:113]
v_pk_add_f32 v[66:67], v[66:67], v[114:115]
v_cvt_pk_bf16_f32 v64, v64, v65
v_cvt_pk_bf16_f32 v65, v66, v67
buffer_store_dwordx2 v[64:65], v200, s[68:71], s40 offen offset:32
s_waitcnt vmcnt(11)
v_pk_add_f32 v[68:69], v[68:69], v[116:117]
v_pk_add_f32 v[70:71], v[70:71], v[118:119]
v_cvt_pk_bf16_f32 v68, v68, v69
v_cvt_pk_bf16_f32 v69, v70, v71
buffer_store_dwordx2 v[68:69], v200, s[68:71], s40 offen offset:64
s_waitcnt vmcnt(11)
v_pk_add_f32 v[72:73], v[72:73], v[120:121]
v_pk_add_f32 v[74:75], v[74:75], v[122:123]
v_cvt_pk_bf16_f32 v72, v72, v73
v_cvt_pk_bf16_f32 v73, v74, v75
buffer_store_dwordx2 v[72:73], v200, s[68:71], s40 offen offset:96
s_waitcnt vmcnt(11)
v_pk_add_f32 v[76:77], v[76:77], v[124:125]
v_pk_add_f32 v[78:79], v[78:79], v[126:127]
v_cvt_pk_bf16_f32 v76, v76, v77
v_cvt_pk_bf16_f32 v77, v78, v79
buffer_store_dwordx2 v[76:77], v200, s[68:71], s40 offen offset:128
s_add_u32 s40, s84, 163840
s_waitcnt vmcnt(11)
v_pk_add_f32 v[80:81], v[80:81], v[128:129]
v_pk_add_f32 v[82:83], v[82:83], v[130:131]
v_cvt_pk_bf16_f32 v80, v80, v81
v_cvt_pk_bf16_f32 v81, v82, v83
buffer_store_dwordx2 v[80:81], v200, s[68:71], s40 offen offset:0
s_waitcnt vmcnt(11)
v_pk_add_f32 v[84:85], v[84:85], v[132:133]
v_pk_add_f32 v[86:87], v[86:87], v[134:135]
v_cvt_pk_bf16_f32 v84, v84, v85
v_cvt_pk_bf16_f32 v85, v86, v87
buffer_store_dwordx2 v[84:85], v200, s[68:71], s40 offen offset:32
s_waitcnt vmcnt(11)
v_pk_add_f32 v[88:89], v[88:89], v[136:137]
v_pk_add_f32 v[90:91], v[90:91], v[138:139]
v_cvt_pk_bf16_f32 v88, v88, v89
v_cvt_pk_bf16_f32 v89, v90, v91
buffer_store_dwordx2 v[88:89], v200, s[68:71], s40 offen offset:64
s_waitcnt vmcnt(11)
v_pk_add_f32 v[92:93], v[92:93], v[140:141]
v_pk_add_f32 v[94:95], v[94:95], v[142:143]
v_cvt_pk_bf16_f32 v92, v92, v93
v_cvt_pk_bf16_f32 v93, v94, v95
buffer_store_dwordx2 v[92:93], v200, s[68:71], s40 offen offset:96
s_waitcnt vmcnt(11)
v_pk_add_f32 v[96:97], v[96:97], v[144:145]
v_pk_add_f32 v[98:99], v[98:99], v[146:147]
v_cvt_pk_bf16_f32 v96, v96, v97
v_cvt_pk_bf16_f32 v97, v98, v99
buffer_store_dwordx2 v[96:97], v200, s[68:71], s40 offen offset:128
L_concat_heads__mha_block_cached__gqa_block_cached__near_ridge_kernel_exdone:
L_concat_heads__mha_block_cached__gqa_block_cached__near_ridge_kernel_done:
s_endpgm
L_tr19:
s_call_b64 s[50:51], L_slowA1
s_branch L_back19
L_tr20:
s_call_b64 s[50:51], L_slowB1
s_branch L_back20
L_tr23:
s_call_b64 s[50:51], L_slowA0
s_branch L_back23
L_tr24:
s_call_b64 s[50:51], L_slowB0
s_branch L_back24
L_tr26:
s_call_b64 s[50:51], L_slowA1
s_branch L_back26
L_tr27:
s_call_b64 s[50:51], L_slowB1
s_branch L_back27
L_tr29:
s_call_b64 s[50:51], L_slowA0
s_branch L_back29
L_tr30:
s_call_b64 s[50:51], L_slowB0
s_branch L_back30
L_tr31:
s_call_b64 s[50:51], L_slowA1
s_branch L_back31
L_tr32:
s_call_b64 s[50:51], L_slowB1
s_branch L_back32
L_tr34:
s_call_b64 s[50:51], L_slowA0
s_branch L_back34
L_tr35:
s_call_b64 s[50:51], L_slowB0
s_branch L_back35
L_tr37:
s_call_b64 s[50:51], L_slowA1
s_branch L_back37
L_tr38:
s_call_b64 s[50:51], L_slowB1
s_branch L_back38
L_tr40:
s_call_b64 s[50:51], L_slowA0
s_branch L_back40
L_tr41:
s_call_b64 s[50:51], L_slowB0
s_branch L_back41
L_tr43:
s_call_b64 s[50:51], L_slowA1
s_branch L_back43
L_tr44:
s_call_b64 s[50:51], L_slowB1
s_branch L_back44
L_tr49:
s_call_b64 s[50:51], L_slowA0
s_branch L_back49
L_tr50:
s_call_b64 s[50:51], L_slowB0
s_branch L_back50
L_tr53:
s_call_b64 s[50:51], L_slowA1
s_branch L_back53
L_tr54:
s_call_b64 s[50:51], L_slowB1
s_branch L_back54
L_tr56:
s_call_b64 s[50:51], L_slowA0
s_branch L_back56
L_tr57:
s_call_b64 s[50:51], L_slowB0
s_branch L_back57
L_tr59:
s_call_b64 s[50:51], L_slowA1
s_branch L_back59
L_tr60:
s_call_b64 s[50:51], L_slowB1
s_branch L_back60
L_slowC:
s_nop 7
v_max3_f32 v230, v120, v121, v122
v_max3_f32 v230, v230, v123, v140
v_max3_f32 v230, v230, v141, v142
v_max_f32 v230, v230, v143
v_mov_b32 v231, v230
s_nop 1
v_permlane32_swap_b32 v230, v231
v_max_f32 v230, v230, v231
v_mov_b32 v231, v230
s_nop 1
v_permlane16_swap_b32 v230, v231
v_max_f32 v230, v230, v231
v_ceil_f32 v230, v230
v_add_f32 v230, 0x40e00000, v230
v_max_f32 v230, s52, v230
v_sub_f32 v200, v200, v230
v_sub_f32 v120, v120, v230
v_sub_f32 v140, v140, v230
v_sub_f32 v201, v201, v230
v_sub_f32 v121, v121, v230
v_sub_f32 v141, v141, v230
v_sub_f32 v202, v202, v230
v_sub_f32 v122, v122, v230
v_sub_f32 v142, v142, v230
v_sub_f32 v203, v203, v230
v_sub_f32 v123, v123, v230
v_sub_f32 v143, v143, v230
v_cvt_i32_f32 v231, v230
v_sub_u32 v225, 0, v231
v_ldexp_f32 v220, v220, v225
v_max3_f32 v230, v124, v125, v126
v_max3_f32 v230, v230, v127, v144
v_max3_f32 v230, v230, v145, v146
v_max_f32 v230, v230, v147
v_mov_b32 v231, v230
s_nop 1
v_permlane32_swap_b32 v230, v231
v_max_f32 v230, v230, v231
v_mov_b32 v231, v230
s_nop 1
v_permlane16_swap_b32 v230, v231
v_max_f32 v230, v230, v231
v_ceil_f32 v230, v230
v_add_f32 v230, 0x40e00000, v230
v_max_f32 v230, s52, v230
v_sub_f32 v204, v204, v230
v_sub_f32 v124, v124, v230
v_sub_f32 v144, v144, v230
v_sub_f32 v205, v205, v230
v_sub_f32 v125, v125, v230
v_sub_f32 v145, v145, v230
v_sub_f32 v206, v206, v230
v_sub_f32 v126, v126, v230
v_sub_f32 v146, v146, v230
v_sub_f32 v207, v207, v230
v_sub_f32 v127, v127, v230
v_sub_f32 v147, v147, v230
v_cvt_i32_f32 v231, v230
v_sub_u32 v226, 0, v231
v_ldexp_f32 v221, v221, v226
v_max3_f32 v230, v128, v129, v130
v_max3_f32 v230, v230, v131, v148
v_max3_f32 v230, v230, v149, v150
v_max_f32 v230, v230, v151
v_mov_b32 v231, v230
s_nop 1
v_permlane32_swap_b32 v230, v231
v_max_f32 v230, v230, v231
v_mov_b32 v231, v230
s_nop 1
v_permlane16_swap_b32 v230, v231
v_max_f32 v230, v230, v231
v_ceil_f32 v230, v230
v_add_f32 v230, 0x40e00000, v230
v_max_f32 v230, s52, v230
v_sub_f32 v208, v208, v230
v_sub_f32 v128, v128, v230
v_sub_f32 v148, v148, v230
v_sub_f32 v209, v209, v230
v_sub_f32 v129, v129, v230
v_sub_f32 v149, v149, v230
v_sub_f32 v210, v210, v230
v_sub_f32 v130, v130, v230
v_sub_f32 v150, v150, v230
v_sub_f32 v211, v211, v230
v_sub_f32 v131, v131, v230
v_sub_f32 v151, v151, v230
v_cvt_i32_f32 v231, v230
v_sub_u32 v227, 0, v231
v_ldexp_f32 v222, v222, v227
v_max3_f32 v230, v132, v133, v134
v_max3_f32 v230, v230, v135, v152
v_max3_f32 v230, v230, v153, v154
v_max_f32 v230, v230, v155
v_mov_b32 v231, v230
s_nop 1
v_permlane32_swap_b32 v230, v231
v_max_f32 v230, v230, v231
v_mov_b32 v231, v230
s_nop 1
v_permlane16_swap_b32 v230, v231
v_max_f32 v230, v230, v231
v_ceil_f32 v230, v230
v_add_f32 v230, 0x40e00000, v230
v_max_f32 v230, s52, v230
v_sub_f32 v212, v212, v230
v_sub_f32 v132, v132, v230
v_sub_f32 v152, v152, v230
v_sub_f32 v213, v213, v230
v_sub_f32 v133, v133, v230
v_sub_f32 v153, v153, v230
v_sub_f32 v214, v214, v230
v_sub_f32 v134, v134, v230
v_sub_f32 v154, v154, v230
v_sub_f32 v215, v215, v230
v_sub_f32 v135, v135, v230
v_sub_f32 v155, v155, v230
v_cvt_i32_f32 v231, v230
v_sub_u32 v228, 0, v231
v_ldexp_f32 v223, v223, v228
v_max3_f32 v230, v136, v137, v138
v_max3_f32 v230, v230, v139, v156
v_max3_f32 v230, v230, v157, v158
v_max_f32 v230, v230, v159
v_mov_b32 v231, v230
s_nop 1
v_permlane32_swap_b32 v230, v231
v_max_f32 v230, v230, v231
v_mov_b32 v231, v230
s_nop 1
v_permlane16_swap_b32 v230, v231
v_max_f32 v230, v230, v231
v_ceil_f32 v230, v230
v_add_f32 v230, 0x40e00000, v230
v_max_f32 v230, s52, v230
v_sub_f32 v216, v216, v230
v_sub_f32 v136, v136, v230
v_sub_f32 v156, v156, v230
v_sub_f32 v217, v217, v230
v_sub_f32 v137, v137, v230
v_sub_f32 v157, v157, v230
v_sub_f32 v218, v218, v230
v_sub_f32 v138, v138, v230
v_sub_f32 v158, v158, v230
v_sub_f32 v219, v219, v230
v_sub_f32 v139, v139, v230
v_sub_f32 v159, v159, v230
v_cvt_i32_f32 v231, v230
v_sub_u32 v229, 0, v231
v_ldexp_f32 v224, v224, v229
s_cmp_eq_u32 s53, 1
s_cbranch_scc1 L_slowC_ret
v_accvgpr_read_b32 v230, a0
v_ldexp_f32 v230, v230, v225
v_accvgpr_write_b32 a0, v230
v_accvgpr_read_b32 v231, a1
v_ldexp_f32 v231, v231, v225
v_accvgpr_write_b32 a1, v231
v_accvgpr_read_b32 v232, a2
v_ldexp_f32 v232, v232, v225
v_accvgpr_write_b32 a2, v232
v_accvgpr_read_b32 v233, a3
v_ldexp_f32 v233, v233, v225
v_accvgpr_write_b32 a3, v233
v_accvgpr_read_b32 v234, a4
v_ldexp_f32 v234, v234, v226
v_accvgpr_write_b32 a4, v234
v_accvgpr_read_b32 v235, a5
v_ldexp_f32 v235, v235, v226
v_accvgpr_write_b32 a5, v235
v_accvgpr_read_b32 v236, a6
v_ldexp_f32 v236, v236, v226
v_accvgpr_write_b32 a6, v236
v_accvgpr_read_b32 v237, a7
v_ldexp_f32 v237, v237, v226
v_accvgpr_write_b32 a7, v237
v_accvgpr_read_b32 v230, a8
v_ldexp_f32 v230, v230, v227
v_accvgpr_write_b32 a8, v230
v_accvgpr_read_b32 v231, a9
v_ldexp_f32 v231, v231, v227
v_accvgpr_write_b32 a9, v231
v_accvgpr_read_b32 v232, a10
v_ldexp_f32 v232, v232, v227
v_accvgpr_write_b32 a10, v232
v_accvgpr_read_b32 v233, a11
v_ldexp_f32 v233, v233, v227
v_accvgpr_write_b32 a11, v233
v_accvgpr_read_b32 v234, a12
v_ldexp_f32 v234, v234, v228
v_accvgpr_write_b32 a12, v234
v_accvgpr_read_b32 v235, a13
v_ldexp_f32 v235, v235, v228
v_accvgpr_write_b32 a13, v235
v_accvgpr_read_b32 v236, a14
v_ldexp_f32 v236, v236, v228
v_accvgpr_write_b32 a14, v236
v_accvgpr_read_b32 v237, a15
v_ldexp_f32 v237, v237, v228
v_accvgpr_write_b32 a15, v237
v_accvgpr_read_b32 v230, a16
v_ldexp_f32 v230, v230, v229
v_accvgpr_write_b32 a16, v230
v_accvgpr_read_b32 v231, a17
v_ldexp_f32 v231, v231, v229
v_accvgpr_write_b32 a17, v231
v_accvgpr_read_b32 v232, a18
v_ldexp_f32 v232, v232, v229
v_accvgpr_write_b32 a18, v232
v_accvgpr_read_b32 v233, a19
v_ldexp_f32 v233, v233, v229
v_accvgpr_write_b32 a19, v233
v_accvgpr_read_b32 v234, a20
v_ldexp_f32 v234, v234, v225
v_accvgpr_write_b32 a20, v234
v_accvgpr_read_b32 v235, a21
v_ldexp_f32 v235, v235, v225
v_accvgpr_write_b32 a21, v235
v_accvgpr_read_b32 v236, a22
v_ldexp_f32 v236, v236, v225
v_accvgpr_write_b32 a22, v236
v_accvgpr_read_b32 v237, a23
v_ldexp_f32 v237, v237, v225
v_accvgpr_write_b32 a23, v237
v_accvgpr_read_b32 v230, a24
v_ldexp_f32 v230, v230, v226
v_accvgpr_write_b32 a24, v230
v_accvgpr_read_b32 v231, a25
v_ldexp_f32 v231, v231, v226
v_accvgpr_write_b32 a25, v231
v_accvgpr_read_b32 v232, a26
v_ldexp_f32 v232, v232, v226
v_accvgpr_write_b32 a26, v232
v_accvgpr_read_b32 v233, a27
v_ldexp_f32 v233, v233, v226
v_accvgpr_write_b32 a27, v233
v_accvgpr_read_b32 v234, a28
v_ldexp_f32 v234, v234, v227
v_accvgpr_write_b32 a28, v234
v_accvgpr_read_b32 v235, a29
v_ldexp_f32 v235, v235, v227
v_accvgpr_write_b32 a29, v235
v_accvgpr_read_b32 v236, a30
v_ldexp_f32 v236, v236, v227
v_accvgpr_write_b32 a30, v236
v_accvgpr_read_b32 v237, a31
v_ldexp_f32 v237, v237, v227
v_accvgpr_write_b32 a31, v237
v_accvgpr_read_b32 v230, a32
v_ldexp_f32 v230, v230, v228
v_accvgpr_write_b32 a32, v230
v_accvgpr_read_b32 v231, a33
v_ldexp_f32 v231, v231, v228
v_accvgpr_write_b32 a33, v231
v_accvgpr_read_b32 v232, a34
v_ldexp_f32 v232, v232, v228
v_accvgpr_write_b32 a34, v232
v_accvgpr_read_b32 v233, a35
v_ldexp_f32 v233, v233, v228
v_accvgpr_write_b32 a35, v233
v_accvgpr_read_b32 v234, a36
v_ldexp_f32 v234, v234, v229
v_accvgpr_write_b32 a36, v234
v_accvgpr_read_b32 v235, a37
v_ldexp_f32 v235, v235, v229
v_accvgpr_write_b32 a37, v235
v_accvgpr_read_b32 v236, a38
v_ldexp_f32 v236, v236, v229
v_accvgpr_write_b32 a38, v236
v_accvgpr_read_b32 v237, a39
v_ldexp_f32 v237, v237, v229
v_accvgpr_write_b32 a39, v237
v_accvgpr_read_b32 v230, a40
v_ldexp_f32 v230, v230, v225
v_accvgpr_write_b32 a40, v230
v_accvgpr_read_b32 v231, a41
v_ldexp_f32 v231, v231, v225
v_accvgpr_write_b32 a41, v231
v_accvgpr_read_b32 v232, a42
v_ldexp_f32 v232, v232, v225
v_accvgpr_write_b32 a42, v232
v_accvgpr_read_b32 v233, a43
v_ldexp_f32 v233, v233, v225
v_accvgpr_write_b32 a43, v233
v_accvgpr_read_b32 v234, a44
v_ldexp_f32 v234, v234, v226
v_accvgpr_write_b32 a44, v234
v_accvgpr_read_b32 v235, a45
v_ldexp_f32 v235, v235, v226
v_accvgpr_write_b32 a45, v235
v_accvgpr_read_b32 v236, a46
v_ldexp_f32 v236, v236, v226
v_accvgpr_write_b32 a46, v236
v_accvgpr_read_b32 v237, a47
v_ldexp_f32 v237, v237, v226
v_accvgpr_write_b32 a47, v237
v_accvgpr_read_b32 v230, a48
v_ldexp_f32 v230, v230, v227
v_accvgpr_write_b32 a48, v230
v_accvgpr_read_b32 v231, a49
v_ldexp_f32 v231, v231, v227
v_accvgpr_write_b32 a49, v231
v_accvgpr_read_b32 v232, a50
v_ldexp_f32 v232, v232, v227
v_accvgpr_write_b32 a50, v232
v_accvgpr_read_b32 v233, a51
v_ldexp_f32 v233, v233, v227
v_accvgpr_write_b32 a51, v233
v_accvgpr_read_b32 v234, a52
v_ldexp_f32 v234, v234, v228
v_accvgpr_write_b32 a52, v234
v_accvgpr_read_b32 v235, a53
v_ldexp_f32 v235, v235, v228
v_accvgpr_write_b32 a53, v235
v_accvgpr_read_b32 v236, a54
v_ldexp_f32 v236, v236, v228
v_accvgpr_write_b32 a54, v236
v_accvgpr_read_b32 v237, a55
v_ldexp_f32 v237, v237, v228
v_accvgpr_write_b32 a55, v237
v_accvgpr_read_b32 v230, a56
v_ldexp_f32 v230, v230, v229
v_accvgpr_write_b32 a56, v230
v_accvgpr_read_b32 v231, a57
v_ldexp_f32 v231, v231, v229
v_accvgpr_write_b32 a57, v231
v_accvgpr_read_b32 v232, a58
v_ldexp_f32 v232, v232, v229
v_accvgpr_write_b32 a58, v232
v_accvgpr_read_b32 v233, a59
v_ldexp_f32 v233, v233, v229
v_accvgpr_write_b32 a59, v233
v_accvgpr_read_b32 v234, a60
v_ldexp_f32 v234, v234, v225
v_accvgpr_write_b32 a60, v234
v_accvgpr_read_b32 v235, a61
v_ldexp_f32 v235, v235, v225
v_accvgpr_write_b32 a61, v235
v_accvgpr_read_b32 v236, a62
v_ldexp_f32 v236, v236, v225
v_accvgpr_write_b32 a62, v236
v_accvgpr_read_b32 v237, a63
v_ldexp_f32 v237, v237, v225
v_accvgpr_write_b32 a63, v237
v_accvgpr_read_b32 v230, a64
v_ldexp_f32 v230, v230, v226
v_accvgpr_write_b32 a64, v230
v_accvgpr_read_b32 v231, a65
v_ldexp_f32 v231, v231, v226
v_accvgpr_write_b32 a65, v231
v_accvgpr_read_b32 v232, a66
v_ldexp_f32 v232, v232, v226
v_accvgpr_write_b32 a66, v232
v_accvgpr_read_b32 v233, a67
v_ldexp_f32 v233, v233, v226
v_accvgpr_write_b32 a67, v233
v_accvgpr_read_b32 v234, a68
v_ldexp_f32 v234, v234, v227
v_accvgpr_write_b32 a68, v234
v_accvgpr_read_b32 v235, a69
v_ldexp_f32 v235, v235, v227
v_accvgpr_write_b32 a69, v235
v_accvgpr_read_b32 v236, a70
v_ldexp_f32 v236, v236, v227
v_accvgpr_write_b32 a70, v236
v_accvgpr_read_b32 v237, a71
v_ldexp_f32 v237, v237, v227
v_accvgpr_write_b32 a71, v237
v_accvgpr_read_b32 v230, a72
v_ldexp_f32 v230, v230, v228
v_accvgpr_write_b32 a72, v230
v_accvgpr_read_b32 v231, a73
v_ldexp_f32 v231, v231, v228
v_accvgpr_write_b32 a73, v231
v_accvgpr_read_b32 v232, a74
v_ldexp_f32 v232, v232, v228
v_accvgpr_write_b32 a74, v232
v_accvgpr_read_b32 v233, a75
v_ldexp_f32 v233, v233, v228
v_accvgpr_write_b32 a75, v233
v_accvgpr_read_b32 v234, a76
v_ldexp_f32 v234, v234, v229
v_accvgpr_write_b32 a76, v234
v_accvgpr_read_b32 v235, a77
v_ldexp_f32 v235, v235, v229
v_accvgpr_write_b32 a77, v235
v_accvgpr_read_b32 v236, a78
v_ldexp_f32 v236, v236, v229
v_accvgpr_write_b32 a78, v236
v_accvgpr_read_b32 v237, a79
v_ldexp_f32 v237, v237, v229
v_accvgpr_write_b32 a79, v237
v_accvgpr_read_b32 v230, a80
v_ldexp_f32 v230, v230, v225
v_accvgpr_write_b32 a80, v230
v_accvgpr_read_b32 v231, a81
v_ldexp_f32 v231, v231, v225
v_accvgpr_write_b32 a81, v231
v_accvgpr_read_b32 v232, a82
v_ldexp_f32 v232, v232, v225
v_accvgpr_write_b32 a82, v232
v_accvgpr_read_b32 v233, a83
v_ldexp_f32 v233, v233, v225
v_accvgpr_write_b32 a83, v233
v_accvgpr_read_b32 v234, a84
v_ldexp_f32 v234, v234, v226
v_accvgpr_write_b32 a84, v234
v_accvgpr_read_b32 v235, a85
v_ldexp_f32 v235, v235, v226
v_accvgpr_write_b32 a85, v235
v_accvgpr_read_b32 v236, a86
v_ldexp_f32 v236, v236, v226
v_accvgpr_write_b32 a86, v236
v_accvgpr_read_b32 v237, a87
v_ldexp_f32 v237, v237, v226
v_accvgpr_write_b32 a87, v237
v_accvgpr_read_b32 v230, a88
v_ldexp_f32 v230, v230, v227
v_accvgpr_write_b32 a88, v230
v_accvgpr_read_b32 v231, a89
v_ldexp_f32 v231, v231, v227
v_accvgpr_write_b32 a89, v231
v_accvgpr_read_b32 v232, a90
v_ldexp_f32 v232, v232, v227
v_accvgpr_write_b32 a90, v232
v_accvgpr_read_b32 v233, a91
v_ldexp_f32 v233, v233, v227
v_accvgpr_write_b32 a91, v233
v_accvgpr_read_b32 v234, a92
v_ldexp_f32 v234, v234, v228
v_accvgpr_write_b32 a92, v234
v_accvgpr_read_b32 v235, a93
v_ldexp_f32 v235, v235, v228
v_accvgpr_write_b32 a93, v235
v_accvgpr_read_b32 v236, a94
v_ldexp_f32 v236, v236, v228
v_accvgpr_write_b32 a94, v236
v_accvgpr_read_b32 v237, a95
v_ldexp_f32 v237, v237, v228
v_accvgpr_write_b32 a95, v237
v_accvgpr_read_b32 v230, a96
v_ldexp_f32 v230, v230, v229
v_accvgpr_write_b32 a96, v230
v_accvgpr_read_b32 v231, a97
v_ldexp_f32 v231, v231, v229
v_accvgpr_write_b32 a97, v231
v_accvgpr_read_b32 v232, a98
v_ldexp_f32 v232, v232, v229
v_accvgpr_write_b32 a98, v232
v_accvgpr_read_b32 v233, a99
v_ldexp_f32 v233, v233, v229
v_accvgpr_write_b32 a99, v233
v_accvgpr_read_b32 v234, a100
v_ldexp_f32 v234, v234, v225
v_accvgpr_write_b32 a100, v234
v_accvgpr_read_b32 v235, a101
v_ldexp_f32 v235, v235, v225
v_accvgpr_write_b32 a101, v235
v_accvgpr_read_b32 v236, a102
v_ldexp_f32 v236, v236, v225
v_accvgpr_write_b32 a102, v236
v_accvgpr_read_b32 v237, a103
v_ldexp_f32 v237, v237, v225
v_accvgpr_write_b32 a103, v237
v_accvgpr_read_b32 v230, a104
v_ldexp_f32 v230, v230, v226
v_accvgpr_write_b32 a104, v230
v_accvgpr_read_b32 v231, a105
v_ldexp_f32 v231, v231, v226
v_accvgpr_write_b32 a105, v231
v_accvgpr_read_b32 v232, a106
v_ldexp_f32 v232, v232, v226
v_accvgpr_write_b32 a106, v232
v_accvgpr_read_b32 v233, a107
v_ldexp_f32 v233, v233, v226
v_accvgpr_write_b32 a107, v233
v_accvgpr_read_b32 v234, a108
v_ldexp_f32 v234, v234, v227
v_accvgpr_write_b32 a108, v234
v_accvgpr_read_b32 v235, a109
v_ldexp_f32 v235, v235, v227
v_accvgpr_write_b32 a109, v235
v_accvgpr_read_b32 v236, a110
v_ldexp_f32 v236, v236, v227
v_accvgpr_write_b32 a110, v236
v_accvgpr_read_b32 v237, a111
v_ldexp_f32 v237, v237, v227
v_accvgpr_write_b32 a111, v237
v_accvgpr_read_b32 v230, a112
v_ldexp_f32 v230, v230, v228
v_accvgpr_write_b32 a112, v230
v_accvgpr_read_b32 v231, a113
v_ldexp_f32 v231, v231, v228
v_accvgpr_write_b32 a113, v231
v_accvgpr_read_b32 v232, a114
v_ldexp_f32 v232, v232, v228
v_accvgpr_write_b32 a114, v232
v_accvgpr_read_b32 v233, a115
v_ldexp_f32 v233, v233, v228
v_accvgpr_write_b32 a115, v233
v_accvgpr_read_b32 v234, a116
v_ldexp_f32 v234, v234, v229
v_accvgpr_write_b32 a116, v234
v_accvgpr_read_b32 v235, a117
v_ldexp_f32 v235, v235, v229
v_accvgpr_write_b32 a117, v235
v_accvgpr_read_b32 v236, a118
v_ldexp_f32 v236, v236, v229
v_accvgpr_write_b32 a118, v236
v_accvgpr_read_b32 v237, a119
v_ldexp_f32 v237, v237, v229
v_accvgpr_write_b32 a119, v237
v_accvgpr_read_b32 v230, a120
v_ldexp_f32 v230, v230, v225
v_accvgpr_write_b32 a120, v230
v_accvgpr_read_b32 v231, a121
v_ldexp_f32 v231, v231, v225
v_accvgpr_write_b32 a121, v231
v_accvgpr_read_b32 v232, a122
v_ldexp_f32 v232, v232, v225
v_accvgpr_write_b32 a122, v232
v_accvgpr_read_b32 v233, a123
v_ldexp_f32 v233, v233, v225
v_accvgpr_write_b32 a123, v233
v_accvgpr_read_b32 v234, a124
v_ldexp_f32 v234, v234, v226
v_accvgpr_write_b32 a124, v234
v_accvgpr_read_b32 v235, a125
v_ldexp_f32 v235, v235, v226
v_accvgpr_write_b32 a125, v235
v_accvgpr_read_b32 v236, a126
v_ldexp_f32 v236, v236, v226
v_accvgpr_write_b32 a126, v236
v_accvgpr_read_b32 v237, a127
v_ldexp_f32 v237, v237, v226
v_accvgpr_write_b32 a127, v237
v_accvgpr_read_b32 v230, a128
v_ldexp_f32 v230, v230, v227
v_accvgpr_write_b32 a128, v230
v_accvgpr_read_b32 v231, a129
v_ldexp_f32 v231, v231, v227
v_accvgpr_write_b32 a129, v231
v_accvgpr_read_b32 v232, a130
v_ldexp_f32 v232, v232, v227
v_accvgpr_write_b32 a130, v232
v_accvgpr_read_b32 v233, a131
v_ldexp_f32 v233, v233, v227
v_accvgpr_write_b32 a131, v233
v_accvgpr_read_b32 v234, a132
v_ldexp_f32 v234, v234, v228
v_accvgpr_write_b32 a132, v234
v_accvgpr_read_b32 v235, a133
v_ldexp_f32 v235, v235, v228
v_accvgpr_write_b32 a133, v235
v_accvgpr_read_b32 v236, a134
v_ldexp_f32 v236, v236, v228
v_accvgpr_write_b32 a134, v236
v_accvgpr_read_b32 v237, a135
v_ldexp_f32 v237, v237, v228
v_accvgpr_write_b32 a135, v237
v_accvgpr_read_b32 v230, a136
v_ldexp_f32 v230, v230, v229
v_accvgpr_write_b32 a136, v230
v_accvgpr_read_b32 v231, a137
v_ldexp_f32 v231, v231, v229
v_accvgpr_write_b32 a137, v231
v_accvgpr_read_b32 v232, a138
v_ldexp_f32 v232, v232, v229
v_accvgpr_write_b32 a138, v232
v_accvgpr_read_b32 v233, a139
v_ldexp_f32 v233, v233, v229
v_accvgpr_write_b32 a139, v233
v_accvgpr_read_b32 v234, a140
v_ldexp_f32 v234, v234, v225
v_accvgpr_write_b32 a140, v234
v_accvgpr_read_b32 v235, a141
v_ldexp_f32 v235, v235, v225
v_accvgpr_write_b32 a141, v235
v_accvgpr_read_b32 v236, a142
v_ldexp_f32 v236, v236, v225
v_accvgpr_write_b32 a142, v236
v_accvgpr_read_b32 v237, a143
v_ldexp_f32 v237, v237, v225
v_accvgpr_write_b32 a143, v237
v_accvgpr_read_b32 v230, a144
v_ldexp_f32 v230, v230, v226
v_accvgpr_write_b32 a144, v230
v_accvgpr_read_b32 v231, a145
v_ldexp_f32 v231, v231, v226
v_accvgpr_write_b32 a145, v231
v_accvgpr_read_b32 v232, a146
v_ldexp_f32 v232, v232, v226
v_accvgpr_write_b32 a146, v232
v_accvgpr_read_b32 v233, a147
v_ldexp_f32 v233, v233, v226
v_accvgpr_write_b32 a147, v233
v_accvgpr_read_b32 v234, a148
v_ldexp_f32 v234, v234, v227
v_accvgpr_write_b32 a148, v234
v_accvgpr_read_b32 v235, a149
v_ldexp_f32 v235, v235, v227
v_accvgpr_write_b32 a149, v235
v_accvgpr_read_b32 v236, a150
v_ldexp_f32 v236, v236, v227
v_accvgpr_write_b32 a150, v236
v_accvgpr_read_b32 v237, a151
v_ldexp_f32 v237, v237, v227
v_accvgpr_write_b32 a151, v237
v_accvgpr_read_b32 v230, a152
v_ldexp_f32 v230, v230, v228
v_accvgpr_write_b32 a152, v230
v_accvgpr_read_b32 v231, a153
v_ldexp_f32 v231, v231, v228
v_accvgpr_write_b32 a153, v231
v_accvgpr_read_b32 v232, a154
v_ldexp_f32 v232, v232, v228
v_accvgpr_write_b32 a154, v232
v_accvgpr_read_b32 v233, a155
v_ldexp_f32 v233, v233, v228
v_accvgpr_write_b32 a155, v233
v_accvgpr_read_b32 v234, a156
v_ldexp_f32 v234, v234, v229
v_accvgpr_write_b32 a156, v234
v_accvgpr_read_b32 v235, a157
v_ldexp_f32 v235, v235, v229
v_accvgpr_write_b32 a157, v235
v_accvgpr_read_b32 v236, a158
v_ldexp_f32 v236, v236, v229
v_accvgpr_write_b32 a158, v236
v_accvgpr_read_b32 v237, a159
v_ldexp_f32 v237, v237, v229
v_accvgpr_write_b32 a159, v237
v_accvgpr_read_b32 v230, a160
v_ldexp_f32 v230, v230, v225
v_accvgpr_write_b32 a160, v230
v_accvgpr_read_b32 v231, a161
v_ldexp_f32 v231, v231, v225
v_accvgpr_write_b32 a161, v231
v_accvgpr_read_b32 v232, a162
v_ldexp_f32 v232, v232, v225
v_accvgpr_write_b32 a162, v232
v_accvgpr_read_b32 v233, a163
v_ldexp_f32 v233, v233, v225
v_accvgpr_write_b32 a163, v233
v_accvgpr_read_b32 v234, a164
v_ldexp_f32 v234, v234, v226
v_accvgpr_write_b32 a164, v234
v_accvgpr_read_b32 v235, a165
v_ldexp_f32 v235, v235, v226
v_accvgpr_write_b32 a165, v235
v_accvgpr_read_b32 v236, a166
v_ldexp_f32 v236, v236, v226
v_accvgpr_write_b32 a166, v236
v_accvgpr_read_b32 v237, a167
v_ldexp_f32 v237, v237, v226
v_accvgpr_write_b32 a167, v237
v_accvgpr_read_b32 v230, a168
v_ldexp_f32 v230, v230, v227
v_accvgpr_write_b32 a168, v230
v_accvgpr_read_b32 v231, a169
v_ldexp_f32 v231, v231, v227
v_accvgpr_write_b32 a169, v231
v_accvgpr_read_b32 v232, a170
v_ldexp_f32 v232, v232, v227
v_accvgpr_write_b32 a170, v232
v_accvgpr_read_b32 v233, a171
v_ldexp_f32 v233, v233, v227
v_accvgpr_write_b32 a171, v233
v_accvgpr_read_b32 v234, a172
v_ldexp_f32 v234, v234, v228
v_accvgpr_write_b32 a172, v234
v_accvgpr_read_b32 v235, a173
v_ldexp_f32 v235, v235, v228
v_accvgpr_write_b32 a173, v235
v_accvgpr_read_b32 v236, a174
v_ldexp_f32 v236, v236, v228
v_accvgpr_write_b32 a174, v236
v_accvgpr_read_b32 v237, a175
v_ldexp_f32 v237, v237, v228
v_accvgpr_write_b32 a175, v237
v_accvgpr_read_b32 v230, a176
v_ldexp_f32 v230, v230, v229
v_accvgpr_write_b32 a176, v230
v_accvgpr_read_b32 v231, a177
v_ldexp_f32 v231, v231, v229
v_accvgpr_write_b32 a177, v231
v_accvgpr_read_b32 v232, a178
v_ldexp_f32 v232, v232, v229
v_accvgpr_write_b32 a178, v232
v_accvgpr_read_b32 v233, a179
v_ldexp_f32 v233, v233, v229
v_accvgpr_write_b32 a179, v233
v_accvgpr_read_b32 v234, a180
v_ldexp_f32 v234, v234, v225
v_accvgpr_write_b32 a180, v234
v_accvgpr_read_b32 v235, a181
v_ldexp_f32 v235, v235, v225
v_accvgpr_write_b32 a181, v235
v_accvgpr_read_b32 v236, a182
v_ldexp_f32 v236, v236, v225
v_accvgpr_write_b32 a182, v236
v_accvgpr_read_b32 v237, a183
v_ldexp_f32 v237, v237, v225
v_accvgpr_write_b32 a183, v237
v_accvgpr_read_b32 v230, a184
v_ldexp_f32 v230, v230, v226
v_accvgpr_write_b32 a184, v230
v_accvgpr_read_b32 v231, a185
v_ldexp_f32 v231, v231, v226
v_accvgpr_write_b32 a185, v231
v_accvgpr_read_b32 v232, a186
v_ldexp_f32 v232, v232, v226
v_accvgpr_write_b32 a186, v232
v_accvgpr_read_b32 v233, a187
v_ldexp_f32 v233, v233, v226
v_accvgpr_write_b32 a187, v233
v_accvgpr_read_b32 v234, a188
v_ldexp_f32 v234, v234, v227
v_accvgpr_write_b32 a188, v234
v_accvgpr_read_b32 v235, a189
v_ldexp_f32 v235, v235, v227
v_accvgpr_write_b32 a189, v235
v_accvgpr_read_b32 v236, a190
v_ldexp_f32 v236, v236, v227
v_accvgpr_write_b32 a190, v236
v_accvgpr_read_b32 v237, a191
v_ldexp_f32 v237, v237, v227
v_accvgpr_write_b32 a191, v237
v_accvgpr_read_b32 v230, a192
v_ldexp_f32 v230, v230, v228
v_accvgpr_write_b32 a192, v230
v_accvgpr_read_b32 v231, a193
v_ldexp_f32 v231, v231, v228
v_accvgpr_write_b32 a193, v231
v_accvgpr_read_b32 v232, a194
v_ldexp_f32 v232, v232, v228
v_accvgpr_write_b32 a194, v232
v_accvgpr_read_b32 v233, a195
v_ldexp_f32 v233, v233, v228
v_accvgpr_write_b32 a195, v233
v_accvgpr_read_b32 v234, a196
v_ldexp_f32 v234, v234, v229
v_accvgpr_write_b32 a196, v234
v_accvgpr_read_b32 v235, a197
v_ldexp_f32 v235, v235, v229
v_accvgpr_write_b32 a197, v235
v_accvgpr_read_b32 v236, a198
v_ldexp_f32 v236, v236, v229
v_accvgpr_write_b32 a198, v236
v_accvgpr_read_b32 v237, a199
v_ldexp_f32 v237, v237, v229
v_accvgpr_write_b32 a199, v237
v_accvgpr_read_b32 v230, a200
v_ldexp_f32 v230, v230, v225
v_accvgpr_write_b32 a200, v230
v_accvgpr_read_b32 v231, a201
v_ldexp_f32 v231, v231, v225
v_accvgpr_write_b32 a201, v231
v_accvgpr_read_b32 v232, a202
v_ldexp_f32 v232, v232, v225
v_accvgpr_write_b32 a202, v232
v_accvgpr_read_b32 v233, a203
v_ldexp_f32 v233, v233, v225
v_accvgpr_write_b32 a203, v233
v_accvgpr_read_b32 v234, a204
v_ldexp_f32 v234, v234, v226
v_accvgpr_write_b32 a204, v234
v_accvgpr_read_b32 v235, a205
v_ldexp_f32 v235, v235, v226
v_accvgpr_write_b32 a205, v235
v_accvgpr_read_b32 v236, a206
v_ldexp_f32 v236, v236, v226
v_accvgpr_write_b32 a206, v236
v_accvgpr_read_b32 v237, a207
v_ldexp_f32 v237, v237, v226
v_accvgpr_write_b32 a207, v237
v_accvgpr_read_b32 v230, a208
v_ldexp_f32 v230, v230, v227
v_accvgpr_write_b32 a208, v230
v_accvgpr_read_b32 v231, a209
v_ldexp_f32 v231, v231, v227
v_accvgpr_write_b32 a209, v231
v_accvgpr_read_b32 v232, a210
v_ldexp_f32 v232, v232, v227
v_accvgpr_write_b32 a210, v232
v_accvgpr_read_b32 v233, a211
v_ldexp_f32 v233, v233, v227
v_accvgpr_write_b32 a211, v233
v_accvgpr_read_b32 v234, a212
v_ldexp_f32 v234, v234, v228
v_accvgpr_write_b32 a212, v234
v_accvgpr_read_b32 v235, a213
v_ldexp_f32 v235, v235, v228
v_accvgpr_write_b32 a213, v235
v_accvgpr_read_b32 v236, a214
v_ldexp_f32 v236, v236, v228
v_accvgpr_write_b32 a214, v236
v_accvgpr_read_b32 v237, a215
v_ldexp_f32 v237, v237, v228
v_accvgpr_write_b32 a215, v237
v_accvgpr_read_b32 v230, a216
v_ldexp_f32 v230, v230, v229
v_accvgpr_write_b32 a216, v230
v_accvgpr_read_b32 v231, a217
v_ldexp_f32 v231, v231, v229
v_accvgpr_write_b32 a217, v231
v_accvgpr_read_b32 v232, a218
v_ldexp_f32 v232, v232, v229
v_accvgpr_write_b32 a218, v232
v_accvgpr_read_b32 v233, a219
v_ldexp_f32 v233, v233, v229
v_accvgpr_write_b32 a219, v233
v_accvgpr_read_b32 v234, a220
v_ldexp_f32 v234, v234, v225
v_accvgpr_write_b32 a220, v234
v_accvgpr_read_b32 v235, a221
v_ldexp_f32 v235, v235, v225
v_accvgpr_write_b32 a221, v235
v_accvgpr_read_b32 v236, a222
v_ldexp_f32 v236, v236, v225
v_accvgpr_write_b32 a222, v236
v_accvgpr_read_b32 v237, a223
v_ldexp_f32 v237, v237, v225
v_accvgpr_write_b32 a223, v237
v_accvgpr_read_b32 v230, a224
v_ldexp_f32 v230, v230, v226
v_accvgpr_write_b32 a224, v230
v_accvgpr_read_b32 v231, a225
v_ldexp_f32 v231, v231, v226
v_accvgpr_write_b32 a225, v231
v_accvgpr_read_b32 v232, a226
v_ldexp_f32 v232, v232, v226
v_accvgpr_write_b32 a226, v232
v_accvgpr_read_b32 v233, a227
v_ldexp_f32 v233, v233, v226
v_accvgpr_write_b32 a227, v233
v_accvgpr_read_b32 v234, a228
v_ldexp_f32 v234, v234, v227
v_accvgpr_write_b32 a228, v234
v_accvgpr_read_b32 v235, a229
v_ldexp_f32 v235, v235, v227
v_accvgpr_write_b32 a229, v235
v_accvgpr_read_b32 v236, a230
v_ldexp_f32 v236, v236, v227
v_accvgpr_write_b32 a230, v236
v_accvgpr_read_b32 v237, a231
v_ldexp_f32 v237, v237, v227
v_accvgpr_write_b32 a231, v237
v_accvgpr_read_b32 v230, a232
v_ldexp_f32 v230, v230, v228
v_accvgpr_write_b32 a232, v230
v_accvgpr_read_b32 v231, a233
v_ldexp_f32 v231, v231, v228
v_accvgpr_write_b32 a233, v231
v_accvgpr_read_b32 v232, a234
v_ldexp_f32 v232, v232, v228
v_accvgpr_write_b32 a234, v232
v_accvgpr_read_b32 v233, a235
v_ldexp_f32 v233, v233, v228
v_accvgpr_write_b32 a235, v233
v_accvgpr_read_b32 v234, a236
v_ldexp_f32 v234, v234, v229
v_accvgpr_write_b32 a236, v234
v_accvgpr_read_b32 v235, a237
v_ldexp_f32 v235, v235, v229
v_accvgpr_write_b32 a237, v235
v_accvgpr_read_b32 v236, a238
v_ldexp_f32 v236, v236, v229
v_accvgpr_write_b32 a238, v236
v_accvgpr_read_b32 v237, a239
v_ldexp_f32 v237, v237, v229
v_accvgpr_write_b32 a239, v237
L_slowC_ret:
s_setpc_b64 s[80:81]
L_slowA0:
s_call_b64 s[80:81], L_slowC
v_lshlrev_b32 v230, 16, v180
v_and_b32 v231, 0xffff0000, v180
v_ldexp_f32 v230, v230, v225
v_ldexp_f32 v231, v231, v225
v_cvt_pk_bf16_f32 v180, v230, v231
v_lshlrev_b32 v230, 16, v181
v_and_b32 v231, 0xffff0000, v181
v_ldexp_f32 v230, v230, v225
v_ldexp_f32 v231, v231, v225
v_cvt_pk_bf16_f32 v181, v230, v231
v_lshlrev_b32 v230, 16, v182
v_and_b32 v231, 0xffff0000, v182
v_ldexp_f32 v230, v230, v225
v_ldexp_f32 v231, v231, v225
v_cvt_pk_bf16_f32 v182, v230, v231
v_lshlrev_b32 v230, 16, v183
v_and_b32 v231, 0xffff0000, v183
v_ldexp_f32 v230, v230, v225
v_ldexp_f32 v231, v231, v225
v_cvt_pk_bf16_f32 v183, v230, v231
v_lshlrev_b32 v230, 16, v184
v_and_b32 v231, 0xffff0000, v184
v_ldexp_f32 v230, v230, v226
v_ldexp_f32 v231, v231, v226
v_cvt_pk_bf16_f32 v184, v230, v231
v_lshlrev_b32 v230, 16, v185
v_and_b32 v231, 0xffff0000, v185
v_ldexp_f32 v230, v230, v226
v_ldexp_f32 v231, v231, v226
v_cvt_pk_bf16_f32 v185, v230, v231
v_lshlrev_b32 v230, 16, v186
v_and_b32 v231, 0xffff0000, v186
v_ldexp_f32 v230, v230, v226
v_ldexp_f32 v231, v231, v226
v_cvt_pk_bf16_f32 v186, v230, v231
v_lshlrev_b32 v230, 16, v187
v_and_b32 v231, 0xffff0000, v187
v_ldexp_f32 v230, v230, v226
v_ldexp_f32 v231, v231, v226
v_cvt_pk_bf16_f32 v187, v230, v231
v_lshlrev_b32 v230, 16, v188
v_and_b32 v231, 0xffff0000, v188
v_ldexp_f32 v230, v230, v227
v_ldexp_f32 v231, v231, v227
v_cvt_pk_bf16_f32 v188, v230, v231
v_lshlrev_b32 v230, 16, v189
v_and_b32 v231, 0xffff0000, v189
v_ldexp_f32 v230, v230, v227
v_ldexp_f32 v231, v231, v227
v_cvt_pk_bf16_f32 v189, v230, v231
v_lshlrev_b32 v230, 16, v190
v_and_b32 v231, 0xffff0000, v190
v_ldexp_f32 v230, v230, v227
v_ldexp_f32 v231, v231, v227
v_cvt_pk_bf16_f32 v190, v230, v231
v_lshlrev_b32 v230, 16, v191
v_and_b32 v231, 0xffff0000, v191
v_ldexp_f32 v230, v230, v227
v_ldexp_f32 v231, v231, v227
v_cvt_pk_bf16_f32 v191, v230, v231
v_lshlrev_b32 v230, 16, v192
v_and_b32 v231, 0xffff0000, v192
v_ldexp_f32 v230, v230, v228
v_ldexp_f32 v231, v231, v228
v_cvt_pk_bf16_f32 v192, v230, v231
v_lshlrev_b32 v230, 16, v193
v_and_b32 v231, 0xffff0000, v193
v_ldexp_f32 v230, v230, v228
v_ldexp_f32 v231, v231, v228
v_cvt_pk_bf16_f32 v193, v230, v231
v_lshlrev_b32 v230, 16, v194
v_and_b32 v231, 0xffff0000, v194
v_ldexp_f32 v230, v230, v228
v_ldexp_f32 v231, v231, v228
v_cvt_pk_bf16_f32 v194, v230, v231
v_lshlrev_b32 v230, 16, v195
v_and_b32 v231, 0xffff0000, v195
v_ldexp_f32 v230, v230, v228
v_ldexp_f32 v231, v231, v228
v_cvt_pk_bf16_f32 v195, v230, v231
v_lshlrev_b32 v230, 16, v196
v_and_b32 v231, 0xffff0000, v196
v_ldexp_f32 v230, v230, v229
v_ldexp_f32 v231, v231, v229
v_cvt_pk_bf16_f32 v196, v230, v231
v_lshlrev_b32 v230, 16, v197
v_and_b32 v231, 0xffff0000, v197
v_ldexp_f32 v230, v230, v229
v_ldexp_f32 v231, v231, v229
v_cvt_pk_bf16_f32 v197, v230, v231
v_lshlrev_b32 v230, 16, v198
v_and_b32 v231, 0xffff0000, v198
v_ldexp_f32 v230, v230, v229
v_ldexp_f32 v231, v231, v229
v_cvt_pk_bf16_f32 v198, v230, v231
v_lshlrev_b32 v230, 16, v199
v_and_b32 v231, 0xffff0000, v199
v_ldexp_f32 v230, v230, v229
v_ldexp_f32 v231, v231, v229
v_cvt_pk_bf16_f32 v199, v230, v231
v_exp_f32 v230, v120
v_exp_f32 v231, v121
v_exp_f32 v232, v122
v_exp_f32 v233, v123
v_cvt_pk_bf16_f32 v160, v230, v231
v_add_f32 v225, v230, v231
v_cvt_pk_bf16_f32 v161, v232, v233
v_add_f32 v225, v225, v232
v_add_f32 v225, v225, v233
v_exp_f32 v234, v124
v_exp_f32 v235, v125
v_exp_f32 v236, v126
v_exp_f32 v237, v127
v_cvt_pk_bf16_f32 v164, v234, v235
v_add_f32 v226, v234, v235
v_cvt_pk_bf16_f32 v165, v236, v237
v_add_f32 v226, v226, v236
v_add_f32 v226, v226, v237
v_exp_f32 v230, v128
v_exp_f32 v231, v129
v_exp_f32 v232, v130
v_exp_f32 v233, v131
v_cvt_pk_bf16_f32 v168, v230, v231
v_add_f32 v227, v230, v231
v_cvt_pk_bf16_f32 v169, v232, v233
v_add_f32 v227, v227, v232
v_add_f32 v227, v227, v233
v_exp_f32 v234, v132
v_exp_f32 v235, v133
v_exp_f32 v236, v134
v_exp_f32 v237, v135
v_cvt_pk_bf16_f32 v172, v234, v235
v_add_f32 v228, v234, v235
v_cvt_pk_bf16_f32 v173, v236, v237
v_add_f32 v228, v228, v236
v_add_f32 v228, v228, v237
v_exp_f32 v230, v136
v_exp_f32 v231, v137
v_exp_f32 v232, v138
v_exp_f32 v233, v139
v_cvt_pk_bf16_f32 v176, v230, v231
v_add_f32 v229, v230, v231
v_cvt_pk_bf16_f32 v177, v232, v233
v_add_f32 v229, v229, v232
v_add_f32 v229, v229, v233
s_nop 1
s_setpc_b64 s[50:51]
L_slowB0:
s_call_b64 s[80:81], L_slowC
v_lshlrev_b32 v230, 16, v160
v_and_b32 v231, 0xffff0000, v160
v_ldexp_f32 v230, v230, v225
v_ldexp_f32 v231, v231, v225
v_cvt_pk_bf16_f32 v160, v230, v231
v_lshlrev_b32 v230, 16, v161
v_and_b32 v231, 0xffff0000, v161
v_ldexp_f32 v230, v230, v225
v_ldexp_f32 v231, v231, v225
v_cvt_pk_bf16_f32 v161, v230, v231
v_lshlrev_b32 v230, 16, v164
v_and_b32 v231, 0xffff0000, v164
v_ldexp_f32 v230, v230, v226
v_ldexp_f32 v231, v231, v226
v_cvt_pk_bf16_f32 v164, v230, v231
v_lshlrev_b32 v230, 16, v165
v_and_b32 v231, 0xffff0000, v165
v_ldexp_f32 v230, v230, v226
v_ldexp_f32 v231, v231, v226
v_cvt_pk_bf16_f32 v165, v230, v231
v_lshlrev_b32 v230, 16, v168
v_and_b32 v231, 0xffff0000, v168
v_ldexp_f32 v230, v230, v227
v_ldexp_f32 v231, v231, v227
v_cvt_pk_bf16_f32 v168, v230, v231
v_lshlrev_b32 v230, 16, v169
v_and_b32 v231, 0xffff0000, v169
v_ldexp_f32 v230, v230, v227
v_ldexp_f32 v231, v231, v227
v_cvt_pk_bf16_f32 v169, v230, v231
v_lshlrev_b32 v230, 16, v172
v_and_b32 v231, 0xffff0000, v172
v_ldexp_f32 v230, v230, v228
v_ldexp_f32 v231, v231, v228
v_cvt_pk_bf16_f32 v172, v230, v231
v_lshlrev_b32 v230, 16, v173
v_and_b32 v231, 0xffff0000, v173
v_ldexp_f32 v230, v230, v228
v_ldexp_f32 v231, v231, v228
v_cvt_pk_bf16_f32 v173, v230, v231
v_lshlrev_b32 v230, 16, v176
v_and_b32 v231, 0xffff0000, v176
v_ldexp_f32 v230, v230, v229
v_ldexp_f32 v231, v231, v229
v_cvt_pk_bf16_f32 v176, v230, v231
v_lshlrev_b32 v230, 16, v177
v_and_b32 v231, 0xffff0000, v177
v_ldexp_f32 v230, v230, v229
v_ldexp_f32 v231, v231, v229
v_cvt_pk_bf16_f32 v177, v230, v231
v_exp_f32 v230, v140
v_exp_f32 v231, v141
v_exp_f32 v232, v142
v_exp_f32 v233, v143
v_cvt_pk_bf16_f32 v162, v230, v231
v_add_f32 v225, v230, v231
v_cvt_pk_bf16_f32 v163, v232, v233
v_add_f32 v225, v225, v232
v_add_f32 v225, v225, v233
v_exp_f32 v234, v144
v_exp_f32 v235, v145
v_exp_f32 v236, v146
v_exp_f32 v237, v147
v_cvt_pk_bf16_f32 v166, v234, v235
v_add_f32 v226, v234, v235
v_cvt_pk_bf16_f32 v167, v236, v237
v_add_f32 v226, v226, v236
v_add_f32 v226, v226, v237
v_exp_f32 v230, v148
v_exp_f32 v231, v149
v_exp_f32 v232, v150
v_exp_f32 v233, v151
v_cvt_pk_bf16_f32 v170, v230, v231
v_add_f32 v227, v230, v231
v_cvt_pk_bf16_f32 v171, v232, v233
v_add_f32 v227, v227, v232
v_add_f32 v227, v227, v233
v_exp_f32 v234, v152
v_exp_f32 v235, v153
v_exp_f32 v236, v154
v_exp_f32 v237, v155
v_cvt_pk_bf16_f32 v174, v234, v235
v_add_f32 v228, v234, v235
v_cvt_pk_bf16_f32 v175, v236, v237
v_add_f32 v228, v228, v236
v_add_f32 v228, v228, v237
v_exp_f32 v230, v156
v_exp_f32 v231, v157
v_exp_f32 v232, v158
v_exp_f32 v233, v159
v_cvt_pk_bf16_f32 v178, v230, v231
v_add_f32 v229, v230, v231
v_cvt_pk_bf16_f32 v179, v232, v233
v_add_f32 v229, v229, v232
v_add_f32 v229, v229, v233
s_nop 1
s_setpc_b64 s[50:51]
L_slowA1:
s_call_b64 s[80:81], L_slowC
v_lshlrev_b32 v230, 16, v160
v_and_b32 v231, 0xffff0000, v160
v_ldexp_f32 v230, v230, v225
v_ldexp_f32 v231, v231, v225
v_cvt_pk_bf16_f32 v160, v230, v231
v_lshlrev_b32 v230, 16, v161
v_and_b32 v231, 0xffff0000, v161
v_ldexp_f32 v230, v230, v225
v_ldexp_f32 v231, v231, v225
v_cvt_pk_bf16_f32 v161, v230, v231
v_lshlrev_b32 v230, 16, v162
v_and_b32 v231, 0xffff0000, v162
v_ldexp_f32 v230, v230, v225
v_ldexp_f32 v231, v231, v225
v_cvt_pk_bf16_f32 v162, v230, v231
v_lshlrev_b32 v230, 16, v163
v_and_b32 v231, 0xffff0000, v163
v_ldexp_f32 v230, v230, v225
v_ldexp_f32 v231, v231, v225
v_cvt_pk_bf16_f32 v163, v230, v231
v_lshlrev_b32 v230, 16, v164
v_and_b32 v231, 0xffff0000, v164
v_ldexp_f32 v230, v230, v226
v_ldexp_f32 v231, v231, v226
v_cvt_pk_bf16_f32 v164, v230, v231
v_lshlrev_b32 v230, 16, v165
v_and_b32 v231, 0xffff0000, v165
v_ldexp_f32 v230, v230, v226
v_ldexp_f32 v231, v231, v226
v_cvt_pk_bf16_f32 v165, v230, v231
v_lshlrev_b32 v230, 16, v166
v_and_b32 v231, 0xffff0000, v166
v_ldexp_f32 v230, v230, v226
v_ldexp_f32 v231, v231, v226
v_cvt_pk_bf16_f32 v166, v230, v231
v_lshlrev_b32 v230, 16, v167
v_and_b32 v231, 0xffff0000, v167
v_ldexp_f32 v230, v230, v226
v_ldexp_f32 v231, v231, v226
v_cvt_pk_bf16_f32 v167, v230, v231
v_lshlrev_b32 v230, 16, v168
v_and_b32 v231, 0xffff0000, v168
v_ldexp_f32 v230, v230, v227
v_ldexp_f32 v231, v231, v227
v_cvt_pk_bf16_f32 v168, v230, v231
v_lshlrev_b32 v230, 16, v169
v_and_b32 v231, 0xffff0000, v169
v_ldexp_f32 v230, v230, v227
v_ldexp_f32 v231, v231, v227
v_cvt_pk_bf16_f32 v169, v230, v231
v_lshlrev_b32 v230, 16, v170
v_and_b32 v231, 0xffff0000, v170
v_ldexp_f32 v230, v230, v227
v_ldexp_f32 v231, v231, v227
v_cvt_pk_bf16_f32 v170, v230, v231
v_lshlrev_b32 v230, 16, v171
v_and_b32 v231, 0xffff0000, v171
v_ldexp_f32 v230, v230, v227
v_ldexp_f32 v231, v231, v227
v_cvt_pk_bf16_f32 v171, v230, v231
v_lshlrev_b32 v230, 16, v172
v_and_b32 v231, 0xffff0000, v172
v_ldexp_f32 v230, v230, v228
v_ldexp_f32 v231, v231, v228
v_cvt_pk_bf16_f32 v172, v230, v231
v_lshlrev_b32 v230, 16, v173
v_and_b32 v231, 0xffff0000, v173
v_ldexp_f32 v230, v230, v228
v_ldexp_f32 v231, v231, v228
v_cvt_pk_bf16_f32 v173, v230, v231
v_lshlrev_b32 v230, 16, v174
v_and_b32 v231, 0xffff0000, v174
v_ldexp_f32 v230, v230, v228
v_ldexp_f32 v231, v231, v228
v_cvt_pk_bf16_f32 v174, v230, v231
v_lshlrev_b32 v230, 16, v175
v_and_b32 v231, 0xffff0000, v175
v_ldexp_f32 v230, v230, v228
v_ldexp_f32 v231, v231, v228
v_cvt_pk_bf16_f32 v175, v230, v231
v_lshlrev_b32 v230, 16, v176
v_and_b32 v231, 0xffff0000, v176
v_ldexp_f32 v230, v230, v229
v_ldexp_f32 v231, v231, v229
v_cvt_pk_bf16_f32 v176, v230, v231
v_lshlrev_b32 v230, 16, v177
v_and_b32 v231, 0xffff0000, v177
v_ldexp_f32 v230, v230, v229
v_ldexp_f32 v231, v231, v229
v_cvt_pk_bf16_f32 v177, v230, v231
v_lshlrev_b32 v230, 16, v178
v_and_b32 v231, 0xffff0000, v178
v_ldexp_f32 v230, v230, v229
v_ldexp_f32 v231, v231, v229
v_cvt_pk_bf16_f32 v178, v230, v231
v_lshlrev_b32 v230, 16, v179
v_and_b32 v231, 0xffff0000, v179
v_ldexp_f32 v230, v230, v229
v_ldexp_f32 v231, v231, v229
v_cvt_pk_bf16_f32 v179, v230, v231
v_exp_f32 v230, v120
v_exp_f32 v231, v121
v_exp_f32 v232, v122
v_exp_f32 v233, v123
v_cvt_pk_bf16_f32 v180, v230, v231
v_add_f32 v225, v230, v231
v_cvt_pk_bf16_f32 v181, v232, v233
v_add_f32 v225, v225, v232
v_add_f32 v225, v225, v233
v_exp_f32 v234, v124
v_exp_f32 v235, v125
v_exp_f32 v236, v126
v_exp_f32 v237, v127
v_cvt_pk_bf16_f32 v184, v234, v235
v_add_f32 v226, v234, v235
v_cvt_pk_bf16_f32 v185, v236, v237
v_add_f32 v226, v226, v236
v_add_f32 v226, v226, v237
v_exp_f32 v230, v128
v_exp_f32 v231, v129
v_exp_f32 v232, v130
v_exp_f32 v233, v131
v_cvt_pk_bf16_f32 v188, v230, v231
v_add_f32 v227, v230, v231
v_cvt_pk_bf16_f32 v189, v232, v233
v_add_f32 v227, v227, v232
v_add_f32 v227, v227, v233
v_exp_f32 v234, v132
v_exp_f32 v235, v133
v_exp_f32 v236, v134
v_exp_f32 v237, v135
v_cvt_pk_bf16_f32 v192, v234, v235
v_add_f32 v228, v234, v235
v_cvt_pk_bf16_f32 v193, v236, v237
v_add_f32 v228, v228, v236
v_add_f32 v228, v228, v237
v_exp_f32 v230, v136
v_exp_f32 v231, v137
v_exp_f32 v232, v138
v_exp_f32 v233, v139
v_cvt_pk_bf16_f32 v196, v230, v231
v_add_f32 v229, v230, v231
v_cvt_pk_bf16_f32 v197, v232, v233
v_add_f32 v229, v229, v232
v_add_f32 v229, v229, v233
s_nop 1
s_setpc_b64 s[50:51]
L_slowB1:
s_call_b64 s[80:81], L_slowC
v_lshlrev_b32 v230, 16, v180
v_and_b32 v231, 0xffff0000, v180
v_ldexp_f32 v230, v230, v225
v_ldexp_f32 v231, v231, v225
v_cvt_pk_bf16_f32 v180, v230, v231
v_lshlrev_b32 v230, 16, v181
v_and_b32 v231, 0xffff0000, v181
v_ldexp_f32 v230, v230, v225
v_ldexp_f32 v231, v231, v225
v_cvt_pk_bf16_f32 v181, v230, v231
v_lshlrev_b32 v230, 16, v184
v_and_b32 v231, 0xffff0000, v184
v_ldexp_f32 v230, v230, v226
v_ldexp_f32 v231, v231, v226
v_cvt_pk_bf16_f32 v184, v230, v231
v_lshlrev_b32 v230, 16, v185
v_and_b32 v231, 0xffff0000, v185
v_ldexp_f32 v230, v230, v226
v_ldexp_f32 v231, v231, v226
v_cvt_pk_bf16_f32 v185, v230, v231
v_lshlrev_b32 v230, 16, v188
v_and_b32 v231, 0xffff0000, v188
v_ldexp_f32 v230, v230, v227
v_ldexp_f32 v231, v231, v227
v_cvt_pk_bf16_f32 v188, v230, v231
v_lshlrev_b32 v230, 16, v189
v_and_b32 v231, 0xffff0000, v189
v_ldexp_f32 v230, v230, v227
v_ldexp_f32 v231, v231, v227
v_cvt_pk_bf16_f32 v189, v230, v231
v_lshlrev_b32 v230, 16, v192
v_and_b32 v231, 0xffff0000, v192
v_ldexp_f32 v230, v230, v228
v_ldexp_f32 v231, v231, v228
v_cvt_pk_bf16_f32 v192, v230, v231
v_lshlrev_b32 v230, 16, v193
v_and_b32 v231, 0xffff0000, v193
v_ldexp_f32 v230, v230, v228
v_ldexp_f32 v231, v231, v228
v_cvt_pk_bf16_f32 v193, v230, v231
v_lshlrev_b32 v230, 16, v196
v_and_b32 v231, 0xffff0000, v196
v_ldexp_f32 v230, v230, v229
v_ldexp_f32 v231, v231, v229
v_cvt_pk_bf16_f32 v196, v230, v231
v_lshlrev_b32 v230, 16, v197
v_and_b32 v231, 0xffff0000, v197
v_ldexp_f32 v230, v230, v229
v_ldexp_f32 v231, v231, v229
v_cvt_pk_bf16_f32 v197, v230, v231
v_exp_f32 v230, v140
v_exp_f32 v231, v141
v_exp_f32 v232, v142
v_exp_f32 v233, v143
v_cvt_pk_bf16_f32 v182, v230, v231
v_add_f32 v225, v230, v231
v_cvt_pk_bf16_f32 v183, v232, v233
v_add_f32 v225, v225, v232
v_add_f32 v225, v225, v233
v_exp_f32 v234, v144
v_exp_f32 v235, v145
v_exp_f32 v236, v146
v_exp_f32 v237, v147
v_cvt_pk_bf16_f32 v186, v234, v235
v_add_f32 v226, v234, v235
v_cvt_pk_bf16_f32 v187, v236, v237
v_add_f32 v226, v226, v236
v_add_f32 v226, v226, v237
v_exp_f32 v230, v148
v_exp_f32 v231, v149
v_exp_f32 v232, v150
v_exp_f32 v233, v151
v_cvt_pk_bf16_f32 v190, v230, v231
v_add_f32 v227, v230, v231
v_cvt_pk_bf16_f32 v191, v232, v233
v_add_f32 v227, v227, v232
v_add_f32 v227, v227, v233
v_exp_f32 v234, v152
v_exp_f32 v235, v153
v_exp_f32 v236, v154
v_exp_f32 v237, v155
v_cvt_pk_bf16_f32 v194, v234, v235
v_add_f32 v228, v234, v235
v_cvt_pk_bf16_f32 v195, v236, v237
v_add_f32 v228, v228, v236
v_add_f32 v228, v228, v237
v_exp_f32 v230, v156
v_exp_f32 v231, v157
v_exp_f32 v232, v158
v_exp_f32 v233, v159
v_cvt_pk_bf16_f32 v198, v230, v231
v_add_f32 v229, v230, v231
v_cvt_pk_bf16_f32 v199, v232, v233
v_add_f32 v229, v229, v232
v_add_f32 v229, v229, v233
s_nop 1
s_setpc_b64 s[50:51]
L_slowF:
s_call_b64 s[80:81], L_slowC
v_exp_f32 v230, v120
v_exp_f32 v231, v121
v_exp_f32 v232, v122
v_exp_f32 v233, v123
v_cvt_pk_bf16_f32 v160, v230, v231
v_add_f32 v225, v230, v231
v_cvt_pk_bf16_f32 v161, v232, v233
v_add_f32 v225, v225, v232
v_add_f32 v225, v225, v233
v_exp_f32 v234, v124
v_exp_f32 v235, v125
v_exp_f32 v236, v126
v_exp_f32 v237, v127
v_cvt_pk_bf16_f32 v164, v234, v235
v_add_f32 v226, v234, v235
v_cvt_pk_bf16_f32 v165, v236, v237
v_add_f32 v226, v226, v236
v_add_f32 v226, v226, v237
v_exp_f32 v230, v128
v_exp_f32 v231, v129
v_exp_f32 v232, v130
v_exp_f32 v233, v131
v_cvt_pk_bf16_f32 v168, v230, v231
v_add_f32 v227, v230, v231
v_cvt_pk_bf16_f32 v169, v232, v233
v_add_f32 v227, v227, v232
v_add_f32 v227, v227, v233
v_exp_f32 v234, v132
v_exp_f32 v235, v133
v_exp_f32 v236, v134
v_exp_f32 v237, v135
v_cvt_pk_bf16_f32 v172, v234, v235
v_add_f32 v228, v234, v235
v_cvt_pk_bf16_f32 v173, v236, v237
v_add_f32 v228, v228, v236
v_add_f32 v228, v228, v237
v_exp_f32 v230, v136
v_exp_f32 v231, v137
v_exp_f32 v232, v138
v_exp_f32 v233, v139
v_cvt_pk_bf16_f32 v176, v230, v231
v_add_f32 v229, v230, v231
v_cvt_pk_bf16_f32 v177, v232, v233
v_add_f32 v229, v229, v232
v_add_f32 v229, v229, v233
v_add_f32 v220, v220, v225
v_add_f32 v221, v221, v226
v_add_f32 v222, v222, v227
v_add_f32 v223, v223, v228
v_add_f32 v224, v224, v229
v_exp_f32 v230, v140
v_exp_f32 v231, v141
v_exp_f32 v232, v142
v_exp_f32 v233, v143
v_cvt_pk_bf16_f32 v162, v230, v231
v_add_f32 v225, v230, v231
v_cvt_pk_bf16_f32 v163, v232, v233
v_add_f32 v225, v225, v232
v_add_f32 v225, v225, v233
v_exp_f32 v234, v144
v_exp_f32 v235, v145
v_exp_f32 v236, v146
v_exp_f32 v237, v147
v_cvt_pk_bf16_f32 v166, v234, v235
v_add_f32 v226, v234, v235
v_cvt_pk_bf16_f32 v167, v236, v237
v_add_f32 v226, v226, v236
v_add_f32 v226, v226, v237
v_exp_f32 v230, v148
v_exp_f32 v231, v149
v_exp_f32 v232, v150
v_exp_f32 v233, v151
v_cvt_pk_bf16_f32 v170, v230, v231
v_add_f32 v227, v230, v231
v_cvt_pk_bf16_f32 v171, v232, v233
v_add_f32 v227, v227, v232
v_add_f32 v227, v227, v233
v_exp_f32 v234, v152
v_exp_f32 v235, v153
v_exp_f32 v236, v154
v_exp_f32 v237, v155
v_cvt_pk_bf16_f32 v174, v234, v235
v_add_f32 v228, v234, v235
v_cvt_pk_bf16_f32 v175, v236, v237
v_add_f32 v228, v228, v236
v_add_f32 v228, v228, v237
v_exp_f32 v230, v156
v_exp_f32 v231, v157
v_exp_f32 v232, v158
v_exp_f32 v233, v159
v_cvt_pk_bf16_f32 v178, v230, v231
v_add_f32 v229, v230, v231
v_cvt_pk_bf16_f32 v179, v232, v233
v_add_f32 v229, v229, v232
v_add_f32 v229, v229, v233
v_add_f32 v220, v220, v225
v_add_f32 v221, v221, v226
v_add_f32 v222, v222, v227
v_add_f32 v223, v223, v228
v_add_f32 v224, v224, v229
s_nop 1
s_setpc_b64 s[50:51]
L_concat_heads__mha_block_cached__gqa_block_cached__near_ridge_kernel_end:
.section .rodata,"a"
.p2align 6
.amdhsa_kernel concat_heads__mha_block_cached__gqa_block_cached__near_ridge_kernel
  .amdhsa_next_free_vgpr 512
  .amdhsa_next_free_sgpr 102
  .amdhsa_accum_offset 256
  .amdhsa_group_segment_fixed_size 0
  .amdhsa_kernarg_size 104
  .amdhsa_user_sgpr_count 2
  .amdhsa_user_sgpr_kernarg_segment_ptr 1
  .amdhsa_system_sgpr_workgroup_id_x 1
.end_amdhsa_kernel
```
